```python
import torch

def _softmax(x, axis=-1):
    return torch.softmax(x, dim=axis)
def _gelu(x):
    return torch.nn.functional.gelu(x, approximate="tanh")
def _silu(x):
    return torch.nn.functional.silu(x)
def _sigmoid(x):
    return torch.sigmoid(x)
def _layernorm(x, axis=-1, eps=1e-5):
    m = x.mean(dim=axis, keepdim=True)
    v = x.var(dim=axis, keepdim=True, unbiased=False)
    return (x - m) / torch.sqrt(v + eps)
def _scatter_add(tgt, idx, src, axis=0):
    return tgt.clone().index_add_(axis, idx, src)
def _segment_sum(src, seg, n):
    out = torch.zeros((n,) + src.shape[1:], dtype=src.dtype)
    return out.index_add_(0, seg, src)
def _pad(x, pw):
    flat = tuple(v for pair in reversed(pw) for v in pair)
    return torch.nn.functional.pad(x, flat)

kernel_name = 'parallel_sum__compressed_kv_cla__glu_gated_bilinear__prompt'

def setup_inputs():

    _w = (lambda a: (lambda t: t.to(torch.bfloat16) if t.is_floating_point() else t)(torch.as_tensor(a)))
    def _A_setup():
        B, H, Sq, Sk, D, M = 1, 16, 2048, 2048, 256, 448
        Dc = 4 * D
        return {
            "x": _w((lambda *s: torch.randn(*s, dtype=torch.bfloat16) * 0.05)(B, Sq, M)),
            "c_kv": _w((lambda *s: torch.randn(*s, dtype=torch.bfloat16) * 0.2)(B, Sk, Dc)),
            "w_q": _w((lambda *s: torch.randn(*s, dtype=torch.bfloat16) * 6.4)(M, H, D) * (M ** -0.5)),
            "w_uk": _w((lambda *s: torch.randn(*s, dtype=torch.bfloat16) * 6.4)(Dc, H, D) * (Dc ** -0.5)),
            "w_uv": _w((lambda *s: torch.randn(*s, dtype=torch.bfloat16) * 0.2)(Dc, H, D) * (Dc ** -0.5)),
            "w_o": _w((lambda *s: torch.randn(*s, dtype=torch.bfloat16) * 0.2)(H, D, M) * ((H * D) ** -0.5)),
        }
    _A_in = _A_setup()

    def _B_setup():
        B, S, D, F = 1, 2048, 448, 1792
        return {
            "x": _w((lambda *s: torch.randn(*s, dtype=torch.bfloat16) * 0.05)(B, S, D)),
            "w_gate": _w((lambda *s: torch.randn(*s, dtype=torch.bfloat16) * 0.2)(D, F) * (D ** -0.5)),
            "w_up": _w((lambda *s: torch.randn(*s, dtype=torch.bfloat16) * 0.2)(D, F) * (D ** -0.5)),
            "w_down": _w((lambda *s: torch.randn(*s, dtype=torch.bfloat16) * 0.2)(F, D) * (F ** -0.5)),
        }
    _B_in = _B_setup()

    return {
        "A_x": _A_in["x"],
        "A_c_kv": _A_in["c_kv"],
        "A_w_q": _A_in["w_q"],
        "A_w_uk": _A_in["w_uk"],
        "A_w_uv": _A_in["w_uv"],
        "A_w_o": _A_in["w_o"],
        "B_x": _B_in["x"],
        "B_w_gate": _B_in["w_gate"],
        "B_w_up": _B_in["w_up"],
        "B_w_down": _B_in["w_down"],
    }

def reference(A_x, A_c_kv, A_w_q, A_w_uk, A_w_uv, A_w_o, B_x, B_w_gate, B_w_up, B_w_down):
    def _A_ref(x, c_kv, w_q, w_uk, w_uv, w_o):
        B, Sq, M = x.shape[0], x.shape[1], x.shape[2]
        Sk = c_kv.shape[1]
        H, D = w_q.shape[1], w_q.shape[2]
        q = torch.einsum("bqm,mhd->bhqd", x, w_q)
        k = torch.einsum("bkc,chd->bhkd", c_kv, w_uk)
        v = torch.einsum("bkc,chd->bhkd", c_kv, w_uv)
        scores = torch.einsum("bhqd,bhkd->bhqk", q, k) * (D ** -0.5)
        off = Sk - Sq
        qi = torch.arange(Sq)[:, None]
        kj = torch.arange(Sk)[None, :]
        cmask = kj <= (qi + off)
        scores = torch.where(cmask[None, None], scores, -1e9)
        p = _softmax(scores, axis=-1)
        ctx = torch.einsum("bhqk,bhkd->bhqd", p, v)
        return torch.einsum("bhqd,hdm->bqm", ctx, w_o)

    def _B_ref(x, w_gate, w_up, w_down):
        g = torch.einsum("bsd,df->bsf", x, w_gate)
        u = torch.einsum("bsd,df->bsf", x, w_up)
        h = g * u
        return torch.einsum("bsf,fd->bsd", h, w_down)

    x = A_x
    xn = _layernorm(x, axis=-1)
    return x + _A_ref(xn, A_c_kv, A_w_q, A_w_uk, A_w_uv, A_w_o) + _B_ref(xn, B_w_gate, B_w_up, B_w_down)
```

```asm
; @launch kernel=fused_kernel grid=(256,1,1) block=(256,1,1) lds=163840
.amdgcn_target "amdgcn-amd-amdhsa--gfx950"
.text
.globl fused_kernel
.p2align 8
.type fused_kernel,@function
fused_kernel:
s_cmp_lt_u32 s2, 256
s_cbranch_scc1 fused_kernel_go
s_endpgm
fused_kernel_go:
s_load_dwordx16 s[72:87], s[0:1], 0
s_load_dwordx8 s[88:95], s[0:1], 64
s_load_dwordx2 s[96:97], s[0:1], 96
v_and_b32 v1, 63, v0
v_lshrrev_b32 v2, 6, v0
s_nop 0
v_readfirstlane_b32 s3, v2
s_waitcnt lgkmcnt(0)
s_mov_b32 s4, s96
s_and_b32 s5, s97, 0xffff
s_mov_b32 s6, 0x10000000
s_mov_b32 s7, 0x20000
s_cmp_lg_u32 s3, 3
s_cbranch_scc1 fused_kernel_nocp_1
s_getpc_b64 s[98:99]
fused_kernel_cp_2:
s_add_u32 s98, s98, fused_kernel_first0-fused_kernel_cp_2
s_addc_u32 s99, s99, 0
s_lshr_b32 s100, s2, 3
s_mul_i32 s101, s100, 4096
s_lshr_b32 s101, s101, 16
s_mul_i32 s101, s101, 16
s_sub_u32 s100, s100, s101
s_lshl_b32 s100, s100, 13
v_lshlrev_b32 v2, 7, v1
v_add_u32 v2, s100, v2
v_min_u32 v2, fused_kernel_codeend-fused_kernel_first0-256, v2
global_load_dword a255, v2, s[98:99]
fused_kernel_nocp_1:
s_and_b32 s60, s2, 7
s_lshr_b32 s61, s2, 3
s_lshr_b32 s62, s61, 4
s_lshl_b32 s48, s60, 1
s_add_u32 s48, s48, s62
s_and_b32 s49, s61, 1
s_bfe_u32 s66, s61, 0x30001
s_lshr_b32 s47, s66, 2
s_and_b32 s59, s66, 3
s_lshl_b32 s67, s49, 2
s_add_u32 s59, s59, s67
s_lshl_b32 s62, s62, 3
s_add_u32 s62, s62, s66
s_cmp_lt_u32 s62, 14
s_cselect_b32 s63, 1, 0
s_mul_i32 s60, s60, 14
s_add_u32 s60, s60, s62
s_min_u32 s60, s60, 111
s_lshr_b32 s19, s60, 3
s_and_b32 s55, s60, 7
s_cmp_eq_u32 s49, 1
s_cselect_b32 s55, s66, s55
s_cselect_b32 s63, 0, s63
s_and_b32 s50, s3, 1
s_lshr_b32 s51, s3, 1
v_mov_b32 v32, 0x40000000
v_mov_b32 v96, 0x40000000
s_cmp_eq_u32 s49, 1
s_cbranch_scc0 fused_kernel_noxl0_3
s_lshl_b32 s66, s55, 8
s_lshl_b32 s67, s48, 4
s_add_u32 s71, s66, s67
s_mov_b32 s40, s71
s_lshl_b32 s60, s3, 1
s_add_u32 s40, s40, s60
v_mov_b32 v32, s40
s_movk_i32 s40, 896
v_mul_lo_u32 v32, v32, s40
v_lshl_add_u32 v32, v1, 4, v32
v_cmp_gt_u32 vcc, 56, v1
v_mov_b32 v33, 0x40000000
s_nop 0
v_cndmask_b32 v32, v33, v32, vcc
s_mov_b32 s64, s72
s_and_b32 s65, s73, 0xffff
s_mov_b32 s66, 0x1c0000
s_mov_b32 s67, 0x20000
buffer_load_dwordx4 v[36:39], v32, s[64:67], 0 offen
buffer_load_dwordx4 v[40:43], v32, s[64:67], 0 offen offset:896
s_add_u32 s71, s71, 8
s_mov_b32 s40, s71
s_lshl_b32 s60, s3, 1
s_add_u32 s40, s40, s60
v_mov_b32 v96, s40
s_movk_i32 s40, 896
v_mul_lo_u32 v96, v96, s40
v_lshl_add_u32 v96, v1, 4, v96
v_cmp_gt_u32 vcc, 56, v1
v_mov_b32 v97, 0x40000000
s_nop 0
v_cndmask_b32 v96, v97, v96, vcc
s_mov_b32 s64, s72
s_and_b32 s65, s73, 0xffff
s_mov_b32 s66, 0x1c0000
s_mov_b32 s67, 0x20000
buffer_load_dwordx4 v[100:103], v96, s[64:67], 0 offen
buffer_load_dwordx4 v[104:107], v96, s[64:67], 0 offen offset:896
fused_kernel_noxl0_3:
s_cmp_eq_u32 s47, 0
s_cselect_b32 s60, s78, s80
s_cselect_b32 s61, s79, s81
s_cmp_eq_u32 s51, 0
s_cselect_b32 s66, s86, s88
s_cselect_b32 s67, s87, s89
s_add_u32 s68, s96, 0x0
s_addc_u32 s69, s97, 0
s_cmp_eq_u32 s49, 1
s_cselect_b32 s66, s76, s66
s_cselect_b32 s67, s77, s67
s_mov_b32 s70, 0x188000
s_cselect_b32 s70, 0x380000, s70
s_mov_b32 s71, 0x1c0000
s_mov_b32 s62, 0x400000
s_mov_b32 s40, 0x800000
s_cmp_eq_u32 s49, 1
s_cselect_b32 s8, s68, s74
s_cselect_b32 s9, s69, s75
s_cselect_b32 s10, s71, s62
s_cselect_b32 s20, s74, s68
s_cselect_b32 s21, s75, s69
s_cselect_b32 s22, s62, s71
s_cselect_b32 s12, s66, s60
s_cselect_b32 s13, s67, s61
s_cselect_b32 s14, s70, s40
s_cselect_b32 s24, s60, s66
s_cselect_b32 s25, s61, s67
s_cselect_b32 s26, s40, s70
s_and_b32 s9, s9, 0xffff
s_mov_b32 s11, 0x20000
s_and_b32 s21, s21, 0xffff
s_mov_b32 s23, 0x20000
s_and_b32 s13, s13, 0xffff
s_mov_b32 s15, 0x20000
s_and_b32 s25, s25, 0xffff
s_mov_b32 s27, 0x20000
s_lshl_b32 s40, s51, 4
s_lshl_b32 s60, s50, 3
s_add_u32 s40, s40, s60
s_lshl_b32 s60, s59, 8
s_add_u32 s60, s60, s40
s_lshl_b32 s60, s60, 11
s_lshl_b32 s61, s55, 8
s_add_u32 s61, s61, s40
s_mul_i32 s61, s61, 896
s_lshl_b32 s35, s40, 7
s_mov_b32 s34, s35
s_add_u32 s36, s35, 98304
s_lshl_b32 s66, s48, 9
s_lshl_b32 s67, s51, 8
s_add_u32 s66, s66, s67
s_lshl_b32 s67, s50, 16
s_add_u32 s66, s66, s67
s_lshl_b32 s67, s19, 8
s_mul_i32 s68, s50, 28672
s_add_u32 s67, s67, s68
s_cmp_eq_u32 s49, 1
s_cselect_b32 s28, s61, s60
s_cselect_b32 s52, s60, s61
s_cselect_b32 s31, s66, s66
s_cselect_b32 s53, s66, s67
s_mov_b32 s60, 65536
s_mov_b32 s61, 28672
s_mov_b32 s66, 4294508672
s_mov_b32 s67, 4294766720
s_cselect_b32 s29, s61, s60
s_cselect_b32 s54, s60, s61
s_cselect_b32 s30, s67, s66
s_cselect_b32 s16, s66, s67
s_mov_b32 s32, 32768
s_mov_b32 s33, 98304
s_mov_b32 s60, 14336
s_mov_b32 s61, 43008
s_cselect_b32 s17, s32, s60
s_cselect_b32 s18, s33, s61
s_lshl_b32 s40, s51, 13
s_lshl_b32 s60, s50, 11
s_add_u32 s40, s40, s60
s_add_u32 s43, s40, 98304
s_lshl_b32 s60, s48, 6
s_lshl_b32 s61, s50, 2
s_add_u32 s60, s60, s61
s_lshl_b32 s61, s51, 11
s_lshl_b32 s66, s59, 3
s_add_u32 s66, s66, s60
s_lshl_b32 s66, s66, 14
s_add_u32 s66, s66, s61
s_mov_b32 s67, 0x2200000
s_cmp_eq_u32 s47, 0
s_cselect_b32 s67, 0x1200000, s67
s_add_u32 s44, s66, s67
s_lshl_b32 s66, s55, 3
s_add_u32 s66, s66, s60
s_lshl_b32 s66, s66, 14
s_add_u32 s66, s66, s61
s_add_u32 s45, s66, 0x200000
s_lshl_b32 s66, s55, 4
s_lshl_b32 s67, s50, 3
s_add_u32 s66, s66, s67
s_mul_i32 s66, s66, 184
s_lshl_b32 s67, s19, 2
s_add_u32 s66, s66, s67
s_lshl_b32 s67, s51, 1
s_add_u32 s66, s66, s67
s_add_u32 s66, s66, 128
s_lshl_b32 s66, s66, 10
s_add_u32 s46, s66, 0x3200000
s_mov_b32 s56, 0x3db8aa3b
s_mov_b32 s57, 0x3db8aa3b
s_mov_b32 s41, 0
s_mov_b32 s42, 98304
s_mov_b32 s37, 0
s_mov_b32 s38, 0
v_lshrrev_b32 v21, 4, v1
v_and_b32 v20, 15, v1
v_lshrrev_b32 v22, 1, v20
v_xor_b32 v23, v21, v22
s_lshl_b32 s40, s50, 14
v_lshlrev_b32 v24, 7, v20
v_add_u32 v24, s40, v24
v_lshl_add_u32 v4, v23, 4, v24
v_xor_b32 v5, 64, v4
v_lshrrev_b32 v22, 2, v20
v_and_b32 v23, 3, v1
v_and_b32 v24, 1, v21
v_lshl_or_b32 v24, v24, 2, v22
v_lshl_add_u32 v25, v21, 3, v22
v_lshlrev_b32 v25, 8, v25
v_lshl_add_u32 v25, v23, 3, v25
v_add_u32 v25, 98304, v25
s_lshl_b32 s40, s51, 2
s_add_u32 s60, s40, 0
v_xor_b32 v26, s60, v24
v_lshl_add_u32 v8, v26, 5, v25
s_add_u32 s60, s40, 1
v_xor_b32 v26, s60, v24
v_lshl_add_u32 v9, v26, 5, v25
s_add_u32 s60, s40, 2
v_xor_b32 v26, s60, v24
v_lshl_add_u32 v10, v26, 5, v25
s_add_u32 s60, s40, 3
v_xor_b32 v26, s60, v24
v_lshl_add_u32 v11, v26, 5, v25
v_lshlrev_b32 v12, 4, v1
s_mov_b32 s64, s94
s_and_b32 s65, s95, 0xffff
s_mov_b32 s66, 0x100
s_mov_b32 s67, 0x20000
s_cmp_eq_u32 s49, 1
s_cbranch_scc1 fused_kernel_clsq
v_lshrrev_b32 v28, 4, v1
s_lshl_b32 s40, s50, 2
v_add_u32 v28, s40, v28
v_and_b32 v2, 7, v1
v_xor_b32 v2, v2, v28
v_lshlrev_b32 v2, 4, v2
v_lshrrev_b32 v29, 3, v1
s_movk_i32 s40, 2048
v_mul_lo_u32 v29, v29, s40
v_add_u32 v2, v2, v29
v_lshrrev_b32 v28, 4, v1
s_lshl_b32 s40, s50, 2
v_add_u32 v28, s40, v28
v_and_b32 v3, 15, v1
v_lshlrev_b32 v28, 1, v28
v_xor_b32 v3, v3, v28
v_lshlrev_b32 v3, 4, v3
v_lshrrev_b32 v29, 4, v1
s_movk_i32 s40, 8192
v_mul_lo_u32 v29, v29, s40
v_add_u32 v3, v3, v29
s_add_u32 m0, s34, 0
s_nop 0
buffer_load_dwordx4 v2, s[8:11], s28 offen lds
s_add_u32 s28, s28, s29
s_add_u32 m0, s34, 4096
s_nop 0
buffer_load_dwordx4 v2, s[8:11], s28 offen lds
s_add_u32 s28, s28, s29
s_add_u32 m0, s34, 8192
s_nop 0
buffer_load_dwordx4 v2, s[8:11], s28 offen lds
s_add_u32 s28, s28, s29
s_add_u32 m0, s34, 12288
s_nop 0
buffer_load_dwordx4 v2, s[8:11], s28 offen lds
s_add_u32 s28, s28, s29
s_add_u32 m0, s34, 16384
s_nop 0
buffer_load_dwordx4 v2, s[8:11], s28 offen lds
s_add_u32 s28, s28, s29
s_add_u32 m0, s34, 20480
s_nop 0
buffer_load_dwordx4 v2, s[8:11], s28 offen lds
s_add_u32 s28, s28, s29
s_add_u32 m0, s34, 24576
s_nop 0
buffer_load_dwordx4 v2, s[8:11], s28 offen lds
s_add_u32 s28, s28, s29
s_add_u32 m0, s34, 28672
s_nop 0
buffer_load_dwordx4 v2, s[8:11], s28 offen lds
s_add_u32 s28, s28, s30
s_add_u32 s34, s34, 32768
s_cmp_ge_u32 s34, s36
s_cselect_b32 s34, s35, s34
s_add_u32 m0, s43, 0
s_nop 0
buffer_load_dwordx4 v3, s[12:15], s31 offen lds
s_add_u32 s31, s31, s32
s_add_u32 m0, s43, 1024
s_nop 0
buffer_load_dwordx4 v3, s[12:15], s31 offen lds
s_add_u32 s31, s31, s33
s_add_u32 m0, s43, 4096
s_nop 0
buffer_load_dwordx4 v3, s[12:15], s31 offen lds
s_add_u32 s31, s31, s32
s_add_u32 m0, s43, 5120
s_nop 0
buffer_load_dwordx4 v3, s[12:15], s31 offen lds
s_add_u32 s31, s31, s33
s_add_u32 m0, s34, 0
s_nop 0
buffer_load_dwordx4 v2, s[8:11], s28 offen lds
s_add_u32 s28, s28, s29
s_add_u32 m0, s34, 4096
s_nop 0
buffer_load_dwordx4 v2, s[8:11], s28 offen lds
s_add_u32 s28, s28, s29
s_add_u32 m0, s34, 8192
s_nop 0
buffer_load_dwordx4 v2, s[8:11], s28 offen lds
s_add_u32 s28, s28, s29
s_add_u32 m0, s34, 12288
s_nop 0
buffer_load_dwordx4 v2, s[8:11], s28 offen lds
s_add_u32 s28, s28, s29
s_add_u32 m0, s43, 16384
s_nop 0
buffer_load_dwordx4 v3, s[12:15], s31 offen lds
s_add_u32 s31, s31, s32
s_add_u32 m0, s43, 17408
s_nop 0
buffer_load_dwordx4 v3, s[12:15], s31 offen lds
s_add_u32 s31, s31, s33
s_add_u32 m0, s43, 20480
s_nop 0
buffer_load_dwordx4 v3, s[12:15], s31 offen lds
s_add_u32 s31, s31, s32
s_add_u32 m0, s43, 21504
s_nop 0
buffer_load_dwordx4 v3, s[12:15], s31 offen lds
s_add_u32 s31, s31, s33
s_add_u32 m0, s34, 16384
s_nop 0
buffer_load_dwordx4 v2, s[8:11], s28 offen lds
s_add_u32 s28, s28, s29
s_add_u32 m0, s34, 20480
s_nop 0
buffer_load_dwordx4 v2, s[8:11], s28 offen lds
s_add_u32 s28, s28, s29
s_add_u32 m0, s34, 24576
s_nop 0
buffer_load_dwordx4 v2, s[8:11], s28 offen lds
s_add_u32 s28, s28, s29
s_add_u32 m0, s34, 28672
s_nop 0
buffer_load_dwordx4 v2, s[8:11], s28 offen lds
s_add_u32 s28, s28, s30
s_add_u32 s34, s34, 32768
s_cmp_ge_u32 s34, s36
s_cselect_b32 s34, s35, s34
s_add_u32 m0, s43, 32768
s_nop 0
buffer_load_dwordx4 v3, s[12:15], s31 offen lds
s_add_u32 s31, s31, s32
s_add_u32 m0, s43, 33792
s_nop 0
buffer_load_dwordx4 v3, s[12:15], s31 offen lds
s_add_u32 s31, s31, s33
s_add_u32 m0, s43, 36864
s_nop 0
buffer_load_dwordx4 v3, s[12:15], s31 offen lds
s_add_u32 s31, s31, s32
s_add_u32 m0, s43, 37888
s_nop 0
buffer_load_dwordx4 v3, s[12:15], s31 offen lds
s_add_u32 s31, s31, s33
s_add_u32 m0, s34, 0
s_nop 0
buffer_load_dwordx4 v2, s[8:11], s28 offen lds
s_add_u32 s28, s28, s29
s_add_u32 m0, s34, 4096
s_nop 0
buffer_load_dwordx4 v2, s[8:11], s28 offen lds
s_add_u32 s28, s28, s29
s_add_u32 m0, s34, 8192
s_nop 0
buffer_load_dwordx4 v2, s[8:11], s28 offen lds
s_add_u32 s28, s28, s29
s_add_u32 m0, s34, 12288
s_nop 0
buffer_load_dwordx4 v2, s[8:11], s28 offen lds
s_add_u32 s28, s28, s29
s_add_u32 m0, s43, 49152
s_nop 0
buffer_load_dwordx4 v3, s[12:15], s31 offen lds
s_add_u32 s31, s31, s32
s_add_u32 m0, s43, 50176
s_nop 0
buffer_load_dwordx4 v3, s[12:15], s31 offen lds
s_add_u32 s31, s31, s33
s_add_u32 m0, s43, 53248
s_nop 0
buffer_load_dwordx4 v3, s[12:15], s31 offen lds
s_add_u32 s31, s31, s32
s_add_u32 m0, s43, 54272
s_nop 0
buffer_load_dwordx4 v3, s[12:15], s31 offen lds
s_add_u32 s31, s31, s33
s_cmp_ge_u32 s3, 2
s_cbranch_scc1 tch_a_4
s_mov_b32 s68, s12
s_mov_b32 s69, s13
s_mov_b32 s70, s14
s_mov_b32 s71, 0x20000
v_lshrrev_b32 v13, 2, v1
v_lshlrev_b32 v13, 13, v13
v_and_b32 v0, 3, v1
v_lshl_add_u32 v13, v0, 7, v13
s_bfe_u32 s40, s2, 0x20004
s_lshl_b32 s40, s40, 5
s_lshl_b32 s60, s3, 4
s_add_u32 s40, s40, s60
s_add_u32 s40, s40, 256
s_lshl_b32 s40, s40, 13
s_lshl_b32 s60, s48, 9
s_add_u32 s84, s40, s60
s_mov_b32 s85, 1048576
s_branch tch_done_5
tch_a_4:
s_mov_b32 s68, s8
s_mov_b32 s69, s9
s_mov_b32 s70, s10
s_mov_b32 s71, 0x20000
v_min_u32 v13, 15, v1
v_lshrrev_b32 v0, 1, v13
v_lshlrev_b32 v0, 11, v0
v_and_b32 v13, 1, v13
v_lshl_add_u32 v13, v13, 7, v0
s_lshl_b32 s40, s47, 1
s_and_b32 s60, s48, 1
s_add_u32 s40, s40, s60
s_lshl_b32 s40, s40, 3
s_and_b32 s60, s2, 7
s_add_u32 s40, s40, s60
s_bfe_u32 s60, s2, 0x20004
s_lshl_b32 s61, s49, 2
s_add_u32 s60, s60, s61
s_lshl_b32 s40, s40, 3
s_lshl_b32 s60, s60, 8
s_add_u32 s40, s40, s60
s_lshl_b32 s40, s40, 11
s_add_u32 s84, s40, 512
s_movk_i32 s85, 256
s_cmp_eq_u32 s3, 3
s_cselect_b32 s84, 0x70000000, s84
tch_done_5:
s_mul_i32 s40, s55, 56
s_and_b32 s60, s3, 1
s_mul_i32 s60, s60, 28
s_add_u32 s40, s40, s60
s_mul_i32 s40, s40, 3584
s_lshl_b32 s60, s19, 8
s_add_u32 s40, s40, s60
v_lshrrev_b32 v0, 1, v1
v_min_u32 v0, 27, v0
s_movk_i32 s60, 3584
v_mul_lo_u32 v0, v0, s60
v_and_b32 v14, 1, v1
v_lshl_add_u32 v0, v14, 7, v0
buffer_load_dword a254, v0, s[24:27], s40 offen
s_waitcnt vmcnt(24)
s_barrier
v_add_u32 v6, s37, v4
s_add_u32 s37, s37, 32768
s_cmp_ge_u32 s37, s42
s_cselect_b32 s37, s41, s37
ds_read_b64_tr_b16 a[32:33], v8 offset:0
ds_read_b64_tr_b16 a[34:35], v8 offset:1024
ds_read_b128 a[0:3], v6 offset:0
ds_read_b128 a[4:7], v6 offset:2048
ds_read_b128 a[8:11], v6 offset:4096
ds_read_b128 a[12:15], v6 offset:6144
ds_read_b128 a[16:19], v6 offset:8192
ds_read_b128 a[20:23], v6 offset:10240
ds_read_b128 a[24:27], v6 offset:12288
ds_read_b128 a[28:31], v6 offset:14336
ds_read_b64_tr_b16 a[36:37], v9 offset:0
ds_read_b64_tr_b16 a[38:39], v9 offset:1024
ds_read_b64_tr_b16 a[40:41], v10 offset:0
ds_read_b64_tr_b16 a[42:43], v10 offset:1024
ds_read_b64_tr_b16 a[44:45], v11 offset:0
ds_read_b64_tr_b16 a[46:47], v11 offset:1024
ds_read_b64_tr_b16 a[48:49], v8 offset:8192
ds_read_b64_tr_b16 a[50:51], v8 offset:9216
ds_read_b64_tr_b16 a[52:53], v9 offset:8192
ds_read_b64_tr_b16 a[54:55], v9 offset:9216
ds_read_b64_tr_b16 a[56:57], v10 offset:8192
ds_read_b64_tr_b16 a[58:59], v10 offset:9216
ds_read_b64_tr_b16 a[60:61], v11 offset:8192
ds_read_b64_tr_b16 a[62:63], v11 offset:9216
s_mov_b32 s39, 6
s_mov_b32 s58, 0
s_cmp_eq_u32 s47, 1
s_cbranch_scc1 fused_kernel_first1
fused_kernel_first0:
s_waitcnt vmcnt(16) lgkmcnt(0)
s_barrier
v_mfma_f32_16x16x32_bf16 v[16:19], a[32:35], a[0:3], 0
v_add_u32 v7, s38, v5
s_add_u32 m0, s34, 16384
v_mfma_f32_16x16x32_bf16 v[24:27], a[32:35], a[4:7], 0
ds_read_b64_tr_b16 a[96:97], v8 offset:16384
buffer_load_dwordx4 v2, s[8:11], s28 offen lds
v_mfma_f32_16x16x32_bf16 v[32:35], a[32:35], a[8:11], 0
ds_read_b64_tr_b16 a[98:99], v8 offset:17408
v_mfma_f32_16x16x32_bf16 v[40:43], a[32:35], a[12:15], 0
s_add_u32 s28, s28, s29
v_mfma_f32_16x16x32_bf16 v[48:51], a[32:35], a[16:19], 0
ds_read_b128 a[64:67], v7 offset:0
v_mfma_f32_16x16x32_bf16 v[56:59], a[32:35], a[20:23], 0
ds_read_b128 a[68:71], v7 offset:2048
s_add_u32 m0, s34, 20480
v_mfma_f32_16x16x32_bf16 v[64:67], a[32:35], a[24:27], 0
v_mfma_f32_16x16x32_bf16 v[72:75], a[32:35], a[28:31], 0
ds_read_b128 a[72:75], v7 offset:4096
buffer_load_dwordx4 v2, s[8:11], s28 offen lds
v_mfma_f32_16x16x32_bf16 v[20:23], a[36:39], a[0:3], 0
v_mfma_f32_16x16x32_bf16 v[28:31], a[36:39], a[4:7], 0
ds_read_b128 a[76:79], v7 offset:6144
s_add_u32 s28, s28, s29
v_mfma_f32_16x16x32_bf16 v[36:39], a[36:39], a[8:11], 0
ds_read_b128 a[80:83], v7 offset:8192
v_mfma_f32_16x16x32_bf16 v[44:47], a[36:39], a[12:15], 0
s_add_u32 m0, s34, 24576
v_mfma_f32_16x16x32_bf16 v[52:55], a[36:39], a[16:19], 0
ds_read_b128 a[84:87], v7 offset:10240
v_mfma_f32_16x16x32_bf16 v[60:63], a[36:39], a[20:23], 0
buffer_load_dwordx4 v2, s[8:11], s28 offen lds
v_mfma_f32_16x16x32_bf16 v[68:71], a[36:39], a[24:27], 0
ds_read_b128 a[88:91], v7 offset:12288
v_mfma_f32_16x16x32_bf16 v[76:79], a[36:39], a[28:31], 0
ds_read_b128 a[92:95], v7 offset:14336
s_add_u32 s28, s28, s29
v_mfma_f32_16x16x32_bf16 v[80:83], a[40:43], a[0:3], 0
v_mfma_f32_16x16x32_bf16 v[88:91], a[40:43], a[4:7], 0
ds_read_b64_tr_b16 a[100:101], v9 offset:16384
s_add_u32 m0, s34, 28672
v_mfma_f32_16x16x32_bf16 v[96:99], a[40:43], a[8:11], 0
ds_read_b64_tr_b16 a[102:103], v9 offset:17408
v_mfma_f32_16x16x32_bf16 v[104:107], a[40:43], a[12:15], 0
buffer_load_dwordx4 v2, s[8:11], s28 offen lds
v_mfma_f32_16x16x32_bf16 v[112:115], a[40:43], a[16:19], 0
ds_read_b64_tr_b16 a[104:105], v10 offset:16384
v_mfma_f32_16x16x32_bf16 v[120:123], a[40:43], a[20:23], 0
s_add_u32 s28, s28, s30
v_mfma_f32_16x16x32_bf16 v[128:131], a[40:43], a[24:27], 0
ds_read_b64_tr_b16 a[106:107], v10 offset:17408
v_mfma_f32_16x16x32_bf16 v[136:139], a[40:43], a[28:31], 0
ds_read_b64_tr_b16 a[108:109], v11 offset:16384
s_add_u32 s34, s34, 32768
v_mfma_f32_16x16x32_bf16 v[84:87], a[44:47], a[0:3], 0
v_mfma_f32_16x16x32_bf16 v[92:95], a[44:47], a[4:7], 0
ds_read_b64_tr_b16 a[110:111], v11 offset:17408
s_cmp_ge_u32 s34, s36
v_mfma_f32_16x16x32_bf16 v[100:103], a[44:47], a[8:11], 0
v_mfma_f32_16x16x32_bf16 v[108:111], a[44:47], a[12:15], 0
ds_read_b64_tr_b16 a[112:113], v8 offset:24576
s_cselect_b32 s34, s35, s34
v_mfma_f32_16x16x32_bf16 v[116:119], a[44:47], a[16:19], 0
ds_read_b64_tr_b16 a[114:115], v8 offset:25600
v_mfma_f32_16x16x32_bf16 v[124:127], a[44:47], a[20:23], 0
s_add_u32 m0, s43, 0
v_mfma_f32_16x16x32_bf16 v[132:135], a[44:47], a[24:27], 0
ds_read_b64_tr_b16 a[116:117], v9 offset:24576
v_mfma_f32_16x16x32_bf16 v[140:143], a[44:47], a[28:31], 0
ds_read_b64_tr_b16 a[118:119], v9 offset:25600
buffer_load_dwordx4 v3, s[12:15], s31 offen lds
v_mfma_f32_16x16x32_bf16 v[144:147], a[48:51], a[0:3], 0
v_mfma_f32_16x16x32_bf16 v[152:155], a[48:51], a[4:7], 0
ds_read_b64_tr_b16 a[120:121], v10 offset:24576
s_add_u32 s31, s31, s32
v_mfma_f32_16x16x32_bf16 v[160:163], a[48:51], a[8:11], 0
v_mfma_f32_16x16x32_bf16 v[168:171], a[48:51], a[12:15], 0
ds_read_b64_tr_b16 a[122:123], v10 offset:25600
s_add_u32 m0, s43, 1024
v_mfma_f32_16x16x32_bf16 v[176:179], a[48:51], a[16:19], 0
ds_read_b64_tr_b16 a[124:125], v11 offset:24576
v_mfma_f32_16x16x32_bf16 v[184:187], a[48:51], a[20:23], 0
buffer_load_dwordx4 v3, s[12:15], s31 offen lds
v_mfma_f32_16x16x32_bf16 v[192:195], a[48:51], a[24:27], 0
ds_read_b64_tr_b16 a[126:127], v11 offset:25600
v_mfma_f32_16x16x32_bf16 v[200:203], a[48:51], a[28:31], 0
s_add_u32 s31, s31, s33
v_mfma_f32_16x16x32_bf16 v[148:151], a[52:55], a[0:3], 0
v_mfma_f32_16x16x32_bf16 v[156:159], a[52:55], a[4:7], 0
s_add_u32 m0, s43, 4096
v_mfma_f32_16x16x32_bf16 v[164:167], a[52:55], a[8:11], 0
v_mfma_f32_16x16x32_bf16 v[172:175], a[52:55], a[12:15], 0
buffer_load_dwordx4 v3, s[12:15], s31 offen lds
v_mfma_f32_16x16x32_bf16 v[180:183], a[52:55], a[16:19], 0
v_mfma_f32_16x16x32_bf16 v[188:191], a[52:55], a[20:23], 0
s_add_u32 s31, s31, s32
v_mfma_f32_16x16x32_bf16 v[196:199], a[52:55], a[24:27], 0
v_mfma_f32_16x16x32_bf16 v[204:207], a[52:55], a[28:31], 0
s_add_u32 m0, s43, 5120
v_mfma_f32_16x16x32_bf16 v[208:211], a[56:59], a[0:3], 0
v_mfma_f32_16x16x32_bf16 v[216:219], a[56:59], a[4:7], 0
buffer_load_dwordx4 v3, s[12:15], s31 offen lds
v_mfma_f32_16x16x32_bf16 v[224:227], a[56:59], a[8:11], 0
v_mfma_f32_16x16x32_bf16 v[232:235], a[56:59], a[12:15], 0
s_add_u32 s31, s31, s33
v_mfma_f32_16x16x32_bf16 v[240:243], a[56:59], a[16:19], 0
v_mfma_f32_16x16x32_bf16 v[248:251], a[56:59], a[20:23], 0
s_add_u32 s38, s38, 32768
v_mfma_f32_16x16x32_bf16 a[128:131], a[56:59], a[24:27], 0
v_mfma_f32_16x16x32_bf16 a[136:139], a[56:59], a[28:31], 0
s_cmp_ge_u32 s38, s42
v_mfma_f32_16x16x32_bf16 v[212:215], a[60:63], a[0:3], 0
v_mfma_f32_16x16x32_bf16 v[220:223], a[60:63], a[4:7], 0
s_cselect_b32 s38, s41, s38
v_mfma_f32_16x16x32_bf16 v[228:231], a[60:63], a[8:11], 0
v_mfma_f32_16x16x32_bf16 v[236:239], a[60:63], a[12:15], 0
buffer_load_dword v0, v13, s[68:71], s84 offen
v_mfma_f32_16x16x32_bf16 v[244:247], a[60:63], a[16:19], 0
v_mfma_f32_16x16x32_bf16 v[252:255], a[60:63], a[20:23], 0
s_add_u32 s84, s84, s85
v_mfma_f32_16x16x32_bf16 a[132:135], a[60:63], a[24:27], 0
v_mfma_f32_16x16x32_bf16 a[140:143], a[60:63], a[28:31], 0
s_waitcnt vmcnt(16) lgkmcnt(0)
s_barrier
v_mfma_f32_16x16x32_bf16 v[16:19], a[96:99], a[64:67], v[16:19]
v_add_u32 v6, s37, v4
s_add_u32 m0, s34, 0
v_mfma_f32_16x16x32_bf16 v[24:27], a[96:99], a[68:71], v[24:27]
ds_read_b64_tr_b16 a[32:33], v8 offset:32768
v_mfma_f32_16x16x32_bf16 v[32:35], a[96:99], a[72:75], v[32:35]
ds_read_b64_tr_b16 a[34:35], v8 offset:33792
buffer_load_dwordx4 v2, s[8:11], s28 offen lds
v_mfma_f32_16x16x32_bf16 v[40:43], a[96:99], a[76:79], v[40:43]
v_mfma_f32_16x16x32_bf16 v[48:51], a[96:99], a[80:83], v[48:51]
ds_read_b128 a[0:3], v6 offset:0
s_add_u32 s28, s28, s29
v_mfma_f32_16x16x32_bf16 v[56:59], a[96:99], a[84:87], v[56:59]
ds_read_b128 a[4:7], v6 offset:2048
v_mfma_f32_16x16x32_bf16 v[64:67], a[96:99], a[88:91], v[64:67]
v_mfma_f32_16x16x32_bf16 v[72:75], a[96:99], a[92:95], v[72:75]
ds_read_b128 a[8:11], v6 offset:4096
s_add_u32 m0, s34, 4096
v_mfma_f32_16x16x32_bf16 v[20:23], a[100:103], a[64:67], v[20:23]
v_mfma_f32_16x16x32_bf16 v[28:31], a[100:103], a[68:71], v[28:31]
ds_read_b128 a[12:15], v6 offset:6144
buffer_load_dwordx4 v2, s[8:11], s28 offen lds
v_mfma_f32_16x16x32_bf16 v[36:39], a[100:103], a[72:75], v[36:39]
ds_read_b128 a[16:19], v6 offset:8192
v_mfma_f32_16x16x32_bf16 v[44:47], a[100:103], a[76:79], v[44:47]
s_add_u32 s28, s28, s29
v_mfma_f32_16x16x32_bf16 v[52:55], a[100:103], a[80:83], v[52:55]
ds_read_b128 a[20:23], v6 offset:10240
v_mfma_f32_16x16x32_bf16 v[60:63], a[100:103], a[84:87], v[60:63]
v_mfma_f32_16x16x32_bf16 v[68:71], a[100:103], a[88:91], v[68:71]
ds_read_b128 a[24:27], v6 offset:12288
s_add_u32 m0, s34, 8192
v_mfma_f32_16x16x32_bf16 v[76:79], a[100:103], a[92:95], v[76:79]
ds_read_b128 a[28:31], v6 offset:14336
v_mfma_f32_16x16x32_bf16 v[80:83], a[104:107], a[64:67], v[80:83]
buffer_load_dwordx4 v2, s[8:11], s28 offen lds
v_mfma_f32_16x16x32_bf16 v[88:91], a[104:107], a[68:71], v[88:91]
ds_read_b64_tr_b16 a[36:37], v9 offset:32768
v_mfma_f32_16x16x32_bf16 v[96:99], a[104:107], a[72:75], v[96:99]
ds_read_b64_tr_b16 a[38:39], v9 offset:33792
s_add_u32 s28, s28, s29
v_mfma_f32_16x16x32_bf16 v[104:107], a[104:107], a[76:79], v[104:107]
v_mfma_f32_16x16x32_bf16 v[112:115], a[104:107], a[80:83], v[112:115]
ds_read_b64_tr_b16 a[40:41], v10 offset:32768
v_mfma_f32_16x16x32_bf16 v[120:123], a[104:107], a[84:87], v[120:123]
s_add_u32 m0, s34, 12288
v_mfma_f32_16x16x32_bf16 v[128:131], a[104:107], a[88:91], v[128:131]
ds_read_b64_tr_b16 a[42:43], v10 offset:33792
v_mfma_f32_16x16x32_bf16 v[136:139], a[104:107], a[92:95], v[136:139]
ds_read_b64_tr_b16 a[44:45], v11 offset:32768
buffer_load_dwordx4 v2, s[8:11], s28 offen lds
v_mfma_f32_16x16x32_bf16 v[84:87], a[108:111], a[64:67], v[84:87]
v_mfma_f32_16x16x32_bf16 v[92:95], a[108:111], a[68:71], v[92:95]
ds_read_b64_tr_b16 a[46:47], v11 offset:33792
s_add_u32 s28, s28, s29
v_mfma_f32_16x16x32_bf16 v[100:103], a[108:111], a[72:75], v[100:103]
v_mfma_f32_16x16x32_bf16 v[108:111], a[108:111], a[76:79], v[108:111]
ds_read_b64_tr_b16 a[48:49], v8 offset:40960
v_mfma_f32_16x16x32_bf16 v[116:119], a[108:111], a[80:83], v[116:119]
ds_read_b64_tr_b16 a[50:51], v8 offset:41984
s_add_u32 m0, s43, 16384
v_mfma_f32_16x16x32_bf16 v[124:127], a[108:111], a[84:87], v[124:127]
v_mfma_f32_16x16x32_bf16 v[132:135], a[108:111], a[88:91], v[132:135]
ds_read_b64_tr_b16 a[52:53], v9 offset:40960
buffer_load_dwordx4 v3, s[12:15], s31 offen lds
v_mfma_f32_16x16x32_bf16 v[140:143], a[108:111], a[92:95], v[140:143]
ds_read_b64_tr_b16 a[54:55], v9 offset:41984
v_mfma_f32_16x16x32_bf16 v[144:147], a[112:115], a[64:67], v[144:147]
s_add_u32 s31, s31, s32
v_mfma_f32_16x16x32_bf16 v[152:155], a[112:115], a[68:71], v[152:155]
ds_read_b64_tr_b16 a[56:57], v10 offset:40960
v_mfma_f32_16x16x32_bf16 v[160:163], a[112:115], a[72:75], v[160:163]
v_mfma_f32_16x16x32_bf16 v[168:171], a[112:115], a[76:79], v[168:171]
ds_read_b64_tr_b16 a[58:59], v10 offset:41984
s_add_u32 m0, s43, 17408
v_mfma_f32_16x16x32_bf16 v[176:179], a[112:115], a[80:83], v[176:179]
ds_read_b64_tr_b16 a[60:61], v11 offset:40960
v_mfma_f32_16x16x32_bf16 v[184:187], a[112:115], a[84:87], v[184:187]
buffer_load_dwordx4 v3, s[12:15], s31 offen lds
v_mfma_f32_16x16x32_bf16 v[192:195], a[112:115], a[88:91], v[192:195]
ds_read_b64_tr_b16 a[62:63], v11 offset:41984
v_mfma_f32_16x16x32_bf16 v[200:203], a[112:115], a[92:95], v[200:203]
s_add_u32 s31, s31, s33
v_mfma_f32_16x16x32_bf16 v[148:151], a[116:119], a[64:67], v[148:151]
v_mfma_f32_16x16x32_bf16 v[156:159], a[116:119], a[68:71], v[156:159]
v_mfma_f32_16x16x32_bf16 v[164:167], a[116:119], a[72:75], v[164:167]
s_add_u32 m0, s43, 20480
v_mfma_f32_16x16x32_bf16 v[172:175], a[116:119], a[76:79], v[172:175]
v_mfma_f32_16x16x32_bf16 v[180:183], a[116:119], a[80:83], v[180:183]
buffer_load_dwordx4 v3, s[12:15], s31 offen lds
v_mfma_f32_16x16x32_bf16 v[188:191], a[116:119], a[84:87], v[188:191]
v_mfma_f32_16x16x32_bf16 v[196:199], a[116:119], a[88:91], v[196:199]
s_add_u32 s31, s31, s32
v_mfma_f32_16x16x32_bf16 v[204:207], a[116:119], a[92:95], v[204:207]
v_mfma_f32_16x16x32_bf16 v[208:211], a[120:123], a[64:67], v[208:211]
v_mfma_f32_16x16x32_bf16 v[216:219], a[120:123], a[68:71], v[216:219]
s_add_u32 m0, s43, 21504
v_mfma_f32_16x16x32_bf16 v[224:227], a[120:123], a[72:75], v[224:227]
v_mfma_f32_16x16x32_bf16 v[232:235], a[120:123], a[76:79], v[232:235]
buffer_load_dwordx4 v3, s[12:15], s31 offen lds
v_mfma_f32_16x16x32_bf16 v[240:243], a[120:123], a[80:83], v[240:243]
v_mfma_f32_16x16x32_bf16 v[248:251], a[120:123], a[84:87], v[248:251]
s_add_u32 s31, s31, s33
v_mfma_f32_16x16x32_bf16 a[128:131], a[120:123], a[88:91], a[128:131]
v_mfma_f32_16x16x32_bf16 a[136:139], a[120:123], a[92:95], a[136:139]
v_mfma_f32_16x16x32_bf16 v[212:215], a[124:127], a[64:67], v[212:215]
s_add_u32 s37, s37, 32768
v_mfma_f32_16x16x32_bf16 v[220:223], a[124:127], a[68:71], v[220:223]
v_mfma_f32_16x16x32_bf16 v[228:231], a[124:127], a[72:75], v[228:231]
s_cmp_ge_u32 s37, s42
v_mfma_f32_16x16x32_bf16 v[236:239], a[124:127], a[76:79], v[236:239]
v_mfma_f32_16x16x32_bf16 v[244:247], a[124:127], a[80:83], v[244:247]
s_cselect_b32 s37, s41, s37
v_mfma_f32_16x16x32_bf16 v[252:255], a[124:127], a[84:87], v[252:255]
v_mfma_f32_16x16x32_bf16 a[132:135], a[124:127], a[88:91], a[132:135]
v_mfma_f32_16x16x32_bf16 a[140:143], a[124:127], a[92:95], a[140:143]
s_waitcnt vmcnt(16) lgkmcnt(0)
s_barrier
v_mfma_f32_16x16x32_bf16 v[16:19], a[32:35], a[0:3], v[16:19]
v_add_u32 v7, s38, v5
s_add_u32 m0, s34, 16384
v_mfma_f32_16x16x32_bf16 v[24:27], a[32:35], a[4:7], v[24:27]
ds_read_b64_tr_b16 a[96:97], v8 offset:49152
v_mfma_f32_16x16x32_bf16 v[32:35], a[32:35], a[8:11], v[32:35]
ds_read_b64_tr_b16 a[98:99], v8 offset:50176
buffer_load_dwordx4 v2, s[8:11], s28 offen lds
v_mfma_f32_16x16x32_bf16 v[40:43], a[32:35], a[12:15], v[40:43]
v_mfma_f32_16x16x32_bf16 v[48:51], a[32:35], a[16:19], v[48:51]
ds_read_b128 a[64:67], v7 offset:0
s_add_u32 s28, s28, s29
v_mfma_f32_16x16x32_bf16 v[56:59], a[32:35], a[20:23], v[56:59]
ds_read_b128 a[68:71], v7 offset:2048
v_mfma_f32_16x16x32_bf16 v[64:67], a[32:35], a[24:27], v[64:67]
s_add_u32 m0, s34, 20480
v_mfma_f32_16x16x32_bf16 v[72:75], a[32:35], a[28:31], v[72:75]
ds_read_b128 a[72:75], v7 offset:4096
v_mfma_f32_16x16x32_bf16 v[20:23], a[36:39], a[0:3], v[20:23]
buffer_load_dwordx4 v2, s[8:11], s28 offen lds
v_mfma_f32_16x16x32_bf16 v[28:31], a[36:39], a[4:7], v[28:31]
ds_read_b128 a[76:79], v7 offset:6144
v_mfma_f32_16x16x32_bf16 v[36:39], a[36:39], a[8:11], v[36:39]
ds_read_b128 a[80:83], v7 offset:8192
s_add_u32 s28, s28, s29
v_mfma_f32_16x16x32_bf16 v[44:47], a[36:39], a[12:15], v[44:47]
v_mfma_f32_16x16x32_bf16 v[52:55], a[36:39], a[16:19], v[52:55]
ds_read_b128 a[84:87], v7 offset:10240
s_add_u32 m0, s34, 24576
v_mfma_f32_16x16x32_bf16 v[60:63], a[36:39], a[20:23], v[60:63]
v_mfma_f32_16x16x32_bf16 v[68:71], a[36:39], a[24:27], v[68:71]
ds_read_b128 a[88:91], v7 offset:12288
buffer_load_dwordx4 v2, s[8:11], s28 offen lds
v_mfma_f32_16x16x32_bf16 v[76:79], a[36:39], a[28:31], v[76:79]
ds_read_b128 a[92:95], v7 offset:14336
v_mfma_f32_16x16x32_bf16 v[80:83], a[40:43], a[0:3], v[80:83]
s_add_u32 s28, s28, s29
v_mfma_f32_16x16x32_bf16 v[88:91], a[40:43], a[4:7], v[88:91]
ds_read_b64_tr_b16 a[100:101], v9 offset:49152
v_mfma_f32_16x16x32_bf16 v[96:99], a[40:43], a[8:11], v[96:99]
ds_read_b64_tr_b16 a[102:103], v9 offset:50176
s_add_u32 m0, s34, 28672
v_mfma_f32_16x16x32_bf16 v[104:107], a[40:43], a[12:15], v[104:107]
v_mfma_f32_16x16x32_bf16 v[112:115], a[40:43], a[16:19], v[112:115]
ds_read_b64_tr_b16 a[104:105], v10 offset:49152
v_mfma_f32_16x16x32_bf16 v[120:123], a[40:43], a[20:23], v[120:123]
buffer_load_dwordx4 v2, s[8:11], s28 offen lds
v_mfma_f32_16x16x32_bf16 v[128:131], a[40:43], a[24:27], v[128:131]
ds_read_b64_tr_b16 a[106:107], v10 offset:50176
v_mfma_f32_16x16x32_bf16 v[136:139], a[40:43], a[28:31], v[136:139]
ds_read_b64_tr_b16 a[108:109], v11 offset:49152
s_add_u32 s28, s28, s30
v_mfma_f32_16x16x32_bf16 v[84:87], a[44:47], a[0:3], v[84:87]
v_mfma_f32_16x16x32_bf16 v[92:95], a[44:47], a[4:7], v[92:95]
ds_read_b64_tr_b16 a[110:111], v11 offset:50176
s_add_u32 s34, s34, 32768
v_mfma_f32_16x16x32_bf16 v[100:103], a[44:47], a[8:11], v[100:103]
v_mfma_f32_16x16x32_bf16 v[108:111], a[44:47], a[12:15], v[108:111]
ds_read_b64_tr_b16 a[112:113], v8 offset:57344
s_cmp_ge_u32 s34, s36
v_mfma_f32_16x16x32_bf16 v[116:119], a[44:47], a[16:19], v[116:119]
ds_read_b64_tr_b16 a[114:115], v8 offset:58368
v_mfma_f32_16x16x32_bf16 v[124:127], a[44:47], a[20:23], v[124:127]
s_cselect_b32 s34, s35, s34
v_mfma_f32_16x16x32_bf16 v[132:135], a[44:47], a[24:27], v[132:135]
ds_read_b64_tr_b16 a[116:117], v9 offset:57344
v_mfma_f32_16x16x32_bf16 v[140:143], a[44:47], a[28:31], v[140:143]
ds_read_b64_tr_b16 a[118:119], v9 offset:58368
s_add_u32 m0, s43, 32768
v_mfma_f32_16x16x32_bf16 v[144:147], a[48:51], a[0:3], v[144:147]
v_mfma_f32_16x16x32_bf16 v[152:155], a[48:51], a[4:7], v[152:155]
ds_read_b64_tr_b16 a[120:121], v10 offset:57344
buffer_load_dwordx4 v3, s[12:15], s31 offen lds
v_mfma_f32_16x16x32_bf16 v[160:163], a[48:51], a[8:11], v[160:163]
v_mfma_f32_16x16x32_bf16 v[168:171], a[48:51], a[12:15], v[168:171]
ds_read_b64_tr_b16 a[122:123], v10 offset:58368
s_add_u32 s31, s31, s32
v_mfma_f32_16x16x32_bf16 v[176:179], a[48:51], a[16:19], v[176:179]
ds_read_b64_tr_b16 a[124:125], v11 offset:57344
v_mfma_f32_16x16x32_bf16 v[184:187], a[48:51], a[20:23], v[184:187]
s_add_u32 m0, s43, 33792
v_mfma_f32_16x16x32_bf16 v[192:195], a[48:51], a[24:27], v[192:195]
ds_read_b64_tr_b16 a[126:127], v11 offset:58368
v_mfma_f32_16x16x32_bf16 v[200:203], a[48:51], a[28:31], v[200:203]
buffer_load_dwordx4 v3, s[12:15], s31 offen lds
v_mfma_f32_16x16x32_bf16 v[148:151], a[52:55], a[0:3], v[148:151]
v_mfma_f32_16x16x32_bf16 v[156:159], a[52:55], a[4:7], v[156:159]
v_mfma_f32_16x16x32_bf16 v[164:167], a[52:55], a[8:11], v[164:167]
s_add_u32 s31, s31, s33
v_mfma_f32_16x16x32_bf16 v[172:175], a[52:55], a[12:15], v[172:175]
v_mfma_f32_16x16x32_bf16 v[180:183], a[52:55], a[16:19], v[180:183]
s_add_u32 m0, s43, 36864
v_mfma_f32_16x16x32_bf16 v[188:191], a[52:55], a[20:23], v[188:191]
v_mfma_f32_16x16x32_bf16 v[196:199], a[52:55], a[24:27], v[196:199]
buffer_load_dwordx4 v3, s[12:15], s31 offen lds
v_mfma_f32_16x16x32_bf16 v[204:207], a[52:55], a[28:31], v[204:207]
v_mfma_f32_16x16x32_bf16 v[208:211], a[56:59], a[0:3], v[208:211]
s_add_u32 s31, s31, s32
v_mfma_f32_16x16x32_bf16 v[216:219], a[56:59], a[4:7], v[216:219]
v_mfma_f32_16x16x32_bf16 v[224:227], a[56:59], a[8:11], v[224:227]
s_add_u32 m0, s43, 37888
v_mfma_f32_16x16x32_bf16 v[232:235], a[56:59], a[12:15], v[232:235]
v_mfma_f32_16x16x32_bf16 v[240:243], a[56:59], a[16:19], v[240:243]
buffer_load_dwordx4 v3, s[12:15], s31 offen lds
v_mfma_f32_16x16x32_bf16 v[248:251], a[56:59], a[20:23], v[248:251]
v_mfma_f32_16x16x32_bf16 a[128:131], a[56:59], a[24:27], a[128:131]
s_add_u32 s31, s31, s33
v_mfma_f32_16x16x32_bf16 a[136:139], a[56:59], a[28:31], a[136:139]
v_mfma_f32_16x16x32_bf16 v[212:215], a[60:63], a[0:3], v[212:215]
s_add_u32 s38, s38, 32768
v_mfma_f32_16x16x32_bf16 v[220:223], a[60:63], a[4:7], v[220:223]
v_mfma_f32_16x16x32_bf16 v[228:231], a[60:63], a[8:11], v[228:231]
s_cmp_ge_u32 s38, s42
v_mfma_f32_16x16x32_bf16 v[236:239], a[60:63], a[12:15], v[236:239]
v_mfma_f32_16x16x32_bf16 v[244:247], a[60:63], a[16:19], v[244:247]
s_cselect_b32 s38, s41, s38
v_mfma_f32_16x16x32_bf16 v[252:255], a[60:63], a[20:23], v[252:255]
v_mfma_f32_16x16x32_bf16 a[132:135], a[60:63], a[24:27], a[132:135]
v_mfma_f32_16x16x32_bf16 a[140:143], a[60:63], a[28:31], a[140:143]
s_waitcnt vmcnt(16) lgkmcnt(0)
s_barrier
v_mfma_f32_16x16x32_bf16 v[16:19], a[96:99], a[64:67], v[16:19]
v_add_u32 v6, s37, v4
s_add_u32 m0, s34, 0
v_mfma_f32_16x16x32_bf16 v[24:27], a[96:99], a[68:71], v[24:27]
ds_read_b64_tr_b16 a[32:33], v8 offset:0
v_mfma_f32_16x16x32_bf16 v[32:35], a[96:99], a[72:75], v[32:35]
ds_read_b64_tr_b16 a[34:35], v8 offset:1024
buffer_load_dwordx4 v2, s[8:11], s28 offen lds
v_mfma_f32_16x16x32_bf16 v[40:43], a[96:99], a[76:79], v[40:43]
v_mfma_f32_16x16x32_bf16 v[48:51], a[96:99], a[80:83], v[48:51]
ds_read_b128 a[0:3], v6 offset:0
s_add_u32 s28, s28, s29
v_mfma_f32_16x16x32_bf16 v[56:59], a[96:99], a[84:87], v[56:59]
ds_read_b128 a[4:7], v6 offset:2048
v_mfma_f32_16x16x32_bf16 v[64:67], a[96:99], a[88:91], v[64:67]
v_mfma_f32_16x16x32_bf16 v[72:75], a[96:99], a[92:95], v[72:75]
ds_read_b128 a[8:11], v6 offset:4096
s_add_u32 m0, s34, 4096
v_mfma_f32_16x16x32_bf16 v[20:23], a[100:103], a[64:67], v[20:23]
v_mfma_f32_16x16x32_bf16 v[28:31], a[100:103], a[68:71], v[28:31]
ds_read_b128 a[12:15], v6 offset:6144
buffer_load_dwordx4 v2, s[8:11], s28 offen lds
v_mfma_f32_16x16x32_bf16 v[36:39], a[100:103], a[72:75], v[36:39]
ds_read_b128 a[16:19], v6 offset:8192
v_mfma_f32_16x16x32_bf16 v[44:47], a[100:103], a[76:79], v[44:47]
s_add_u32 s28, s28, s29
v_mfma_f32_16x16x32_bf16 v[52:55], a[100:103], a[80:83], v[52:55]
ds_read_b128 a[20:23], v6 offset:10240
v_mfma_f32_16x16x32_bf16 v[60:63], a[100:103], a[84:87], v[60:63]
v_mfma_f32_16x16x32_bf16 v[68:71], a[100:103], a[88:91], v[68:71]
ds_read_b128 a[24:27], v6 offset:12288
s_add_u32 m0, s34, 8192
v_mfma_f32_16x16x32_bf16 v[76:79], a[100:103], a[92:95], v[76:79]
ds_read_b128 a[28:31], v6 offset:14336
v_mfma_f32_16x16x32_bf16 v[80:83], a[104:107], a[64:67], v[80:83]
buffer_load_dwordx4 v2, s[8:11], s28 offen lds
v_mfma_f32_16x16x32_bf16 v[88:91], a[104:107], a[68:71], v[88:91]
ds_read_b64_tr_b16 a[36:37], v9 offset:0
v_mfma_f32_16x16x32_bf16 v[96:99], a[104:107], a[72:75], v[96:99]
ds_read_b64_tr_b16 a[38:39], v9 offset:1024
s_add_u32 s28, s28, s29
v_mfma_f32_16x16x32_bf16 v[104:107], a[104:107], a[76:79], v[104:107]
v_mfma_f32_16x16x32_bf16 v[112:115], a[104:107], a[80:83], v[112:115]
ds_read_b64_tr_b16 a[40:41], v10 offset:0
v_mfma_f32_16x16x32_bf16 v[120:123], a[104:107], a[84:87], v[120:123]
s_add_u32 m0, s34, 12288
v_mfma_f32_16x16x32_bf16 v[128:131], a[104:107], a[88:91], v[128:131]
ds_read_b64_tr_b16 a[42:43], v10 offset:1024
v_mfma_f32_16x16x32_bf16 v[136:139], a[104:107], a[92:95], v[136:139]
ds_read_b64_tr_b16 a[44:45], v11 offset:0
buffer_load_dwordx4 v2, s[8:11], s28 offen lds
v_mfma_f32_16x16x32_bf16 v[84:87], a[108:111], a[64:67], v[84:87]
v_mfma_f32_16x16x32_bf16 v[92:95], a[108:111], a[68:71], v[92:95]
ds_read_b64_tr_b16 a[46:47], v11 offset:1024
s_add_u32 s28, s28, s29
v_mfma_f32_16x16x32_bf16 v[100:103], a[108:111], a[72:75], v[100:103]
v_mfma_f32_16x16x32_bf16 v[108:111], a[108:111], a[76:79], v[108:111]
ds_read_b64_tr_b16 a[48:49], v8 offset:8192
v_mfma_f32_16x16x32_bf16 v[116:119], a[108:111], a[80:83], v[116:119]
ds_read_b64_tr_b16 a[50:51], v8 offset:9216
s_add_u32 m0, s43, 49152
v_mfma_f32_16x16x32_bf16 v[124:127], a[108:111], a[84:87], v[124:127]
v_mfma_f32_16x16x32_bf16 v[132:135], a[108:111], a[88:91], v[132:135]
ds_read_b64_tr_b16 a[52:53], v9 offset:8192
buffer_load_dwordx4 v3, s[12:15], s31 offen lds
v_mfma_f32_16x16x32_bf16 v[140:143], a[108:111], a[92:95], v[140:143]
ds_read_b64_tr_b16 a[54:55], v9 offset:9216
v_mfma_f32_16x16x32_bf16 v[144:147], a[112:115], a[64:67], v[144:147]
s_add_u32 s31, s31, s32
v_mfma_f32_16x16x32_bf16 v[152:155], a[112:115], a[68:71], v[152:155]
ds_read_b64_tr_b16 a[56:57], v10 offset:8192
v_mfma_f32_16x16x32_bf16 v[160:163], a[112:115], a[72:75], v[160:163]
v_mfma_f32_16x16x32_bf16 v[168:171], a[112:115], a[76:79], v[168:171]
ds_read_b64_tr_b16 a[58:59], v10 offset:9216
s_add_u32 m0, s43, 50176
v_mfma_f32_16x16x32_bf16 v[176:179], a[112:115], a[80:83], v[176:179]
ds_read_b64_tr_b16 a[60:61], v11 offset:8192
v_mfma_f32_16x16x32_bf16 v[184:187], a[112:115], a[84:87], v[184:187]
buffer_load_dwordx4 v3, s[12:15], s31 offen lds
v_mfma_f32_16x16x32_bf16 v[192:195], a[112:115], a[88:91], v[192:195]
ds_read_b64_tr_b16 a[62:63], v11 offset:9216
v_mfma_f32_16x16x32_bf16 v[200:203], a[112:115], a[92:95], v[200:203]
s_add_u32 s31, s31, s33
v_mfma_f32_16x16x32_bf16 v[148:151], a[116:119], a[64:67], v[148:151]
v_mfma_f32_16x16x32_bf16 v[156:159], a[116:119], a[68:71], v[156:159]
v_mfma_f32_16x16x32_bf16 v[164:167], a[116:119], a[72:75], v[164:167]
s_add_u32 m0, s43, 53248
v_mfma_f32_16x16x32_bf16 v[172:175], a[116:119], a[76:79], v[172:175]
v_mfma_f32_16x16x32_bf16 v[180:183], a[116:119], a[80:83], v[180:183]
buffer_load_dwordx4 v3, s[12:15], s31 offen lds
v_mfma_f32_16x16x32_bf16 v[188:191], a[116:119], a[84:87], v[188:191]
v_mfma_f32_16x16x32_bf16 v[196:199], a[116:119], a[88:91], v[196:199]
s_add_u32 s31, s31, s32
v_mfma_f32_16x16x32_bf16 v[204:207], a[116:119], a[92:95], v[204:207]
v_mfma_f32_16x16x32_bf16 v[208:211], a[120:123], a[64:67], v[208:211]
v_mfma_f32_16x16x32_bf16 v[216:219], a[120:123], a[68:71], v[216:219]
s_add_u32 m0, s43, 54272
v_mfma_f32_16x16x32_bf16 v[224:227], a[120:123], a[72:75], v[224:227]
v_mfma_f32_16x16x32_bf16 v[232:235], a[120:123], a[76:79], v[232:235]
buffer_load_dwordx4 v3, s[12:15], s31 offen lds
v_mfma_f32_16x16x32_bf16 v[240:243], a[120:123], a[80:83], v[240:243]
v_mfma_f32_16x16x32_bf16 v[248:251], a[120:123], a[84:87], v[248:251]
s_add_u32 s31, s31, s33
v_mfma_f32_16x16x32_bf16 a[128:131], a[120:123], a[88:91], a[128:131]
v_mfma_f32_16x16x32_bf16 a[136:139], a[120:123], a[92:95], a[136:139]
v_mfma_f32_16x16x32_bf16 v[212:215], a[124:127], a[64:67], v[212:215]
s_add_u32 s37, s37, 32768
v_mfma_f32_16x16x32_bf16 v[220:223], a[124:127], a[68:71], v[220:223]
v_mfma_f32_16x16x32_bf16 v[228:231], a[124:127], a[72:75], v[228:231]
s_cmp_ge_u32 s37, s42
v_mfma_f32_16x16x32_bf16 v[236:239], a[124:127], a[76:79], v[236:239]
v_mfma_f32_16x16x32_bf16 v[244:247], a[124:127], a[80:83], v[244:247]
s_cselect_b32 s37, s41, s37
v_mfma_f32_16x16x32_bf16 v[252:255], a[124:127], a[84:87], v[252:255]
v_mfma_f32_16x16x32_bf16 a[132:135], a[124:127], a[88:91], a[132:135]
v_mfma_f32_16x16x32_bf16 a[140:143], a[124:127], a[92:95], a[140:143]
.p2align 6
fused_kernel_L0_0:
s_waitcnt vmcnt(16) lgkmcnt(0)
s_barrier
v_mfma_f32_16x16x32_bf16 v[16:19], a[32:35], a[0:3], v[16:19]
v_add_u32 v7, s38, v5
s_add_u32 m0, s34, 16384
v_mfma_f32_16x16x32_bf16 v[24:27], a[32:35], a[4:7], v[24:27]
ds_read_b64_tr_b16 a[96:97], v8 offset:16384
buffer_load_dwordx4 v2, s[8:11], s28 offen lds
v_mfma_f32_16x16x32_bf16 v[32:35], a[32:35], a[8:11], v[32:35]
ds_read_b64_tr_b16 a[98:99], v8 offset:17408
v_mfma_f32_16x16x32_bf16 v[40:43], a[32:35], a[12:15], v[40:43]
s_add_u32 s28, s28, s29
v_mfma_f32_16x16x32_bf16 v[48:51], a[32:35], a[16:19], v[48:51]
ds_read_b128 a[64:67], v7 offset:0
v_mfma_f32_16x16x32_bf16 v[56:59], a[32:35], a[20:23], v[56:59]
ds_read_b128 a[68:71], v7 offset:2048
s_add_u32 m0, s34, 20480
v_mfma_f32_16x16x32_bf16 v[64:67], a[32:35], a[24:27], v[64:67]
v_mfma_f32_16x16x32_bf16 v[72:75], a[32:35], a[28:31], v[72:75]
ds_read_b128 a[72:75], v7 offset:4096
buffer_load_dwordx4 v2, s[8:11], s28 offen lds
v_mfma_f32_16x16x32_bf16 v[20:23], a[36:39], a[0:3], v[20:23]
v_mfma_f32_16x16x32_bf16 v[28:31], a[36:39], a[4:7], v[28:31]
ds_read_b128 a[76:79], v7 offset:6144
s_add_u32 s28, s28, s29
v_mfma_f32_16x16x32_bf16 v[36:39], a[36:39], a[8:11], v[36:39]
ds_read_b128 a[80:83], v7 offset:8192
v_mfma_f32_16x16x32_bf16 v[44:47], a[36:39], a[12:15], v[44:47]
s_add_u32 m0, s34, 24576
v_mfma_f32_16x16x32_bf16 v[52:55], a[36:39], a[16:19], v[52:55]
ds_read_b128 a[84:87], v7 offset:10240
v_mfma_f32_16x16x32_bf16 v[60:63], a[36:39], a[20:23], v[60:63]
buffer_load_dwordx4 v2, s[8:11], s28 offen lds
v_mfma_f32_16x16x32_bf16 v[68:71], a[36:39], a[24:27], v[68:71]
ds_read_b128 a[88:91], v7 offset:12288
v_mfma_f32_16x16x32_bf16 v[76:79], a[36:39], a[28:31], v[76:79]
ds_read_b128 a[92:95], v7 offset:14336
s_add_u32 s28, s28, s29
v_mfma_f32_16x16x32_bf16 v[80:83], a[40:43], a[0:3], v[80:83]
v_mfma_f32_16x16x32_bf16 v[88:91], a[40:43], a[4:7], v[88:91]
ds_read_b64_tr_b16 a[100:101], v9 offset:16384
s_add_u32 m0, s34, 28672
v_mfma_f32_16x16x32_bf16 v[96:99], a[40:43], a[8:11], v[96:99]
ds_read_b64_tr_b16 a[102:103], v9 offset:17408
v_mfma_f32_16x16x32_bf16 v[104:107], a[40:43], a[12:15], v[104:107]
buffer_load_dwordx4 v2, s[8:11], s28 offen lds
v_mfma_f32_16x16x32_bf16 v[112:115], a[40:43], a[16:19], v[112:115]
ds_read_b64_tr_b16 a[104:105], v10 offset:16384
v_mfma_f32_16x16x32_bf16 v[120:123], a[40:43], a[20:23], v[120:123]
s_add_u32 s28, s28, s30
v_mfma_f32_16x16x32_bf16 v[128:131], a[40:43], a[24:27], v[128:131]
ds_read_b64_tr_b16 a[106:107], v10 offset:17408
v_mfma_f32_16x16x32_bf16 v[136:139], a[40:43], a[28:31], v[136:139]
ds_read_b64_tr_b16 a[108:109], v11 offset:16384
s_add_u32 s34, s34, 32768
v_mfma_f32_16x16x32_bf16 v[84:87], a[44:47], a[0:3], v[84:87]
v_mfma_f32_16x16x32_bf16 v[92:95], a[44:47], a[4:7], v[92:95]
ds_read_b64_tr_b16 a[110:111], v11 offset:17408
s_cmp_ge_u32 s34, s36
v_mfma_f32_16x16x32_bf16 v[100:103], a[44:47], a[8:11], v[100:103]
v_mfma_f32_16x16x32_bf16 v[108:111], a[44:47], a[12:15], v[108:111]
ds_read_b64_tr_b16 a[112:113], v8 offset:24576
s_cselect_b32 s34, s35, s34
v_mfma_f32_16x16x32_bf16 v[116:119], a[44:47], a[16:19], v[116:119]
ds_read_b64_tr_b16 a[114:115], v8 offset:25600
v_mfma_f32_16x16x32_bf16 v[124:127], a[44:47], a[20:23], v[124:127]
s_add_u32 m0, s43, 0
v_mfma_f32_16x16x32_bf16 v[132:135], a[44:47], a[24:27], v[132:135]
ds_read_b64_tr_b16 a[116:117], v9 offset:24576
v_mfma_f32_16x16x32_bf16 v[140:143], a[44:47], a[28:31], v[140:143]
ds_read_b64_tr_b16 a[118:119], v9 offset:25600
buffer_load_dwordx4 v3, s[12:15], s31 offen lds
v_mfma_f32_16x16x32_bf16 v[144:147], a[48:51], a[0:3], v[144:147]
v_mfma_f32_16x16x32_bf16 v[152:155], a[48:51], a[4:7], v[152:155]
ds_read_b64_tr_b16 a[120:121], v10 offset:24576
s_add_u32 s31, s31, s32
v_mfma_f32_16x16x32_bf16 v[160:163], a[48:51], a[8:11], v[160:163]
v_mfma_f32_16x16x32_bf16 v[168:171], a[48:51], a[12:15], v[168:171]
ds_read_b64_tr_b16 a[122:123], v10 offset:25600
s_add_u32 m0, s43, 1024
v_mfma_f32_16x16x32_bf16 v[176:179], a[48:51], a[16:19], v[176:179]
ds_read_b64_tr_b16 a[124:125], v11 offset:24576
v_mfma_f32_16x16x32_bf16 v[184:187], a[48:51], a[20:23], v[184:187]
buffer_load_dwordx4 v3, s[12:15], s31 offen lds
v_mfma_f32_16x16x32_bf16 v[192:195], a[48:51], a[24:27], v[192:195]
ds_read_b64_tr_b16 a[126:127], v11 offset:25600
v_mfma_f32_16x16x32_bf16 v[200:203], a[48:51], a[28:31], v[200:203]
s_add_u32 s31, s31, s33
v_mfma_f32_16x16x32_bf16 v[148:151], a[52:55], a[0:3], v[148:151]
v_mfma_f32_16x16x32_bf16 v[156:159], a[52:55], a[4:7], v[156:159]
s_add_u32 m0, s43, 4096
v_mfma_f32_16x16x32_bf16 v[164:167], a[52:55], a[8:11], v[164:167]
v_mfma_f32_16x16x32_bf16 v[172:175], a[52:55], a[12:15], v[172:175]
buffer_load_dwordx4 v3, s[12:15], s31 offen lds
v_mfma_f32_16x16x32_bf16 v[180:183], a[52:55], a[16:19], v[180:183]
v_mfma_f32_16x16x32_bf16 v[188:191], a[52:55], a[20:23], v[188:191]
s_add_u32 s31, s31, s32
v_mfma_f32_16x16x32_bf16 v[196:199], a[52:55], a[24:27], v[196:199]
v_mfma_f32_16x16x32_bf16 v[204:207], a[52:55], a[28:31], v[204:207]
s_add_u32 m0, s43, 5120
v_mfma_f32_16x16x32_bf16 v[208:211], a[56:59], a[0:3], v[208:211]
v_mfma_f32_16x16x32_bf16 v[216:219], a[56:59], a[4:7], v[216:219]
buffer_load_dwordx4 v3, s[12:15], s31 offen lds
v_mfma_f32_16x16x32_bf16 v[224:227], a[56:59], a[8:11], v[224:227]
v_mfma_f32_16x16x32_bf16 v[232:235], a[56:59], a[12:15], v[232:235]
s_add_u32 s31, s31, s33
v_mfma_f32_16x16x32_bf16 v[240:243], a[56:59], a[16:19], v[240:243]
v_mfma_f32_16x16x32_bf16 v[248:251], a[56:59], a[20:23], v[248:251]
s_add_u32 s38, s38, 32768
v_mfma_f32_16x16x32_bf16 a[128:131], a[56:59], a[24:27], a[128:131]
v_mfma_f32_16x16x32_bf16 a[136:139], a[56:59], a[28:31], a[136:139]
s_cmp_ge_u32 s38, s42
v_mfma_f32_16x16x32_bf16 v[212:215], a[60:63], a[0:3], v[212:215]
v_mfma_f32_16x16x32_bf16 v[220:223], a[60:63], a[4:7], v[220:223]
s_cselect_b32 s38, s41, s38
v_mfma_f32_16x16x32_bf16 v[228:231], a[60:63], a[8:11], v[228:231]
v_mfma_f32_16x16x32_bf16 v[236:239], a[60:63], a[12:15], v[236:239]
buffer_load_dword v0, v13, s[68:71], s84 offen
v_mfma_f32_16x16x32_bf16 v[244:247], a[60:63], a[16:19], v[244:247]
v_mfma_f32_16x16x32_bf16 v[252:255], a[60:63], a[20:23], v[252:255]
s_add_u32 s84, s84, s85
v_mfma_f32_16x16x32_bf16 a[132:135], a[60:63], a[24:27], a[132:135]
v_mfma_f32_16x16x32_bf16 a[140:143], a[60:63], a[28:31], a[140:143]
s_waitcnt vmcnt(16) lgkmcnt(0)
s_barrier
v_mfma_f32_16x16x32_bf16 v[16:19], a[96:99], a[64:67], v[16:19]
v_add_u32 v6, s37, v4
s_add_u32 m0, s34, 0
v_mfma_f32_16x16x32_bf16 v[24:27], a[96:99], a[68:71], v[24:27]
ds_read_b64_tr_b16 a[32:33], v8 offset:32768
v_mfma_f32_16x16x32_bf16 v[32:35], a[96:99], a[72:75], v[32:35]
ds_read_b64_tr_b16 a[34:35], v8 offset:33792
buffer_load_dwordx4 v2, s[8:11], s28 offen lds
v_mfma_f32_16x16x32_bf16 v[40:43], a[96:99], a[76:79], v[40:43]
v_mfma_f32_16x16x32_bf16 v[48:51], a[96:99], a[80:83], v[48:51]
ds_read_b128 a[0:3], v6 offset:0
s_add_u32 s28, s28, s29
v_mfma_f32_16x16x32_bf16 v[56:59], a[96:99], a[84:87], v[56:59]
ds_read_b128 a[4:7], v6 offset:2048
v_mfma_f32_16x16x32_bf16 v[64:67], a[96:99], a[88:91], v[64:67]
v_mfma_f32_16x16x32_bf16 v[72:75], a[96:99], a[92:95], v[72:75]
ds_read_b128 a[8:11], v6 offset:4096
s_add_u32 m0, s34, 4096
v_mfma_f32_16x16x32_bf16 v[20:23], a[100:103], a[64:67], v[20:23]
v_mfma_f32_16x16x32_bf16 v[28:31], a[100:103], a[68:71], v[28:31]
ds_read_b128 a[12:15], v6 offset:6144
buffer_load_dwordx4 v2, s[8:11], s28 offen lds
v_mfma_f32_16x16x32_bf16 v[36:39], a[100:103], a[72:75], v[36:39]
ds_read_b128 a[16:19], v6 offset:8192
v_mfma_f32_16x16x32_bf16 v[44:47], a[100:103], a[76:79], v[44:47]
s_add_u32 s28, s28, s29
v_mfma_f32_16x16x32_bf16 v[52:55], a[100:103], a[80:83], v[52:55]
ds_read_b128 a[20:23], v6 offset:10240
v_mfma_f32_16x16x32_bf16 v[60:63], a[100:103], a[84:87], v[60:63]
v_mfma_f32_16x16x32_bf16 v[68:71], a[100:103], a[88:91], v[68:71]
ds_read_b128 a[24:27], v6 offset:12288
s_add_u32 m0, s34, 8192
v_mfma_f32_16x16x32_bf16 v[76:79], a[100:103], a[92:95], v[76:79]
ds_read_b128 a[28:31], v6 offset:14336
v_mfma_f32_16x16x32_bf16 v[80:83], a[104:107], a[64:67], v[80:83]
buffer_load_dwordx4 v2, s[8:11], s28 offen lds
v_mfma_f32_16x16x32_bf16 v[88:91], a[104:107], a[68:71], v[88:91]
ds_read_b64_tr_b16 a[36:37], v9 offset:32768
v_mfma_f32_16x16x32_bf16 v[96:99], a[104:107], a[72:75], v[96:99]
ds_read_b64_tr_b16 a[38:39], v9 offset:33792
s_add_u32 s28, s28, s29
v_mfma_f32_16x16x32_bf16 v[104:107], a[104:107], a[76:79], v[104:107]
v_mfma_f32_16x16x32_bf16 v[112:115], a[104:107], a[80:83], v[112:115]
ds_read_b64_tr_b16 a[40:41], v10 offset:32768
v_mfma_f32_16x16x32_bf16 v[120:123], a[104:107], a[84:87], v[120:123]
s_add_u32 m0, s34, 12288
v_mfma_f32_16x16x32_bf16 v[128:131], a[104:107], a[88:91], v[128:131]
ds_read_b64_tr_b16 a[42:43], v10 offset:33792
v_mfma_f32_16x16x32_bf16 v[136:139], a[104:107], a[92:95], v[136:139]
ds_read_b64_tr_b16 a[44:45], v11 offset:32768
buffer_load_dwordx4 v2, s[8:11], s28 offen lds
v_mfma_f32_16x16x32_bf16 v[84:87], a[108:111], a[64:67], v[84:87]
v_mfma_f32_16x16x32_bf16 v[92:95], a[108:111], a[68:71], v[92:95]
ds_read_b64_tr_b16 a[46:47], v11 offset:33792
s_add_u32 s28, s28, s29
v_mfma_f32_16x16x32_bf16 v[100:103], a[108:111], a[72:75], v[100:103]
v_mfma_f32_16x16x32_bf16 v[108:111], a[108:111], a[76:79], v[108:111]
ds_read_b64_tr_b16 a[48:49], v8 offset:40960
v_mfma_f32_16x16x32_bf16 v[116:119], a[108:111], a[80:83], v[116:119]
ds_read_b64_tr_b16 a[50:51], v8 offset:41984
s_add_u32 m0, s43, 16384
v_mfma_f32_16x16x32_bf16 v[124:127], a[108:111], a[84:87], v[124:127]
v_mfma_f32_16x16x32_bf16 v[132:135], a[108:111], a[88:91], v[132:135]
ds_read_b64_tr_b16 a[52:53], v9 offset:40960
buffer_load_dwordx4 v3, s[12:15], s31 offen lds
v_mfma_f32_16x16x32_bf16 v[140:143], a[108:111], a[92:95], v[140:143]
ds_read_b64_tr_b16 a[54:55], v9 offset:41984
v_mfma_f32_16x16x32_bf16 v[144:147], a[112:115], a[64:67], v[144:147]
s_add_u32 s31, s31, s32
v_mfma_f32_16x16x32_bf16 v[152:155], a[112:115], a[68:71], v[152:155]
ds_read_b64_tr_b16 a[56:57], v10 offset:40960
v_mfma_f32_16x16x32_bf16 v[160:163], a[112:115], a[72:75], v[160:163]
v_mfma_f32_16x16x32_bf16 v[168:171], a[112:115], a[76:79], v[168:171]
ds_read_b64_tr_b16 a[58:59], v10 offset:41984
s_add_u32 m0, s43, 17408
v_mfma_f32_16x16x32_bf16 v[176:179], a[112:115], a[80:83], v[176:179]
ds_read_b64_tr_b16 a[60:61], v11 offset:40960
v_mfma_f32_16x16x32_bf16 v[184:187], a[112:115], a[84:87], v[184:187]
buffer_load_dwordx4 v3, s[12:15], s31 offen lds
v_mfma_f32_16x16x32_bf16 v[192:195], a[112:115], a[88:91], v[192:195]
ds_read_b64_tr_b16 a[62:63], v11 offset:41984
v_mfma_f32_16x16x32_bf16 v[200:203], a[112:115], a[92:95], v[200:203]
s_add_u32 s31, s31, s33
v_mfma_f32_16x16x32_bf16 v[148:151], a[116:119], a[64:67], v[148:151]
v_mfma_f32_16x16x32_bf16 v[156:159], a[116:119], a[68:71], v[156:159]
v_mfma_f32_16x16x32_bf16 v[164:167], a[116:119], a[72:75], v[164:167]
s_add_u32 m0, s43, 20480
v_mfma_f32_16x16x32_bf16 v[172:175], a[116:119], a[76:79], v[172:175]
v_mfma_f32_16x16x32_bf16 v[180:183], a[116:119], a[80:83], v[180:183]
buffer_load_dwordx4 v3, s[12:15], s31 offen lds
v_mfma_f32_16x16x32_bf16 v[188:191], a[116:119], a[84:87], v[188:191]
v_mfma_f32_16x16x32_bf16 v[196:199], a[116:119], a[88:91], v[196:199]
s_add_u32 s31, s31, s32
v_mfma_f32_16x16x32_bf16 v[204:207], a[116:119], a[92:95], v[204:207]
v_mfma_f32_16x16x32_bf16 v[208:211], a[120:123], a[64:67], v[208:211]
v_mfma_f32_16x16x32_bf16 v[216:219], a[120:123], a[68:71], v[216:219]
s_add_u32 m0, s43, 21504
v_mfma_f32_16x16x32_bf16 v[224:227], a[120:123], a[72:75], v[224:227]
v_mfma_f32_16x16x32_bf16 v[232:235], a[120:123], a[76:79], v[232:235]
buffer_load_dwordx4 v3, s[12:15], s31 offen lds
v_mfma_f32_16x16x32_bf16 v[240:243], a[120:123], a[80:83], v[240:243]
v_mfma_f32_16x16x32_bf16 v[248:251], a[120:123], a[84:87], v[248:251]
s_add_u32 s31, s31, s33
v_mfma_f32_16x16x32_bf16 a[128:131], a[120:123], a[88:91], a[128:131]
v_mfma_f32_16x16x32_bf16 a[136:139], a[120:123], a[92:95], a[136:139]
v_mfma_f32_16x16x32_bf16 v[212:215], a[124:127], a[64:67], v[212:215]
s_add_u32 s37, s37, 32768
v_mfma_f32_16x16x32_bf16 v[220:223], a[124:127], a[68:71], v[220:223]
v_mfma_f32_16x16x32_bf16 v[228:231], a[124:127], a[72:75], v[228:231]
s_cmp_ge_u32 s37, s42
v_mfma_f32_16x16x32_bf16 v[236:239], a[124:127], a[76:79], v[236:239]
v_mfma_f32_16x16x32_bf16 v[244:247], a[124:127], a[80:83], v[244:247]
s_cselect_b32 s37, s41, s37
v_mfma_f32_16x16x32_bf16 v[252:255], a[124:127], a[84:87], v[252:255]
v_mfma_f32_16x16x32_bf16 a[132:135], a[124:127], a[88:91], a[132:135]
v_mfma_f32_16x16x32_bf16 a[140:143], a[124:127], a[92:95], a[140:143]
s_waitcnt vmcnt(16) lgkmcnt(0)
s_barrier
v_mfma_f32_16x16x32_bf16 v[16:19], a[32:35], a[0:3], v[16:19]
v_add_u32 v7, s38, v5
s_add_u32 m0, s34, 16384
v_mfma_f32_16x16x32_bf16 v[24:27], a[32:35], a[4:7], v[24:27]
ds_read_b64_tr_b16 a[96:97], v8 offset:49152
v_mfma_f32_16x16x32_bf16 v[32:35], a[32:35], a[8:11], v[32:35]
ds_read_b64_tr_b16 a[98:99], v8 offset:50176
buffer_load_dwordx4 v2, s[8:11], s28 offen lds
v_mfma_f32_16x16x32_bf16 v[40:43], a[32:35], a[12:15], v[40:43]
v_mfma_f32_16x16x32_bf16 v[48:51], a[32:35], a[16:19], v[48:51]
ds_read_b128 a[64:67], v7 offset:0
s_add_u32 s28, s28, s29
v_mfma_f32_16x16x32_bf16 v[56:59], a[32:35], a[20:23], v[56:59]
ds_read_b128 a[68:71], v7 offset:2048
v_mfma_f32_16x16x32_bf16 v[64:67], a[32:35], a[24:27], v[64:67]
s_add_u32 m0, s34, 20480
v_mfma_f32_16x16x32_bf16 v[72:75], a[32:35], a[28:31], v[72:75]
ds_read_b128 a[72:75], v7 offset:4096
v_mfma_f32_16x16x32_bf16 v[20:23], a[36:39], a[0:3], v[20:23]
buffer_load_dwordx4 v2, s[8:11], s28 offen lds
v_mfma_f32_16x16x32_bf16 v[28:31], a[36:39], a[4:7], v[28:31]
ds_read_b128 a[76:79], v7 offset:6144
v_mfma_f32_16x16x32_bf16 v[36:39], a[36:39], a[8:11], v[36:39]
ds_read_b128 a[80:83], v7 offset:8192
s_add_u32 s28, s28, s29
v_mfma_f32_16x16x32_bf16 v[44:47], a[36:39], a[12:15], v[44:47]
v_mfma_f32_16x16x32_bf16 v[52:55], a[36:39], a[16:19], v[52:55]
ds_read_b128 a[84:87], v7 offset:10240
s_add_u32 m0, s34, 24576
v_mfma_f32_16x16x32_bf16 v[60:63], a[36:39], a[20:23], v[60:63]
v_mfma_f32_16x16x32_bf16 v[68:71], a[36:39], a[24:27], v[68:71]
ds_read_b128 a[88:91], v7 offset:12288
buffer_load_dwordx4 v2, s[8:11], s28 offen lds
v_mfma_f32_16x16x32_bf16 v[76:79], a[36:39], a[28:31], v[76:79]
ds_read_b128 a[92:95], v7 offset:14336
v_mfma_f32_16x16x32_bf16 v[80:83], a[40:43], a[0:3], v[80:83]
s_add_u32 s28, s28, s29
v_mfma_f32_16x16x32_bf16 v[88:91], a[40:43], a[4:7], v[88:91]
ds_read_b64_tr_b16 a[100:101], v9 offset:49152
v_mfma_f32_16x16x32_bf16 v[96:99], a[40:43], a[8:11], v[96:99]
ds_read_b64_tr_b16 a[102:103], v9 offset:50176
s_add_u32 m0, s34, 28672
v_mfma_f32_16x16x32_bf16 v[104:107], a[40:43], a[12:15], v[104:107]
v_mfma_f32_16x16x32_bf16 v[112:115], a[40:43], a[16:19], v[112:115]
ds_read_b64_tr_b16 a[104:105], v10 offset:49152
v_mfma_f32_16x16x32_bf16 v[120:123], a[40:43], a[20:23], v[120:123]
buffer_load_dwordx4 v2, s[8:11], s28 offen lds
v_mfma_f32_16x16x32_bf16 v[128:131], a[40:43], a[24:27], v[128:131]
ds_read_b64_tr_b16 a[106:107], v10 offset:50176
v_mfma_f32_16x16x32_bf16 v[136:139], a[40:43], a[28:31], v[136:139]
ds_read_b64_tr_b16 a[108:109], v11 offset:49152
s_add_u32 s28, s28, s30
v_mfma_f32_16x16x32_bf16 v[84:87], a[44:47], a[0:3], v[84:87]
v_mfma_f32_16x16x32_bf16 v[92:95], a[44:47], a[4:7], v[92:95]
ds_read_b64_tr_b16 a[110:111], v11 offset:50176
s_add_u32 s34, s34, 32768
v_mfma_f32_16x16x32_bf16 v[100:103], a[44:47], a[8:11], v[100:103]
v_mfma_f32_16x16x32_bf16 v[108:111], a[44:47], a[12:15], v[108:111]
ds_read_b64_tr_b16 a[112:113], v8 offset:57344
s_cmp_ge_u32 s34, s36
v_mfma_f32_16x16x32_bf16 v[116:119], a[44:47], a[16:19], v[116:119]
ds_read_b64_tr_b16 a[114:115], v8 offset:58368
v_mfma_f32_16x16x32_bf16 v[124:127], a[44:47], a[20:23], v[124:127]
s_cselect_b32 s34, s35, s34
v_mfma_f32_16x16x32_bf16 v[132:135], a[44:47], a[24:27], v[132:135]
ds_read_b64_tr_b16 a[116:117], v9 offset:57344
v_mfma_f32_16x16x32_bf16 v[140:143], a[44:47], a[28:31], v[140:143]
ds_read_b64_tr_b16 a[118:119], v9 offset:58368
s_add_u32 m0, s43, 32768
v_mfma_f32_16x16x32_bf16 v[144:147], a[48:51], a[0:3], v[144:147]
v_mfma_f32_16x16x32_bf16 v[152:155], a[48:51], a[4:7], v[152:155]
ds_read_b64_tr_b16 a[120:121], v10 offset:57344
buffer_load_dwordx4 v3, s[12:15], s31 offen lds
v_mfma_f32_16x16x32_bf16 v[160:163], a[48:51], a[8:11], v[160:163]
v_mfma_f32_16x16x32_bf16 v[168:171], a[48:51], a[12:15], v[168:171]
ds_read_b64_tr_b16 a[122:123], v10 offset:58368
s_add_u32 s31, s31, s32
v_mfma_f32_16x16x32_bf16 v[176:179], a[48:51], a[16:19], v[176:179]
ds_read_b64_tr_b16 a[124:125], v11 offset:57344
v_mfma_f32_16x16x32_bf16 v[184:187], a[48:51], a[20:23], v[184:187]
s_add_u32 m0, s43, 33792
v_mfma_f32_16x16x32_bf16 v[192:195], a[48:51], a[24:27], v[192:195]
ds_read_b64_tr_b16 a[126:127], v11 offset:58368
v_mfma_f32_16x16x32_bf16 v[200:203], a[48:51], a[28:31], v[200:203]
buffer_load_dwordx4 v3, s[12:15], s31 offen lds
v_mfma_f32_16x16x32_bf16 v[148:151], a[52:55], a[0:3], v[148:151]
v_mfma_f32_16x16x32_bf16 v[156:159], a[52:55], a[4:7], v[156:159]
v_mfma_f32_16x16x32_bf16 v[164:167], a[52:55], a[8:11], v[164:167]
s_add_u32 s31, s31, s33
v_mfma_f32_16x16x32_bf16 v[172:175], a[52:55], a[12:15], v[172:175]
v_mfma_f32_16x16x32_bf16 v[180:183], a[52:55], a[16:19], v[180:183]
s_add_u32 m0, s43, 36864
v_mfma_f32_16x16x32_bf16 v[188:191], a[52:55], a[20:23], v[188:191]
v_mfma_f32_16x16x32_bf16 v[196:199], a[52:55], a[24:27], v[196:199]
buffer_load_dwordx4 v3, s[12:15], s31 offen lds
v_mfma_f32_16x16x32_bf16 v[204:207], a[52:55], a[28:31], v[204:207]
v_mfma_f32_16x16x32_bf16 v[208:211], a[56:59], a[0:3], v[208:211]
s_add_u32 s31, s31, s32
v_mfma_f32_16x16x32_bf16 v[216:219], a[56:59], a[4:7], v[216:219]
v_mfma_f32_16x16x32_bf16 v[224:227], a[56:59], a[8:11], v[224:227]
s_add_u32 m0, s43, 37888
v_mfma_f32_16x16x32_bf16 v[232:235], a[56:59], a[12:15], v[232:235]
v_mfma_f32_16x16x32_bf16 v[240:243], a[56:59], a[16:19], v[240:243]
buffer_load_dwordx4 v3, s[12:15], s31 offen lds
v_mfma_f32_16x16x32_bf16 v[248:251], a[56:59], a[20:23], v[248:251]
v_mfma_f32_16x16x32_bf16 a[128:131], a[56:59], a[24:27], a[128:131]
s_add_u32 s31, s31, s33
v_mfma_f32_16x16x32_bf16 a[136:139], a[56:59], a[28:31], a[136:139]
v_mfma_f32_16x16x32_bf16 v[212:215], a[60:63], a[0:3], v[212:215]
s_add_u32 s38, s38, 32768
v_mfma_f32_16x16x32_bf16 v[220:223], a[60:63], a[4:7], v[220:223]
v_mfma_f32_16x16x32_bf16 v[228:231], a[60:63], a[8:11], v[228:231]
s_cmp_ge_u32 s38, s42
v_mfma_f32_16x16x32_bf16 v[236:239], a[60:63], a[12:15], v[236:239]
v_mfma_f32_16x16x32_bf16 v[244:247], a[60:63], a[16:19], v[244:247]
s_cselect_b32 s38, s41, s38
v_mfma_f32_16x16x32_bf16 v[252:255], a[60:63], a[20:23], v[252:255]
v_mfma_f32_16x16x32_bf16 a[132:135], a[60:63], a[24:27], a[132:135]
v_mfma_f32_16x16x32_bf16 a[140:143], a[60:63], a[28:31], a[140:143]
s_sub_u32 s40, s39, s58
s_cmp_eq_u32 s40, 1
s_cbranch_scc1 fused_kernel_swa_6
fused_kernel_swab_7:
s_waitcnt vmcnt(16) lgkmcnt(0)
s_barrier
v_mfma_f32_16x16x32_bf16 v[16:19], a[96:99], a[64:67], v[16:19]
v_add_u32 v6, s37, v4
s_add_u32 m0, s34, 0
v_mfma_f32_16x16x32_bf16 v[24:27], a[96:99], a[68:71], v[24:27]
ds_read_b64_tr_b16 a[32:33], v8 offset:0
v_mfma_f32_16x16x32_bf16 v[32:35], a[96:99], a[72:75], v[32:35]
ds_read_b64_tr_b16 a[34:35], v8 offset:1024
buffer_load_dwordx4 v2, s[8:11], s28 offen lds
v_mfma_f32_16x16x32_bf16 v[40:43], a[96:99], a[76:79], v[40:43]
v_mfma_f32_16x16x32_bf16 v[48:51], a[96:99], a[80:83], v[48:51]
ds_read_b128 a[0:3], v6 offset:0
s_add_u32 s28, s28, s29
v_mfma_f32_16x16x32_bf16 v[56:59], a[96:99], a[84:87], v[56:59]
ds_read_b128 a[4:7], v6 offset:2048
v_mfma_f32_16x16x32_bf16 v[64:67], a[96:99], a[88:91], v[64:67]
v_mfma_f32_16x16x32_bf16 v[72:75], a[96:99], a[92:95], v[72:75]
ds_read_b128 a[8:11], v6 offset:4096
s_add_u32 m0, s34, 4096
v_mfma_f32_16x16x32_bf16 v[20:23], a[100:103], a[64:67], v[20:23]
v_mfma_f32_16x16x32_bf16 v[28:31], a[100:103], a[68:71], v[28:31]
ds_read_b128 a[12:15], v6 offset:6144
buffer_load_dwordx4 v2, s[8:11], s28 offen lds
v_mfma_f32_16x16x32_bf16 v[36:39], a[100:103], a[72:75], v[36:39]
ds_read_b128 a[16:19], v6 offset:8192
v_mfma_f32_16x16x32_bf16 v[44:47], a[100:103], a[76:79], v[44:47]
s_add_u32 s28, s28, s29
v_mfma_f32_16x16x32_bf16 v[52:55], a[100:103], a[80:83], v[52:55]
ds_read_b128 a[20:23], v6 offset:10240
v_mfma_f32_16x16x32_bf16 v[60:63], a[100:103], a[84:87], v[60:63]
v_mfma_f32_16x16x32_bf16 v[68:71], a[100:103], a[88:91], v[68:71]
ds_read_b128 a[24:27], v6 offset:12288
s_add_u32 m0, s34, 8192
v_mfma_f32_16x16x32_bf16 v[76:79], a[100:103], a[92:95], v[76:79]
ds_read_b128 a[28:31], v6 offset:14336
v_mfma_f32_16x16x32_bf16 v[80:83], a[104:107], a[64:67], v[80:83]
buffer_load_dwordx4 v2, s[8:11], s28 offen lds
v_mfma_f32_16x16x32_bf16 v[88:91], a[104:107], a[68:71], v[88:91]
ds_read_b64_tr_b16 a[36:37], v9 offset:0
v_mfma_f32_16x16x32_bf16 v[96:99], a[104:107], a[72:75], v[96:99]
ds_read_b64_tr_b16 a[38:39], v9 offset:1024
s_add_u32 s28, s28, s29
v_mfma_f32_16x16x32_bf16 v[104:107], a[104:107], a[76:79], v[104:107]
v_mfma_f32_16x16x32_bf16 v[112:115], a[104:107], a[80:83], v[112:115]
ds_read_b64_tr_b16 a[40:41], v10 offset:0
v_mfma_f32_16x16x32_bf16 v[120:123], a[104:107], a[84:87], v[120:123]
s_add_u32 m0, s34, 12288
v_mfma_f32_16x16x32_bf16 v[128:131], a[104:107], a[88:91], v[128:131]
ds_read_b64_tr_b16 a[42:43], v10 offset:1024
v_mfma_f32_16x16x32_bf16 v[136:139], a[104:107], a[92:95], v[136:139]
ds_read_b64_tr_b16 a[44:45], v11 offset:0
buffer_load_dwordx4 v2, s[8:11], s28 offen lds
v_mfma_f32_16x16x32_bf16 v[84:87], a[108:111], a[64:67], v[84:87]
v_mfma_f32_16x16x32_bf16 v[92:95], a[108:111], a[68:71], v[92:95]
ds_read_b64_tr_b16 a[46:47], v11 offset:1024
s_add_u32 s28, s28, s29
v_mfma_f32_16x16x32_bf16 v[100:103], a[108:111], a[72:75], v[100:103]
v_mfma_f32_16x16x32_bf16 v[108:111], a[108:111], a[76:79], v[108:111]
ds_read_b64_tr_b16 a[48:49], v8 offset:8192
v_mfma_f32_16x16x32_bf16 v[116:119], a[108:111], a[80:83], v[116:119]
ds_read_b64_tr_b16 a[50:51], v8 offset:9216
s_add_u32 m0, s43, 49152
v_mfma_f32_16x16x32_bf16 v[124:127], a[108:111], a[84:87], v[124:127]
v_mfma_f32_16x16x32_bf16 v[132:135], a[108:111], a[88:91], v[132:135]
ds_read_b64_tr_b16 a[52:53], v9 offset:8192
buffer_load_dwordx4 v3, s[12:15], s31 offen lds
v_mfma_f32_16x16x32_bf16 v[140:143], a[108:111], a[92:95], v[140:143]
ds_read_b64_tr_b16 a[54:55], v9 offset:9216
v_mfma_f32_16x16x32_bf16 v[144:147], a[112:115], a[64:67], v[144:147]
s_add_u32 s31, s31, s32
v_mfma_f32_16x16x32_bf16 v[152:155], a[112:115], a[68:71], v[152:155]
ds_read_b64_tr_b16 a[56:57], v10 offset:8192
v_mfma_f32_16x16x32_bf16 v[160:163], a[112:115], a[72:75], v[160:163]
v_mfma_f32_16x16x32_bf16 v[168:171], a[112:115], a[76:79], v[168:171]
ds_read_b64_tr_b16 a[58:59], v10 offset:9216
s_add_u32 m0, s43, 50176
v_mfma_f32_16x16x32_bf16 v[176:179], a[112:115], a[80:83], v[176:179]
ds_read_b64_tr_b16 a[60:61], v11 offset:8192
v_mfma_f32_16x16x32_bf16 v[184:187], a[112:115], a[84:87], v[184:187]
buffer_load_dwordx4 v3, s[12:15], s31 offen lds
v_mfma_f32_16x16x32_bf16 v[192:195], a[112:115], a[88:91], v[192:195]
ds_read_b64_tr_b16 a[62:63], v11 offset:9216
v_mfma_f32_16x16x32_bf16 v[200:203], a[112:115], a[92:95], v[200:203]
s_add_u32 s31, s31, s33
v_mfma_f32_16x16x32_bf16 v[148:151], a[116:119], a[64:67], v[148:151]
v_mfma_f32_16x16x32_bf16 v[156:159], a[116:119], a[68:71], v[156:159]
v_mfma_f32_16x16x32_bf16 v[164:167], a[116:119], a[72:75], v[164:167]
s_add_u32 m0, s43, 53248
v_mfma_f32_16x16x32_bf16 v[172:175], a[116:119], a[76:79], v[172:175]
v_mfma_f32_16x16x32_bf16 v[180:183], a[116:119], a[80:83], v[180:183]
buffer_load_dwordx4 v3, s[12:15], s31 offen lds
v_mfma_f32_16x16x32_bf16 v[188:191], a[116:119], a[84:87], v[188:191]
v_mfma_f32_16x16x32_bf16 v[196:199], a[116:119], a[88:91], v[196:199]
s_add_u32 s31, s31, s32
v_mfma_f32_16x16x32_bf16 v[204:207], a[116:119], a[92:95], v[204:207]
v_mfma_f32_16x16x32_bf16 v[208:211], a[120:123], a[64:67], v[208:211]
v_mfma_f32_16x16x32_bf16 v[216:219], a[120:123], a[68:71], v[216:219]
s_add_u32 m0, s43, 54272
v_mfma_f32_16x16x32_bf16 v[224:227], a[120:123], a[72:75], v[224:227]
v_mfma_f32_16x16x32_bf16 v[232:235], a[120:123], a[76:79], v[232:235]
buffer_load_dwordx4 v3, s[12:15], s31 offen lds
v_mfma_f32_16x16x32_bf16 v[240:243], a[120:123], a[80:83], v[240:243]
v_mfma_f32_16x16x32_bf16 v[248:251], a[120:123], a[84:87], v[248:251]
s_add_u32 s31, s31, s33
v_mfma_f32_16x16x32_bf16 a[128:131], a[120:123], a[88:91], a[128:131]
v_mfma_f32_16x16x32_bf16 a[136:139], a[120:123], a[92:95], a[136:139]
v_mfma_f32_16x16x32_bf16 v[212:215], a[124:127], a[64:67], v[212:215]
s_add_u32 s37, s37, 32768
v_mfma_f32_16x16x32_bf16 v[220:223], a[124:127], a[68:71], v[220:223]
v_mfma_f32_16x16x32_bf16 v[228:231], a[124:127], a[72:75], v[228:231]
s_cmp_ge_u32 s37, s42
v_mfma_f32_16x16x32_bf16 v[236:239], a[124:127], a[76:79], v[236:239]
v_mfma_f32_16x16x32_bf16 v[244:247], a[124:127], a[80:83], v[244:247]
s_cselect_b32 s37, s41, s37
v_mfma_f32_16x16x32_bf16 v[252:255], a[124:127], a[84:87], v[252:255]
v_mfma_f32_16x16x32_bf16 a[132:135], a[124:127], a[88:91], a[132:135]
v_mfma_f32_16x16x32_bf16 a[140:143], a[124:127], a[92:95], a[140:143]
s_cmp_lg_u32 s39, 3
s_cbranch_scc1 fused_kernel_notouch_8
s_cmp_eq_u32 s49, 1
s_cbranch_scc1 fused_kernel_notouch_8
s_cmp_lg_u32 s3, 0
s_cbranch_scc1 fused_kernel_nolncld_9
buffer_load_dword v14, v12, s[64:67], 0 offen sc1
fused_kernel_nolncld_9:
fused_kernel_notouch_8:
s_sub_u32 s39, s39, 1
s_cmp_lg_u32 s39, 0
s_cbranch_scc1 fused_kernel_L0_0
s_cmp_eq_u32 s49, 1
s_cbranch_scc1 fused_kernel_qtail0
s_mov_b64 s[12:13], s[24:25]
s_mov_b64 s[14:15], s[26:27]
s_mov_b32 s31, s53
s_mov_b32 s32, s17
s_mov_b32 s33, s18
v_lshrrev_b32 v14, 4, v1
s_lshl_b32 s40, s50, 2
v_add_u32 v14, s40, v14
v_and_b32 v3, 15, v1
v_lshlrev_b32 v14, 1, v14
v_xor_b32 v3, v3, v14
v_lshlrev_b32 v3, 4, v3
v_lshrrev_b32 v0, 4, v1
s_movk_i32 s40, 3584
v_mul_lo_u32 v0, v0, s40
v_add_u32 v3, v3, v0
s_waitcnt vmcnt(16) lgkmcnt(0)
s_barrier
v_mfma_f32_16x16x32_bf16 v[16:19], a[32:35], a[0:3], v[16:19]
v_add_u32 v7, s38, v5
s_add_u32 m0, s34, 16384
v_mfma_f32_16x16x32_bf16 v[24:27], a[32:35], a[4:7], v[24:27]
ds_read_b64_tr_b16 a[96:97], v8 offset:16384
v_mfma_f32_16x16x32_bf16 v[32:35], a[32:35], a[8:11], v[32:35]
ds_read_b64_tr_b16 a[98:99], v8 offset:17408
buffer_load_dwordx4 v2, s[8:11], s28 offen lds
v_mfma_f32_16x16x32_bf16 v[40:43], a[32:35], a[12:15], v[40:43]
v_mfma_f32_16x16x32_bf16 v[48:51], a[32:35], a[16:19], v[48:51]
ds_read_b128 a[64:67], v7 offset:0
s_add_u32 s28, s28, s29
v_mfma_f32_16x16x32_bf16 v[56:59], a[32:35], a[20:23], v[56:59]
ds_read_b128 a[68:71], v7 offset:2048
v_mfma_f32_16x16x32_bf16 v[64:67], a[32:35], a[24:27], v[64:67]
s_add_u32 m0, s34, 20480
v_mfma_f32_16x16x32_bf16 v[72:75], a[32:35], a[28:31], v[72:75]
ds_read_b128 a[72:75], v7 offset:4096
v_mfma_f32_16x16x32_bf16 v[20:23], a[36:39], a[0:3], v[20:23]
buffer_load_dwordx4 v2, s[8:11], s28 offen lds
v_mfma_f32_16x16x32_bf16 v[28:31], a[36:39], a[4:7], v[28:31]
ds_read_b128 a[76:79], v7 offset:6144
v_mfma_f32_16x16x32_bf16 v[36:39], a[36:39], a[8:11], v[36:39]
ds_read_b128 a[80:83], v7 offset:8192
s_add_u32 s28, s28, s29
v_mfma_f32_16x16x32_bf16 v[44:47], a[36:39], a[12:15], v[44:47]
v_mfma_f32_16x16x32_bf16 v[52:55], a[36:39], a[16:19], v[52:55]
ds_read_b128 a[84:87], v7 offset:10240
s_add_u32 m0, s34, 24576
v_mfma_f32_16x16x32_bf16 v[60:63], a[36:39], a[20:23], v[60:63]
v_mfma_f32_16x16x32_bf16 v[68:71], a[36:39], a[24:27], v[68:71]
ds_read_b128 a[88:91], v7 offset:12288
buffer_load_dwordx4 v2, s[8:11], s28 offen lds
v_mfma_f32_16x16x32_bf16 v[76:79], a[36:39], a[28:31], v[76:79]
ds_read_b128 a[92:95], v7 offset:14336
v_mfma_f32_16x16x32_bf16 v[80:83], a[40:43], a[0:3], v[80:83]
s_add_u32 s28, s28, s29
v_mfma_f32_16x16x32_bf16 v[88:91], a[40:43], a[4:7], v[88:91]
ds_read_b64_tr_b16 a[100:101], v9 offset:16384
v_mfma_f32_16x16x32_bf16 v[96:99], a[40:43], a[8:11], v[96:99]
ds_read_b64_tr_b16 a[102:103], v9 offset:17408
s_add_u32 m0, s34, 28672
v_mfma_f32_16x16x32_bf16 v[104:107], a[40:43], a[12:15], v[104:107]
v_mfma_f32_16x16x32_bf16 v[112:115], a[40:43], a[16:19], v[112:115]
ds_read_b64_tr_b16 a[104:105], v10 offset:16384
v_mfma_f32_16x16x32_bf16 v[120:123], a[40:43], a[20:23], v[120:123]
buffer_load_dwordx4 v2, s[8:11], s28 offen lds
v_mfma_f32_16x16x32_bf16 v[128:131], a[40:43], a[24:27], v[128:131]
ds_read_b64_tr_b16 a[106:107], v10 offset:17408
v_mfma_f32_16x16x32_bf16 v[136:139], a[40:43], a[28:31], v[136:139]
ds_read_b64_tr_b16 a[108:109], v11 offset:16384
s_add_u32 s28, s28, s30
v_mfma_f32_16x16x32_bf16 v[84:87], a[44:47], a[0:3], v[84:87]
v_mfma_f32_16x16x32_bf16 v[92:95], a[44:47], a[4:7], v[92:95]
ds_read_b64_tr_b16 a[110:111], v11 offset:17408
s_add_u32 s34, s34, 32768
v_mfma_f32_16x16x32_bf16 v[100:103], a[44:47], a[8:11], v[100:103]
v_mfma_f32_16x16x32_bf16 v[108:111], a[44:47], a[12:15], v[108:111]
ds_read_b64_tr_b16 a[112:113], v8 offset:24576
s_cmp_ge_u32 s34, s36
v_mfma_f32_16x16x32_bf16 v[116:119], a[44:47], a[16:19], v[116:119]
ds_read_b64_tr_b16 a[114:115], v8 offset:25600
v_mfma_f32_16x16x32_bf16 v[124:127], a[44:47], a[20:23], v[124:127]
s_cselect_b32 s34, s35, s34
v_mfma_f32_16x16x32_bf16 v[132:135], a[44:47], a[24:27], v[132:135]
ds_read_b64_tr_b16 a[116:117], v9 offset:24576
v_mfma_f32_16x16x32_bf16 v[140:143], a[44:47], a[28:31], v[140:143]
ds_read_b64_tr_b16 a[118:119], v9 offset:25600
s_add_u32 m0, s43, 0
v_mfma_f32_16x16x32_bf16 v[144:147], a[48:51], a[0:3], v[144:147]
v_mfma_f32_16x16x32_bf16 v[152:155], a[48:51], a[4:7], v[152:155]
ds_read_b64_tr_b16 a[120:121], v10 offset:24576
buffer_load_dwordx4 v3, s[12:15], s31 offen lds
v_mfma_f32_16x16x32_bf16 v[160:163], a[48:51], a[8:11], v[160:163]
v_mfma_f32_16x16x32_bf16 v[168:171], a[48:51], a[12:15], v[168:171]
ds_read_b64_tr_b16 a[122:123], v10 offset:25600
s_add_u32 s31, s31, s32
v_mfma_f32_16x16x32_bf16 v[176:179], a[48:51], a[16:19], v[176:179]
ds_read_b64_tr_b16 a[124:125], v11 offset:24576
v_mfma_f32_16x16x32_bf16 v[184:187], a[48:51], a[20:23], v[184:187]
s_add_u32 m0, s43, 1024
v_mfma_f32_16x16x32_bf16 v[192:195], a[48:51], a[24:27], v[192:195]
ds_read_b64_tr_b16 a[126:127], v11 offset:25600
v_mfma_f32_16x16x32_bf16 v[200:203], a[48:51], a[28:31], v[200:203]
buffer_load_dwordx4 v3, s[12:15], s31 offen lds
v_mfma_f32_16x16x32_bf16 v[148:151], a[52:55], a[0:3], v[148:151]
v_mfma_f32_16x16x32_bf16 v[156:159], a[52:55], a[4:7], v[156:159]
v_mfma_f32_16x16x32_bf16 v[164:167], a[52:55], a[8:11], v[164:167]
s_add_u32 s31, s31, s33
v_mfma_f32_16x16x32_bf16 v[172:175], a[52:55], a[12:15], v[172:175]
v_mfma_f32_16x16x32_bf16 v[180:183], a[52:55], a[16:19], v[180:183]
s_add_u32 m0, s43, 4096
v_mfma_f32_16x16x32_bf16 v[188:191], a[52:55], a[20:23], v[188:191]
v_mfma_f32_16x16x32_bf16 v[196:199], a[52:55], a[24:27], v[196:199]
buffer_load_dwordx4 v3, s[12:15], s31 offen lds
v_mfma_f32_16x16x32_bf16 v[204:207], a[52:55], a[28:31], v[204:207]
v_mfma_f32_16x16x32_bf16 v[208:211], a[56:59], a[0:3], v[208:211]
s_add_u32 s31, s31, s32
v_mfma_f32_16x16x32_bf16 v[216:219], a[56:59], a[4:7], v[216:219]
v_mfma_f32_16x16x32_bf16 v[224:227], a[56:59], a[8:11], v[224:227]
s_add_u32 m0, s43, 5120
v_mfma_f32_16x16x32_bf16 v[232:235], a[56:59], a[12:15], v[232:235]
v_mfma_f32_16x16x32_bf16 v[240:243], a[56:59], a[16:19], v[240:243]
buffer_load_dwordx4 v3, s[12:15], s31 offen lds
v_mfma_f32_16x16x32_bf16 v[248:251], a[56:59], a[20:23], v[248:251]
v_mfma_f32_16x16x32_bf16 a[128:131], a[56:59], a[24:27], a[128:131]
s_add_u32 s31, s31, s33
v_mfma_f32_16x16x32_bf16 a[136:139], a[56:59], a[28:31], a[136:139]
v_mfma_f32_16x16x32_bf16 v[212:215], a[60:63], a[0:3], v[212:215]
s_add_u32 s38, s38, 32768
v_mfma_f32_16x16x32_bf16 v[220:223], a[60:63], a[4:7], v[220:223]
v_mfma_f32_16x16x32_bf16 v[228:231], a[60:63], a[8:11], v[228:231]
s_cmp_ge_u32 s38, s42
v_mfma_f32_16x16x32_bf16 v[236:239], a[60:63], a[12:15], v[236:239]
v_mfma_f32_16x16x32_bf16 v[244:247], a[60:63], a[16:19], v[244:247]
s_cselect_b32 s38, s41, s38
v_mfma_f32_16x16x32_bf16 v[252:255], a[60:63], a[20:23], v[252:255]
v_mfma_f32_16x16x32_bf16 a[132:135], a[60:63], a[24:27], a[132:135]
v_mfma_f32_16x16x32_bf16 a[140:143], a[60:63], a[28:31], a[140:143]
s_waitcnt vmcnt(16) lgkmcnt(0)
s_barrier
v_mfma_f32_16x16x32_bf16 v[16:19], a[96:99], a[64:67], v[16:19]
v_add_u32 v6, s37, v4
s_add_u32 m0, s34, 0
v_mfma_f32_16x16x32_bf16 v[24:27], a[96:99], a[68:71], v[24:27]
ds_read_b64_tr_b16 a[32:33], v8 offset:32768
v_mfma_f32_16x16x32_bf16 v[32:35], a[96:99], a[72:75], v[32:35]
ds_read_b64_tr_b16 a[34:35], v8 offset:33792
buffer_load_dwordx4 v2, s[8:11], s28 offen lds
v_mfma_f32_16x16x32_bf16 v[40:43], a[96:99], a[76:79], v[40:43]
v_mfma_f32_16x16x32_bf16 v[48:51], a[96:99], a[80:83], v[48:51]
ds_read_b128 a[0:3], v6 offset:0
s_add_u32 s28, s28, s29
v_mfma_f32_16x16x32_bf16 v[56:59], a[96:99], a[84:87], v[56:59]
ds_read_b128 a[4:7], v6 offset:2048
v_mfma_f32_16x16x32_bf16 v[64:67], a[96:99], a[88:91], v[64:67]
v_mfma_f32_16x16x32_bf16 v[72:75], a[96:99], a[92:95], v[72:75]
ds_read_b128 a[8:11], v6 offset:4096
s_add_u32 m0, s34, 4096
v_mfma_f32_16x16x32_bf16 v[20:23], a[100:103], a[64:67], v[20:23]
v_mfma_f32_16x16x32_bf16 v[28:31], a[100:103], a[68:71], v[28:31]
ds_read_b128 a[12:15], v6 offset:6144
buffer_load_dwordx4 v2, s[8:11], s28 offen lds
v_mfma_f32_16x16x32_bf16 v[36:39], a[100:103], a[72:75], v[36:39]
ds_read_b128 a[16:19], v6 offset:8192
v_mfma_f32_16x16x32_bf16 v[44:47], a[100:103], a[76:79], v[44:47]
s_add_u32 s28, s28, s29
v_mfma_f32_16x16x32_bf16 v[52:55], a[100:103], a[80:83], v[52:55]
ds_read_b128 a[20:23], v6 offset:10240
v_mfma_f32_16x16x32_bf16 v[60:63], a[100:103], a[84:87], v[60:63]
v_mfma_f32_16x16x32_bf16 v[68:71], a[100:103], a[88:91], v[68:71]
ds_read_b128 a[24:27], v6 offset:12288
s_add_u32 m0, s34, 8192
v_mfma_f32_16x16x32_bf16 v[76:79], a[100:103], a[92:95], v[76:79]
ds_read_b128 a[28:31], v6 offset:14336
v_mfma_f32_16x16x32_bf16 v[80:83], a[104:107], a[64:67], v[80:83]
buffer_load_dwordx4 v2, s[8:11], s28 offen lds
v_mfma_f32_16x16x32_bf16 v[88:91], a[104:107], a[68:71], v[88:91]
ds_read_b64_tr_b16 a[36:37], v9 offset:32768
v_mfma_f32_16x16x32_bf16 v[96:99], a[104:107], a[72:75], v[96:99]
ds_read_b64_tr_b16 a[38:39], v9 offset:33792
s_add_u32 s28, s28, s29
v_mfma_f32_16x16x32_bf16 v[104:107], a[104:107], a[76:79], v[104:107]
v_mfma_f32_16x16x32_bf16 v[112:115], a[104:107], a[80:83], v[112:115]
ds_read_b64_tr_b16 a[40:41], v10 offset:32768
v_mfma_f32_16x16x32_bf16 v[120:123], a[104:107], a[84:87], v[120:123]
s_add_u32 m0, s34, 12288
v_mfma_f32_16x16x32_bf16 v[128:131], a[104:107], a[88:91], v[128:131]
ds_read_b64_tr_b16 a[42:43], v10 offset:33792
v_mfma_f32_16x16x32_bf16 v[136:139], a[104:107], a[92:95], v[136:139]
ds_read_b64_tr_b16 a[44:45], v11 offset:32768
buffer_load_dwordx4 v2, s[8:11], s28 offen lds
v_mfma_f32_16x16x32_bf16 v[84:87], a[108:111], a[64:67], v[84:87]
v_mfma_f32_16x16x32_bf16 v[92:95], a[108:111], a[68:71], v[92:95]
ds_read_b64_tr_b16 a[46:47], v11 offset:33792
s_add_u32 s28, s28, s29
v_mfma_f32_16x16x32_bf16 v[100:103], a[108:111], a[72:75], v[100:103]
v_mfma_f32_16x16x32_bf16 v[108:111], a[108:111], a[76:79], v[108:111]
ds_read_b64_tr_b16 a[48:49], v8 offset:40960
v_mfma_f32_16x16x32_bf16 v[116:119], a[108:111], a[80:83], v[116:119]
ds_read_b64_tr_b16 a[50:51], v8 offset:41984
s_add_u32 m0, s43, 16384
v_mfma_f32_16x16x32_bf16 v[124:127], a[108:111], a[84:87], v[124:127]
v_mfma_f32_16x16x32_bf16 v[132:135], a[108:111], a[88:91], v[132:135]
ds_read_b64_tr_b16 a[52:53], v9 offset:40960
buffer_load_dwordx4 v3, s[12:15], s31 offen lds
v_mfma_f32_16x16x32_bf16 v[140:143], a[108:111], a[92:95], v[140:143]
ds_read_b64_tr_b16 a[54:55], v9 offset:41984
v_mfma_f32_16x16x32_bf16 v[144:147], a[112:115], a[64:67], v[144:147]
s_add_u32 s31, s31, s32
v_mfma_f32_16x16x32_bf16 v[152:155], a[112:115], a[68:71], v[152:155]
ds_read_b64_tr_b16 a[56:57], v10 offset:40960
v_mfma_f32_16x16x32_bf16 v[160:163], a[112:115], a[72:75], v[160:163]
v_mfma_f32_16x16x32_bf16 v[168:171], a[112:115], a[76:79], v[168:171]
ds_read_b64_tr_b16 a[58:59], v10 offset:41984
s_add_u32 m0, s43, 17408
v_mfma_f32_16x16x32_bf16 v[176:179], a[112:115], a[80:83], v[176:179]
ds_read_b64_tr_b16 a[60:61], v11 offset:40960
v_mfma_f32_16x16x32_bf16 v[184:187], a[112:115], a[84:87], v[184:187]
buffer_load_dwordx4 v3, s[12:15], s31 offen lds
v_mfma_f32_16x16x32_bf16 v[192:195], a[112:115], a[88:91], v[192:195]
ds_read_b64_tr_b16 a[62:63], v11 offset:41984
v_mfma_f32_16x16x32_bf16 v[200:203], a[112:115], a[92:95], v[200:203]
s_add_u32 s31, s31, s33
v_mfma_f32_16x16x32_bf16 v[148:151], a[116:119], a[64:67], v[148:151]
v_mfma_f32_16x16x32_bf16 v[156:159], a[116:119], a[68:71], v[156:159]
v_mfma_f32_16x16x32_bf16 v[164:167], a[116:119], a[72:75], v[164:167]
s_add_u32 m0, s43, 20480
v_mfma_f32_16x16x32_bf16 v[172:175], a[116:119], a[76:79], v[172:175]
v_mfma_f32_16x16x32_bf16 v[180:183], a[116:119], a[80:83], v[180:183]
buffer_load_dwordx4 v3, s[12:15], s31 offen lds
v_mfma_f32_16x16x32_bf16 v[188:191], a[116:119], a[84:87], v[188:191]
v_mfma_f32_16x16x32_bf16 v[196:199], a[116:119], a[88:91], v[196:199]
s_add_u32 s31, s31, s32
v_mfma_f32_16x16x32_bf16 v[204:207], a[116:119], a[92:95], v[204:207]
v_mfma_f32_16x16x32_bf16 v[208:211], a[120:123], a[64:67], v[208:211]
v_mfma_f32_16x16x32_bf16 v[216:219], a[120:123], a[68:71], v[216:219]
s_add_u32 m0, s43, 21504
v_mfma_f32_16x16x32_bf16 v[224:227], a[120:123], a[72:75], v[224:227]
v_mfma_f32_16x16x32_bf16 v[232:235], a[120:123], a[76:79], v[232:235]
buffer_load_dwordx4 v3, s[12:15], s31 offen lds
v_mfma_f32_16x16x32_bf16 v[240:243], a[120:123], a[80:83], v[240:243]
v_mfma_f32_16x16x32_bf16 v[248:251], a[120:123], a[84:87], v[248:251]
s_add_u32 s31, s31, s33
v_mfma_f32_16x16x32_bf16 a[128:131], a[120:123], a[88:91], a[128:131]
v_mfma_f32_16x16x32_bf16 a[136:139], a[120:123], a[92:95], a[136:139]
v_mfma_f32_16x16x32_bf16 v[212:215], a[124:127], a[64:67], v[212:215]
s_add_u32 s37, s37, 32768
v_mfma_f32_16x16x32_bf16 v[220:223], a[124:127], a[68:71], v[220:223]
v_mfma_f32_16x16x32_bf16 v[228:231], a[124:127], a[72:75], v[228:231]
s_cmp_ge_u32 s37, s42
v_mfma_f32_16x16x32_bf16 v[236:239], a[124:127], a[76:79], v[236:239]
v_mfma_f32_16x16x32_bf16 v[244:247], a[124:127], a[80:83], v[244:247]
s_cselect_b32 s37, s41, s37
v_mfma_f32_16x16x32_bf16 v[252:255], a[124:127], a[84:87], v[252:255]
v_mfma_f32_16x16x32_bf16 a[132:135], a[124:127], a[88:91], a[132:135]
v_mfma_f32_16x16x32_bf16 a[140:143], a[124:127], a[92:95], a[140:143]
s_waitcnt vmcnt(16) lgkmcnt(0)
s_barrier
v_mfma_f32_16x16x32_bf16 v[16:19], a[32:35], a[0:3], v[16:19]
v_add_u32 v7, s38, v5
s_add_u32 m0, s34, 16384
v_mfma_f32_16x16x32_bf16 v[24:27], a[32:35], a[4:7], v[24:27]
ds_read_b64_tr_b16 a[96:97], v8 offset:49152
v_mfma_f32_16x16x32_bf16 v[32:35], a[32:35], a[8:11], v[32:35]
ds_read_b64_tr_b16 a[98:99], v8 offset:50176
buffer_load_dwordx4 v2, s[8:11], s28 offen lds
v_mfma_f32_16x16x32_bf16 v[40:43], a[32:35], a[12:15], v[40:43]
v_mfma_f32_16x16x32_bf16 v[48:51], a[32:35], a[16:19], v[48:51]
ds_read_b128 a[64:67], v7 offset:0
s_add_u32 s28, s28, s29
v_mfma_f32_16x16x32_bf16 v[56:59], a[32:35], a[20:23], v[56:59]
ds_read_b128 a[68:71], v7 offset:2048
v_mfma_f32_16x16x32_bf16 v[64:67], a[32:35], a[24:27], v[64:67]
s_add_u32 m0, s34, 20480
v_mfma_f32_16x16x32_bf16 v[72:75], a[32:35], a[28:31], v[72:75]
ds_read_b128 a[72:75], v7 offset:4096
v_mfma_f32_16x16x32_bf16 v[20:23], a[36:39], a[0:3], v[20:23]
buffer_load_dwordx4 v2, s[8:11], s28 offen lds
v_mfma_f32_16x16x32_bf16 v[28:31], a[36:39], a[4:7], v[28:31]
ds_read_b128 a[76:79], v7 offset:6144
v_mfma_f32_16x16x32_bf16 v[36:39], a[36:39], a[8:11], v[36:39]
ds_read_b128 a[80:83], v7 offset:8192
s_add_u32 s28, s28, s29
v_mfma_f32_16x16x32_bf16 v[44:47], a[36:39], a[12:15], v[44:47]
v_mfma_f32_16x16x32_bf16 v[52:55], a[36:39], a[16:19], v[52:55]
ds_read_b128 a[84:87], v7 offset:10240
s_add_u32 m0, s34, 24576
v_mfma_f32_16x16x32_bf16 v[60:63], a[36:39], a[20:23], v[60:63]
v_mfma_f32_16x16x32_bf16 v[68:71], a[36:39], a[24:27], v[68:71]
ds_read_b128 a[88:91], v7 offset:12288
buffer_load_dwordx4 v2, s[8:11], s28 offen lds
v_mfma_f32_16x16x32_bf16 v[76:79], a[36:39], a[28:31], v[76:79]
ds_read_b128 a[92:95], v7 offset:14336
v_mfma_f32_16x16x32_bf16 v[80:83], a[40:43], a[0:3], v[80:83]
s_add_u32 s28, s28, s29
v_mfma_f32_16x16x32_bf16 v[88:91], a[40:43], a[4:7], v[88:91]
ds_read_b64_tr_b16 a[100:101], v9 offset:49152
v_mfma_f32_16x16x32_bf16 v[96:99], a[40:43], a[8:11], v[96:99]
ds_read_b64_tr_b16 a[102:103], v9 offset:50176
s_add_u32 m0, s34, 28672
v_mfma_f32_16x16x32_bf16 v[104:107], a[40:43], a[12:15], v[104:107]
v_mfma_f32_16x16x32_bf16 v[112:115], a[40:43], a[16:19], v[112:115]
ds_read_b64_tr_b16 a[104:105], v10 offset:49152
v_mfma_f32_16x16x32_bf16 v[120:123], a[40:43], a[20:23], v[120:123]
buffer_load_dwordx4 v2, s[8:11], s28 offen lds
v_mfma_f32_16x16x32_bf16 v[128:131], a[40:43], a[24:27], v[128:131]
ds_read_b64_tr_b16 a[106:107], v10 offset:50176
v_mfma_f32_16x16x32_bf16 v[136:139], a[40:43], a[28:31], v[136:139]
ds_read_b64_tr_b16 a[108:109], v11 offset:49152
s_add_u32 s28, s28, s30
v_mfma_f32_16x16x32_bf16 v[84:87], a[44:47], a[0:3], v[84:87]
v_mfma_f32_16x16x32_bf16 v[92:95], a[44:47], a[4:7], v[92:95]
ds_read_b64_tr_b16 a[110:111], v11 offset:50176
s_add_u32 s34, s34, 32768
v_mfma_f32_16x16x32_bf16 v[100:103], a[44:47], a[8:11], v[100:103]
v_mfma_f32_16x16x32_bf16 v[108:111], a[44:47], a[12:15], v[108:111]
ds_read_b64_tr_b16 a[112:113], v8 offset:57344
s_cmp_ge_u32 s34, s36
v_mfma_f32_16x16x32_bf16 v[116:119], a[44:47], a[16:19], v[116:119]
ds_read_b64_tr_b16 a[114:115], v8 offset:58368
v_mfma_f32_16x16x32_bf16 v[124:127], a[44:47], a[20:23], v[124:127]
s_cselect_b32 s34, s35, s34
v_mfma_f32_16x16x32_bf16 v[132:135], a[44:47], a[24:27], v[132:135]
ds_read_b64_tr_b16 a[116:117], v9 offset:57344
v_mfma_f32_16x16x32_bf16 v[140:143], a[44:47], a[28:31], v[140:143]
ds_read_b64_tr_b16 a[118:119], v9 offset:58368
s_add_u32 m0, s43, 32768
v_mfma_f32_16x16x32_bf16 v[144:147], a[48:51], a[0:3], v[144:147]
v_mfma_f32_16x16x32_bf16 v[152:155], a[48:51], a[4:7], v[152:155]
ds_read_b64_tr_b16 a[120:121], v10 offset:57344
buffer_load_dwordx4 v3, s[12:15], s31 offen lds
v_mfma_f32_16x16x32_bf16 v[160:163], a[48:51], a[8:11], v[160:163]
v_mfma_f32_16x16x32_bf16 v[168:171], a[48:51], a[12:15], v[168:171]
ds_read_b64_tr_b16 a[122:123], v10 offset:58368
s_add_u32 s31, s31, s32
v_mfma_f32_16x16x32_bf16 v[176:179], a[48:51], a[16:19], v[176:179]
ds_read_b64_tr_b16 a[124:125], v11 offset:57344
v_mfma_f32_16x16x32_bf16 v[184:187], a[48:51], a[20:23], v[184:187]
s_add_u32 m0, s43, 33792
v_mfma_f32_16x16x32_bf16 v[192:195], a[48:51], a[24:27], v[192:195]
ds_read_b64_tr_b16 a[126:127], v11 offset:58368
v_mfma_f32_16x16x32_bf16 v[200:203], a[48:51], a[28:31], v[200:203]
buffer_load_dwordx4 v3, s[12:15], s31 offen lds
v_mfma_f32_16x16x32_bf16 v[148:151], a[52:55], a[0:3], v[148:151]
v_mfma_f32_16x16x32_bf16 v[156:159], a[52:55], a[4:7], v[156:159]
v_mfma_f32_16x16x32_bf16 v[164:167], a[52:55], a[8:11], v[164:167]
s_add_u32 s31, s31, s33
v_mfma_f32_16x16x32_bf16 v[172:175], a[52:55], a[12:15], v[172:175]
v_mfma_f32_16x16x32_bf16 v[180:183], a[52:55], a[16:19], v[180:183]
s_add_u32 m0, s43, 36864
v_mfma_f32_16x16x32_bf16 v[188:191], a[52:55], a[20:23], v[188:191]
v_mfma_f32_16x16x32_bf16 v[196:199], a[52:55], a[24:27], v[196:199]
buffer_load_dwordx4 v3, s[12:15], s31 offen lds
v_mfma_f32_16x16x32_bf16 v[204:207], a[52:55], a[28:31], v[204:207]
v_mfma_f32_16x16x32_bf16 v[208:211], a[56:59], a[0:3], v[208:211]
s_add_u32 s31, s31, s32
v_mfma_f32_16x16x32_bf16 v[216:219], a[56:59], a[4:7], v[216:219]
v_mfma_f32_16x16x32_bf16 v[224:227], a[56:59], a[8:11], v[224:227]
s_add_u32 m0, s43, 37888
v_mfma_f32_16x16x32_bf16 v[232:235], a[56:59], a[12:15], v[232:235]
v_mfma_f32_16x16x32_bf16 v[240:243], a[56:59], a[16:19], v[240:243]
buffer_load_dwordx4 v3, s[12:15], s31 offen lds
v_mfma_f32_16x16x32_bf16 v[248:251], a[56:59], a[20:23], v[248:251]
v_mfma_f32_16x16x32_bf16 a[128:131], a[56:59], a[24:27], a[128:131]
s_add_u32 s31, s31, s33
v_mfma_f32_16x16x32_bf16 a[136:139], a[56:59], a[28:31], a[136:139]
v_mfma_f32_16x16x32_bf16 v[212:215], a[60:63], a[0:3], v[212:215]
s_add_u32 s38, s38, 32768
v_mfma_f32_16x16x32_bf16 v[220:223], a[60:63], a[4:7], v[220:223]
v_mfma_f32_16x16x32_bf16 v[228:231], a[60:63], a[8:11], v[228:231]
s_cmp_ge_u32 s38, s42
v_mfma_f32_16x16x32_bf16 v[236:239], a[60:63], a[12:15], v[236:239]
v_mfma_f32_16x16x32_bf16 v[244:247], a[60:63], a[16:19], v[244:247]
s_cselect_b32 s38, s41, s38
v_mfma_f32_16x16x32_bf16 v[252:255], a[60:63], a[20:23], v[252:255]
v_mfma_f32_16x16x32_bf16 a[132:135], a[60:63], a[24:27], a[132:135]
v_mfma_f32_16x16x32_bf16 a[140:143], a[60:63], a[28:31], a[140:143]
s_waitcnt vmcnt(16) lgkmcnt(0)
s_barrier
v_mfma_f32_16x16x32_bf16 v[16:19], a[96:99], a[64:67], v[16:19]
v_add_u32 v6, s37, v4
s_add_u32 m0, s34, 0
v_mfma_f32_16x16x32_bf16 v[24:27], a[96:99], a[68:71], v[24:27]
ds_read_b64_tr_b16 a[32:33], v8 offset:0
v_mfma_f32_16x16x32_bf16 v[32:35], a[96:99], a[72:75], v[32:35]
ds_read_b64_tr_b16 a[34:35], v8 offset:1024
buffer_load_dwordx4 v2, s[8:11], s28 offen lds
v_mfma_f32_16x16x32_bf16 v[40:43], a[96:99], a[76:79], v[40:43]
v_mfma_f32_16x16x32_bf16 v[48:51], a[96:99], a[80:83], v[48:51]
ds_read_b128 a[0:3], v6 offset:0
s_add_u32 s28, s28, s29
v_mfma_f32_16x16x32_bf16 v[56:59], a[96:99], a[84:87], v[56:59]
ds_read_b128 a[4:7], v6 offset:2048
v_mfma_f32_16x16x32_bf16 v[64:67], a[96:99], a[88:91], v[64:67]
v_mfma_f32_16x16x32_bf16 v[72:75], a[96:99], a[92:95], v[72:75]
ds_read_b128 a[8:11], v6 offset:4096
s_add_u32 m0, s34, 4096
v_mfma_f32_16x16x32_bf16 v[20:23], a[100:103], a[64:67], v[20:23]
v_mfma_f32_16x16x32_bf16 v[28:31], a[100:103], a[68:71], v[28:31]
ds_read_b128 a[12:15], v6 offset:6144
buffer_load_dwordx4 v2, s[8:11], s28 offen lds
v_mfma_f32_16x16x32_bf16 v[36:39], a[100:103], a[72:75], v[36:39]
ds_read_b128 a[16:19], v6 offset:8192
v_mfma_f32_16x16x32_bf16 v[44:47], a[100:103], a[76:79], v[44:47]
s_add_u32 s28, s28, s29
v_mfma_f32_16x16x32_bf16 v[52:55], a[100:103], a[80:83], v[52:55]
ds_read_b128 a[20:23], v6 offset:10240
v_mfma_f32_16x16x32_bf16 v[60:63], a[100:103], a[84:87], v[60:63]
v_mfma_f32_16x16x32_bf16 v[68:71], a[100:103], a[88:91], v[68:71]
ds_read_b128 a[24:27], v6 offset:12288
s_add_u32 m0, s34, 8192
v_mfma_f32_16x16x32_bf16 v[76:79], a[100:103], a[92:95], v[76:79]
ds_read_b128 a[28:31], v6 offset:14336
v_mfma_f32_16x16x32_bf16 v[80:83], a[104:107], a[64:67], v[80:83]
buffer_load_dwordx4 v2, s[8:11], s28 offen lds
v_mfma_f32_16x16x32_bf16 v[88:91], a[104:107], a[68:71], v[88:91]
ds_read_b64_tr_b16 a[36:37], v9 offset:0
v_mfma_f32_16x16x32_bf16 v[96:99], a[104:107], a[72:75], v[96:99]
ds_read_b64_tr_b16 a[38:39], v9 offset:1024
s_add_u32 s28, s28, s29
v_mfma_f32_16x16x32_bf16 v[104:107], a[104:107], a[76:79], v[104:107]
v_mfma_f32_16x16x32_bf16 v[112:115], a[104:107], a[80:83], v[112:115]
ds_read_b64_tr_b16 a[40:41], v10 offset:0
v_mfma_f32_16x16x32_bf16 v[120:123], a[104:107], a[84:87], v[120:123]
s_add_u32 m0, s34, 12288
v_mfma_f32_16x16x32_bf16 v[128:131], a[104:107], a[88:91], v[128:131]
ds_read_b64_tr_b16 a[42:43], v10 offset:1024
v_mfma_f32_16x16x32_bf16 v[136:139], a[104:107], a[92:95], v[136:139]
ds_read_b64_tr_b16 a[44:45], v11 offset:0
buffer_load_dwordx4 v2, s[8:11], s28 offen lds
v_mfma_f32_16x16x32_bf16 v[84:87], a[108:111], a[64:67], v[84:87]
v_mfma_f32_16x16x32_bf16 v[92:95], a[108:111], a[68:71], v[92:95]
ds_read_b64_tr_b16 a[46:47], v11 offset:1024
s_add_u32 s28, s28, s29
v_mfma_f32_16x16x32_bf16 v[100:103], a[108:111], a[72:75], v[100:103]
v_mfma_f32_16x16x32_bf16 v[108:111], a[108:111], a[76:79], v[108:111]
ds_read_b64_tr_b16 a[48:49], v8 offset:8192
v_mfma_f32_16x16x32_bf16 v[116:119], a[108:111], a[80:83], v[116:119]
ds_read_b64_tr_b16 a[50:51], v8 offset:9216
s_add_u32 m0, s43, 49152
v_mfma_f32_16x16x32_bf16 v[124:127], a[108:111], a[84:87], v[124:127]
v_mfma_f32_16x16x32_bf16 v[132:135], a[108:111], a[88:91], v[132:135]
ds_read_b64_tr_b16 a[52:53], v9 offset:8192
buffer_load_dwordx4 v3, s[12:15], s31 offen lds
v_mfma_f32_16x16x32_bf16 v[140:143], a[108:111], a[92:95], v[140:143]
ds_read_b64_tr_b16 a[54:55], v9 offset:9216
v_mfma_f32_16x16x32_bf16 v[144:147], a[112:115], a[64:67], v[144:147]
s_add_u32 s31, s31, s32
v_mfma_f32_16x16x32_bf16 v[152:155], a[112:115], a[68:71], v[152:155]
ds_read_b64_tr_b16 a[56:57], v10 offset:8192
v_mfma_f32_16x16x32_bf16 v[160:163], a[112:115], a[72:75], v[160:163]
v_mfma_f32_16x16x32_bf16 v[168:171], a[112:115], a[76:79], v[168:171]
ds_read_b64_tr_b16 a[58:59], v10 offset:9216
s_add_u32 m0, s43, 50176
v_mfma_f32_16x16x32_bf16 v[176:179], a[112:115], a[80:83], v[176:179]
ds_read_b64_tr_b16 a[60:61], v11 offset:8192
v_mfma_f32_16x16x32_bf16 v[184:187], a[112:115], a[84:87], v[184:187]
buffer_load_dwordx4 v3, s[12:15], s31 offen lds
v_mfma_f32_16x16x32_bf16 v[192:195], a[112:115], a[88:91], v[192:195]
ds_read_b64_tr_b16 a[62:63], v11 offset:9216
v_mfma_f32_16x16x32_bf16 v[200:203], a[112:115], a[92:95], v[200:203]
s_add_u32 s31, s31, s33
v_mfma_f32_16x16x32_bf16 v[148:151], a[116:119], a[64:67], v[148:151]
v_mfma_f32_16x16x32_bf16 v[156:159], a[116:119], a[68:71], v[156:159]
v_mfma_f32_16x16x32_bf16 v[164:167], a[116:119], a[72:75], v[164:167]
s_add_u32 m0, s43, 53248
v_mfma_f32_16x16x32_bf16 v[172:175], a[116:119], a[76:79], v[172:175]
v_mfma_f32_16x16x32_bf16 v[180:183], a[116:119], a[80:83], v[180:183]
buffer_load_dwordx4 v3, s[12:15], s31 offen lds
v_mfma_f32_16x16x32_bf16 v[188:191], a[116:119], a[84:87], v[188:191]
v_mfma_f32_16x16x32_bf16 v[196:199], a[116:119], a[88:91], v[196:199]
s_add_u32 s31, s31, s32
v_mfma_f32_16x16x32_bf16 v[204:207], a[116:119], a[92:95], v[204:207]
v_mfma_f32_16x16x32_bf16 v[208:211], a[120:123], a[64:67], v[208:211]
v_mfma_f32_16x16x32_bf16 v[216:219], a[120:123], a[68:71], v[216:219]
s_add_u32 m0, s43, 54272
v_mfma_f32_16x16x32_bf16 v[224:227], a[120:123], a[72:75], v[224:227]
v_mfma_f32_16x16x32_bf16 v[232:235], a[120:123], a[76:79], v[232:235]
buffer_load_dwordx4 v3, s[12:15], s31 offen lds
v_mfma_f32_16x16x32_bf16 v[240:243], a[120:123], a[80:83], v[240:243]
v_mfma_f32_16x16x32_bf16 v[248:251], a[120:123], a[84:87], v[248:251]
s_add_u32 s31, s31, s33
v_mfma_f32_16x16x32_bf16 a[128:131], a[120:123], a[88:91], a[128:131]
v_mfma_f32_16x16x32_bf16 a[136:139], a[120:123], a[92:95], a[136:139]
v_mfma_f32_16x16x32_bf16 v[212:215], a[124:127], a[64:67], v[212:215]
s_add_u32 s37, s37, 32768
v_mfma_f32_16x16x32_bf16 v[220:223], a[124:127], a[68:71], v[220:223]
v_mfma_f32_16x16x32_bf16 v[228:231], a[124:127], a[72:75], v[228:231]
s_cmp_ge_u32 s37, s42
v_mfma_f32_16x16x32_bf16 v[236:239], a[124:127], a[76:79], v[236:239]
v_mfma_f32_16x16x32_bf16 v[244:247], a[124:127], a[80:83], v[244:247]
s_cselect_b32 s37, s41, s37
v_mfma_f32_16x16x32_bf16 v[252:255], a[124:127], a[84:87], v[252:255]
v_mfma_f32_16x16x32_bf16 a[132:135], a[124:127], a[88:91], a[132:135]
v_mfma_f32_16x16x32_bf16 a[140:143], a[124:127], a[92:95], a[140:143]
s_nop 7
s_cmp_eq_u32 s63, 0
s_cbranch_scc1 fused_kernel_gnogu0
v_cvt_pk_bf16_f32 v16, v16, v17
v_cvt_pk_bf16_f32 v17, v18, v19
v_cvt_pk_bf16_f32 v18, v20, v21
v_cvt_pk_bf16_f32 v19, v22, v23
v_accvgpr_write_b32 a144, v16
v_accvgpr_write_b32 a145, v17
v_accvgpr_write_b32 a146, v18
v_accvgpr_write_b32 a147, v19
v_accvgpr_read_b32 v16, a136
v_accvgpr_read_b32 v20, a140
v_accvgpr_read_b32 v17, a137
v_accvgpr_read_b32 v21, a141
v_accvgpr_read_b32 v18, a138
v_accvgpr_read_b32 v22, a142
v_accvgpr_read_b32 v19, a139
v_accvgpr_read_b32 v23, a143
v_cvt_pk_bf16_f32 v16, v16, v17
v_cvt_pk_bf16_f32 v17, v18, v19
v_cvt_pk_bf16_f32 v18, v20, v21
v_cvt_pk_bf16_f32 v19, v22, v23
s_add_u32 s40, s44, 62464
buffer_store_dwordx4 v[16:19], v12, s[4:7], s40 offen sc1
s_nop 1
v_accvgpr_read_b32 v16, a128
v_accvgpr_read_b32 v20, a132
v_accvgpr_read_b32 v17, a129
v_accvgpr_read_b32 v21, a133
v_accvgpr_read_b32 v18, a130
v_accvgpr_read_b32 v22, a134
v_accvgpr_read_b32 v19, a131
v_accvgpr_read_b32 v23, a135
v_cvt_pk_bf16_f32 v16, v16, v17
v_cvt_pk_bf16_f32 v17, v18, v19
v_cvt_pk_bf16_f32 v18, v20, v21
v_cvt_pk_bf16_f32 v19, v22, v23
v_accvgpr_write_b32 a252, v16
v_accvgpr_write_b32 a253, v17
v_accvgpr_write_b32 a254, v18
v_accvgpr_write_b32 a255, v19
s_waitcnt vmcnt(17) lgkmcnt(0)
s_barrier
v_mfma_f32_16x16x32_bf16 v[16:19], a[32:35], a[0:3], 0
v_add_u32 v7, s38, v5
s_add_u32 m0, s34, 16384
v_cvt_pk_bf16_f32 v24, v24, v25
v_cvt_pk_bf16_f32 v25, v26, v27
v_cvt_pk_bf16_f32 v26, v28, v29
v_cvt_pk_bf16_f32 v27, v30, v31
v_accvgpr_write_b32 a160, v24
v_accvgpr_write_b32 a161, v25
v_accvgpr_write_b32 a162, v26
v_accvgpr_write_b32 a163, v27
v_mfma_f32_16x16x32_bf16 v[24:27], a[32:35], a[4:7], 0
ds_read_b64_tr_b16 a[96:97], v8 offset:16384
v_cvt_pk_bf16_f32 v32, v32, v33
v_cvt_pk_bf16_f32 v33, v34, v35
v_cvt_pk_bf16_f32 v34, v36, v37
v_cvt_pk_bf16_f32 v35, v38, v39
v_accvgpr_write_b32 a176, v32
v_accvgpr_write_b32 a177, v33
v_accvgpr_write_b32 a178, v34
v_accvgpr_write_b32 a179, v35
v_mfma_f32_16x16x32_bf16 v[32:35], a[32:35], a[8:11], 0
ds_read_b64_tr_b16 a[98:99], v8 offset:17408
buffer_load_dwordx4 v2, s[8:11], s28 offen lds
v_cvt_pk_bf16_f32 v40, v40, v41
v_cvt_pk_bf16_f32 v41, v42, v43
v_cvt_pk_bf16_f32 v42, v44, v45
v_cvt_pk_bf16_f32 v43, v46, v47
v_accvgpr_write_b32 a192, v40
v_accvgpr_write_b32 a193, v41
v_accvgpr_write_b32 a194, v42
v_accvgpr_write_b32 a195, v43
v_mfma_f32_16x16x32_bf16 v[40:43], a[32:35], a[12:15], 0
v_cvt_pk_bf16_f32 v48, v48, v49
v_cvt_pk_bf16_f32 v49, v50, v51
v_cvt_pk_bf16_f32 v50, v52, v53
v_cvt_pk_bf16_f32 v51, v54, v55
v_accvgpr_write_b32 a208, v48
v_accvgpr_write_b32 a209, v49
v_accvgpr_write_b32 a210, v50
v_accvgpr_write_b32 a211, v51
v_mfma_f32_16x16x32_bf16 v[48:51], a[32:35], a[16:19], 0
ds_read_b128 a[64:67], v7 offset:0
s_add_u32 s28, s28, s29
v_cvt_pk_bf16_f32 v56, v56, v57
v_cvt_pk_bf16_f32 v57, v58, v59
v_cvt_pk_bf16_f32 v58, v60, v61
v_cvt_pk_bf16_f32 v59, v62, v63
v_accvgpr_write_b32 a224, v56
v_accvgpr_write_b32 a225, v57
v_accvgpr_write_b32 a226, v58
v_accvgpr_write_b32 a227, v59
v_mfma_f32_16x16x32_bf16 v[56:59], a[32:35], a[20:23], 0
ds_read_b128 a[68:71], v7 offset:2048
v_cvt_pk_bf16_f32 v64, v64, v65
v_cvt_pk_bf16_f32 v65, v66, v67
v_cvt_pk_bf16_f32 v66, v68, v69
v_cvt_pk_bf16_f32 v67, v70, v71
v_accvgpr_write_b32 a240, v64
v_accvgpr_write_b32 a241, v65
v_accvgpr_write_b32 a242, v66
v_accvgpr_write_b32 a243, v67
v_mfma_f32_16x16x32_bf16 v[64:67], a[32:35], a[24:27], 0
s_add_u32 m0, s34, 20480
v_cvt_pk_bf16_f32 v72, v72, v73
v_cvt_pk_bf16_f32 v73, v74, v75
v_cvt_pk_bf16_f32 v74, v76, v77
v_cvt_pk_bf16_f32 v75, v78, v79
s_add_u32 s40, s44, 57344
buffer_store_dwordx4 v[72:75], v12, s[4:7], s40 offen sc1
s_nop 1
v_mfma_f32_16x16x32_bf16 v[72:75], a[32:35], a[28:31], 0
ds_read_b128 a[72:75], v7 offset:4096
v_mfma_f32_16x16x32_bf16 v[20:23], a[36:39], a[0:3], 0
buffer_load_dwordx4 v2, s[8:11], s28 offen lds
v_mfma_f32_16x16x32_bf16 v[28:31], a[36:39], a[4:7], 0
ds_read_b128 a[76:79], v7 offset:6144
v_mfma_f32_16x16x32_bf16 v[36:39], a[36:39], a[8:11], 0
ds_read_b128 a[80:83], v7 offset:8192
s_add_u32 s28, s28, s29
v_mfma_f32_16x16x32_bf16 v[44:47], a[36:39], a[12:15], 0
v_mfma_f32_16x16x32_bf16 v[52:55], a[36:39], a[16:19], 0
ds_read_b128 a[84:87], v7 offset:10240
s_add_u32 m0, s34, 24576
v_mfma_f32_16x16x32_bf16 v[60:63], a[36:39], a[20:23], 0
v_mfma_f32_16x16x32_bf16 v[68:71], a[36:39], a[24:27], 0
ds_read_b128 a[88:91], v7 offset:12288
buffer_load_dwordx4 v2, s[8:11], s28 offen lds
v_mfma_f32_16x16x32_bf16 v[76:79], a[36:39], a[28:31], 0
ds_read_b128 a[92:95], v7 offset:14336
v_cvt_pk_bf16_f32 v80, v80, v81
v_cvt_pk_bf16_f32 v81, v82, v83
v_cvt_pk_bf16_f32 v82, v84, v85
v_cvt_pk_bf16_f32 v83, v86, v87
v_accvgpr_write_b32 a148, v80
v_accvgpr_write_b32 a149, v81
v_accvgpr_write_b32 a150, v82
v_accvgpr_write_b32 a151, v83
v_mfma_f32_16x16x32_bf16 v[80:83], a[40:43], a[0:3], 0
s_add_u32 s28, s28, s29
v_cvt_pk_bf16_f32 v88, v88, v89
v_cvt_pk_bf16_f32 v89, v90, v91
v_cvt_pk_bf16_f32 v90, v92, v93
v_cvt_pk_bf16_f32 v91, v94, v95
v_accvgpr_write_b32 a164, v88
v_accvgpr_write_b32 a165, v89
v_accvgpr_write_b32 a166, v90
v_accvgpr_write_b32 a167, v91
v_mfma_f32_16x16x32_bf16 v[88:91], a[40:43], a[4:7], 0
ds_read_b64_tr_b16 a[100:101], v9 offset:16384
v_cvt_pk_bf16_f32 v96, v96, v97
v_cvt_pk_bf16_f32 v97, v98, v99
v_cvt_pk_bf16_f32 v98, v100, v101
v_cvt_pk_bf16_f32 v99, v102, v103
v_accvgpr_write_b32 a180, v96
v_accvgpr_write_b32 a181, v97
v_accvgpr_write_b32 a182, v98
v_accvgpr_write_b32 a183, v99
v_mfma_f32_16x16x32_bf16 v[96:99], a[40:43], a[8:11], 0
ds_read_b64_tr_b16 a[102:103], v9 offset:17408
s_add_u32 m0, s34, 28672
v_cvt_pk_bf16_f32 v104, v104, v105
v_cvt_pk_bf16_f32 v105, v106, v107
v_cvt_pk_bf16_f32 v106, v108, v109
v_cvt_pk_bf16_f32 v107, v110, v111
v_accvgpr_write_b32 a196, v104
v_accvgpr_write_b32 a197, v105
v_accvgpr_write_b32 a198, v106
v_accvgpr_write_b32 a199, v107
v_mfma_f32_16x16x32_bf16 v[104:107], a[40:43], a[12:15], 0
v_cvt_pk_bf16_f32 v112, v112, v113
v_cvt_pk_bf16_f32 v113, v114, v115
v_cvt_pk_bf16_f32 v114, v116, v117
v_cvt_pk_bf16_f32 v115, v118, v119
v_accvgpr_write_b32 a212, v112
v_accvgpr_write_b32 a213, v113
v_accvgpr_write_b32 a214, v114
v_accvgpr_write_b32 a215, v115
v_mfma_f32_16x16x32_bf16 v[112:115], a[40:43], a[16:19], 0
ds_read_b64_tr_b16 a[104:105], v10 offset:16384
v_cvt_pk_bf16_f32 v120, v120, v121
v_cvt_pk_bf16_f32 v121, v122, v123
v_cvt_pk_bf16_f32 v122, v124, v125
v_cvt_pk_bf16_f32 v123, v126, v127
v_accvgpr_write_b32 a228, v120
v_accvgpr_write_b32 a229, v121
v_accvgpr_write_b32 a230, v122
v_accvgpr_write_b32 a231, v123
v_mfma_f32_16x16x32_bf16 v[120:123], a[40:43], a[20:23], 0
buffer_load_dwordx4 v2, s[8:11], s28 offen lds
v_cvt_pk_bf16_f32 v128, v128, v129
v_cvt_pk_bf16_f32 v129, v130, v131
v_cvt_pk_bf16_f32 v130, v132, v133
v_cvt_pk_bf16_f32 v131, v134, v135
v_accvgpr_write_b32 a244, v128
v_accvgpr_write_b32 a245, v129
v_accvgpr_write_b32 a246, v130
v_accvgpr_write_b32 a247, v131
v_mfma_f32_16x16x32_bf16 v[128:131], a[40:43], a[24:27], 0
ds_read_b64_tr_b16 a[106:107], v10 offset:17408
v_cvt_pk_bf16_f32 v136, v136, v137
v_cvt_pk_bf16_f32 v137, v138, v139
v_cvt_pk_bf16_f32 v138, v140, v141
v_cvt_pk_bf16_f32 v139, v142, v143
s_add_u32 s40, s44, 58368
buffer_store_dwordx4 v[136:139], v12, s[4:7], s40 offen sc1
s_nop 1
v_mfma_f32_16x16x32_bf16 v[136:139], a[40:43], a[28:31], 0
ds_read_b64_tr_b16 a[108:109], v11 offset:16384
s_add_u32 s28, s28, s30
v_mfma_f32_16x16x32_bf16 v[84:87], a[44:47], a[0:3], 0
v_mfma_f32_16x16x32_bf16 v[92:95], a[44:47], a[4:7], 0
ds_read_b64_tr_b16 a[110:111], v11 offset:17408
s_add_u32 s34, s34, 32768
v_mfma_f32_16x16x32_bf16 v[100:103], a[44:47], a[8:11], 0
v_mfma_f32_16x16x32_bf16 v[108:111], a[44:47], a[12:15], 0
ds_read_b64_tr_b16 a[112:113], v8 offset:24576
s_cmp_ge_u32 s34, s36
v_mfma_f32_16x16x32_bf16 v[116:119], a[44:47], a[16:19], 0
ds_read_b64_tr_b16 a[114:115], v8 offset:25600
v_mfma_f32_16x16x32_bf16 v[124:127], a[44:47], a[20:23], 0
s_cselect_b32 s34, s35, s34
v_mfma_f32_16x16x32_bf16 v[132:135], a[44:47], a[24:27], 0
ds_read_b64_tr_b16 a[116:117], v9 offset:24576
v_mfma_f32_16x16x32_bf16 v[140:143], a[44:47], a[28:31], 0
ds_read_b64_tr_b16 a[118:119], v9 offset:25600
s_add_u32 m0, s43, 0
v_cvt_pk_bf16_f32 v144, v144, v145
v_cvt_pk_bf16_f32 v145, v146, v147
v_cvt_pk_bf16_f32 v146, v148, v149
v_cvt_pk_bf16_f32 v147, v150, v151
v_accvgpr_write_b32 a152, v144
v_accvgpr_write_b32 a153, v145
v_accvgpr_write_b32 a154, v146
v_accvgpr_write_b32 a155, v147
v_mfma_f32_16x16x32_bf16 v[144:147], a[48:51], a[0:3], 0
v_cvt_pk_bf16_f32 v152, v152, v153
v_cvt_pk_bf16_f32 v153, v154, v155
v_cvt_pk_bf16_f32 v154, v156, v157
v_cvt_pk_bf16_f32 v155, v158, v159
v_accvgpr_write_b32 a168, v152
v_accvgpr_write_b32 a169, v153
v_accvgpr_write_b32 a170, v154
v_accvgpr_write_b32 a171, v155
v_mfma_f32_16x16x32_bf16 v[152:155], a[48:51], a[4:7], 0
ds_read_b64_tr_b16 a[120:121], v10 offset:24576
buffer_load_dwordx4 v3, s[12:15], s31 offen lds
v_cvt_pk_bf16_f32 v160, v160, v161
v_cvt_pk_bf16_f32 v161, v162, v163
v_cvt_pk_bf16_f32 v162, v164, v165
v_cvt_pk_bf16_f32 v163, v166, v167
v_accvgpr_write_b32 a184, v160
v_accvgpr_write_b32 a185, v161
v_accvgpr_write_b32 a186, v162
v_accvgpr_write_b32 a187, v163
v_mfma_f32_16x16x32_bf16 v[160:163], a[48:51], a[8:11], 0
v_cvt_pk_bf16_f32 v168, v168, v169
v_cvt_pk_bf16_f32 v169, v170, v171
v_cvt_pk_bf16_f32 v170, v172, v173
v_cvt_pk_bf16_f32 v171, v174, v175
v_accvgpr_write_b32 a200, v168
v_accvgpr_write_b32 a201, v169
v_accvgpr_write_b32 a202, v170
v_accvgpr_write_b32 a203, v171
v_mfma_f32_16x16x32_bf16 v[168:171], a[48:51], a[12:15], 0
ds_read_b64_tr_b16 a[122:123], v10 offset:25600
s_add_u32 s31, s31, s32
v_cvt_pk_bf16_f32 v176, v176, v177
v_cvt_pk_bf16_f32 v177, v178, v179
v_cvt_pk_bf16_f32 v178, v180, v181
v_cvt_pk_bf16_f32 v179, v182, v183
v_accvgpr_write_b32 a216, v176
v_accvgpr_write_b32 a217, v177
v_accvgpr_write_b32 a218, v178
v_accvgpr_write_b32 a219, v179
v_mfma_f32_16x16x32_bf16 v[176:179], a[48:51], a[16:19], 0
ds_read_b64_tr_b16 a[124:125], v11 offset:24576
v_cvt_pk_bf16_f32 v184, v184, v185
v_cvt_pk_bf16_f32 v185, v186, v187
v_cvt_pk_bf16_f32 v186, v188, v189
v_cvt_pk_bf16_f32 v187, v190, v191
v_accvgpr_write_b32 a232, v184
v_accvgpr_write_b32 a233, v185
v_accvgpr_write_b32 a234, v186
v_accvgpr_write_b32 a235, v187
v_mfma_f32_16x16x32_bf16 v[184:187], a[48:51], a[20:23], 0
s_add_u32 m0, s43, 1024
v_cvt_pk_bf16_f32 v192, v192, v193
v_cvt_pk_bf16_f32 v193, v194, v195
v_cvt_pk_bf16_f32 v194, v196, v197
v_cvt_pk_bf16_f32 v195, v198, v199
v_accvgpr_write_b32 a248, v192
v_accvgpr_write_b32 a249, v193
v_accvgpr_write_b32 a250, v194
v_accvgpr_write_b32 a251, v195
v_mfma_f32_16x16x32_bf16 v[192:195], a[48:51], a[24:27], 0
ds_read_b64_tr_b16 a[126:127], v11 offset:25600
v_cvt_pk_bf16_f32 v200, v200, v201
v_cvt_pk_bf16_f32 v201, v202, v203
v_cvt_pk_bf16_f32 v202, v204, v205
v_cvt_pk_bf16_f32 v203, v206, v207
s_add_u32 s40, s44, 61440
buffer_store_dwordx4 v[200:203], v12, s[4:7], s40 offen sc1
s_nop 1
v_mfma_f32_16x16x32_bf16 v[200:203], a[48:51], a[28:31], 0
buffer_load_dwordx4 v3, s[12:15], s31 offen lds
v_mfma_f32_16x16x32_bf16 v[148:151], a[52:55], a[0:3], 0
v_mfma_f32_16x16x32_bf16 v[156:159], a[52:55], a[4:7], 0
v_mfma_f32_16x16x32_bf16 v[164:167], a[52:55], a[8:11], 0
s_add_u32 s31, s31, s33
v_mfma_f32_16x16x32_bf16 v[172:175], a[52:55], a[12:15], 0
v_mfma_f32_16x16x32_bf16 v[180:183], a[52:55], a[16:19], 0
s_add_u32 m0, s43, 4096
v_mfma_f32_16x16x32_bf16 v[188:191], a[52:55], a[20:23], 0
v_mfma_f32_16x16x32_bf16 v[196:199], a[52:55], a[24:27], 0
buffer_load_dwordx4 v3, s[12:15], s31 offen lds
v_mfma_f32_16x16x32_bf16 v[204:207], a[52:55], a[28:31], 0
v_cvt_pk_bf16_f32 v208, v208, v209
v_cvt_pk_bf16_f32 v209, v210, v211
v_cvt_pk_bf16_f32 v210, v212, v213
v_cvt_pk_bf16_f32 v211, v214, v215
v_accvgpr_write_b32 a156, v208
v_accvgpr_write_b32 a157, v209
v_accvgpr_write_b32 a158, v210
v_accvgpr_write_b32 a159, v211
v_mfma_f32_16x16x32_bf16 v[208:211], a[56:59], a[0:3], 0
s_add_u32 s31, s31, s32
v_cvt_pk_bf16_f32 v216, v216, v217
v_cvt_pk_bf16_f32 v217, v218, v219
v_cvt_pk_bf16_f32 v218, v220, v221
v_cvt_pk_bf16_f32 v219, v222, v223
v_accvgpr_write_b32 a172, v216
v_accvgpr_write_b32 a173, v217
v_accvgpr_write_b32 a174, v218
v_accvgpr_write_b32 a175, v219
v_mfma_f32_16x16x32_bf16 v[216:219], a[56:59], a[4:7], 0
v_cvt_pk_bf16_f32 v224, v224, v225
v_cvt_pk_bf16_f32 v225, v226, v227
v_cvt_pk_bf16_f32 v226, v228, v229
v_cvt_pk_bf16_f32 v227, v230, v231
v_accvgpr_write_b32 a188, v224
v_accvgpr_write_b32 a189, v225
v_accvgpr_write_b32 a190, v226
v_accvgpr_write_b32 a191, v227
v_mfma_f32_16x16x32_bf16 v[224:227], a[56:59], a[8:11], 0
s_add_u32 m0, s43, 5120
v_cvt_pk_bf16_f32 v232, v232, v233
v_cvt_pk_bf16_f32 v233, v234, v235
v_cvt_pk_bf16_f32 v234, v236, v237
v_cvt_pk_bf16_f32 v235, v238, v239
v_accvgpr_write_b32 a204, v232
v_accvgpr_write_b32 a205, v233
v_accvgpr_write_b32 a206, v234
v_accvgpr_write_b32 a207, v235
v_mfma_f32_16x16x32_bf16 v[232:235], a[56:59], a[12:15], 0
v_cvt_pk_bf16_f32 v240, v240, v241
v_cvt_pk_bf16_f32 v241, v242, v243
v_cvt_pk_bf16_f32 v242, v244, v245
v_cvt_pk_bf16_f32 v243, v246, v247
v_accvgpr_write_b32 a220, v240
v_accvgpr_write_b32 a221, v241
v_accvgpr_write_b32 a222, v242
v_accvgpr_write_b32 a223, v243
v_mfma_f32_16x16x32_bf16 v[240:243], a[56:59], a[16:19], 0
buffer_load_dwordx4 v3, s[12:15], s31 offen lds
v_cvt_pk_bf16_f32 v248, v248, v249
v_cvt_pk_bf16_f32 v249, v250, v251
v_cvt_pk_bf16_f32 v250, v252, v253
v_cvt_pk_bf16_f32 v251, v254, v255
v_accvgpr_write_b32 a236, v248
v_accvgpr_write_b32 a237, v249
v_accvgpr_write_b32 a238, v250
v_accvgpr_write_b32 a239, v251
v_mfma_f32_16x16x32_bf16 v[248:251], a[56:59], a[20:23], 0
v_mfma_f32_16x16x32_bf16 a[128:131], a[56:59], a[24:27], 0
s_add_u32 s31, s31, s33
v_mfma_f32_16x16x32_bf16 a[136:139], a[56:59], a[28:31], 0
v_mfma_f32_16x16x32_bf16 v[212:215], a[60:63], a[0:3], 0
s_add_u32 s38, s38, 32768
v_mfma_f32_16x16x32_bf16 v[220:223], a[60:63], a[4:7], 0
v_mfma_f32_16x16x32_bf16 v[228:231], a[60:63], a[8:11], 0
s_cmp_ge_u32 s38, s42
v_mfma_f32_16x16x32_bf16 v[236:239], a[60:63], a[12:15], 0
v_mfma_f32_16x16x32_bf16 v[244:247], a[60:63], a[16:19], 0
s_cselect_b32 s38, s41, s38
v_mfma_f32_16x16x32_bf16 v[252:255], a[60:63], a[20:23], 0
v_mfma_f32_16x16x32_bf16 a[132:135], a[60:63], a[24:27], 0
v_mfma_f32_16x16x32_bf16 a[140:143], a[60:63], a[28:31], 0
s_branch fused_kernel_gu
fused_kernel_gnogu0:
v_cvt_pk_bf16_f32 v16, v16, v17
v_cvt_pk_bf16_f32 v17, v18, v19
v_cvt_pk_bf16_f32 v18, v20, v21
v_cvt_pk_bf16_f32 v19, v22, v23
s_add_u32 s40, s44, 0
buffer_store_dwordx4 v[16:19], v12, s[4:7], s40 offen sc1
v_cvt_pk_bf16_f32 v24, v24, v25
v_cvt_pk_bf16_f32 v25, v26, v27
v_cvt_pk_bf16_f32 v26, v28, v29
v_cvt_pk_bf16_f32 v27, v30, v31
s_add_u32 s40, s44, 8192
buffer_store_dwordx4 v[24:27], v12, s[4:7], s40 offen sc1
v_cvt_pk_bf16_f32 v32, v32, v33
v_cvt_pk_bf16_f32 v33, v34, v35
v_cvt_pk_bf16_f32 v34, v36, v37
v_cvt_pk_bf16_f32 v35, v38, v39
s_add_u32 s40, s44, 16384
buffer_store_dwordx4 v[32:35], v12, s[4:7], s40 offen sc1
v_cvt_pk_bf16_f32 v40, v40, v41
v_cvt_pk_bf16_f32 v41, v42, v43
v_cvt_pk_bf16_f32 v42, v44, v45
v_cvt_pk_bf16_f32 v43, v46, v47
s_add_u32 s40, s44, 24576
buffer_store_dwordx4 v[40:43], v12, s[4:7], s40 offen sc1
v_cvt_pk_bf16_f32 v48, v48, v49
v_cvt_pk_bf16_f32 v49, v50, v51
v_cvt_pk_bf16_f32 v50, v52, v53
v_cvt_pk_bf16_f32 v51, v54, v55
s_add_u32 s40, s44, 32768
buffer_store_dwordx4 v[48:51], v12, s[4:7], s40 offen sc1
v_cvt_pk_bf16_f32 v56, v56, v57
v_cvt_pk_bf16_f32 v57, v58, v59
v_cvt_pk_bf16_f32 v58, v60, v61
v_cvt_pk_bf16_f32 v59, v62, v63
s_add_u32 s40, s44, 40960
buffer_store_dwordx4 v[56:59], v12, s[4:7], s40 offen sc1
v_cvt_pk_bf16_f32 v64, v64, v65
v_cvt_pk_bf16_f32 v65, v66, v67
v_cvt_pk_bf16_f32 v66, v68, v69
v_cvt_pk_bf16_f32 v67, v70, v71
s_add_u32 s40, s44, 49152
buffer_store_dwordx4 v[64:67], v12, s[4:7], s40 offen sc1
v_cvt_pk_bf16_f32 v72, v72, v73
v_cvt_pk_bf16_f32 v73, v74, v75
v_cvt_pk_bf16_f32 v74, v76, v77
v_cvt_pk_bf16_f32 v75, v78, v79
s_add_u32 s40, s44, 57344
buffer_store_dwordx4 v[72:75], v12, s[4:7], s40 offen sc1
v_cvt_pk_bf16_f32 v80, v80, v81
v_cvt_pk_bf16_f32 v81, v82, v83
v_cvt_pk_bf16_f32 v82, v84, v85
v_cvt_pk_bf16_f32 v83, v86, v87
s_add_u32 s40, s44, 1024
buffer_store_dwordx4 v[80:83], v12, s[4:7], s40 offen sc1
v_cvt_pk_bf16_f32 v88, v88, v89
v_cvt_pk_bf16_f32 v89, v90, v91
v_cvt_pk_bf16_f32 v90, v92, v93
v_cvt_pk_bf16_f32 v91, v94, v95
s_add_u32 s40, s44, 9216
buffer_store_dwordx4 v[88:91], v12, s[4:7], s40 offen sc1
v_cvt_pk_bf16_f32 v96, v96, v97
v_cvt_pk_bf16_f32 v97, v98, v99
v_cvt_pk_bf16_f32 v98, v100, v101
v_cvt_pk_bf16_f32 v99, v102, v103
s_add_u32 s40, s44, 17408
buffer_store_dwordx4 v[96:99], v12, s[4:7], s40 offen sc1
v_cvt_pk_bf16_f32 v104, v104, v105
v_cvt_pk_bf16_f32 v105, v106, v107
v_cvt_pk_bf16_f32 v106, v108, v109
v_cvt_pk_bf16_f32 v107, v110, v111
s_add_u32 s40, s44, 25600
buffer_store_dwordx4 v[104:107], v12, s[4:7], s40 offen sc1
v_cvt_pk_bf16_f32 v112, v112, v113
v_cvt_pk_bf16_f32 v113, v114, v115
v_cvt_pk_bf16_f32 v114, v116, v117
v_cvt_pk_bf16_f32 v115, v118, v119
s_add_u32 s40, s44, 33792
buffer_store_dwordx4 v[112:115], v12, s[4:7], s40 offen sc1
v_cvt_pk_bf16_f32 v120, v120, v121
v_cvt_pk_bf16_f32 v121, v122, v123
v_cvt_pk_bf16_f32 v122, v124, v125
v_cvt_pk_bf16_f32 v123, v126, v127
s_add_u32 s40, s44, 41984
buffer_store_dwordx4 v[120:123], v12, s[4:7], s40 offen sc1
v_cvt_pk_bf16_f32 v128, v128, v129
v_cvt_pk_bf16_f32 v129, v130, v131
v_cvt_pk_bf16_f32 v130, v132, v133
v_cvt_pk_bf16_f32 v131, v134, v135
s_add_u32 s40, s44, 50176
buffer_store_dwordx4 v[128:131], v12, s[4:7], s40 offen sc1
v_cvt_pk_bf16_f32 v136, v136, v137
v_cvt_pk_bf16_f32 v137, v138, v139
v_cvt_pk_bf16_f32 v138, v140, v141
v_cvt_pk_bf16_f32 v139, v142, v143
s_add_u32 s40, s44, 58368
buffer_store_dwordx4 v[136:139], v12, s[4:7], s40 offen sc1
v_cvt_pk_bf16_f32 v144, v144, v145
v_cvt_pk_bf16_f32 v145, v146, v147
v_cvt_pk_bf16_f32 v146, v148, v149
v_cvt_pk_bf16_f32 v147, v150, v151
s_add_u32 s40, s44, 4096
buffer_store_dwordx4 v[144:147], v12, s[4:7], s40 offen sc1
v_cvt_pk_bf16_f32 v152, v152, v153
v_cvt_pk_bf16_f32 v153, v154, v155
v_cvt_pk_bf16_f32 v154, v156, v157
v_cvt_pk_bf16_f32 v155, v158, v159
s_add_u32 s40, s44, 12288
buffer_store_dwordx4 v[152:155], v12, s[4:7], s40 offen sc1
v_cvt_pk_bf16_f32 v160, v160, v161
v_cvt_pk_bf16_f32 v161, v162, v163
v_cvt_pk_bf16_f32 v162, v164, v165
v_cvt_pk_bf16_f32 v163, v166, v167
s_add_u32 s40, s44, 20480
buffer_store_dwordx4 v[160:163], v12, s[4:7], s40 offen sc1
v_cvt_pk_bf16_f32 v168, v168, v169
v_cvt_pk_bf16_f32 v169, v170, v171
v_cvt_pk_bf16_f32 v170, v172, v173
v_cvt_pk_bf16_f32 v171, v174, v175
s_add_u32 s40, s44, 28672
buffer_store_dwordx4 v[168:171], v12, s[4:7], s40 offen sc1
v_cvt_pk_bf16_f32 v176, v176, v177
v_cvt_pk_bf16_f32 v177, v178, v179
v_cvt_pk_bf16_f32 v178, v180, v181
v_cvt_pk_bf16_f32 v179, v182, v183
s_add_u32 s40, s44, 36864
buffer_store_dwordx4 v[176:179], v12, s[4:7], s40 offen sc1
v_cvt_pk_bf16_f32 v184, v184, v185
v_cvt_pk_bf16_f32 v185, v186, v187
v_cvt_pk_bf16_f32 v186, v188, v189
v_cvt_pk_bf16_f32 v187, v190, v191
s_add_u32 s40, s44, 45056
buffer_store_dwordx4 v[184:187], v12, s[4:7], s40 offen sc1
v_cvt_pk_bf16_f32 v192, v192, v193
v_cvt_pk_bf16_f32 v193, v194, v195
v_cvt_pk_bf16_f32 v194, v196, v197
v_cvt_pk_bf16_f32 v195, v198, v199
s_add_u32 s40, s44, 53248
buffer_store_dwordx4 v[192:195], v12, s[4:7], s40 offen sc1
v_cvt_pk_bf16_f32 v200, v200, v201
v_cvt_pk_bf16_f32 v201, v202, v203
v_cvt_pk_bf16_f32 v202, v204, v205
v_cvt_pk_bf16_f32 v203, v206, v207
s_add_u32 s40, s44, 61440
buffer_store_dwordx4 v[200:203], v12, s[4:7], s40 offen sc1
v_cvt_pk_bf16_f32 v208, v208, v209
v_cvt_pk_bf16_f32 v209, v210, v211
v_cvt_pk_bf16_f32 v210, v212, v213
v_cvt_pk_bf16_f32 v211, v214, v215
s_add_u32 s40, s44, 5120
buffer_store_dwordx4 v[208:211], v12, s[4:7], s40 offen sc1
v_cvt_pk_bf16_f32 v216, v216, v217
v_cvt_pk_bf16_f32 v217, v218, v219
v_cvt_pk_bf16_f32 v218, v220, v221
v_cvt_pk_bf16_f32 v219, v222, v223
s_add_u32 s40, s44, 13312
buffer_store_dwordx4 v[216:219], v12, s[4:7], s40 offen sc1
v_cvt_pk_bf16_f32 v224, v224, v225
v_cvt_pk_bf16_f32 v225, v226, v227
v_cvt_pk_bf16_f32 v226, v228, v229
v_cvt_pk_bf16_f32 v227, v230, v231
s_add_u32 s40, s44, 21504
buffer_store_dwordx4 v[224:227], v12, s[4:7], s40 offen sc1
v_cvt_pk_bf16_f32 v232, v232, v233
v_cvt_pk_bf16_f32 v233, v234, v235
v_cvt_pk_bf16_f32 v234, v236, v237
v_cvt_pk_bf16_f32 v235, v238, v239
s_add_u32 s40, s44, 29696
buffer_store_dwordx4 v[232:235], v12, s[4:7], s40 offen sc1
v_cvt_pk_bf16_f32 v240, v240, v241
v_cvt_pk_bf16_f32 v241, v242, v243
v_cvt_pk_bf16_f32 v242, v244, v245
v_cvt_pk_bf16_f32 v243, v246, v247
s_add_u32 s40, s44, 37888
buffer_store_dwordx4 v[240:243], v12, s[4:7], s40 offen sc1
v_cvt_pk_bf16_f32 v248, v248, v249
v_cvt_pk_bf16_f32 v249, v250, v251
v_cvt_pk_bf16_f32 v250, v252, v253
v_cvt_pk_bf16_f32 v251, v254, v255
s_add_u32 s40, s44, 46080
buffer_store_dwordx4 v[248:251], v12, s[4:7], s40 offen sc1
v_accvgpr_read_b32 v16, a128
v_accvgpr_read_b32 v20, a132
v_accvgpr_read_b32 v17, a129
v_accvgpr_read_b32 v21, a133
v_accvgpr_read_b32 v18, a130
v_accvgpr_read_b32 v22, a134
v_accvgpr_read_b32 v19, a131
v_accvgpr_read_b32 v23, a135
v_cvt_pk_bf16_f32 v16, v16, v17
v_cvt_pk_bf16_f32 v17, v18, v19
v_cvt_pk_bf16_f32 v18, v20, v21
v_cvt_pk_bf16_f32 v19, v22, v23
s_add_u32 s40, s44, 54272
buffer_store_dwordx4 v[16:19], v12, s[4:7], s40 offen sc1
v_accvgpr_read_b32 v24, a136
v_accvgpr_read_b32 v28, a140
v_accvgpr_read_b32 v25, a137
v_accvgpr_read_b32 v29, a141
v_accvgpr_read_b32 v26, a138
v_accvgpr_read_b32 v30, a142
v_accvgpr_read_b32 v27, a139
v_accvgpr_read_b32 v31, a143
v_cvt_pk_bf16_f32 v24, v24, v25
v_cvt_pk_bf16_f32 v25, v26, v27
v_cvt_pk_bf16_f32 v26, v28, v29
v_cvt_pk_bf16_f32 v27, v30, v31
s_add_u32 s40, s44, 62464
buffer_store_dwordx4 v[24:27], v12, s[4:7], s40 offen sc1
s_branch fused_kernel_gnogu
fused_kernel_first1:
s_waitcnt vmcnt(16) lgkmcnt(0)
s_barrier
v_mfma_f32_16x16x32_bf16 v[16:19], a[0:3], a[32:35], 0
v_add_u32 v7, s38, v5
s_add_u32 m0, s34, 16384
v_mfma_f32_16x16x32_bf16 v[20:23], a[4:7], a[32:35], 0
ds_read_b64_tr_b16 a[96:97], v8 offset:16384
buffer_load_dwordx4 v2, s[8:11], s28 offen lds
v_mfma_f32_16x16x32_bf16 v[80:83], a[8:11], a[32:35], 0
ds_read_b64_tr_b16 a[98:99], v8 offset:17408
v_mfma_f32_16x16x32_bf16 v[84:87], a[12:15], a[32:35], 0
s_add_u32 s28, s28, s29
v_mfma_f32_16x16x32_bf16 v[144:147], a[16:19], a[32:35], 0
ds_read_b128 a[64:67], v7 offset:0
v_mfma_f32_16x16x32_bf16 v[148:151], a[20:23], a[32:35], 0
ds_read_b128 a[68:71], v7 offset:2048
s_add_u32 m0, s34, 20480
v_mfma_f32_16x16x32_bf16 v[208:211], a[24:27], a[32:35], 0
v_mfma_f32_16x16x32_bf16 v[212:215], a[28:31], a[32:35], 0
ds_read_b128 a[72:75], v7 offset:4096
buffer_load_dwordx4 v2, s[8:11], s28 offen lds
v_mfma_f32_16x16x32_bf16 v[24:27], a[0:3], a[36:39], 0
v_mfma_f32_16x16x32_bf16 v[28:31], a[4:7], a[36:39], 0
ds_read_b128 a[76:79], v7 offset:6144
s_add_u32 s28, s28, s29
v_mfma_f32_16x16x32_bf16 v[88:91], a[8:11], a[36:39], 0
ds_read_b128 a[80:83], v7 offset:8192
v_mfma_f32_16x16x32_bf16 v[92:95], a[12:15], a[36:39], 0
s_add_u32 m0, s34, 24576
v_mfma_f32_16x16x32_bf16 v[152:155], a[16:19], a[36:39], 0
ds_read_b128 a[84:87], v7 offset:10240
v_mfma_f32_16x16x32_bf16 v[156:159], a[20:23], a[36:39], 0
buffer_load_dwordx4 v2, s[8:11], s28 offen lds
v_mfma_f32_16x16x32_bf16 v[216:219], a[24:27], a[36:39], 0
ds_read_b128 a[88:91], v7 offset:12288
v_mfma_f32_16x16x32_bf16 v[220:223], a[28:31], a[36:39], 0
ds_read_b128 a[92:95], v7 offset:14336
s_add_u32 s28, s28, s29
v_mfma_f32_16x16x32_bf16 v[32:35], a[0:3], a[40:43], 0
v_mfma_f32_16x16x32_bf16 v[36:39], a[4:7], a[40:43], 0
ds_read_b64_tr_b16 a[100:101], v9 offset:16384
s_add_u32 m0, s34, 28672
v_mfma_f32_16x16x32_bf16 v[96:99], a[8:11], a[40:43], 0
ds_read_b64_tr_b16 a[102:103], v9 offset:17408
v_mfma_f32_16x16x32_bf16 v[100:103], a[12:15], a[40:43], 0
buffer_load_dwordx4 v2, s[8:11], s28 offen lds
v_mfma_f32_16x16x32_bf16 v[160:163], a[16:19], a[40:43], 0
ds_read_b64_tr_b16 a[104:105], v10 offset:16384
v_mfma_f32_16x16x32_bf16 v[164:167], a[20:23], a[40:43], 0
s_add_u32 s28, s28, s30
v_mfma_f32_16x16x32_bf16 v[224:227], a[24:27], a[40:43], 0
ds_read_b64_tr_b16 a[106:107], v10 offset:17408
v_mfma_f32_16x16x32_bf16 v[228:231], a[28:31], a[40:43], 0
ds_read_b64_tr_b16 a[108:109], v11 offset:16384
s_add_u32 s34, s34, 32768
v_mfma_f32_16x16x32_bf16 v[40:43], a[0:3], a[44:47], 0
v_mfma_f32_16x16x32_bf16 v[44:47], a[4:7], a[44:47], 0
ds_read_b64_tr_b16 a[110:111], v11 offset:17408
s_cmp_ge_u32 s34, s36
v_mfma_f32_16x16x32_bf16 v[104:107], a[8:11], a[44:47], 0
v_mfma_f32_16x16x32_bf16 v[108:111], a[12:15], a[44:47], 0
ds_read_b64_tr_b16 a[112:113], v8 offset:24576
s_cselect_b32 s34, s35, s34
v_mfma_f32_16x16x32_bf16 v[168:171], a[16:19], a[44:47], 0
ds_read_b64_tr_b16 a[114:115], v8 offset:25600
v_mfma_f32_16x16x32_bf16 v[172:175], a[20:23], a[44:47], 0
s_add_u32 m0, s43, 0
v_mfma_f32_16x16x32_bf16 v[232:235], a[24:27], a[44:47], 0
ds_read_b64_tr_b16 a[116:117], v9 offset:24576
v_mfma_f32_16x16x32_bf16 v[236:239], a[28:31], a[44:47], 0
ds_read_b64_tr_b16 a[118:119], v9 offset:25600
buffer_load_dwordx4 v3, s[12:15], s31 offen lds
v_mfma_f32_16x16x32_bf16 v[48:51], a[0:3], a[48:51], 0
v_mfma_f32_16x16x32_bf16 v[52:55], a[4:7], a[48:51], 0
ds_read_b64_tr_b16 a[120:121], v10 offset:24576
s_add_u32 s31, s31, s32
v_mfma_f32_16x16x32_bf16 v[112:115], a[8:11], a[48:51], 0
v_mfma_f32_16x16x32_bf16 v[116:119], a[12:15], a[48:51], 0
ds_read_b64_tr_b16 a[122:123], v10 offset:25600
s_add_u32 m0, s43, 1024
v_mfma_f32_16x16x32_bf16 v[176:179], a[16:19], a[48:51], 0
ds_read_b64_tr_b16 a[124:125], v11 offset:24576
v_mfma_f32_16x16x32_bf16 v[180:183], a[20:23], a[48:51], 0
buffer_load_dwordx4 v3, s[12:15], s31 offen lds
v_mfma_f32_16x16x32_bf16 v[240:243], a[24:27], a[48:51], 0
ds_read_b64_tr_b16 a[126:127], v11 offset:25600
v_mfma_f32_16x16x32_bf16 v[244:247], a[28:31], a[48:51], 0
s_add_u32 s31, s31, s33
v_mfma_f32_16x16x32_bf16 v[56:59], a[0:3], a[52:55], 0
v_mfma_f32_16x16x32_bf16 v[60:63], a[4:7], a[52:55], 0
s_add_u32 m0, s43, 4096
v_mfma_f32_16x16x32_bf16 v[120:123], a[8:11], a[52:55], 0
v_mfma_f32_16x16x32_bf16 v[124:127], a[12:15], a[52:55], 0
buffer_load_dwordx4 v3, s[12:15], s31 offen lds
v_mfma_f32_16x16x32_bf16 v[184:187], a[16:19], a[52:55], 0
v_mfma_f32_16x16x32_bf16 v[188:191], a[20:23], a[52:55], 0
s_add_u32 s31, s31, s32
v_mfma_f32_16x16x32_bf16 v[248:251], a[24:27], a[52:55], 0
v_mfma_f32_16x16x32_bf16 v[252:255], a[28:31], a[52:55], 0
s_add_u32 m0, s43, 5120
v_mfma_f32_16x16x32_bf16 v[64:67], a[0:3], a[56:59], 0
v_mfma_f32_16x16x32_bf16 v[68:71], a[4:7], a[56:59], 0
buffer_load_dwordx4 v3, s[12:15], s31 offen lds
v_mfma_f32_16x16x32_bf16 v[128:131], a[8:11], a[56:59], 0
v_mfma_f32_16x16x32_bf16 v[132:135], a[12:15], a[56:59], 0
s_add_u32 s31, s31, s33
v_mfma_f32_16x16x32_bf16 v[192:195], a[16:19], a[56:59], 0
v_mfma_f32_16x16x32_bf16 v[196:199], a[20:23], a[56:59], 0
s_add_u32 s38, s38, 32768
v_mfma_f32_16x16x32_bf16 a[128:131], a[24:27], a[56:59], 0
v_mfma_f32_16x16x32_bf16 a[132:135], a[28:31], a[56:59], 0
s_cmp_ge_u32 s38, s42
v_mfma_f32_16x16x32_bf16 v[72:75], a[0:3], a[60:63], 0
v_mfma_f32_16x16x32_bf16 v[76:79], a[4:7], a[60:63], 0
s_cselect_b32 s38, s41, s38
v_mfma_f32_16x16x32_bf16 v[136:139], a[8:11], a[60:63], 0
v_mfma_f32_16x16x32_bf16 v[140:143], a[12:15], a[60:63], 0
buffer_load_dword v0, v13, s[68:71], s84 offen
v_mfma_f32_16x16x32_bf16 v[200:203], a[16:19], a[60:63], 0
v_mfma_f32_16x16x32_bf16 v[204:207], a[20:23], a[60:63], 0
s_add_u32 s84, s84, s85
v_mfma_f32_16x16x32_bf16 a[136:139], a[24:27], a[60:63], 0
v_mfma_f32_16x16x32_bf16 a[140:143], a[28:31], a[60:63], 0
s_waitcnt vmcnt(16) lgkmcnt(0)
s_barrier
v_mfma_f32_16x16x32_bf16 v[16:19], a[64:67], a[96:99], v[16:19]
v_add_u32 v6, s37, v4
s_add_u32 m0, s34, 0
v_mfma_f32_16x16x32_bf16 v[20:23], a[68:71], a[96:99], v[20:23]
ds_read_b64_tr_b16 a[32:33], v8 offset:32768
v_mfma_f32_16x16x32_bf16 v[80:83], a[72:75], a[96:99], v[80:83]
ds_read_b64_tr_b16 a[34:35], v8 offset:33792
buffer_load_dwordx4 v2, s[8:11], s28 offen lds
v_mfma_f32_16x16x32_bf16 v[84:87], a[76:79], a[96:99], v[84:87]
v_mfma_f32_16x16x32_bf16 v[144:147], a[80:83], a[96:99], v[144:147]
ds_read_b128 a[0:3], v6 offset:0
s_add_u32 s28, s28, s29
v_mfma_f32_16x16x32_bf16 v[148:151], a[84:87], a[96:99], v[148:151]
ds_read_b128 a[4:7], v6 offset:2048
v_mfma_f32_16x16x32_bf16 v[208:211], a[88:91], a[96:99], v[208:211]
v_mfma_f32_16x16x32_bf16 v[212:215], a[92:95], a[96:99], v[212:215]
ds_read_b128 a[8:11], v6 offset:4096
s_add_u32 m0, s34, 4096
v_mfma_f32_16x16x32_bf16 v[24:27], a[64:67], a[100:103], v[24:27]
v_mfma_f32_16x16x32_bf16 v[28:31], a[68:71], a[100:103], v[28:31]
ds_read_b128 a[12:15], v6 offset:6144
buffer_load_dwordx4 v2, s[8:11], s28 offen lds
v_mfma_f32_16x16x32_bf16 v[88:91], a[72:75], a[100:103], v[88:91]
ds_read_b128 a[16:19], v6 offset:8192
v_mfma_f32_16x16x32_bf16 v[92:95], a[76:79], a[100:103], v[92:95]
s_add_u32 s28, s28, s29
v_mfma_f32_16x16x32_bf16 v[152:155], a[80:83], a[100:103], v[152:155]
ds_read_b128 a[20:23], v6 offset:10240
v_mfma_f32_16x16x32_bf16 v[156:159], a[84:87], a[100:103], v[156:159]
v_mfma_f32_16x16x32_bf16 v[216:219], a[88:91], a[100:103], v[216:219]
ds_read_b128 a[24:27], v6 offset:12288
s_add_u32 m0, s34, 8192
v_mfma_f32_16x16x32_bf16 v[220:223], a[92:95], a[100:103], v[220:223]
ds_read_b128 a[28:31], v6 offset:14336
v_mfma_f32_16x16x32_bf16 v[32:35], a[64:67], a[104:107], v[32:35]
buffer_load_dwordx4 v2, s[8:11], s28 offen lds
v_mfma_f32_16x16x32_bf16 v[36:39], a[68:71], a[104:107], v[36:39]
ds_read_b64_tr_b16 a[36:37], v9 offset:32768
v_mfma_f32_16x16x32_bf16 v[96:99], a[72:75], a[104:107], v[96:99]
ds_read_b64_tr_b16 a[38:39], v9 offset:33792
s_add_u32 s28, s28, s29
v_mfma_f32_16x16x32_bf16 v[100:103], a[76:79], a[104:107], v[100:103]
v_mfma_f32_16x16x32_bf16 v[160:163], a[80:83], a[104:107], v[160:163]
ds_read_b64_tr_b16 a[40:41], v10 offset:32768
v_mfma_f32_16x16x32_bf16 v[164:167], a[84:87], a[104:107], v[164:167]
s_add_u32 m0, s34, 12288
v_mfma_f32_16x16x32_bf16 v[224:227], a[88:91], a[104:107], v[224:227]
ds_read_b64_tr_b16 a[42:43], v10 offset:33792
v_mfma_f32_16x16x32_bf16 v[228:231], a[92:95], a[104:107], v[228:231]
ds_read_b64_tr_b16 a[44:45], v11 offset:32768
buffer_load_dwordx4 v2, s[8:11], s28 offen lds
v_mfma_f32_16x16x32_bf16 v[40:43], a[64:67], a[108:111], v[40:43]
v_mfma_f32_16x16x32_bf16 v[44:47], a[68:71], a[108:111], v[44:47]
ds_read_b64_tr_b16 a[46:47], v11 offset:33792
s_add_u32 s28, s28, s29
v_mfma_f32_16x16x32_bf16 v[104:107], a[72:75], a[108:111], v[104:107]
v_mfma_f32_16x16x32_bf16 v[108:111], a[76:79], a[108:111], v[108:111]
ds_read_b64_tr_b16 a[48:49], v8 offset:40960
v_mfma_f32_16x16x32_bf16 v[168:171], a[80:83], a[108:111], v[168:171]
ds_read_b64_tr_b16 a[50:51], v8 offset:41984
s_add_u32 m0, s43, 16384
v_mfma_f32_16x16x32_bf16 v[172:175], a[84:87], a[108:111], v[172:175]
v_mfma_f32_16x16x32_bf16 v[232:235], a[88:91], a[108:111], v[232:235]
ds_read_b64_tr_b16 a[52:53], v9 offset:40960
buffer_load_dwordx4 v3, s[12:15], s31 offen lds
v_mfma_f32_16x16x32_bf16 v[236:239], a[92:95], a[108:111], v[236:239]
ds_read_b64_tr_b16 a[54:55], v9 offset:41984
v_mfma_f32_16x16x32_bf16 v[48:51], a[64:67], a[112:115], v[48:51]
s_add_u32 s31, s31, s32
v_mfma_f32_16x16x32_bf16 v[52:55], a[68:71], a[112:115], v[52:55]
ds_read_b64_tr_b16 a[56:57], v10 offset:40960
v_mfma_f32_16x16x32_bf16 v[112:115], a[72:75], a[112:115], v[112:115]
v_mfma_f32_16x16x32_bf16 v[116:119], a[76:79], a[112:115], v[116:119]
ds_read_b64_tr_b16 a[58:59], v10 offset:41984
s_add_u32 m0, s43, 17408
v_mfma_f32_16x16x32_bf16 v[176:179], a[80:83], a[112:115], v[176:179]
ds_read_b64_tr_b16 a[60:61], v11 offset:40960
v_mfma_f32_16x16x32_bf16 v[180:183], a[84:87], a[112:115], v[180:183]
buffer_load_dwordx4 v3, s[12:15], s31 offen lds
v_mfma_f32_16x16x32_bf16 v[240:243], a[88:91], a[112:115], v[240:243]
ds_read_b64_tr_b16 a[62:63], v11 offset:41984
v_mfma_f32_16x16x32_bf16 v[244:247], a[92:95], a[112:115], v[244:247]
s_add_u32 s31, s31, s33
v_mfma_f32_16x16x32_bf16 v[56:59], a[64:67], a[116:119], v[56:59]
v_mfma_f32_16x16x32_bf16 v[60:63], a[68:71], a[116:119], v[60:63]
v_mfma_f32_16x16x32_bf16 v[120:123], a[72:75], a[116:119], v[120:123]
s_add_u32 m0, s43, 20480
v_mfma_f32_16x16x32_bf16 v[124:127], a[76:79], a[116:119], v[124:127]
v_mfma_f32_16x16x32_bf16 v[184:187], a[80:83], a[116:119], v[184:187]
buffer_load_dwordx4 v3, s[12:15], s31 offen lds
v_mfma_f32_16x16x32_bf16 v[188:191], a[84:87], a[116:119], v[188:191]
v_mfma_f32_16x16x32_bf16 v[248:251], a[88:91], a[116:119], v[248:251]
s_add_u32 s31, s31, s32
v_mfma_f32_16x16x32_bf16 v[252:255], a[92:95], a[116:119], v[252:255]
v_mfma_f32_16x16x32_bf16 v[64:67], a[64:67], a[120:123], v[64:67]
v_mfma_f32_16x16x32_bf16 v[68:71], a[68:71], a[120:123], v[68:71]
s_add_u32 m0, s43, 21504
v_mfma_f32_16x16x32_bf16 v[128:131], a[72:75], a[120:123], v[128:131]
v_mfma_f32_16x16x32_bf16 v[132:135], a[76:79], a[120:123], v[132:135]
buffer_load_dwordx4 v3, s[12:15], s31 offen lds
v_mfma_f32_16x16x32_bf16 v[192:195], a[80:83], a[120:123], v[192:195]
v_mfma_f32_16x16x32_bf16 v[196:199], a[84:87], a[120:123], v[196:199]
s_add_u32 s31, s31, s33
v_mfma_f32_16x16x32_bf16 a[128:131], a[88:91], a[120:123], a[128:131]
v_mfma_f32_16x16x32_bf16 a[132:135], a[92:95], a[120:123], a[132:135]
v_mfma_f32_16x16x32_bf16 v[72:75], a[64:67], a[124:127], v[72:75]
s_add_u32 s37, s37, 32768
v_mfma_f32_16x16x32_bf16 v[76:79], a[68:71], a[124:127], v[76:79]
v_mfma_f32_16x16x32_bf16 v[136:139], a[72:75], a[124:127], v[136:139]
s_cmp_ge_u32 s37, s42
v_mfma_f32_16x16x32_bf16 v[140:143], a[76:79], a[124:127], v[140:143]
v_mfma_f32_16x16x32_bf16 v[200:203], a[80:83], a[124:127], v[200:203]
s_cselect_b32 s37, s41, s37
v_mfma_f32_16x16x32_bf16 v[204:207], a[84:87], a[124:127], v[204:207]
v_mfma_f32_16x16x32_bf16 a[136:139], a[88:91], a[124:127], a[136:139]
v_mfma_f32_16x16x32_bf16 a[140:143], a[92:95], a[124:127], a[140:143]
s_waitcnt vmcnt(16) lgkmcnt(0)
s_barrier
v_mfma_f32_16x16x32_bf16 v[16:19], a[0:3], a[32:35], v[16:19]
v_add_u32 v7, s38, v5
s_add_u32 m0, s34, 16384
v_mfma_f32_16x16x32_bf16 v[20:23], a[4:7], a[32:35], v[20:23]
ds_read_b64_tr_b16 a[96:97], v8 offset:49152
v_mfma_f32_16x16x32_bf16 v[80:83], a[8:11], a[32:35], v[80:83]
ds_read_b64_tr_b16 a[98:99], v8 offset:50176
buffer_load_dwordx4 v2, s[8:11], s28 offen lds
v_mfma_f32_16x16x32_bf16 v[84:87], a[12:15], a[32:35], v[84:87]
v_mfma_f32_16x16x32_bf16 v[144:147], a[16:19], a[32:35], v[144:147]
ds_read_b128 a[64:67], v7 offset:0
s_add_u32 s28, s28, s29
v_mfma_f32_16x16x32_bf16 v[148:151], a[20:23], a[32:35], v[148:151]
ds_read_b128 a[68:71], v7 offset:2048
v_mfma_f32_16x16x32_bf16 v[208:211], a[24:27], a[32:35], v[208:211]
s_add_u32 m0, s34, 20480
v_mfma_f32_16x16x32_bf16 v[212:215], a[28:31], a[32:35], v[212:215]
ds_read_b128 a[72:75], v7 offset:4096
v_mfma_f32_16x16x32_bf16 v[24:27], a[0:3], a[36:39], v[24:27]
buffer_load_dwordx4 v2, s[8:11], s28 offen lds
v_mfma_f32_16x16x32_bf16 v[28:31], a[4:7], a[36:39], v[28:31]
ds_read_b128 a[76:79], v7 offset:6144
v_mfma_f32_16x16x32_bf16 v[88:91], a[8:11], a[36:39], v[88:91]
ds_read_b128 a[80:83], v7 offset:8192
s_add_u32 s28, s28, s29
v_mfma_f32_16x16x32_bf16 v[92:95], a[12:15], a[36:39], v[92:95]
v_mfma_f32_16x16x32_bf16 v[152:155], a[16:19], a[36:39], v[152:155]
ds_read_b128 a[84:87], v7 offset:10240
s_add_u32 m0, s34, 24576
v_mfma_f32_16x16x32_bf16 v[156:159], a[20:23], a[36:39], v[156:159]
v_mfma_f32_16x16x32_bf16 v[216:219], a[24:27], a[36:39], v[216:219]
ds_read_b128 a[88:91], v7 offset:12288
buffer_load_dwordx4 v2, s[8:11], s28 offen lds
v_mfma_f32_16x16x32_bf16 v[220:223], a[28:31], a[36:39], v[220:223]
ds_read_b128 a[92:95], v7 offset:14336
v_mfma_f32_16x16x32_bf16 v[32:35], a[0:3], a[40:43], v[32:35]
s_add_u32 s28, s28, s29
v_mfma_f32_16x16x32_bf16 v[36:39], a[4:7], a[40:43], v[36:39]
ds_read_b64_tr_b16 a[100:101], v9 offset:49152
v_mfma_f32_16x16x32_bf16 v[96:99], a[8:11], a[40:43], v[96:99]
ds_read_b64_tr_b16 a[102:103], v9 offset:50176
s_add_u32 m0, s34, 28672
v_mfma_f32_16x16x32_bf16 v[100:103], a[12:15], a[40:43], v[100:103]
v_mfma_f32_16x16x32_bf16 v[160:163], a[16:19], a[40:43], v[160:163]
ds_read_b64_tr_b16 a[104:105], v10 offset:49152
v_mfma_f32_16x16x32_bf16 v[164:167], a[20:23], a[40:43], v[164:167]
buffer_load_dwordx4 v2, s[8:11], s28 offen lds
v_mfma_f32_16x16x32_bf16 v[224:227], a[24:27], a[40:43], v[224:227]
ds_read_b64_tr_b16 a[106:107], v10 offset:50176
v_mfma_f32_16x16x32_bf16 v[228:231], a[28:31], a[40:43], v[228:231]
ds_read_b64_tr_b16 a[108:109], v11 offset:49152
s_add_u32 s28, s28, s30
v_mfma_f32_16x16x32_bf16 v[40:43], a[0:3], a[44:47], v[40:43]
v_mfma_f32_16x16x32_bf16 v[44:47], a[4:7], a[44:47], v[44:47]
ds_read_b64_tr_b16 a[110:111], v11 offset:50176
s_add_u32 s34, s34, 32768
v_mfma_f32_16x16x32_bf16 v[104:107], a[8:11], a[44:47], v[104:107]
v_mfma_f32_16x16x32_bf16 v[108:111], a[12:15], a[44:47], v[108:111]
ds_read_b64_tr_b16 a[112:113], v8 offset:57344
s_cmp_ge_u32 s34, s36
v_mfma_f32_16x16x32_bf16 v[168:171], a[16:19], a[44:47], v[168:171]
ds_read_b64_tr_b16 a[114:115], v8 offset:58368
v_mfma_f32_16x16x32_bf16 v[172:175], a[20:23], a[44:47], v[172:175]
s_cselect_b32 s34, s35, s34
v_mfma_f32_16x16x32_bf16 v[232:235], a[24:27], a[44:47], v[232:235]
ds_read_b64_tr_b16 a[116:117], v9 offset:57344
v_mfma_f32_16x16x32_bf16 v[236:239], a[28:31], a[44:47], v[236:239]
ds_read_b64_tr_b16 a[118:119], v9 offset:58368
s_add_u32 m0, s43, 32768
v_mfma_f32_16x16x32_bf16 v[48:51], a[0:3], a[48:51], v[48:51]
v_mfma_f32_16x16x32_bf16 v[52:55], a[4:7], a[48:51], v[52:55]
ds_read_b64_tr_b16 a[120:121], v10 offset:57344
buffer_load_dwordx4 v3, s[12:15], s31 offen lds
v_mfma_f32_16x16x32_bf16 v[112:115], a[8:11], a[48:51], v[112:115]
v_mfma_f32_16x16x32_bf16 v[116:119], a[12:15], a[48:51], v[116:119]
ds_read_b64_tr_b16 a[122:123], v10 offset:58368
s_add_u32 s31, s31, s32
v_mfma_f32_16x16x32_bf16 v[176:179], a[16:19], a[48:51], v[176:179]
ds_read_b64_tr_b16 a[124:125], v11 offset:57344
v_mfma_f32_16x16x32_bf16 v[180:183], a[20:23], a[48:51], v[180:183]
s_add_u32 m0, s43, 33792
v_mfma_f32_16x16x32_bf16 v[240:243], a[24:27], a[48:51], v[240:243]
ds_read_b64_tr_b16 a[126:127], v11 offset:58368
v_mfma_f32_16x16x32_bf16 v[244:247], a[28:31], a[48:51], v[244:247]
buffer_load_dwordx4 v3, s[12:15], s31 offen lds
v_mfma_f32_16x16x32_bf16 v[56:59], a[0:3], a[52:55], v[56:59]
v_mfma_f32_16x16x32_bf16 v[60:63], a[4:7], a[52:55], v[60:63]
v_mfma_f32_16x16x32_bf16 v[120:123], a[8:11], a[52:55], v[120:123]
s_add_u32 s31, s31, s33
v_mfma_f32_16x16x32_bf16 v[124:127], a[12:15], a[52:55], v[124:127]
v_mfma_f32_16x16x32_bf16 v[184:187], a[16:19], a[52:55], v[184:187]
s_add_u32 m0, s43, 36864
v_mfma_f32_16x16x32_bf16 v[188:191], a[20:23], a[52:55], v[188:191]
v_mfma_f32_16x16x32_bf16 v[248:251], a[24:27], a[52:55], v[248:251]
buffer_load_dwordx4 v3, s[12:15], s31 offen lds
v_mfma_f32_16x16x32_bf16 v[252:255], a[28:31], a[52:55], v[252:255]
v_mfma_f32_16x16x32_bf16 v[64:67], a[0:3], a[56:59], v[64:67]
s_add_u32 s31, s31, s32
v_mfma_f32_16x16x32_bf16 v[68:71], a[4:7], a[56:59], v[68:71]
v_mfma_f32_16x16x32_bf16 v[128:131], a[8:11], a[56:59], v[128:131]
s_add_u32 m0, s43, 37888
v_mfma_f32_16x16x32_bf16 v[132:135], a[12:15], a[56:59], v[132:135]
v_mfma_f32_16x16x32_bf16 v[192:195], a[16:19], a[56:59], v[192:195]
buffer_load_dwordx4 v3, s[12:15], s31 offen lds
v_mfma_f32_16x16x32_bf16 v[196:199], a[20:23], a[56:59], v[196:199]
v_mfma_f32_16x16x32_bf16 a[128:131], a[24:27], a[56:59], a[128:131]
s_add_u32 s31, s31, s33
v_mfma_f32_16x16x32_bf16 a[132:135], a[28:31], a[56:59], a[132:135]
v_mfma_f32_16x16x32_bf16 v[72:75], a[0:3], a[60:63], v[72:75]
s_add_u32 s38, s38, 32768
v_mfma_f32_16x16x32_bf16 v[76:79], a[4:7], a[60:63], v[76:79]
v_mfma_f32_16x16x32_bf16 v[136:139], a[8:11], a[60:63], v[136:139]
s_cmp_ge_u32 s38, s42
v_mfma_f32_16x16x32_bf16 v[140:143], a[12:15], a[60:63], v[140:143]
v_mfma_f32_16x16x32_bf16 v[200:203], a[16:19], a[60:63], v[200:203]
s_cselect_b32 s38, s41, s38
v_mfma_f32_16x16x32_bf16 v[204:207], a[20:23], a[60:63], v[204:207]
v_mfma_f32_16x16x32_bf16 a[136:139], a[24:27], a[60:63], a[136:139]
v_mfma_f32_16x16x32_bf16 a[140:143], a[28:31], a[60:63], a[140:143]
s_waitcnt vmcnt(16) lgkmcnt(0)
s_barrier
v_mfma_f32_16x16x32_bf16 v[16:19], a[64:67], a[96:99], v[16:19]
v_add_u32 v6, s37, v4
s_add_u32 m0, s34, 0
v_mfma_f32_16x16x32_bf16 v[20:23], a[68:71], a[96:99], v[20:23]
ds_read_b64_tr_b16 a[32:33], v8 offset:0
v_mfma_f32_16x16x32_bf16 v[80:83], a[72:75], a[96:99], v[80:83]
ds_read_b64_tr_b16 a[34:35], v8 offset:1024
buffer_load_dwordx4 v2, s[8:11], s28 offen lds
v_mfma_f32_16x16x32_bf16 v[84:87], a[76:79], a[96:99], v[84:87]
v_mfma_f32_16x16x32_bf16 v[144:147], a[80:83], a[96:99], v[144:147]
ds_read_b128 a[0:3], v6 offset:0
s_add_u32 s28, s28, s29
v_mfma_f32_16x16x32_bf16 v[148:151], a[84:87], a[96:99], v[148:151]
ds_read_b128 a[4:7], v6 offset:2048
v_mfma_f32_16x16x32_bf16 v[208:211], a[88:91], a[96:99], v[208:211]
v_mfma_f32_16x16x32_bf16 v[212:215], a[92:95], a[96:99], v[212:215]
ds_read_b128 a[8:11], v6 offset:4096
s_add_u32 m0, s34, 4096
v_mfma_f32_16x16x32_bf16 v[24:27], a[64:67], a[100:103], v[24:27]
v_mfma_f32_16x16x32_bf16 v[28:31], a[68:71], a[100:103], v[28:31]
ds_read_b128 a[12:15], v6 offset:6144
buffer_load_dwordx4 v2, s[8:11], s28 offen lds
v_mfma_f32_16x16x32_bf16 v[88:91], a[72:75], a[100:103], v[88:91]
ds_read_b128 a[16:19], v6 offset:8192
v_mfma_f32_16x16x32_bf16 v[92:95], a[76:79], a[100:103], v[92:95]
s_add_u32 s28, s28, s29
v_mfma_f32_16x16x32_bf16 v[152:155], a[80:83], a[100:103], v[152:155]
ds_read_b128 a[20:23], v6 offset:10240
v_mfma_f32_16x16x32_bf16 v[156:159], a[84:87], a[100:103], v[156:159]
v_mfma_f32_16x16x32_bf16 v[216:219], a[88:91], a[100:103], v[216:219]
ds_read_b128 a[24:27], v6 offset:12288
s_add_u32 m0, s34, 8192
v_mfma_f32_16x16x32_bf16 v[220:223], a[92:95], a[100:103], v[220:223]
ds_read_b128 a[28:31], v6 offset:14336
v_mfma_f32_16x16x32_bf16 v[32:35], a[64:67], a[104:107], v[32:35]
buffer_load_dwordx4 v2, s[8:11], s28 offen lds
v_mfma_f32_16x16x32_bf16 v[36:39], a[68:71], a[104:107], v[36:39]
ds_read_b64_tr_b16 a[36:37], v9 offset:0
v_mfma_f32_16x16x32_bf16 v[96:99], a[72:75], a[104:107], v[96:99]
ds_read_b64_tr_b16 a[38:39], v9 offset:1024
s_add_u32 s28, s28, s29
v_mfma_f32_16x16x32_bf16 v[100:103], a[76:79], a[104:107], v[100:103]
v_mfma_f32_16x16x32_bf16 v[160:163], a[80:83], a[104:107], v[160:163]
ds_read_b64_tr_b16 a[40:41], v10 offset:0
v_mfma_f32_16x16x32_bf16 v[164:167], a[84:87], a[104:107], v[164:167]
s_add_u32 m0, s34, 12288
v_mfma_f32_16x16x32_bf16 v[224:227], a[88:91], a[104:107], v[224:227]
ds_read_b64_tr_b16 a[42:43], v10 offset:1024
v_mfma_f32_16x16x32_bf16 v[228:231], a[92:95], a[104:107], v[228:231]
ds_read_b64_tr_b16 a[44:45], v11 offset:0
buffer_load_dwordx4 v2, s[8:11], s28 offen lds
v_mfma_f32_16x16x32_bf16 v[40:43], a[64:67], a[108:111], v[40:43]
v_mfma_f32_16x16x32_bf16 v[44:47], a[68:71], a[108:111], v[44:47]
ds_read_b64_tr_b16 a[46:47], v11 offset:1024
s_add_u32 s28, s28, s29
v_mfma_f32_16x16x32_bf16 v[104:107], a[72:75], a[108:111], v[104:107]
v_mfma_f32_16x16x32_bf16 v[108:111], a[76:79], a[108:111], v[108:111]
ds_read_b64_tr_b16 a[48:49], v8 offset:8192
v_mfma_f32_16x16x32_bf16 v[168:171], a[80:83], a[108:111], v[168:171]
ds_read_b64_tr_b16 a[50:51], v8 offset:9216
s_add_u32 m0, s43, 49152
v_mfma_f32_16x16x32_bf16 v[172:175], a[84:87], a[108:111], v[172:175]
v_mfma_f32_16x16x32_bf16 v[232:235], a[88:91], a[108:111], v[232:235]
ds_read_b64_tr_b16 a[52:53], v9 offset:8192
buffer_load_dwordx4 v3, s[12:15], s31 offen lds
v_mfma_f32_16x16x32_bf16 v[236:239], a[92:95], a[108:111], v[236:239]
ds_read_b64_tr_b16 a[54:55], v9 offset:9216
v_mfma_f32_16x16x32_bf16 v[48:51], a[64:67], a[112:115], v[48:51]
s_add_u32 s31, s31, s32
v_mfma_f32_16x16x32_bf16 v[52:55], a[68:71], a[112:115], v[52:55]
ds_read_b64_tr_b16 a[56:57], v10 offset:8192
v_mfma_f32_16x16x32_bf16 v[112:115], a[72:75], a[112:115], v[112:115]
v_mfma_f32_16x16x32_bf16 v[116:119], a[76:79], a[112:115], v[116:119]
ds_read_b64_tr_b16 a[58:59], v10 offset:9216
s_add_u32 m0, s43, 50176
v_mfma_f32_16x16x32_bf16 v[176:179], a[80:83], a[112:115], v[176:179]
ds_read_b64_tr_b16 a[60:61], v11 offset:8192
v_mfma_f32_16x16x32_bf16 v[180:183], a[84:87], a[112:115], v[180:183]
buffer_load_dwordx4 v3, s[12:15], s31 offen lds
v_mfma_f32_16x16x32_bf16 v[240:243], a[88:91], a[112:115], v[240:243]
ds_read_b64_tr_b16 a[62:63], v11 offset:9216
v_mfma_f32_16x16x32_bf16 v[244:247], a[92:95], a[112:115], v[244:247]
s_add_u32 s31, s31, s33
v_mfma_f32_16x16x32_bf16 v[56:59], a[64:67], a[116:119], v[56:59]
v_mfma_f32_16x16x32_bf16 v[60:63], a[68:71], a[116:119], v[60:63]
v_mfma_f32_16x16x32_bf16 v[120:123], a[72:75], a[116:119], v[120:123]
s_add_u32 m0, s43, 53248
v_mfma_f32_16x16x32_bf16 v[124:127], a[76:79], a[116:119], v[124:127]
v_mfma_f32_16x16x32_bf16 v[184:187], a[80:83], a[116:119], v[184:187]
buffer_load_dwordx4 v3, s[12:15], s31 offen lds
v_mfma_f32_16x16x32_bf16 v[188:191], a[84:87], a[116:119], v[188:191]
v_mfma_f32_16x16x32_bf16 v[248:251], a[88:91], a[116:119], v[248:251]
s_add_u32 s31, s31, s32
v_mfma_f32_16x16x32_bf16 v[252:255], a[92:95], a[116:119], v[252:255]
v_mfma_f32_16x16x32_bf16 v[64:67], a[64:67], a[120:123], v[64:67]
v_mfma_f32_16x16x32_bf16 v[68:71], a[68:71], a[120:123], v[68:71]
s_add_u32 m0, s43, 54272
v_mfma_f32_16x16x32_bf16 v[128:131], a[72:75], a[120:123], v[128:131]
v_mfma_f32_16x16x32_bf16 v[132:135], a[76:79], a[120:123], v[132:135]
buffer_load_dwordx4 v3, s[12:15], s31 offen lds
v_mfma_f32_16x16x32_bf16 v[192:195], a[80:83], a[120:123], v[192:195]
v_mfma_f32_16x16x32_bf16 v[196:199], a[84:87], a[120:123], v[196:199]
s_add_u32 s31, s31, s33
v_mfma_f32_16x16x32_bf16 a[128:131], a[88:91], a[120:123], a[128:131]
v_mfma_f32_16x16x32_bf16 a[132:135], a[92:95], a[120:123], a[132:135]
v_mfma_f32_16x16x32_bf16 v[72:75], a[64:67], a[124:127], v[72:75]
s_add_u32 s37, s37, 32768
v_mfma_f32_16x16x32_bf16 v[76:79], a[68:71], a[124:127], v[76:79]
v_mfma_f32_16x16x32_bf16 v[136:139], a[72:75], a[124:127], v[136:139]
s_cmp_ge_u32 s37, s42
v_mfma_f32_16x16x32_bf16 v[140:143], a[76:79], a[124:127], v[140:143]
v_mfma_f32_16x16x32_bf16 v[200:203], a[80:83], a[124:127], v[200:203]
s_cselect_b32 s37, s41, s37
v_mfma_f32_16x16x32_bf16 v[204:207], a[84:87], a[124:127], v[204:207]
v_mfma_f32_16x16x32_bf16 a[136:139], a[88:91], a[124:127], a[136:139]
v_mfma_f32_16x16x32_bf16 a[140:143], a[92:95], a[124:127], a[140:143]
.p2align 6
fused_kernel_L0_1:
s_waitcnt vmcnt(16) lgkmcnt(0)
s_barrier
v_mfma_f32_16x16x32_bf16 v[16:19], a[0:3], a[32:35], v[16:19]
v_add_u32 v7, s38, v5
s_add_u32 m0, s34, 16384
v_mfma_f32_16x16x32_bf16 v[20:23], a[4:7], a[32:35], v[20:23]
ds_read_b64_tr_b16 a[96:97], v8 offset:16384
buffer_load_dwordx4 v2, s[8:11], s28 offen lds
v_mfma_f32_16x16x32_bf16 v[80:83], a[8:11], a[32:35], v[80:83]
ds_read_b64_tr_b16 a[98:99], v8 offset:17408
v_mfma_f32_16x16x32_bf16 v[84:87], a[12:15], a[32:35], v[84:87]
s_add_u32 s28, s28, s29
v_mfma_f32_16x16x32_bf16 v[144:147], a[16:19], a[32:35], v[144:147]
ds_read_b128 a[64:67], v7 offset:0
v_mfma_f32_16x16x32_bf16 v[148:151], a[20:23], a[32:35], v[148:151]
ds_read_b128 a[68:71], v7 offset:2048
s_add_u32 m0, s34, 20480
v_mfma_f32_16x16x32_bf16 v[208:211], a[24:27], a[32:35], v[208:211]
v_mfma_f32_16x16x32_bf16 v[212:215], a[28:31], a[32:35], v[212:215]
ds_read_b128 a[72:75], v7 offset:4096
buffer_load_dwordx4 v2, s[8:11], s28 offen lds
v_mfma_f32_16x16x32_bf16 v[24:27], a[0:3], a[36:39], v[24:27]
v_mfma_f32_16x16x32_bf16 v[28:31], a[4:7], a[36:39], v[28:31]
ds_read_b128 a[76:79], v7 offset:6144
s_add_u32 s28, s28, s29
v_mfma_f32_16x16x32_bf16 v[88:91], a[8:11], a[36:39], v[88:91]
ds_read_b128 a[80:83], v7 offset:8192
v_mfma_f32_16x16x32_bf16 v[92:95], a[12:15], a[36:39], v[92:95]
s_add_u32 m0, s34, 24576
v_mfma_f32_16x16x32_bf16 v[152:155], a[16:19], a[36:39], v[152:155]
ds_read_b128 a[84:87], v7 offset:10240
v_mfma_f32_16x16x32_bf16 v[156:159], a[20:23], a[36:39], v[156:159]
buffer_load_dwordx4 v2, s[8:11], s28 offen lds
v_mfma_f32_16x16x32_bf16 v[216:219], a[24:27], a[36:39], v[216:219]
ds_read_b128 a[88:91], v7 offset:12288
v_mfma_f32_16x16x32_bf16 v[220:223], a[28:31], a[36:39], v[220:223]
ds_read_b128 a[92:95], v7 offset:14336
s_add_u32 s28, s28, s29
v_mfma_f32_16x16x32_bf16 v[32:35], a[0:3], a[40:43], v[32:35]
v_mfma_f32_16x16x32_bf16 v[36:39], a[4:7], a[40:43], v[36:39]
ds_read_b64_tr_b16 a[100:101], v9 offset:16384
s_add_u32 m0, s34, 28672
v_mfma_f32_16x16x32_bf16 v[96:99], a[8:11], a[40:43], v[96:99]
ds_read_b64_tr_b16 a[102:103], v9 offset:17408
v_mfma_f32_16x16x32_bf16 v[100:103], a[12:15], a[40:43], v[100:103]
buffer_load_dwordx4 v2, s[8:11], s28 offen lds
v_mfma_f32_16x16x32_bf16 v[160:163], a[16:19], a[40:43], v[160:163]
ds_read_b64_tr_b16 a[104:105], v10 offset:16384
v_mfma_f32_16x16x32_bf16 v[164:167], a[20:23], a[40:43], v[164:167]
s_add_u32 s28, s28, s30
v_mfma_f32_16x16x32_bf16 v[224:227], a[24:27], a[40:43], v[224:227]
ds_read_b64_tr_b16 a[106:107], v10 offset:17408
v_mfma_f32_16x16x32_bf16 v[228:231], a[28:31], a[40:43], v[228:231]
ds_read_b64_tr_b16 a[108:109], v11 offset:16384
s_add_u32 s34, s34, 32768
v_mfma_f32_16x16x32_bf16 v[40:43], a[0:3], a[44:47], v[40:43]
v_mfma_f32_16x16x32_bf16 v[44:47], a[4:7], a[44:47], v[44:47]
ds_read_b64_tr_b16 a[110:111], v11 offset:17408
s_cmp_ge_u32 s34, s36
v_mfma_f32_16x16x32_bf16 v[104:107], a[8:11], a[44:47], v[104:107]
v_mfma_f32_16x16x32_bf16 v[108:111], a[12:15], a[44:47], v[108:111]
ds_read_b64_tr_b16 a[112:113], v8 offset:24576
s_cselect_b32 s34, s35, s34
v_mfma_f32_16x16x32_bf16 v[168:171], a[16:19], a[44:47], v[168:171]
ds_read_b64_tr_b16 a[114:115], v8 offset:25600
v_mfma_f32_16x16x32_bf16 v[172:175], a[20:23], a[44:47], v[172:175]
s_add_u32 m0, s43, 0
v_mfma_f32_16x16x32_bf16 v[232:235], a[24:27], a[44:47], v[232:235]
ds_read_b64_tr_b16 a[116:117], v9 offset:24576
v_mfma_f32_16x16x32_bf16 v[236:239], a[28:31], a[44:47], v[236:239]
ds_read_b64_tr_b16 a[118:119], v9 offset:25600
buffer_load_dwordx4 v3, s[12:15], s31 offen lds
v_mfma_f32_16x16x32_bf16 v[48:51], a[0:3], a[48:51], v[48:51]
v_mfma_f32_16x16x32_bf16 v[52:55], a[4:7], a[48:51], v[52:55]
ds_read_b64_tr_b16 a[120:121], v10 offset:24576
s_add_u32 s31, s31, s32
v_mfma_f32_16x16x32_bf16 v[112:115], a[8:11], a[48:51], v[112:115]
v_mfma_f32_16x16x32_bf16 v[116:119], a[12:15], a[48:51], v[116:119]
ds_read_b64_tr_b16 a[122:123], v10 offset:25600
s_add_u32 m0, s43, 1024
v_mfma_f32_16x16x32_bf16 v[176:179], a[16:19], a[48:51], v[176:179]
ds_read_b64_tr_b16 a[124:125], v11 offset:24576
v_mfma_f32_16x16x32_bf16 v[180:183], a[20:23], a[48:51], v[180:183]
buffer_load_dwordx4 v3, s[12:15], s31 offen lds
v_mfma_f32_16x16x32_bf16 v[240:243], a[24:27], a[48:51], v[240:243]
ds_read_b64_tr_b16 a[126:127], v11 offset:25600
v_mfma_f32_16x16x32_bf16 v[244:247], a[28:31], a[48:51], v[244:247]
s_add_u32 s31, s31, s33
v_mfma_f32_16x16x32_bf16 v[56:59], a[0:3], a[52:55], v[56:59]
v_mfma_f32_16x16x32_bf16 v[60:63], a[4:7], a[52:55], v[60:63]
s_add_u32 m0, s43, 4096
v_mfma_f32_16x16x32_bf16 v[120:123], a[8:11], a[52:55], v[120:123]
v_mfma_f32_16x16x32_bf16 v[124:127], a[12:15], a[52:55], v[124:127]
buffer_load_dwordx4 v3, s[12:15], s31 offen lds
v_mfma_f32_16x16x32_bf16 v[184:187], a[16:19], a[52:55], v[184:187]
v_mfma_f32_16x16x32_bf16 v[188:191], a[20:23], a[52:55], v[188:191]
s_add_u32 s31, s31, s32
v_mfma_f32_16x16x32_bf16 v[248:251], a[24:27], a[52:55], v[248:251]
v_mfma_f32_16x16x32_bf16 v[252:255], a[28:31], a[52:55], v[252:255]
s_add_u32 m0, s43, 5120
v_mfma_f32_16x16x32_bf16 v[64:67], a[0:3], a[56:59], v[64:67]
v_mfma_f32_16x16x32_bf16 v[68:71], a[4:7], a[56:59], v[68:71]
buffer_load_dwordx4 v3, s[12:15], s31 offen lds
v_mfma_f32_16x16x32_bf16 v[128:131], a[8:11], a[56:59], v[128:131]
v_mfma_f32_16x16x32_bf16 v[132:135], a[12:15], a[56:59], v[132:135]
s_add_u32 s31, s31, s33
v_mfma_f32_16x16x32_bf16 v[192:195], a[16:19], a[56:59], v[192:195]
v_mfma_f32_16x16x32_bf16 v[196:199], a[20:23], a[56:59], v[196:199]
s_add_u32 s38, s38, 32768
v_mfma_f32_16x16x32_bf16 a[128:131], a[24:27], a[56:59], a[128:131]
v_mfma_f32_16x16x32_bf16 a[132:135], a[28:31], a[56:59], a[132:135]
s_cmp_ge_u32 s38, s42
v_mfma_f32_16x16x32_bf16 v[72:75], a[0:3], a[60:63], v[72:75]
v_mfma_f32_16x16x32_bf16 v[76:79], a[4:7], a[60:63], v[76:79]
s_cselect_b32 s38, s41, s38
v_mfma_f32_16x16x32_bf16 v[136:139], a[8:11], a[60:63], v[136:139]
v_mfma_f32_16x16x32_bf16 v[140:143], a[12:15], a[60:63], v[140:143]
buffer_load_dword v0, v13, s[68:71], s84 offen
v_mfma_f32_16x16x32_bf16 v[200:203], a[16:19], a[60:63], v[200:203]
v_mfma_f32_16x16x32_bf16 v[204:207], a[20:23], a[60:63], v[204:207]
s_add_u32 s84, s84, s85
v_mfma_f32_16x16x32_bf16 a[136:139], a[24:27], a[60:63], a[136:139]
v_mfma_f32_16x16x32_bf16 a[140:143], a[28:31], a[60:63], a[140:143]
s_waitcnt vmcnt(16) lgkmcnt(0)
s_barrier
v_mfma_f32_16x16x32_bf16 v[16:19], a[64:67], a[96:99], v[16:19]
v_add_u32 v6, s37, v4
s_add_u32 m0, s34, 0
v_mfma_f32_16x16x32_bf16 v[20:23], a[68:71], a[96:99], v[20:23]
ds_read_b64_tr_b16 a[32:33], v8 offset:32768
v_mfma_f32_16x16x32_bf16 v[80:83], a[72:75], a[96:99], v[80:83]
ds_read_b64_tr_b16 a[34:35], v8 offset:33792
buffer_load_dwordx4 v2, s[8:11], s28 offen lds
v_mfma_f32_16x16x32_bf16 v[84:87], a[76:79], a[96:99], v[84:87]
v_mfma_f32_16x16x32_bf16 v[144:147], a[80:83], a[96:99], v[144:147]
ds_read_b128 a[0:3], v6 offset:0
s_add_u32 s28, s28, s29
v_mfma_f32_16x16x32_bf16 v[148:151], a[84:87], a[96:99], v[148:151]
ds_read_b128 a[4:7], v6 offset:2048
v_mfma_f32_16x16x32_bf16 v[208:211], a[88:91], a[96:99], v[208:211]
v_mfma_f32_16x16x32_bf16 v[212:215], a[92:95], a[96:99], v[212:215]
ds_read_b128 a[8:11], v6 offset:4096
s_add_u32 m0, s34, 4096
v_mfma_f32_16x16x32_bf16 v[24:27], a[64:67], a[100:103], v[24:27]
v_mfma_f32_16x16x32_bf16 v[28:31], a[68:71], a[100:103], v[28:31]
ds_read_b128 a[12:15], v6 offset:6144
buffer_load_dwordx4 v2, s[8:11], s28 offen lds
v_mfma_f32_16x16x32_bf16 v[88:91], a[72:75], a[100:103], v[88:91]
ds_read_b128 a[16:19], v6 offset:8192
v_mfma_f32_16x16x32_bf16 v[92:95], a[76:79], a[100:103], v[92:95]
s_add_u32 s28, s28, s29
v_mfma_f32_16x16x32_bf16 v[152:155], a[80:83], a[100:103], v[152:155]
ds_read_b128 a[20:23], v6 offset:10240
v_mfma_f32_16x16x32_bf16 v[156:159], a[84:87], a[100:103], v[156:159]
v_mfma_f32_16x16x32_bf16 v[216:219], a[88:91], a[100:103], v[216:219]
ds_read_b128 a[24:27], v6 offset:12288
s_add_u32 m0, s34, 8192
v_mfma_f32_16x16x32_bf16 v[220:223], a[92:95], a[100:103], v[220:223]
ds_read_b128 a[28:31], v6 offset:14336
v_mfma_f32_16x16x32_bf16 v[32:35], a[64:67], a[104:107], v[32:35]
buffer_load_dwordx4 v2, s[8:11], s28 offen lds
v_mfma_f32_16x16x32_bf16 v[36:39], a[68:71], a[104:107], v[36:39]
ds_read_b64_tr_b16 a[36:37], v9 offset:32768
v_mfma_f32_16x16x32_bf16 v[96:99], a[72:75], a[104:107], v[96:99]
ds_read_b64_tr_b16 a[38:39], v9 offset:33792
s_add_u32 s28, s28, s29
v_mfma_f32_16x16x32_bf16 v[100:103], a[76:79], a[104:107], v[100:103]
v_mfma_f32_16x16x32_bf16 v[160:163], a[80:83], a[104:107], v[160:163]
ds_read_b64_tr_b16 a[40:41], v10 offset:32768
v_mfma_f32_16x16x32_bf16 v[164:167], a[84:87], a[104:107], v[164:167]
s_add_u32 m0, s34, 12288
v_mfma_f32_16x16x32_bf16 v[224:227], a[88:91], a[104:107], v[224:227]
ds_read_b64_tr_b16 a[42:43], v10 offset:33792
v_mfma_f32_16x16x32_bf16 v[228:231], a[92:95], a[104:107], v[228:231]
ds_read_b64_tr_b16 a[44:45], v11 offset:32768
buffer_load_dwordx4 v2, s[8:11], s28 offen lds
v_mfma_f32_16x16x32_bf16 v[40:43], a[64:67], a[108:111], v[40:43]
v_mfma_f32_16x16x32_bf16 v[44:47], a[68:71], a[108:111], v[44:47]
ds_read_b64_tr_b16 a[46:47], v11 offset:33792
s_add_u32 s28, s28, s29
v_mfma_f32_16x16x32_bf16 v[104:107], a[72:75], a[108:111], v[104:107]
v_mfma_f32_16x16x32_bf16 v[108:111], a[76:79], a[108:111], v[108:111]
ds_read_b64_tr_b16 a[48:49], v8 offset:40960
v_mfma_f32_16x16x32_bf16 v[168:171], a[80:83], a[108:111], v[168:171]
ds_read_b64_tr_b16 a[50:51], v8 offset:41984
s_add_u32 m0, s43, 16384
v_mfma_f32_16x16x32_bf16 v[172:175], a[84:87], a[108:111], v[172:175]
v_mfma_f32_16x16x32_bf16 v[232:235], a[88:91], a[108:111], v[232:235]
ds_read_b64_tr_b16 a[52:53], v9 offset:40960
buffer_load_dwordx4 v3, s[12:15], s31 offen lds
v_mfma_f32_16x16x32_bf16 v[236:239], a[92:95], a[108:111], v[236:239]
ds_read_b64_tr_b16 a[54:55], v9 offset:41984
v_mfma_f32_16x16x32_bf16 v[48:51], a[64:67], a[112:115], v[48:51]
s_add_u32 s31, s31, s32
v_mfma_f32_16x16x32_bf16 v[52:55], a[68:71], a[112:115], v[52:55]
ds_read_b64_tr_b16 a[56:57], v10 offset:40960
v_mfma_f32_16x16x32_bf16 v[112:115], a[72:75], a[112:115], v[112:115]
v_mfma_f32_16x16x32_bf16 v[116:119], a[76:79], a[112:115], v[116:119]
ds_read_b64_tr_b16 a[58:59], v10 offset:41984
s_add_u32 m0, s43, 17408
v_mfma_f32_16x16x32_bf16 v[176:179], a[80:83], a[112:115], v[176:179]
ds_read_b64_tr_b16 a[60:61], v11 offset:40960
v_mfma_f32_16x16x32_bf16 v[180:183], a[84:87], a[112:115], v[180:183]
buffer_load_dwordx4 v3, s[12:15], s31 offen lds
v_mfma_f32_16x16x32_bf16 v[240:243], a[88:91], a[112:115], v[240:243]
ds_read_b64_tr_b16 a[62:63], v11 offset:41984
v_mfma_f32_16x16x32_bf16 v[244:247], a[92:95], a[112:115], v[244:247]
s_add_u32 s31, s31, s33
v_mfma_f32_16x16x32_bf16 v[56:59], a[64:67], a[116:119], v[56:59]
v_mfma_f32_16x16x32_bf16 v[60:63], a[68:71], a[116:119], v[60:63]
v_mfma_f32_16x16x32_bf16 v[120:123], a[72:75], a[116:119], v[120:123]
s_add_u32 m0, s43, 20480
v_mfma_f32_16x16x32_bf16 v[124:127], a[76:79], a[116:119], v[124:127]
v_mfma_f32_16x16x32_bf16 v[184:187], a[80:83], a[116:119], v[184:187]
buffer_load_dwordx4 v3, s[12:15], s31 offen lds
v_mfma_f32_16x16x32_bf16 v[188:191], a[84:87], a[116:119], v[188:191]
v_mfma_f32_16x16x32_bf16 v[248:251], a[88:91], a[116:119], v[248:251]
s_add_u32 s31, s31, s32
v_mfma_f32_16x16x32_bf16 v[252:255], a[92:95], a[116:119], v[252:255]
v_mfma_f32_16x16x32_bf16 v[64:67], a[64:67], a[120:123], v[64:67]
v_mfma_f32_16x16x32_bf16 v[68:71], a[68:71], a[120:123], v[68:71]
s_add_u32 m0, s43, 21504
v_mfma_f32_16x16x32_bf16 v[128:131], a[72:75], a[120:123], v[128:131]
v_mfma_f32_16x16x32_bf16 v[132:135], a[76:79], a[120:123], v[132:135]
buffer_load_dwordx4 v3, s[12:15], s31 offen lds
v_mfma_f32_16x16x32_bf16 v[192:195], a[80:83], a[120:123], v[192:195]
v_mfma_f32_16x16x32_bf16 v[196:199], a[84:87], a[120:123], v[196:199]
s_add_u32 s31, s31, s33
v_mfma_f32_16x16x32_bf16 a[128:131], a[88:91], a[120:123], a[128:131]
v_mfma_f32_16x16x32_bf16 a[132:135], a[92:95], a[120:123], a[132:135]
v_mfma_f32_16x16x32_bf16 v[72:75], a[64:67], a[124:127], v[72:75]
s_add_u32 s37, s37, 32768
v_mfma_f32_16x16x32_bf16 v[76:79], a[68:71], a[124:127], v[76:79]
v_mfma_f32_16x16x32_bf16 v[136:139], a[72:75], a[124:127], v[136:139]
s_cmp_ge_u32 s37, s42
v_mfma_f32_16x16x32_bf16 v[140:143], a[76:79], a[124:127], v[140:143]
v_mfma_f32_16x16x32_bf16 v[200:203], a[80:83], a[124:127], v[200:203]
s_cselect_b32 s37, s41, s37
v_mfma_f32_16x16x32_bf16 v[204:207], a[84:87], a[124:127], v[204:207]
v_mfma_f32_16x16x32_bf16 a[136:139], a[88:91], a[124:127], a[136:139]
v_mfma_f32_16x16x32_bf16 a[140:143], a[92:95], a[124:127], a[140:143]
s_waitcnt vmcnt(16) lgkmcnt(0)
s_barrier
v_mfma_f32_16x16x32_bf16 v[16:19], a[0:3], a[32:35], v[16:19]
v_add_u32 v7, s38, v5
s_add_u32 m0, s34, 16384
v_mfma_f32_16x16x32_bf16 v[20:23], a[4:7], a[32:35], v[20:23]
ds_read_b64_tr_b16 a[96:97], v8 offset:49152
v_mfma_f32_16x16x32_bf16 v[80:83], a[8:11], a[32:35], v[80:83]
ds_read_b64_tr_b16 a[98:99], v8 offset:50176
buffer_load_dwordx4 v2, s[8:11], s28 offen lds
v_mfma_f32_16x16x32_bf16 v[84:87], a[12:15], a[32:35], v[84:87]
v_mfma_f32_16x16x32_bf16 v[144:147], a[16:19], a[32:35], v[144:147]
ds_read_b128 a[64:67], v7 offset:0
s_add_u32 s28, s28, s29
v_mfma_f32_16x16x32_bf16 v[148:151], a[20:23], a[32:35], v[148:151]
ds_read_b128 a[68:71], v7 offset:2048
v_mfma_f32_16x16x32_bf16 v[208:211], a[24:27], a[32:35], v[208:211]
s_add_u32 m0, s34, 20480
v_mfma_f32_16x16x32_bf16 v[212:215], a[28:31], a[32:35], v[212:215]
ds_read_b128 a[72:75], v7 offset:4096
v_mfma_f32_16x16x32_bf16 v[24:27], a[0:3], a[36:39], v[24:27]
buffer_load_dwordx4 v2, s[8:11], s28 offen lds
v_mfma_f32_16x16x32_bf16 v[28:31], a[4:7], a[36:39], v[28:31]
ds_read_b128 a[76:79], v7 offset:6144
v_mfma_f32_16x16x32_bf16 v[88:91], a[8:11], a[36:39], v[88:91]
ds_read_b128 a[80:83], v7 offset:8192
s_add_u32 s28, s28, s29
v_mfma_f32_16x16x32_bf16 v[92:95], a[12:15], a[36:39], v[92:95]
v_mfma_f32_16x16x32_bf16 v[152:155], a[16:19], a[36:39], v[152:155]
ds_read_b128 a[84:87], v7 offset:10240
s_add_u32 m0, s34, 24576
v_mfma_f32_16x16x32_bf16 v[156:159], a[20:23], a[36:39], v[156:159]
v_mfma_f32_16x16x32_bf16 v[216:219], a[24:27], a[36:39], v[216:219]
ds_read_b128 a[88:91], v7 offset:12288
buffer_load_dwordx4 v2, s[8:11], s28 offen lds
v_mfma_f32_16x16x32_bf16 v[220:223], a[28:31], a[36:39], v[220:223]
ds_read_b128 a[92:95], v7 offset:14336
v_mfma_f32_16x16x32_bf16 v[32:35], a[0:3], a[40:43], v[32:35]
s_add_u32 s28, s28, s29
v_mfma_f32_16x16x32_bf16 v[36:39], a[4:7], a[40:43], v[36:39]
ds_read_b64_tr_b16 a[100:101], v9 offset:49152
v_mfma_f32_16x16x32_bf16 v[96:99], a[8:11], a[40:43], v[96:99]
ds_read_b64_tr_b16 a[102:103], v9 offset:50176
s_add_u32 m0, s34, 28672
v_mfma_f32_16x16x32_bf16 v[100:103], a[12:15], a[40:43], v[100:103]
v_mfma_f32_16x16x32_bf16 v[160:163], a[16:19], a[40:43], v[160:163]
ds_read_b64_tr_b16 a[104:105], v10 offset:49152
v_mfma_f32_16x16x32_bf16 v[164:167], a[20:23], a[40:43], v[164:167]
buffer_load_dwordx4 v2, s[8:11], s28 offen lds
v_mfma_f32_16x16x32_bf16 v[224:227], a[24:27], a[40:43], v[224:227]
ds_read_b64_tr_b16 a[106:107], v10 offset:50176
v_mfma_f32_16x16x32_bf16 v[228:231], a[28:31], a[40:43], v[228:231]
ds_read_b64_tr_b16 a[108:109], v11 offset:49152
s_add_u32 s28, s28, s30
v_mfma_f32_16x16x32_bf16 v[40:43], a[0:3], a[44:47], v[40:43]
v_mfma_f32_16x16x32_bf16 v[44:47], a[4:7], a[44:47], v[44:47]
ds_read_b64_tr_b16 a[110:111], v11 offset:50176
s_add_u32 s34, s34, 32768
v_mfma_f32_16x16x32_bf16 v[104:107], a[8:11], a[44:47], v[104:107]
v_mfma_f32_16x16x32_bf16 v[108:111], a[12:15], a[44:47], v[108:111]
ds_read_b64_tr_b16 a[112:113], v8 offset:57344
s_cmp_ge_u32 s34, s36
v_mfma_f32_16x16x32_bf16 v[168:171], a[16:19], a[44:47], v[168:171]
ds_read_b64_tr_b16 a[114:115], v8 offset:58368
v_mfma_f32_16x16x32_bf16 v[172:175], a[20:23], a[44:47], v[172:175]
s_cselect_b32 s34, s35, s34
v_mfma_f32_16x16x32_bf16 v[232:235], a[24:27], a[44:47], v[232:235]
ds_read_b64_tr_b16 a[116:117], v9 offset:57344
v_mfma_f32_16x16x32_bf16 v[236:239], a[28:31], a[44:47], v[236:239]
ds_read_b64_tr_b16 a[118:119], v9 offset:58368
s_add_u32 m0, s43, 32768
v_mfma_f32_16x16x32_bf16 v[48:51], a[0:3], a[48:51], v[48:51]
v_mfma_f32_16x16x32_bf16 v[52:55], a[4:7], a[48:51], v[52:55]
ds_read_b64_tr_b16 a[120:121], v10 offset:57344
buffer_load_dwordx4 v3, s[12:15], s31 offen lds
v_mfma_f32_16x16x32_bf16 v[112:115], a[8:11], a[48:51], v[112:115]
v_mfma_f32_16x16x32_bf16 v[116:119], a[12:15], a[48:51], v[116:119]
ds_read_b64_tr_b16 a[122:123], v10 offset:58368
s_add_u32 s31, s31, s32
v_mfma_f32_16x16x32_bf16 v[176:179], a[16:19], a[48:51], v[176:179]
ds_read_b64_tr_b16 a[124:125], v11 offset:57344
v_mfma_f32_16x16x32_bf16 v[180:183], a[20:23], a[48:51], v[180:183]
s_add_u32 m0, s43, 33792
v_mfma_f32_16x16x32_bf16 v[240:243], a[24:27], a[48:51], v[240:243]
ds_read_b64_tr_b16 a[126:127], v11 offset:58368
v_mfma_f32_16x16x32_bf16 v[244:247], a[28:31], a[48:51], v[244:247]
buffer_load_dwordx4 v3, s[12:15], s31 offen lds
v_mfma_f32_16x16x32_bf16 v[56:59], a[0:3], a[52:55], v[56:59]
v_mfma_f32_16x16x32_bf16 v[60:63], a[4:7], a[52:55], v[60:63]
v_mfma_f32_16x16x32_bf16 v[120:123], a[8:11], a[52:55], v[120:123]
s_add_u32 s31, s31, s33
v_mfma_f32_16x16x32_bf16 v[124:127], a[12:15], a[52:55], v[124:127]
v_mfma_f32_16x16x32_bf16 v[184:187], a[16:19], a[52:55], v[184:187]
s_add_u32 m0, s43, 36864
v_mfma_f32_16x16x32_bf16 v[188:191], a[20:23], a[52:55], v[188:191]
v_mfma_f32_16x16x32_bf16 v[248:251], a[24:27], a[52:55], v[248:251]
buffer_load_dwordx4 v3, s[12:15], s31 offen lds
v_mfma_f32_16x16x32_bf16 v[252:255], a[28:31], a[52:55], v[252:255]
v_mfma_f32_16x16x32_bf16 v[64:67], a[0:3], a[56:59], v[64:67]
s_add_u32 s31, s31, s32
v_mfma_f32_16x16x32_bf16 v[68:71], a[4:7], a[56:59], v[68:71]
v_mfma_f32_16x16x32_bf16 v[128:131], a[8:11], a[56:59], v[128:131]
s_add_u32 m0, s43, 37888
v_mfma_f32_16x16x32_bf16 v[132:135], a[12:15], a[56:59], v[132:135]
v_mfma_f32_16x16x32_bf16 v[192:195], a[16:19], a[56:59], v[192:195]
buffer_load_dwordx4 v3, s[12:15], s31 offen lds
v_mfma_f32_16x16x32_bf16 v[196:199], a[20:23], a[56:59], v[196:199]
v_mfma_f32_16x16x32_bf16 a[128:131], a[24:27], a[56:59], a[128:131]
s_add_u32 s31, s31, s33
v_mfma_f32_16x16x32_bf16 a[132:135], a[28:31], a[56:59], a[132:135]
v_mfma_f32_16x16x32_bf16 v[72:75], a[0:3], a[60:63], v[72:75]
s_add_u32 s38, s38, 32768
v_mfma_f32_16x16x32_bf16 v[76:79], a[4:7], a[60:63], v[76:79]
v_mfma_f32_16x16x32_bf16 v[136:139], a[8:11], a[60:63], v[136:139]
s_cmp_ge_u32 s38, s42
v_mfma_f32_16x16x32_bf16 v[140:143], a[12:15], a[60:63], v[140:143]
v_mfma_f32_16x16x32_bf16 v[200:203], a[16:19], a[60:63], v[200:203]
s_cselect_b32 s38, s41, s38
v_mfma_f32_16x16x32_bf16 v[204:207], a[20:23], a[60:63], v[204:207]
v_mfma_f32_16x16x32_bf16 a[136:139], a[24:27], a[60:63], a[136:139]
v_mfma_f32_16x16x32_bf16 a[140:143], a[28:31], a[60:63], a[140:143]
s_sub_u32 s40, s39, s58
s_cmp_eq_u32 s40, 1
s_cbranch_scc1 fused_kernel_swa_10
fused_kernel_swab_11:
s_waitcnt vmcnt(16) lgkmcnt(0)
s_barrier
v_mfma_f32_16x16x32_bf16 v[16:19], a[64:67], a[96:99], v[16:19]
v_add_u32 v6, s37, v4
s_add_u32 m0, s34, 0
v_mfma_f32_16x16x32_bf16 v[20:23], a[68:71], a[96:99], v[20:23]
ds_read_b64_tr_b16 a[32:33], v8 offset:0
v_mfma_f32_16x16x32_bf16 v[80:83], a[72:75], a[96:99], v[80:83]
ds_read_b64_tr_b16 a[34:35], v8 offset:1024
buffer_load_dwordx4 v2, s[8:11], s28 offen lds
v_mfma_f32_16x16x32_bf16 v[84:87], a[76:79], a[96:99], v[84:87]
v_mfma_f32_16x16x32_bf16 v[144:147], a[80:83], a[96:99], v[144:147]
ds_read_b128 a[0:3], v6 offset:0
s_add_u32 s28, s28, s29
v_mfma_f32_16x16x32_bf16 v[148:151], a[84:87], a[96:99], v[148:151]
ds_read_b128 a[4:7], v6 offset:2048
v_mfma_f32_16x16x32_bf16 v[208:211], a[88:91], a[96:99], v[208:211]
v_mfma_f32_16x16x32_bf16 v[212:215], a[92:95], a[96:99], v[212:215]
ds_read_b128 a[8:11], v6 offset:4096
s_add_u32 m0, s34, 4096
v_mfma_f32_16x16x32_bf16 v[24:27], a[64:67], a[100:103], v[24:27]
v_mfma_f32_16x16x32_bf16 v[28:31], a[68:71], a[100:103], v[28:31]
ds_read_b128 a[12:15], v6 offset:6144
buffer_load_dwordx4 v2, s[8:11], s28 offen lds
v_mfma_f32_16x16x32_bf16 v[88:91], a[72:75], a[100:103], v[88:91]
ds_read_b128 a[16:19], v6 offset:8192
v_mfma_f32_16x16x32_bf16 v[92:95], a[76:79], a[100:103], v[92:95]
s_add_u32 s28, s28, s29
v_mfma_f32_16x16x32_bf16 v[152:155], a[80:83], a[100:103], v[152:155]
ds_read_b128 a[20:23], v6 offset:10240
v_mfma_f32_16x16x32_bf16 v[156:159], a[84:87], a[100:103], v[156:159]
v_mfma_f32_16x16x32_bf16 v[216:219], a[88:91], a[100:103], v[216:219]
ds_read_b128 a[24:27], v6 offset:12288
s_add_u32 m0, s34, 8192
v_mfma_f32_16x16x32_bf16 v[220:223], a[92:95], a[100:103], v[220:223]
ds_read_b128 a[28:31], v6 offset:14336
v_mfma_f32_16x16x32_bf16 v[32:35], a[64:67], a[104:107], v[32:35]
buffer_load_dwordx4 v2, s[8:11], s28 offen lds
v_mfma_f32_16x16x32_bf16 v[36:39], a[68:71], a[104:107], v[36:39]
ds_read_b64_tr_b16 a[36:37], v9 offset:0
v_mfma_f32_16x16x32_bf16 v[96:99], a[72:75], a[104:107], v[96:99]
ds_read_b64_tr_b16 a[38:39], v9 offset:1024
s_add_u32 s28, s28, s29
v_mfma_f32_16x16x32_bf16 v[100:103], a[76:79], a[104:107], v[100:103]
v_mfma_f32_16x16x32_bf16 v[160:163], a[80:83], a[104:107], v[160:163]
ds_read_b64_tr_b16 a[40:41], v10 offset:0
v_mfma_f32_16x16x32_bf16 v[164:167], a[84:87], a[104:107], v[164:167]
s_add_u32 m0, s34, 12288
v_mfma_f32_16x16x32_bf16 v[224:227], a[88:91], a[104:107], v[224:227]
ds_read_b64_tr_b16 a[42:43], v10 offset:1024
v_mfma_f32_16x16x32_bf16 v[228:231], a[92:95], a[104:107], v[228:231]
ds_read_b64_tr_b16 a[44:45], v11 offset:0
buffer_load_dwordx4 v2, s[8:11], s28 offen lds
v_mfma_f32_16x16x32_bf16 v[40:43], a[64:67], a[108:111], v[40:43]
v_mfma_f32_16x16x32_bf16 v[44:47], a[68:71], a[108:111], v[44:47]
ds_read_b64_tr_b16 a[46:47], v11 offset:1024
s_add_u32 s28, s28, s29
v_mfma_f32_16x16x32_bf16 v[104:107], a[72:75], a[108:111], v[104:107]
v_mfma_f32_16x16x32_bf16 v[108:111], a[76:79], a[108:111], v[108:111]
ds_read_b64_tr_b16 a[48:49], v8 offset:8192
v_mfma_f32_16x16x32_bf16 v[168:171], a[80:83], a[108:111], v[168:171]
ds_read_b64_tr_b16 a[50:51], v8 offset:9216
s_add_u32 m0, s43, 49152
v_mfma_f32_16x16x32_bf16 v[172:175], a[84:87], a[108:111], v[172:175]
v_mfma_f32_16x16x32_bf16 v[232:235], a[88:91], a[108:111], v[232:235]
ds_read_b64_tr_b16 a[52:53], v9 offset:8192
buffer_load_dwordx4 v3, s[12:15], s31 offen lds
v_mfma_f32_16x16x32_bf16 v[236:239], a[92:95], a[108:111], v[236:239]
ds_read_b64_tr_b16 a[54:55], v9 offset:9216
v_mfma_f32_16x16x32_bf16 v[48:51], a[64:67], a[112:115], v[48:51]
s_add_u32 s31, s31, s32
v_mfma_f32_16x16x32_bf16 v[52:55], a[68:71], a[112:115], v[52:55]
ds_read_b64_tr_b16 a[56:57], v10 offset:8192
v_mfma_f32_16x16x32_bf16 v[112:115], a[72:75], a[112:115], v[112:115]
v_mfma_f32_16x16x32_bf16 v[116:119], a[76:79], a[112:115], v[116:119]
ds_read_b64_tr_b16 a[58:59], v10 offset:9216
s_add_u32 m0, s43, 50176
v_mfma_f32_16x16x32_bf16 v[176:179], a[80:83], a[112:115], v[176:179]
ds_read_b64_tr_b16 a[60:61], v11 offset:8192
v_mfma_f32_16x16x32_bf16 v[180:183], a[84:87], a[112:115], v[180:183]
buffer_load_dwordx4 v3, s[12:15], s31 offen lds
v_mfma_f32_16x16x32_bf16 v[240:243], a[88:91], a[112:115], v[240:243]
ds_read_b64_tr_b16 a[62:63], v11 offset:9216
v_mfma_f32_16x16x32_bf16 v[244:247], a[92:95], a[112:115], v[244:247]
s_add_u32 s31, s31, s33
v_mfma_f32_16x16x32_bf16 v[56:59], a[64:67], a[116:119], v[56:59]
v_mfma_f32_16x16x32_bf16 v[60:63], a[68:71], a[116:119], v[60:63]
v_mfma_f32_16x16x32_bf16 v[120:123], a[72:75], a[116:119], v[120:123]
s_add_u32 m0, s43, 53248
v_mfma_f32_16x16x32_bf16 v[124:127], a[76:79], a[116:119], v[124:127]
v_mfma_f32_16x16x32_bf16 v[184:187], a[80:83], a[116:119], v[184:187]
buffer_load_dwordx4 v3, s[12:15], s31 offen lds
v_mfma_f32_16x16x32_bf16 v[188:191], a[84:87], a[116:119], v[188:191]
v_mfma_f32_16x16x32_bf16 v[248:251], a[88:91], a[116:119], v[248:251]
s_add_u32 s31, s31, s32
v_mfma_f32_16x16x32_bf16 v[252:255], a[92:95], a[116:119], v[252:255]
v_mfma_f32_16x16x32_bf16 v[64:67], a[64:67], a[120:123], v[64:67]
v_mfma_f32_16x16x32_bf16 v[68:71], a[68:71], a[120:123], v[68:71]
s_add_u32 m0, s43, 54272
v_mfma_f32_16x16x32_bf16 v[128:131], a[72:75], a[120:123], v[128:131]
v_mfma_f32_16x16x32_bf16 v[132:135], a[76:79], a[120:123], v[132:135]
buffer_load_dwordx4 v3, s[12:15], s31 offen lds
v_mfma_f32_16x16x32_bf16 v[192:195], a[80:83], a[120:123], v[192:195]
v_mfma_f32_16x16x32_bf16 v[196:199], a[84:87], a[120:123], v[196:199]
s_add_u32 s31, s31, s33
v_mfma_f32_16x16x32_bf16 a[128:131], a[88:91], a[120:123], a[128:131]
v_mfma_f32_16x16x32_bf16 a[132:135], a[92:95], a[120:123], a[132:135]
v_mfma_f32_16x16x32_bf16 v[72:75], a[64:67], a[124:127], v[72:75]
s_add_u32 s37, s37, 32768
v_mfma_f32_16x16x32_bf16 v[76:79], a[68:71], a[124:127], v[76:79]
v_mfma_f32_16x16x32_bf16 v[136:139], a[72:75], a[124:127], v[136:139]
s_cmp_ge_u32 s37, s42
v_mfma_f32_16x16x32_bf16 v[140:143], a[76:79], a[124:127], v[140:143]
v_mfma_f32_16x16x32_bf16 v[200:203], a[80:83], a[124:127], v[200:203]
s_cselect_b32 s37, s41, s37
v_mfma_f32_16x16x32_bf16 v[204:207], a[84:87], a[124:127], v[204:207]
v_mfma_f32_16x16x32_bf16 a[136:139], a[88:91], a[124:127], a[136:139]
v_mfma_f32_16x16x32_bf16 a[140:143], a[92:95], a[124:127], a[140:143]
s_cmp_lg_u32 s39, 3
s_cbranch_scc1 fused_kernel_notouch_12
s_cmp_eq_u32 s49, 1
s_cbranch_scc1 fused_kernel_notouch_12
s_cmp_lg_u32 s3, 0
s_cbranch_scc1 fused_kernel_nolncld_13
buffer_load_dword v14, v12, s[64:67], 0 offen sc1
fused_kernel_nolncld_13:
fused_kernel_notouch_12:
s_sub_u32 s39, s39, 1
s_cmp_lg_u32 s39, 0
s_cbranch_scc1 fused_kernel_L0_1
s_cmp_eq_u32 s49, 1
s_cbranch_scc1 fused_kernel_qtail1
s_mov_b64 s[12:13], s[24:25]
s_mov_b64 s[14:15], s[26:27]
s_mov_b32 s31, s53
s_mov_b32 s32, s17
s_mov_b32 s33, s18
v_lshrrev_b32 v14, 4, v1
s_lshl_b32 s40, s50, 2
v_add_u32 v14, s40, v14
v_and_b32 v3, 15, v1
v_lshlrev_b32 v14, 1, v14
v_xor_b32 v3, v3, v14
v_lshlrev_b32 v3, 4, v3
v_lshrrev_b32 v0, 4, v1
s_movk_i32 s40, 3584
v_mul_lo_u32 v0, v0, s40
v_add_u32 v3, v3, v0
s_waitcnt vmcnt(16) lgkmcnt(0)
s_barrier
v_mfma_f32_16x16x32_bf16 v[16:19], a[0:3], a[32:35], v[16:19]
v_add_u32 v7, s38, v5
s_add_u32 m0, s34, 16384
v_mfma_f32_16x16x32_bf16 v[20:23], a[4:7], a[32:35], v[20:23]
ds_read_b64_tr_b16 a[96:97], v8 offset:16384
v_mfma_f32_16x16x32_bf16 v[80:83], a[8:11], a[32:35], v[80:83]
ds_read_b64_tr_b16 a[98:99], v8 offset:17408
buffer_load_dwordx4 v2, s[8:11], s28 offen lds
v_mfma_f32_16x16x32_bf16 v[84:87], a[12:15], a[32:35], v[84:87]
v_mfma_f32_16x16x32_bf16 v[144:147], a[16:19], a[32:35], v[144:147]
ds_read_b128 a[64:67], v7 offset:0
s_add_u32 s28, s28, s29
v_mfma_f32_16x16x32_bf16 v[148:151], a[20:23], a[32:35], v[148:151]
ds_read_b128 a[68:71], v7 offset:2048
v_mfma_f32_16x16x32_bf16 v[208:211], a[24:27], a[32:35], v[208:211]
s_add_u32 m0, s34, 20480
v_mfma_f32_16x16x32_bf16 v[212:215], a[28:31], a[32:35], v[212:215]
ds_read_b128 a[72:75], v7 offset:4096
v_mfma_f32_16x16x32_bf16 v[24:27], a[0:3], a[36:39], v[24:27]
buffer_load_dwordx4 v2, s[8:11], s28 offen lds
v_mfma_f32_16x16x32_bf16 v[28:31], a[4:7], a[36:39], v[28:31]
ds_read_b128 a[76:79], v7 offset:6144
v_mfma_f32_16x16x32_bf16 v[88:91], a[8:11], a[36:39], v[88:91]
ds_read_b128 a[80:83], v7 offset:8192
s_add_u32 s28, s28, s29
v_mfma_f32_16x16x32_bf16 v[92:95], a[12:15], a[36:39], v[92:95]
v_mfma_f32_16x16x32_bf16 v[152:155], a[16:19], a[36:39], v[152:155]
ds_read_b128 a[84:87], v7 offset:10240
s_add_u32 m0, s34, 24576
v_mfma_f32_16x16x32_bf16 v[156:159], a[20:23], a[36:39], v[156:159]
v_mfma_f32_16x16x32_bf16 v[216:219], a[24:27], a[36:39], v[216:219]
ds_read_b128 a[88:91], v7 offset:12288
buffer_load_dwordx4 v2, s[8:11], s28 offen lds
v_mfma_f32_16x16x32_bf16 v[220:223], a[28:31], a[36:39], v[220:223]
ds_read_b128 a[92:95], v7 offset:14336
v_mfma_f32_16x16x32_bf16 v[32:35], a[0:3], a[40:43], v[32:35]
s_add_u32 s28, s28, s29
v_mfma_f32_16x16x32_bf16 v[36:39], a[4:7], a[40:43], v[36:39]
ds_read_b64_tr_b16 a[100:101], v9 offset:16384
v_mfma_f32_16x16x32_bf16 v[96:99], a[8:11], a[40:43], v[96:99]
ds_read_b64_tr_b16 a[102:103], v9 offset:17408
s_add_u32 m0, s34, 28672
v_mfma_f32_16x16x32_bf16 v[100:103], a[12:15], a[40:43], v[100:103]
v_mfma_f32_16x16x32_bf16 v[160:163], a[16:19], a[40:43], v[160:163]
ds_read_b64_tr_b16 a[104:105], v10 offset:16384
v_mfma_f32_16x16x32_bf16 v[164:167], a[20:23], a[40:43], v[164:167]
buffer_load_dwordx4 v2, s[8:11], s28 offen lds
v_mfma_f32_16x16x32_bf16 v[224:227], a[24:27], a[40:43], v[224:227]
ds_read_b64_tr_b16 a[106:107], v10 offset:17408
v_mfma_f32_16x16x32_bf16 v[228:231], a[28:31], a[40:43], v[228:231]
ds_read_b64_tr_b16 a[108:109], v11 offset:16384
s_add_u32 s28, s28, s30
v_mfma_f32_16x16x32_bf16 v[40:43], a[0:3], a[44:47], v[40:43]
v_mfma_f32_16x16x32_bf16 v[44:47], a[4:7], a[44:47], v[44:47]
ds_read_b64_tr_b16 a[110:111], v11 offset:17408
s_add_u32 s34, s34, 32768
v_mfma_f32_16x16x32_bf16 v[104:107], a[8:11], a[44:47], v[104:107]
v_mfma_f32_16x16x32_bf16 v[108:111], a[12:15], a[44:47], v[108:111]
ds_read_b64_tr_b16 a[112:113], v8 offset:24576
s_cmp_ge_u32 s34, s36
v_mfma_f32_16x16x32_bf16 v[168:171], a[16:19], a[44:47], v[168:171]
ds_read_b64_tr_b16 a[114:115], v8 offset:25600
v_mfma_f32_16x16x32_bf16 v[172:175], a[20:23], a[44:47], v[172:175]
s_cselect_b32 s34, s35, s34
v_mfma_f32_16x16x32_bf16 v[232:235], a[24:27], a[44:47], v[232:235]
ds_read_b64_tr_b16 a[116:117], v9 offset:24576
v_mfma_f32_16x16x32_bf16 v[236:239], a[28:31], a[44:47], v[236:239]
ds_read_b64_tr_b16 a[118:119], v9 offset:25600
s_add_u32 m0, s43, 0
v_mfma_f32_16x16x32_bf16 v[48:51], a[0:3], a[48:51], v[48:51]
v_mfma_f32_16x16x32_bf16 v[52:55], a[4:7], a[48:51], v[52:55]
ds_read_b64_tr_b16 a[120:121], v10 offset:24576
buffer_load_dwordx4 v3, s[12:15], s31 offen lds
v_mfma_f32_16x16x32_bf16 v[112:115], a[8:11], a[48:51], v[112:115]
v_mfma_f32_16x16x32_bf16 v[116:119], a[12:15], a[48:51], v[116:119]
ds_read_b64_tr_b16 a[122:123], v10 offset:25600
s_add_u32 s31, s31, s32
v_mfma_f32_16x16x32_bf16 v[176:179], a[16:19], a[48:51], v[176:179]
ds_read_b64_tr_b16 a[124:125], v11 offset:24576
v_mfma_f32_16x16x32_bf16 v[180:183], a[20:23], a[48:51], v[180:183]
s_add_u32 m0, s43, 1024
v_mfma_f32_16x16x32_bf16 v[240:243], a[24:27], a[48:51], v[240:243]
ds_read_b64_tr_b16 a[126:127], v11 offset:25600
v_mfma_f32_16x16x32_bf16 v[244:247], a[28:31], a[48:51], v[244:247]
buffer_load_dwordx4 v3, s[12:15], s31 offen lds
v_mfma_f32_16x16x32_bf16 v[56:59], a[0:3], a[52:55], v[56:59]
v_mfma_f32_16x16x32_bf16 v[60:63], a[4:7], a[52:55], v[60:63]
v_mfma_f32_16x16x32_bf16 v[120:123], a[8:11], a[52:55], v[120:123]
s_add_u32 s31, s31, s33
v_mfma_f32_16x16x32_bf16 v[124:127], a[12:15], a[52:55], v[124:127]
v_mfma_f32_16x16x32_bf16 v[184:187], a[16:19], a[52:55], v[184:187]
s_add_u32 m0, s43, 4096
v_mfma_f32_16x16x32_bf16 v[188:191], a[20:23], a[52:55], v[188:191]
v_mfma_f32_16x16x32_bf16 v[248:251], a[24:27], a[52:55], v[248:251]
buffer_load_dwordx4 v3, s[12:15], s31 offen lds
v_mfma_f32_16x16x32_bf16 v[252:255], a[28:31], a[52:55], v[252:255]
v_mfma_f32_16x16x32_bf16 v[64:67], a[0:3], a[56:59], v[64:67]
s_add_u32 s31, s31, s32
v_mfma_f32_16x16x32_bf16 v[68:71], a[4:7], a[56:59], v[68:71]
v_mfma_f32_16x16x32_bf16 v[128:131], a[8:11], a[56:59], v[128:131]
s_add_u32 m0, s43, 5120
v_mfma_f32_16x16x32_bf16 v[132:135], a[12:15], a[56:59], v[132:135]
v_mfma_f32_16x16x32_bf16 v[192:195], a[16:19], a[56:59], v[192:195]
buffer_load_dwordx4 v3, s[12:15], s31 offen lds
v_mfma_f32_16x16x32_bf16 v[196:199], a[20:23], a[56:59], v[196:199]
v_mfma_f32_16x16x32_bf16 a[128:131], a[24:27], a[56:59], a[128:131]
s_add_u32 s31, s31, s33
v_mfma_f32_16x16x32_bf16 a[132:135], a[28:31], a[56:59], a[132:135]
v_mfma_f32_16x16x32_bf16 v[72:75], a[0:3], a[60:63], v[72:75]
s_add_u32 s38, s38, 32768
v_mfma_f32_16x16x32_bf16 v[76:79], a[4:7], a[60:63], v[76:79]
v_mfma_f32_16x16x32_bf16 v[136:139], a[8:11], a[60:63], v[136:139]
s_cmp_ge_u32 s38, s42
v_mfma_f32_16x16x32_bf16 v[140:143], a[12:15], a[60:63], v[140:143]
v_mfma_f32_16x16x32_bf16 v[200:203], a[16:19], a[60:63], v[200:203]
s_cselect_b32 s38, s41, s38
v_mfma_f32_16x16x32_bf16 v[204:207], a[20:23], a[60:63], v[204:207]
v_mfma_f32_16x16x32_bf16 a[136:139], a[24:27], a[60:63], a[136:139]
v_mfma_f32_16x16x32_bf16 a[140:143], a[28:31], a[60:63], a[140:143]
s_waitcnt vmcnt(16) lgkmcnt(0)
s_barrier
v_mfma_f32_16x16x32_bf16 v[16:19], a[64:67], a[96:99], v[16:19]
v_add_u32 v6, s37, v4
s_add_u32 m0, s34, 0
v_mfma_f32_16x16x32_bf16 v[20:23], a[68:71], a[96:99], v[20:23]
ds_read_b64_tr_b16 a[32:33], v8 offset:32768
v_mfma_f32_16x16x32_bf16 v[80:83], a[72:75], a[96:99], v[80:83]
ds_read_b64_tr_b16 a[34:35], v8 offset:33792
buffer_load_dwordx4 v2, s[8:11], s28 offen lds
v_mfma_f32_16x16x32_bf16 v[84:87], a[76:79], a[96:99], v[84:87]
v_mfma_f32_16x16x32_bf16 v[144:147], a[80:83], a[96:99], v[144:147]
ds_read_b128 a[0:3], v6 offset:0
s_add_u32 s28, s28, s29
v_mfma_f32_16x16x32_bf16 v[148:151], a[84:87], a[96:99], v[148:151]
ds_read_b128 a[4:7], v6 offset:2048
v_mfma_f32_16x16x32_bf16 v[208:211], a[88:91], a[96:99], v[208:211]
v_mfma_f32_16x16x32_bf16 v[212:215], a[92:95], a[96:99], v[212:215]
ds_read_b128 a[8:11], v6 offset:4096
s_add_u32 m0, s34, 4096
v_mfma_f32_16x16x32_bf16 v[24:27], a[64:67], a[100:103], v[24:27]
v_mfma_f32_16x16x32_bf16 v[28:31], a[68:71], a[100:103], v[28:31]
ds_read_b128 a[12:15], v6 offset:6144
buffer_load_dwordx4 v2, s[8:11], s28 offen lds
v_mfma_f32_16x16x32_bf16 v[88:91], a[72:75], a[100:103], v[88:91]
ds_read_b128 a[16:19], v6 offset:8192
v_mfma_f32_16x16x32_bf16 v[92:95], a[76:79], a[100:103], v[92:95]
s_add_u32 s28, s28, s29
v_mfma_f32_16x16x32_bf16 v[152:155], a[80:83], a[100:103], v[152:155]
ds_read_b128 a[20:23], v6 offset:10240
v_mfma_f32_16x16x32_bf16 v[156:159], a[84:87], a[100:103], v[156:159]
v_mfma_f32_16x16x32_bf16 v[216:219], a[88:91], a[100:103], v[216:219]
ds_read_b128 a[24:27], v6 offset:12288
s_add_u32 m0, s34, 8192
v_mfma_f32_16x16x32_bf16 v[220:223], a[92:95], a[100:103], v[220:223]
ds_read_b128 a[28:31], v6 offset:14336
v_mfma_f32_16x16x32_bf16 v[32:35], a[64:67], a[104:107], v[32:35]
buffer_load_dwordx4 v2, s[8:11], s28 offen lds
v_mfma_f32_16x16x32_bf16 v[36:39], a[68:71], a[104:107], v[36:39]
ds_read_b64_tr_b16 a[36:37], v9 offset:32768
v_mfma_f32_16x16x32_bf16 v[96:99], a[72:75], a[104:107], v[96:99]
ds_read_b64_tr_b16 a[38:39], v9 offset:33792
s_add_u32 s28, s28, s29
v_mfma_f32_16x16x32_bf16 v[100:103], a[76:79], a[104:107], v[100:103]
v_mfma_f32_16x16x32_bf16 v[160:163], a[80:83], a[104:107], v[160:163]
ds_read_b64_tr_b16 a[40:41], v10 offset:32768
v_mfma_f32_16x16x32_bf16 v[164:167], a[84:87], a[104:107], v[164:167]
s_add_u32 m0, s34, 12288
v_mfma_f32_16x16x32_bf16 v[224:227], a[88:91], a[104:107], v[224:227]
ds_read_b64_tr_b16 a[42:43], v10 offset:33792
v_mfma_f32_16x16x32_bf16 v[228:231], a[92:95], a[104:107], v[228:231]
ds_read_b64_tr_b16 a[44:45], v11 offset:32768
buffer_load_dwordx4 v2, s[8:11], s28 offen lds
v_mfma_f32_16x16x32_bf16 v[40:43], a[64:67], a[108:111], v[40:43]
v_mfma_f32_16x16x32_bf16 v[44:47], a[68:71], a[108:111], v[44:47]
ds_read_b64_tr_b16 a[46:47], v11 offset:33792
s_add_u32 s28, s28, s29
v_mfma_f32_16x16x32_bf16 v[104:107], a[72:75], a[108:111], v[104:107]
v_mfma_f32_16x16x32_bf16 v[108:111], a[76:79], a[108:111], v[108:111]
ds_read_b64_tr_b16 a[48:49], v8 offset:40960
v_mfma_f32_16x16x32_bf16 v[168:171], a[80:83], a[108:111], v[168:171]
ds_read_b64_tr_b16 a[50:51], v8 offset:41984
s_add_u32 m0, s43, 16384
v_mfma_f32_16x16x32_bf16 v[172:175], a[84:87], a[108:111], v[172:175]
v_mfma_f32_16x16x32_bf16 v[232:235], a[88:91], a[108:111], v[232:235]
ds_read_b64_tr_b16 a[52:53], v9 offset:40960
buffer_load_dwordx4 v3, s[12:15], s31 offen lds
v_mfma_f32_16x16x32_bf16 v[236:239], a[92:95], a[108:111], v[236:239]
ds_read_b64_tr_b16 a[54:55], v9 offset:41984
v_mfma_f32_16x16x32_bf16 v[48:51], a[64:67], a[112:115], v[48:51]
s_add_u32 s31, s31, s32
v_mfma_f32_16x16x32_bf16 v[52:55], a[68:71], a[112:115], v[52:55]
ds_read_b64_tr_b16 a[56:57], v10 offset:40960
v_mfma_f32_16x16x32_bf16 v[112:115], a[72:75], a[112:115], v[112:115]
v_mfma_f32_16x16x32_bf16 v[116:119], a[76:79], a[112:115], v[116:119]
ds_read_b64_tr_b16 a[58:59], v10 offset:41984
s_add_u32 m0, s43, 17408
v_mfma_f32_16x16x32_bf16 v[176:179], a[80:83], a[112:115], v[176:179]
ds_read_b64_tr_b16 a[60:61], v11 offset:40960
v_mfma_f32_16x16x32_bf16 v[180:183], a[84:87], a[112:115], v[180:183]
buffer_load_dwordx4 v3, s[12:15], s31 offen lds
v_mfma_f32_16x16x32_bf16 v[240:243], a[88:91], a[112:115], v[240:243]
ds_read_b64_tr_b16 a[62:63], v11 offset:41984
v_mfma_f32_16x16x32_bf16 v[244:247], a[92:95], a[112:115], v[244:247]
s_add_u32 s31, s31, s33
v_mfma_f32_16x16x32_bf16 v[56:59], a[64:67], a[116:119], v[56:59]
v_mfma_f32_16x16x32_bf16 v[60:63], a[68:71], a[116:119], v[60:63]
v_mfma_f32_16x16x32_bf16 v[120:123], a[72:75], a[116:119], v[120:123]
s_add_u32 m0, s43, 20480
v_mfma_f32_16x16x32_bf16 v[124:127], a[76:79], a[116:119], v[124:127]
v_mfma_f32_16x16x32_bf16 v[184:187], a[80:83], a[116:119], v[184:187]
buffer_load_dwordx4 v3, s[12:15], s31 offen lds
v_mfma_f32_16x16x32_bf16 v[188:191], a[84:87], a[116:119], v[188:191]
v_mfma_f32_16x16x32_bf16 v[248:251], a[88:91], a[116:119], v[248:251]
s_add_u32 s31, s31, s32
v_mfma_f32_16x16x32_bf16 v[252:255], a[92:95], a[116:119], v[252:255]
v_mfma_f32_16x16x32_bf16 v[64:67], a[64:67], a[120:123], v[64:67]
v_mfma_f32_16x16x32_bf16 v[68:71], a[68:71], a[120:123], v[68:71]
s_add_u32 m0, s43, 21504
v_mfma_f32_16x16x32_bf16 v[128:131], a[72:75], a[120:123], v[128:131]
v_mfma_f32_16x16x32_bf16 v[132:135], a[76:79], a[120:123], v[132:135]
buffer_load_dwordx4 v3, s[12:15], s31 offen lds
v_mfma_f32_16x16x32_bf16 v[192:195], a[80:83], a[120:123], v[192:195]
v_mfma_f32_16x16x32_bf16 v[196:199], a[84:87], a[120:123], v[196:199]
s_add_u32 s31, s31, s33
v_mfma_f32_16x16x32_bf16 a[128:131], a[88:91], a[120:123], a[128:131]
v_mfma_f32_16x16x32_bf16 a[132:135], a[92:95], a[120:123], a[132:135]
v_mfma_f32_16x16x32_bf16 v[72:75], a[64:67], a[124:127], v[72:75]
s_add_u32 s37, s37, 32768
v_mfma_f32_16x16x32_bf16 v[76:79], a[68:71], a[124:127], v[76:79]
v_mfma_f32_16x16x32_bf16 v[136:139], a[72:75], a[124:127], v[136:139]
s_cmp_ge_u32 s37, s42
v_mfma_f32_16x16x32_bf16 v[140:143], a[76:79], a[124:127], v[140:143]
v_mfma_f32_16x16x32_bf16 v[200:203], a[80:83], a[124:127], v[200:203]
s_cselect_b32 s37, s41, s37
v_mfma_f32_16x16x32_bf16 v[204:207], a[84:87], a[124:127], v[204:207]
v_mfma_f32_16x16x32_bf16 a[136:139], a[88:91], a[124:127], a[136:139]
v_mfma_f32_16x16x32_bf16 a[140:143], a[92:95], a[124:127], a[140:143]
s_waitcnt vmcnt(16) lgkmcnt(0)
s_barrier
v_mfma_f32_16x16x32_bf16 v[16:19], a[0:3], a[32:35], v[16:19]
v_add_u32 v7, s38, v5
s_add_u32 m0, s34, 16384
v_mfma_f32_16x16x32_bf16 v[20:23], a[4:7], a[32:35], v[20:23]
ds_read_b64_tr_b16 a[96:97], v8 offset:49152
v_mfma_f32_16x16x32_bf16 v[80:83], a[8:11], a[32:35], v[80:83]
ds_read_b64_tr_b16 a[98:99], v8 offset:50176
buffer_load_dwordx4 v2, s[8:11], s28 offen lds
v_mfma_f32_16x16x32_bf16 v[84:87], a[12:15], a[32:35], v[84:87]
v_mfma_f32_16x16x32_bf16 v[144:147], a[16:19], a[32:35], v[144:147]
ds_read_b128 a[64:67], v7 offset:0
s_add_u32 s28, s28, s29
v_mfma_f32_16x16x32_bf16 v[148:151], a[20:23], a[32:35], v[148:151]
ds_read_b128 a[68:71], v7 offset:2048
v_mfma_f32_16x16x32_bf16 v[208:211], a[24:27], a[32:35], v[208:211]
s_add_u32 m0, s34, 20480
v_mfma_f32_16x16x32_bf16 v[212:215], a[28:31], a[32:35], v[212:215]
ds_read_b128 a[72:75], v7 offset:4096
v_mfma_f32_16x16x32_bf16 v[24:27], a[0:3], a[36:39], v[24:27]
buffer_load_dwordx4 v2, s[8:11], s28 offen lds
v_mfma_f32_16x16x32_bf16 v[28:31], a[4:7], a[36:39], v[28:31]
ds_read_b128 a[76:79], v7 offset:6144
v_mfma_f32_16x16x32_bf16 v[88:91], a[8:11], a[36:39], v[88:91]
ds_read_b128 a[80:83], v7 offset:8192
s_add_u32 s28, s28, s29
v_mfma_f32_16x16x32_bf16 v[92:95], a[12:15], a[36:39], v[92:95]
v_mfma_f32_16x16x32_bf16 v[152:155], a[16:19], a[36:39], v[152:155]
ds_read_b128 a[84:87], v7 offset:10240
s_add_u32 m0, s34, 24576
v_mfma_f32_16x16x32_bf16 v[156:159], a[20:23], a[36:39], v[156:159]
v_mfma_f32_16x16x32_bf16 v[216:219], a[24:27], a[36:39], v[216:219]
ds_read_b128 a[88:91], v7 offset:12288
buffer_load_dwordx4 v2, s[8:11], s28 offen lds
v_mfma_f32_16x16x32_bf16 v[220:223], a[28:31], a[36:39], v[220:223]
ds_read_b128 a[92:95], v7 offset:14336
v_mfma_f32_16x16x32_bf16 v[32:35], a[0:3], a[40:43], v[32:35]
s_add_u32 s28, s28, s29
v_mfma_f32_16x16x32_bf16 v[36:39], a[4:7], a[40:43], v[36:39]
ds_read_b64_tr_b16 a[100:101], v9 offset:49152
v_mfma_f32_16x16x32_bf16 v[96:99], a[8:11], a[40:43], v[96:99]
ds_read_b64_tr_b16 a[102:103], v9 offset:50176
s_add_u32 m0, s34, 28672
v_mfma_f32_16x16x32_bf16 v[100:103], a[12:15], a[40:43], v[100:103]
v_mfma_f32_16x16x32_bf16 v[160:163], a[16:19], a[40:43], v[160:163]
ds_read_b64_tr_b16 a[104:105], v10 offset:49152
v_mfma_f32_16x16x32_bf16 v[164:167], a[20:23], a[40:43], v[164:167]
buffer_load_dwordx4 v2, s[8:11], s28 offen lds
v_mfma_f32_16x16x32_bf16 v[224:227], a[24:27], a[40:43], v[224:227]
ds_read_b64_tr_b16 a[106:107], v10 offset:50176
v_mfma_f32_16x16x32_bf16 v[228:231], a[28:31], a[40:43], v[228:231]
ds_read_b64_tr_b16 a[108:109], v11 offset:49152
s_add_u32 s28, s28, s30
v_mfma_f32_16x16x32_bf16 v[40:43], a[0:3], a[44:47], v[40:43]
v_mfma_f32_16x16x32_bf16 v[44:47], a[4:7], a[44:47], v[44:47]
ds_read_b64_tr_b16 a[110:111], v11 offset:50176
s_add_u32 s34, s34, 32768
v_mfma_f32_16x16x32_bf16 v[104:107], a[8:11], a[44:47], v[104:107]
v_mfma_f32_16x16x32_bf16 v[108:111], a[12:15], a[44:47], v[108:111]
ds_read_b64_tr_b16 a[112:113], v8 offset:57344
s_cmp_ge_u32 s34, s36
v_mfma_f32_16x16x32_bf16 v[168:171], a[16:19], a[44:47], v[168:171]
ds_read_b64_tr_b16 a[114:115], v8 offset:58368
v_mfma_f32_16x16x32_bf16 v[172:175], a[20:23], a[44:47], v[172:175]
s_cselect_b32 s34, s35, s34
v_mfma_f32_16x16x32_bf16 v[232:235], a[24:27], a[44:47], v[232:235]
ds_read_b64_tr_b16 a[116:117], v9 offset:57344
v_mfma_f32_16x16x32_bf16 v[236:239], a[28:31], a[44:47], v[236:239]
ds_read_b64_tr_b16 a[118:119], v9 offset:58368
s_add_u32 m0, s43, 32768
v_mfma_f32_16x16x32_bf16 v[48:51], a[0:3], a[48:51], v[48:51]
v_mfma_f32_16x16x32_bf16 v[52:55], a[4:7], a[48:51], v[52:55]
ds_read_b64_tr_b16 a[120:121], v10 offset:57344
buffer_load_dwordx4 v3, s[12:15], s31 offen lds
v_mfma_f32_16x16x32_bf16 v[112:115], a[8:11], a[48:51], v[112:115]
v_mfma_f32_16x16x32_bf16 v[116:119], a[12:15], a[48:51], v[116:119]
ds_read_b64_tr_b16 a[122:123], v10 offset:58368
s_add_u32 s31, s31, s32
v_mfma_f32_16x16x32_bf16 v[176:179], a[16:19], a[48:51], v[176:179]
ds_read_b64_tr_b16 a[124:125], v11 offset:57344
v_mfma_f32_16x16x32_bf16 v[180:183], a[20:23], a[48:51], v[180:183]
s_add_u32 m0, s43, 33792
v_mfma_f32_16x16x32_bf16 v[240:243], a[24:27], a[48:51], v[240:243]
ds_read_b64_tr_b16 a[126:127], v11 offset:58368
v_mfma_f32_16x16x32_bf16 v[244:247], a[28:31], a[48:51], v[244:247]
buffer_load_dwordx4 v3, s[12:15], s31 offen lds
v_mfma_f32_16x16x32_bf16 v[56:59], a[0:3], a[52:55], v[56:59]
v_mfma_f32_16x16x32_bf16 v[60:63], a[4:7], a[52:55], v[60:63]
v_mfma_f32_16x16x32_bf16 v[120:123], a[8:11], a[52:55], v[120:123]
s_add_u32 s31, s31, s33
v_mfma_f32_16x16x32_bf16 v[124:127], a[12:15], a[52:55], v[124:127]
v_mfma_f32_16x16x32_bf16 v[184:187], a[16:19], a[52:55], v[184:187]
s_add_u32 m0, s43, 36864
v_mfma_f32_16x16x32_bf16 v[188:191], a[20:23], a[52:55], v[188:191]
v_mfma_f32_16x16x32_bf16 v[248:251], a[24:27], a[52:55], v[248:251]
buffer_load_dwordx4 v3, s[12:15], s31 offen lds
v_mfma_f32_16x16x32_bf16 v[252:255], a[28:31], a[52:55], v[252:255]
v_mfma_f32_16x16x32_bf16 v[64:67], a[0:3], a[56:59], v[64:67]
s_add_u32 s31, s31, s32
v_mfma_f32_16x16x32_bf16 v[68:71], a[4:7], a[56:59], v[68:71]
v_mfma_f32_16x16x32_bf16 v[128:131], a[8:11], a[56:59], v[128:131]
s_add_u32 m0, s43, 37888
v_mfma_f32_16x16x32_bf16 v[132:135], a[12:15], a[56:59], v[132:135]
v_mfma_f32_16x16x32_bf16 v[192:195], a[16:19], a[56:59], v[192:195]
buffer_load_dwordx4 v3, s[12:15], s31 offen lds
v_mfma_f32_16x16x32_bf16 v[196:199], a[20:23], a[56:59], v[196:199]
v_mfma_f32_16x16x32_bf16 a[128:131], a[24:27], a[56:59], a[128:131]
s_add_u32 s31, s31, s33
v_mfma_f32_16x16x32_bf16 a[132:135], a[28:31], a[56:59], a[132:135]
v_mfma_f32_16x16x32_bf16 v[72:75], a[0:3], a[60:63], v[72:75]
s_add_u32 s38, s38, 32768
v_mfma_f32_16x16x32_bf16 v[76:79], a[4:7], a[60:63], v[76:79]
v_mfma_f32_16x16x32_bf16 v[136:139], a[8:11], a[60:63], v[136:139]
s_cmp_ge_u32 s38, s42
v_mfma_f32_16x16x32_bf16 v[140:143], a[12:15], a[60:63], v[140:143]
v_mfma_f32_16x16x32_bf16 v[200:203], a[16:19], a[60:63], v[200:203]
s_cselect_b32 s38, s41, s38
v_mfma_f32_16x16x32_bf16 v[204:207], a[20:23], a[60:63], v[204:207]
v_mfma_f32_16x16x32_bf16 a[136:139], a[24:27], a[60:63], a[136:139]
v_mfma_f32_16x16x32_bf16 a[140:143], a[28:31], a[60:63], a[140:143]
s_waitcnt vmcnt(16) lgkmcnt(0)
s_barrier
v_mfma_f32_16x16x32_bf16 v[16:19], a[64:67], a[96:99], v[16:19]
v_add_u32 v6, s37, v4
s_add_u32 m0, s34, 0
v_mfma_f32_16x16x32_bf16 v[20:23], a[68:71], a[96:99], v[20:23]
ds_read_b64_tr_b16 a[32:33], v8 offset:0
v_mfma_f32_16x16x32_bf16 v[80:83], a[72:75], a[96:99], v[80:83]
ds_read_b64_tr_b16 a[34:35], v8 offset:1024
buffer_load_dwordx4 v2, s[8:11], s28 offen lds
v_mfma_f32_16x16x32_bf16 v[84:87], a[76:79], a[96:99], v[84:87]
v_mfma_f32_16x16x32_bf16 v[144:147], a[80:83], a[96:99], v[144:147]
ds_read_b128 a[0:3], v6 offset:0
s_add_u32 s28, s28, s29
v_mfma_f32_16x16x32_bf16 v[148:151], a[84:87], a[96:99], v[148:151]
ds_read_b128 a[4:7], v6 offset:2048
v_mfma_f32_16x16x32_bf16 v[208:211], a[88:91], a[96:99], v[208:211]
v_mfma_f32_16x16x32_bf16 v[212:215], a[92:95], a[96:99], v[212:215]
ds_read_b128 a[8:11], v6 offset:4096
s_add_u32 m0, s34, 4096
v_mfma_f32_16x16x32_bf16 v[24:27], a[64:67], a[100:103], v[24:27]
v_mfma_f32_16x16x32_bf16 v[28:31], a[68:71], a[100:103], v[28:31]
ds_read_b128 a[12:15], v6 offset:6144
buffer_load_dwordx4 v2, s[8:11], s28 offen lds
v_mfma_f32_16x16x32_bf16 v[88:91], a[72:75], a[100:103], v[88:91]
ds_read_b128 a[16:19], v6 offset:8192
v_mfma_f32_16x16x32_bf16 v[92:95], a[76:79], a[100:103], v[92:95]
s_add_u32 s28, s28, s29
v_mfma_f32_16x16x32_bf16 v[152:155], a[80:83], a[100:103], v[152:155]
ds_read_b128 a[20:23], v6 offset:10240
v_mfma_f32_16x16x32_bf16 v[156:159], a[84:87], a[100:103], v[156:159]
v_mfma_f32_16x16x32_bf16 v[216:219], a[88:91], a[100:103], v[216:219]
ds_read_b128 a[24:27], v6 offset:12288
s_add_u32 m0, s34, 8192
v_mfma_f32_16x16x32_bf16 v[220:223], a[92:95], a[100:103], v[220:223]
ds_read_b128 a[28:31], v6 offset:14336
v_mfma_f32_16x16x32_bf16 v[32:35], a[64:67], a[104:107], v[32:35]
buffer_load_dwordx4 v2, s[8:11], s28 offen lds
v_mfma_f32_16x16x32_bf16 v[36:39], a[68:71], a[104:107], v[36:39]
ds_read_b64_tr_b16 a[36:37], v9 offset:0
v_mfma_f32_16x16x32_bf16 v[96:99], a[72:75], a[104:107], v[96:99]
ds_read_b64_tr_b16 a[38:39], v9 offset:1024
s_add_u32 s28, s28, s29
v_mfma_f32_16x16x32_bf16 v[100:103], a[76:79], a[104:107], v[100:103]
v_mfma_f32_16x16x32_bf16 v[160:163], a[80:83], a[104:107], v[160:163]
ds_read_b64_tr_b16 a[40:41], v10 offset:0
v_mfma_f32_16x16x32_bf16 v[164:167], a[84:87], a[104:107], v[164:167]
s_add_u32 m0, s34, 12288
v_mfma_f32_16x16x32_bf16 v[224:227], a[88:91], a[104:107], v[224:227]
ds_read_b64_tr_b16 a[42:43], v10 offset:1024
v_mfma_f32_16x16x32_bf16 v[228:231], a[92:95], a[104:107], v[228:231]
ds_read_b64_tr_b16 a[44:45], v11 offset:0
buffer_load_dwordx4 v2, s[8:11], s28 offen lds
v_mfma_f32_16x16x32_bf16 v[40:43], a[64:67], a[108:111], v[40:43]
v_mfma_f32_16x16x32_bf16 v[44:47], a[68:71], a[108:111], v[44:47]
ds_read_b64_tr_b16 a[46:47], v11 offset:1024
s_add_u32 s28, s28, s29
v_mfma_f32_16x16x32_bf16 v[104:107], a[72:75], a[108:111], v[104:107]
v_mfma_f32_16x16x32_bf16 v[108:111], a[76:79], a[108:111], v[108:111]
ds_read_b64_tr_b16 a[48:49], v8 offset:8192
v_mfma_f32_16x16x32_bf16 v[168:171], a[80:83], a[108:111], v[168:171]
ds_read_b64_tr_b16 a[50:51], v8 offset:9216
s_add_u32 m0, s43, 49152
v_mfma_f32_16x16x32_bf16 v[172:175], a[84:87], a[108:111], v[172:175]
v_mfma_f32_16x16x32_bf16 v[232:235], a[88:91], a[108:111], v[232:235]
ds_read_b64_tr_b16 a[52:53], v9 offset:8192
buffer_load_dwordx4 v3, s[12:15], s31 offen lds
v_mfma_f32_16x16x32_bf16 v[236:239], a[92:95], a[108:111], v[236:239]
ds_read_b64_tr_b16 a[54:55], v9 offset:9216
v_mfma_f32_16x16x32_bf16 v[48:51], a[64:67], a[112:115], v[48:51]
s_add_u32 s31, s31, s32
v_mfma_f32_16x16x32_bf16 v[52:55], a[68:71], a[112:115], v[52:55]
ds_read_b64_tr_b16 a[56:57], v10 offset:8192
v_mfma_f32_16x16x32_bf16 v[112:115], a[72:75], a[112:115], v[112:115]
v_mfma_f32_16x16x32_bf16 v[116:119], a[76:79], a[112:115], v[116:119]
ds_read_b64_tr_b16 a[58:59], v10 offset:9216
s_add_u32 m0, s43, 50176
v_mfma_f32_16x16x32_bf16 v[176:179], a[80:83], a[112:115], v[176:179]
ds_read_b64_tr_b16 a[60:61], v11 offset:8192
v_mfma_f32_16x16x32_bf16 v[180:183], a[84:87], a[112:115], v[180:183]
buffer_load_dwordx4 v3, s[12:15], s31 offen lds
v_mfma_f32_16x16x32_bf16 v[240:243], a[88:91], a[112:115], v[240:243]
ds_read_b64_tr_b16 a[62:63], v11 offset:9216
v_mfma_f32_16x16x32_bf16 v[244:247], a[92:95], a[112:115], v[244:247]
s_add_u32 s31, s31, s33
v_mfma_f32_16x16x32_bf16 v[56:59], a[64:67], a[116:119], v[56:59]
v_mfma_f32_16x16x32_bf16 v[60:63], a[68:71], a[116:119], v[60:63]
v_mfma_f32_16x16x32_bf16 v[120:123], a[72:75], a[116:119], v[120:123]
s_add_u32 m0, s43, 53248
v_mfma_f32_16x16x32_bf16 v[124:127], a[76:79], a[116:119], v[124:127]
v_mfma_f32_16x16x32_bf16 v[184:187], a[80:83], a[116:119], v[184:187]
buffer_load_dwordx4 v3, s[12:15], s31 offen lds
v_mfma_f32_16x16x32_bf16 v[188:191], a[84:87], a[116:119], v[188:191]
v_mfma_f32_16x16x32_bf16 v[248:251], a[88:91], a[116:119], v[248:251]
s_add_u32 s31, s31, s32
v_mfma_f32_16x16x32_bf16 v[252:255], a[92:95], a[116:119], v[252:255]
v_mfma_f32_16x16x32_bf16 v[64:67], a[64:67], a[120:123], v[64:67]
v_mfma_f32_16x16x32_bf16 v[68:71], a[68:71], a[120:123], v[68:71]
s_add_u32 m0, s43, 54272
v_mfma_f32_16x16x32_bf16 v[128:131], a[72:75], a[120:123], v[128:131]
v_mfma_f32_16x16x32_bf16 v[132:135], a[76:79], a[120:123], v[132:135]
buffer_load_dwordx4 v3, s[12:15], s31 offen lds
v_mfma_f32_16x16x32_bf16 v[192:195], a[80:83], a[120:123], v[192:195]
v_mfma_f32_16x16x32_bf16 v[196:199], a[84:87], a[120:123], v[196:199]
s_add_u32 s31, s31, s33
v_mfma_f32_16x16x32_bf16 a[128:131], a[88:91], a[120:123], a[128:131]
v_mfma_f32_16x16x32_bf16 a[132:135], a[92:95], a[120:123], a[132:135]
v_mfma_f32_16x16x32_bf16 v[72:75], a[64:67], a[124:127], v[72:75]
s_add_u32 s37, s37, 32768
v_mfma_f32_16x16x32_bf16 v[76:79], a[68:71], a[124:127], v[76:79]
v_mfma_f32_16x16x32_bf16 v[136:139], a[72:75], a[124:127], v[136:139]
s_cmp_ge_u32 s37, s42
v_mfma_f32_16x16x32_bf16 v[140:143], a[76:79], a[124:127], v[140:143]
v_mfma_f32_16x16x32_bf16 v[200:203], a[80:83], a[124:127], v[200:203]
s_cselect_b32 s37, s41, s37
v_mfma_f32_16x16x32_bf16 v[204:207], a[84:87], a[124:127], v[204:207]
v_mfma_f32_16x16x32_bf16 a[136:139], a[88:91], a[124:127], a[136:139]
v_mfma_f32_16x16x32_bf16 a[140:143], a[92:95], a[124:127], a[140:143]
s_nop 7
s_cmp_eq_u32 s63, 0
s_cbranch_scc1 fused_kernel_gnogu1
v_cvt_pk_bf16_f32 v16, v16, v17
v_cvt_pk_bf16_f32 v17, v18, v19
v_cvt_pk_bf16_f32 v18, v20, v21
v_cvt_pk_bf16_f32 v19, v22, v23
v_accvgpr_write_b32 a144, v16
v_accvgpr_write_b32 a145, v17
v_accvgpr_write_b32 a146, v18
v_accvgpr_write_b32 a147, v19
v_accvgpr_read_b32 v16, a136
v_accvgpr_read_b32 v20, a140
v_accvgpr_read_b32 v17, a137
v_accvgpr_read_b32 v21, a141
v_accvgpr_read_b32 v18, a138
v_accvgpr_read_b32 v22, a142
v_accvgpr_read_b32 v19, a139
v_accvgpr_read_b32 v23, a143
v_cvt_pk_bf16_f32 v16, v16, v17
v_cvt_pk_bf16_f32 v17, v18, v19
v_cvt_pk_bf16_f32 v18, v20, v21
v_cvt_pk_bf16_f32 v19, v22, v23
s_add_u32 s40, s44, 62464
buffer_store_dwordx4 v[16:19], v12, s[4:7], s40 offen sc1
s_nop 1
v_accvgpr_read_b32 v16, a128
v_accvgpr_read_b32 v20, a132
v_accvgpr_read_b32 v17, a129
v_accvgpr_read_b32 v21, a133
v_accvgpr_read_b32 v18, a130
v_accvgpr_read_b32 v22, a134
v_accvgpr_read_b32 v19, a131
v_accvgpr_read_b32 v23, a135
v_cvt_pk_bf16_f32 v16, v16, v17
v_cvt_pk_bf16_f32 v17, v18, v19
v_cvt_pk_bf16_f32 v18, v20, v21
v_cvt_pk_bf16_f32 v19, v22, v23
v_accvgpr_write_b32 a252, v16
v_accvgpr_write_b32 a253, v17
v_accvgpr_write_b32 a254, v18
v_accvgpr_write_b32 a255, v19
s_waitcnt vmcnt(17) lgkmcnt(0)
s_barrier
v_mfma_f32_16x16x32_bf16 v[16:19], a[32:35], a[0:3], 0
v_add_u32 v7, s38, v5
s_add_u32 m0, s34, 16384
v_cvt_pk_bf16_f32 v24, v24, v25
v_cvt_pk_bf16_f32 v25, v26, v27
v_cvt_pk_bf16_f32 v26, v28, v29
v_cvt_pk_bf16_f32 v27, v30, v31
v_accvgpr_write_b32 a160, v24
v_accvgpr_write_b32 a161, v25
v_accvgpr_write_b32 a162, v26
v_accvgpr_write_b32 a163, v27
v_mfma_f32_16x16x32_bf16 v[24:27], a[32:35], a[4:7], 0
ds_read_b64_tr_b16 a[96:97], v8 offset:16384
v_cvt_pk_bf16_f32 v32, v32, v33
v_cvt_pk_bf16_f32 v33, v34, v35
v_cvt_pk_bf16_f32 v34, v36, v37
v_cvt_pk_bf16_f32 v35, v38, v39
v_accvgpr_write_b32 a148, v32
v_accvgpr_write_b32 a149, v33
v_accvgpr_write_b32 a150, v34
v_accvgpr_write_b32 a151, v35
v_mfma_f32_16x16x32_bf16 v[32:35], a[32:35], a[8:11], 0
ds_read_b64_tr_b16 a[98:99], v8 offset:17408
buffer_load_dwordx4 v2, s[8:11], s28 offen lds
v_cvt_pk_bf16_f32 v40, v40, v41
v_cvt_pk_bf16_f32 v41, v42, v43
v_cvt_pk_bf16_f32 v42, v44, v45
v_cvt_pk_bf16_f32 v43, v46, v47
v_accvgpr_write_b32 a164, v40
v_accvgpr_write_b32 a165, v41
v_accvgpr_write_b32 a166, v42
v_accvgpr_write_b32 a167, v43
v_mfma_f32_16x16x32_bf16 v[40:43], a[32:35], a[12:15], 0
v_cvt_pk_bf16_f32 v48, v48, v49
v_cvt_pk_bf16_f32 v49, v50, v51
v_cvt_pk_bf16_f32 v50, v52, v53
v_cvt_pk_bf16_f32 v51, v54, v55
v_accvgpr_write_b32 a152, v48
v_accvgpr_write_b32 a153, v49
v_accvgpr_write_b32 a154, v50
v_accvgpr_write_b32 a155, v51
v_mfma_f32_16x16x32_bf16 v[48:51], a[32:35], a[16:19], 0
ds_read_b128 a[64:67], v7 offset:0
s_add_u32 s28, s28, s29
v_cvt_pk_bf16_f32 v56, v56, v57
v_cvt_pk_bf16_f32 v57, v58, v59
v_cvt_pk_bf16_f32 v58, v60, v61
v_cvt_pk_bf16_f32 v59, v62, v63
v_accvgpr_write_b32 a168, v56
v_accvgpr_write_b32 a169, v57
v_accvgpr_write_b32 a170, v58
v_accvgpr_write_b32 a171, v59
v_mfma_f32_16x16x32_bf16 v[56:59], a[32:35], a[20:23], 0
ds_read_b128 a[68:71], v7 offset:2048
v_cvt_pk_bf16_f32 v64, v64, v65
v_cvt_pk_bf16_f32 v65, v66, v67
v_cvt_pk_bf16_f32 v66, v68, v69
v_cvt_pk_bf16_f32 v67, v70, v71
v_accvgpr_write_b32 a156, v64
v_accvgpr_write_b32 a157, v65
v_accvgpr_write_b32 a158, v66
v_accvgpr_write_b32 a159, v67
v_mfma_f32_16x16x32_bf16 v[64:67], a[32:35], a[24:27], 0
s_add_u32 m0, s34, 20480
v_cvt_pk_bf16_f32 v72, v72, v73
v_cvt_pk_bf16_f32 v73, v74, v75
v_cvt_pk_bf16_f32 v74, v76, v77
v_cvt_pk_bf16_f32 v75, v78, v79
v_accvgpr_write_b32 a172, v72
v_accvgpr_write_b32 a173, v73
v_accvgpr_write_b32 a174, v74
v_accvgpr_write_b32 a175, v75
v_mfma_f32_16x16x32_bf16 v[72:75], a[32:35], a[28:31], 0
ds_read_b128 a[72:75], v7 offset:4096
v_mfma_f32_16x16x32_bf16 v[20:23], a[36:39], a[0:3], 0
buffer_load_dwordx4 v2, s[8:11], s28 offen lds
v_mfma_f32_16x16x32_bf16 v[28:31], a[36:39], a[4:7], 0
ds_read_b128 a[76:79], v7 offset:6144
v_mfma_f32_16x16x32_bf16 v[36:39], a[36:39], a[8:11], 0
ds_read_b128 a[80:83], v7 offset:8192
s_add_u32 s28, s28, s29
v_mfma_f32_16x16x32_bf16 v[44:47], a[36:39], a[12:15], 0
v_mfma_f32_16x16x32_bf16 v[52:55], a[36:39], a[16:19], 0
ds_read_b128 a[84:87], v7 offset:10240
s_add_u32 m0, s34, 24576
v_mfma_f32_16x16x32_bf16 v[60:63], a[36:39], a[20:23], 0
v_mfma_f32_16x16x32_bf16 v[68:71], a[36:39], a[24:27], 0
ds_read_b128 a[88:91], v7 offset:12288
buffer_load_dwordx4 v2, s[8:11], s28 offen lds
v_mfma_f32_16x16x32_bf16 v[76:79], a[36:39], a[28:31], 0
ds_read_b128 a[92:95], v7 offset:14336
v_cvt_pk_bf16_f32 v80, v80, v81
v_cvt_pk_bf16_f32 v81, v82, v83
v_cvt_pk_bf16_f32 v82, v84, v85
v_cvt_pk_bf16_f32 v83, v86, v87
v_accvgpr_write_b32 a176, v80
v_accvgpr_write_b32 a177, v81
v_accvgpr_write_b32 a178, v82
v_accvgpr_write_b32 a179, v83
v_mfma_f32_16x16x32_bf16 v[80:83], a[40:43], a[0:3], 0
s_add_u32 s28, s28, s29
v_cvt_pk_bf16_f32 v88, v88, v89
v_cvt_pk_bf16_f32 v89, v90, v91
v_cvt_pk_bf16_f32 v90, v92, v93
v_cvt_pk_bf16_f32 v91, v94, v95
v_accvgpr_write_b32 a192, v88
v_accvgpr_write_b32 a193, v89
v_accvgpr_write_b32 a194, v90
v_accvgpr_write_b32 a195, v91
v_mfma_f32_16x16x32_bf16 v[88:91], a[40:43], a[4:7], 0
ds_read_b64_tr_b16 a[100:101], v9 offset:16384
v_cvt_pk_bf16_f32 v96, v96, v97
v_cvt_pk_bf16_f32 v97, v98, v99
v_cvt_pk_bf16_f32 v98, v100, v101
v_cvt_pk_bf16_f32 v99, v102, v103
v_accvgpr_write_b32 a180, v96
v_accvgpr_write_b32 a181, v97
v_accvgpr_write_b32 a182, v98
v_accvgpr_write_b32 a183, v99
v_mfma_f32_16x16x32_bf16 v[96:99], a[40:43], a[8:11], 0
ds_read_b64_tr_b16 a[102:103], v9 offset:17408
s_add_u32 m0, s34, 28672
v_cvt_pk_bf16_f32 v104, v104, v105
v_cvt_pk_bf16_f32 v105, v106, v107
v_cvt_pk_bf16_f32 v106, v108, v109
v_cvt_pk_bf16_f32 v107, v110, v111
v_accvgpr_write_b32 a196, v104
v_accvgpr_write_b32 a197, v105
v_accvgpr_write_b32 a198, v106
v_accvgpr_write_b32 a199, v107
v_mfma_f32_16x16x32_bf16 v[104:107], a[40:43], a[12:15], 0
v_cvt_pk_bf16_f32 v112, v112, v113
v_cvt_pk_bf16_f32 v113, v114, v115
v_cvt_pk_bf16_f32 v114, v116, v117
v_cvt_pk_bf16_f32 v115, v118, v119
v_accvgpr_write_b32 a184, v112
v_accvgpr_write_b32 a185, v113
v_accvgpr_write_b32 a186, v114
v_accvgpr_write_b32 a187, v115
v_mfma_f32_16x16x32_bf16 v[112:115], a[40:43], a[16:19], 0
ds_read_b64_tr_b16 a[104:105], v10 offset:16384
v_cvt_pk_bf16_f32 v120, v120, v121
v_cvt_pk_bf16_f32 v121, v122, v123
v_cvt_pk_bf16_f32 v122, v124, v125
v_cvt_pk_bf16_f32 v123, v126, v127
v_accvgpr_write_b32 a200, v120
v_accvgpr_write_b32 a201, v121
v_accvgpr_write_b32 a202, v122
v_accvgpr_write_b32 a203, v123
v_mfma_f32_16x16x32_bf16 v[120:123], a[40:43], a[20:23], 0
buffer_load_dwordx4 v2, s[8:11], s28 offen lds
v_cvt_pk_bf16_f32 v128, v128, v129
v_cvt_pk_bf16_f32 v129, v130, v131
v_cvt_pk_bf16_f32 v130, v132, v133
v_cvt_pk_bf16_f32 v131, v134, v135
v_accvgpr_write_b32 a188, v128
v_accvgpr_write_b32 a189, v129
v_accvgpr_write_b32 a190, v130
v_accvgpr_write_b32 a191, v131
v_mfma_f32_16x16x32_bf16 v[128:131], a[40:43], a[24:27], 0
ds_read_b64_tr_b16 a[106:107], v10 offset:17408
v_cvt_pk_bf16_f32 v136, v136, v137
v_cvt_pk_bf16_f32 v137, v138, v139
v_cvt_pk_bf16_f32 v138, v140, v141
v_cvt_pk_bf16_f32 v139, v142, v143
v_accvgpr_write_b32 a204, v136
v_accvgpr_write_b32 a205, v137
v_accvgpr_write_b32 a206, v138
v_accvgpr_write_b32 a207, v139
v_mfma_f32_16x16x32_bf16 v[136:139], a[40:43], a[28:31], 0
ds_read_b64_tr_b16 a[108:109], v11 offset:16384
s_add_u32 s28, s28, s30
v_mfma_f32_16x16x32_bf16 v[84:87], a[44:47], a[0:3], 0
v_mfma_f32_16x16x32_bf16 v[92:95], a[44:47], a[4:7], 0
ds_read_b64_tr_b16 a[110:111], v11 offset:17408
s_add_u32 s34, s34, 32768
v_mfma_f32_16x16x32_bf16 v[100:103], a[44:47], a[8:11], 0
v_mfma_f32_16x16x32_bf16 v[108:111], a[44:47], a[12:15], 0
ds_read_b64_tr_b16 a[112:113], v8 offset:24576
s_cmp_ge_u32 s34, s36
v_mfma_f32_16x16x32_bf16 v[116:119], a[44:47], a[16:19], 0
ds_read_b64_tr_b16 a[114:115], v8 offset:25600
v_mfma_f32_16x16x32_bf16 v[124:127], a[44:47], a[20:23], 0
s_cselect_b32 s34, s35, s34
v_mfma_f32_16x16x32_bf16 v[132:135], a[44:47], a[24:27], 0
ds_read_b64_tr_b16 a[116:117], v9 offset:24576
v_mfma_f32_16x16x32_bf16 v[140:143], a[44:47], a[28:31], 0
ds_read_b64_tr_b16 a[118:119], v9 offset:25600
s_add_u32 m0, s43, 0
v_cvt_pk_bf16_f32 v144, v144, v145
v_cvt_pk_bf16_f32 v145, v146, v147
v_cvt_pk_bf16_f32 v146, v148, v149
v_cvt_pk_bf16_f32 v147, v150, v151
v_accvgpr_write_b32 a208, v144
v_accvgpr_write_b32 a209, v145
v_accvgpr_write_b32 a210, v146
v_accvgpr_write_b32 a211, v147
v_mfma_f32_16x16x32_bf16 v[144:147], a[48:51], a[0:3], 0
v_cvt_pk_bf16_f32 v152, v152, v153
v_cvt_pk_bf16_f32 v153, v154, v155
v_cvt_pk_bf16_f32 v154, v156, v157
v_cvt_pk_bf16_f32 v155, v158, v159
v_accvgpr_write_b32 a224, v152
v_accvgpr_write_b32 a225, v153
v_accvgpr_write_b32 a226, v154
v_accvgpr_write_b32 a227, v155
v_mfma_f32_16x16x32_bf16 v[152:155], a[48:51], a[4:7], 0
ds_read_b64_tr_b16 a[120:121], v10 offset:24576
buffer_load_dwordx4 v3, s[12:15], s31 offen lds
v_cvt_pk_bf16_f32 v160, v160, v161
v_cvt_pk_bf16_f32 v161, v162, v163
v_cvt_pk_bf16_f32 v162, v164, v165
v_cvt_pk_bf16_f32 v163, v166, v167
v_accvgpr_write_b32 a212, v160
v_accvgpr_write_b32 a213, v161
v_accvgpr_write_b32 a214, v162
v_accvgpr_write_b32 a215, v163
v_mfma_f32_16x16x32_bf16 v[160:163], a[48:51], a[8:11], 0
v_cvt_pk_bf16_f32 v168, v168, v169
v_cvt_pk_bf16_f32 v169, v170, v171
v_cvt_pk_bf16_f32 v170, v172, v173
v_cvt_pk_bf16_f32 v171, v174, v175
v_accvgpr_write_b32 a228, v168
v_accvgpr_write_b32 a229, v169
v_accvgpr_write_b32 a230, v170
v_accvgpr_write_b32 a231, v171
v_mfma_f32_16x16x32_bf16 v[168:171], a[48:51], a[12:15], 0
ds_read_b64_tr_b16 a[122:123], v10 offset:25600
s_add_u32 s31, s31, s32
v_cvt_pk_bf16_f32 v176, v176, v177
v_cvt_pk_bf16_f32 v177, v178, v179
v_cvt_pk_bf16_f32 v178, v180, v181
v_cvt_pk_bf16_f32 v179, v182, v183
v_accvgpr_write_b32 a216, v176
v_accvgpr_write_b32 a217, v177
v_accvgpr_write_b32 a218, v178
v_accvgpr_write_b32 a219, v179
v_mfma_f32_16x16x32_bf16 v[176:179], a[48:51], a[16:19], 0
ds_read_b64_tr_b16 a[124:125], v11 offset:24576
v_cvt_pk_bf16_f32 v184, v184, v185
v_cvt_pk_bf16_f32 v185, v186, v187
v_cvt_pk_bf16_f32 v186, v188, v189
v_cvt_pk_bf16_f32 v187, v190, v191
v_accvgpr_write_b32 a232, v184
v_accvgpr_write_b32 a233, v185
v_accvgpr_write_b32 a234, v186
v_accvgpr_write_b32 a235, v187
v_mfma_f32_16x16x32_bf16 v[184:187], a[48:51], a[20:23], 0
s_add_u32 m0, s43, 1024
v_cvt_pk_bf16_f32 v192, v192, v193
v_cvt_pk_bf16_f32 v193, v194, v195
v_cvt_pk_bf16_f32 v194, v196, v197
v_cvt_pk_bf16_f32 v195, v198, v199
v_accvgpr_write_b32 a220, v192
v_accvgpr_write_b32 a221, v193
v_accvgpr_write_b32 a222, v194
v_accvgpr_write_b32 a223, v195
v_mfma_f32_16x16x32_bf16 v[192:195], a[48:51], a[24:27], 0
ds_read_b64_tr_b16 a[126:127], v11 offset:25600
v_cvt_pk_bf16_f32 v200, v200, v201
v_cvt_pk_bf16_f32 v201, v202, v203
v_cvt_pk_bf16_f32 v202, v204, v205
v_cvt_pk_bf16_f32 v203, v206, v207
v_accvgpr_write_b32 a236, v200
v_accvgpr_write_b32 a237, v201
v_accvgpr_write_b32 a238, v202
v_accvgpr_write_b32 a239, v203
v_mfma_f32_16x16x32_bf16 v[200:203], a[48:51], a[28:31], 0
buffer_load_dwordx4 v3, s[12:15], s31 offen lds
v_mfma_f32_16x16x32_bf16 v[148:151], a[52:55], a[0:3], 0
v_mfma_f32_16x16x32_bf16 v[156:159], a[52:55], a[4:7], 0
v_mfma_f32_16x16x32_bf16 v[164:167], a[52:55], a[8:11], 0
s_add_u32 s31, s31, s33
v_mfma_f32_16x16x32_bf16 v[172:175], a[52:55], a[12:15], 0
v_mfma_f32_16x16x32_bf16 v[180:183], a[52:55], a[16:19], 0
s_add_u32 m0, s43, 4096
v_mfma_f32_16x16x32_bf16 v[188:191], a[52:55], a[20:23], 0
v_mfma_f32_16x16x32_bf16 v[196:199], a[52:55], a[24:27], 0
buffer_load_dwordx4 v3, s[12:15], s31 offen lds
v_mfma_f32_16x16x32_bf16 v[204:207], a[52:55], a[28:31], 0
v_cvt_pk_bf16_f32 v208, v208, v209
v_cvt_pk_bf16_f32 v209, v210, v211
v_cvt_pk_bf16_f32 v210, v212, v213
v_cvt_pk_bf16_f32 v211, v214, v215
v_accvgpr_write_b32 a240, v208
v_accvgpr_write_b32 a241, v209
v_accvgpr_write_b32 a242, v210
v_accvgpr_write_b32 a243, v211
v_mfma_f32_16x16x32_bf16 v[208:211], a[56:59], a[0:3], 0
s_add_u32 s31, s31, s32
v_cvt_pk_bf16_f32 v216, v216, v217
v_cvt_pk_bf16_f32 v217, v218, v219
v_cvt_pk_bf16_f32 v218, v220, v221
v_cvt_pk_bf16_f32 v219, v222, v223
s_add_u32 s40, s44, 57344
buffer_store_dwordx4 v[216:219], v12, s[4:7], s40 offen sc1
s_nop 1
v_mfma_f32_16x16x32_bf16 v[216:219], a[56:59], a[4:7], 0
v_cvt_pk_bf16_f32 v224, v224, v225
v_cvt_pk_bf16_f32 v225, v226, v227
v_cvt_pk_bf16_f32 v226, v228, v229
v_cvt_pk_bf16_f32 v227, v230, v231
v_accvgpr_write_b32 a244, v224
v_accvgpr_write_b32 a245, v225
v_accvgpr_write_b32 a246, v226
v_accvgpr_write_b32 a247, v227
v_mfma_f32_16x16x32_bf16 v[224:227], a[56:59], a[8:11], 0
s_add_u32 m0, s43, 5120
v_cvt_pk_bf16_f32 v232, v232, v233
v_cvt_pk_bf16_f32 v233, v234, v235
v_cvt_pk_bf16_f32 v234, v236, v237
v_cvt_pk_bf16_f32 v235, v238, v239
s_add_u32 s40, s44, 58368
buffer_store_dwordx4 v[232:235], v12, s[4:7], s40 offen sc1
s_nop 1
v_mfma_f32_16x16x32_bf16 v[232:235], a[56:59], a[12:15], 0
v_cvt_pk_bf16_f32 v240, v240, v241
v_cvt_pk_bf16_f32 v241, v242, v243
v_cvt_pk_bf16_f32 v242, v244, v245
v_cvt_pk_bf16_f32 v243, v246, v247
v_accvgpr_write_b32 a248, v240
v_accvgpr_write_b32 a249, v241
v_accvgpr_write_b32 a250, v242
v_accvgpr_write_b32 a251, v243
v_mfma_f32_16x16x32_bf16 v[240:243], a[56:59], a[16:19], 0
buffer_load_dwordx4 v3, s[12:15], s31 offen lds
v_cvt_pk_bf16_f32 v248, v248, v249
v_cvt_pk_bf16_f32 v249, v250, v251
v_cvt_pk_bf16_f32 v250, v252, v253
v_cvt_pk_bf16_f32 v251, v254, v255
s_add_u32 s40, s44, 61440
buffer_store_dwordx4 v[248:251], v12, s[4:7], s40 offen sc1
s_nop 1
v_mfma_f32_16x16x32_bf16 v[248:251], a[56:59], a[20:23], 0
v_mfma_f32_16x16x32_bf16 a[128:131], a[56:59], a[24:27], 0
s_add_u32 s31, s31, s33
v_mfma_f32_16x16x32_bf16 a[136:139], a[56:59], a[28:31], 0
v_mfma_f32_16x16x32_bf16 v[212:215], a[60:63], a[0:3], 0
s_add_u32 s38, s38, 32768
v_mfma_f32_16x16x32_bf16 v[220:223], a[60:63], a[4:7], 0
v_mfma_f32_16x16x32_bf16 v[228:231], a[60:63], a[8:11], 0
s_cmp_ge_u32 s38, s42
v_mfma_f32_16x16x32_bf16 v[236:239], a[60:63], a[12:15], 0
v_mfma_f32_16x16x32_bf16 v[244:247], a[60:63], a[16:19], 0
s_cselect_b32 s38, s41, s38
v_mfma_f32_16x16x32_bf16 v[252:255], a[60:63], a[20:23], 0
v_mfma_f32_16x16x32_bf16 a[132:135], a[60:63], a[24:27], 0
v_mfma_f32_16x16x32_bf16 a[140:143], a[60:63], a[28:31], 0
s_branch fused_kernel_gu
fused_kernel_gnogu1:
v_cvt_pk_bf16_f32 v16, v16, v17
v_cvt_pk_bf16_f32 v17, v18, v19
v_cvt_pk_bf16_f32 v18, v20, v21
v_cvt_pk_bf16_f32 v19, v22, v23
s_add_u32 s40, s44, 0
buffer_store_dwordx4 v[16:19], v12, s[4:7], s40 offen sc1
v_cvt_pk_bf16_f32 v24, v24, v25
v_cvt_pk_bf16_f32 v25, v26, v27
v_cvt_pk_bf16_f32 v26, v28, v29
v_cvt_pk_bf16_f32 v27, v30, v31
s_add_u32 s40, s44, 8192
buffer_store_dwordx4 v[24:27], v12, s[4:7], s40 offen sc1
v_cvt_pk_bf16_f32 v32, v32, v33
v_cvt_pk_bf16_f32 v33, v34, v35
v_cvt_pk_bf16_f32 v34, v36, v37
v_cvt_pk_bf16_f32 v35, v38, v39
s_add_u32 s40, s44, 1024
buffer_store_dwordx4 v[32:35], v12, s[4:7], s40 offen sc1
v_cvt_pk_bf16_f32 v40, v40, v41
v_cvt_pk_bf16_f32 v41, v42, v43
v_cvt_pk_bf16_f32 v42, v44, v45
v_cvt_pk_bf16_f32 v43, v46, v47
s_add_u32 s40, s44, 9216
buffer_store_dwordx4 v[40:43], v12, s[4:7], s40 offen sc1
v_cvt_pk_bf16_f32 v48, v48, v49
v_cvt_pk_bf16_f32 v49, v50, v51
v_cvt_pk_bf16_f32 v50, v52, v53
v_cvt_pk_bf16_f32 v51, v54, v55
s_add_u32 s40, s44, 4096
buffer_store_dwordx4 v[48:51], v12, s[4:7], s40 offen sc1
v_cvt_pk_bf16_f32 v56, v56, v57
v_cvt_pk_bf16_f32 v57, v58, v59
v_cvt_pk_bf16_f32 v58, v60, v61
v_cvt_pk_bf16_f32 v59, v62, v63
s_add_u32 s40, s44, 12288
buffer_store_dwordx4 v[56:59], v12, s[4:7], s40 offen sc1
v_cvt_pk_bf16_f32 v64, v64, v65
v_cvt_pk_bf16_f32 v65, v66, v67
v_cvt_pk_bf16_f32 v66, v68, v69
v_cvt_pk_bf16_f32 v67, v70, v71
s_add_u32 s40, s44, 5120
buffer_store_dwordx4 v[64:67], v12, s[4:7], s40 offen sc1
v_cvt_pk_bf16_f32 v72, v72, v73
v_cvt_pk_bf16_f32 v73, v74, v75
v_cvt_pk_bf16_f32 v74, v76, v77
v_cvt_pk_bf16_f32 v75, v78, v79
s_add_u32 s40, s44, 13312
buffer_store_dwordx4 v[72:75], v12, s[4:7], s40 offen sc1
v_cvt_pk_bf16_f32 v80, v80, v81
v_cvt_pk_bf16_f32 v81, v82, v83
v_cvt_pk_bf16_f32 v82, v84, v85
v_cvt_pk_bf16_f32 v83, v86, v87
s_add_u32 s40, s44, 16384
buffer_store_dwordx4 v[80:83], v12, s[4:7], s40 offen sc1
v_cvt_pk_bf16_f32 v88, v88, v89
v_cvt_pk_bf16_f32 v89, v90, v91
v_cvt_pk_bf16_f32 v90, v92, v93
v_cvt_pk_bf16_f32 v91, v94, v95
s_add_u32 s40, s44, 24576
buffer_store_dwordx4 v[88:91], v12, s[4:7], s40 offen sc1
v_cvt_pk_bf16_f32 v96, v96, v97
v_cvt_pk_bf16_f32 v97, v98, v99
v_cvt_pk_bf16_f32 v98, v100, v101
v_cvt_pk_bf16_f32 v99, v102, v103
s_add_u32 s40, s44, 17408
buffer_store_dwordx4 v[96:99], v12, s[4:7], s40 offen sc1
v_cvt_pk_bf16_f32 v104, v104, v105
v_cvt_pk_bf16_f32 v105, v106, v107
v_cvt_pk_bf16_f32 v106, v108, v109
v_cvt_pk_bf16_f32 v107, v110, v111
s_add_u32 s40, s44, 25600
buffer_store_dwordx4 v[104:107], v12, s[4:7], s40 offen sc1
v_cvt_pk_bf16_f32 v112, v112, v113
v_cvt_pk_bf16_f32 v113, v114, v115
v_cvt_pk_bf16_f32 v114, v116, v117
v_cvt_pk_bf16_f32 v115, v118, v119
s_add_u32 s40, s44, 20480
buffer_store_dwordx4 v[112:115], v12, s[4:7], s40 offen sc1
v_cvt_pk_bf16_f32 v120, v120, v121
v_cvt_pk_bf16_f32 v121, v122, v123
v_cvt_pk_bf16_f32 v122, v124, v125
v_cvt_pk_bf16_f32 v123, v126, v127
s_add_u32 s40, s44, 28672
buffer_store_dwordx4 v[120:123], v12, s[4:7], s40 offen sc1
v_cvt_pk_bf16_f32 v128, v128, v129
v_cvt_pk_bf16_f32 v129, v130, v131
v_cvt_pk_bf16_f32 v130, v132, v133
v_cvt_pk_bf16_f32 v131, v134, v135
s_add_u32 s40, s44, 21504
buffer_store_dwordx4 v[128:131], v12, s[4:7], s40 offen sc1
v_cvt_pk_bf16_f32 v136, v136, v137
v_cvt_pk_bf16_f32 v137, v138, v139
v_cvt_pk_bf16_f32 v138, v140, v141
v_cvt_pk_bf16_f32 v139, v142, v143
s_add_u32 s40, s44, 29696
buffer_store_dwordx4 v[136:139], v12, s[4:7], s40 offen sc1
v_cvt_pk_bf16_f32 v144, v144, v145
v_cvt_pk_bf16_f32 v145, v146, v147
v_cvt_pk_bf16_f32 v146, v148, v149
v_cvt_pk_bf16_f32 v147, v150, v151
s_add_u32 s40, s44, 32768
buffer_store_dwordx4 v[144:147], v12, s[4:7], s40 offen sc1
v_cvt_pk_bf16_f32 v152, v152, v153
v_cvt_pk_bf16_f32 v153, v154, v155
v_cvt_pk_bf16_f32 v154, v156, v157
v_cvt_pk_bf16_f32 v155, v158, v159
s_add_u32 s40, s44, 40960
buffer_store_dwordx4 v[152:155], v12, s[4:7], s40 offen sc1
v_cvt_pk_bf16_f32 v160, v160, v161
v_cvt_pk_bf16_f32 v161, v162, v163
v_cvt_pk_bf16_f32 v162, v164, v165
v_cvt_pk_bf16_f32 v163, v166, v167
s_add_u32 s40, s44, 33792
buffer_store_dwordx4 v[160:163], v12, s[4:7], s40 offen sc1
v_cvt_pk_bf16_f32 v168, v168, v169
v_cvt_pk_bf16_f32 v169, v170, v171
v_cvt_pk_bf16_f32 v170, v172, v173
v_cvt_pk_bf16_f32 v171, v174, v175
s_add_u32 s40, s44, 41984
buffer_store_dwordx4 v[168:171], v12, s[4:7], s40 offen sc1
v_cvt_pk_bf16_f32 v176, v176, v177
v_cvt_pk_bf16_f32 v177, v178, v179
v_cvt_pk_bf16_f32 v178, v180, v181
v_cvt_pk_bf16_f32 v179, v182, v183
s_add_u32 s40, s44, 36864
buffer_store_dwordx4 v[176:179], v12, s[4:7], s40 offen sc1
v_cvt_pk_bf16_f32 v184, v184, v185
v_cvt_pk_bf16_f32 v185, v186, v187
v_cvt_pk_bf16_f32 v186, v188, v189
v_cvt_pk_bf16_f32 v187, v190, v191
s_add_u32 s40, s44, 45056
buffer_store_dwordx4 v[184:187], v12, s[4:7], s40 offen sc1
v_cvt_pk_bf16_f32 v192, v192, v193
v_cvt_pk_bf16_f32 v193, v194, v195
v_cvt_pk_bf16_f32 v194, v196, v197
v_cvt_pk_bf16_f32 v195, v198, v199
s_add_u32 s40, s44, 37888
buffer_store_dwordx4 v[192:195], v12, s[4:7], s40 offen sc1
v_cvt_pk_bf16_f32 v200, v200, v201
v_cvt_pk_bf16_f32 v201, v202, v203
v_cvt_pk_bf16_f32 v202, v204, v205
v_cvt_pk_bf16_f32 v203, v206, v207
s_add_u32 s40, s44, 46080
buffer_store_dwordx4 v[200:203], v12, s[4:7], s40 offen sc1
v_cvt_pk_bf16_f32 v208, v208, v209
v_cvt_pk_bf16_f32 v209, v210, v211
v_cvt_pk_bf16_f32 v210, v212, v213
v_cvt_pk_bf16_f32 v211, v214, v215
s_add_u32 s40, s44, 49152
buffer_store_dwordx4 v[208:211], v12, s[4:7], s40 offen sc1
v_cvt_pk_bf16_f32 v216, v216, v217
v_cvt_pk_bf16_f32 v217, v218, v219
v_cvt_pk_bf16_f32 v218, v220, v221
v_cvt_pk_bf16_f32 v219, v222, v223
s_add_u32 s40, s44, 57344
buffer_store_dwordx4 v[216:219], v12, s[4:7], s40 offen sc1
v_cvt_pk_bf16_f32 v224, v224, v225
v_cvt_pk_bf16_f32 v225, v226, v227
v_cvt_pk_bf16_f32 v226, v228, v229
v_cvt_pk_bf16_f32 v227, v230, v231
s_add_u32 s40, s44, 50176
buffer_store_dwordx4 v[224:227], v12, s[4:7], s40 offen sc1
v_cvt_pk_bf16_f32 v232, v232, v233
v_cvt_pk_bf16_f32 v233, v234, v235
v_cvt_pk_bf16_f32 v234, v236, v237
v_cvt_pk_bf16_f32 v235, v238, v239
s_add_u32 s40, s44, 58368
buffer_store_dwordx4 v[232:235], v12, s[4:7], s40 offen sc1
v_cvt_pk_bf16_f32 v240, v240, v241
v_cvt_pk_bf16_f32 v241, v242, v243
v_cvt_pk_bf16_f32 v242, v244, v245
v_cvt_pk_bf16_f32 v243, v246, v247
s_add_u32 s40, s44, 53248
buffer_store_dwordx4 v[240:243], v12, s[4:7], s40 offen sc1
v_cvt_pk_bf16_f32 v248, v248, v249
v_cvt_pk_bf16_f32 v249, v250, v251
v_cvt_pk_bf16_f32 v250, v252, v253
v_cvt_pk_bf16_f32 v251, v254, v255
s_add_u32 s40, s44, 61440
buffer_store_dwordx4 v[248:251], v12, s[4:7], s40 offen sc1
v_accvgpr_read_b32 v16, a128
v_accvgpr_read_b32 v20, a132
v_accvgpr_read_b32 v17, a129
v_accvgpr_read_b32 v21, a133
v_accvgpr_read_b32 v18, a130
v_accvgpr_read_b32 v22, a134
v_accvgpr_read_b32 v19, a131
v_accvgpr_read_b32 v23, a135
v_cvt_pk_bf16_f32 v16, v16, v17
v_cvt_pk_bf16_f32 v17, v18, v19
v_cvt_pk_bf16_f32 v18, v20, v21
v_cvt_pk_bf16_f32 v19, v22, v23
s_add_u32 s40, s44, 54272
buffer_store_dwordx4 v[16:19], v12, s[4:7], s40 offen sc1
v_accvgpr_read_b32 v24, a136
v_accvgpr_read_b32 v28, a140
v_accvgpr_read_b32 v25, a137
v_accvgpr_read_b32 v29, a141
v_accvgpr_read_b32 v26, a138
v_accvgpr_read_b32 v30, a142
v_accvgpr_read_b32 v27, a139
v_accvgpr_read_b32 v31, a143
v_cvt_pk_bf16_f32 v24, v24, v25
v_cvt_pk_bf16_f32 v25, v26, v27
v_cvt_pk_bf16_f32 v26, v28, v29
v_cvt_pk_bf16_f32 v27, v30, v31
s_add_u32 s40, s44, 62464
buffer_store_dwordx4 v[24:27], v12, s[4:7], s40 offen sc1
s_branch fused_kernel_gnogu
fused_kernel_gu:
s_waitcnt vmcnt(17) lgkmcnt(0)
s_barrier
v_mfma_f32_16x16x32_bf16 v[16:19], a[96:99], a[64:67], v[16:19]
v_add_u32 v6, s37, v4
s_add_u32 m0, s34, 0
v_mfma_f32_16x16x32_bf16 v[24:27], a[96:99], a[68:71], v[24:27]
ds_read_b64_tr_b16 a[32:33], v8 offset:32768
buffer_load_dwordx4 v2, s[8:11], s28 offen lds
v_mfma_f32_16x16x32_bf16 v[32:35], a[96:99], a[72:75], v[32:35]
ds_read_b64_tr_b16 a[34:35], v8 offset:33792
v_mfma_f32_16x16x32_bf16 v[40:43], a[96:99], a[76:79], v[40:43]
s_add_u32 s28, s28, s29
v_mfma_f32_16x16x32_bf16 v[48:51], a[96:99], a[80:83], v[48:51]
ds_read_b128 a[0:3], v6 offset:0
v_mfma_f32_16x16x32_bf16 v[56:59], a[96:99], a[84:87], v[56:59]
ds_read_b128 a[4:7], v6 offset:2048
s_add_u32 m0, s34, 4096
v_mfma_f32_16x16x32_bf16 v[64:67], a[96:99], a[88:91], v[64:67]
v_mfma_f32_16x16x32_bf16 v[72:75], a[96:99], a[92:95], v[72:75]
ds_read_b128 a[8:11], v6 offset:4096
buffer_load_dwordx4 v2, s[8:11], s28 offen lds
v_mfma_f32_16x16x32_bf16 v[20:23], a[100:103], a[64:67], v[20:23]
v_mfma_f32_16x16x32_bf16 v[28:31], a[100:103], a[68:71], v[28:31]
ds_read_b128 a[12:15], v6 offset:6144
s_add_u32 s28, s28, s29
v_mfma_f32_16x16x32_bf16 v[36:39], a[100:103], a[72:75], v[36:39]
ds_read_b128 a[16:19], v6 offset:8192
s_add_u32 m0, s34, 8192
v_mfma_f32_16x16x32_bf16 v[44:47], a[100:103], a[76:79], v[44:47]
v_mfma_f32_16x16x32_bf16 v[52:55], a[100:103], a[80:83], v[52:55]
ds_read_b128 a[20:23], v6 offset:10240
buffer_load_dwordx4 v2, s[8:11], s28 offen lds
v_mfma_f32_16x16x32_bf16 v[60:63], a[100:103], a[84:87], v[60:63]
v_mfma_f32_16x16x32_bf16 v[68:71], a[100:103], a[88:91], v[68:71]
ds_read_b128 a[24:27], v6 offset:12288
s_add_u32 s28, s28, s29
v_mfma_f32_16x16x32_bf16 v[76:79], a[100:103], a[92:95], v[76:79]
ds_read_b128 a[28:31], v6 offset:14336
v_mfma_f32_16x16x32_bf16 v[80:83], a[104:107], a[64:67], v[80:83]
s_add_u32 m0, s34, 12288
v_mfma_f32_16x16x32_bf16 v[88:91], a[104:107], a[68:71], v[88:91]
ds_read_b64_tr_b16 a[36:37], v9 offset:32768
v_mfma_f32_16x16x32_bf16 v[96:99], a[104:107], a[72:75], v[96:99]
ds_read_b64_tr_b16 a[38:39], v9 offset:33792
buffer_load_dwordx4 v2, s[8:11], s28 offen lds
v_mfma_f32_16x16x32_bf16 v[104:107], a[104:107], a[76:79], v[104:107]
s_add_u32 s28, s28, s29
v_mfma_f32_16x16x32_bf16 v[112:115], a[104:107], a[80:83], v[112:115]
ds_read_b64_tr_b16 a[40:41], v10 offset:32768
v_mfma_f32_16x16x32_bf16 v[120:123], a[104:107], a[84:87], v[120:123]
s_add_u32 m0, s43, 16384
v_mfma_f32_16x16x32_bf16 v[128:131], a[104:107], a[88:91], v[128:131]
ds_read_b64_tr_b16 a[42:43], v10 offset:33792
v_mfma_f32_16x16x32_bf16 v[136:139], a[104:107], a[92:95], v[136:139]
ds_read_b64_tr_b16 a[44:45], v11 offset:32768
buffer_load_dwordx4 v3, s[12:15], s31 offen lds
v_mfma_f32_16x16x32_bf16 v[84:87], a[108:111], a[64:67], v[84:87]
v_mfma_f32_16x16x32_bf16 v[92:95], a[108:111], a[68:71], v[92:95]
ds_read_b64_tr_b16 a[46:47], v11 offset:33792
s_add_u32 s31, s31, s32
v_mfma_f32_16x16x32_bf16 v[100:103], a[108:111], a[72:75], v[100:103]
v_mfma_f32_16x16x32_bf16 v[108:111], a[108:111], a[76:79], v[108:111]
ds_read_b64_tr_b16 a[48:49], v8 offset:40960
s_add_u32 m0, s43, 17408
v_mfma_f32_16x16x32_bf16 v[116:119], a[108:111], a[80:83], v[116:119]
ds_read_b64_tr_b16 a[50:51], v8 offset:41984
buffer_load_dwordx4 v3, s[12:15], s31 offen lds
v_mfma_f32_16x16x32_bf16 v[124:127], a[108:111], a[84:87], v[124:127]
v_mfma_f32_16x16x32_bf16 v[132:135], a[108:111], a[88:91], v[132:135]
ds_read_b64_tr_b16 a[52:53], v9 offset:40960
s_add_u32 s31, s31, s33
v_mfma_f32_16x16x32_bf16 v[140:143], a[108:111], a[92:95], v[140:143]
ds_read_b64_tr_b16 a[54:55], v9 offset:41984
v_mfma_f32_16x16x32_bf16 v[144:147], a[112:115], a[64:67], v[144:147]
s_add_u32 m0, s43, 20480
v_mfma_f32_16x16x32_bf16 v[152:155], a[112:115], a[68:71], v[152:155]
ds_read_b64_tr_b16 a[56:57], v10 offset:40960
v_mfma_f32_16x16x32_bf16 v[160:163], a[112:115], a[72:75], v[160:163]
buffer_load_dwordx4 v3, s[12:15], s31 offen lds
v_mfma_f32_16x16x32_bf16 v[168:171], a[112:115], a[76:79], v[168:171]
ds_read_b64_tr_b16 a[58:59], v10 offset:41984
v_mfma_f32_16x16x32_bf16 v[176:179], a[112:115], a[80:83], v[176:179]
ds_read_b64_tr_b16 a[60:61], v11 offset:40960
s_add_u32 s31, s31, s32
v_mfma_f32_16x16x32_bf16 v[184:187], a[112:115], a[84:87], v[184:187]
s_add_u32 m0, s43, 21504
v_mfma_f32_16x16x32_bf16 v[192:195], a[112:115], a[88:91], v[192:195]
ds_read_b64_tr_b16 a[62:63], v11 offset:41984
v_mfma_f32_16x16x32_bf16 v[200:203], a[112:115], a[92:95], v[200:203]
buffer_load_dwordx4 v3, s[12:15], s31 offen lds
v_mfma_f32_16x16x32_bf16 v[148:151], a[116:119], a[64:67], v[148:151]
v_mfma_f32_16x16x32_bf16 v[156:159], a[116:119], a[68:71], v[156:159]
s_add_u32 s31, s31, s33
v_mfma_f32_16x16x32_bf16 v[164:167], a[116:119], a[72:75], v[164:167]
v_mfma_f32_16x16x32_bf16 v[172:175], a[116:119], a[76:79], v[172:175]
s_add_u32 s37, s37, 32768
v_mfma_f32_16x16x32_bf16 v[180:183], a[116:119], a[80:83], v[180:183]
v_mfma_f32_16x16x32_bf16 v[188:191], a[116:119], a[84:87], v[188:191]
s_cmp_ge_u32 s37, s42
v_mfma_f32_16x16x32_bf16 v[196:199], a[116:119], a[88:91], v[196:199]
s_cselect_b32 s37, s41, s37
v_mfma_f32_16x16x32_bf16 v[204:207], a[116:119], a[92:95], v[204:207]
v_mfma_f32_16x16x32_bf16 v[208:211], a[120:123], a[64:67], v[208:211]
s_add_u32 s40, s44, 0
v_mfma_f32_16x16x32_bf16 v[216:219], a[120:123], a[68:71], v[216:219]
v_mfma_f32_16x16x32_bf16 v[224:227], a[120:123], a[72:75], v[224:227]
buffer_store_dwordx4 a[144:147], v12, s[4:7], s40 offen sc1
v_mfma_f32_16x16x32_bf16 v[232:235], a[120:123], a[76:79], v[232:235]
v_mfma_f32_16x16x32_bf16 v[240:243], a[120:123], a[80:83], v[240:243]
s_add_u32 s40, s44, 1024
v_mfma_f32_16x16x32_bf16 v[248:251], a[120:123], a[84:87], v[248:251]
v_mfma_f32_16x16x32_bf16 a[128:131], a[120:123], a[88:91], a[128:131]
buffer_store_dwordx4 a[148:151], v12, s[4:7], s40 offen sc1
v_mfma_f32_16x16x32_bf16 a[136:139], a[120:123], a[92:95], a[136:139]
s_add_u32 s40, s44, 4096
v_mfma_f32_16x16x32_bf16 v[212:215], a[124:127], a[64:67], v[212:215]
v_mfma_f32_16x16x32_bf16 v[220:223], a[124:127], a[68:71], v[220:223]
buffer_store_dwordx4 a[152:155], v12, s[4:7], s40 offen sc1
v_mfma_f32_16x16x32_bf16 v[228:231], a[124:127], a[72:75], v[228:231]
v_mfma_f32_16x16x32_bf16 v[236:239], a[124:127], a[76:79], v[236:239]
s_add_u32 s40, s44, 5120
v_mfma_f32_16x16x32_bf16 v[244:247], a[124:127], a[80:83], v[244:247]
v_mfma_f32_16x16x32_bf16 v[252:255], a[124:127], a[84:87], v[252:255]
buffer_store_dwordx4 a[156:159], v12, s[4:7], s40 offen sc1
v_mfma_f32_16x16x32_bf16 a[132:135], a[124:127], a[88:91], a[132:135]
v_mfma_f32_16x16x32_bf16 a[140:143], a[124:127], a[92:95], a[140:143]
s_waitcnt vmcnt(21) lgkmcnt(0)
s_barrier
v_mfma_f32_16x16x32_bf16 v[16:19], a[32:35], a[0:3], v[16:19]
v_add_u32 v7, s38, v5
s_add_u32 m0, s34, 16384
v_mfma_f32_16x16x32_bf16 v[24:27], a[32:35], a[4:7], v[24:27]
ds_read_b64_tr_b16 a[96:97], v8 offset:49152
buffer_load_dwordx4 v2, s[8:11], s28 offen lds
v_mfma_f32_16x16x32_bf16 v[32:35], a[32:35], a[8:11], v[32:35]
ds_read_b64_tr_b16 a[98:99], v8 offset:50176
v_mfma_f32_16x16x32_bf16 v[40:43], a[32:35], a[12:15], v[40:43]
s_add_u32 s28, s28, s29
v_mfma_f32_16x16x32_bf16 v[48:51], a[32:35], a[16:19], v[48:51]
ds_read_b128 a[64:67], v7 offset:0
s_add_u32 m0, s34, 20480
v_mfma_f32_16x16x32_bf16 v[56:59], a[32:35], a[20:23], v[56:59]
ds_read_b128 a[68:71], v7 offset:2048
v_mfma_f32_16x16x32_bf16 v[64:67], a[32:35], a[24:27], v[64:67]
buffer_load_dwordx4 v2, s[8:11], s28 offen lds
v_mfma_f32_16x16x32_bf16 v[72:75], a[32:35], a[28:31], v[72:75]
ds_read_b128 a[72:75], v7 offset:4096
v_mfma_f32_16x16x32_bf16 v[20:23], a[36:39], a[0:3], v[20:23]
s_add_u32 s28, s28, s29
v_mfma_f32_16x16x32_bf16 v[28:31], a[36:39], a[4:7], v[28:31]
ds_read_b128 a[76:79], v7 offset:6144
s_add_u32 m0, s34, 24576
v_mfma_f32_16x16x32_bf16 v[36:39], a[36:39], a[8:11], v[36:39]
ds_read_b128 a[80:83], v7 offset:8192
v_mfma_f32_16x16x32_bf16 v[44:47], a[36:39], a[12:15], v[44:47]
buffer_load_dwordx4 v2, s[8:11], s28 offen lds
v_mfma_f32_16x16x32_bf16 v[52:55], a[36:39], a[16:19], v[52:55]
ds_read_b128 a[84:87], v7 offset:10240
v_mfma_f32_16x16x32_bf16 v[60:63], a[36:39], a[20:23], v[60:63]
s_add_u32 s28, s28, s29
v_mfma_f32_16x16x32_bf16 v[68:71], a[36:39], a[24:27], v[68:71]
ds_read_b128 a[88:91], v7 offset:12288
s_add_u32 m0, s34, 28672
v_mfma_f32_16x16x32_bf16 v[76:79], a[36:39], a[28:31], v[76:79]
ds_read_b128 a[92:95], v7 offset:14336
v_mfma_f32_16x16x32_bf16 v[80:83], a[40:43], a[0:3], v[80:83]
buffer_load_dwordx4 v2, s[8:11], s28 offen lds
v_mfma_f32_16x16x32_bf16 v[88:91], a[40:43], a[4:7], v[88:91]
ds_read_b64_tr_b16 a[100:101], v9 offset:49152
v_mfma_f32_16x16x32_bf16 v[96:99], a[40:43], a[8:11], v[96:99]
ds_read_b64_tr_b16 a[102:103], v9 offset:50176
s_add_u32 s28, s28, s30
v_mfma_f32_16x16x32_bf16 v[104:107], a[40:43], a[12:15], v[104:107]
s_add_u32 s34, s34, 32768
v_mfma_f32_16x16x32_bf16 v[112:115], a[40:43], a[16:19], v[112:115]
ds_read_b64_tr_b16 a[104:105], v10 offset:49152
v_mfma_f32_16x16x32_bf16 v[120:123], a[40:43], a[20:23], v[120:123]
s_cmp_ge_u32 s34, s36
v_mfma_f32_16x16x32_bf16 v[128:131], a[40:43], a[24:27], v[128:131]
ds_read_b64_tr_b16 a[106:107], v10 offset:50176
v_mfma_f32_16x16x32_bf16 v[136:139], a[40:43], a[28:31], v[136:139]
ds_read_b64_tr_b16 a[108:109], v11 offset:49152
s_cselect_b32 s34, s35, s34
v_mfma_f32_16x16x32_bf16 v[84:87], a[44:47], a[0:3], v[84:87]
s_add_u32 m0, s43, 32768
v_mfma_f32_16x16x32_bf16 v[92:95], a[44:47], a[4:7], v[92:95]
ds_read_b64_tr_b16 a[110:111], v11 offset:50176
v_mfma_f32_16x16x32_bf16 v[100:103], a[44:47], a[8:11], v[100:103]
buffer_load_dwordx4 v3, s[12:15], s31 offen lds
v_mfma_f32_16x16x32_bf16 v[108:111], a[44:47], a[12:15], v[108:111]
ds_read_b64_tr_b16 a[112:113], v8 offset:57344
v_mfma_f32_16x16x32_bf16 v[116:119], a[44:47], a[16:19], v[116:119]
ds_read_b64_tr_b16 a[114:115], v8 offset:58368
s_add_u32 s31, s31, s32
v_mfma_f32_16x16x32_bf16 v[124:127], a[44:47], a[20:23], v[124:127]
s_add_u32 m0, s43, 33792
v_mfma_f32_16x16x32_bf16 v[132:135], a[44:47], a[24:27], v[132:135]
ds_read_b64_tr_b16 a[116:117], v9 offset:57344
v_mfma_f32_16x16x32_bf16 v[140:143], a[44:47], a[28:31], v[140:143]
ds_read_b64_tr_b16 a[118:119], v9 offset:58368
buffer_load_dwordx4 v3, s[12:15], s31 offen lds
v_mfma_f32_16x16x32_bf16 v[144:147], a[48:51], a[0:3], v[144:147]
v_mfma_f32_16x16x32_bf16 v[152:155], a[48:51], a[4:7], v[152:155]
ds_read_b64_tr_b16 a[120:121], v10 offset:57344
s_add_u32 s31, s31, s33
v_mfma_f32_16x16x32_bf16 v[160:163], a[48:51], a[8:11], v[160:163]
s_add_u32 m0, s43, 36864
v_mfma_f32_16x16x32_bf16 v[168:171], a[48:51], a[12:15], v[168:171]
ds_read_b64_tr_b16 a[122:123], v10 offset:58368
v_mfma_f32_16x16x32_bf16 v[176:179], a[48:51], a[16:19], v[176:179]
ds_read_b64_tr_b16 a[124:125], v11 offset:57344
buffer_load_dwordx4 v3, s[12:15], s31 offen lds
v_mfma_f32_16x16x32_bf16 v[184:187], a[48:51], a[20:23], v[184:187]
v_mfma_f32_16x16x32_bf16 v[192:195], a[48:51], a[24:27], v[192:195]
ds_read_b64_tr_b16 a[126:127], v11 offset:58368
s_add_u32 s31, s31, s32
v_mfma_f32_16x16x32_bf16 v[200:203], a[48:51], a[28:31], v[200:203]
s_add_u32 m0, s43, 37888
v_mfma_f32_16x16x32_bf16 v[148:151], a[52:55], a[0:3], v[148:151]
v_mfma_f32_16x16x32_bf16 v[156:159], a[52:55], a[4:7], v[156:159]
buffer_load_dwordx4 v3, s[12:15], s31 offen lds
v_mfma_f32_16x16x32_bf16 v[164:167], a[52:55], a[8:11], v[164:167]
v_mfma_f32_16x16x32_bf16 v[172:175], a[52:55], a[12:15], v[172:175]
s_add_u32 s31, s31, s33
v_mfma_f32_16x16x32_bf16 v[180:183], a[52:55], a[16:19], v[180:183]
s_add_u32 s38, s38, 32768
v_mfma_f32_16x16x32_bf16 v[188:191], a[52:55], a[20:23], v[188:191]
v_mfma_f32_16x16x32_bf16 v[196:199], a[52:55], a[24:27], v[196:199]
s_cmp_ge_u32 s38, s42
v_mfma_f32_16x16x32_bf16 v[204:207], a[52:55], a[28:31], v[204:207]
v_mfma_f32_16x16x32_bf16 v[208:211], a[56:59], a[0:3], v[208:211]
s_cselect_b32 s38, s41, s38
v_mfma_f32_16x16x32_bf16 v[216:219], a[56:59], a[4:7], v[216:219]
s_add_u32 s40, s44, 8192
v_mfma_f32_16x16x32_bf16 v[224:227], a[56:59], a[8:11], v[224:227]
v_mfma_f32_16x16x32_bf16 v[232:235], a[56:59], a[12:15], v[232:235]
buffer_store_dwordx4 a[160:163], v12, s[4:7], s40 offen sc1
v_mfma_f32_16x16x32_bf16 v[240:243], a[56:59], a[16:19], v[240:243]
v_mfma_f32_16x16x32_bf16 v[248:251], a[56:59], a[20:23], v[248:251]
s_add_u32 s40, s44, 9216
v_mfma_f32_16x16x32_bf16 a[128:131], a[56:59], a[24:27], a[128:131]
buffer_store_dwordx4 a[164:167], v12, s[4:7], s40 offen sc1
v_mfma_f32_16x16x32_bf16 a[136:139], a[56:59], a[28:31], a[136:139]
v_mfma_f32_16x16x32_bf16 v[212:215], a[60:63], a[0:3], v[212:215]
s_add_u32 s40, s44, 12288
v_mfma_f32_16x16x32_bf16 v[220:223], a[60:63], a[4:7], v[220:223]
v_mfma_f32_16x16x32_bf16 v[228:231], a[60:63], a[8:11], v[228:231]
buffer_store_dwordx4 a[168:171], v12, s[4:7], s40 offen sc1
v_mfma_f32_16x16x32_bf16 v[236:239], a[60:63], a[12:15], v[236:239]
s_add_u32 s40, s44, 13312
v_mfma_f32_16x16x32_bf16 v[244:247], a[60:63], a[16:19], v[244:247]
v_mfma_f32_16x16x32_bf16 v[252:255], a[60:63], a[20:23], v[252:255]
buffer_store_dwordx4 a[172:175], v12, s[4:7], s40 offen sc1
v_mfma_f32_16x16x32_bf16 a[132:135], a[60:63], a[24:27], a[132:135]
v_mfma_f32_16x16x32_bf16 a[140:143], a[60:63], a[28:31], a[140:143]
s_waitcnt vmcnt(24) lgkmcnt(0)
s_barrier
v_mfma_f32_16x16x32_bf16 v[16:19], a[96:99], a[64:67], v[16:19]
v_add_u32 v6, s37, v4
s_add_u32 m0, s34, 0
v_mfma_f32_16x16x32_bf16 v[24:27], a[96:99], a[68:71], v[24:27]
ds_read_b64_tr_b16 a[32:33], v8 offset:0
buffer_load_dwordx4 v2, s[8:11], s28 offen lds
v_mfma_f32_16x16x32_bf16 v[32:35], a[96:99], a[72:75], v[32:35]
ds_read_b64_tr_b16 a[34:35], v8 offset:1024
v_mfma_f32_16x16x32_bf16 v[40:43], a[96:99], a[76:79], v[40:43]
s_add_u32 s28, s28, s29
v_mfma_f32_16x16x32_bf16 v[48:51], a[96:99], a[80:83], v[48:51]
ds_read_b128 a[0:3], v6 offset:0
v_mfma_f32_16x16x32_bf16 v[56:59], a[96:99], a[84:87], v[56:59]
ds_read_b128 a[4:7], v6 offset:2048
s_add_u32 m0, s34, 4096
v_mfma_f32_16x16x32_bf16 v[64:67], a[96:99], a[88:91], v[64:67]
v_mfma_f32_16x16x32_bf16 v[72:75], a[96:99], a[92:95], v[72:75]
ds_read_b128 a[8:11], v6 offset:4096
buffer_load_dwordx4 v2, s[8:11], s28 offen lds
v_mfma_f32_16x16x32_bf16 v[20:23], a[100:103], a[64:67], v[20:23]
v_mfma_f32_16x16x32_bf16 v[28:31], a[100:103], a[68:71], v[28:31]
ds_read_b128 a[12:15], v6 offset:6144
s_add_u32 s28, s28, s29
v_mfma_f32_16x16x32_bf16 v[36:39], a[100:103], a[72:75], v[36:39]
ds_read_b128 a[16:19], v6 offset:8192
s_add_u32 m0, s34, 8192
v_mfma_f32_16x16x32_bf16 v[44:47], a[100:103], a[76:79], v[44:47]
v_mfma_f32_16x16x32_bf16 v[52:55], a[100:103], a[80:83], v[52:55]
ds_read_b128 a[20:23], v6 offset:10240
buffer_load_dwordx4 v2, s[8:11], s28 offen lds
v_mfma_f32_16x16x32_bf16 v[60:63], a[100:103], a[84:87], v[60:63]
v_mfma_f32_16x16x32_bf16 v[68:71], a[100:103], a[88:91], v[68:71]
ds_read_b128 a[24:27], v6 offset:12288
s_add_u32 s28, s28, s29
v_mfma_f32_16x16x32_bf16 v[76:79], a[100:103], a[92:95], v[76:79]
ds_read_b128 a[28:31], v6 offset:14336
v_mfma_f32_16x16x32_bf16 v[80:83], a[104:107], a[64:67], v[80:83]
s_add_u32 m0, s34, 12288
v_mfma_f32_16x16x32_bf16 v[88:91], a[104:107], a[68:71], v[88:91]
ds_read_b64_tr_b16 a[36:37], v9 offset:0
v_mfma_f32_16x16x32_bf16 v[96:99], a[104:107], a[72:75], v[96:99]
ds_read_b64_tr_b16 a[38:39], v9 offset:1024
buffer_load_dwordx4 v2, s[8:11], s28 offen lds
v_mfma_f32_16x16x32_bf16 v[104:107], a[104:107], a[76:79], v[104:107]
s_add_u32 s28, s28, s29
v_mfma_f32_16x16x32_bf16 v[112:115], a[104:107], a[80:83], v[112:115]
ds_read_b64_tr_b16 a[40:41], v10 offset:0
v_mfma_f32_16x16x32_bf16 v[120:123], a[104:107], a[84:87], v[120:123]
s_add_u32 m0, s43, 49152
v_mfma_f32_16x16x32_bf16 v[128:131], a[104:107], a[88:91], v[128:131]
ds_read_b64_tr_b16 a[42:43], v10 offset:1024
v_mfma_f32_16x16x32_bf16 v[136:139], a[104:107], a[92:95], v[136:139]
ds_read_b64_tr_b16 a[44:45], v11 offset:0
buffer_load_dwordx4 v3, s[12:15], s31 offen lds
v_mfma_f32_16x16x32_bf16 v[84:87], a[108:111], a[64:67], v[84:87]
v_mfma_f32_16x16x32_bf16 v[92:95], a[108:111], a[68:71], v[92:95]
ds_read_b64_tr_b16 a[46:47], v11 offset:1024
s_add_u32 s31, s31, s32
v_mfma_f32_16x16x32_bf16 v[100:103], a[108:111], a[72:75], v[100:103]
v_mfma_f32_16x16x32_bf16 v[108:111], a[108:111], a[76:79], v[108:111]
ds_read_b64_tr_b16 a[48:49], v8 offset:8192
s_add_u32 m0, s43, 50176
v_mfma_f32_16x16x32_bf16 v[116:119], a[108:111], a[80:83], v[116:119]
ds_read_b64_tr_b16 a[50:51], v8 offset:9216
buffer_load_dwordx4 v3, s[12:15], s31 offen lds
v_mfma_f32_16x16x32_bf16 v[124:127], a[108:111], a[84:87], v[124:127]
v_mfma_f32_16x16x32_bf16 v[132:135], a[108:111], a[88:91], v[132:135]
ds_read_b64_tr_b16 a[52:53], v9 offset:8192
s_add_u32 s31, s31, s33
v_mfma_f32_16x16x32_bf16 v[140:143], a[108:111], a[92:95], v[140:143]
ds_read_b64_tr_b16 a[54:55], v9 offset:9216
v_mfma_f32_16x16x32_bf16 v[144:147], a[112:115], a[64:67], v[144:147]
s_add_u32 m0, s43, 53248
v_mfma_f32_16x16x32_bf16 v[152:155], a[112:115], a[68:71], v[152:155]
ds_read_b64_tr_b16 a[56:57], v10 offset:8192
v_mfma_f32_16x16x32_bf16 v[160:163], a[112:115], a[72:75], v[160:163]
buffer_load_dwordx4 v3, s[12:15], s31 offen lds
v_mfma_f32_16x16x32_bf16 v[168:171], a[112:115], a[76:79], v[168:171]
ds_read_b64_tr_b16 a[58:59], v10 offset:9216
v_mfma_f32_16x16x32_bf16 v[176:179], a[112:115], a[80:83], v[176:179]
ds_read_b64_tr_b16 a[60:61], v11 offset:8192
s_add_u32 s31, s31, s32
v_mfma_f32_16x16x32_bf16 v[184:187], a[112:115], a[84:87], v[184:187]
s_add_u32 m0, s43, 54272
v_mfma_f32_16x16x32_bf16 v[192:195], a[112:115], a[88:91], v[192:195]
ds_read_b64_tr_b16 a[62:63], v11 offset:9216
v_mfma_f32_16x16x32_bf16 v[200:203], a[112:115], a[92:95], v[200:203]
buffer_load_dwordx4 v3, s[12:15], s31 offen lds
v_mfma_f32_16x16x32_bf16 v[148:151], a[116:119], a[64:67], v[148:151]
v_mfma_f32_16x16x32_bf16 v[156:159], a[116:119], a[68:71], v[156:159]
s_add_u32 s31, s31, s33
v_mfma_f32_16x16x32_bf16 v[164:167], a[116:119], a[72:75], v[164:167]
v_mfma_f32_16x16x32_bf16 v[172:175], a[116:119], a[76:79], v[172:175]
s_add_u32 s37, s37, 32768
v_mfma_f32_16x16x32_bf16 v[180:183], a[116:119], a[80:83], v[180:183]
v_mfma_f32_16x16x32_bf16 v[188:191], a[116:119], a[84:87], v[188:191]
s_cmp_ge_u32 s37, s42
v_mfma_f32_16x16x32_bf16 v[196:199], a[116:119], a[88:91], v[196:199]
s_cselect_b32 s37, s41, s37
v_mfma_f32_16x16x32_bf16 v[204:207], a[116:119], a[92:95], v[204:207]
v_mfma_f32_16x16x32_bf16 v[208:211], a[120:123], a[64:67], v[208:211]
s_add_u32 s40, s44, 16384
v_mfma_f32_16x16x32_bf16 v[216:219], a[120:123], a[68:71], v[216:219]
v_mfma_f32_16x16x32_bf16 v[224:227], a[120:123], a[72:75], v[224:227]
buffer_store_dwordx4 a[176:179], v12, s[4:7], s40 offen sc1
v_mfma_f32_16x16x32_bf16 v[232:235], a[120:123], a[76:79], v[232:235]
v_mfma_f32_16x16x32_bf16 v[240:243], a[120:123], a[80:83], v[240:243]
s_add_u32 s40, s44, 17408
v_mfma_f32_16x16x32_bf16 v[248:251], a[120:123], a[84:87], v[248:251]
v_mfma_f32_16x16x32_bf16 a[128:131], a[120:123], a[88:91], a[128:131]
buffer_store_dwordx4 a[180:183], v12, s[4:7], s40 offen sc1
v_mfma_f32_16x16x32_bf16 a[136:139], a[120:123], a[92:95], a[136:139]
s_add_u32 s40, s44, 20480
v_mfma_f32_16x16x32_bf16 v[212:215], a[124:127], a[64:67], v[212:215]
v_mfma_f32_16x16x32_bf16 v[220:223], a[124:127], a[68:71], v[220:223]
buffer_store_dwordx4 a[184:187], v12, s[4:7], s40 offen sc1
v_mfma_f32_16x16x32_bf16 v[228:231], a[124:127], a[72:75], v[228:231]
v_mfma_f32_16x16x32_bf16 v[236:239], a[124:127], a[76:79], v[236:239]
s_add_u32 s40, s44, 21504
v_mfma_f32_16x16x32_bf16 v[244:247], a[124:127], a[80:83], v[244:247]
v_mfma_f32_16x16x32_bf16 v[252:255], a[124:127], a[84:87], v[252:255]
buffer_store_dwordx4 a[188:191], v12, s[4:7], s40 offen sc1
v_mfma_f32_16x16x32_bf16 a[132:135], a[124:127], a[88:91], a[132:135]
v_mfma_f32_16x16x32_bf16 a[140:143], a[124:127], a[92:95], a[140:143]
s_waitcnt vmcnt(28) lgkmcnt(0)
s_barrier
v_mfma_f32_16x16x32_bf16 v[16:19], a[32:35], a[0:3], v[16:19]
v_add_u32 v7, s38, v5
s_add_u32 m0, s34, 16384
v_mfma_f32_16x16x32_bf16 v[24:27], a[32:35], a[4:7], v[24:27]
ds_read_b64_tr_b16 a[96:97], v8 offset:16384
buffer_load_dwordx4 v2, s[8:11], s28 offen lds
v_mfma_f32_16x16x32_bf16 v[32:35], a[32:35], a[8:11], v[32:35]
ds_read_b64_tr_b16 a[98:99], v8 offset:17408
v_mfma_f32_16x16x32_bf16 v[40:43], a[32:35], a[12:15], v[40:43]
s_add_u32 s28, s28, s29
v_mfma_f32_16x16x32_bf16 v[48:51], a[32:35], a[16:19], v[48:51]
ds_read_b128 a[64:67], v7 offset:0
s_add_u32 m0, s34, 20480
v_mfma_f32_16x16x32_bf16 v[56:59], a[32:35], a[20:23], v[56:59]
ds_read_b128 a[68:71], v7 offset:2048
v_mfma_f32_16x16x32_bf16 v[64:67], a[32:35], a[24:27], v[64:67]
buffer_load_dwordx4 v2, s[8:11], s28 offen lds
v_mfma_f32_16x16x32_bf16 v[72:75], a[32:35], a[28:31], v[72:75]
ds_read_b128 a[72:75], v7 offset:4096
v_mfma_f32_16x16x32_bf16 v[20:23], a[36:39], a[0:3], v[20:23]
s_add_u32 s28, s28, s29
v_mfma_f32_16x16x32_bf16 v[28:31], a[36:39], a[4:7], v[28:31]
ds_read_b128 a[76:79], v7 offset:6144
s_add_u32 m0, s34, 24576
v_mfma_f32_16x16x32_bf16 v[36:39], a[36:39], a[8:11], v[36:39]
ds_read_b128 a[80:83], v7 offset:8192
v_mfma_f32_16x16x32_bf16 v[44:47], a[36:39], a[12:15], v[44:47]
buffer_load_dwordx4 v2, s[8:11], s28 offen lds
v_mfma_f32_16x16x32_bf16 v[52:55], a[36:39], a[16:19], v[52:55]
ds_read_b128 a[84:87], v7 offset:10240
v_mfma_f32_16x16x32_bf16 v[60:63], a[36:39], a[20:23], v[60:63]
s_add_u32 s28, s28, s29
v_mfma_f32_16x16x32_bf16 v[68:71], a[36:39], a[24:27], v[68:71]
ds_read_b128 a[88:91], v7 offset:12288
s_add_u32 m0, s34, 28672
v_mfma_f32_16x16x32_bf16 v[76:79], a[36:39], a[28:31], v[76:79]
ds_read_b128 a[92:95], v7 offset:14336
v_mfma_f32_16x16x32_bf16 v[80:83], a[40:43], a[0:3], v[80:83]
buffer_load_dwordx4 v2, s[8:11], s28 offen lds
v_mfma_f32_16x16x32_bf16 v[88:91], a[40:43], a[4:7], v[88:91]
ds_read_b64_tr_b16 a[100:101], v9 offset:16384
v_mfma_f32_16x16x32_bf16 v[96:99], a[40:43], a[8:11], v[96:99]
ds_read_b64_tr_b16 a[102:103], v9 offset:17408
s_add_u32 s28, s28, s30
v_mfma_f32_16x16x32_bf16 v[104:107], a[40:43], a[12:15], v[104:107]
s_add_u32 s34, s34, 32768
v_mfma_f32_16x16x32_bf16 v[112:115], a[40:43], a[16:19], v[112:115]
ds_read_b64_tr_b16 a[104:105], v10 offset:16384
v_mfma_f32_16x16x32_bf16 v[120:123], a[40:43], a[20:23], v[120:123]
s_cmp_ge_u32 s34, s36
v_mfma_f32_16x16x32_bf16 v[128:131], a[40:43], a[24:27], v[128:131]
ds_read_b64_tr_b16 a[106:107], v10 offset:17408
v_mfma_f32_16x16x32_bf16 v[136:139], a[40:43], a[28:31], v[136:139]
ds_read_b64_tr_b16 a[108:109], v11 offset:16384
s_cselect_b32 s34, s35, s34
v_mfma_f32_16x16x32_bf16 v[84:87], a[44:47], a[0:3], v[84:87]
s_add_u32 m0, s43, 0
v_mfma_f32_16x16x32_bf16 v[92:95], a[44:47], a[4:7], v[92:95]
ds_read_b64_tr_b16 a[110:111], v11 offset:17408
v_mfma_f32_16x16x32_bf16 v[100:103], a[44:47], a[8:11], v[100:103]
buffer_load_dwordx4 v3, s[12:15], s31 offen lds
v_mfma_f32_16x16x32_bf16 v[108:111], a[44:47], a[12:15], v[108:111]
ds_read_b64_tr_b16 a[112:113], v8 offset:24576
v_mfma_f32_16x16x32_bf16 v[116:119], a[44:47], a[16:19], v[116:119]
ds_read_b64_tr_b16 a[114:115], v8 offset:25600
s_add_u32 s31, s31, s32
v_mfma_f32_16x16x32_bf16 v[124:127], a[44:47], a[20:23], v[124:127]
s_add_u32 m0, s43, 1024
v_mfma_f32_16x16x32_bf16 v[132:135], a[44:47], a[24:27], v[132:135]
ds_read_b64_tr_b16 a[116:117], v9 offset:24576
v_mfma_f32_16x16x32_bf16 v[140:143], a[44:47], a[28:31], v[140:143]
ds_read_b64_tr_b16 a[118:119], v9 offset:25600
buffer_load_dwordx4 v3, s[12:15], s31 offen lds
v_mfma_f32_16x16x32_bf16 v[144:147], a[48:51], a[0:3], v[144:147]
v_mfma_f32_16x16x32_bf16 v[152:155], a[48:51], a[4:7], v[152:155]
ds_read_b64_tr_b16 a[120:121], v10 offset:24576
s_add_u32 s31, s31, s33
v_mfma_f32_16x16x32_bf16 v[160:163], a[48:51], a[8:11], v[160:163]
s_add_u32 m0, s43, 4096
v_mfma_f32_16x16x32_bf16 v[168:171], a[48:51], a[12:15], v[168:171]
ds_read_b64_tr_b16 a[122:123], v10 offset:25600
v_mfma_f32_16x16x32_bf16 v[176:179], a[48:51], a[16:19], v[176:179]
ds_read_b64_tr_b16 a[124:125], v11 offset:24576
buffer_load_dwordx4 v3, s[12:15], s31 offen lds
v_mfma_f32_16x16x32_bf16 v[184:187], a[48:51], a[20:23], v[184:187]
v_mfma_f32_16x16x32_bf16 v[192:195], a[48:51], a[24:27], v[192:195]
ds_read_b64_tr_b16 a[126:127], v11 offset:25600
s_add_u32 s31, s31, s32
v_mfma_f32_16x16x32_bf16 v[200:203], a[48:51], a[28:31], v[200:203]
s_add_u32 m0, s43, 5120
v_mfma_f32_16x16x32_bf16 v[148:151], a[52:55], a[0:3], v[148:151]
v_mfma_f32_16x16x32_bf16 v[156:159], a[52:55], a[4:7], v[156:159]
buffer_load_dwordx4 v3, s[12:15], s31 offen lds
v_mfma_f32_16x16x32_bf16 v[164:167], a[52:55], a[8:11], v[164:167]
v_mfma_f32_16x16x32_bf16 v[172:175], a[52:55], a[12:15], v[172:175]
s_add_u32 s31, s31, s33
v_mfma_f32_16x16x32_bf16 v[180:183], a[52:55], a[16:19], v[180:183]
s_add_u32 s38, s38, 32768
v_mfma_f32_16x16x32_bf16 v[188:191], a[52:55], a[20:23], v[188:191]
v_mfma_f32_16x16x32_bf16 v[196:199], a[52:55], a[24:27], v[196:199]
s_cmp_ge_u32 s38, s42
v_mfma_f32_16x16x32_bf16 v[204:207], a[52:55], a[28:31], v[204:207]
v_mfma_f32_16x16x32_bf16 v[208:211], a[56:59], a[0:3], v[208:211]
s_cselect_b32 s38, s41, s38
v_mfma_f32_16x16x32_bf16 v[216:219], a[56:59], a[4:7], v[216:219]
s_add_u32 s40, s44, 24576
v_mfma_f32_16x16x32_bf16 v[224:227], a[56:59], a[8:11], v[224:227]
v_mfma_f32_16x16x32_bf16 v[232:235], a[56:59], a[12:15], v[232:235]
buffer_store_dwordx4 a[192:195], v12, s[4:7], s40 offen sc1
v_mfma_f32_16x16x32_bf16 v[240:243], a[56:59], a[16:19], v[240:243]
v_mfma_f32_16x16x32_bf16 v[248:251], a[56:59], a[20:23], v[248:251]
s_add_u32 s40, s44, 25600
v_mfma_f32_16x16x32_bf16 a[128:131], a[56:59], a[24:27], a[128:131]
buffer_store_dwordx4 a[196:199], v12, s[4:7], s40 offen sc1
v_mfma_f32_16x16x32_bf16 a[136:139], a[56:59], a[28:31], a[136:139]
v_mfma_f32_16x16x32_bf16 v[212:215], a[60:63], a[0:3], v[212:215]
s_add_u32 s40, s44, 28672
v_mfma_f32_16x16x32_bf16 v[220:223], a[60:63], a[4:7], v[220:223]
v_mfma_f32_16x16x32_bf16 v[228:231], a[60:63], a[8:11], v[228:231]
buffer_store_dwordx4 a[200:203], v12, s[4:7], s40 offen sc1
v_mfma_f32_16x16x32_bf16 v[236:239], a[60:63], a[12:15], v[236:239]
s_add_u32 s40, s44, 29696
v_mfma_f32_16x16x32_bf16 v[244:247], a[60:63], a[16:19], v[244:247]
v_mfma_f32_16x16x32_bf16 v[252:255], a[60:63], a[20:23], v[252:255]
buffer_store_dwordx4 a[204:207], v12, s[4:7], s40 offen sc1
v_mfma_f32_16x16x32_bf16 a[132:135], a[60:63], a[24:27], a[132:135]
v_mfma_f32_16x16x32_bf16 a[140:143], a[60:63], a[28:31], a[140:143]
s_waitcnt vmcnt(28) lgkmcnt(0)
s_barrier
v_mfma_f32_16x16x32_bf16 v[16:19], a[96:99], a[64:67], v[16:19]
v_add_u32 v6, s37, v4
s_add_u32 m0, s34, 0
v_mfma_f32_16x16x32_bf16 v[24:27], a[96:99], a[68:71], v[24:27]
ds_read_b64_tr_b16 a[32:33], v8 offset:32768
buffer_load_dwordx4 v2, s[8:11], s28 offen lds
v_mfma_f32_16x16x32_bf16 v[32:35], a[96:99], a[72:75], v[32:35]
ds_read_b64_tr_b16 a[34:35], v8 offset:33792
v_mfma_f32_16x16x32_bf16 v[40:43], a[96:99], a[76:79], v[40:43]
s_add_u32 s28, s28, s29
v_mfma_f32_16x16x32_bf16 v[48:51], a[96:99], a[80:83], v[48:51]
ds_read_b128 a[0:3], v6 offset:0
v_mfma_f32_16x16x32_bf16 v[56:59], a[96:99], a[84:87], v[56:59]
ds_read_b128 a[4:7], v6 offset:2048
s_add_u32 m0, s34, 4096
v_mfma_f32_16x16x32_bf16 v[64:67], a[96:99], a[88:91], v[64:67]
v_mfma_f32_16x16x32_bf16 v[72:75], a[96:99], a[92:95], v[72:75]
ds_read_b128 a[8:11], v6 offset:4096
buffer_load_dwordx4 v2, s[8:11], s28 offen lds
v_mfma_f32_16x16x32_bf16 v[20:23], a[100:103], a[64:67], v[20:23]
v_mfma_f32_16x16x32_bf16 v[28:31], a[100:103], a[68:71], v[28:31]
ds_read_b128 a[12:15], v6 offset:6144
s_add_u32 s28, s28, s29
v_mfma_f32_16x16x32_bf16 v[36:39], a[100:103], a[72:75], v[36:39]
ds_read_b128 a[16:19], v6 offset:8192
s_add_u32 m0, s34, 8192
v_mfma_f32_16x16x32_bf16 v[44:47], a[100:103], a[76:79], v[44:47]
v_mfma_f32_16x16x32_bf16 v[52:55], a[100:103], a[80:83], v[52:55]
ds_read_b128 a[20:23], v6 offset:10240
buffer_load_dwordx4 v2, s[8:11], s28 offen lds
v_mfma_f32_16x16x32_bf16 v[60:63], a[100:103], a[84:87], v[60:63]
v_mfma_f32_16x16x32_bf16 v[68:71], a[100:103], a[88:91], v[68:71]
ds_read_b128 a[24:27], v6 offset:12288
s_add_u32 s28, s28, s29
v_mfma_f32_16x16x32_bf16 v[76:79], a[100:103], a[92:95], v[76:79]
ds_read_b128 a[28:31], v6 offset:14336
v_mfma_f32_16x16x32_bf16 v[80:83], a[104:107], a[64:67], v[80:83]
s_add_u32 m0, s34, 12288
v_mfma_f32_16x16x32_bf16 v[88:91], a[104:107], a[68:71], v[88:91]
ds_read_b64_tr_b16 a[36:37], v9 offset:32768
v_mfma_f32_16x16x32_bf16 v[96:99], a[104:107], a[72:75], v[96:99]
ds_read_b64_tr_b16 a[38:39], v9 offset:33792
buffer_load_dwordx4 v2, s[8:11], s28 offen lds
v_mfma_f32_16x16x32_bf16 v[104:107], a[104:107], a[76:79], v[104:107]
s_add_u32 s28, s28, s29
v_mfma_f32_16x16x32_bf16 v[112:115], a[104:107], a[80:83], v[112:115]
ds_read_b64_tr_b16 a[40:41], v10 offset:32768
v_mfma_f32_16x16x32_bf16 v[120:123], a[104:107], a[84:87], v[120:123]
s_add_u32 m0, s43, 16384
v_mfma_f32_16x16x32_bf16 v[128:131], a[104:107], a[88:91], v[128:131]
ds_read_b64_tr_b16 a[42:43], v10 offset:33792
v_mfma_f32_16x16x32_bf16 v[136:139], a[104:107], a[92:95], v[136:139]
ds_read_b64_tr_b16 a[44:45], v11 offset:32768
buffer_load_dwordx4 v3, s[12:15], s31 offen lds
v_mfma_f32_16x16x32_bf16 v[84:87], a[108:111], a[64:67], v[84:87]
v_mfma_f32_16x16x32_bf16 v[92:95], a[108:111], a[68:71], v[92:95]
ds_read_b64_tr_b16 a[46:47], v11 offset:33792
s_add_u32 s31, s31, s32
v_mfma_f32_16x16x32_bf16 v[100:103], a[108:111], a[72:75], v[100:103]
v_mfma_f32_16x16x32_bf16 v[108:111], a[108:111], a[76:79], v[108:111]
ds_read_b64_tr_b16 a[48:49], v8 offset:40960
s_add_u32 m0, s43, 17408
v_mfma_f32_16x16x32_bf16 v[116:119], a[108:111], a[80:83], v[116:119]
ds_read_b64_tr_b16 a[50:51], v8 offset:41984
buffer_load_dwordx4 v3, s[12:15], s31 offen lds
v_mfma_f32_16x16x32_bf16 v[124:127], a[108:111], a[84:87], v[124:127]
v_mfma_f32_16x16x32_bf16 v[132:135], a[108:111], a[88:91], v[132:135]
ds_read_b64_tr_b16 a[52:53], v9 offset:40960
s_add_u32 s31, s31, s33
v_mfma_f32_16x16x32_bf16 v[140:143], a[108:111], a[92:95], v[140:143]
ds_read_b64_tr_b16 a[54:55], v9 offset:41984
v_mfma_f32_16x16x32_bf16 v[144:147], a[112:115], a[64:67], v[144:147]
s_add_u32 m0, s43, 20480
v_mfma_f32_16x16x32_bf16 v[152:155], a[112:115], a[68:71], v[152:155]
ds_read_b64_tr_b16 a[56:57], v10 offset:40960
v_mfma_f32_16x16x32_bf16 v[160:163], a[112:115], a[72:75], v[160:163]
buffer_load_dwordx4 v3, s[12:15], s31 offen lds
v_mfma_f32_16x16x32_bf16 v[168:171], a[112:115], a[76:79], v[168:171]
ds_read_b64_tr_b16 a[58:59], v10 offset:41984
v_mfma_f32_16x16x32_bf16 v[176:179], a[112:115], a[80:83], v[176:179]
ds_read_b64_tr_b16 a[60:61], v11 offset:40960
s_add_u32 s31, s31, s32
v_mfma_f32_16x16x32_bf16 v[184:187], a[112:115], a[84:87], v[184:187]
s_add_u32 m0, s43, 21504
v_mfma_f32_16x16x32_bf16 v[192:195], a[112:115], a[88:91], v[192:195]
ds_read_b64_tr_b16 a[62:63], v11 offset:41984
v_mfma_f32_16x16x32_bf16 v[200:203], a[112:115], a[92:95], v[200:203]
buffer_load_dwordx4 v3, s[12:15], s31 offen lds
v_mfma_f32_16x16x32_bf16 v[148:151], a[116:119], a[64:67], v[148:151]
v_mfma_f32_16x16x32_bf16 v[156:159], a[116:119], a[68:71], v[156:159]
s_add_u32 s31, s31, s33
v_mfma_f32_16x16x32_bf16 v[164:167], a[116:119], a[72:75], v[164:167]
v_mfma_f32_16x16x32_bf16 v[172:175], a[116:119], a[76:79], v[172:175]
s_add_u32 s37, s37, 32768
v_mfma_f32_16x16x32_bf16 v[180:183], a[116:119], a[80:83], v[180:183]
v_mfma_f32_16x16x32_bf16 v[188:191], a[116:119], a[84:87], v[188:191]
s_cmp_ge_u32 s37, s42
v_mfma_f32_16x16x32_bf16 v[196:199], a[116:119], a[88:91], v[196:199]
s_cselect_b32 s37, s41, s37
v_mfma_f32_16x16x32_bf16 v[204:207], a[116:119], a[92:95], v[204:207]
v_mfma_f32_16x16x32_bf16 v[208:211], a[120:123], a[64:67], v[208:211]
s_add_u32 s40, s44, 32768
v_mfma_f32_16x16x32_bf16 v[216:219], a[120:123], a[68:71], v[216:219]
v_mfma_f32_16x16x32_bf16 v[224:227], a[120:123], a[72:75], v[224:227]
buffer_store_dwordx4 a[208:211], v12, s[4:7], s40 offen sc1
v_mfma_f32_16x16x32_bf16 v[232:235], a[120:123], a[76:79], v[232:235]
v_mfma_f32_16x16x32_bf16 v[240:243], a[120:123], a[80:83], v[240:243]
s_add_u32 s40, s44, 33792
v_mfma_f32_16x16x32_bf16 v[248:251], a[120:123], a[84:87], v[248:251]
v_mfma_f32_16x16x32_bf16 a[128:131], a[120:123], a[88:91], a[128:131]
buffer_store_dwordx4 a[212:215], v12, s[4:7], s40 offen sc1
v_mfma_f32_16x16x32_bf16 a[136:139], a[120:123], a[92:95], a[136:139]
s_add_u32 s40, s44, 36864
v_mfma_f32_16x16x32_bf16 v[212:215], a[124:127], a[64:67], v[212:215]
v_mfma_f32_16x16x32_bf16 v[220:223], a[124:127], a[68:71], v[220:223]
buffer_store_dwordx4 a[216:219], v12, s[4:7], s40 offen sc1
v_mfma_f32_16x16x32_bf16 v[228:231], a[124:127], a[72:75], v[228:231]
v_mfma_f32_16x16x32_bf16 v[236:239], a[124:127], a[76:79], v[236:239]
s_add_u32 s40, s44, 37888
v_mfma_f32_16x16x32_bf16 v[244:247], a[124:127], a[80:83], v[244:247]
v_mfma_f32_16x16x32_bf16 v[252:255], a[124:127], a[84:87], v[252:255]
buffer_store_dwordx4 a[220:223], v12, s[4:7], s40 offen sc1
v_mfma_f32_16x16x32_bf16 a[132:135], a[124:127], a[88:91], a[132:135]
v_mfma_f32_16x16x32_bf16 a[140:143], a[124:127], a[92:95], a[140:143]
s_waitcnt vmcnt(28) lgkmcnt(0)
s_barrier
v_mfma_f32_16x16x32_bf16 v[16:19], a[32:35], a[0:3], v[16:19]
v_add_u32 v7, s38, v5
s_add_u32 m0, s34, 16384
v_mfma_f32_16x16x32_bf16 v[24:27], a[32:35], a[4:7], v[24:27]
ds_read_b64_tr_b16 a[96:97], v8 offset:49152
buffer_load_dwordx4 v2, s[8:11], s28 offen lds
v_mfma_f32_16x16x32_bf16 v[32:35], a[32:35], a[8:11], v[32:35]
ds_read_b64_tr_b16 a[98:99], v8 offset:50176
v_mfma_f32_16x16x32_bf16 v[40:43], a[32:35], a[12:15], v[40:43]
s_add_u32 s28, s28, s29
v_mfma_f32_16x16x32_bf16 v[48:51], a[32:35], a[16:19], v[48:51]
ds_read_b128 a[64:67], v7 offset:0
s_add_u32 m0, s34, 20480
v_mfma_f32_16x16x32_bf16 v[56:59], a[32:35], a[20:23], v[56:59]
ds_read_b128 a[68:71], v7 offset:2048
v_mfma_f32_16x16x32_bf16 v[64:67], a[32:35], a[24:27], v[64:67]
buffer_load_dwordx4 v2, s[8:11], s28 offen lds
v_mfma_f32_16x16x32_bf16 v[72:75], a[32:35], a[28:31], v[72:75]
ds_read_b128 a[72:75], v7 offset:4096
v_mfma_f32_16x16x32_bf16 v[20:23], a[36:39], a[0:3], v[20:23]
s_add_u32 s28, s28, s29
v_mfma_f32_16x16x32_bf16 v[28:31], a[36:39], a[4:7], v[28:31]
ds_read_b128 a[76:79], v7 offset:6144
s_add_u32 m0, s34, 24576
v_mfma_f32_16x16x32_bf16 v[36:39], a[36:39], a[8:11], v[36:39]
ds_read_b128 a[80:83], v7 offset:8192
v_mfma_f32_16x16x32_bf16 v[44:47], a[36:39], a[12:15], v[44:47]
buffer_load_dwordx4 v2, s[8:11], s28 offen lds
v_mfma_f32_16x16x32_bf16 v[52:55], a[36:39], a[16:19], v[52:55]
ds_read_b128 a[84:87], v7 offset:10240
v_mfma_f32_16x16x32_bf16 v[60:63], a[36:39], a[20:23], v[60:63]
s_add_u32 s28, s28, s29
v_mfma_f32_16x16x32_bf16 v[68:71], a[36:39], a[24:27], v[68:71]
ds_read_b128 a[88:91], v7 offset:12288
s_add_u32 m0, s34, 28672
v_mfma_f32_16x16x32_bf16 v[76:79], a[36:39], a[28:31], v[76:79]
ds_read_b128 a[92:95], v7 offset:14336
v_mfma_f32_16x16x32_bf16 v[80:83], a[40:43], a[0:3], v[80:83]
buffer_load_dwordx4 v2, s[8:11], s28 offen lds
v_mfma_f32_16x16x32_bf16 v[88:91], a[40:43], a[4:7], v[88:91]
ds_read_b64_tr_b16 a[100:101], v9 offset:49152
v_mfma_f32_16x16x32_bf16 v[96:99], a[40:43], a[8:11], v[96:99]
ds_read_b64_tr_b16 a[102:103], v9 offset:50176
s_add_u32 s28, s28, s30
v_mfma_f32_16x16x32_bf16 v[104:107], a[40:43], a[12:15], v[104:107]
s_add_u32 s34, s34, 32768
v_mfma_f32_16x16x32_bf16 v[112:115], a[40:43], a[16:19], v[112:115]
ds_read_b64_tr_b16 a[104:105], v10 offset:49152
v_mfma_f32_16x16x32_bf16 v[120:123], a[40:43], a[20:23], v[120:123]
s_cmp_ge_u32 s34, s36
v_mfma_f32_16x16x32_bf16 v[128:131], a[40:43], a[24:27], v[128:131]
ds_read_b64_tr_b16 a[106:107], v10 offset:50176
v_mfma_f32_16x16x32_bf16 v[136:139], a[40:43], a[28:31], v[136:139]
ds_read_b64_tr_b16 a[108:109], v11 offset:49152
s_cselect_b32 s34, s35, s34
v_mfma_f32_16x16x32_bf16 v[84:87], a[44:47], a[0:3], v[84:87]
s_add_u32 m0, s43, 32768
v_mfma_f32_16x16x32_bf16 v[92:95], a[44:47], a[4:7], v[92:95]
ds_read_b64_tr_b16 a[110:111], v11 offset:50176
v_mfma_f32_16x16x32_bf16 v[100:103], a[44:47], a[8:11], v[100:103]
buffer_load_dwordx4 v3, s[12:15], s31 offen lds
v_mfma_f32_16x16x32_bf16 v[108:111], a[44:47], a[12:15], v[108:111]
ds_read_b64_tr_b16 a[112:113], v8 offset:57344
v_mfma_f32_16x16x32_bf16 v[116:119], a[44:47], a[16:19], v[116:119]
ds_read_b64_tr_b16 a[114:115], v8 offset:58368
s_add_u32 s31, s31, s32
v_mfma_f32_16x16x32_bf16 v[124:127], a[44:47], a[20:23], v[124:127]
s_add_u32 m0, s43, 33792
v_mfma_f32_16x16x32_bf16 v[132:135], a[44:47], a[24:27], v[132:135]
ds_read_b64_tr_b16 a[116:117], v9 offset:57344
v_mfma_f32_16x16x32_bf16 v[140:143], a[44:47], a[28:31], v[140:143]
ds_read_b64_tr_b16 a[118:119], v9 offset:58368
buffer_load_dwordx4 v3, s[12:15], s31 offen lds
v_mfma_f32_16x16x32_bf16 v[144:147], a[48:51], a[0:3], v[144:147]
v_mfma_f32_16x16x32_bf16 v[152:155], a[48:51], a[4:7], v[152:155]
ds_read_b64_tr_b16 a[120:121], v10 offset:57344
s_add_u32 s31, s31, s33
v_mfma_f32_16x16x32_bf16 v[160:163], a[48:51], a[8:11], v[160:163]
s_add_u32 m0, s43, 36864
v_mfma_f32_16x16x32_bf16 v[168:171], a[48:51], a[12:15], v[168:171]
ds_read_b64_tr_b16 a[122:123], v10 offset:58368
v_mfma_f32_16x16x32_bf16 v[176:179], a[48:51], a[16:19], v[176:179]
ds_read_b64_tr_b16 a[124:125], v11 offset:57344
buffer_load_dwordx4 v3, s[12:15], s31 offen lds
v_mfma_f32_16x16x32_bf16 v[184:187], a[48:51], a[20:23], v[184:187]
v_mfma_f32_16x16x32_bf16 v[192:195], a[48:51], a[24:27], v[192:195]
ds_read_b64_tr_b16 a[126:127], v11 offset:58368
s_add_u32 s31, s31, s32
v_mfma_f32_16x16x32_bf16 v[200:203], a[48:51], a[28:31], v[200:203]
s_add_u32 m0, s43, 37888
v_mfma_f32_16x16x32_bf16 v[148:151], a[52:55], a[0:3], v[148:151]
v_mfma_f32_16x16x32_bf16 v[156:159], a[52:55], a[4:7], v[156:159]
buffer_load_dwordx4 v3, s[12:15], s31 offen lds
v_mfma_f32_16x16x32_bf16 v[164:167], a[52:55], a[8:11], v[164:167]
v_mfma_f32_16x16x32_bf16 v[172:175], a[52:55], a[12:15], v[172:175]
s_add_u32 s31, s31, s33
v_mfma_f32_16x16x32_bf16 v[180:183], a[52:55], a[16:19], v[180:183]
s_add_u32 s38, s38, 32768
v_mfma_f32_16x16x32_bf16 v[188:191], a[52:55], a[20:23], v[188:191]
v_mfma_f32_16x16x32_bf16 v[196:199], a[52:55], a[24:27], v[196:199]
s_cmp_ge_u32 s38, s42
v_mfma_f32_16x16x32_bf16 v[204:207], a[52:55], a[28:31], v[204:207]
v_mfma_f32_16x16x32_bf16 v[208:211], a[56:59], a[0:3], v[208:211]
s_cselect_b32 s38, s41, s38
v_mfma_f32_16x16x32_bf16 v[216:219], a[56:59], a[4:7], v[216:219]
s_add_u32 s40, s44, 40960
v_mfma_f32_16x16x32_bf16 v[224:227], a[56:59], a[8:11], v[224:227]
v_mfma_f32_16x16x32_bf16 v[232:235], a[56:59], a[12:15], v[232:235]
buffer_store_dwordx4 a[224:227], v12, s[4:7], s40 offen sc1
v_mfma_f32_16x16x32_bf16 v[240:243], a[56:59], a[16:19], v[240:243]
v_mfma_f32_16x16x32_bf16 v[248:251], a[56:59], a[20:23], v[248:251]
s_add_u32 s40, s44, 41984
v_mfma_f32_16x16x32_bf16 a[128:131], a[56:59], a[24:27], a[128:131]
buffer_store_dwordx4 a[228:231], v12, s[4:7], s40 offen sc1
v_mfma_f32_16x16x32_bf16 a[136:139], a[56:59], a[28:31], a[136:139]
v_mfma_f32_16x16x32_bf16 v[212:215], a[60:63], a[0:3], v[212:215]
s_add_u32 s40, s44, 45056
v_mfma_f32_16x16x32_bf16 v[220:223], a[60:63], a[4:7], v[220:223]
v_mfma_f32_16x16x32_bf16 v[228:231], a[60:63], a[8:11], v[228:231]
buffer_store_dwordx4 a[232:235], v12, s[4:7], s40 offen sc1
v_mfma_f32_16x16x32_bf16 v[236:239], a[60:63], a[12:15], v[236:239]
s_add_u32 s40, s44, 46080
v_mfma_f32_16x16x32_bf16 v[244:247], a[60:63], a[16:19], v[244:247]
v_mfma_f32_16x16x32_bf16 v[252:255], a[60:63], a[20:23], v[252:255]
buffer_store_dwordx4 a[236:239], v12, s[4:7], s40 offen sc1
v_mfma_f32_16x16x32_bf16 a[132:135], a[60:63], a[24:27], a[132:135]
v_mfma_f32_16x16x32_bf16 a[140:143], a[60:63], a[28:31], a[140:143]
s_waitcnt vmcnt(28) lgkmcnt(0)
s_barrier
v_mfma_f32_16x16x32_bf16 v[16:19], a[96:99], a[64:67], v[16:19]
v_add_u32 v6, s37, v4
s_add_u32 m0, s34, 0
v_mfma_f32_16x16x32_bf16 v[24:27], a[96:99], a[68:71], v[24:27]
ds_read_b64_tr_b16 a[32:33], v8 offset:0
buffer_load_dwordx4 v2, s[8:11], s28 offen lds
v_mfma_f32_16x16x32_bf16 v[32:35], a[96:99], a[72:75], v[32:35]
ds_read_b64_tr_b16 a[34:35], v8 offset:1024
v_mfma_f32_16x16x32_bf16 v[40:43], a[96:99], a[76:79], v[40:43]
s_add_u32 s28, s28, s29
v_mfma_f32_16x16x32_bf16 v[48:51], a[96:99], a[80:83], v[48:51]
ds_read_b128 a[0:3], v6 offset:0
v_mfma_f32_16x16x32_bf16 v[56:59], a[96:99], a[84:87], v[56:59]
ds_read_b128 a[4:7], v6 offset:2048
s_add_u32 m0, s34, 4096
v_mfma_f32_16x16x32_bf16 v[64:67], a[96:99], a[88:91], v[64:67]
v_mfma_f32_16x16x32_bf16 v[72:75], a[96:99], a[92:95], v[72:75]
ds_read_b128 a[8:11], v6 offset:4096
buffer_load_dwordx4 v2, s[8:11], s28 offen lds
v_mfma_f32_16x16x32_bf16 v[20:23], a[100:103], a[64:67], v[20:23]
v_mfma_f32_16x16x32_bf16 v[28:31], a[100:103], a[68:71], v[28:31]
ds_read_b128 a[12:15], v6 offset:6144
s_add_u32 s28, s28, s29
v_mfma_f32_16x16x32_bf16 v[36:39], a[100:103], a[72:75], v[36:39]
ds_read_b128 a[16:19], v6 offset:8192
s_add_u32 m0, s34, 8192
v_mfma_f32_16x16x32_bf16 v[44:47], a[100:103], a[76:79], v[44:47]
v_mfma_f32_16x16x32_bf16 v[52:55], a[100:103], a[80:83], v[52:55]
ds_read_b128 a[20:23], v6 offset:10240
buffer_load_dwordx4 v2, s[8:11], s28 offen lds
v_mfma_f32_16x16x32_bf16 v[60:63], a[100:103], a[84:87], v[60:63]
v_mfma_f32_16x16x32_bf16 v[68:71], a[100:103], a[88:91], v[68:71]
ds_read_b128 a[24:27], v6 offset:12288
s_add_u32 s28, s28, s29
v_mfma_f32_16x16x32_bf16 v[76:79], a[100:103], a[92:95], v[76:79]
ds_read_b128 a[28:31], v6 offset:14336
v_mfma_f32_16x16x32_bf16 v[80:83], a[104:107], a[64:67], v[80:83]
s_add_u32 m0, s34, 12288
v_mfma_f32_16x16x32_bf16 v[88:91], a[104:107], a[68:71], v[88:91]
ds_read_b64_tr_b16 a[36:37], v9 offset:0
v_mfma_f32_16x16x32_bf16 v[96:99], a[104:107], a[72:75], v[96:99]
ds_read_b64_tr_b16 a[38:39], v9 offset:1024
buffer_load_dwordx4 v2, s[8:11], s28 offen lds
v_mfma_f32_16x16x32_bf16 v[104:107], a[104:107], a[76:79], v[104:107]
s_add_u32 s28, s28, s29
v_mfma_f32_16x16x32_bf16 v[112:115], a[104:107], a[80:83], v[112:115]
ds_read_b64_tr_b16 a[40:41], v10 offset:0
v_mfma_f32_16x16x32_bf16 v[120:123], a[104:107], a[84:87], v[120:123]
s_add_u32 m0, s43, 49152
v_mfma_f32_16x16x32_bf16 v[128:131], a[104:107], a[88:91], v[128:131]
ds_read_b64_tr_b16 a[42:43], v10 offset:1024
v_mfma_f32_16x16x32_bf16 v[136:139], a[104:107], a[92:95], v[136:139]
ds_read_b64_tr_b16 a[44:45], v11 offset:0
buffer_load_dwordx4 v3, s[12:15], s31 offen lds
v_mfma_f32_16x16x32_bf16 v[84:87], a[108:111], a[64:67], v[84:87]
v_mfma_f32_16x16x32_bf16 v[92:95], a[108:111], a[68:71], v[92:95]
ds_read_b64_tr_b16 a[46:47], v11 offset:1024
s_add_u32 s31, s31, s32
v_mfma_f32_16x16x32_bf16 v[100:103], a[108:111], a[72:75], v[100:103]
v_mfma_f32_16x16x32_bf16 v[108:111], a[108:111], a[76:79], v[108:111]
ds_read_b64_tr_b16 a[48:49], v8 offset:8192
s_add_u32 m0, s43, 50176
v_mfma_f32_16x16x32_bf16 v[116:119], a[108:111], a[80:83], v[116:119]
ds_read_b64_tr_b16 a[50:51], v8 offset:9216
buffer_load_dwordx4 v3, s[12:15], s31 offen lds
v_mfma_f32_16x16x32_bf16 v[124:127], a[108:111], a[84:87], v[124:127]
v_mfma_f32_16x16x32_bf16 v[132:135], a[108:111], a[88:91], v[132:135]
ds_read_b64_tr_b16 a[52:53], v9 offset:8192
s_add_u32 s31, s31, s33
v_mfma_f32_16x16x32_bf16 v[140:143], a[108:111], a[92:95], v[140:143]
ds_read_b64_tr_b16 a[54:55], v9 offset:9216
v_mfma_f32_16x16x32_bf16 v[144:147], a[112:115], a[64:67], v[144:147]
s_add_u32 m0, s43, 53248
v_mfma_f32_16x16x32_bf16 v[152:155], a[112:115], a[68:71], v[152:155]
ds_read_b64_tr_b16 a[56:57], v10 offset:8192
v_mfma_f32_16x16x32_bf16 v[160:163], a[112:115], a[72:75], v[160:163]
buffer_load_dwordx4 v3, s[12:15], s31 offen lds
v_mfma_f32_16x16x32_bf16 v[168:171], a[112:115], a[76:79], v[168:171]
ds_read_b64_tr_b16 a[58:59], v10 offset:9216
v_mfma_f32_16x16x32_bf16 v[176:179], a[112:115], a[80:83], v[176:179]
ds_read_b64_tr_b16 a[60:61], v11 offset:8192
s_add_u32 s31, s31, s32
v_mfma_f32_16x16x32_bf16 v[184:187], a[112:115], a[84:87], v[184:187]
s_add_u32 m0, s43, 54272
v_mfma_f32_16x16x32_bf16 v[192:195], a[112:115], a[88:91], v[192:195]
ds_read_b64_tr_b16 a[62:63], v11 offset:9216
v_mfma_f32_16x16x32_bf16 v[200:203], a[112:115], a[92:95], v[200:203]
buffer_load_dwordx4 v3, s[12:15], s31 offen lds
v_mfma_f32_16x16x32_bf16 v[148:151], a[116:119], a[64:67], v[148:151]
v_mfma_f32_16x16x32_bf16 v[156:159], a[116:119], a[68:71], v[156:159]
s_add_u32 s31, s31, s33
v_mfma_f32_16x16x32_bf16 v[164:167], a[116:119], a[72:75], v[164:167]
v_mfma_f32_16x16x32_bf16 v[172:175], a[116:119], a[76:79], v[172:175]
s_add_u32 s37, s37, 32768
v_mfma_f32_16x16x32_bf16 v[180:183], a[116:119], a[80:83], v[180:183]
v_mfma_f32_16x16x32_bf16 v[188:191], a[116:119], a[84:87], v[188:191]
s_cmp_ge_u32 s37, s42
v_mfma_f32_16x16x32_bf16 v[196:199], a[116:119], a[88:91], v[196:199]
s_cselect_b32 s37, s41, s37
v_mfma_f32_16x16x32_bf16 v[204:207], a[116:119], a[92:95], v[204:207]
v_mfma_f32_16x16x32_bf16 v[208:211], a[120:123], a[64:67], v[208:211]
s_add_u32 s40, s44, 49152
v_mfma_f32_16x16x32_bf16 v[216:219], a[120:123], a[68:71], v[216:219]
v_mfma_f32_16x16x32_bf16 v[224:227], a[120:123], a[72:75], v[224:227]
buffer_store_dwordx4 a[240:243], v12, s[4:7], s40 offen sc1
v_mfma_f32_16x16x32_bf16 v[232:235], a[120:123], a[76:79], v[232:235]
v_mfma_f32_16x16x32_bf16 v[240:243], a[120:123], a[80:83], v[240:243]
s_add_u32 s40, s44, 50176
v_mfma_f32_16x16x32_bf16 v[248:251], a[120:123], a[84:87], v[248:251]
v_mfma_f32_16x16x32_bf16 a[128:131], a[120:123], a[88:91], a[128:131]
buffer_store_dwordx4 a[244:247], v12, s[4:7], s40 offen sc1
v_mfma_f32_16x16x32_bf16 a[136:139], a[120:123], a[92:95], a[136:139]
s_add_u32 s40, s44, 53248
v_mfma_f32_16x16x32_bf16 v[212:215], a[124:127], a[64:67], v[212:215]
v_mfma_f32_16x16x32_bf16 v[220:223], a[124:127], a[68:71], v[220:223]
buffer_store_dwordx4 a[248:251], v12, s[4:7], s40 offen sc1
v_mfma_f32_16x16x32_bf16 v[228:231], a[124:127], a[72:75], v[228:231]
v_mfma_f32_16x16x32_bf16 v[236:239], a[124:127], a[76:79], v[236:239]
s_add_u32 s40, s44, 54272
v_mfma_f32_16x16x32_bf16 v[244:247], a[124:127], a[80:83], v[244:247]
v_mfma_f32_16x16x32_bf16 v[252:255], a[124:127], a[84:87], v[252:255]
buffer_store_dwordx4 a[252:255], v12, s[4:7], s40 offen sc1
v_mfma_f32_16x16x32_bf16 a[132:135], a[124:127], a[88:91], a[132:135]
v_mfma_f32_16x16x32_bf16 a[140:143], a[124:127], a[92:95], a[140:143]
s_waitcnt vmcnt(28) lgkmcnt(0)
s_barrier
v_mfma_f32_16x16x32_bf16 v[16:19], a[32:35], a[0:3], v[16:19]
v_add_u32 v7, s38, v5
s_add_u32 m0, s34, 16384
v_mfma_f32_16x16x32_bf16 v[24:27], a[32:35], a[4:7], v[24:27]
ds_read_b64_tr_b16 a[96:97], v8 offset:16384
v_mfma_f32_16x16x32_bf16 v[32:35], a[32:35], a[8:11], v[32:35]
ds_read_b64_tr_b16 a[98:99], v8 offset:17408
buffer_load_dwordx4 v2, s[8:11], s28 offen lds
v_mfma_f32_16x16x32_bf16 v[40:43], a[32:35], a[12:15], v[40:43]
v_mfma_f32_16x16x32_bf16 v[48:51], a[32:35], a[16:19], v[48:51]
ds_read_b128 a[64:67], v7 offset:0
s_add_u32 s28, s28, s29
v_mfma_f32_16x16x32_bf16 v[56:59], a[32:35], a[20:23], v[56:59]
ds_read_b128 a[68:71], v7 offset:2048
v_mfma_f32_16x16x32_bf16 v[64:67], a[32:35], a[24:27], v[64:67]
s_add_u32 m0, s34, 20480
v_mfma_f32_16x16x32_bf16 v[72:75], a[32:35], a[28:31], v[72:75]
ds_read_b128 a[72:75], v7 offset:4096
v_mfma_f32_16x16x32_bf16 v[20:23], a[36:39], a[0:3], v[20:23]
buffer_load_dwordx4 v2, s[8:11], s28 offen lds
v_mfma_f32_16x16x32_bf16 v[28:31], a[36:39], a[4:7], v[28:31]
ds_read_b128 a[76:79], v7 offset:6144
v_mfma_f32_16x16x32_bf16 v[36:39], a[36:39], a[8:11], v[36:39]
ds_read_b128 a[80:83], v7 offset:8192
s_add_u32 s28, s28, s29
v_mfma_f32_16x16x32_bf16 v[44:47], a[36:39], a[12:15], v[44:47]
v_mfma_f32_16x16x32_bf16 v[52:55], a[36:39], a[16:19], v[52:55]
ds_read_b128 a[84:87], v7 offset:10240
s_add_u32 m0, s34, 24576
v_mfma_f32_16x16x32_bf16 v[60:63], a[36:39], a[20:23], v[60:63]
v_mfma_f32_16x16x32_bf16 v[68:71], a[36:39], a[24:27], v[68:71]
ds_read_b128 a[88:91], v7 offset:12288
buffer_load_dwordx4 v2, s[8:11], s28 offen lds
v_mfma_f32_16x16x32_bf16 v[76:79], a[36:39], a[28:31], v[76:79]
ds_read_b128 a[92:95], v7 offset:14336
v_mfma_f32_16x16x32_bf16 v[80:83], a[40:43], a[0:3], v[80:83]
s_add_u32 s28, s28, s29
v_mfma_f32_16x16x32_bf16 v[88:91], a[40:43], a[4:7], v[88:91]
ds_read_b64_tr_b16 a[100:101], v9 offset:16384
v_mfma_f32_16x16x32_bf16 v[96:99], a[40:43], a[8:11], v[96:99]
ds_read_b64_tr_b16 a[102:103], v9 offset:17408
s_add_u32 m0, s34, 28672
v_mfma_f32_16x16x32_bf16 v[104:107], a[40:43], a[12:15], v[104:107]
v_mfma_f32_16x16x32_bf16 v[112:115], a[40:43], a[16:19], v[112:115]
ds_read_b64_tr_b16 a[104:105], v10 offset:16384
v_mfma_f32_16x16x32_bf16 v[120:123], a[40:43], a[20:23], v[120:123]
buffer_load_dwordx4 v2, s[8:11], s28 offen lds
v_mfma_f32_16x16x32_bf16 v[128:131], a[40:43], a[24:27], v[128:131]
ds_read_b64_tr_b16 a[106:107], v10 offset:17408
v_mfma_f32_16x16x32_bf16 v[136:139], a[40:43], a[28:31], v[136:139]
ds_read_b64_tr_b16 a[108:109], v11 offset:16384
s_add_u32 s28, s28, s30
v_mfma_f32_16x16x32_bf16 v[84:87], a[44:47], a[0:3], v[84:87]
v_mfma_f32_16x16x32_bf16 v[92:95], a[44:47], a[4:7], v[92:95]
ds_read_b64_tr_b16 a[110:111], v11 offset:17408
s_add_u32 s34, s34, 32768
v_mfma_f32_16x16x32_bf16 v[100:103], a[44:47], a[8:11], v[100:103]
v_mfma_f32_16x16x32_bf16 v[108:111], a[44:47], a[12:15], v[108:111]
ds_read_b64_tr_b16 a[112:113], v8 offset:24576
s_cmp_ge_u32 s34, s36
v_mfma_f32_16x16x32_bf16 v[116:119], a[44:47], a[16:19], v[116:119]
ds_read_b64_tr_b16 a[114:115], v8 offset:25600
v_mfma_f32_16x16x32_bf16 v[124:127], a[44:47], a[20:23], v[124:127]
s_cselect_b32 s34, s35, s34
v_mfma_f32_16x16x32_bf16 v[132:135], a[44:47], a[24:27], v[132:135]
ds_read_b64_tr_b16 a[116:117], v9 offset:24576
v_mfma_f32_16x16x32_bf16 v[140:143], a[44:47], a[28:31], v[140:143]
ds_read_b64_tr_b16 a[118:119], v9 offset:25600
s_add_u32 m0, s43, 0
v_mfma_f32_16x16x32_bf16 v[144:147], a[48:51], a[0:3], v[144:147]
v_mfma_f32_16x16x32_bf16 v[152:155], a[48:51], a[4:7], v[152:155]
ds_read_b64_tr_b16 a[120:121], v10 offset:24576
buffer_load_dwordx4 v3, s[12:15], s31 offen lds
v_mfma_f32_16x16x32_bf16 v[160:163], a[48:51], a[8:11], v[160:163]
v_mfma_f32_16x16x32_bf16 v[168:171], a[48:51], a[12:15], v[168:171]
ds_read_b64_tr_b16 a[122:123], v10 offset:25600
s_add_u32 s31, s31, s32
v_mfma_f32_16x16x32_bf16 v[176:179], a[48:51], a[16:19], v[176:179]
ds_read_b64_tr_b16 a[124:125], v11 offset:24576
v_mfma_f32_16x16x32_bf16 v[184:187], a[48:51], a[20:23], v[184:187]
s_add_u32 m0, s43, 1024
v_mfma_f32_16x16x32_bf16 v[192:195], a[48:51], a[24:27], v[192:195]
ds_read_b64_tr_b16 a[126:127], v11 offset:25600
v_mfma_f32_16x16x32_bf16 v[200:203], a[48:51], a[28:31], v[200:203]
buffer_load_dwordx4 v3, s[12:15], s31 offen lds
v_mfma_f32_16x16x32_bf16 v[148:151], a[52:55], a[0:3], v[148:151]
v_mfma_f32_16x16x32_bf16 v[156:159], a[52:55], a[4:7], v[156:159]
v_mfma_f32_16x16x32_bf16 v[164:167], a[52:55], a[8:11], v[164:167]
s_add_u32 s31, s31, s33
v_mfma_f32_16x16x32_bf16 v[172:175], a[52:55], a[12:15], v[172:175]
v_mfma_f32_16x16x32_bf16 v[180:183], a[52:55], a[16:19], v[180:183]
s_add_u32 m0, s43, 4096
v_mfma_f32_16x16x32_bf16 v[188:191], a[52:55], a[20:23], v[188:191]
v_mfma_f32_16x16x32_bf16 v[196:199], a[52:55], a[24:27], v[196:199]
buffer_load_dwordx4 v3, s[12:15], s31 offen lds
v_mfma_f32_16x16x32_bf16 v[204:207], a[52:55], a[28:31], v[204:207]
v_mfma_f32_16x16x32_bf16 v[208:211], a[56:59], a[0:3], v[208:211]
s_add_u32 s31, s31, s32
v_mfma_f32_16x16x32_bf16 v[216:219], a[56:59], a[4:7], v[216:219]
v_mfma_f32_16x16x32_bf16 v[224:227], a[56:59], a[8:11], v[224:227]
s_add_u32 m0, s43, 5120
v_mfma_f32_16x16x32_bf16 v[232:235], a[56:59], a[12:15], v[232:235]
v_mfma_f32_16x16x32_bf16 v[240:243], a[56:59], a[16:19], v[240:243]
buffer_load_dwordx4 v3, s[12:15], s31 offen lds
v_mfma_f32_16x16x32_bf16 v[248:251], a[56:59], a[20:23], v[248:251]
v_mfma_f32_16x16x32_bf16 a[128:131], a[56:59], a[24:27], a[128:131]
s_add_u32 s31, s31, s33
v_mfma_f32_16x16x32_bf16 a[136:139], a[56:59], a[28:31], a[136:139]
v_mfma_f32_16x16x32_bf16 v[212:215], a[60:63], a[0:3], v[212:215]
s_add_u32 s38, s38, 32768
v_mfma_f32_16x16x32_bf16 v[220:223], a[60:63], a[4:7], v[220:223]
v_mfma_f32_16x16x32_bf16 v[228:231], a[60:63], a[8:11], v[228:231]
s_cmp_ge_u32 s38, s42
v_mfma_f32_16x16x32_bf16 v[236:239], a[60:63], a[12:15], v[236:239]
v_mfma_f32_16x16x32_bf16 v[244:247], a[60:63], a[16:19], v[244:247]
s_cselect_b32 s38, s41, s38
v_mfma_f32_16x16x32_bf16 v[252:255], a[60:63], a[20:23], v[252:255]
v_mfma_f32_16x16x32_bf16 a[132:135], a[60:63], a[24:27], a[132:135]
v_mfma_f32_16x16x32_bf16 a[140:143], a[60:63], a[28:31], a[140:143]
s_waitcnt vmcnt(24) lgkmcnt(0)
s_barrier
v_mfma_f32_16x16x32_bf16 v[16:19], a[96:99], a[64:67], v[16:19]
v_add_u32 v6, s37, v4
s_add_u32 m0, s43, 16384
v_mfma_f32_16x16x32_bf16 v[24:27], a[96:99], a[68:71], v[24:27]
ds_read_b64_tr_b16 a[32:33], v8 offset:32768
v_mfma_f32_16x16x32_bf16 v[32:35], a[96:99], a[72:75], v[32:35]
ds_read_b64_tr_b16 a[34:35], v8 offset:33792
v_mfma_f32_16x16x32_bf16 v[40:43], a[96:99], a[76:79], v[40:43]
v_mfma_f32_16x16x32_bf16 v[48:51], a[96:99], a[80:83], v[48:51]
ds_read_b128 a[0:3], v6 offset:0
buffer_load_dwordx4 v3, s[12:15], s31 offen lds
v_mfma_f32_16x16x32_bf16 v[56:59], a[96:99], a[84:87], v[56:59]
ds_read_b128 a[4:7], v6 offset:2048
v_mfma_f32_16x16x32_bf16 v[64:67], a[96:99], a[88:91], v[64:67]
v_mfma_f32_16x16x32_bf16 v[72:75], a[96:99], a[92:95], v[72:75]
ds_read_b128 a[8:11], v6 offset:4096
v_mfma_f32_16x16x32_bf16 v[20:23], a[100:103], a[64:67], v[20:23]
s_add_u32 s31, s31, s32
v_mfma_f32_16x16x32_bf16 v[28:31], a[100:103], a[68:71], v[28:31]
ds_read_b128 a[12:15], v6 offset:6144
v_mfma_f32_16x16x32_bf16 v[36:39], a[100:103], a[72:75], v[36:39]
ds_read_b128 a[16:19], v6 offset:8192
v_mfma_f32_16x16x32_bf16 v[44:47], a[100:103], a[76:79], v[44:47]
v_mfma_f32_16x16x32_bf16 v[52:55], a[100:103], a[80:83], v[52:55]
ds_read_b128 a[20:23], v6 offset:10240
s_add_u32 m0, s43, 17408
v_mfma_f32_16x16x32_bf16 v[60:63], a[100:103], a[84:87], v[60:63]
v_mfma_f32_16x16x32_bf16 v[68:71], a[100:103], a[88:91], v[68:71]
ds_read_b128 a[24:27], v6 offset:12288
v_mfma_f32_16x16x32_bf16 v[76:79], a[100:103], a[92:95], v[76:79]
ds_read_b128 a[28:31], v6 offset:14336
v_mfma_f32_16x16x32_bf16 v[80:83], a[104:107], a[64:67], v[80:83]
buffer_load_dwordx4 v3, s[12:15], s31 offen lds
v_mfma_f32_16x16x32_bf16 v[88:91], a[104:107], a[68:71], v[88:91]
ds_read_b64_tr_b16 a[36:37], v9 offset:32768
v_mfma_f32_16x16x32_bf16 v[96:99], a[104:107], a[72:75], v[96:99]
ds_read_b64_tr_b16 a[38:39], v9 offset:33792
v_mfma_f32_16x16x32_bf16 v[104:107], a[104:107], a[76:79], v[104:107]
v_mfma_f32_16x16x32_bf16 v[112:115], a[104:107], a[80:83], v[112:115]
ds_read_b64_tr_b16 a[40:41], v10 offset:32768
v_mfma_f32_16x16x32_bf16 v[120:123], a[104:107], a[84:87], v[120:123]
s_add_u32 s31, s31, s33
v_mfma_f32_16x16x32_bf16 v[128:131], a[104:107], a[88:91], v[128:131]
ds_read_b64_tr_b16 a[42:43], v10 offset:33792
v_mfma_f32_16x16x32_bf16 v[136:139], a[104:107], a[92:95], v[136:139]
ds_read_b64_tr_b16 a[44:45], v11 offset:32768
v_mfma_f32_16x16x32_bf16 v[84:87], a[108:111], a[64:67], v[84:87]
v_mfma_f32_16x16x32_bf16 v[92:95], a[108:111], a[68:71], v[92:95]
ds_read_b64_tr_b16 a[46:47], v11 offset:33792
s_add_u32 m0, s43, 20480
v_mfma_f32_16x16x32_bf16 v[100:103], a[108:111], a[72:75], v[100:103]
v_mfma_f32_16x16x32_bf16 v[108:111], a[108:111], a[76:79], v[108:111]
ds_read_b64_tr_b16 a[48:49], v8 offset:40960
v_mfma_f32_16x16x32_bf16 v[116:119], a[108:111], a[80:83], v[116:119]
ds_read_b64_tr_b16 a[50:51], v8 offset:41984
v_mfma_f32_16x16x32_bf16 v[124:127], a[108:111], a[84:87], v[124:127]
buffer_load_dwordx4 v3, s[12:15], s31 offen lds
v_mfma_f32_16x16x32_bf16 v[132:135], a[108:111], a[88:91], v[132:135]
ds_read_b64_tr_b16 a[52:53], v9 offset:40960
v_mfma_f32_16x16x32_bf16 v[140:143], a[108:111], a[92:95], v[140:143]
ds_read_b64_tr_b16 a[54:55], v9 offset:41984
v_mfma_f32_16x16x32_bf16 v[144:147], a[112:115], a[64:67], v[144:147]
v_mfma_f32_16x16x32_bf16 v[152:155], a[112:115], a[68:71], v[152:155]
ds_read_b64_tr_b16 a[56:57], v10 offset:40960
s_add_u32 s31, s31, s32
v_mfma_f32_16x16x32_bf16 v[160:163], a[112:115], a[72:75], v[160:163]
v_mfma_f32_16x16x32_bf16 v[168:171], a[112:115], a[76:79], v[168:171]
ds_read_b64_tr_b16 a[58:59], v10 offset:41984
v_mfma_f32_16x16x32_bf16 v[176:179], a[112:115], a[80:83], v[176:179]
ds_read_b64_tr_b16 a[60:61], v11 offset:40960
v_mfma_f32_16x16x32_bf16 v[184:187], a[112:115], a[84:87], v[184:187]
s_add_u32 m0, s43, 21504
v_mfma_f32_16x16x32_bf16 v[192:195], a[112:115], a[88:91], v[192:195]
ds_read_b64_tr_b16 a[62:63], v11 offset:41984
v_mfma_f32_16x16x32_bf16 v[200:203], a[112:115], a[92:95], v[200:203]
v_mfma_f32_16x16x32_bf16 v[148:151], a[116:119], a[64:67], v[148:151]
v_mfma_f32_16x16x32_bf16 v[156:159], a[116:119], a[68:71], v[156:159]
v_mfma_f32_16x16x32_bf16 v[164:167], a[116:119], a[72:75], v[164:167]
buffer_load_dwordx4 v3, s[12:15], s31 offen lds
v_mfma_f32_16x16x32_bf16 v[172:175], a[116:119], a[76:79], v[172:175]
v_mfma_f32_16x16x32_bf16 v[180:183], a[116:119], a[80:83], v[180:183]
v_mfma_f32_16x16x32_bf16 v[188:191], a[116:119], a[84:87], v[188:191]
v_mfma_f32_16x16x32_bf16 v[196:199], a[116:119], a[88:91], v[196:199]
s_add_u32 s31, s31, s33
v_mfma_f32_16x16x32_bf16 v[204:207], a[116:119], a[92:95], v[204:207]
v_mfma_f32_16x16x32_bf16 v[208:211], a[120:123], a[64:67], v[208:211]
v_mfma_f32_16x16x32_bf16 v[216:219], a[120:123], a[68:71], v[216:219]
v_mfma_f32_16x16x32_bf16 v[224:227], a[120:123], a[72:75], v[224:227]
s_add_u32 s37, s37, 32768
v_mfma_f32_16x16x32_bf16 v[232:235], a[120:123], a[76:79], v[232:235]
v_mfma_f32_16x16x32_bf16 v[240:243], a[120:123], a[80:83], v[240:243]
v_mfma_f32_16x16x32_bf16 v[248:251], a[120:123], a[84:87], v[248:251]
v_mfma_f32_16x16x32_bf16 a[128:131], a[120:123], a[88:91], a[128:131]
s_cmp_ge_u32 s37, s42
v_mfma_f32_16x16x32_bf16 a[136:139], a[120:123], a[92:95], a[136:139]
v_mfma_f32_16x16x32_bf16 v[212:215], a[124:127], a[64:67], v[212:215]
v_mfma_f32_16x16x32_bf16 v[220:223], a[124:127], a[68:71], v[220:223]
v_mfma_f32_16x16x32_bf16 v[228:231], a[124:127], a[72:75], v[228:231]
s_cselect_b32 s37, s41, s37
v_mfma_f32_16x16x32_bf16 v[236:239], a[124:127], a[76:79], v[236:239]
v_mfma_f32_16x16x32_bf16 v[244:247], a[124:127], a[80:83], v[244:247]
v_mfma_f32_16x16x32_bf16 v[252:255], a[124:127], a[84:87], v[252:255]
v_mfma_f32_16x16x32_bf16 a[132:135], a[124:127], a[88:91], a[132:135]
v_mfma_f32_16x16x32_bf16 a[140:143], a[124:127], a[92:95], a[140:143]
s_waitcnt vmcnt(12) lgkmcnt(0)
s_barrier
s_add_u32 s62, s48, 0
s_cmp_lg_u32 s3, 0
s_cbranch_scc1 fused_kernel_kvlo_14
s_lshl_b32 s68, s62, 7
s_add_u32 s68, s68, 0x5b00000
v_mov_b32 v13, 1
v_mov_b32 v14, 0
s_mov_b64 s[70:71], exec
s_mov_b64 exec, 1
buffer_atomic_add v13, v14, s[4:7], s68 offen
s_mov_b64 exec, s[70:71]
fused_kernel_kvlo_14:
v_mfma_f32_16x16x32_bf16 v[16:19], a[32:35], a[0:3], v[16:19]
v_add_u32 v7, s38, v5
s_add_u32 s38, s38, 32768
v_mfma_f32_16x16x32_bf16 v[24:27], a[32:35], a[4:7], v[24:27]
ds_read_b64_tr_b16 a[96:97], v8 offset:49152
v_mfma_f32_16x16x32_bf16 v[32:35], a[32:35], a[8:11], v[32:35]
ds_read_b64_tr_b16 a[98:99], v8 offset:50176
v_mfma_f32_16x16x32_bf16 v[40:43], a[32:35], a[12:15], v[40:43]
v_mfma_f32_16x16x32_bf16 v[48:51], a[32:35], a[16:19], v[48:51]
ds_read_b128 a[64:67], v7 offset:0
v_mfma_f32_16x16x32_bf16 v[56:59], a[32:35], a[20:23], v[56:59]
ds_read_b128 a[68:71], v7 offset:2048
v_mfma_f32_16x16x32_bf16 v[64:67], a[32:35], a[24:27], v[64:67]
v_mfma_f32_16x16x32_bf16 v[72:75], a[32:35], a[28:31], v[72:75]
ds_read_b128 a[72:75], v7 offset:4096
v_mfma_f32_16x16x32_bf16 v[20:23], a[36:39], a[0:3], v[20:23]
v_mfma_f32_16x16x32_bf16 v[28:31], a[36:39], a[4:7], v[28:31]
ds_read_b128 a[76:79], v7 offset:6144
v_mfma_f32_16x16x32_bf16 v[36:39], a[36:39], a[8:11], v[36:39]
ds_read_b128 a[80:83], v7 offset:8192
v_mfma_f32_16x16x32_bf16 v[44:47], a[36:39], a[12:15], v[44:47]
v_mfma_f32_16x16x32_bf16 v[52:55], a[36:39], a[16:19], v[52:55]
ds_read_b128 a[84:87], v7 offset:10240
v_mfma_f32_16x16x32_bf16 v[60:63], a[36:39], a[20:23], v[60:63]
v_mfma_f32_16x16x32_bf16 v[68:71], a[36:39], a[24:27], v[68:71]
ds_read_b128 a[88:91], v7 offset:12288
v_mfma_f32_16x16x32_bf16 v[76:79], a[36:39], a[28:31], v[76:79]
ds_read_b128 a[92:95], v7 offset:14336
v_mfma_f32_16x16x32_bf16 v[80:83], a[40:43], a[0:3], v[80:83]
v_mfma_f32_16x16x32_bf16 v[88:91], a[40:43], a[4:7], v[88:91]
ds_read_b64_tr_b16 a[100:101], v9 offset:49152
v_mfma_f32_16x16x32_bf16 v[96:99], a[40:43], a[8:11], v[96:99]
ds_read_b64_tr_b16 a[102:103], v9 offset:50176
v_mfma_f32_16x16x32_bf16 v[104:107], a[40:43], a[12:15], v[104:107]
v_mfma_f32_16x16x32_bf16 v[112:115], a[40:43], a[16:19], v[112:115]
ds_read_b64_tr_b16 a[104:105], v10 offset:49152
v_mfma_f32_16x16x32_bf16 v[120:123], a[40:43], a[20:23], v[120:123]
s_cmp_ge_u32 s38, s42
v_mfma_f32_16x16x32_bf16 v[128:131], a[40:43], a[24:27], v[128:131]
ds_read_b64_tr_b16 a[106:107], v10 offset:50176
v_mfma_f32_16x16x32_bf16 v[136:139], a[40:43], a[28:31], v[136:139]
ds_read_b64_tr_b16 a[108:109], v11 offset:49152
v_mfma_f32_16x16x32_bf16 v[84:87], a[44:47], a[0:3], v[84:87]
v_mfma_f32_16x16x32_bf16 v[92:95], a[44:47], a[4:7], v[92:95]
ds_read_b64_tr_b16 a[110:111], v11 offset:50176
v_mfma_f32_16x16x32_bf16 v[100:103], a[44:47], a[8:11], v[100:103]
v_mfma_f32_16x16x32_bf16 v[108:111], a[44:47], a[12:15], v[108:111]
ds_read_b64_tr_b16 a[112:113], v8 offset:57344
v_mfma_f32_16x16x32_bf16 v[116:119], a[44:47], a[16:19], v[116:119]
ds_read_b64_tr_b16 a[114:115], v8 offset:58368
v_mfma_f32_16x16x32_bf16 v[124:127], a[44:47], a[20:23], v[124:127]
v_mfma_f32_16x16x32_bf16 v[132:135], a[44:47], a[24:27], v[132:135]
ds_read_b64_tr_b16 a[116:117], v9 offset:57344
v_mfma_f32_16x16x32_bf16 v[140:143], a[44:47], a[28:31], v[140:143]
ds_read_b64_tr_b16 a[118:119], v9 offset:58368
v_mfma_f32_16x16x32_bf16 v[144:147], a[48:51], a[0:3], v[144:147]
v_mfma_f32_16x16x32_bf16 v[152:155], a[48:51], a[4:7], v[152:155]
ds_read_b64_tr_b16 a[120:121], v10 offset:57344
v_mfma_f32_16x16x32_bf16 v[160:163], a[48:51], a[8:11], v[160:163]
v_mfma_f32_16x16x32_bf16 v[168:171], a[48:51], a[12:15], v[168:171]
ds_read_b64_tr_b16 a[122:123], v10 offset:58368
v_mfma_f32_16x16x32_bf16 v[176:179], a[48:51], a[16:19], v[176:179]
ds_read_b64_tr_b16 a[124:125], v11 offset:57344
v_mfma_f32_16x16x32_bf16 v[184:187], a[48:51], a[20:23], v[184:187]
v_mfma_f32_16x16x32_bf16 v[192:195], a[48:51], a[24:27], v[192:195]
ds_read_b64_tr_b16 a[126:127], v11 offset:58368
v_mfma_f32_16x16x32_bf16 v[200:203], a[48:51], a[28:31], v[200:203]
v_mfma_f32_16x16x32_bf16 v[148:151], a[52:55], a[0:3], v[148:151]
v_mfma_f32_16x16x32_bf16 v[156:159], a[52:55], a[4:7], v[156:159]
v_mfma_f32_16x16x32_bf16 v[164:167], a[52:55], a[8:11], v[164:167]
s_cselect_b32 s38, s41, s38
v_mfma_f32_16x16x32_bf16 v[172:175], a[52:55], a[12:15], v[172:175]
v_mfma_f32_16x16x32_bf16 v[180:183], a[52:55], a[16:19], v[180:183]
v_mfma_f32_16x16x32_bf16 v[188:191], a[52:55], a[20:23], v[188:191]
v_mfma_f32_16x16x32_bf16 v[196:199], a[52:55], a[24:27], v[196:199]
v_mfma_f32_16x16x32_bf16 v[204:207], a[52:55], a[28:31], v[204:207]
v_mfma_f32_16x16x32_bf16 v[208:211], a[56:59], a[0:3], v[208:211]
v_mfma_f32_16x16x32_bf16 v[216:219], a[56:59], a[4:7], v[216:219]
v_mfma_f32_16x16x32_bf16 v[224:227], a[56:59], a[8:11], v[224:227]
v_mfma_f32_16x16x32_bf16 v[232:235], a[56:59], a[12:15], v[232:235]
v_mfma_f32_16x16x32_bf16 v[240:243], a[56:59], a[16:19], v[240:243]
v_mfma_f32_16x16x32_bf16 v[248:251], a[56:59], a[20:23], v[248:251]
v_mfma_f32_16x16x32_bf16 a[128:131], a[56:59], a[24:27], a[128:131]
v_mfma_f32_16x16x32_bf16 a[136:139], a[56:59], a[28:31], a[136:139]
v_mfma_f32_16x16x32_bf16 v[212:215], a[60:63], a[0:3], v[212:215]
v_mfma_f32_16x16x32_bf16 v[220:223], a[60:63], a[4:7], v[220:223]
v_mfma_f32_16x16x32_bf16 v[228:231], a[60:63], a[8:11], v[228:231]
v_mfma_f32_16x16x32_bf16 v[236:239], a[60:63], a[12:15], v[236:239]
v_mfma_f32_16x16x32_bf16 v[244:247], a[60:63], a[16:19], v[244:247]
v_mfma_f32_16x16x32_bf16 v[252:255], a[60:63], a[20:23], v[252:255]
v_mfma_f32_16x16x32_bf16 a[132:135], a[60:63], a[24:27], a[132:135]
v_mfma_f32_16x16x32_bf16 a[140:143], a[60:63], a[28:31], a[140:143]
s_waitcnt vmcnt(4) lgkmcnt(0)
s_barrier
v_mfma_f32_16x16x32_bf16 v[16:19], a[96:99], a[64:67], v[16:19]
v_add_u32 v6, s37, v4
s_add_u32 s37, s37, 32768
v_mfma_f32_16x16x32_bf16 v[24:27], a[96:99], a[68:71], v[24:27]
ds_read_b64_tr_b16 a[32:33], v8 offset:0
v_mfma_f32_16x16x32_bf16 v[32:35], a[96:99], a[72:75], v[32:35]
ds_read_b64_tr_b16 a[34:35], v8 offset:1024
v_mfma_f32_16x16x32_bf16 v[40:43], a[96:99], a[76:79], v[40:43]
v_mfma_f32_16x16x32_bf16 v[48:51], a[96:99], a[80:83], v[48:51]
ds_read_b128 a[0:3], v6 offset:0
v_mfma_f32_16x16x32_bf16 v[56:59], a[96:99], a[84:87], v[56:59]
ds_read_b128 a[4:7], v6 offset:2048
v_mfma_f32_16x16x32_bf16 v[64:67], a[96:99], a[88:91], v[64:67]
v_mfma_f32_16x16x32_bf16 v[72:75], a[96:99], a[92:95], v[72:75]
ds_read_b128 a[8:11], v6 offset:4096
v_mfma_f32_16x16x32_bf16 v[20:23], a[100:103], a[64:67], v[20:23]
v_mfma_f32_16x16x32_bf16 v[28:31], a[100:103], a[68:71], v[28:31]
ds_read_b128 a[12:15], v6 offset:6144
v_mfma_f32_16x16x32_bf16 v[36:39], a[100:103], a[72:75], v[36:39]
ds_read_b128 a[16:19], v6 offset:8192
v_mfma_f32_16x16x32_bf16 v[44:47], a[100:103], a[76:79], v[44:47]
v_mfma_f32_16x16x32_bf16 v[52:55], a[100:103], a[80:83], v[52:55]
ds_read_b128 a[20:23], v6 offset:10240
v_mfma_f32_16x16x32_bf16 v[60:63], a[100:103], a[84:87], v[60:63]
v_mfma_f32_16x16x32_bf16 v[68:71], a[100:103], a[88:91], v[68:71]
ds_read_b128 a[24:27], v6 offset:12288
v_mfma_f32_16x16x32_bf16 v[76:79], a[100:103], a[92:95], v[76:79]
ds_read_b128 a[28:31], v6 offset:14336
v_mfma_f32_16x16x32_bf16 v[80:83], a[104:107], a[64:67], v[80:83]
v_mfma_f32_16x16x32_bf16 v[88:91], a[104:107], a[68:71], v[88:91]
ds_read_b64_tr_b16 a[36:37], v9 offset:0
v_mfma_f32_16x16x32_bf16 v[96:99], a[104:107], a[72:75], v[96:99]
ds_read_b64_tr_b16 a[38:39], v9 offset:1024
v_mfma_f32_16x16x32_bf16 v[104:107], a[104:107], a[76:79], v[104:107]
v_mfma_f32_16x16x32_bf16 v[112:115], a[104:107], a[80:83], v[112:115]
ds_read_b64_tr_b16 a[40:41], v10 offset:0
v_mfma_f32_16x16x32_bf16 v[120:123], a[104:107], a[84:87], v[120:123]
s_cmp_ge_u32 s37, s42
v_mfma_f32_16x16x32_bf16 v[128:131], a[104:107], a[88:91], v[128:131]
ds_read_b64_tr_b16 a[42:43], v10 offset:1024
v_mfma_f32_16x16x32_bf16 v[136:139], a[104:107], a[92:95], v[136:139]
ds_read_b64_tr_b16 a[44:45], v11 offset:0
v_mfma_f32_16x16x32_bf16 v[84:87], a[108:111], a[64:67], v[84:87]
v_mfma_f32_16x16x32_bf16 v[92:95], a[108:111], a[68:71], v[92:95]
ds_read_b64_tr_b16 a[46:47], v11 offset:1024
v_mfma_f32_16x16x32_bf16 v[100:103], a[108:111], a[72:75], v[100:103]
v_mfma_f32_16x16x32_bf16 v[108:111], a[108:111], a[76:79], v[108:111]
ds_read_b64_tr_b16 a[48:49], v8 offset:8192
v_mfma_f32_16x16x32_bf16 v[116:119], a[108:111], a[80:83], v[116:119]
ds_read_b64_tr_b16 a[50:51], v8 offset:9216
v_mfma_f32_16x16x32_bf16 v[124:127], a[108:111], a[84:87], v[124:127]
v_mfma_f32_16x16x32_bf16 v[132:135], a[108:111], a[88:91], v[132:135]
ds_read_b64_tr_b16 a[52:53], v9 offset:8192
v_mfma_f32_16x16x32_bf16 v[140:143], a[108:111], a[92:95], v[140:143]
ds_read_b64_tr_b16 a[54:55], v9 offset:9216
v_mfma_f32_16x16x32_bf16 v[144:147], a[112:115], a[64:67], v[144:147]
v_mfma_f32_16x16x32_bf16 v[152:155], a[112:115], a[68:71], v[152:155]
ds_read_b64_tr_b16 a[56:57], v10 offset:8192
v_mfma_f32_16x16x32_bf16 v[160:163], a[112:115], a[72:75], v[160:163]
v_mfma_f32_16x16x32_bf16 v[168:171], a[112:115], a[76:79], v[168:171]
ds_read_b64_tr_b16 a[58:59], v10 offset:9216
v_mfma_f32_16x16x32_bf16 v[176:179], a[112:115], a[80:83], v[176:179]
ds_read_b64_tr_b16 a[60:61], v11 offset:8192
v_mfma_f32_16x16x32_bf16 v[184:187], a[112:115], a[84:87], v[184:187]
v_mfma_f32_16x16x32_bf16 v[192:195], a[112:115], a[88:91], v[192:195]
ds_read_b64_tr_b16 a[62:63], v11 offset:9216
v_mfma_f32_16x16x32_bf16 v[200:203], a[112:115], a[92:95], v[200:203]
v_mfma_f32_16x16x32_bf16 v[148:151], a[116:119], a[64:67], v[148:151]
v_mfma_f32_16x16x32_bf16 v[156:159], a[116:119], a[68:71], v[156:159]
v_mfma_f32_16x16x32_bf16 v[164:167], a[116:119], a[72:75], v[164:167]
s_cselect_b32 s37, s41, s37
v_mfma_f32_16x16x32_bf16 v[172:175], a[116:119], a[76:79], v[172:175]
v_mfma_f32_16x16x32_bf16 v[180:183], a[116:119], a[80:83], v[180:183]
v_mfma_f32_16x16x32_bf16 v[188:191], a[116:119], a[84:87], v[188:191]
v_mfma_f32_16x16x32_bf16 v[196:199], a[116:119], a[88:91], v[196:199]
v_mfma_f32_16x16x32_bf16 v[204:207], a[116:119], a[92:95], v[204:207]
v_mfma_f32_16x16x32_bf16 v[208:211], a[120:123], a[64:67], v[208:211]
v_mfma_f32_16x16x32_bf16 v[216:219], a[120:123], a[68:71], v[216:219]
v_mfma_f32_16x16x32_bf16 v[224:227], a[120:123], a[72:75], v[224:227]
v_mfma_f32_16x16x32_bf16 v[232:235], a[120:123], a[76:79], v[232:235]
v_mfma_f32_16x16x32_bf16 v[240:243], a[120:123], a[80:83], v[240:243]
v_mfma_f32_16x16x32_bf16 v[248:251], a[120:123], a[84:87], v[248:251]
v_mfma_f32_16x16x32_bf16 a[128:131], a[120:123], a[88:91], a[128:131]
v_mfma_f32_16x16x32_bf16 a[136:139], a[120:123], a[92:95], a[136:139]
v_mfma_f32_16x16x32_bf16 v[212:215], a[124:127], a[64:67], v[212:215]
v_mfma_f32_16x16x32_bf16 v[220:223], a[124:127], a[68:71], v[220:223]
v_mfma_f32_16x16x32_bf16 v[228:231], a[124:127], a[72:75], v[228:231]
v_mfma_f32_16x16x32_bf16 v[236:239], a[124:127], a[76:79], v[236:239]
v_mfma_f32_16x16x32_bf16 v[244:247], a[124:127], a[80:83], v[244:247]
v_mfma_f32_16x16x32_bf16 v[252:255], a[124:127], a[84:87], v[252:255]
v_mfma_f32_16x16x32_bf16 a[132:135], a[124:127], a[88:91], a[132:135]
v_mfma_f32_16x16x32_bf16 a[140:143], a[124:127], a[92:95], a[140:143]
s_waitcnt vmcnt(0) lgkmcnt(0)
s_barrier
v_mfma_f32_16x16x32_bf16 v[16:19], a[32:35], a[0:3], v[16:19]
v_add_u32 v7, s38, v5
s_add_u32 s38, s38, 32768
v_mfma_f32_16x16x32_bf16 v[24:27], a[32:35], a[4:7], v[24:27]
ds_read_b64_tr_b16 a[96:97], v8 offset:16384
v_mfma_f32_16x16x32_bf16 v[32:35], a[32:35], a[8:11], v[32:35]
ds_read_b64_tr_b16 a[98:99], v8 offset:17408
v_mfma_f32_16x16x32_bf16 v[40:43], a[32:35], a[12:15], v[40:43]
s_cmp_ge_u32 s38, s42
v_mfma_f32_16x16x32_bf16 v[48:51], a[32:35], a[16:19], v[48:51]
ds_read_b128 a[64:67], v7 offset:0
v_mfma_f32_16x16x32_bf16 v[56:59], a[32:35], a[20:23], v[56:59]
ds_read_b128 a[68:71], v7 offset:2048
v_mfma_f32_16x16x32_bf16 v[64:67], a[32:35], a[24:27], v[64:67]
v_mfma_f32_16x16x32_bf16 v[72:75], a[32:35], a[28:31], v[72:75]
ds_read_b128 a[72:75], v7 offset:4096
s_cselect_b32 s38, s41, s38
v_mfma_f32_16x16x32_bf16 v[20:23], a[36:39], a[0:3], v[20:23]
v_mfma_f32_16x16x32_bf16 v[28:31], a[36:39], a[4:7], v[28:31]
ds_read_b128 a[76:79], v7 offset:6144
v_mfma_f32_16x16x32_bf16 v[36:39], a[36:39], a[8:11], v[36:39]
ds_read_b128 a[80:83], v7 offset:8192
v_mfma_f32_16x16x32_bf16 v[44:47], a[36:39], a[12:15], v[44:47]
s_add_u32 s58, s48, 0
v_mfma_f32_16x16x32_bf16 v[52:55], a[36:39], a[16:19], v[52:55]
ds_read_b128 a[84:87], v7 offset:10240
v_mfma_f32_16x16x32_bf16 v[60:63], a[36:39], a[20:23], v[60:63]
v_mfma_f32_16x16x32_bf16 v[68:71], a[36:39], a[24:27], v[68:71]
ds_read_b128 a[88:91], v7 offset:12288
s_lshl_b32 s58, s58, 7
v_mfma_f32_16x16x32_bf16 v[76:79], a[36:39], a[28:31], v[76:79]
ds_read_b128 a[92:95], v7 offset:14336
v_mfma_f32_16x16x32_bf16 v[80:83], a[40:43], a[0:3], v[80:83]
v_mfma_f32_16x16x32_bf16 v[88:91], a[40:43], a[4:7], v[88:91]
ds_read_b64_tr_b16 a[100:101], v9 offset:16384
v_mfma_f32_16x16x32_bf16 v[96:99], a[40:43], a[8:11], v[96:99]
ds_read_b64_tr_b16 a[102:103], v9 offset:17408
s_add_u32 s58, s58, 0x5b00000
v_mfma_f32_16x16x32_bf16 v[104:107], a[40:43], a[12:15], v[104:107]
v_mfma_f32_16x16x32_bf16 v[112:115], a[40:43], a[16:19], v[112:115]
ds_read_b64_tr_b16 a[104:105], v10 offset:16384
v_mfma_f32_16x16x32_bf16 v[120:123], a[40:43], a[20:23], v[120:123]
v_mfma_f32_16x16x32_bf16 v[128:131], a[40:43], a[24:27], v[128:131]
ds_read_b64_tr_b16 a[106:107], v10 offset:17408
s_add_u32 s59, s48, 48
v_mfma_f32_16x16x32_bf16 v[136:139], a[40:43], a[28:31], v[136:139]
ds_read_b64_tr_b16 a[108:109], v11 offset:16384
v_mfma_f32_16x16x32_bf16 v[84:87], a[44:47], a[0:3], v[84:87]
v_mfma_f32_16x16x32_bf16 v[92:95], a[44:47], a[4:7], v[92:95]
ds_read_b64_tr_b16 a[110:111], v11 offset:17408
s_lshl_b32 s59, s59, 7
v_mfma_f32_16x16x32_bf16 v[100:103], a[44:47], a[8:11], v[100:103]
v_mfma_f32_16x16x32_bf16 v[108:111], a[44:47], a[12:15], v[108:111]
ds_read_b64_tr_b16 a[112:113], v8 offset:24576
v_mfma_f32_16x16x32_bf16 v[116:119], a[44:47], a[16:19], v[116:119]
ds_read_b64_tr_b16 a[114:115], v8 offset:25600
v_mfma_f32_16x16x32_bf16 v[124:127], a[44:47], a[20:23], v[124:127]
s_add_u32 s59, s59, 0x5b00000
v_mfma_f32_16x16x32_bf16 v[132:135], a[44:47], a[24:27], v[132:135]
ds_read_b64_tr_b16 a[116:117], v9 offset:24576
v_mfma_f32_16x16x32_bf16 v[140:143], a[44:47], a[28:31], v[140:143]
ds_read_b64_tr_b16 a[118:119], v9 offset:25600
v_mfma_f32_16x16x32_bf16 v[144:147], a[48:51], a[0:3], v[144:147]
v_mfma_f32_16x16x32_bf16 v[152:155], a[48:51], a[4:7], v[152:155]
ds_read_b64_tr_b16 a[120:121], v10 offset:24576
s_add_u32 s66, s48, 32
v_mfma_f32_16x16x32_bf16 v[160:163], a[48:51], a[8:11], v[160:163]
v_mfma_f32_16x16x32_bf16 v[168:171], a[48:51], a[12:15], v[168:171]
ds_read_b64_tr_b16 a[122:123], v10 offset:25600
v_mfma_f32_16x16x32_bf16 v[176:179], a[48:51], a[16:19], v[176:179]
ds_read_b64_tr_b16 a[124:125], v11 offset:24576
v_mfma_f32_16x16x32_bf16 v[184:187], a[48:51], a[20:23], v[184:187]
s_lshl_b32 s66, s66, 7
v_mfma_f32_16x16x32_bf16 v[192:195], a[48:51], a[24:27], v[192:195]
ds_read_b64_tr_b16 a[126:127], v11 offset:25600
v_mfma_f32_16x16x32_bf16 v[200:203], a[48:51], a[28:31], v[200:203]
v_mfma_f32_16x16x32_bf16 v[148:151], a[52:55], a[0:3], v[148:151]
s_add_u32 s66, s66, 0x5b00000
v_mfma_f32_16x16x32_bf16 v[156:159], a[52:55], a[4:7], v[156:159]
v_mfma_f32_16x16x32_bf16 v[164:167], a[52:55], a[8:11], v[164:167]
v_mfma_f32_16x16x32_bf16 v[172:175], a[52:55], a[12:15], v[172:175]
v_mfma_f32_16x16x32_bf16 v[180:183], a[52:55], a[16:19], v[180:183]
s_mov_b32 s66, s58
v_mfma_f32_16x16x32_bf16 v[188:191], a[52:55], a[20:23], v[188:191]
v_mfma_f32_16x16x32_bf16 v[196:199], a[52:55], a[24:27], v[196:199]
v_mfma_f32_16x16x32_bf16 v[204:207], a[52:55], a[28:31], v[204:207]
v_mfma_f32_16x16x32_bf16 v[208:211], a[56:59], a[0:3], v[208:211]
v_mov_b32 v13, s66
v_mfma_f32_16x16x32_bf16 v[216:219], a[56:59], a[4:7], v[216:219]
v_mfma_f32_16x16x32_bf16 v[224:227], a[56:59], a[8:11], v[224:227]
v_mfma_f32_16x16x32_bf16 v[232:235], a[56:59], a[12:15], v[232:235]
v_writelane_b32 v13, s58, 0
v_mfma_f32_16x16x32_bf16 v[240:243], a[56:59], a[16:19], v[240:243]
v_mfma_f32_16x16x32_bf16 v[248:251], a[56:59], a[20:23], v[248:251]
v_mfma_f32_16x16x32_bf16 a[128:131], a[56:59], a[24:27], a[128:131]
v_mfma_f32_16x16x32_bf16 a[136:139], a[56:59], a[28:31], a[136:139]
v_writelane_b32 v13, s59, 1
v_mfma_f32_16x16x32_bf16 v[212:215], a[60:63], a[0:3], v[212:215]
v_mfma_f32_16x16x32_bf16 v[220:223], a[60:63], a[4:7], v[220:223]
v_mfma_f32_16x16x32_bf16 v[228:231], a[60:63], a[8:11], v[228:231]
v_mfma_f32_16x16x32_bf16 v[236:239], a[60:63], a[12:15], v[236:239]
buffer_load_dword v14, v13, s[4:7], 0 offen sc1
v_mfma_f32_16x16x32_bf16 v[244:247], a[60:63], a[16:19], v[244:247]
v_mfma_f32_16x16x32_bf16 v[252:255], a[60:63], a[20:23], v[252:255]
v_mfma_f32_16x16x32_bf16 a[132:135], a[60:63], a[24:27], a[132:135]
v_mfma_f32_16x16x32_bf16 a[140:143], a[60:63], a[28:31], a[140:143]
s_waitcnt vmcnt(0) lgkmcnt(0)
s_mov_b32 s67, 0x80000
fused_kernel_dpoll_16:
v_readlane_b32 s66, v14, 0
v_readlane_b32 s68, v14, 1
v_readlane_b32 s69, v14, 2
s_sub_u32 s67, s67, 1
s_cmp_eq_u32 s67, 0
s_cbranch_scc1 fused_kernel_dok_15
s_min_u32 s66, s66, s68
s_min_u32 s66, s66, s69
s_cmp_ge_u32 s66, 8
s_cbranch_scc1 fused_kernel_dok_15
s_sleep 1
buffer_load_dword v14, v13, s[4:7], 0 offen sc1
s_waitcnt vmcnt(0)
s_branch fused_kernel_dpoll_16
fused_kernel_dok_15:
s_barrier
v_mfma_f32_16x16x32_bf16 v[16:19], a[96:99], a[64:67], v[16:19]
s_and_b32 s28, s2, 7
s_lshr_b32 s29, s2, 3
v_mfma_f32_16x16x32_bf16 v[24:27], a[96:99], a[68:71], v[24:27]
s_lshr_b32 s30, s29, 4
s_lshl_b32 s8, s28, 1
v_mfma_f32_16x16x32_bf16 v[32:35], a[96:99], a[72:75], v[32:35]
s_add_u32 s8, s8, s30
v_mfma_f32_16x16x32_bf16 v[40:43], a[96:99], a[76:79], v[40:43]
s_bfe_u32 s9, s29, 0x30001
s_and_b32 s10, s29, 1
v_mfma_f32_16x16x32_bf16 v[48:51], a[96:99], a[80:83], v[48:51]
s_lshl_b32 s37, s8, 3
s_add_u32 s37, s37, s9
v_mfma_f32_16x16x32_bf16 v[56:59], a[96:99], a[84:87], v[56:59]
s_lshl_b32 s33, s3, 12
v_mfma_f32_16x16x32_bf16 v[64:67], a[96:99], a[88:91], v[64:67]
s_sub_u32 s22, 15, s9
s_lshl_b32 s29, s22, 2
v_mfma_f32_16x16x32_bf16 v[72:75], a[96:99], a[92:95], v[72:75]
s_add_u32 s29, s29, 4
s_cmp_eq_u32 s9, 0
v_mfma_f32_16x16x32_bf16 v[20:23], a[100:103], a[64:67], v[20:23]
s_cselect_b32 s30, 40, 38
v_mfma_f32_16x16x32_bf16 v[28:31], a[100:103], a[68:71], v[28:31]
s_min_u32 s30, s29, s30
s_sub_u32 s11, s29, s30
v_mfma_f32_16x16x32_bf16 v[36:39], a[100:103], a[72:75], v[36:39]
s_lshl_b32 s58, s9, 2
s_add_u32 s58, s58, 4
v_mfma_f32_16x16x32_bf16 v[44:47], a[100:103], a[76:79], v[44:47]
s_cmp_eq_u32 s11, 0
v_mfma_f32_16x16x32_bf16 v[52:55], a[100:103], a[80:83], v[52:55]
s_cselect_b32 s32, 0, 1
s_cselect_b32 s38, 0, 3
v_mfma_f32_16x16x32_bf16 v[60:63], a[100:103], a[84:87], v[60:63]
s_cmp_eq_u32 s10, 0
s_cselect_b32 s32, s32, s38
v_mfma_f32_16x16x32_bf16 v[68:71], a[100:103], a[88:91], v[68:71]
s_cselect_b32 s34, s30, s58
v_mfma_f32_16x16x32_bf16 v[76:79], a[100:103], a[92:95], v[76:79]
s_cselect_b32 s22, s22, s9
s_mov_b32 s35, 0
v_mfma_f32_16x16x32_bf16 v[80:83], a[104:107], a[64:67], v[80:83]
s_lshl_b32 s28, s8, 20
s_add_u32 s28, s28, s33
v_mfma_f32_16x16x32_bf16 v[88:91], a[104:107], a[68:71], v[88:91]
s_add_u32 s12, s28, 0x1200000
v_mfma_f32_16x16x32_bf16 v[96:99], a[104:107], a[72:75], v[96:99]
s_add_u32 s13, s28, 0x2200000
s_lshl_b32 s31, s58, 14
v_mfma_f32_16x16x32_bf16 v[104:107], a[104:107], a[76:79], v[104:107]
s_add_u32 s14, s12, s31
s_add_u32 s15, s13, s31
v_mfma_f32_16x16x32_bf16 v[112:115], a[104:107], a[80:83], v[112:115]
s_lshl_b32 s31, s30, 14
v_mfma_f32_16x16x32_bf16 v[120:123], a[104:107], a[84:87], v[120:123]
s_add_u32 s16, s12, s31
s_add_u32 s17, s13, s31
v_mfma_f32_16x16x32_bf16 v[128:131], a[104:107], a[88:91], v[128:131]
s_cmp_eq_u32 s32, 3
s_cselect_b32 s14, s14, -1
v_mfma_f32_16x16x32_bf16 v[136:139], a[104:107], a[92:95], v[136:139]
s_cselect_b32 s15, s15, -1
v_mfma_f32_16x16x32_bf16 v[84:87], a[108:111], a[64:67], v[84:87]
s_add_u32 s20, s33, 163840
s_mov_b32 s25, s30
v_mfma_f32_16x16x32_bf16 v[92:95], a[108:111], a[68:71], v[92:95]
s_sub_u32 s39, s58, 7
s_cmp_eq_u32 s32, 3
v_mfma_f32_16x16x32_bf16 v[100:103], a[108:111], a[72:75], v[100:103]
s_cselect_b32 s39, s39, -1
v_mfma_f32_16x16x32_bf16 v[108:111], a[108:111], a[76:79], v[108:111]
s_cmp_eq_u32 s9, 0
s_cselect_b32 s39, -1, s39
v_mfma_f32_16x16x32_bf16 v[116:119], a[108:111], a[80:83], v[116:119]
s_cmp_eq_u32 s10, 0
s_cselect_b32 s39, 25, s39
v_mfma_f32_16x16x32_bf16 v[124:127], a[108:111], a[84:87], v[124:127]
s_mov_b32 s38, 0
v_mfma_f32_16x16x32_bf16 v[132:135], a[108:111], a[88:91], v[132:135]
s_cmp_eq_u32 s9, 0
s_cselect_b32 s59, 1, 0
v_mfma_f32_16x16x32_bf16 v[140:143], a[108:111], a[92:95], v[140:143]
s_cmp_eq_u32 s32, 3
s_cselect_b32 s59, s59, 0
v_mfma_f32_16x16x32_bf16 v[144:147], a[112:115], a[64:67], v[144:147]
s_lshl_b32 s24, s22, 2
v_mfma_f32_16x16x32_bf16 v[152:155], a[112:115], a[68:71], v[152:155]
s_mov_b32 s23, s35
s_sub_u32 s21, s34, 2
v_mfma_f32_16x16x32_bf16 v[160:163], a[112:115], a[72:75], v[160:163]
s_lshr_b32 s21, s21, 1
s_lshl_b32 s28, s8, 6
v_mfma_f32_16x16x32_bf16 v[168:171], a[112:115], a[76:79], v[168:171]
s_lshl_b32 s29, s22, 2
v_mfma_f32_16x16x32_bf16 v[176:179], a[112:115], a[80:83], v[176:179]
s_add_u32 s28, s28, s29
s_add_u32 s28, s28, s3
v_mfma_f32_16x16x32_bf16 v[184:187], a[112:115], a[84:87], v[184:187]
s_lshl_b32 s28, s28, 14
s_add_u32 s36, s28, 0x200000
v_mfma_f32_16x16x32_bf16 v[192:195], a[112:115], a[88:91], v[192:195]
v_lshlrev_b32 v12, 4, v1
v_mfma_f32_16x16x32_bf16 v[200:203], a[112:115], a[92:95], v[200:203]
v_bfe_u32 v0, v1, 4, 1
v_lshlrev_b32 v0, 13, v0
v_mfma_f32_16x16x32_bf16 v[148:151], a[116:119], a[64:67], v[148:151]
v_lshrrev_b32 v14, 5, v1
v_lshl_add_u32 v0, v14, 8, v0
v_mfma_f32_16x16x32_bf16 v[156:159], a[116:119], a[68:71], v[156:159]
v_and_b32 v14, 15, v1
v_mfma_f32_16x16x32_bf16 v[164:167], a[116:119], a[72:75], v[164:167]
v_lshl_add_u32 v0, v14, 4, v0
s_add_u32 s28, s36, 0
v_mfma_f32_16x16x32_bf16 v[172:175], a[116:119], a[76:79], v[172:175]
buffer_load_dwordx4 a[0:3], v0, s[4:7], s28 offen offset:0
buffer_load_dwordx4 a[4:7], v0, s[4:7], s28 offen offset:512
v_mfma_f32_16x16x32_bf16 v[180:183], a[116:119], a[80:83], v[180:183]
buffer_load_dwordx4 a[8:11], v0, s[4:7], s28 offen offset:1024
v_mfma_f32_16x16x32_bf16 v[188:191], a[116:119], a[84:87], v[188:191]
buffer_load_dwordx4 a[12:15], v0, s[4:7], s28 offen offset:1536
buffer_load_dwordx4 a[16:19], v0, s[4:7], s28 offen offset:2048
v_mfma_f32_16x16x32_bf16 v[196:199], a[116:119], a[88:91], v[196:199]
buffer_load_dwordx4 a[20:23], v0, s[4:7], s28 offen offset:2560
buffer_load_dwordx4 a[24:27], v0, s[4:7], s28 offen offset:3072
v_mfma_f32_16x16x32_bf16 v[204:207], a[116:119], a[92:95], v[204:207]
buffer_load_dwordx4 a[28:31], v0, s[4:7], s28 offen offset:3584
v_mfma_f32_16x16x32_bf16 v[208:211], a[120:123], a[64:67], v[208:211]
s_add_u32 s28, s36, 4096
buffer_load_dwordx4 a[32:35], v0, s[4:7], s28 offen offset:0
v_mfma_f32_16x16x32_bf16 v[216:219], a[120:123], a[68:71], v[216:219]
buffer_load_dwordx4 a[36:39], v0, s[4:7], s28 offen offset:512
buffer_load_dwordx4 a[40:43], v0, s[4:7], s28 offen offset:1024
v_mfma_f32_16x16x32_bf16 v[224:227], a[120:123], a[72:75], v[224:227]
buffer_load_dwordx4 a[44:47], v0, s[4:7], s28 offen offset:1536
v_mfma_f32_16x16x32_bf16 v[232:235], a[120:123], a[76:79], v[232:235]
buffer_load_dwordx4 a[48:51], v0, s[4:7], s28 offen offset:2048
buffer_load_dwordx4 a[52:55], v0, s[4:7], s28 offen offset:2560
v_mfma_f32_16x16x32_bf16 v[240:243], a[120:123], a[80:83], v[240:243]
buffer_load_dwordx4 a[56:59], v0, s[4:7], s28 offen offset:3072
buffer_load_dwordx4 a[60:63], v0, s[4:7], s28 offen offset:3584
v_mfma_f32_16x16x32_bf16 v[248:251], a[120:123], a[84:87], v[248:251]
s_add_u32 m0, s33, 0
v_mfma_f32_16x16x32_bf16 a[128:131], a[120:123], a[88:91], a[128:131]
buffer_load_dwordx4 v12, s[4:7], s12 offen offset:0 lds
buffer_load_dwordx4 v12, s[4:7], s12 offen offset:1024 lds
v_mfma_f32_16x16x32_bf16 a[136:139], a[120:123], a[92:95], a[136:139]
buffer_load_dwordx4 v12, s[4:7], s12 offen offset:2048 lds
buffer_load_dwordx4 v12, s[4:7], s12 offen offset:3072 lds
v_mfma_f32_16x16x32_bf16 v[212:215], a[124:127], a[64:67], v[212:215]
s_add_u32 s12, s12, 16384
v_mfma_f32_16x16x32_bf16 v[220:223], a[124:127], a[68:71], v[220:223]
s_cmp_eq_u32 s12, s14
s_cselect_b32 s12, s16, s12
v_mfma_f32_16x16x32_bf16 v[228:231], a[124:127], a[72:75], v[228:231]
s_add_u32 m0, s33, 32768
s_nop 0
buffer_load_dwordx4 v12, s[4:7], s12 offen offset:0 lds
v_mfma_f32_16x16x32_bf16 v[236:239], a[124:127], a[76:79], v[236:239]
buffer_load_dwordx4 v12, s[4:7], s12 offen offset:1024 lds
v_mfma_f32_16x16x32_bf16 v[244:247], a[124:127], a[80:83], v[244:247]
buffer_load_dwordx4 v12, s[4:7], s12 offen offset:2048 lds
buffer_load_dwordx4 v12, s[4:7], s12 offen offset:3072 lds
v_mfma_f32_16x16x32_bf16 v[252:255], a[124:127], a[84:87], v[252:255]
s_add_u32 s12, s12, 16384
s_cmp_eq_u32 s12, s14
v_mfma_f32_16x16x32_bf16 a[132:135], a[124:127], a[88:91], a[132:135]
s_cselect_b32 s12, s16, s12
v_mfma_f32_16x16x32_bf16 a[140:143], a[124:127], a[92:95], a[140:143]
s_nop 7
v_pk_mul_f32 v[16:17], v[16:17], v[144:145]
v_pk_mul_f32 v[18:19], v[18:19], v[146:147]
v_pk_mul_f32 v[20:21], v[20:21], v[148:149]
v_pk_mul_f32 v[22:23], v[22:23], v[150:151]
v_cvt_pk_bf16_f32 v16, v16, v17
v_cvt_pk_bf16_f32 v17, v18, v19
v_cvt_pk_bf16_f32 v18, v20, v21
v_cvt_pk_bf16_f32 v19, v22, v23
v_accvgpr_write_b32 a144, v16
v_accvgpr_write_b32 a145, v17
v_accvgpr_write_b32 a146, v18
v_accvgpr_write_b32 a147, v19
v_pk_mul_f32 v[80:81], v[80:81], v[208:209]
v_pk_mul_f32 v[82:83], v[82:83], v[210:211]
v_pk_mul_f32 v[84:85], v[84:85], v[212:213]
v_pk_mul_f32 v[86:87], v[86:87], v[214:215]
v_cvt_pk_bf16_f32 v80, v80, v81
v_cvt_pk_bf16_f32 v81, v82, v83
v_cvt_pk_bf16_f32 v82, v84, v85
v_cvt_pk_bf16_f32 v83, v86, v87
v_accvgpr_write_b32 a148, v80
v_accvgpr_write_b32 a149, v81
v_accvgpr_write_b32 a150, v82
v_accvgpr_write_b32 a151, v83
v_pk_mul_f32 v[24:25], v[24:25], v[152:153]
v_pk_mul_f32 v[26:27], v[26:27], v[154:155]
v_pk_mul_f32 v[28:29], v[28:29], v[156:157]
v_pk_mul_f32 v[30:31], v[30:31], v[158:159]
v_cvt_pk_bf16_f32 v24, v24, v25
v_cvt_pk_bf16_f32 v25, v26, v27
v_cvt_pk_bf16_f32 v26, v28, v29
v_cvt_pk_bf16_f32 v27, v30, v31
v_accvgpr_write_b32 a152, v24
v_accvgpr_write_b32 a153, v25
v_accvgpr_write_b32 a154, v26
v_accvgpr_write_b32 a155, v27
v_pk_mul_f32 v[88:89], v[88:89], v[216:217]
v_pk_mul_f32 v[90:91], v[90:91], v[218:219]
v_pk_mul_f32 v[92:93], v[92:93], v[220:221]
v_pk_mul_f32 v[94:95], v[94:95], v[222:223]
v_cvt_pk_bf16_f32 v88, v88, v89
v_cvt_pk_bf16_f32 v89, v90, v91
v_cvt_pk_bf16_f32 v90, v92, v93
v_cvt_pk_bf16_f32 v91, v94, v95
v_accvgpr_write_b32 a156, v88
v_accvgpr_write_b32 a157, v89
v_accvgpr_write_b32 a158, v90
v_accvgpr_write_b32 a159, v91
v_pk_mul_f32 v[32:33], v[32:33], v[160:161]
v_pk_mul_f32 v[34:35], v[34:35], v[162:163]
v_pk_mul_f32 v[36:37], v[36:37], v[164:165]
v_pk_mul_f32 v[38:39], v[38:39], v[166:167]
v_cvt_pk_bf16_f32 v32, v32, v33
v_cvt_pk_bf16_f32 v33, v34, v35
v_cvt_pk_bf16_f32 v34, v36, v37
v_cvt_pk_bf16_f32 v35, v38, v39
v_accvgpr_write_b32 a160, v32
v_accvgpr_write_b32 a161, v33
v_accvgpr_write_b32 a162, v34
v_accvgpr_write_b32 a163, v35
v_pk_mul_f32 v[96:97], v[96:97], v[224:225]
v_pk_mul_f32 v[98:99], v[98:99], v[226:227]
v_pk_mul_f32 v[100:101], v[100:101], v[228:229]
v_pk_mul_f32 v[102:103], v[102:103], v[230:231]
v_cvt_pk_bf16_f32 v96, v96, v97
v_cvt_pk_bf16_f32 v97, v98, v99
v_cvt_pk_bf16_f32 v98, v100, v101
v_cvt_pk_bf16_f32 v99, v102, v103
v_accvgpr_write_b32 a164, v96
v_accvgpr_write_b32 a165, v97
v_accvgpr_write_b32 a166, v98
v_accvgpr_write_b32 a167, v99
v_pk_mul_f32 v[40:41], v[40:41], v[168:169]
v_pk_mul_f32 v[42:43], v[42:43], v[170:171]
v_pk_mul_f32 v[44:45], v[44:45], v[172:173]
v_pk_mul_f32 v[46:47], v[46:47], v[174:175]
v_cvt_pk_bf16_f32 v40, v40, v41
v_cvt_pk_bf16_f32 v41, v42, v43
v_cvt_pk_bf16_f32 v42, v44, v45
v_cvt_pk_bf16_f32 v43, v46, v47
v_accvgpr_write_b32 a168, v40
v_accvgpr_write_b32 a169, v41
v_accvgpr_write_b32 a170, v42
v_accvgpr_write_b32 a171, v43
v_pk_mul_f32 v[104:105], v[104:105], v[232:233]
v_pk_mul_f32 v[106:107], v[106:107], v[234:235]
v_pk_mul_f32 v[108:109], v[108:109], v[236:237]
v_pk_mul_f32 v[110:111], v[110:111], v[238:239]
v_cvt_pk_bf16_f32 v104, v104, v105
v_cvt_pk_bf16_f32 v105, v106, v107
v_cvt_pk_bf16_f32 v106, v108, v109
v_cvt_pk_bf16_f32 v107, v110, v111
v_accvgpr_write_b32 a172, v104
v_accvgpr_write_b32 a173, v105
v_accvgpr_write_b32 a174, v106
v_accvgpr_write_b32 a175, v107
v_pk_mul_f32 v[48:49], v[48:49], v[176:177]
v_pk_mul_f32 v[50:51], v[50:51], v[178:179]
v_pk_mul_f32 v[52:53], v[52:53], v[180:181]
v_pk_mul_f32 v[54:55], v[54:55], v[182:183]
v_cvt_pk_bf16_f32 v48, v48, v49
v_cvt_pk_bf16_f32 v49, v50, v51
v_cvt_pk_bf16_f32 v50, v52, v53
v_cvt_pk_bf16_f32 v51, v54, v55
v_accvgpr_write_b32 a176, v48
v_accvgpr_write_b32 a177, v49
v_accvgpr_write_b32 a178, v50
v_accvgpr_write_b32 a179, v51
v_pk_mul_f32 v[112:113], v[112:113], v[240:241]
v_pk_mul_f32 v[114:115], v[114:115], v[242:243]
v_pk_mul_f32 v[116:117], v[116:117], v[244:245]
v_pk_mul_f32 v[118:119], v[118:119], v[246:247]
v_cvt_pk_bf16_f32 v112, v112, v113
v_cvt_pk_bf16_f32 v113, v114, v115
v_cvt_pk_bf16_f32 v114, v116, v117
v_cvt_pk_bf16_f32 v115, v118, v119
v_accvgpr_write_b32 a180, v112
v_accvgpr_write_b32 a181, v113
v_accvgpr_write_b32 a182, v114
v_accvgpr_write_b32 a183, v115
v_pk_mul_f32 v[56:57], v[56:57], v[184:185]
v_pk_mul_f32 v[58:59], v[58:59], v[186:187]
v_pk_mul_f32 v[60:61], v[60:61], v[188:189]
v_pk_mul_f32 v[62:63], v[62:63], v[190:191]
v_cvt_pk_bf16_f32 v56, v56, v57
v_cvt_pk_bf16_f32 v57, v58, v59
v_cvt_pk_bf16_f32 v58, v60, v61
v_cvt_pk_bf16_f32 v59, v62, v63
v_accvgpr_write_b32 a184, v56
v_accvgpr_write_b32 a185, v57
v_accvgpr_write_b32 a186, v58
v_accvgpr_write_b32 a187, v59
v_pk_mul_f32 v[120:121], v[120:121], v[248:249]
v_pk_mul_f32 v[122:123], v[122:123], v[250:251]
v_pk_mul_f32 v[124:125], v[124:125], v[252:253]
v_pk_mul_f32 v[126:127], v[126:127], v[254:255]
v_cvt_pk_bf16_f32 v120, v120, v121
v_cvt_pk_bf16_f32 v121, v122, v123
v_cvt_pk_bf16_f32 v122, v124, v125
v_cvt_pk_bf16_f32 v123, v126, v127
v_accvgpr_write_b32 a188, v120
v_accvgpr_write_b32 a189, v121
v_accvgpr_write_b32 a190, v122
v_accvgpr_write_b32 a191, v123
v_pk_mul_f32 v[64:65], v[64:65], v[192:193]
v_pk_mul_f32 v[66:67], v[66:67], v[194:195]
v_pk_mul_f32 v[68:69], v[68:69], v[196:197]
v_pk_mul_f32 v[70:71], v[70:71], v[198:199]
v_cvt_pk_bf16_f32 v64, v64, v65
v_cvt_pk_bf16_f32 v65, v66, v67
v_cvt_pk_bf16_f32 v66, v68, v69
v_cvt_pk_bf16_f32 v67, v70, v71
v_accvgpr_write_b32 a192, v64
v_accvgpr_write_b32 a193, v65
v_accvgpr_write_b32 a194, v66
v_accvgpr_write_b32 a195, v67
v_accvgpr_read_b32 v16, a128
v_accvgpr_read_b32 v17, a129
v_accvgpr_read_b32 v18, a130
v_accvgpr_read_b32 v19, a131
v_accvgpr_read_b32 v20, a132
v_accvgpr_read_b32 v21, a133
v_accvgpr_read_b32 v22, a134
v_accvgpr_read_b32 v23, a135
v_pk_mul_f32 v[128:129], v[128:129], v[16:17]
v_pk_mul_f32 v[130:131], v[130:131], v[18:19]
v_pk_mul_f32 v[132:133], v[132:133], v[20:21]
v_pk_mul_f32 v[134:135], v[134:135], v[22:23]
v_cvt_pk_bf16_f32 v128, v128, v129
v_cvt_pk_bf16_f32 v129, v130, v131
v_cvt_pk_bf16_f32 v130, v132, v133
v_cvt_pk_bf16_f32 v131, v134, v135
v_accvgpr_write_b32 a196, v128
v_accvgpr_write_b32 a197, v129
v_accvgpr_write_b32 a198, v130
v_accvgpr_write_b32 a199, v131
v_pk_mul_f32 v[72:73], v[72:73], v[200:201]
v_pk_mul_f32 v[74:75], v[74:75], v[202:203]
v_pk_mul_f32 v[76:77], v[76:77], v[204:205]
v_pk_mul_f32 v[78:79], v[78:79], v[206:207]
v_cvt_pk_bf16_f32 v72, v72, v73
v_cvt_pk_bf16_f32 v73, v74, v75
v_cvt_pk_bf16_f32 v74, v76, v77
v_cvt_pk_bf16_f32 v75, v78, v79
v_accvgpr_write_b32 a200, v72
v_accvgpr_write_b32 a201, v73
v_accvgpr_write_b32 a202, v74
v_accvgpr_write_b32 a203, v75
v_accvgpr_read_b32 v16, a136
v_accvgpr_read_b32 v17, a137
v_accvgpr_read_b32 v18, a138
v_accvgpr_read_b32 v19, a139
v_accvgpr_read_b32 v20, a140
v_accvgpr_read_b32 v21, a141
v_accvgpr_read_b32 v22, a142
v_accvgpr_read_b32 v23, a143
v_pk_mul_f32 v[136:137], v[136:137], v[16:17]
v_pk_mul_f32 v[138:139], v[138:139], v[18:19]
v_pk_mul_f32 v[140:141], v[140:141], v[20:21]
v_pk_mul_f32 v[142:143], v[142:143], v[22:23]
v_cvt_pk_bf16_f32 v136, v136, v137
v_cvt_pk_bf16_f32 v137, v138, v139
v_cvt_pk_bf16_f32 v138, v140, v141
v_cvt_pk_bf16_f32 v139, v142, v143
v_accvgpr_write_b32 a204, v136
v_accvgpr_write_b32 a205, v137
v_accvgpr_write_b32 a206, v138
v_accvgpr_write_b32 a207, v139
v_mov_b32 v126, 0
v_subrev_u32 v2, s33, v0
v_mov_b32 v10, 0x5b800000
v_lshrrev_b32 v16, 5, v1
v_lshlrev_b32 v16, 2, v16
v_and_b32 v17, 31, v1
v_sub_u32 v9, v16, v17
v_bfe_u32 v16, v1, 4, 1
s_mov_b32 s28, 188416
v_mul_lo_u32 v16, v16, s28
v_lshrrev_b32 v17, 5, v1
v_lshl_add_u32 v16, v17, 8, v16
v_and_b32 v17, 15, v1
v_lshl_add_u32 v11, v17, 4, v16
v_mov_b32 v128, 0
v_mov_b32 v129, 0
v_mov_b32 v130, 0
v_mov_b32 v131, 0
v_mov_b32 v132, 0
v_mov_b32 v133, 0
v_mov_b32 v134, 0
v_mov_b32 v135, 0
v_mov_b32 v136, 0
v_mov_b32 v137, 0
v_mov_b32 v138, 0
v_mov_b32 v139, 0
v_mov_b32 v140, 0
v_mov_b32 v141, 0
v_mov_b32 v142, 0
v_mov_b32 v143, 0
v_mov_b32 v144, 0
v_mov_b32 v145, 0
v_mov_b32 v146, 0
v_mov_b32 v147, 0
v_mov_b32 v148, 0
v_mov_b32 v149, 0
v_mov_b32 v150, 0
v_mov_b32 v151, 0
v_mov_b32 v152, 0
v_mov_b32 v153, 0
v_mov_b32 v154, 0
v_mov_b32 v155, 0
v_mov_b32 v156, 0
v_mov_b32 v157, 0
v_mov_b32 v158, 0
v_mov_b32 v159, 0
v_mov_b32 v160, 0
v_mov_b32 v161, 0
v_mov_b32 v162, 0
v_mov_b32 v163, 0
v_mov_b32 v164, 0
v_mov_b32 v165, 0
v_mov_b32 v166, 0
v_mov_b32 v167, 0
v_mov_b32 v168, 0
v_mov_b32 v169, 0
v_mov_b32 v170, 0
v_mov_b32 v171, 0
v_mov_b32 v172, 0
v_mov_b32 v173, 0
v_mov_b32 v174, 0
v_mov_b32 v175, 0
v_mov_b32 v176, 0
v_mov_b32 v177, 0
v_mov_b32 v178, 0
v_mov_b32 v179, 0
v_mov_b32 v180, 0
v_mov_b32 v181, 0
v_mov_b32 v182, 0
v_mov_b32 v183, 0
v_mov_b32 v184, 0
v_mov_b32 v185, 0
v_mov_b32 v186, 0
v_mov_b32 v187, 0
v_mov_b32 v188, 0
v_mov_b32 v189, 0
v_mov_b32 v190, 0
v_mov_b32 v191, 0
v_mov_b32 v192, 0
v_mov_b32 v193, 0
v_mov_b32 v194, 0
v_mov_b32 v195, 0
v_mov_b32 v196, 0
v_mov_b32 v197, 0
v_mov_b32 v198, 0
v_mov_b32 v199, 0
v_mov_b32 v200, 0
v_mov_b32 v201, 0
v_mov_b32 v202, 0
v_mov_b32 v203, 0
v_mov_b32 v204, 0
v_mov_b32 v205, 0
v_mov_b32 v206, 0
v_mov_b32 v207, 0
v_mov_b32 v208, 0
v_mov_b32 v209, 0
v_mov_b32 v210, 0
v_mov_b32 v211, 0
v_mov_b32 v212, 0
v_mov_b32 v213, 0
v_mov_b32 v214, 0
v_mov_b32 v215, 0
v_mov_b32 v216, 0
v_mov_b32 v217, 0
v_mov_b32 v218, 0
v_mov_b32 v219, 0
v_mov_b32 v220, 0
v_mov_b32 v221, 0
v_mov_b32 v222, 0
v_mov_b32 v223, 0
v_mov_b32 v224, 0
v_mov_b32 v225, 0
v_mov_b32 v226, 0
v_mov_b32 v227, 0
v_mov_b32 v228, 0
v_mov_b32 v229, 0
v_mov_b32 v230, 0
v_mov_b32 v231, 0
v_mov_b32 v232, 0
v_mov_b32 v233, 0
v_mov_b32 v234, 0
v_mov_b32 v235, 0
v_mov_b32 v236, 0
v_mov_b32 v237, 0
v_mov_b32 v238, 0
v_mov_b32 v239, 0
v_mov_b32 v240, 0
v_mov_b32 v241, 0
v_mov_b32 v242, 0
v_mov_b32 v243, 0
v_mov_b32 v244, 0
v_mov_b32 v245, 0
v_mov_b32 v246, 0
v_mov_b32 v247, 0
v_mov_b32 v248, 0
v_mov_b32 v249, 0
v_mov_b32 v250, 0
v_mov_b32 v251, 0
v_mov_b32 v252, 0
v_mov_b32 v253, 0
v_mov_b32 v254, 0
v_mov_b32 v255, 0
s_mov_b32 s49, s55
s_mov_b32 s48, 0
s_waitcnt vmcnt(0)
s_branch fused_kernel_dstart
fused_kernel_gnogu:
s_waitcnt vmcnt(0)
s_barrier
s_add_u32 s62, s48, 0
s_cmp_lg_u32 s3, 0
s_cbranch_scc1 fused_kernel_kvf_17
s_lshl_b32 s68, s62, 7
s_add_u32 s68, s68, 0x5b00000
v_mov_b32 v13, 1
v_mov_b32 v14, 0
s_mov_b64 s[70:71], exec
s_mov_b64 exec, 1
buffer_atomic_add v13, v14, s[4:7], s68 offen
s_mov_b64 exec, s[70:71]
fused_kernel_kvf_17:
s_add_u32 s58, s48, 0
s_lshl_b32 s58, s58, 7
s_add_u32 s58, s58, 0x5b00000
s_add_u32 s59, s48, 48
s_lshl_b32 s59, s59, 7
s_add_u32 s59, s59, 0x5b00000
s_add_u32 s66, s48, 32
s_lshl_b32 s66, s66, 7
s_add_u32 s66, s66, 0x5b00000
s_mov_b32 s66, s58
v_mov_b32 v13, s66
v_writelane_b32 v13, s58, 0
v_writelane_b32 v13, s59, 1
buffer_load_dword v14, v13, s[4:7], 0 offen sc1
s_and_b32 s28, s2, 7
s_lshr_b32 s29, s2, 3
s_lshr_b32 s30, s29, 4
s_lshl_b32 s8, s28, 1
s_add_u32 s8, s8, s30
s_bfe_u32 s9, s29, 0x30001
s_and_b32 s10, s29, 1
s_lshl_b32 s37, s8, 3
s_add_u32 s37, s37, s9
s_lshl_b32 s33, s3, 12
s_sub_u32 s22, 15, s9
s_lshl_b32 s29, s22, 2
s_add_u32 s29, s29, 4
s_cmp_eq_u32 s9, 0
s_cselect_b32 s30, 40, 38
s_min_u32 s30, s29, s30
s_sub_u32 s11, s29, s30
s_lshl_b32 s58, s9, 2
s_add_u32 s58, s58, 4
s_cmp_eq_u32 s11, 0
s_cselect_b32 s32, 0, 1
s_cselect_b32 s38, 0, 3
s_cmp_eq_u32 s10, 0
s_cselect_b32 s32, s32, s38
s_cselect_b32 s34, s30, s58
s_cselect_b32 s22, s22, s9
s_mov_b32 s35, 0
s_lshl_b32 s28, s8, 20
s_add_u32 s28, s28, s33
s_add_u32 s12, s28, 0x1200000
s_add_u32 s13, s28, 0x2200000
s_lshl_b32 s31, s58, 14
s_add_u32 s14, s12, s31
s_add_u32 s15, s13, s31
s_lshl_b32 s31, s30, 14
s_add_u32 s16, s12, s31
s_add_u32 s17, s13, s31
s_cmp_eq_u32 s32, 3
s_cselect_b32 s14, s14, -1
s_cselect_b32 s15, s15, -1
s_add_u32 s20, s33, 163840
s_mov_b32 s25, s30
s_sub_u32 s39, s58, 7
s_cmp_eq_u32 s32, 3
s_cselect_b32 s39, s39, -1
s_cmp_eq_u32 s9, 0
s_cselect_b32 s39, -1, s39
s_cmp_eq_u32 s10, 0
s_cselect_b32 s39, 25, s39
s_mov_b32 s38, 0
s_cmp_eq_u32 s9, 0
s_cselect_b32 s59, 1, 0
s_cmp_eq_u32 s32, 3
s_cselect_b32 s59, s59, 0
s_lshl_b32 s24, s22, 2
s_mov_b32 s23, s35
s_sub_u32 s21, s34, 2
s_lshr_b32 s21, s21, 1
s_lshl_b32 s28, s8, 6
s_lshl_b32 s29, s22, 2
s_add_u32 s28, s28, s29
s_add_u32 s28, s28, s3
s_lshl_b32 s28, s28, 14
s_add_u32 s36, s28, 0x200000
v_lshlrev_b32 v12, 4, v1
v_bfe_u32 v0, v1, 4, 1
v_lshlrev_b32 v0, 13, v0
v_lshrrev_b32 v16, 5, v1
v_lshl_add_u32 v0, v16, 8, v0
v_and_b32 v16, 15, v1
v_lshl_add_u32 v0, v16, 4, v0
v_mov_b32 v126, 0
v_subrev_u32 v2, s33, v0
v_mov_b32 v10, 0x5b800000
v_lshrrev_b32 v16, 5, v1
v_lshlrev_b32 v16, 2, v16
v_and_b32 v17, 31, v1
v_sub_u32 v9, v16, v17
v_bfe_u32 v16, v1, 4, 1
s_mov_b32 s28, 188416
v_mul_lo_u32 v16, v16, s28
v_lshrrev_b32 v17, 5, v1
v_lshl_add_u32 v16, v17, 8, v16
v_and_b32 v17, 15, v1
v_lshl_add_u32 v11, v17, 4, v16
s_waitcnt vmcnt(0) lgkmcnt(0)
s_mov_b32 s67, 0x80000
fused_kernel_dpoll_19:
v_readlane_b32 s66, v14, 0
v_readlane_b32 s68, v14, 1
v_readlane_b32 s69, v14, 2
s_sub_u32 s67, s67, 1
s_cmp_eq_u32 s67, 0
s_cbranch_scc1 fused_kernel_dok_18
s_min_u32 s66, s66, s68
s_min_u32 s66, s66, s69
s_cmp_ge_u32 s66, 8
s_cbranch_scc1 fused_kernel_dok_18
s_sleep 1
buffer_load_dword v14, v13, s[4:7], 0 offen sc1
s_waitcnt vmcnt(0)
s_branch fused_kernel_dpoll_19
fused_kernel_dok_18:
s_barrier
s_add_u32 s28, s36, 0
buffer_load_dwordx4 a[0:3], v0, s[4:7], s28 offen offset:0
buffer_load_dwordx4 a[4:7], v0, s[4:7], s28 offen offset:512
buffer_load_dwordx4 a[8:11], v0, s[4:7], s28 offen offset:1024
buffer_load_dwordx4 a[12:15], v0, s[4:7], s28 offen offset:1536
buffer_load_dwordx4 a[16:19], v0, s[4:7], s28 offen offset:2048
buffer_load_dwordx4 a[20:23], v0, s[4:7], s28 offen offset:2560
buffer_load_dwordx4 a[24:27], v0, s[4:7], s28 offen offset:3072
buffer_load_dwordx4 a[28:31], v0, s[4:7], s28 offen offset:3584
s_add_u32 s28, s36, 4096
buffer_load_dwordx4 a[32:35], v0, s[4:7], s28 offen offset:0
buffer_load_dwordx4 a[36:39], v0, s[4:7], s28 offen offset:512
buffer_load_dwordx4 a[40:43], v0, s[4:7], s28 offen offset:1024
buffer_load_dwordx4 a[44:47], v0, s[4:7], s28 offen offset:1536
buffer_load_dwordx4 a[48:51], v0, s[4:7], s28 offen offset:2048
buffer_load_dwordx4 a[52:55], v0, s[4:7], s28 offen offset:2560
buffer_load_dwordx4 a[56:59], v0, s[4:7], s28 offen offset:3072
buffer_load_dwordx4 a[60:63], v0, s[4:7], s28 offen offset:3584
s_add_u32 m0, s33, 0
s_nop 0
buffer_load_dwordx4 v12, s[4:7], s12 offen offset:0 lds
buffer_load_dwordx4 v12, s[4:7], s12 offen offset:1024 lds
buffer_load_dwordx4 v12, s[4:7], s12 offen offset:2048 lds
buffer_load_dwordx4 v12, s[4:7], s12 offen offset:3072 lds
s_add_u32 s12, s12, 16384
s_cmp_eq_u32 s12, s14
s_cselect_b32 s12, s16, s12
s_add_u32 m0, s33, 32768
s_nop 0
buffer_load_dwordx4 v12, s[4:7], s12 offen offset:0 lds
buffer_load_dwordx4 v12, s[4:7], s12 offen offset:1024 lds
buffer_load_dwordx4 v12, s[4:7], s12 offen offset:2048 lds
buffer_load_dwordx4 v12, s[4:7], s12 offen offset:3072 lds
s_add_u32 s12, s12, 16384
s_cmp_eq_u32 s12, s14
s_cselect_b32 s12, s16, s12
v_mov_b32 v128, 0
v_mov_b32 v129, 0
v_mov_b32 v130, 0
v_mov_b32 v131, 0
v_mov_b32 v132, 0
v_mov_b32 v133, 0
v_mov_b32 v134, 0
v_mov_b32 v135, 0
v_mov_b32 v136, 0
v_mov_b32 v137, 0
v_mov_b32 v138, 0
v_mov_b32 v139, 0
v_mov_b32 v140, 0
v_mov_b32 v141, 0
v_mov_b32 v142, 0
v_mov_b32 v143, 0
v_mov_b32 v144, 0
v_mov_b32 v145, 0
v_mov_b32 v146, 0
v_mov_b32 v147, 0
v_mov_b32 v148, 0
v_mov_b32 v149, 0
v_mov_b32 v150, 0
v_mov_b32 v151, 0
v_mov_b32 v152, 0
v_mov_b32 v153, 0
v_mov_b32 v154, 0
v_mov_b32 v155, 0
v_mov_b32 v156, 0
v_mov_b32 v157, 0
v_mov_b32 v158, 0
v_mov_b32 v159, 0
v_mov_b32 v160, 0
v_mov_b32 v161, 0
v_mov_b32 v162, 0
v_mov_b32 v163, 0
v_mov_b32 v164, 0
v_mov_b32 v165, 0
v_mov_b32 v166, 0
v_mov_b32 v167, 0
v_mov_b32 v168, 0
v_mov_b32 v169, 0
v_mov_b32 v170, 0
v_mov_b32 v171, 0
v_mov_b32 v172, 0
v_mov_b32 v173, 0
v_mov_b32 v174, 0
v_mov_b32 v175, 0
v_mov_b32 v176, 0
v_mov_b32 v177, 0
v_mov_b32 v178, 0
v_mov_b32 v179, 0
v_mov_b32 v180, 0
v_mov_b32 v181, 0
v_mov_b32 v182, 0
v_mov_b32 v183, 0
v_mov_b32 v184, 0
v_mov_b32 v185, 0
v_mov_b32 v186, 0
v_mov_b32 v187, 0
v_mov_b32 v188, 0
v_mov_b32 v189, 0
v_mov_b32 v190, 0
v_mov_b32 v191, 0
v_mov_b32 v192, 0
v_mov_b32 v193, 0
v_mov_b32 v194, 0
v_mov_b32 v195, 0
v_mov_b32 v196, 0
v_mov_b32 v197, 0
v_mov_b32 v198, 0
v_mov_b32 v199, 0
v_mov_b32 v200, 0
v_mov_b32 v201, 0
v_mov_b32 v202, 0
v_mov_b32 v203, 0
v_mov_b32 v204, 0
v_mov_b32 v205, 0
v_mov_b32 v206, 0
v_mov_b32 v207, 0
v_mov_b32 v208, 0
v_mov_b32 v209, 0
v_mov_b32 v210, 0
v_mov_b32 v211, 0
v_mov_b32 v212, 0
v_mov_b32 v213, 0
v_mov_b32 v214, 0
v_mov_b32 v215, 0
v_mov_b32 v216, 0
v_mov_b32 v217, 0
v_mov_b32 v218, 0
v_mov_b32 v219, 0
v_mov_b32 v220, 0
v_mov_b32 v221, 0
v_mov_b32 v222, 0
v_mov_b32 v223, 0
v_mov_b32 v224, 0
v_mov_b32 v225, 0
v_mov_b32 v226, 0
v_mov_b32 v227, 0
v_mov_b32 v228, 0
v_mov_b32 v229, 0
v_mov_b32 v230, 0
v_mov_b32 v231, 0
v_mov_b32 v232, 0
v_mov_b32 v233, 0
v_mov_b32 v234, 0
v_mov_b32 v235, 0
v_mov_b32 v236, 0
v_mov_b32 v237, 0
v_mov_b32 v238, 0
v_mov_b32 v239, 0
v_mov_b32 v240, 0
v_mov_b32 v241, 0
v_mov_b32 v242, 0
v_mov_b32 v243, 0
v_mov_b32 v244, 0
v_mov_b32 v245, 0
v_mov_b32 v246, 0
v_mov_b32 v247, 0
v_mov_b32 v248, 0
v_mov_b32 v249, 0
v_mov_b32 v250, 0
v_mov_b32 v251, 0
v_mov_b32 v252, 0
v_mov_b32 v253, 0
v_mov_b32 v254, 0
v_mov_b32 v255, 0
s_mov_b32 s49, 0xffff
s_mov_b32 s48, 0
s_waitcnt vmcnt(0)
s_branch fused_kernel_dstart
fused_kernel_swa_6:
s_cmp_lg_u32 s3, 0
s_cbranch_scc1 fused_kernelg_xok_20
s_mov_b32 s60, 0x40000
s_movk_i32 s61, 0x5555
s_waitcnt vmcnt(12)
s_branch fused_kernelg_xchk_22
fused_kernelg_xpoll_21:
buffer_load_dword v14, v12, s[64:67], 0 offen sc1
s_waitcnt vmcnt(0)
fused_kernelg_xchk_22:
v_cmp_gt_u32 vcc, 16, v14
s_sub_u32 s60, s60, 1
s_cmp_eq_u32 s60, 0
s_cbranch_scc1 fused_kernelg_xok_20
s_and_b32 s40, vcc_lo, s61
s_cbranch_scc0 fused_kernelg_xok_20
s_sleep 2
s_branch fused_kernelg_xpoll_21
fused_kernelg_xok_20:
s_mov_b64 s[8:9], s[20:21]
s_mov_b64 s[10:11], s[22:23]
s_mov_b32 s28, s52
s_mov_b32 s29, s54
s_mov_b32 s30, s16
v_lshrrev_b32 v14, 4, v1
s_lshl_b32 s40, s50, 2
v_add_u32 v14, s40, v14
v_and_b32 v2, 7, v1
v_xor_b32 v2, v2, v14
v_lshlrev_b32 v2, 4, v2
v_lshrrev_b32 v0, 3, v1
s_movk_i32 s40, 896
v_mul_lo_u32 v0, v0, s40
v_add_u32 v2, v2, v0
s_branch fused_kernel_swab_7
fused_kernel_swa_10:
s_cmp_lg_u32 s3, 0
s_cbranch_scc1 fused_kernelg_xok_23
s_mov_b32 s60, 0x40000
s_movk_i32 s61, 0x5555
s_waitcnt vmcnt(12)
s_branch fused_kernelg_xchk_25
fused_kernelg_xpoll_24:
buffer_load_dword v14, v12, s[64:67], 0 offen sc1
s_waitcnt vmcnt(0)
fused_kernelg_xchk_25:
v_cmp_gt_u32 vcc, 16, v14
s_sub_u32 s60, s60, 1
s_cmp_eq_u32 s60, 0
s_cbranch_scc1 fused_kernelg_xok_23
s_and_b32 s40, vcc_lo, s61
s_cbranch_scc0 fused_kernelg_xok_23
s_sleep 2
s_branch fused_kernelg_xpoll_24
fused_kernelg_xok_23:
s_mov_b64 s[8:9], s[20:21]
s_mov_b64 s[10:11], s[22:23]
s_mov_b32 s28, s52
s_mov_b32 s29, s54
s_mov_b32 s30, s16
v_lshrrev_b32 v14, 4, v1
s_lshl_b32 s40, s50, 2
v_add_u32 v14, s40, v14
v_and_b32 v2, 7, v1
v_xor_b32 v2, v2, v14
v_lshlrev_b32 v2, 4, v2
v_lshrrev_b32 v0, 3, v1
s_movk_i32 s40, 896
v_mul_lo_u32 v0, v0, s40
v_add_u32 v2, v2, v0
s_branch fused_kernel_swab_11
fused_kernel_clsq:
v_lshrrev_b32 v28, 4, v1
s_lshl_b32 s40, s50, 2
v_add_u32 v28, s40, v28
v_and_b32 v2, 7, v1
v_xor_b32 v2, v2, v28
v_lshlrev_b32 v2, 4, v2
v_lshrrev_b32 v29, 3, v1
s_movk_i32 s40, 896
v_mul_lo_u32 v29, v29, s40
v_add_u32 v2, v2, v29
v_lshrrev_b32 v28, 4, v1
s_lshl_b32 s40, s50, 2
v_add_u32 v28, s40, v28
v_and_b32 v3, 15, v1
v_lshlrev_b32 v28, 1, v28
v_xor_b32 v3, v3, v28
v_lshlrev_b32 v3, 4, v3
v_lshrrev_b32 v29, 4, v1
s_movk_i32 s40, 8192
v_mul_lo_u32 v29, v29, s40
v_add_u32 v3, v3, v29
s_lshr_b32 s58, s2, 4
s_lshl_b32 s58, s58, 3
s_and_b32 s59, s2, 7
s_add_u32 s58, s58, s59
s_cmp_ge_u32 s58, 128
s_cselect_b32 s68, s90, s82
s_cselect_b32 s69, s91, s83
s_cselect_b32 s61, 128, 0
s_mov_b32 s70, 0x380000
s_cselect_b32 s70, 0x188000, s70
s_and_b32 s69, s69, 0xffff
s_mov_b32 s71, 0x20000
s_sub_u32 s61, s58, s61
s_mul_i32 s61, s61, 28672
s_mul_i32 s62, s3, 7168
s_add_u32 s61, s61, s62
s_cmp_ge_u32 s58, 184
s_cselect_b32 s61, 0x70000000, s61
v_lshlrev_b32 v30, 4, v1
s_add_u32 m0, s62, 0
s_add_u32 s40, s61, 0
buffer_load_dwordx4 v30, s[68:71], s40 offen lds
s_add_u32 m0, s62, 1024
s_add_u32 s40, s61, 1024
buffer_load_dwordx4 v30, s[68:71], s40 offen lds
s_add_u32 m0, s62, 2048
s_add_u32 s40, s61, 2048
buffer_load_dwordx4 v30, s[68:71], s40 offen lds
s_add_u32 m0, s62, 3072
s_add_u32 s40, s61, 3072
buffer_load_dwordx4 v30, s[68:71], s40 offen lds
s_add_u32 m0, s62, 4096
s_add_u32 s40, s61, 4096
buffer_load_dwordx4 v30, s[68:71], s40 offen lds
s_add_u32 m0, s62, 5120
s_add_u32 s40, s61, 5120
buffer_load_dwordx4 v30, s[68:71], s40 offen lds
s_add_u32 m0, s62, 6144
s_add_u32 s40, s61, 6144
buffer_load_dwordx4 v30, s[68:71], s40 offen lds
s_add_u32 s59, s58, 128
s_cmp_ge_u32 s59, 128
s_cselect_b32 s68, s90, s82
s_cselect_b32 s69, s91, s83
s_cselect_b32 s61, 128, 0
s_mov_b32 s70, 0x380000
s_cselect_b32 s70, 0x188000, s70
s_and_b32 s69, s69, 0xffff
s_mov_b32 s71, 0x20000
s_sub_u32 s61, s59, s61
s_mul_i32 s61, s61, 28672
s_mul_i32 s62, s3, 7168
s_add_u32 s61, s61, s62
s_cmp_ge_u32 s59, 184
s_cselect_b32 s61, 0x70000000, s61
v_lshlrev_b32 v30, 4, v1
s_add_u32 m0, s62, 32768
s_add_u32 s40, s61, 0
buffer_load_dwordx4 v30, s[68:71], s40 offen lds
s_add_u32 m0, s62, 33792
s_add_u32 s40, s61, 1024
buffer_load_dwordx4 v30, s[68:71], s40 offen lds
s_add_u32 m0, s62, 34816
s_add_u32 s40, s61, 2048
buffer_load_dwordx4 v30, s[68:71], s40 offen lds
s_add_u32 m0, s62, 35840
s_add_u32 s40, s61, 3072
buffer_load_dwordx4 v30, s[68:71], s40 offen lds
s_add_u32 m0, s62, 36864
s_add_u32 s40, s61, 4096
buffer_load_dwordx4 v30, s[68:71], s40 offen lds
s_add_u32 m0, s62, 37888
s_add_u32 s40, s61, 5120
buffer_load_dwordx4 v30, s[68:71], s40 offen lds
s_add_u32 m0, s62, 38912
s_add_u32 s40, s61, 6144
buffer_load_dwordx4 v30, s[68:71], s40 offen lds
s_add_u32 m0, s43, 0
s_nop 0
buffer_load_dwordx4 v3, s[12:15], s31 offen lds
s_add_u32 s31, s31, s32
s_add_u32 m0, s43, 1024
s_nop 0
buffer_load_dwordx4 v3, s[12:15], s31 offen lds
s_add_u32 s31, s31, s33
s_add_u32 m0, s43, 4096
s_nop 0
buffer_load_dwordx4 v3, s[12:15], s31 offen lds
s_add_u32 s31, s31, s32
s_add_u32 m0, s43, 5120
s_nop 0
buffer_load_dwordx4 v3, s[12:15], s31 offen lds
s_add_u32 s31, s31, s33
s_add_u32 m0, s43, 16384
s_nop 0
buffer_load_dwordx4 v3, s[12:15], s31 offen lds
s_add_u32 s31, s31, s32
s_add_u32 m0, s43, 17408
s_nop 0
buffer_load_dwordx4 v3, s[12:15], s31 offen lds
s_add_u32 s31, s31, s33
s_add_u32 m0, s43, 20480
s_nop 0
buffer_load_dwordx4 v3, s[12:15], s31 offen lds
s_add_u32 s31, s31, s32
s_add_u32 m0, s43, 21504
s_nop 0
buffer_load_dwordx4 v3, s[12:15], s31 offen lds
s_add_u32 s31, s31, s33
s_add_u32 m0, s43, 32768
s_nop 0
buffer_load_dwordx4 v3, s[12:15], s31 offen lds
s_add_u32 s31, s31, s32
s_add_u32 m0, s43, 33792
s_nop 0
buffer_load_dwordx4 v3, s[12:15], s31 offen lds
s_add_u32 s31, s31, s33
s_add_u32 m0, s43, 36864
s_nop 0
buffer_load_dwordx4 v3, s[12:15], s31 offen lds
s_add_u32 s31, s31, s32
s_add_u32 m0, s43, 37888
s_nop 0
buffer_load_dwordx4 v3, s[12:15], s31 offen lds
s_add_u32 s31, s31, s33
s_add_u32 m0, s43, 49152
s_nop 0
buffer_load_dwordx4 v3, s[12:15], s31 offen lds
s_add_u32 s31, s31, s32
s_add_u32 m0, s43, 50176
s_nop 0
buffer_load_dwordx4 v3, s[12:15], s31 offen lds
s_add_u32 s31, s31, s33
s_add_u32 m0, s43, 53248
s_nop 0
buffer_load_dwordx4 v3, s[12:15], s31 offen lds
s_add_u32 s31, s31, s32
s_add_u32 m0, s43, 54272
s_nop 0
buffer_load_dwordx4 v3, s[12:15], s31 offen lds
s_add_u32 s31, s31, s33
s_add_u32 s40, s96, 0x0
s_addc_u32 s60, s97, 0
s_mov_b32 s68, s40
s_and_b32 s69, s60, 0xffff
s_mov_b32 s70, 0x1c0000
s_mov_b32 s71, 0x20000
s_waitcnt vmcnt(30)
v_lshlrev_b32 v44, 16, v36
v_and_b32 v45, 0xffff0000, v36
v_lshlrev_b32 v46, 16, v37
v_and_b32 v47, 0xffff0000, v37
v_lshlrev_b32 v48, 16, v38
v_and_b32 v49, 0xffff0000, v38
v_lshlrev_b32 v50, 16, v39
v_and_b32 v51, 0xffff0000, v39
v_add_f32 v60, v44, v45
v_add_f32 v60, v60, v46
v_add_f32 v60, v60, v47
v_add_f32 v60, v60, v48
v_add_f32 v60, v60, v49
v_add_f32 v60, v60, v50
v_add_f32 v60, v60, v51
v_lshlrev_b32 v52, 16, v40
v_and_b32 v53, 0xffff0000, v40
v_lshlrev_b32 v54, 16, v41
v_and_b32 v55, 0xffff0000, v41
v_lshlrev_b32 v56, 16, v42
v_and_b32 v57, 0xffff0000, v42
v_lshlrev_b32 v58, 16, v43
v_and_b32 v59, 0xffff0000, v43
v_add_f32 v61, v52, v53
v_add_f32 v61, v61, v54
v_add_f32 v61, v61, v55
v_add_f32 v61, v61, v56
v_add_f32 v61, v61, v57
v_add_f32 v61, v61, v58
v_add_f32 v61, v61, v59
v_lshlrev_b32 v108, 16, v100
v_and_b32 v109, 0xffff0000, v100
v_lshlrev_b32 v110, 16, v101
v_and_b32 v111, 0xffff0000, v101
v_lshlrev_b32 v112, 16, v102
v_and_b32 v113, 0xffff0000, v102
v_lshlrev_b32 v114, 16, v103
v_and_b32 v115, 0xffff0000, v103
v_add_f32 v124, v108, v109
v_add_f32 v124, v124, v110
v_add_f32 v124, v124, v111
v_add_f32 v124, v124, v112
v_add_f32 v124, v124, v113
v_add_f32 v124, v124, v114
v_add_f32 v124, v124, v115
v_lshlrev_b32 v116, 16, v104
v_and_b32 v117, 0xffff0000, v104
v_lshlrev_b32 v118, 16, v105
v_and_b32 v119, 0xffff0000, v105
v_lshlrev_b32 v120, 16, v106
v_and_b32 v121, 0xffff0000, v106
v_lshlrev_b32 v122, 16, v107
v_and_b32 v123, 0xffff0000, v107
v_add_f32 v125, v116, v117
v_add_f32 v125, v125, v118
v_add_f32 v125, v125, v119
v_add_f32 v125, v125, v120
v_add_f32 v125, v125, v121
v_add_f32 v125, v125, v122
v_add_f32 v125, v125, v123
s_nop 1
v_add_f32_dpp v60, v60, v60 row_ror:8 row_mask:0xf bank_mask:0xf
v_add_f32_dpp v61, v61, v61 row_ror:8 row_mask:0xf bank_mask:0xf
v_add_f32_dpp v124, v124, v124 row_ror:8 row_mask:0xf bank_mask:0xf
v_add_f32_dpp v125, v125, v125 row_ror:8 row_mask:0xf bank_mask:0xf
s_nop 1
v_add_f32_dpp v60, v60, v60 row_ror:4 row_mask:0xf bank_mask:0xf
v_add_f32_dpp v61, v61, v61 row_ror:4 row_mask:0xf bank_mask:0xf
v_add_f32_dpp v124, v124, v124 row_ror:4 row_mask:0xf bank_mask:0xf
v_add_f32_dpp v125, v125, v125 row_ror:4 row_mask:0xf bank_mask:0xf
s_nop 1
v_add_f32_dpp v60, v60, v60 row_ror:2 row_mask:0xf bank_mask:0xf
v_add_f32_dpp v61, v61, v61 row_ror:2 row_mask:0xf bank_mask:0xf
v_add_f32_dpp v124, v124, v124 row_ror:2 row_mask:0xf bank_mask:0xf
v_add_f32_dpp v125, v125, v125 row_ror:2 row_mask:0xf bank_mask:0xf
s_nop 1
v_add_f32_dpp v60, v60, v60 row_ror:1 row_mask:0xf bank_mask:0xf
v_add_f32_dpp v61, v61, v61 row_ror:1 row_mask:0xf bank_mask:0xf
v_add_f32_dpp v124, v124, v124 row_ror:1 row_mask:0xf bank_mask:0xf
v_add_f32_dpp v125, v125, v125 row_ror:1 row_mask:0xf bank_mask:0xf
v_mov_b32 v62, v60
v_mov_b32 v63, v61
v_mov_b32 v126, v124
v_mov_b32 v127, v125
s_nop 1
v_permlane16_swap_b32 v60, v62
v_permlane16_swap_b32 v61, v63
v_permlane16_swap_b32 v124, v126
v_permlane16_swap_b32 v125, v127
s_nop 1
v_add_f32 v60, v60, v62
v_add_f32 v61, v61, v63
v_add_f32 v124, v124, v126
v_add_f32 v125, v125, v127
v_mov_b32 v62, v60
v_mov_b32 v63, v61
v_mov_b32 v126, v124
v_mov_b32 v127, v125
s_nop 1
v_permlane32_swap_b32 v60, v62
v_permlane32_swap_b32 v61, v63
v_permlane32_swap_b32 v124, v126
v_permlane32_swap_b32 v125, v127
s_nop 1
v_add_f32 v60, v60, v62
v_add_f32 v61, v61, v63
v_add_f32 v124, v124, v126
v_add_f32 v125, v125, v127
v_cmp_gt_u32 vcc, 56, v1
v_mul_f32 v60, 0x3b124925, v60
v_sub_f32 v62, v44, v60
v_mul_f32 v64, v62, v62
v_sub_f32 v62, v45, v60
v_fmac_f32 v64, v62, v62
v_sub_f32 v62, v46, v60
v_fmac_f32 v64, v62, v62
v_sub_f32 v62, v47, v60
v_fmac_f32 v64, v62, v62
v_sub_f32 v62, v48, v60
v_fmac_f32 v64, v62, v62
v_sub_f32 v62, v49, v60
v_fmac_f32 v64, v62, v62
v_sub_f32 v62, v50, v60
v_fmac_f32 v64, v62, v62
v_sub_f32 v62, v51, v60
v_fmac_f32 v64, v62, v62
v_cndmask_b32 v64, 0, v64, vcc
v_mul_f32 v61, 0x3b124925, v61
v_sub_f32 v63, v52, v61
v_mul_f32 v65, v63, v63
v_sub_f32 v63, v53, v61
v_fmac_f32 v65, v63, v63
v_sub_f32 v63, v54, v61
v_fmac_f32 v65, v63, v63
v_sub_f32 v63, v55, v61
v_fmac_f32 v65, v63, v63
v_sub_f32 v63, v56, v61
v_fmac_f32 v65, v63, v63
v_sub_f32 v63, v57, v61
v_fmac_f32 v65, v63, v63
v_sub_f32 v63, v58, v61
v_fmac_f32 v65, v63, v63
v_sub_f32 v63, v59, v61
v_fmac_f32 v65, v63, v63
v_cndmask_b32 v65, 0, v65, vcc
v_mul_f32 v124, 0x3b124925, v124
v_sub_f32 v126, v108, v124
v_mul_f32 v128, v126, v126
v_sub_f32 v126, v109, v124
v_fmac_f32 v128, v126, v126
v_sub_f32 v126, v110, v124
v_fmac_f32 v128, v126, v126
v_sub_f32 v126, v111, v124
v_fmac_f32 v128, v126, v126
v_sub_f32 v126, v112, v124
v_fmac_f32 v128, v126, v126
v_sub_f32 v126, v113, v124
v_fmac_f32 v128, v126, v126
v_sub_f32 v126, v114, v124
v_fmac_f32 v128, v126, v126
v_sub_f32 v126, v115, v124
v_fmac_f32 v128, v126, v126
v_cndmask_b32 v128, 0, v128, vcc
v_mul_f32 v125, 0x3b124925, v125
v_sub_f32 v127, v116, v125
v_mul_f32 v129, v127, v127
v_sub_f32 v127, v117, v125
v_fmac_f32 v129, v127, v127
v_sub_f32 v127, v118, v125
v_fmac_f32 v129, v127, v127
v_sub_f32 v127, v119, v125
v_fmac_f32 v129, v127, v127
v_sub_f32 v127, v120, v125
v_fmac_f32 v129, v127, v127
v_sub_f32 v127, v121, v125
v_fmac_f32 v129, v127, v127
v_sub_f32 v127, v122, v125
v_fmac_f32 v129, v127, v127
v_sub_f32 v127, v123, v125
v_fmac_f32 v129, v127, v127
v_cndmask_b32 v129, 0, v129, vcc
s_nop 1
v_add_f32_dpp v64, v64, v64 row_ror:8 row_mask:0xf bank_mask:0xf
v_add_f32_dpp v65, v65, v65 row_ror:8 row_mask:0xf bank_mask:0xf
v_add_f32_dpp v128, v128, v128 row_ror:8 row_mask:0xf bank_mask:0xf
v_add_f32_dpp v129, v129, v129 row_ror:8 row_mask:0xf bank_mask:0xf
s_nop 1
v_add_f32_dpp v64, v64, v64 row_ror:4 row_mask:0xf bank_mask:0xf
v_add_f32_dpp v65, v65, v65 row_ror:4 row_mask:0xf bank_mask:0xf
v_add_f32_dpp v128, v128, v128 row_ror:4 row_mask:0xf bank_mask:0xf
v_add_f32_dpp v129, v129, v129 row_ror:4 row_mask:0xf bank_mask:0xf
s_nop 1
v_add_f32_dpp v64, v64, v64 row_ror:2 row_mask:0xf bank_mask:0xf
v_add_f32_dpp v65, v65, v65 row_ror:2 row_mask:0xf bank_mask:0xf
v_add_f32_dpp v128, v128, v128 row_ror:2 row_mask:0xf bank_mask:0xf
v_add_f32_dpp v129, v129, v129 row_ror:2 row_mask:0xf bank_mask:0xf
s_nop 1
v_add_f32_dpp v64, v64, v64 row_ror:1 row_mask:0xf bank_mask:0xf
v_add_f32_dpp v65, v65, v65 row_ror:1 row_mask:0xf bank_mask:0xf
v_add_f32_dpp v128, v128, v128 row_ror:1 row_mask:0xf bank_mask:0xf
v_add_f32_dpp v129, v129, v129 row_ror:1 row_mask:0xf bank_mask:0xf
v_mov_b32 v62, v64
v_mov_b32 v63, v65
v_mov_b32 v126, v128
v_mov_b32 v127, v129
s_nop 1
v_permlane16_swap_b32 v64, v62
v_permlane16_swap_b32 v65, v63
v_permlane16_swap_b32 v128, v126
v_permlane16_swap_b32 v129, v127
s_nop 1
v_add_f32 v64, v64, v62
v_add_f32 v65, v65, v63
v_add_f32 v128, v128, v126
v_add_f32 v129, v129, v127
v_mov_b32 v62, v64
v_mov_b32 v63, v65
v_mov_b32 v126, v128
v_mov_b32 v127, v129
s_nop 1
v_permlane32_swap_b32 v64, v62
v_permlane32_swap_b32 v65, v63
v_permlane32_swap_b32 v128, v126
v_permlane32_swap_b32 v129, v127
s_nop 1
v_add_f32 v64, v64, v62
v_add_f32 v65, v65, v63
v_add_f32 v128, v128, v126
v_add_f32 v129, v129, v127
v_mul_f32 v64, 0x3b124925, v64
v_cvt_pk_bf16_f32 v64, v64, v64
v_lshlrev_b32 v64, 16, v64
v_add_f32 v64, 0x3727c5ac, v64
v_cvt_pk_bf16_f32 v64, v64, v64
v_lshlrev_b32 v64, 16, v64
v_sqrt_f32 v64, v64
v_mul_f32 v65, 0x3b124925, v65
v_cvt_pk_bf16_f32 v65, v65, v65
v_lshlrev_b32 v65, 16, v65
v_add_f32 v65, 0x3727c5ac, v65
v_cvt_pk_bf16_f32 v65, v65, v65
v_lshlrev_b32 v65, 16, v65
v_sqrt_f32 v65, v65
v_mul_f32 v128, 0x3b124925, v128
v_cvt_pk_bf16_f32 v128, v128, v128
v_lshlrev_b32 v128, 16, v128
v_add_f32 v128, 0x3727c5ac, v128
v_cvt_pk_bf16_f32 v128, v128, v128
v_lshlrev_b32 v128, 16, v128
v_sqrt_f32 v128, v128
v_mul_f32 v129, 0x3b124925, v129
v_cvt_pk_bf16_f32 v129, v129, v129
v_lshlrev_b32 v129, 16, v129
v_add_f32 v129, 0x3727c5ac, v129
v_cvt_pk_bf16_f32 v129, v129, v129
v_lshlrev_b32 v129, 16, v129
v_sqrt_f32 v129, v129
s_nop 0
v_cvt_pk_bf16_f32 v64, v64, v64
v_lshlrev_b32 v64, 16, v64
v_cvt_pk_bf16_f32 v60, v60, v60
v_lshlrev_b32 v60, 16, v60
v_rcp_f32 v62, v64
v_cvt_pk_bf16_f32 v65, v65, v65
v_lshlrev_b32 v65, 16, v65
v_cvt_pk_bf16_f32 v61, v61, v61
v_lshlrev_b32 v61, 16, v61
v_rcp_f32 v63, v65
v_cvt_pk_bf16_f32 v128, v128, v128
v_lshlrev_b32 v128, 16, v128
v_cvt_pk_bf16_f32 v124, v124, v124
v_lshlrev_b32 v124, 16, v124
v_rcp_f32 v126, v128
v_cvt_pk_bf16_f32 v129, v129, v129
v_lshlrev_b32 v129, 16, v129
v_cvt_pk_bf16_f32 v125, v125, v125
v_lshlrev_b32 v125, 16, v125
v_rcp_f32 v127, v129
s_nop 0
v_sub_f32 v44, v44, v60
v_sub_f32 v45, v45, v60
v_cvt_pk_bf16_f32 v66, v44, v45
v_lshlrev_b32 v44, 16, v66
v_and_b32 v45, 0xffff0000, v66
v_mul_f32 v67, v44, v62
v_fma_f32 v68, -v67, v64, v44
v_fma_f32 v44, v68, v62, v67
v_mul_f32 v67, v45, v62
v_fma_f32 v68, -v67, v64, v45
v_fma_f32 v45, v68, v62, v67
v_cvt_pk_bf16_f32 v36, v44, v45
v_sub_f32 v46, v46, v60
v_sub_f32 v47, v47, v60
v_cvt_pk_bf16_f32 v66, v46, v47
v_lshlrev_b32 v46, 16, v66
v_and_b32 v47, 0xffff0000, v66
v_mul_f32 v67, v46, v62
v_fma_f32 v68, -v67, v64, v46
v_fma_f32 v46, v68, v62, v67
v_mul_f32 v67, v47, v62
v_fma_f32 v68, -v67, v64, v47
v_fma_f32 v47, v68, v62, v67
v_cvt_pk_bf16_f32 v37, v46, v47
v_sub_f32 v48, v48, v60
v_sub_f32 v49, v49, v60
v_cvt_pk_bf16_f32 v66, v48, v49
v_lshlrev_b32 v48, 16, v66
v_and_b32 v49, 0xffff0000, v66
v_mul_f32 v67, v48, v62
v_fma_f32 v68, -v67, v64, v48
v_fma_f32 v48, v68, v62, v67
v_mul_f32 v67, v49, v62
v_fma_f32 v68, -v67, v64, v49
v_fma_f32 v49, v68, v62, v67
v_cvt_pk_bf16_f32 v38, v48, v49
v_sub_f32 v50, v50, v60
v_sub_f32 v51, v51, v60
v_cvt_pk_bf16_f32 v66, v50, v51
v_lshlrev_b32 v50, 16, v66
v_and_b32 v51, 0xffff0000, v66
v_mul_f32 v67, v50, v62
v_fma_f32 v68, -v67, v64, v50
v_fma_f32 v50, v68, v62, v67
v_mul_f32 v67, v51, v62
v_fma_f32 v68, -v67, v64, v51
v_fma_f32 v51, v68, v62, v67
v_cvt_pk_bf16_f32 v39, v50, v51
buffer_store_dwordx4 v[36:39], v32, s[68:71], 0 offen sc1
v_sub_f32 v52, v52, v61
v_sub_f32 v53, v53, v61
v_cvt_pk_bf16_f32 v69, v52, v53
v_lshlrev_b32 v52, 16, v69
v_and_b32 v53, 0xffff0000, v69
v_mul_f32 v70, v52, v63
v_fma_f32 v71, -v70, v65, v52
v_fma_f32 v52, v71, v63, v70
v_mul_f32 v70, v53, v63
v_fma_f32 v71, -v70, v65, v53
v_fma_f32 v53, v71, v63, v70
v_cvt_pk_bf16_f32 v40, v52, v53
v_sub_f32 v54, v54, v61
v_sub_f32 v55, v55, v61
v_cvt_pk_bf16_f32 v69, v54, v55
v_lshlrev_b32 v54, 16, v69
v_and_b32 v55, 0xffff0000, v69
v_mul_f32 v70, v54, v63
v_fma_f32 v71, -v70, v65, v54
v_fma_f32 v54, v71, v63, v70
v_mul_f32 v70, v55, v63
v_fma_f32 v71, -v70, v65, v55
v_fma_f32 v55, v71, v63, v70
v_cvt_pk_bf16_f32 v41, v54, v55
v_sub_f32 v56, v56, v61
v_sub_f32 v57, v57, v61
v_cvt_pk_bf16_f32 v69, v56, v57
v_lshlrev_b32 v56, 16, v69
v_and_b32 v57, 0xffff0000, v69
v_mul_f32 v70, v56, v63
v_fma_f32 v71, -v70, v65, v56
v_fma_f32 v56, v71, v63, v70
v_mul_f32 v70, v57, v63
v_fma_f32 v71, -v70, v65, v57
v_fma_f32 v57, v71, v63, v70
v_cvt_pk_bf16_f32 v42, v56, v57
v_sub_f32 v58, v58, v61
v_sub_f32 v59, v59, v61
v_cvt_pk_bf16_f32 v69, v58, v59
v_lshlrev_b32 v58, 16, v69
v_and_b32 v59, 0xffff0000, v69
v_mul_f32 v70, v58, v63
v_fma_f32 v71, -v70, v65, v58
v_fma_f32 v58, v71, v63, v70
v_mul_f32 v70, v59, v63
v_fma_f32 v71, -v70, v65, v59
v_fma_f32 v59, v71, v63, v70
v_cvt_pk_bf16_f32 v43, v58, v59
buffer_store_dwordx4 v[40:43], v32, s[68:71], 0 offen offset:896 sc1
v_sub_f32 v108, v108, v124
v_sub_f32 v109, v109, v124
v_cvt_pk_bf16_f32 v130, v108, v109
v_lshlrev_b32 v108, 16, v130
v_and_b32 v109, 0xffff0000, v130
v_mul_f32 v131, v108, v126
v_fma_f32 v132, -v131, v128, v108
v_fma_f32 v108, v132, v126, v131
v_mul_f32 v131, v109, v126
v_fma_f32 v132, -v131, v128, v109
v_fma_f32 v109, v132, v126, v131
v_cvt_pk_bf16_f32 v100, v108, v109
v_sub_f32 v110, v110, v124
v_sub_f32 v111, v111, v124
v_cvt_pk_bf16_f32 v130, v110, v111
v_lshlrev_b32 v110, 16, v130
v_and_b32 v111, 0xffff0000, v130
v_mul_f32 v131, v110, v126
v_fma_f32 v132, -v131, v128, v110
v_fma_f32 v110, v132, v126, v131
v_mul_f32 v131, v111, v126
v_fma_f32 v132, -v131, v128, v111
v_fma_f32 v111, v132, v126, v131
v_cvt_pk_bf16_f32 v101, v110, v111
v_sub_f32 v112, v112, v124
v_sub_f32 v113, v113, v124
v_cvt_pk_bf16_f32 v130, v112, v113
v_lshlrev_b32 v112, 16, v130
v_and_b32 v113, 0xffff0000, v130
v_mul_f32 v131, v112, v126
v_fma_f32 v132, -v131, v128, v112
v_fma_f32 v112, v132, v126, v131
v_mul_f32 v131, v113, v126
v_fma_f32 v132, -v131, v128, v113
v_fma_f32 v113, v132, v126, v131
v_cvt_pk_bf16_f32 v102, v112, v113
v_sub_f32 v114, v114, v124
v_sub_f32 v115, v115, v124
v_cvt_pk_bf16_f32 v130, v114, v115
v_lshlrev_b32 v114, 16, v130
v_and_b32 v115, 0xffff0000, v130
v_mul_f32 v131, v114, v126
v_fma_f32 v132, -v131, v128, v114
v_fma_f32 v114, v132, v126, v131
v_mul_f32 v131, v115, v126
v_fma_f32 v132, -v131, v128, v115
v_fma_f32 v115, v132, v126, v131
v_cvt_pk_bf16_f32 v103, v114, v115
buffer_store_dwordx4 v[100:103], v96, s[68:71], 0 offen sc1
v_sub_f32 v116, v116, v125
v_sub_f32 v117, v117, v125
v_cvt_pk_bf16_f32 v133, v116, v117
v_lshlrev_b32 v116, 16, v133
v_and_b32 v117, 0xffff0000, v133
v_mul_f32 v134, v116, v127
v_fma_f32 v135, -v134, v129, v116
v_fma_f32 v116, v135, v127, v134
v_mul_f32 v134, v117, v127
v_fma_f32 v135, -v134, v129, v117
v_fma_f32 v117, v135, v127, v134
v_cvt_pk_bf16_f32 v104, v116, v117
v_sub_f32 v118, v118, v125
v_sub_f32 v119, v119, v125
v_cvt_pk_bf16_f32 v133, v118, v119
v_lshlrev_b32 v118, 16, v133
v_and_b32 v119, 0xffff0000, v133
v_mul_f32 v134, v118, v127
v_fma_f32 v135, -v134, v129, v118
v_fma_f32 v118, v135, v127, v134
v_mul_f32 v134, v119, v127
v_fma_f32 v135, -v134, v129, v119
v_fma_f32 v119, v135, v127, v134
v_cvt_pk_bf16_f32 v105, v118, v119
v_sub_f32 v120, v120, v125
v_sub_f32 v121, v121, v125
v_cvt_pk_bf16_f32 v133, v120, v121
v_lshlrev_b32 v120, 16, v133
v_and_b32 v121, 0xffff0000, v133
v_mul_f32 v134, v120, v127
v_fma_f32 v135, -v134, v129, v120
v_fma_f32 v120, v135, v127, v134
v_mul_f32 v134, v121, v127
v_fma_f32 v135, -v134, v129, v121
v_fma_f32 v121, v135, v127, v134
v_cvt_pk_bf16_f32 v106, v120, v121
v_sub_f32 v122, v122, v125
v_sub_f32 v123, v123, v125
v_cvt_pk_bf16_f32 v133, v122, v123
v_lshlrev_b32 v122, 16, v133
v_and_b32 v123, 0xffff0000, v133
v_mul_f32 v134, v122, v127
v_fma_f32 v135, -v134, v129, v122
v_fma_f32 v122, v135, v127, v134
v_mul_f32 v134, v123, v127
v_fma_f32 v135, -v134, v129, v123
v_fma_f32 v123, v135, v127, v134
v_cvt_pk_bf16_f32 v107, v122, v123
buffer_store_dwordx4 v[104:107], v96, s[68:71], 0 offen offset:896 sc1
s_cmp_lg_u32 s3, 0
s_cbranch_scc1 fused_kernel_nozero_26
s_lshl_b32 s40, s58, 9
s_add_u32 s40, s40, 0x5b00000
v_mov_b32 v28, 0
v_lshlrev_b32 v29, 7, v1
s_mov_b64 s[60:61], exec
s_mov_b64 exec, 15
buffer_store_dword v28, v29, s[4:7], s40 offen sc1
s_lshl_b32 s40, s55, 4
s_add_u32 s40, s40, s48
s_lshl_b32 s40, s40, 7
s_add_u32 s40, s40, 0x5af0000
s_mov_b64 exec, 1
buffer_store_dword v28, off, s[4:7], s40 sc1
s_mov_b64 exec, s[60:61]
fused_kernel_nozero_26:
s_mov_b32 s64, s94
s_and_b32 s65, s95, 0xffff
s_mov_b32 s66, 0x100
s_mov_b32 s67, 0x20000
s_waitcnt vmcnt(0)
s_barrier
s_mov_b32 s77, 0
s_cmp_lg_u32 s3, 0
s_cbranch_scc1 fused_kernel_noarr_27
s_lshl_b32 s40, s55, 5
v_mov_b32 v14, 1
s_mov_b64 s[60:61], exec
s_mov_b64 exec, 1
buffer_atomic_add v14, off, s[64:67], s40 sc0
s_mov_b64 exec, s[60:61]
s_waitcnt vmcnt(0)
v_readfirstlane_b32 s40, v14
s_nop 3
s_cmp_lg_u32 s40, 15
s_cbranch_scc1 fused_kernel_noarr_27
s_mov_b32 s77, 1
s_lshl_b32 s40, s55, 11
s_add_u32 s40, s40, 0x5af0000
v_mov_b32 v14, 1
v_lshlrev_b32 v29, 7, v1
s_mov_b64 s[60:61], exec
s_mov_b64 exec, 0xffff
buffer_store_dword v14, v29, s[4:7], s40 offen sc1
s_mov_b64 exec, s[60:61]
fused_kernel_noarr_27:
v_lshrrev_b32 v26, 3, v1
v_lshlrev_b32 v26, 11, v26
v_and_b32 v27, 7, v1
v_lshl_add_u32 v26, v27, 7, v26
s_lshl_b32 s40, s58, 14
s_add_u32 s40, s40, 2097152
s_sub_u32 s60, s3, 1
s_lshl_b32 s60, s60, 10
s_add_u32 s40, s40, s60
s_cmp_eq_u32 s3, 0
s_cselect_b32 s40, 0x70000000, s40
s_cmp_eq_u32 s3, 3
s_cselect_b32 s40, 0x70000000, s40
buffer_load_dword v0, v26, s[20:23], s40 offen
s_add_u32 s59, s58, 128
v_lshrrev_b32 v80, 4, v1
v_bfe_u32 v81, v1, 2, 2
v_lshl_add_u32 v80, v80, 2, v81
s_movk_i32 s40, 896
v_mul_lo_u32 v80, v80, s40
v_and_b32 v81, 3, v1
v_lshl_add_u32 v80, v81, 3, v80
s_mul_i32 s40, s3, 224
s_add_u32 s40, s40, 0
v_add_u32 v80, s40, v80
ds_read_b64_tr_b16 v[160:161], v80 offset:0
ds_read_b64_tr_b16 v[162:163], v80 offset:14336
ds_read_b64_tr_b16 v[164:165], v80 offset:32
ds_read_b64_tr_b16 v[166:167], v80 offset:14368
ds_read_b64_tr_b16 v[168:169], v80 offset:64
ds_read_b64_tr_b16 v[170:171], v80 offset:14400
ds_read_b64_tr_b16 v[172:173], v80 offset:96
ds_read_b64_tr_b16 v[174:175], v80 offset:14432
ds_read_b64_tr_b16 v[176:177], v80 offset:128
ds_read_b64_tr_b16 v[178:179], v80 offset:14464
ds_read_b64_tr_b16 v[180:181], v80 offset:160
ds_read_b64_tr_b16 v[182:183], v80 offset:14496
ds_read_b64_tr_b16 v[184:185], v80 offset:192
ds_read_b64_tr_b16 v[186:187], v80 offset:14528
v_lshrrev_b32 v80, 4, v1
v_bfe_u32 v81, v1, 2, 2
v_lshl_add_u32 v80, v80, 2, v81
s_movk_i32 s40, 896
v_mul_lo_u32 v80, v80, s40
v_and_b32 v81, 3, v1
v_lshl_add_u32 v80, v81, 3, v80
s_mul_i32 s40, s3, 224
s_add_u32 s40, s40, 32768
v_add_u32 v80, s40, v80
ds_read_b64_tr_b16 v[192:193], v80 offset:0
ds_read_b64_tr_b16 v[194:195], v80 offset:14336
ds_read_b64_tr_b16 v[196:197], v80 offset:32
ds_read_b64_tr_b16 v[198:199], v80 offset:14368
ds_read_b64_tr_b16 v[200:201], v80 offset:64
ds_read_b64_tr_b16 v[202:203], v80 offset:14400
ds_read_b64_tr_b16 v[204:205], v80 offset:96
ds_read_b64_tr_b16 v[206:207], v80 offset:14432
ds_read_b64_tr_b16 v[208:209], v80 offset:128
ds_read_b64_tr_b16 v[210:211], v80 offset:14464
ds_read_b64_tr_b16 v[212:213], v80 offset:160
ds_read_b64_tr_b16 v[214:215], v80 offset:14496
ds_read_b64_tr_b16 v[216:217], v80 offset:192
ds_read_b64_tr_b16 v[218:219], v80 offset:14528
s_waitcnt lgkmcnt(0)
s_mul_i32 s40, s58, 28
s_mul_i32 s60, s3, 7
s_add_u32 s40, s40, s60
s_lshl_b32 s40, s40, 10
s_add_u32 s40, s40, 0x6c00000
s_cmp_ge_u32 s58, 184
s_cselect_b32 s40, 0x70000000, s40
v_lshlrev_b32 v81, 4, v1
s_add_u32 s60, s40, 0
buffer_store_dwordx4 v[160:163], v81, s[4:7], s60 offen sc1
s_add_u32 s60, s40, 1024
buffer_store_dwordx4 v[164:167], v81, s[4:7], s60 offen sc1
s_add_u32 s60, s40, 2048
buffer_store_dwordx4 v[168:171], v81, s[4:7], s60 offen sc1
s_add_u32 s60, s40, 3072
buffer_store_dwordx4 v[172:175], v81, s[4:7], s60 offen sc1
s_add_u32 s60, s40, 4096
buffer_store_dwordx4 v[176:179], v81, s[4:7], s60 offen sc1
s_add_u32 s60, s40, 5120
buffer_store_dwordx4 v[180:183], v81, s[4:7], s60 offen sc1
s_add_u32 s60, s40, 6144
buffer_store_dwordx4 v[184:187], v81, s[4:7], s60 offen sc1
s_mul_i32 s40, s59, 28
s_mul_i32 s60, s3, 7
s_add_u32 s40, s40, s60
s_lshl_b32 s40, s40, 10
s_add_u32 s40, s40, 0x6c00000
s_cmp_ge_u32 s59, 184
s_cselect_b32 s40, 0x70000000, s40
v_lshlrev_b32 v81, 4, v1
s_add_u32 s60, s40, 0
buffer_store_dwordx4 v[192:195], v81, s[4:7], s60 offen sc1
s_add_u32 s60, s40, 1024
buffer_store_dwordx4 v[196:199], v81, s[4:7], s60 offen sc1
s_add_u32 s60, s40, 2048
buffer_store_dwordx4 v[200:203], v81, s[4:7], s60 offen sc1
s_add_u32 s60, s40, 3072
buffer_store_dwordx4 v[204:207], v81, s[4:7], s60 offen sc1
s_add_u32 s60, s40, 4096
buffer_store_dwordx4 v[208:211], v81, s[4:7], s60 offen sc1
s_add_u32 s60, s40, 5120
buffer_store_dwordx4 v[212:215], v81, s[4:7], s60 offen sc1
s_add_u32 s60, s40, 6144
buffer_store_dwordx4 v[216:219], v81, s[4:7], s60 offen sc1
s_cmp_lg_u32 s3, 0
s_cbranch_scc1 fused_kernel_xpok_28
s_cmp_eq_u32 s77, 1
s_cbranch_scc1 fused_kernel_xpok_28
s_lshl_b32 s40, s55, 4
s_add_u32 s40, s40, s48
s_lshl_b32 s40, s40, 7
s_add_u32 s40, s40, 0x5af0000
s_mov_b32 s60, 0x80000
fused_kernel_xppoll_29:
buffer_load_dword v14, off, s[4:7], s40 sc1
s_waitcnt vmcnt(0)
v_readfirstlane_b32 s61, v14
s_sub_u32 s60, s60, 1
s_cmp_eq_u32 s60, 0
s_cbranch_scc1 fused_kernel_xpok_28
s_cmp_eq_u32 s61, 1
s_cbranch_scc1 fused_kernel_xpok_28
s_sleep 1
s_branch fused_kernel_xppoll_29
fused_kernel_xpok_28:
s_barrier
s_add_u32 m0, s34, 0
s_nop 0
buffer_load_dwordx4 v2, s[8:11], s28 offen lds
s_add_u32 s28, s28, s29
s_add_u32 m0, s34, 4096
s_nop 0
buffer_load_dwordx4 v2, s[8:11], s28 offen lds
s_add_u32 s28, s28, s29
s_add_u32 m0, s34, 8192
s_nop 0
buffer_load_dwordx4 v2, s[8:11], s28 offen lds
s_add_u32 s28, s28, s29
s_add_u32 m0, s34, 12288
s_nop 0
buffer_load_dwordx4 v2, s[8:11], s28 offen lds
s_add_u32 s28, s28, s29
s_add_u32 m0, s34, 16384
s_nop 0
buffer_load_dwordx4 v2, s[8:11], s28 offen lds
s_add_u32 s28, s28, s29
s_add_u32 m0, s34, 20480
s_nop 0
buffer_load_dwordx4 v2, s[8:11], s28 offen lds
s_add_u32 s28, s28, s29
s_add_u32 m0, s34, 24576
s_nop 0
buffer_load_dwordx4 v2, s[8:11], s28 offen lds
s_add_u32 s28, s28, s29
s_add_u32 m0, s34, 28672
s_nop 0
buffer_load_dwordx4 v2, s[8:11], s28 offen lds
s_add_u32 s28, s28, s30
s_add_u32 s34, s34, 32768
s_cmp_ge_u32 s34, s36
s_cselect_b32 s34, s35, s34
s_add_u32 m0, s34, 0
s_nop 0
buffer_load_dwordx4 v2, s[8:11], s28 offen lds
s_add_u32 s28, s28, s29
s_add_u32 m0, s34, 4096
s_nop 0
buffer_load_dwordx4 v2, s[8:11], s28 offen lds
s_add_u32 s28, s28, s29
s_add_u32 m0, s34, 8192
s_nop 0
buffer_load_dwordx4 v2, s[8:11], s28 offen lds
s_add_u32 s28, s28, s29
s_add_u32 m0, s34, 12288
s_nop 0
buffer_load_dwordx4 v2, s[8:11], s28 offen lds
s_add_u32 s28, s28, s29
s_add_u32 m0, s34, 16384
s_nop 0
buffer_load_dwordx4 v2, s[8:11], s28 offen lds
s_add_u32 s28, s28, s29
s_add_u32 m0, s34, 20480
s_nop 0
buffer_load_dwordx4 v2, s[8:11], s28 offen lds
s_add_u32 s28, s28, s29
s_add_u32 m0, s34, 24576
s_nop 0
buffer_load_dwordx4 v2, s[8:11], s28 offen lds
s_add_u32 s28, s28, s29
s_add_u32 m0, s34, 28672
s_nop 0
buffer_load_dwordx4 v2, s[8:11], s28 offen lds
s_add_u32 s28, s28, s30
s_add_u32 s34, s34, 32768
s_cmp_ge_u32 s34, s36
s_cselect_b32 s34, s35, s34
s_add_u32 m0, s34, 0
s_nop 0
buffer_load_dwordx4 v2, s[8:11], s28 offen lds
s_add_u32 s28, s28, s29
s_add_u32 m0, s34, 4096
s_nop 0
buffer_load_dwordx4 v2, s[8:11], s28 offen lds
s_add_u32 s28, s28, s29
s_add_u32 m0, s34, 8192
s_nop 0
buffer_load_dwordx4 v2, s[8:11], s28 offen lds
s_add_u32 s28, s28, s29
s_add_u32 m0, s34, 12288
s_nop 0
buffer_load_dwordx4 v2, s[8:11], s28 offen lds
s_add_u32 s28, s28, s29
s_waitcnt vmcnt(12)
s_barrier
v_add_u32 v6, s37, v4
s_add_u32 s37, s37, 32768
s_cmp_ge_u32 s37, s42
s_cselect_b32 s37, s41, s37
ds_read_b64_tr_b16 a[32:33], v8 offset:0
ds_read_b64_tr_b16 a[34:35], v8 offset:1024
ds_read_b128 a[0:3], v6 offset:0
ds_read_b128 a[4:7], v6 offset:2048
ds_read_b128 a[8:11], v6 offset:4096
ds_read_b128 a[12:15], v6 offset:6144
ds_read_b128 a[16:19], v6 offset:8192
ds_read_b128 a[20:23], v6 offset:10240
ds_read_b128 a[24:27], v6 offset:12288
ds_read_b128 a[28:31], v6 offset:14336
ds_read_b64_tr_b16 a[36:37], v9 offset:0
ds_read_b64_tr_b16 a[38:39], v9 offset:1024
ds_read_b64_tr_b16 a[40:41], v10 offset:0
ds_read_b64_tr_b16 a[42:43], v10 offset:1024
ds_read_b64_tr_b16 a[44:45], v11 offset:0
ds_read_b64_tr_b16 a[46:47], v11 offset:1024
ds_read_b64_tr_b16 a[48:49], v8 offset:8192
ds_read_b64_tr_b16 a[50:51], v8 offset:9216
ds_read_b64_tr_b16 a[52:53], v9 offset:8192
ds_read_b64_tr_b16 a[54:55], v9 offset:9216
ds_read_b64_tr_b16 a[56:57], v10 offset:8192
ds_read_b64_tr_b16 a[58:59], v10 offset:9216
ds_read_b64_tr_b16 a[60:61], v11 offset:8192
ds_read_b64_tr_b16 a[62:63], v11 offset:9216
s_waitcnt vmcnt(8) lgkmcnt(0)
s_barrier
v_mfma_f32_16x16x32_bf16 v[16:19], a[32:35], a[0:3], 0
v_add_u32 v7, s38, v5
s_add_u32 m0, s34, 16384
v_mfma_f32_16x16x32_bf16 v[24:27], a[32:35], a[4:7], 0
ds_read_b64_tr_b16 a[96:97], v8 offset:16384
v_mfma_f32_16x16x32_bf16 v[32:35], a[32:35], a[8:11], 0
ds_read_b64_tr_b16 a[98:99], v8 offset:17408
buffer_load_dwordx4 v2, s[8:11], s28 offen lds
v_mfma_f32_16x16x32_bf16 v[40:43], a[32:35], a[12:15], 0
v_mfma_f32_16x16x32_bf16 v[48:51], a[32:35], a[16:19], 0
ds_read_b128 a[64:67], v7 offset:0
s_add_u32 s28, s28, s29
v_mfma_f32_16x16x32_bf16 v[56:59], a[32:35], a[20:23], 0
ds_read_b128 a[68:71], v7 offset:2048
v_mfma_f32_16x16x32_bf16 v[64:67], a[32:35], a[24:27], 0
s_add_u32 m0, s34, 20480
v_mfma_f32_16x16x32_bf16 v[72:75], a[32:35], a[28:31], 0
ds_read_b128 a[72:75], v7 offset:4096
v_mfma_f32_16x16x32_bf16 v[20:23], a[36:39], a[0:3], 0
buffer_load_dwordx4 v2, s[8:11], s28 offen lds
v_mfma_f32_16x16x32_bf16 v[28:31], a[36:39], a[4:7], 0
ds_read_b128 a[76:79], v7 offset:6144
v_mfma_f32_16x16x32_bf16 v[36:39], a[36:39], a[8:11], 0
ds_read_b128 a[80:83], v7 offset:8192
s_add_u32 s28, s28, s29
v_mfma_f32_16x16x32_bf16 v[44:47], a[36:39], a[12:15], 0
v_mfma_f32_16x16x32_bf16 v[52:55], a[36:39], a[16:19], 0
ds_read_b128 a[84:87], v7 offset:10240
s_add_u32 m0, s34, 24576
v_mfma_f32_16x16x32_bf16 v[60:63], a[36:39], a[20:23], 0
v_mfma_f32_16x16x32_bf16 v[68:71], a[36:39], a[24:27], 0
ds_read_b128 a[88:91], v7 offset:12288
buffer_load_dwordx4 v2, s[8:11], s28 offen lds
v_mfma_f32_16x16x32_bf16 v[76:79], a[36:39], a[28:31], 0
ds_read_b128 a[92:95], v7 offset:14336
v_mfma_f32_16x16x32_bf16 v[80:83], a[40:43], a[0:3], 0
s_add_u32 s28, s28, s29
v_mfma_f32_16x16x32_bf16 v[88:91], a[40:43], a[4:7], 0
ds_read_b64_tr_b16 a[100:101], v9 offset:16384
v_mfma_f32_16x16x32_bf16 v[96:99], a[40:43], a[8:11], 0
ds_read_b64_tr_b16 a[102:103], v9 offset:17408
s_add_u32 m0, s34, 28672
v_mfma_f32_16x16x32_bf16 v[104:107], a[40:43], a[12:15], 0
v_mfma_f32_16x16x32_bf16 v[112:115], a[40:43], a[16:19], 0
ds_read_b64_tr_b16 a[104:105], v10 offset:16384
v_mfma_f32_16x16x32_bf16 v[120:123], a[40:43], a[20:23], 0
buffer_load_dwordx4 v2, s[8:11], s28 offen lds
v_mfma_f32_16x16x32_bf16 v[128:131], a[40:43], a[24:27], 0
ds_read_b64_tr_b16 a[106:107], v10 offset:17408
v_mfma_f32_16x16x32_bf16 v[136:139], a[40:43], a[28:31], 0
ds_read_b64_tr_b16 a[108:109], v11 offset:16384
s_add_u32 s28, s28, s30
v_mfma_f32_16x16x32_bf16 v[84:87], a[44:47], a[0:3], 0
v_mfma_f32_16x16x32_bf16 v[92:95], a[44:47], a[4:7], 0
ds_read_b64_tr_b16 a[110:111], v11 offset:17408
s_add_u32 s34, s34, 32768
v_mfma_f32_16x16x32_bf16 v[100:103], a[44:47], a[8:11], 0
v_mfma_f32_16x16x32_bf16 v[108:111], a[44:47], a[12:15], 0
ds_read_b64_tr_b16 a[112:113], v8 offset:24576
s_cmp_ge_u32 s34, s36
v_mfma_f32_16x16x32_bf16 v[116:119], a[44:47], a[16:19], 0
ds_read_b64_tr_b16 a[114:115], v8 offset:25600
v_mfma_f32_16x16x32_bf16 v[124:127], a[44:47], a[20:23], 0
s_cselect_b32 s34, s35, s34
v_mfma_f32_16x16x32_bf16 v[132:135], a[44:47], a[24:27], 0
ds_read_b64_tr_b16 a[116:117], v9 offset:24576
v_mfma_f32_16x16x32_bf16 v[140:143], a[44:47], a[28:31], 0
ds_read_b64_tr_b16 a[118:119], v9 offset:25600
s_add_u32 m0, s43, 0
v_mfma_f32_16x16x32_bf16 v[144:147], a[48:51], a[0:3], 0
v_mfma_f32_16x16x32_bf16 v[152:155], a[48:51], a[4:7], 0
ds_read_b64_tr_b16 a[120:121], v10 offset:24576
buffer_load_dwordx4 v3, s[12:15], s31 offen lds
v_mfma_f32_16x16x32_bf16 v[160:163], a[48:51], a[8:11], 0
v_mfma_f32_16x16x32_bf16 v[168:171], a[48:51], a[12:15], 0
ds_read_b64_tr_b16 a[122:123], v10 offset:25600
s_add_u32 s31, s31, s32
v_mfma_f32_16x16x32_bf16 v[176:179], a[48:51], a[16:19], 0
ds_read_b64_tr_b16 a[124:125], v11 offset:24576
v_mfma_f32_16x16x32_bf16 v[184:187], a[48:51], a[20:23], 0
s_add_u32 m0, s43, 1024
v_mfma_f32_16x16x32_bf16 v[192:195], a[48:51], a[24:27], 0
ds_read_b64_tr_b16 a[126:127], v11 offset:25600
v_mfma_f32_16x16x32_bf16 v[200:203], a[48:51], a[28:31], 0
buffer_load_dwordx4 v3, s[12:15], s31 offen lds
v_mfma_f32_16x16x32_bf16 v[148:151], a[52:55], a[0:3], 0
v_mfma_f32_16x16x32_bf16 v[156:159], a[52:55], a[4:7], 0
v_mfma_f32_16x16x32_bf16 v[164:167], a[52:55], a[8:11], 0
s_add_u32 s31, s31, s33
v_mfma_f32_16x16x32_bf16 v[172:175], a[52:55], a[12:15], 0
v_mfma_f32_16x16x32_bf16 v[180:183], a[52:55], a[16:19], 0
s_add_u32 m0, s43, 4096
v_mfma_f32_16x16x32_bf16 v[188:191], a[52:55], a[20:23], 0
v_mfma_f32_16x16x32_bf16 v[196:199], a[52:55], a[24:27], 0
buffer_load_dwordx4 v3, s[12:15], s31 offen lds
v_mfma_f32_16x16x32_bf16 v[204:207], a[52:55], a[28:31], 0
v_mfma_f32_16x16x32_bf16 v[208:211], a[56:59], a[0:3], 0
s_add_u32 s31, s31, s32
v_mfma_f32_16x16x32_bf16 v[216:219], a[56:59], a[4:7], 0
v_mfma_f32_16x16x32_bf16 v[224:227], a[56:59], a[8:11], 0
s_add_u32 m0, s43, 5120
v_mfma_f32_16x16x32_bf16 v[232:235], a[56:59], a[12:15], 0
v_mfma_f32_16x16x32_bf16 v[240:243], a[56:59], a[16:19], 0
buffer_load_dwordx4 v3, s[12:15], s31 offen lds
v_mfma_f32_16x16x32_bf16 v[248:251], a[56:59], a[20:23], 0
v_mfma_f32_16x16x32_bf16 a[128:131], a[56:59], a[24:27], 0
s_add_u32 s31, s31, s33
v_mfma_f32_16x16x32_bf16 a[136:139], a[56:59], a[28:31], 0
v_mfma_f32_16x16x32_bf16 v[212:215], a[60:63], a[0:3], 0
s_add_u32 s38, s38, 32768
v_mfma_f32_16x16x32_bf16 v[220:223], a[60:63], a[4:7], 0
v_mfma_f32_16x16x32_bf16 v[228:231], a[60:63], a[8:11], 0
s_cmp_ge_u32 s38, s42
v_mfma_f32_16x16x32_bf16 v[236:239], a[60:63], a[12:15], 0
v_mfma_f32_16x16x32_bf16 v[244:247], a[60:63], a[16:19], 0
s_cselect_b32 s38, s41, s38
v_mfma_f32_16x16x32_bf16 v[252:255], a[60:63], a[20:23], 0
v_mfma_f32_16x16x32_bf16 a[132:135], a[60:63], a[24:27], 0
v_mfma_f32_16x16x32_bf16 a[140:143], a[60:63], a[28:31], 0
s_waitcnt vmcnt(12) lgkmcnt(0)
s_barrier
v_mfma_f32_16x16x32_bf16 v[16:19], a[96:99], a[64:67], v[16:19]
v_add_u32 v6, s37, v4
s_add_u32 m0, s34, 0
v_mfma_f32_16x16x32_bf16 v[24:27], a[96:99], a[68:71], v[24:27]
ds_read_b64_tr_b16 a[32:33], v8 offset:32768
v_mfma_f32_16x16x32_bf16 v[32:35], a[96:99], a[72:75], v[32:35]
ds_read_b64_tr_b16 a[34:35], v8 offset:33792
buffer_load_dwordx4 v2, s[8:11], s28 offen lds
v_mfma_f32_16x16x32_bf16 v[40:43], a[96:99], a[76:79], v[40:43]
v_mfma_f32_16x16x32_bf16 v[48:51], a[96:99], a[80:83], v[48:51]
ds_read_b128 a[0:3], v6 offset:0
s_add_u32 s28, s28, s29
v_mfma_f32_16x16x32_bf16 v[56:59], a[96:99], a[84:87], v[56:59]
ds_read_b128 a[4:7], v6 offset:2048
v_mfma_f32_16x16x32_bf16 v[64:67], a[96:99], a[88:91], v[64:67]
v_mfma_f32_16x16x32_bf16 v[72:75], a[96:99], a[92:95], v[72:75]
ds_read_b128 a[8:11], v6 offset:4096
s_add_u32 m0, s34, 4096
v_mfma_f32_16x16x32_bf16 v[20:23], a[100:103], a[64:67], v[20:23]
v_mfma_f32_16x16x32_bf16 v[28:31], a[100:103], a[68:71], v[28:31]
ds_read_b128 a[12:15], v6 offset:6144
buffer_load_dwordx4 v2, s[8:11], s28 offen lds
v_mfma_f32_16x16x32_bf16 v[36:39], a[100:103], a[72:75], v[36:39]
ds_read_b128 a[16:19], v6 offset:8192
v_mfma_f32_16x16x32_bf16 v[44:47], a[100:103], a[76:79], v[44:47]
s_add_u32 s28, s28, s29
v_mfma_f32_16x16x32_bf16 v[52:55], a[100:103], a[80:83], v[52:55]
ds_read_b128 a[20:23], v6 offset:10240
v_mfma_f32_16x16x32_bf16 v[60:63], a[100:103], a[84:87], v[60:63]
v_mfma_f32_16x16x32_bf16 v[68:71], a[100:103], a[88:91], v[68:71]
ds_read_b128 a[24:27], v6 offset:12288
s_add_u32 m0, s34, 8192
v_mfma_f32_16x16x32_bf16 v[76:79], a[100:103], a[92:95], v[76:79]
ds_read_b128 a[28:31], v6 offset:14336
v_mfma_f32_16x16x32_bf16 v[80:83], a[104:107], a[64:67], v[80:83]
buffer_load_dwordx4 v2, s[8:11], s28 offen lds
v_mfma_f32_16x16x32_bf16 v[88:91], a[104:107], a[68:71], v[88:91]
ds_read_b64_tr_b16 a[36:37], v9 offset:32768
v_mfma_f32_16x16x32_bf16 v[96:99], a[104:107], a[72:75], v[96:99]
ds_read_b64_tr_b16 a[38:39], v9 offset:33792
s_add_u32 s28, s28, s29
v_mfma_f32_16x16x32_bf16 v[104:107], a[104:107], a[76:79], v[104:107]
v_mfma_f32_16x16x32_bf16 v[112:115], a[104:107], a[80:83], v[112:115]
ds_read_b64_tr_b16 a[40:41], v10 offset:32768
v_mfma_f32_16x16x32_bf16 v[120:123], a[104:107], a[84:87], v[120:123]
s_add_u32 m0, s34, 12288
v_mfma_f32_16x16x32_bf16 v[128:131], a[104:107], a[88:91], v[128:131]
ds_read_b64_tr_b16 a[42:43], v10 offset:33792
v_mfma_f32_16x16x32_bf16 v[136:139], a[104:107], a[92:95], v[136:139]
ds_read_b64_tr_b16 a[44:45], v11 offset:32768
buffer_load_dwordx4 v2, s[8:11], s28 offen lds
v_mfma_f32_16x16x32_bf16 v[84:87], a[108:111], a[64:67], v[84:87]
v_mfma_f32_16x16x32_bf16 v[92:95], a[108:111], a[68:71], v[92:95]
ds_read_b64_tr_b16 a[46:47], v11 offset:33792
s_add_u32 s28, s28, s29
v_mfma_f32_16x16x32_bf16 v[100:103], a[108:111], a[72:75], v[100:103]
v_mfma_f32_16x16x32_bf16 v[108:111], a[108:111], a[76:79], v[108:111]
ds_read_b64_tr_b16 a[48:49], v8 offset:40960
v_mfma_f32_16x16x32_bf16 v[116:119], a[108:111], a[80:83], v[116:119]
ds_read_b64_tr_b16 a[50:51], v8 offset:41984
s_add_u32 m0, s43, 16384
v_mfma_f32_16x16x32_bf16 v[124:127], a[108:111], a[84:87], v[124:127]
v_mfma_f32_16x16x32_bf16 v[132:135], a[108:111], a[88:91], v[132:135]
ds_read_b64_tr_b16 a[52:53], v9 offset:40960
buffer_load_dwordx4 v3, s[12:15], s31 offen lds
v_mfma_f32_16x16x32_bf16 v[140:143], a[108:111], a[92:95], v[140:143]
ds_read_b64_tr_b16 a[54:55], v9 offset:41984
v_mfma_f32_16x16x32_bf16 v[144:147], a[112:115], a[64:67], v[144:147]
s_add_u32 s31, s31, s32
v_mfma_f32_16x16x32_bf16 v[152:155], a[112:115], a[68:71], v[152:155]
ds_read_b64_tr_b16 a[56:57], v10 offset:40960
v_mfma_f32_16x16x32_bf16 v[160:163], a[112:115], a[72:75], v[160:163]
v_mfma_f32_16x16x32_bf16 v[168:171], a[112:115], a[76:79], v[168:171]
ds_read_b64_tr_b16 a[58:59], v10 offset:41984
s_add_u32 m0, s43, 17408
v_mfma_f32_16x16x32_bf16 v[176:179], a[112:115], a[80:83], v[176:179]
ds_read_b64_tr_b16 a[60:61], v11 offset:40960
v_mfma_f32_16x16x32_bf16 v[184:187], a[112:115], a[84:87], v[184:187]
buffer_load_dwordx4 v3, s[12:15], s31 offen lds
v_mfma_f32_16x16x32_bf16 v[192:195], a[112:115], a[88:91], v[192:195]
ds_read_b64_tr_b16 a[62:63], v11 offset:41984
v_mfma_f32_16x16x32_bf16 v[200:203], a[112:115], a[92:95], v[200:203]
s_add_u32 s31, s31, s33
v_mfma_f32_16x16x32_bf16 v[148:151], a[116:119], a[64:67], v[148:151]
v_mfma_f32_16x16x32_bf16 v[156:159], a[116:119], a[68:71], v[156:159]
v_mfma_f32_16x16x32_bf16 v[164:167], a[116:119], a[72:75], v[164:167]
s_add_u32 m0, s43, 20480
v_mfma_f32_16x16x32_bf16 v[172:175], a[116:119], a[76:79], v[172:175]
v_mfma_f32_16x16x32_bf16 v[180:183], a[116:119], a[80:83], v[180:183]
buffer_load_dwordx4 v3, s[12:15], s31 offen lds
v_mfma_f32_16x16x32_bf16 v[188:191], a[116:119], a[84:87], v[188:191]
v_mfma_f32_16x16x32_bf16 v[196:199], a[116:119], a[88:91], v[196:199]
s_add_u32 s31, s31, s32
v_mfma_f32_16x16x32_bf16 v[204:207], a[116:119], a[92:95], v[204:207]
v_mfma_f32_16x16x32_bf16 v[208:211], a[120:123], a[64:67], v[208:211]
v_mfma_f32_16x16x32_bf16 v[216:219], a[120:123], a[68:71], v[216:219]
s_add_u32 m0, s43, 21504
v_mfma_f32_16x16x32_bf16 v[224:227], a[120:123], a[72:75], v[224:227]
v_mfma_f32_16x16x32_bf16 v[232:235], a[120:123], a[76:79], v[232:235]
buffer_load_dwordx4 v3, s[12:15], s31 offen lds
v_mfma_f32_16x16x32_bf16 v[240:243], a[120:123], a[80:83], v[240:243]
v_mfma_f32_16x16x32_bf16 v[248:251], a[120:123], a[84:87], v[248:251]
s_add_u32 s31, s31, s33
v_mfma_f32_16x16x32_bf16 a[128:131], a[120:123], a[88:91], a[128:131]
v_mfma_f32_16x16x32_bf16 a[136:139], a[120:123], a[92:95], a[136:139]
v_mfma_f32_16x16x32_bf16 v[212:215], a[124:127], a[64:67], v[212:215]
s_add_u32 s37, s37, 32768
v_mfma_f32_16x16x32_bf16 v[220:223], a[124:127], a[68:71], v[220:223]
v_mfma_f32_16x16x32_bf16 v[228:231], a[124:127], a[72:75], v[228:231]
s_cmp_ge_u32 s37, s42
v_mfma_f32_16x16x32_bf16 v[236:239], a[124:127], a[76:79], v[236:239]
v_mfma_f32_16x16x32_bf16 v[244:247], a[124:127], a[80:83], v[244:247]
s_cselect_b32 s37, s41, s37
v_mfma_f32_16x16x32_bf16 v[252:255], a[124:127], a[84:87], v[252:255]
v_mfma_f32_16x16x32_bf16 a[132:135], a[124:127], a[88:91], a[132:135]
v_mfma_f32_16x16x32_bf16 a[140:143], a[124:127], a[92:95], a[140:143]
s_waitcnt vmcnt(16) lgkmcnt(0)
s_barrier
v_mfma_f32_16x16x32_bf16 v[16:19], a[32:35], a[0:3], v[16:19]
v_add_u32 v7, s38, v5
s_add_u32 m0, s34, 16384
v_mfma_f32_16x16x32_bf16 v[24:27], a[32:35], a[4:7], v[24:27]
ds_read_b64_tr_b16 a[96:97], v8 offset:49152
v_mfma_f32_16x16x32_bf16 v[32:35], a[32:35], a[8:11], v[32:35]
ds_read_b64_tr_b16 a[98:99], v8 offset:50176
buffer_load_dwordx4 v2, s[8:11], s28 offen lds
v_mfma_f32_16x16x32_bf16 v[40:43], a[32:35], a[12:15], v[40:43]
v_mfma_f32_16x16x32_bf16 v[48:51], a[32:35], a[16:19], v[48:51]
ds_read_b128 a[64:67], v7 offset:0
s_add_u32 s28, s28, s29
v_mfma_f32_16x16x32_bf16 v[56:59], a[32:35], a[20:23], v[56:59]
ds_read_b128 a[68:71], v7 offset:2048
v_mfma_f32_16x16x32_bf16 v[64:67], a[32:35], a[24:27], v[64:67]
s_add_u32 m0, s34, 20480
v_mfma_f32_16x16x32_bf16 v[72:75], a[32:35], a[28:31], v[72:75]
ds_read_b128 a[72:75], v7 offset:4096
v_mfma_f32_16x16x32_bf16 v[20:23], a[36:39], a[0:3], v[20:23]
buffer_load_dwordx4 v2, s[8:11], s28 offen lds
v_mfma_f32_16x16x32_bf16 v[28:31], a[36:39], a[4:7], v[28:31]
ds_read_b128 a[76:79], v7 offset:6144
v_mfma_f32_16x16x32_bf16 v[36:39], a[36:39], a[8:11], v[36:39]
ds_read_b128 a[80:83], v7 offset:8192
s_add_u32 s28, s28, s29
v_mfma_f32_16x16x32_bf16 v[44:47], a[36:39], a[12:15], v[44:47]
v_mfma_f32_16x16x32_bf16 v[52:55], a[36:39], a[16:19], v[52:55]
ds_read_b128 a[84:87], v7 offset:10240
s_add_u32 m0, s34, 24576
v_mfma_f32_16x16x32_bf16 v[60:63], a[36:39], a[20:23], v[60:63]
v_mfma_f32_16x16x32_bf16 v[68:71], a[36:39], a[24:27], v[68:71]
ds_read_b128 a[88:91], v7 offset:12288
buffer_load_dwordx4 v2, s[8:11], s28 offen lds
v_mfma_f32_16x16x32_bf16 v[76:79], a[36:39], a[28:31], v[76:79]
ds_read_b128 a[92:95], v7 offset:14336
v_mfma_f32_16x16x32_bf16 v[80:83], a[40:43], a[0:3], v[80:83]
s_add_u32 s28, s28, s29
v_mfma_f32_16x16x32_bf16 v[88:91], a[40:43], a[4:7], v[88:91]
ds_read_b64_tr_b16 a[100:101], v9 offset:49152
v_mfma_f32_16x16x32_bf16 v[96:99], a[40:43], a[8:11], v[96:99]
ds_read_b64_tr_b16 a[102:103], v9 offset:50176
s_add_u32 m0, s34, 28672
v_mfma_f32_16x16x32_bf16 v[104:107], a[40:43], a[12:15], v[104:107]
v_mfma_f32_16x16x32_bf16 v[112:115], a[40:43], a[16:19], v[112:115]
ds_read_b64_tr_b16 a[104:105], v10 offset:49152
v_mfma_f32_16x16x32_bf16 v[120:123], a[40:43], a[20:23], v[120:123]
buffer_load_dwordx4 v2, s[8:11], s28 offen lds
v_mfma_f32_16x16x32_bf16 v[128:131], a[40:43], a[24:27], v[128:131]
ds_read_b64_tr_b16 a[106:107], v10 offset:50176
v_mfma_f32_16x16x32_bf16 v[136:139], a[40:43], a[28:31], v[136:139]
ds_read_b64_tr_b16 a[108:109], v11 offset:49152
s_add_u32 s28, s28, s30
v_mfma_f32_16x16x32_bf16 v[84:87], a[44:47], a[0:3], v[84:87]
v_mfma_f32_16x16x32_bf16 v[92:95], a[44:47], a[4:7], v[92:95]
ds_read_b64_tr_b16 a[110:111], v11 offset:50176
s_add_u32 s34, s34, 32768
v_mfma_f32_16x16x32_bf16 v[100:103], a[44:47], a[8:11], v[100:103]
v_mfma_f32_16x16x32_bf16 v[108:111], a[44:47], a[12:15], v[108:111]
ds_read_b64_tr_b16 a[112:113], v8 offset:57344
s_cmp_ge_u32 s34, s36
v_mfma_f32_16x16x32_bf16 v[116:119], a[44:47], a[16:19], v[116:119]
ds_read_b64_tr_b16 a[114:115], v8 offset:58368
v_mfma_f32_16x16x32_bf16 v[124:127], a[44:47], a[20:23], v[124:127]
s_cselect_b32 s34, s35, s34
v_mfma_f32_16x16x32_bf16 v[132:135], a[44:47], a[24:27], v[132:135]
ds_read_b64_tr_b16 a[116:117], v9 offset:57344
v_mfma_f32_16x16x32_bf16 v[140:143], a[44:47], a[28:31], v[140:143]
ds_read_b64_tr_b16 a[118:119], v9 offset:58368
s_add_u32 m0, s43, 32768
v_mfma_f32_16x16x32_bf16 v[144:147], a[48:51], a[0:3], v[144:147]
v_mfma_f32_16x16x32_bf16 v[152:155], a[48:51], a[4:7], v[152:155]
ds_read_b64_tr_b16 a[120:121], v10 offset:57344
buffer_load_dwordx4 v3, s[12:15], s31 offen lds
v_mfma_f32_16x16x32_bf16 v[160:163], a[48:51], a[8:11], v[160:163]
v_mfma_f32_16x16x32_bf16 v[168:171], a[48:51], a[12:15], v[168:171]
ds_read_b64_tr_b16 a[122:123], v10 offset:58368
s_add_u32 s31, s31, s32
v_mfma_f32_16x16x32_bf16 v[176:179], a[48:51], a[16:19], v[176:179]
ds_read_b64_tr_b16 a[124:125], v11 offset:57344
v_mfma_f32_16x16x32_bf16 v[184:187], a[48:51], a[20:23], v[184:187]
s_add_u32 m0, s43, 33792
v_mfma_f32_16x16x32_bf16 v[192:195], a[48:51], a[24:27], v[192:195]
ds_read_b64_tr_b16 a[126:127], v11 offset:58368
v_mfma_f32_16x16x32_bf16 v[200:203], a[48:51], a[28:31], v[200:203]
buffer_load_dwordx4 v3, s[12:15], s31 offen lds
v_mfma_f32_16x16x32_bf16 v[148:151], a[52:55], a[0:3], v[148:151]
v_mfma_f32_16x16x32_bf16 v[156:159], a[52:55], a[4:7], v[156:159]
v_mfma_f32_16x16x32_bf16 v[164:167], a[52:55], a[8:11], v[164:167]
s_add_u32 s31, s31, s33
v_mfma_f32_16x16x32_bf16 v[172:175], a[52:55], a[12:15], v[172:175]
v_mfma_f32_16x16x32_bf16 v[180:183], a[52:55], a[16:19], v[180:183]
s_add_u32 m0, s43, 36864
v_mfma_f32_16x16x32_bf16 v[188:191], a[52:55], a[20:23], v[188:191]
v_mfma_f32_16x16x32_bf16 v[196:199], a[52:55], a[24:27], v[196:199]
buffer_load_dwordx4 v3, s[12:15], s31 offen lds
v_mfma_f32_16x16x32_bf16 v[204:207], a[52:55], a[28:31], v[204:207]
v_mfma_f32_16x16x32_bf16 v[208:211], a[56:59], a[0:3], v[208:211]
s_add_u32 s31, s31, s32
v_mfma_f32_16x16x32_bf16 v[216:219], a[56:59], a[4:7], v[216:219]
v_mfma_f32_16x16x32_bf16 v[224:227], a[56:59], a[8:11], v[224:227]
s_add_u32 m0, s43, 37888
v_mfma_f32_16x16x32_bf16 v[232:235], a[56:59], a[12:15], v[232:235]
v_mfma_f32_16x16x32_bf16 v[240:243], a[56:59], a[16:19], v[240:243]
buffer_load_dwordx4 v3, s[12:15], s31 offen lds
v_mfma_f32_16x16x32_bf16 v[248:251], a[56:59], a[20:23], v[248:251]
v_mfma_f32_16x16x32_bf16 a[128:131], a[56:59], a[24:27], a[128:131]
s_add_u32 s31, s31, s33
v_mfma_f32_16x16x32_bf16 a[136:139], a[56:59], a[28:31], a[136:139]
v_mfma_f32_16x16x32_bf16 v[212:215], a[60:63], a[0:3], v[212:215]
s_add_u32 s38, s38, 32768
v_mfma_f32_16x16x32_bf16 v[220:223], a[60:63], a[4:7], v[220:223]
v_mfma_f32_16x16x32_bf16 v[228:231], a[60:63], a[8:11], v[228:231]
s_cmp_ge_u32 s38, s42
v_mfma_f32_16x16x32_bf16 v[236:239], a[60:63], a[12:15], v[236:239]
v_mfma_f32_16x16x32_bf16 v[244:247], a[60:63], a[16:19], v[244:247]
s_cselect_b32 s38, s41, s38
v_mfma_f32_16x16x32_bf16 v[252:255], a[60:63], a[20:23], v[252:255]
v_mfma_f32_16x16x32_bf16 a[132:135], a[60:63], a[24:27], a[132:135]
v_mfma_f32_16x16x32_bf16 a[140:143], a[60:63], a[28:31], a[140:143]
s_waitcnt vmcnt(16) lgkmcnt(0)
s_barrier
v_mfma_f32_16x16x32_bf16 v[16:19], a[96:99], a[64:67], v[16:19]
v_add_u32 v6, s37, v4
s_add_u32 m0, s34, 0
v_mfma_f32_16x16x32_bf16 v[24:27], a[96:99], a[68:71], v[24:27]
ds_read_b64_tr_b16 a[32:33], v8 offset:0
v_mfma_f32_16x16x32_bf16 v[32:35], a[96:99], a[72:75], v[32:35]
ds_read_b64_tr_b16 a[34:35], v8 offset:1024
buffer_load_dwordx4 v2, s[8:11], s28 offen lds
v_mfma_f32_16x16x32_bf16 v[40:43], a[96:99], a[76:79], v[40:43]
v_mfma_f32_16x16x32_bf16 v[48:51], a[96:99], a[80:83], v[48:51]
ds_read_b128 a[0:3], v6 offset:0
s_add_u32 s28, s28, s29
v_mfma_f32_16x16x32_bf16 v[56:59], a[96:99], a[84:87], v[56:59]
ds_read_b128 a[4:7], v6 offset:2048
v_mfma_f32_16x16x32_bf16 v[64:67], a[96:99], a[88:91], v[64:67]
v_mfma_f32_16x16x32_bf16 v[72:75], a[96:99], a[92:95], v[72:75]
ds_read_b128 a[8:11], v6 offset:4096
s_add_u32 m0, s34, 4096
v_mfma_f32_16x16x32_bf16 v[20:23], a[100:103], a[64:67], v[20:23]
v_mfma_f32_16x16x32_bf16 v[28:31], a[100:103], a[68:71], v[28:31]
ds_read_b128 a[12:15], v6 offset:6144
buffer_load_dwordx4 v2, s[8:11], s28 offen lds
v_mfma_f32_16x16x32_bf16 v[36:39], a[100:103], a[72:75], v[36:39]
ds_read_b128 a[16:19], v6 offset:8192
v_mfma_f32_16x16x32_bf16 v[44:47], a[100:103], a[76:79], v[44:47]
s_add_u32 s28, s28, s29
v_mfma_f32_16x16x32_bf16 v[52:55], a[100:103], a[80:83], v[52:55]
ds_read_b128 a[20:23], v6 offset:10240
v_mfma_f32_16x16x32_bf16 v[60:63], a[100:103], a[84:87], v[60:63]
v_mfma_f32_16x16x32_bf16 v[68:71], a[100:103], a[88:91], v[68:71]
ds_read_b128 a[24:27], v6 offset:12288
s_add_u32 m0, s34, 8192
v_mfma_f32_16x16x32_bf16 v[76:79], a[100:103], a[92:95], v[76:79]
ds_read_b128 a[28:31], v6 offset:14336
v_mfma_f32_16x16x32_bf16 v[80:83], a[104:107], a[64:67], v[80:83]
buffer_load_dwordx4 v2, s[8:11], s28 offen lds
v_mfma_f32_16x16x32_bf16 v[88:91], a[104:107], a[68:71], v[88:91]
ds_read_b64_tr_b16 a[36:37], v9 offset:0
v_mfma_f32_16x16x32_bf16 v[96:99], a[104:107], a[72:75], v[96:99]
ds_read_b64_tr_b16 a[38:39], v9 offset:1024
s_add_u32 s28, s28, s29
v_mfma_f32_16x16x32_bf16 v[104:107], a[104:107], a[76:79], v[104:107]
v_mfma_f32_16x16x32_bf16 v[112:115], a[104:107], a[80:83], v[112:115]
ds_read_b64_tr_b16 a[40:41], v10 offset:0
v_mfma_f32_16x16x32_bf16 v[120:123], a[104:107], a[84:87], v[120:123]
s_add_u32 m0, s34, 12288
v_mfma_f32_16x16x32_bf16 v[128:131], a[104:107], a[88:91], v[128:131]
ds_read_b64_tr_b16 a[42:43], v10 offset:1024
v_mfma_f32_16x16x32_bf16 v[136:139], a[104:107], a[92:95], v[136:139]
ds_read_b64_tr_b16 a[44:45], v11 offset:0
buffer_load_dwordx4 v2, s[8:11], s28 offen lds
v_mfma_f32_16x16x32_bf16 v[84:87], a[108:111], a[64:67], v[84:87]
v_mfma_f32_16x16x32_bf16 v[92:95], a[108:111], a[68:71], v[92:95]
ds_read_b64_tr_b16 a[46:47], v11 offset:1024
s_add_u32 s28, s28, s29
v_mfma_f32_16x16x32_bf16 v[100:103], a[108:111], a[72:75], v[100:103]
v_mfma_f32_16x16x32_bf16 v[108:111], a[108:111], a[76:79], v[108:111]
ds_read_b64_tr_b16 a[48:49], v8 offset:8192
v_mfma_f32_16x16x32_bf16 v[116:119], a[108:111], a[80:83], v[116:119]
ds_read_b64_tr_b16 a[50:51], v8 offset:9216
s_add_u32 m0, s43, 49152
v_mfma_f32_16x16x32_bf16 v[124:127], a[108:111], a[84:87], v[124:127]
v_mfma_f32_16x16x32_bf16 v[132:135], a[108:111], a[88:91], v[132:135]
ds_read_b64_tr_b16 a[52:53], v9 offset:8192
buffer_load_dwordx4 v3, s[12:15], s31 offen lds
v_mfma_f32_16x16x32_bf16 v[140:143], a[108:111], a[92:95], v[140:143]
ds_read_b64_tr_b16 a[54:55], v9 offset:9216
v_mfma_f32_16x16x32_bf16 v[144:147], a[112:115], a[64:67], v[144:147]
s_add_u32 s31, s31, s32
v_mfma_f32_16x16x32_bf16 v[152:155], a[112:115], a[68:71], v[152:155]
ds_read_b64_tr_b16 a[56:57], v10 offset:8192
v_mfma_f32_16x16x32_bf16 v[160:163], a[112:115], a[72:75], v[160:163]
v_mfma_f32_16x16x32_bf16 v[168:171], a[112:115], a[76:79], v[168:171]
ds_read_b64_tr_b16 a[58:59], v10 offset:9216
s_add_u32 m0, s43, 50176
v_mfma_f32_16x16x32_bf16 v[176:179], a[112:115], a[80:83], v[176:179]
ds_read_b64_tr_b16 a[60:61], v11 offset:8192
v_mfma_f32_16x16x32_bf16 v[184:187], a[112:115], a[84:87], v[184:187]
buffer_load_dwordx4 v3, s[12:15], s31 offen lds
v_mfma_f32_16x16x32_bf16 v[192:195], a[112:115], a[88:91], v[192:195]
ds_read_b64_tr_b16 a[62:63], v11 offset:9216
v_mfma_f32_16x16x32_bf16 v[200:203], a[112:115], a[92:95], v[200:203]
s_add_u32 s31, s31, s33
v_mfma_f32_16x16x32_bf16 v[148:151], a[116:119], a[64:67], v[148:151]
v_mfma_f32_16x16x32_bf16 v[156:159], a[116:119], a[68:71], v[156:159]
v_mfma_f32_16x16x32_bf16 v[164:167], a[116:119], a[72:75], v[164:167]
s_add_u32 m0, s43, 53248
v_mfma_f32_16x16x32_bf16 v[172:175], a[116:119], a[76:79], v[172:175]
v_mfma_f32_16x16x32_bf16 v[180:183], a[116:119], a[80:83], v[180:183]
buffer_load_dwordx4 v3, s[12:15], s31 offen lds
v_mfma_f32_16x16x32_bf16 v[188:191], a[116:119], a[84:87], v[188:191]
v_mfma_f32_16x16x32_bf16 v[196:199], a[116:119], a[88:91], v[196:199]
s_add_u32 s31, s31, s32
v_mfma_f32_16x16x32_bf16 v[204:207], a[116:119], a[92:95], v[204:207]
v_mfma_f32_16x16x32_bf16 v[208:211], a[120:123], a[64:67], v[208:211]
v_mfma_f32_16x16x32_bf16 v[216:219], a[120:123], a[68:71], v[216:219]
s_add_u32 m0, s43, 54272
v_mfma_f32_16x16x32_bf16 v[224:227], a[120:123], a[72:75], v[224:227]
v_mfma_f32_16x16x32_bf16 v[232:235], a[120:123], a[76:79], v[232:235]
buffer_load_dwordx4 v3, s[12:15], s31 offen lds
v_mfma_f32_16x16x32_bf16 v[240:243], a[120:123], a[80:83], v[240:243]
v_mfma_f32_16x16x32_bf16 v[248:251], a[120:123], a[84:87], v[248:251]
s_add_u32 s31, s31, s33
v_mfma_f32_16x16x32_bf16 a[128:131], a[120:123], a[88:91], a[128:131]
v_mfma_f32_16x16x32_bf16 a[136:139], a[120:123], a[92:95], a[136:139]
v_mfma_f32_16x16x32_bf16 v[212:215], a[124:127], a[64:67], v[212:215]
s_add_u32 s37, s37, 32768
v_mfma_f32_16x16x32_bf16 v[220:223], a[124:127], a[68:71], v[220:223]
v_mfma_f32_16x16x32_bf16 v[228:231], a[124:127], a[72:75], v[228:231]
s_cmp_ge_u32 s37, s42
v_mfma_f32_16x16x32_bf16 v[236:239], a[124:127], a[76:79], v[236:239]
v_mfma_f32_16x16x32_bf16 v[244:247], a[124:127], a[80:83], v[244:247]
s_cselect_b32 s37, s41, s37
v_mfma_f32_16x16x32_bf16 v[252:255], a[124:127], a[84:87], v[252:255]
v_mfma_f32_16x16x32_bf16 a[132:135], a[124:127], a[88:91], a[132:135]
v_mfma_f32_16x16x32_bf16 a[140:143], a[124:127], a[92:95], a[140:143]
s_waitcnt vmcnt(16) lgkmcnt(0)
s_barrier
v_mfma_f32_16x16x32_bf16 v[16:19], a[32:35], a[0:3], v[16:19]
v_add_u32 v7, s38, v5
s_add_u32 m0, s34, 16384
v_mfma_f32_16x16x32_bf16 v[24:27], a[32:35], a[4:7], v[24:27]
ds_read_b64_tr_b16 a[96:97], v8 offset:16384
v_mfma_f32_16x16x32_bf16 v[32:35], a[32:35], a[8:11], v[32:35]
ds_read_b64_tr_b16 a[98:99], v8 offset:17408
buffer_load_dwordx4 v2, s[8:11], s28 offen lds
v_mfma_f32_16x16x32_bf16 v[40:43], a[32:35], a[12:15], v[40:43]
v_mfma_f32_16x16x32_bf16 v[48:51], a[32:35], a[16:19], v[48:51]
ds_read_b128 a[64:67], v7 offset:0
s_add_u32 s28, s28, s29
v_mfma_f32_16x16x32_bf16 v[56:59], a[32:35], a[20:23], v[56:59]
ds_read_b128 a[68:71], v7 offset:2048
v_mfma_f32_16x16x32_bf16 v[64:67], a[32:35], a[24:27], v[64:67]
s_add_u32 m0, s34, 20480
v_mfma_f32_16x16x32_bf16 v[72:75], a[32:35], a[28:31], v[72:75]
ds_read_b128 a[72:75], v7 offset:4096
v_mfma_f32_16x16x32_bf16 v[20:23], a[36:39], a[0:3], v[20:23]
buffer_load_dwordx4 v2, s[8:11], s28 offen lds
v_mfma_f32_16x16x32_bf16 v[28:31], a[36:39], a[4:7], v[28:31]
ds_read_b128 a[76:79], v7 offset:6144
v_mfma_f32_16x16x32_bf16 v[36:39], a[36:39], a[8:11], v[36:39]
ds_read_b128 a[80:83], v7 offset:8192
s_add_u32 s28, s28, s29
v_mfma_f32_16x16x32_bf16 v[44:47], a[36:39], a[12:15], v[44:47]
v_mfma_f32_16x16x32_bf16 v[52:55], a[36:39], a[16:19], v[52:55]
ds_read_b128 a[84:87], v7 offset:10240
s_add_u32 m0, s34, 24576
v_mfma_f32_16x16x32_bf16 v[60:63], a[36:39], a[20:23], v[60:63]
v_mfma_f32_16x16x32_bf16 v[68:71], a[36:39], a[24:27], v[68:71]
ds_read_b128 a[88:91], v7 offset:12288
buffer_load_dwordx4 v2, s[8:11], s28 offen lds
v_mfma_f32_16x16x32_bf16 v[76:79], a[36:39], a[28:31], v[76:79]
ds_read_b128 a[92:95], v7 offset:14336
v_mfma_f32_16x16x32_bf16 v[80:83], a[40:43], a[0:3], v[80:83]
s_add_u32 s28, s28, s29
v_mfma_f32_16x16x32_bf16 v[88:91], a[40:43], a[4:7], v[88:91]
ds_read_b64_tr_b16 a[100:101], v9 offset:16384
v_mfma_f32_16x16x32_bf16 v[96:99], a[40:43], a[8:11], v[96:99]
ds_read_b64_tr_b16 a[102:103], v9 offset:17408
s_add_u32 m0, s34, 28672
v_mfma_f32_16x16x32_bf16 v[104:107], a[40:43], a[12:15], v[104:107]
v_mfma_f32_16x16x32_bf16 v[112:115], a[40:43], a[16:19], v[112:115]
ds_read_b64_tr_b16 a[104:105], v10 offset:16384
v_mfma_f32_16x16x32_bf16 v[120:123], a[40:43], a[20:23], v[120:123]
buffer_load_dwordx4 v2, s[8:11], s28 offen lds
v_mfma_f32_16x16x32_bf16 v[128:131], a[40:43], a[24:27], v[128:131]
ds_read_b64_tr_b16 a[106:107], v10 offset:17408
v_mfma_f32_16x16x32_bf16 v[136:139], a[40:43], a[28:31], v[136:139]
ds_read_b64_tr_b16 a[108:109], v11 offset:16384
s_add_u32 s28, s28, s30
v_mfma_f32_16x16x32_bf16 v[84:87], a[44:47], a[0:3], v[84:87]
v_mfma_f32_16x16x32_bf16 v[92:95], a[44:47], a[4:7], v[92:95]
ds_read_b64_tr_b16 a[110:111], v11 offset:17408
s_add_u32 s34, s34, 32768
v_mfma_f32_16x16x32_bf16 v[100:103], a[44:47], a[8:11], v[100:103]
v_mfma_f32_16x16x32_bf16 v[108:111], a[44:47], a[12:15], v[108:111]
ds_read_b64_tr_b16 a[112:113], v8 offset:24576
s_cmp_ge_u32 s34, s36
v_mfma_f32_16x16x32_bf16 v[116:119], a[44:47], a[16:19], v[116:119]
ds_read_b64_tr_b16 a[114:115], v8 offset:25600
v_mfma_f32_16x16x32_bf16 v[124:127], a[44:47], a[20:23], v[124:127]
s_cselect_b32 s34, s35, s34
v_mfma_f32_16x16x32_bf16 v[132:135], a[44:47], a[24:27], v[132:135]
ds_read_b64_tr_b16 a[116:117], v9 offset:24576
v_mfma_f32_16x16x32_bf16 v[140:143], a[44:47], a[28:31], v[140:143]
ds_read_b64_tr_b16 a[118:119], v9 offset:25600
s_add_u32 m0, s43, 0
v_mfma_f32_16x16x32_bf16 v[144:147], a[48:51], a[0:3], v[144:147]
v_mfma_f32_16x16x32_bf16 v[152:155], a[48:51], a[4:7], v[152:155]
ds_read_b64_tr_b16 a[120:121], v10 offset:24576
buffer_load_dwordx4 v3, s[12:15], s31 offen lds
v_mfma_f32_16x16x32_bf16 v[160:163], a[48:51], a[8:11], v[160:163]
v_mfma_f32_16x16x32_bf16 v[168:171], a[48:51], a[12:15], v[168:171]
ds_read_b64_tr_b16 a[122:123], v10 offset:25600
s_add_u32 s31, s31, s32
v_mfma_f32_16x16x32_bf16 v[176:179], a[48:51], a[16:19], v[176:179]
ds_read_b64_tr_b16 a[124:125], v11 offset:24576
v_mfma_f32_16x16x32_bf16 v[184:187], a[48:51], a[20:23], v[184:187]
s_add_u32 m0, s43, 1024
v_mfma_f32_16x16x32_bf16 v[192:195], a[48:51], a[24:27], v[192:195]
ds_read_b64_tr_b16 a[126:127], v11 offset:25600
v_mfma_f32_16x16x32_bf16 v[200:203], a[48:51], a[28:31], v[200:203]
buffer_load_dwordx4 v3, s[12:15], s31 offen lds
v_mfma_f32_16x16x32_bf16 v[148:151], a[52:55], a[0:3], v[148:151]
v_mfma_f32_16x16x32_bf16 v[156:159], a[52:55], a[4:7], v[156:159]
v_mfma_f32_16x16x32_bf16 v[164:167], a[52:55], a[8:11], v[164:167]
s_add_u32 s31, s31, s33
v_mfma_f32_16x16x32_bf16 v[172:175], a[52:55], a[12:15], v[172:175]
v_mfma_f32_16x16x32_bf16 v[180:183], a[52:55], a[16:19], v[180:183]
s_add_u32 m0, s43, 4096
v_mfma_f32_16x16x32_bf16 v[188:191], a[52:55], a[20:23], v[188:191]
v_mfma_f32_16x16x32_bf16 v[196:199], a[52:55], a[24:27], v[196:199]
buffer_load_dwordx4 v3, s[12:15], s31 offen lds
v_mfma_f32_16x16x32_bf16 v[204:207], a[52:55], a[28:31], v[204:207]
v_mfma_f32_16x16x32_bf16 v[208:211], a[56:59], a[0:3], v[208:211]
s_add_u32 s31, s31, s32
v_mfma_f32_16x16x32_bf16 v[216:219], a[56:59], a[4:7], v[216:219]
v_mfma_f32_16x16x32_bf16 v[224:227], a[56:59], a[8:11], v[224:227]
s_add_u32 m0, s43, 5120
v_mfma_f32_16x16x32_bf16 v[232:235], a[56:59], a[12:15], v[232:235]
v_mfma_f32_16x16x32_bf16 v[240:243], a[56:59], a[16:19], v[240:243]
buffer_load_dwordx4 v3, s[12:15], s31 offen lds
v_mfma_f32_16x16x32_bf16 v[248:251], a[56:59], a[20:23], v[248:251]
v_mfma_f32_16x16x32_bf16 a[128:131], a[56:59], a[24:27], a[128:131]
s_add_u32 s31, s31, s33
v_mfma_f32_16x16x32_bf16 a[136:139], a[56:59], a[28:31], a[136:139]
v_mfma_f32_16x16x32_bf16 v[212:215], a[60:63], a[0:3], v[212:215]
s_add_u32 s38, s38, 32768
v_mfma_f32_16x16x32_bf16 v[220:223], a[60:63], a[4:7], v[220:223]
v_mfma_f32_16x16x32_bf16 v[228:231], a[60:63], a[8:11], v[228:231]
s_cmp_ge_u32 s38, s42
v_mfma_f32_16x16x32_bf16 v[236:239], a[60:63], a[12:15], v[236:239]
v_mfma_f32_16x16x32_bf16 v[244:247], a[60:63], a[16:19], v[244:247]
s_cselect_b32 s38, s41, s38
v_mfma_f32_16x16x32_bf16 v[252:255], a[60:63], a[20:23], v[252:255]
v_mfma_f32_16x16x32_bf16 a[132:135], a[60:63], a[24:27], a[132:135]
v_mfma_f32_16x16x32_bf16 a[140:143], a[60:63], a[28:31], a[140:143]
s_cmp_lg_u32 s3, 0
s_cbranch_scc1 fused_kernel_noxl_30
buffer_load_dword v14, v12, s[64:67], 0 offen sc1
fused_kernel_noxl_30:
s_waitcnt vmcnt(16) lgkmcnt(0)
s_barrier
v_mfma_f32_16x16x32_bf16 v[16:19], a[96:99], a[64:67], v[16:19]
v_add_u32 v6, s37, v4
s_add_u32 m0, s34, 0
v_mfma_f32_16x16x32_bf16 v[24:27], a[96:99], a[68:71], v[24:27]
ds_read_b64_tr_b16 a[32:33], v8 offset:32768
v_mfma_f32_16x16x32_bf16 v[32:35], a[96:99], a[72:75], v[32:35]
ds_read_b64_tr_b16 a[34:35], v8 offset:33792
buffer_load_dwordx4 v2, s[8:11], s28 offen lds
v_mfma_f32_16x16x32_bf16 v[40:43], a[96:99], a[76:79], v[40:43]
v_mfma_f32_16x16x32_bf16 v[48:51], a[96:99], a[80:83], v[48:51]
ds_read_b128 a[0:3], v6 offset:0
s_add_u32 s28, s28, s29
v_mfma_f32_16x16x32_bf16 v[56:59], a[96:99], a[84:87], v[56:59]
ds_read_b128 a[4:7], v6 offset:2048
v_mfma_f32_16x16x32_bf16 v[64:67], a[96:99], a[88:91], v[64:67]
v_mfma_f32_16x16x32_bf16 v[72:75], a[96:99], a[92:95], v[72:75]
ds_read_b128 a[8:11], v6 offset:4096
s_add_u32 m0, s34, 4096
v_mfma_f32_16x16x32_bf16 v[20:23], a[100:103], a[64:67], v[20:23]
v_mfma_f32_16x16x32_bf16 v[28:31], a[100:103], a[68:71], v[28:31]
ds_read_b128 a[12:15], v6 offset:6144
buffer_load_dwordx4 v2, s[8:11], s28 offen lds
v_mfma_f32_16x16x32_bf16 v[36:39], a[100:103], a[72:75], v[36:39]
ds_read_b128 a[16:19], v6 offset:8192
v_mfma_f32_16x16x32_bf16 v[44:47], a[100:103], a[76:79], v[44:47]
s_add_u32 s28, s28, s29
v_mfma_f32_16x16x32_bf16 v[52:55], a[100:103], a[80:83], v[52:55]
ds_read_b128 a[20:23], v6 offset:10240
v_mfma_f32_16x16x32_bf16 v[60:63], a[100:103], a[84:87], v[60:63]
v_mfma_f32_16x16x32_bf16 v[68:71], a[100:103], a[88:91], v[68:71]
ds_read_b128 a[24:27], v6 offset:12288
s_add_u32 m0, s34, 8192
v_mfma_f32_16x16x32_bf16 v[76:79], a[100:103], a[92:95], v[76:79]
ds_read_b128 a[28:31], v6 offset:14336
v_mfma_f32_16x16x32_bf16 v[80:83], a[104:107], a[64:67], v[80:83]
buffer_load_dwordx4 v2, s[8:11], s28 offen lds
v_mfma_f32_16x16x32_bf16 v[88:91], a[104:107], a[68:71], v[88:91]
ds_read_b64_tr_b16 a[36:37], v9 offset:32768
v_mfma_f32_16x16x32_bf16 v[96:99], a[104:107], a[72:75], v[96:99]
ds_read_b64_tr_b16 a[38:39], v9 offset:33792
s_add_u32 s28, s28, s29
v_mfma_f32_16x16x32_bf16 v[104:107], a[104:107], a[76:79], v[104:107]
v_mfma_f32_16x16x32_bf16 v[112:115], a[104:107], a[80:83], v[112:115]
ds_read_b64_tr_b16 a[40:41], v10 offset:32768
v_mfma_f32_16x16x32_bf16 v[120:123], a[104:107], a[84:87], v[120:123]
s_add_u32 m0, s34, 12288
v_mfma_f32_16x16x32_bf16 v[128:131], a[104:107], a[88:91], v[128:131]
ds_read_b64_tr_b16 a[42:43], v10 offset:33792
v_mfma_f32_16x16x32_bf16 v[136:139], a[104:107], a[92:95], v[136:139]
ds_read_b64_tr_b16 a[44:45], v11 offset:32768
buffer_load_dwordx4 v2, s[8:11], s28 offen lds
v_mfma_f32_16x16x32_bf16 v[84:87], a[108:111], a[64:67], v[84:87]
v_mfma_f32_16x16x32_bf16 v[92:95], a[108:111], a[68:71], v[92:95]
ds_read_b64_tr_b16 a[46:47], v11 offset:33792
s_add_u32 s28, s28, s29
v_mfma_f32_16x16x32_bf16 v[100:103], a[108:111], a[72:75], v[100:103]
v_mfma_f32_16x16x32_bf16 v[108:111], a[108:111], a[76:79], v[108:111]
ds_read_b64_tr_b16 a[48:49], v8 offset:40960
v_mfma_f32_16x16x32_bf16 v[116:119], a[108:111], a[80:83], v[116:119]
ds_read_b64_tr_b16 a[50:51], v8 offset:41984
s_add_u32 m0, s43, 16384
v_mfma_f32_16x16x32_bf16 v[124:127], a[108:111], a[84:87], v[124:127]
v_mfma_f32_16x16x32_bf16 v[132:135], a[108:111], a[88:91], v[132:135]
ds_read_b64_tr_b16 a[52:53], v9 offset:40960
buffer_load_dwordx4 v3, s[12:15], s31 offen lds
v_mfma_f32_16x16x32_bf16 v[140:143], a[108:111], a[92:95], v[140:143]
ds_read_b64_tr_b16 a[54:55], v9 offset:41984
v_mfma_f32_16x16x32_bf16 v[144:147], a[112:115], a[64:67], v[144:147]
s_add_u32 s31, s31, s32
v_mfma_f32_16x16x32_bf16 v[152:155], a[112:115], a[68:71], v[152:155]
ds_read_b64_tr_b16 a[56:57], v10 offset:40960
v_mfma_f32_16x16x32_bf16 v[160:163], a[112:115], a[72:75], v[160:163]
v_mfma_f32_16x16x32_bf16 v[168:171], a[112:115], a[76:79], v[168:171]
ds_read_b64_tr_b16 a[58:59], v10 offset:41984
s_add_u32 m0, s43, 17408
v_mfma_f32_16x16x32_bf16 v[176:179], a[112:115], a[80:83], v[176:179]
ds_read_b64_tr_b16 a[60:61], v11 offset:40960
v_mfma_f32_16x16x32_bf16 v[184:187], a[112:115], a[84:87], v[184:187]
buffer_load_dwordx4 v3, s[12:15], s31 offen lds
v_mfma_f32_16x16x32_bf16 v[192:195], a[112:115], a[88:91], v[192:195]
ds_read_b64_tr_b16 a[62:63], v11 offset:41984
v_mfma_f32_16x16x32_bf16 v[200:203], a[112:115], a[92:95], v[200:203]
s_add_u32 s31, s31, s33
v_mfma_f32_16x16x32_bf16 v[148:151], a[116:119], a[64:67], v[148:151]
v_mfma_f32_16x16x32_bf16 v[156:159], a[116:119], a[68:71], v[156:159]
v_mfma_f32_16x16x32_bf16 v[164:167], a[116:119], a[72:75], v[164:167]
s_add_u32 m0, s43, 20480
v_mfma_f32_16x16x32_bf16 v[172:175], a[116:119], a[76:79], v[172:175]
v_mfma_f32_16x16x32_bf16 v[180:183], a[116:119], a[80:83], v[180:183]
buffer_load_dwordx4 v3, s[12:15], s31 offen lds
v_mfma_f32_16x16x32_bf16 v[188:191], a[116:119], a[84:87], v[188:191]
v_mfma_f32_16x16x32_bf16 v[196:199], a[116:119], a[88:91], v[196:199]
s_add_u32 s31, s31, s32
v_mfma_f32_16x16x32_bf16 v[204:207], a[116:119], a[92:95], v[204:207]
v_mfma_f32_16x16x32_bf16 v[208:211], a[120:123], a[64:67], v[208:211]
v_mfma_f32_16x16x32_bf16 v[216:219], a[120:123], a[68:71], v[216:219]
s_add_u32 m0, s43, 21504
v_mfma_f32_16x16x32_bf16 v[224:227], a[120:123], a[72:75], v[224:227]
v_mfma_f32_16x16x32_bf16 v[232:235], a[120:123], a[76:79], v[232:235]
buffer_load_dwordx4 v3, s[12:15], s31 offen lds
v_mfma_f32_16x16x32_bf16 v[240:243], a[120:123], a[80:83], v[240:243]
v_mfma_f32_16x16x32_bf16 v[248:251], a[120:123], a[84:87], v[248:251]
s_add_u32 s31, s31, s33
v_mfma_f32_16x16x32_bf16 a[128:131], a[120:123], a[88:91], a[128:131]
v_mfma_f32_16x16x32_bf16 a[136:139], a[120:123], a[92:95], a[136:139]
v_mfma_f32_16x16x32_bf16 v[212:215], a[124:127], a[64:67], v[212:215]
s_add_u32 s37, s37, 32768
v_mfma_f32_16x16x32_bf16 v[220:223], a[124:127], a[68:71], v[220:223]
v_mfma_f32_16x16x32_bf16 v[228:231], a[124:127], a[72:75], v[228:231]
s_cmp_ge_u32 s37, s42
v_mfma_f32_16x16x32_bf16 v[236:239], a[124:127], a[76:79], v[236:239]
v_mfma_f32_16x16x32_bf16 v[244:247], a[124:127], a[80:83], v[244:247]
s_cselect_b32 s37, s41, s37
v_mfma_f32_16x16x32_bf16 v[252:255], a[124:127], a[84:87], v[252:255]
v_mfma_f32_16x16x32_bf16 a[132:135], a[124:127], a[88:91], a[132:135]
v_mfma_f32_16x16x32_bf16 a[140:143], a[124:127], a[92:95], a[140:143]
s_waitcnt vmcnt(16) lgkmcnt(0)
s_barrier
v_mfma_f32_16x16x32_bf16 v[16:19], a[32:35], a[0:3], v[16:19]
v_add_u32 v7, s38, v5
s_add_u32 m0, s34, 16384
v_mfma_f32_16x16x32_bf16 v[24:27], a[32:35], a[4:7], v[24:27]
ds_read_b64_tr_b16 a[96:97], v8 offset:49152
v_mfma_f32_16x16x32_bf16 v[32:35], a[32:35], a[8:11], v[32:35]
ds_read_b64_tr_b16 a[98:99], v8 offset:50176
buffer_load_dwordx4 v2, s[8:11], s28 offen lds
v_mfma_f32_16x16x32_bf16 v[40:43], a[32:35], a[12:15], v[40:43]
v_mfma_f32_16x16x32_bf16 v[48:51], a[32:35], a[16:19], v[48:51]
ds_read_b128 a[64:67], v7 offset:0
s_add_u32 s28, s28, s29
v_mfma_f32_16x16x32_bf16 v[56:59], a[32:35], a[20:23], v[56:59]
ds_read_b128 a[68:71], v7 offset:2048
v_mfma_f32_16x16x32_bf16 v[64:67], a[32:35], a[24:27], v[64:67]
s_add_u32 m0, s34, 20480
v_mfma_f32_16x16x32_bf16 v[72:75], a[32:35], a[28:31], v[72:75]
ds_read_b128 a[72:75], v7 offset:4096
v_mfma_f32_16x16x32_bf16 v[20:23], a[36:39], a[0:3], v[20:23]
buffer_load_dwordx4 v2, s[8:11], s28 offen lds
v_mfma_f32_16x16x32_bf16 v[28:31], a[36:39], a[4:7], v[28:31]
ds_read_b128 a[76:79], v7 offset:6144
v_mfma_f32_16x16x32_bf16 v[36:39], a[36:39], a[8:11], v[36:39]
ds_read_b128 a[80:83], v7 offset:8192
s_add_u32 s28, s28, s29
v_mfma_f32_16x16x32_bf16 v[44:47], a[36:39], a[12:15], v[44:47]
v_mfma_f32_16x16x32_bf16 v[52:55], a[36:39], a[16:19], v[52:55]
ds_read_b128 a[84:87], v7 offset:10240
s_add_u32 m0, s34, 24576
v_mfma_f32_16x16x32_bf16 v[60:63], a[36:39], a[20:23], v[60:63]
v_mfma_f32_16x16x32_bf16 v[68:71], a[36:39], a[24:27], v[68:71]
ds_read_b128 a[88:91], v7 offset:12288
buffer_load_dwordx4 v2, s[8:11], s28 offen lds
v_mfma_f32_16x16x32_bf16 v[76:79], a[36:39], a[28:31], v[76:79]
ds_read_b128 a[92:95], v7 offset:14336
v_mfma_f32_16x16x32_bf16 v[80:83], a[40:43], a[0:3], v[80:83]
s_add_u32 s28, s28, s29
v_mfma_f32_16x16x32_bf16 v[88:91], a[40:43], a[4:7], v[88:91]
ds_read_b64_tr_b16 a[100:101], v9 offset:49152
v_mfma_f32_16x16x32_bf16 v[96:99], a[40:43], a[8:11], v[96:99]
ds_read_b64_tr_b16 a[102:103], v9 offset:50176
s_add_u32 m0, s34, 28672
v_mfma_f32_16x16x32_bf16 v[104:107], a[40:43], a[12:15], v[104:107]
v_mfma_f32_16x16x32_bf16 v[112:115], a[40:43], a[16:19], v[112:115]
ds_read_b64_tr_b16 a[104:105], v10 offset:49152
v_mfma_f32_16x16x32_bf16 v[120:123], a[40:43], a[20:23], v[120:123]
buffer_load_dwordx4 v2, s[8:11], s28 offen lds
v_mfma_f32_16x16x32_bf16 v[128:131], a[40:43], a[24:27], v[128:131]
ds_read_b64_tr_b16 a[106:107], v10 offset:50176
v_mfma_f32_16x16x32_bf16 v[136:139], a[40:43], a[28:31], v[136:139]
ds_read_b64_tr_b16 a[108:109], v11 offset:49152
s_add_u32 s28, s28, s30
v_mfma_f32_16x16x32_bf16 v[84:87], a[44:47], a[0:3], v[84:87]
v_mfma_f32_16x16x32_bf16 v[92:95], a[44:47], a[4:7], v[92:95]
ds_read_b64_tr_b16 a[110:111], v11 offset:50176
s_add_u32 s34, s34, 32768
v_mfma_f32_16x16x32_bf16 v[100:103], a[44:47], a[8:11], v[100:103]
v_mfma_f32_16x16x32_bf16 v[108:111], a[44:47], a[12:15], v[108:111]
ds_read_b64_tr_b16 a[112:113], v8 offset:57344
s_cmp_ge_u32 s34, s36
v_mfma_f32_16x16x32_bf16 v[116:119], a[44:47], a[16:19], v[116:119]
ds_read_b64_tr_b16 a[114:115], v8 offset:58368
v_mfma_f32_16x16x32_bf16 v[124:127], a[44:47], a[20:23], v[124:127]
s_cselect_b32 s34, s35, s34
v_mfma_f32_16x16x32_bf16 v[132:135], a[44:47], a[24:27], v[132:135]
ds_read_b64_tr_b16 a[116:117], v9 offset:57344
v_mfma_f32_16x16x32_bf16 v[140:143], a[44:47], a[28:31], v[140:143]
ds_read_b64_tr_b16 a[118:119], v9 offset:58368
s_add_u32 m0, s43, 32768
v_mfma_f32_16x16x32_bf16 v[144:147], a[48:51], a[0:3], v[144:147]
v_mfma_f32_16x16x32_bf16 v[152:155], a[48:51], a[4:7], v[152:155]
ds_read_b64_tr_b16 a[120:121], v10 offset:57344
buffer_load_dwordx4 v3, s[12:15], s31 offen lds
v_mfma_f32_16x16x32_bf16 v[160:163], a[48:51], a[8:11], v[160:163]
v_mfma_f32_16x16x32_bf16 v[168:171], a[48:51], a[12:15], v[168:171]
ds_read_b64_tr_b16 a[122:123], v10 offset:58368
s_add_u32 s31, s31, s32
v_mfma_f32_16x16x32_bf16 v[176:179], a[48:51], a[16:19], v[176:179]
ds_read_b64_tr_b16 a[124:125], v11 offset:57344
v_mfma_f32_16x16x32_bf16 v[184:187], a[48:51], a[20:23], v[184:187]
s_add_u32 m0, s43, 33792
v_mfma_f32_16x16x32_bf16 v[192:195], a[48:51], a[24:27], v[192:195]
ds_read_b64_tr_b16 a[126:127], v11 offset:58368
v_mfma_f32_16x16x32_bf16 v[200:203], a[48:51], a[28:31], v[200:203]
buffer_load_dwordx4 v3, s[12:15], s31 offen lds
v_mfma_f32_16x16x32_bf16 v[148:151], a[52:55], a[0:3], v[148:151]
v_mfma_f32_16x16x32_bf16 v[156:159], a[52:55], a[4:7], v[156:159]
v_mfma_f32_16x16x32_bf16 v[164:167], a[52:55], a[8:11], v[164:167]
s_add_u32 s31, s31, s33
v_mfma_f32_16x16x32_bf16 v[172:175], a[52:55], a[12:15], v[172:175]
v_mfma_f32_16x16x32_bf16 v[180:183], a[52:55], a[16:19], v[180:183]
s_add_u32 m0, s43, 36864
v_mfma_f32_16x16x32_bf16 v[188:191], a[52:55], a[20:23], v[188:191]
v_mfma_f32_16x16x32_bf16 v[196:199], a[52:55], a[24:27], v[196:199]
buffer_load_dwordx4 v3, s[12:15], s31 offen lds
v_mfma_f32_16x16x32_bf16 v[204:207], a[52:55], a[28:31], v[204:207]
v_mfma_f32_16x16x32_bf16 v[208:211], a[56:59], a[0:3], v[208:211]
s_add_u32 s31, s31, s32
v_mfma_f32_16x16x32_bf16 v[216:219], a[56:59], a[4:7], v[216:219]
v_mfma_f32_16x16x32_bf16 v[224:227], a[56:59], a[8:11], v[224:227]
s_add_u32 m0, s43, 37888
v_mfma_f32_16x16x32_bf16 v[232:235], a[56:59], a[12:15], v[232:235]
v_mfma_f32_16x16x32_bf16 v[240:243], a[56:59], a[16:19], v[240:243]
buffer_load_dwordx4 v3, s[12:15], s31 offen lds
v_mfma_f32_16x16x32_bf16 v[248:251], a[56:59], a[20:23], v[248:251]
v_mfma_f32_16x16x32_bf16 a[128:131], a[56:59], a[24:27], a[128:131]
s_add_u32 s31, s31, s33
v_mfma_f32_16x16x32_bf16 a[136:139], a[56:59], a[28:31], a[136:139]
v_mfma_f32_16x16x32_bf16 v[212:215], a[60:63], a[0:3], v[212:215]
s_add_u32 s38, s38, 32768
v_mfma_f32_16x16x32_bf16 v[220:223], a[60:63], a[4:7], v[220:223]
v_mfma_f32_16x16x32_bf16 v[228:231], a[60:63], a[8:11], v[228:231]
s_cmp_ge_u32 s38, s42
v_mfma_f32_16x16x32_bf16 v[236:239], a[60:63], a[12:15], v[236:239]
v_mfma_f32_16x16x32_bf16 v[244:247], a[60:63], a[16:19], v[244:247]
s_cselect_b32 s38, s41, s38
v_mfma_f32_16x16x32_bf16 v[252:255], a[60:63], a[20:23], v[252:255]
v_mfma_f32_16x16x32_bf16 a[132:135], a[60:63], a[24:27], a[132:135]
v_mfma_f32_16x16x32_bf16 a[140:143], a[60:63], a[28:31], a[140:143]
s_waitcnt vmcnt(16) lgkmcnt(0)
s_barrier
v_mfma_f32_16x16x32_bf16 v[16:19], a[96:99], a[64:67], v[16:19]
v_add_u32 v6, s37, v4
s_add_u32 m0, s34, 0
v_mfma_f32_16x16x32_bf16 v[24:27], a[96:99], a[68:71], v[24:27]
ds_read_b64_tr_b16 a[32:33], v8 offset:0
v_mfma_f32_16x16x32_bf16 v[32:35], a[96:99], a[72:75], v[32:35]
ds_read_b64_tr_b16 a[34:35], v8 offset:1024
buffer_load_dwordx4 v2, s[8:11], s28 offen lds
v_mfma_f32_16x16x32_bf16 v[40:43], a[96:99], a[76:79], v[40:43]
v_mfma_f32_16x16x32_bf16 v[48:51], a[96:99], a[80:83], v[48:51]
ds_read_b128 a[0:3], v6 offset:0
s_add_u32 s28, s28, s29
v_mfma_f32_16x16x32_bf16 v[56:59], a[96:99], a[84:87], v[56:59]
ds_read_b128 a[4:7], v6 offset:2048
v_mfma_f32_16x16x32_bf16 v[64:67], a[96:99], a[88:91], v[64:67]
v_mfma_f32_16x16x32_bf16 v[72:75], a[96:99], a[92:95], v[72:75]
ds_read_b128 a[8:11], v6 offset:4096
s_add_u32 m0, s34, 4096
v_mfma_f32_16x16x32_bf16 v[20:23], a[100:103], a[64:67], v[20:23]
v_mfma_f32_16x16x32_bf16 v[28:31], a[100:103], a[68:71], v[28:31]
ds_read_b128 a[12:15], v6 offset:6144
buffer_load_dwordx4 v2, s[8:11], s28 offen lds
v_mfma_f32_16x16x32_bf16 v[36:39], a[100:103], a[72:75], v[36:39]
ds_read_b128 a[16:19], v6 offset:8192
v_mfma_f32_16x16x32_bf16 v[44:47], a[100:103], a[76:79], v[44:47]
s_add_u32 s28, s28, s29
v_mfma_f32_16x16x32_bf16 v[52:55], a[100:103], a[80:83], v[52:55]
ds_read_b128 a[20:23], v6 offset:10240
v_mfma_f32_16x16x32_bf16 v[60:63], a[100:103], a[84:87], v[60:63]
v_mfma_f32_16x16x32_bf16 v[68:71], a[100:103], a[88:91], v[68:71]
ds_read_b128 a[24:27], v6 offset:12288
s_add_u32 m0, s34, 8192
v_mfma_f32_16x16x32_bf16 v[76:79], a[100:103], a[92:95], v[76:79]
ds_read_b128 a[28:31], v6 offset:14336
v_mfma_f32_16x16x32_bf16 v[80:83], a[104:107], a[64:67], v[80:83]
buffer_load_dwordx4 v2, s[8:11], s28 offen lds
v_mfma_f32_16x16x32_bf16 v[88:91], a[104:107], a[68:71], v[88:91]
ds_read_b64_tr_b16 a[36:37], v9 offset:0
v_mfma_f32_16x16x32_bf16 v[96:99], a[104:107], a[72:75], v[96:99]
ds_read_b64_tr_b16 a[38:39], v9 offset:1024
s_add_u32 s28, s28, s29
v_mfma_f32_16x16x32_bf16 v[104:107], a[104:107], a[76:79], v[104:107]
v_mfma_f32_16x16x32_bf16 v[112:115], a[104:107], a[80:83], v[112:115]
ds_read_b64_tr_b16 a[40:41], v10 offset:0
v_mfma_f32_16x16x32_bf16 v[120:123], a[104:107], a[84:87], v[120:123]
s_add_u32 m0, s34, 12288
v_mfma_f32_16x16x32_bf16 v[128:131], a[104:107], a[88:91], v[128:131]
ds_read_b64_tr_b16 a[42:43], v10 offset:1024
v_mfma_f32_16x16x32_bf16 v[136:139], a[104:107], a[92:95], v[136:139]
ds_read_b64_tr_b16 a[44:45], v11 offset:0
buffer_load_dwordx4 v2, s[8:11], s28 offen lds
v_mfma_f32_16x16x32_bf16 v[84:87], a[108:111], a[64:67], v[84:87]
v_mfma_f32_16x16x32_bf16 v[92:95], a[108:111], a[68:71], v[92:95]
ds_read_b64_tr_b16 a[46:47], v11 offset:1024
s_add_u32 s28, s28, s29
v_mfma_f32_16x16x32_bf16 v[100:103], a[108:111], a[72:75], v[100:103]
v_mfma_f32_16x16x32_bf16 v[108:111], a[108:111], a[76:79], v[108:111]
ds_read_b64_tr_b16 a[48:49], v8 offset:8192
v_mfma_f32_16x16x32_bf16 v[116:119], a[108:111], a[80:83], v[116:119]
ds_read_b64_tr_b16 a[50:51], v8 offset:9216
s_add_u32 m0, s43, 49152
v_mfma_f32_16x16x32_bf16 v[124:127], a[108:111], a[84:87], v[124:127]
v_mfma_f32_16x16x32_bf16 v[132:135], a[108:111], a[88:91], v[132:135]
ds_read_b64_tr_b16 a[52:53], v9 offset:8192
buffer_load_dwordx4 v3, s[12:15], s31 offen lds
v_mfma_f32_16x16x32_bf16 v[140:143], a[108:111], a[92:95], v[140:143]
ds_read_b64_tr_b16 a[54:55], v9 offset:9216
v_mfma_f32_16x16x32_bf16 v[144:147], a[112:115], a[64:67], v[144:147]
s_add_u32 s31, s31, s32
v_mfma_f32_16x16x32_bf16 v[152:155], a[112:115], a[68:71], v[152:155]
ds_read_b64_tr_b16 a[56:57], v10 offset:8192
v_mfma_f32_16x16x32_bf16 v[160:163], a[112:115], a[72:75], v[160:163]
v_mfma_f32_16x16x32_bf16 v[168:171], a[112:115], a[76:79], v[168:171]
ds_read_b64_tr_b16 a[58:59], v10 offset:9216
s_add_u32 m0, s43, 50176
v_mfma_f32_16x16x32_bf16 v[176:179], a[112:115], a[80:83], v[176:179]
ds_read_b64_tr_b16 a[60:61], v11 offset:8192
v_mfma_f32_16x16x32_bf16 v[184:187], a[112:115], a[84:87], v[184:187]
buffer_load_dwordx4 v3, s[12:15], s31 offen lds
v_mfma_f32_16x16x32_bf16 v[192:195], a[112:115], a[88:91], v[192:195]
ds_read_b64_tr_b16 a[62:63], v11 offset:9216
v_mfma_f32_16x16x32_bf16 v[200:203], a[112:115], a[92:95], v[200:203]
s_add_u32 s31, s31, s33
v_mfma_f32_16x16x32_bf16 v[148:151], a[116:119], a[64:67], v[148:151]
v_mfma_f32_16x16x32_bf16 v[156:159], a[116:119], a[68:71], v[156:159]
v_mfma_f32_16x16x32_bf16 v[164:167], a[116:119], a[72:75], v[164:167]
s_add_u32 m0, s43, 53248
v_mfma_f32_16x16x32_bf16 v[172:175], a[116:119], a[76:79], v[172:175]
v_mfma_f32_16x16x32_bf16 v[180:183], a[116:119], a[80:83], v[180:183]
buffer_load_dwordx4 v3, s[12:15], s31 offen lds
v_mfma_f32_16x16x32_bf16 v[188:191], a[116:119], a[84:87], v[188:191]
v_mfma_f32_16x16x32_bf16 v[196:199], a[116:119], a[88:91], v[196:199]
s_add_u32 s31, s31, s32
v_mfma_f32_16x16x32_bf16 v[204:207], a[116:119], a[92:95], v[204:207]
v_mfma_f32_16x16x32_bf16 v[208:211], a[120:123], a[64:67], v[208:211]
v_mfma_f32_16x16x32_bf16 v[216:219], a[120:123], a[68:71], v[216:219]
s_add_u32 m0, s43, 54272
v_mfma_f32_16x16x32_bf16 v[224:227], a[120:123], a[72:75], v[224:227]
v_mfma_f32_16x16x32_bf16 v[232:235], a[120:123], a[76:79], v[232:235]
buffer_load_dwordx4 v3, s[12:15], s31 offen lds
v_mfma_f32_16x16x32_bf16 v[240:243], a[120:123], a[80:83], v[240:243]
v_mfma_f32_16x16x32_bf16 v[248:251], a[120:123], a[84:87], v[248:251]
s_add_u32 s31, s31, s33
v_mfma_f32_16x16x32_bf16 a[128:131], a[120:123], a[88:91], a[128:131]
v_mfma_f32_16x16x32_bf16 a[136:139], a[120:123], a[92:95], a[136:139]
v_mfma_f32_16x16x32_bf16 v[212:215], a[124:127], a[64:67], v[212:215]
s_add_u32 s37, s37, 32768
v_mfma_f32_16x16x32_bf16 v[220:223], a[124:127], a[68:71], v[220:223]
v_mfma_f32_16x16x32_bf16 v[228:231], a[124:127], a[72:75], v[228:231]
s_cmp_ge_u32 s37, s42
v_mfma_f32_16x16x32_bf16 v[236:239], a[124:127], a[76:79], v[236:239]
v_mfma_f32_16x16x32_bf16 v[244:247], a[124:127], a[80:83], v[244:247]
s_cselect_b32 s37, s41, s37
v_mfma_f32_16x16x32_bf16 v[252:255], a[124:127], a[84:87], v[252:255]
v_mfma_f32_16x16x32_bf16 a[132:135], a[124:127], a[88:91], a[132:135]
v_mfma_f32_16x16x32_bf16 a[140:143], a[124:127], a[92:95], a[140:143]
s_cmp_lg_u32 s3, 0
s_cbranch_scc1 fused_kernelq_xok_31
s_mov_b32 s60, 0x40000
s_movk_i32 s61, 0x5555
s_waitcnt vmcnt(12)
s_branch fused_kernelq_xchk_33
fused_kernelq_xpoll_32:
buffer_load_dword v14, v12, s[64:67], 0 offen sc1
s_waitcnt vmcnt(0)
fused_kernelq_xchk_33:
v_cmp_gt_u32 vcc, 16, v14
s_sub_u32 s60, s60, 1
s_cmp_eq_u32 s60, 0
s_cbranch_scc1 fused_kernelq_xok_31
s_and_b32 s40, vcc_lo, s61
s_cbranch_scc0 fused_kernelq_xok_31
s_sleep 2
s_branch fused_kernelq_xpoll_32
fused_kernelq_xok_31:
s_waitcnt vmcnt(16) lgkmcnt(0)
s_barrier
v_mfma_f32_16x16x32_bf16 v[16:19], a[32:35], a[0:3], v[16:19]
v_add_u32 v7, s38, v5
s_add_u32 m0, s34, 16384
v_mfma_f32_16x16x32_bf16 v[24:27], a[32:35], a[4:7], v[24:27]
ds_read_b64_tr_b16 a[96:97], v8 offset:16384
v_mfma_f32_16x16x32_bf16 v[32:35], a[32:35], a[8:11], v[32:35]
ds_read_b64_tr_b16 a[98:99], v8 offset:17408
buffer_load_dwordx4 v2, s[8:11], s28 offen lds
v_mfma_f32_16x16x32_bf16 v[40:43], a[32:35], a[12:15], v[40:43]
v_mfma_f32_16x16x32_bf16 v[48:51], a[32:35], a[16:19], v[48:51]
ds_read_b128 a[64:67], v7 offset:0
s_add_u32 s28, s28, s29
v_mfma_f32_16x16x32_bf16 v[56:59], a[32:35], a[20:23], v[56:59]
ds_read_b128 a[68:71], v7 offset:2048
v_mfma_f32_16x16x32_bf16 v[64:67], a[32:35], a[24:27], v[64:67]
s_add_u32 m0, s34, 20480
v_mfma_f32_16x16x32_bf16 v[72:75], a[32:35], a[28:31], v[72:75]
ds_read_b128 a[72:75], v7 offset:4096
v_mfma_f32_16x16x32_bf16 v[20:23], a[36:39], a[0:3], v[20:23]
buffer_load_dwordx4 v2, s[8:11], s28 offen lds
v_mfma_f32_16x16x32_bf16 v[28:31], a[36:39], a[4:7], v[28:31]
ds_read_b128 a[76:79], v7 offset:6144
v_mfma_f32_16x16x32_bf16 v[36:39], a[36:39], a[8:11], v[36:39]
ds_read_b128 a[80:83], v7 offset:8192
s_add_u32 s28, s28, s29
v_mfma_f32_16x16x32_bf16 v[44:47], a[36:39], a[12:15], v[44:47]
v_mfma_f32_16x16x32_bf16 v[52:55], a[36:39], a[16:19], v[52:55]
ds_read_b128 a[84:87], v7 offset:10240
s_add_u32 m0, s34, 24576
v_mfma_f32_16x16x32_bf16 v[60:63], a[36:39], a[20:23], v[60:63]
v_mfma_f32_16x16x32_bf16 v[68:71], a[36:39], a[24:27], v[68:71]
ds_read_b128 a[88:91], v7 offset:12288
buffer_load_dwordx4 v2, s[8:11], s28 offen lds
v_mfma_f32_16x16x32_bf16 v[76:79], a[36:39], a[28:31], v[76:79]
ds_read_b128 a[92:95], v7 offset:14336
v_mfma_f32_16x16x32_bf16 v[80:83], a[40:43], a[0:3], v[80:83]
s_add_u32 s28, s28, s29
v_mfma_f32_16x16x32_bf16 v[88:91], a[40:43], a[4:7], v[88:91]
ds_read_b64_tr_b16 a[100:101], v9 offset:16384
v_mfma_f32_16x16x32_bf16 v[96:99], a[40:43], a[8:11], v[96:99]
ds_read_b64_tr_b16 a[102:103], v9 offset:17408
s_add_u32 m0, s34, 28672
v_mfma_f32_16x16x32_bf16 v[104:107], a[40:43], a[12:15], v[104:107]
v_mfma_f32_16x16x32_bf16 v[112:115], a[40:43], a[16:19], v[112:115]
ds_read_b64_tr_b16 a[104:105], v10 offset:16384
v_mfma_f32_16x16x32_bf16 v[120:123], a[40:43], a[20:23], v[120:123]
buffer_load_dwordx4 v2, s[8:11], s28 offen lds
v_mfma_f32_16x16x32_bf16 v[128:131], a[40:43], a[24:27], v[128:131]
ds_read_b64_tr_b16 a[106:107], v10 offset:17408
v_mfma_f32_16x16x32_bf16 v[136:139], a[40:43], a[28:31], v[136:139]
ds_read_b64_tr_b16 a[108:109], v11 offset:16384
s_add_u32 s28, s28, s30
v_mfma_f32_16x16x32_bf16 v[84:87], a[44:47], a[0:3], v[84:87]
v_mfma_f32_16x16x32_bf16 v[92:95], a[44:47], a[4:7], v[92:95]
ds_read_b64_tr_b16 a[110:111], v11 offset:17408
s_add_u32 s34, s34, 32768
v_mfma_f32_16x16x32_bf16 v[100:103], a[44:47], a[8:11], v[100:103]
v_mfma_f32_16x16x32_bf16 v[108:111], a[44:47], a[12:15], v[108:111]
ds_read_b64_tr_b16 a[112:113], v8 offset:24576
s_cmp_ge_u32 s34, s36
v_mfma_f32_16x16x32_bf16 v[116:119], a[44:47], a[16:19], v[116:119]
ds_read_b64_tr_b16 a[114:115], v8 offset:25600
v_mfma_f32_16x16x32_bf16 v[124:127], a[44:47], a[20:23], v[124:127]
s_cselect_b32 s34, s35, s34
v_mfma_f32_16x16x32_bf16 v[132:135], a[44:47], a[24:27], v[132:135]
ds_read_b64_tr_b16 a[116:117], v9 offset:24576
v_mfma_f32_16x16x32_bf16 v[140:143], a[44:47], a[28:31], v[140:143]
ds_read_b64_tr_b16 a[118:119], v9 offset:25600
s_add_u32 m0, s43, 0
v_mfma_f32_16x16x32_bf16 v[144:147], a[48:51], a[0:3], v[144:147]
v_mfma_f32_16x16x32_bf16 v[152:155], a[48:51], a[4:7], v[152:155]
ds_read_b64_tr_b16 a[120:121], v10 offset:24576
buffer_load_dwordx4 v3, s[12:15], s31 offen lds
v_mfma_f32_16x16x32_bf16 v[160:163], a[48:51], a[8:11], v[160:163]
v_mfma_f32_16x16x32_bf16 v[168:171], a[48:51], a[12:15], v[168:171]
ds_read_b64_tr_b16 a[122:123], v10 offset:25600
s_add_u32 s31, s31, s32
v_mfma_f32_16x16x32_bf16 v[176:179], a[48:51], a[16:19], v[176:179]
ds_read_b64_tr_b16 a[124:125], v11 offset:24576
v_mfma_f32_16x16x32_bf16 v[184:187], a[48:51], a[20:23], v[184:187]
s_add_u32 m0, s43, 1024
v_mfma_f32_16x16x32_bf16 v[192:195], a[48:51], a[24:27], v[192:195]
ds_read_b64_tr_b16 a[126:127], v11 offset:25600
v_mfma_f32_16x16x32_bf16 v[200:203], a[48:51], a[28:31], v[200:203]
buffer_load_dwordx4 v3, s[12:15], s31 offen lds
v_mfma_f32_16x16x32_bf16 v[148:151], a[52:55], a[0:3], v[148:151]
v_mfma_f32_16x16x32_bf16 v[156:159], a[52:55], a[4:7], v[156:159]
v_mfma_f32_16x16x32_bf16 v[164:167], a[52:55], a[8:11], v[164:167]
s_add_u32 s31, s31, s33
v_mfma_f32_16x16x32_bf16 v[172:175], a[52:55], a[12:15], v[172:175]
v_mfma_f32_16x16x32_bf16 v[180:183], a[52:55], a[16:19], v[180:183]
s_add_u32 m0, s43, 4096
v_mfma_f32_16x16x32_bf16 v[188:191], a[52:55], a[20:23], v[188:191]
v_mfma_f32_16x16x32_bf16 v[196:199], a[52:55], a[24:27], v[196:199]
buffer_load_dwordx4 v3, s[12:15], s31 offen lds
v_mfma_f32_16x16x32_bf16 v[204:207], a[52:55], a[28:31], v[204:207]
v_mfma_f32_16x16x32_bf16 v[208:211], a[56:59], a[0:3], v[208:211]
s_add_u32 s31, s31, s32
v_mfma_f32_16x16x32_bf16 v[216:219], a[56:59], a[4:7], v[216:219]
v_mfma_f32_16x16x32_bf16 v[224:227], a[56:59], a[8:11], v[224:227]
s_add_u32 m0, s43, 5120
v_mfma_f32_16x16x32_bf16 v[232:235], a[56:59], a[12:15], v[232:235]
v_mfma_f32_16x16x32_bf16 v[240:243], a[56:59], a[16:19], v[240:243]
buffer_load_dwordx4 v3, s[12:15], s31 offen lds
v_mfma_f32_16x16x32_bf16 v[248:251], a[56:59], a[20:23], v[248:251]
v_mfma_f32_16x16x32_bf16 a[128:131], a[56:59], a[24:27], a[128:131]
s_add_u32 s31, s31, s33
v_mfma_f32_16x16x32_bf16 a[136:139], a[56:59], a[28:31], a[136:139]
v_mfma_f32_16x16x32_bf16 v[212:215], a[60:63], a[0:3], v[212:215]
s_add_u32 s38, s38, 32768
v_mfma_f32_16x16x32_bf16 v[220:223], a[60:63], a[4:7], v[220:223]
v_mfma_f32_16x16x32_bf16 v[228:231], a[60:63], a[8:11], v[228:231]
s_cmp_ge_u32 s38, s42
v_mfma_f32_16x16x32_bf16 v[236:239], a[60:63], a[12:15], v[236:239]
v_mfma_f32_16x16x32_bf16 v[244:247], a[60:63], a[16:19], v[244:247]
s_cselect_b32 s38, s41, s38
v_mfma_f32_16x16x32_bf16 v[252:255], a[60:63], a[20:23], v[252:255]
v_mfma_f32_16x16x32_bf16 a[132:135], a[60:63], a[24:27], a[132:135]
v_mfma_f32_16x16x32_bf16 a[140:143], a[60:63], a[28:31], a[140:143]
s_mov_b64 s[8:9], s[20:21]
s_mov_b64 s[10:11], s[22:23]
s_mov_b32 s28, s52
s_mov_b32 s29, s54
s_mov_b32 s30, s16
v_lshrrev_b32 v14, 4, v1
s_lshl_b32 s40, s50, 2
v_add_u32 v14, s40, v14
v_and_b32 v2, 7, v1
v_xor_b32 v2, v2, v14
v_lshlrev_b32 v2, 4, v2
v_lshrrev_b32 v0, 3, v1
s_movk_i32 s40, 2048
v_mul_lo_u32 v0, v0, s40
v_add_u32 v2, v2, v0
s_waitcnt vmcnt(16) lgkmcnt(0)
s_barrier
v_mfma_f32_16x16x32_bf16 v[16:19], a[96:99], a[64:67], v[16:19]
v_add_u32 v6, s37, v4
s_add_u32 m0, s34, 0
v_mfma_f32_16x16x32_bf16 v[24:27], a[96:99], a[68:71], v[24:27]
ds_read_b64_tr_b16 a[32:33], v8 offset:32768
v_mfma_f32_16x16x32_bf16 v[32:35], a[96:99], a[72:75], v[32:35]
ds_read_b64_tr_b16 a[34:35], v8 offset:33792
buffer_load_dwordx4 v2, s[8:11], s28 offen lds
v_mfma_f32_16x16x32_bf16 v[40:43], a[96:99], a[76:79], v[40:43]
v_mfma_f32_16x16x32_bf16 v[48:51], a[96:99], a[80:83], v[48:51]
ds_read_b128 a[0:3], v6 offset:0
s_add_u32 s28, s28, s29
v_mfma_f32_16x16x32_bf16 v[56:59], a[96:99], a[84:87], v[56:59]
ds_read_b128 a[4:7], v6 offset:2048
v_mfma_f32_16x16x32_bf16 v[64:67], a[96:99], a[88:91], v[64:67]
v_mfma_f32_16x16x32_bf16 v[72:75], a[96:99], a[92:95], v[72:75]
ds_read_b128 a[8:11], v6 offset:4096
s_add_u32 m0, s34, 4096
v_mfma_f32_16x16x32_bf16 v[20:23], a[100:103], a[64:67], v[20:23]
v_mfma_f32_16x16x32_bf16 v[28:31], a[100:103], a[68:71], v[28:31]
ds_read_b128 a[12:15], v6 offset:6144
buffer_load_dwordx4 v2, s[8:11], s28 offen lds
v_mfma_f32_16x16x32_bf16 v[36:39], a[100:103], a[72:75], v[36:39]
ds_read_b128 a[16:19], v6 offset:8192
v_mfma_f32_16x16x32_bf16 v[44:47], a[100:103], a[76:79], v[44:47]
s_add_u32 s28, s28, s29
v_mfma_f32_16x16x32_bf16 v[52:55], a[100:103], a[80:83], v[52:55]
ds_read_b128 a[20:23], v6 offset:10240
v_mfma_f32_16x16x32_bf16 v[60:63], a[100:103], a[84:87], v[60:63]
v_mfma_f32_16x16x32_bf16 v[68:71], a[100:103], a[88:91], v[68:71]
ds_read_b128 a[24:27], v6 offset:12288
s_add_u32 m0, s34, 8192
v_mfma_f32_16x16x32_bf16 v[76:79], a[100:103], a[92:95], v[76:79]
ds_read_b128 a[28:31], v6 offset:14336
v_mfma_f32_16x16x32_bf16 v[80:83], a[104:107], a[64:67], v[80:83]
buffer_load_dwordx4 v2, s[8:11], s28 offen lds
v_mfma_f32_16x16x32_bf16 v[88:91], a[104:107], a[68:71], v[88:91]
ds_read_b64_tr_b16 a[36:37], v9 offset:32768
v_mfma_f32_16x16x32_bf16 v[96:99], a[104:107], a[72:75], v[96:99]
ds_read_b64_tr_b16 a[38:39], v9 offset:33792
s_add_u32 s28, s28, s29
v_mfma_f32_16x16x32_bf16 v[104:107], a[104:107], a[76:79], v[104:107]
v_mfma_f32_16x16x32_bf16 v[112:115], a[104:107], a[80:83], v[112:115]
ds_read_b64_tr_b16 a[40:41], v10 offset:32768
v_mfma_f32_16x16x32_bf16 v[120:123], a[104:107], a[84:87], v[120:123]
s_add_u32 m0, s34, 12288
v_mfma_f32_16x16x32_bf16 v[128:131], a[104:107], a[88:91], v[128:131]
ds_read_b64_tr_b16 a[42:43], v10 offset:33792
v_mfma_f32_16x16x32_bf16 v[136:139], a[104:107], a[92:95], v[136:139]
ds_read_b64_tr_b16 a[44:45], v11 offset:32768
buffer_load_dwordx4 v2, s[8:11], s28 offen lds
v_mfma_f32_16x16x32_bf16 v[84:87], a[108:111], a[64:67], v[84:87]
v_mfma_f32_16x16x32_bf16 v[92:95], a[108:111], a[68:71], v[92:95]
ds_read_b64_tr_b16 a[46:47], v11 offset:33792
s_add_u32 s28, s28, s29
v_mfma_f32_16x16x32_bf16 v[100:103], a[108:111], a[72:75], v[100:103]
v_mfma_f32_16x16x32_bf16 v[108:111], a[108:111], a[76:79], v[108:111]
ds_read_b64_tr_b16 a[48:49], v8 offset:40960
v_mfma_f32_16x16x32_bf16 v[116:119], a[108:111], a[80:83], v[116:119]
ds_read_b64_tr_b16 a[50:51], v8 offset:41984
s_add_u32 m0, s43, 16384
v_mfma_f32_16x16x32_bf16 v[124:127], a[108:111], a[84:87], v[124:127]
v_mfma_f32_16x16x32_bf16 v[132:135], a[108:111], a[88:91], v[132:135]
ds_read_b64_tr_b16 a[52:53], v9 offset:40960
buffer_load_dwordx4 v3, s[12:15], s31 offen lds
v_mfma_f32_16x16x32_bf16 v[140:143], a[108:111], a[92:95], v[140:143]
ds_read_b64_tr_b16 a[54:55], v9 offset:41984
v_mfma_f32_16x16x32_bf16 v[144:147], a[112:115], a[64:67], v[144:147]
s_add_u32 s31, s31, s32
v_mfma_f32_16x16x32_bf16 v[152:155], a[112:115], a[68:71], v[152:155]
ds_read_b64_tr_b16 a[56:57], v10 offset:40960
v_mfma_f32_16x16x32_bf16 v[160:163], a[112:115], a[72:75], v[160:163]
v_mfma_f32_16x16x32_bf16 v[168:171], a[112:115], a[76:79], v[168:171]
ds_read_b64_tr_b16 a[58:59], v10 offset:41984
s_add_u32 m0, s43, 17408
v_mfma_f32_16x16x32_bf16 v[176:179], a[112:115], a[80:83], v[176:179]
ds_read_b64_tr_b16 a[60:61], v11 offset:40960
v_mfma_f32_16x16x32_bf16 v[184:187], a[112:115], a[84:87], v[184:187]
buffer_load_dwordx4 v3, s[12:15], s31 offen lds
v_mfma_f32_16x16x32_bf16 v[192:195], a[112:115], a[88:91], v[192:195]
ds_read_b64_tr_b16 a[62:63], v11 offset:41984
v_mfma_f32_16x16x32_bf16 v[200:203], a[112:115], a[92:95], v[200:203]
s_add_u32 s31, s31, s33
v_mfma_f32_16x16x32_bf16 v[148:151], a[116:119], a[64:67], v[148:151]
v_mfma_f32_16x16x32_bf16 v[156:159], a[116:119], a[68:71], v[156:159]
v_mfma_f32_16x16x32_bf16 v[164:167], a[116:119], a[72:75], v[164:167]
s_add_u32 m0, s43, 20480
v_mfma_f32_16x16x32_bf16 v[172:175], a[116:119], a[76:79], v[172:175]
v_mfma_f32_16x16x32_bf16 v[180:183], a[116:119], a[80:83], v[180:183]
buffer_load_dwordx4 v3, s[12:15], s31 offen lds
v_mfma_f32_16x16x32_bf16 v[188:191], a[116:119], a[84:87], v[188:191]
v_mfma_f32_16x16x32_bf16 v[196:199], a[116:119], a[88:91], v[196:199]
s_add_u32 s31, s31, s32
v_mfma_f32_16x16x32_bf16 v[204:207], a[116:119], a[92:95], v[204:207]
v_mfma_f32_16x16x32_bf16 v[208:211], a[120:123], a[64:67], v[208:211]
v_mfma_f32_16x16x32_bf16 v[216:219], a[120:123], a[68:71], v[216:219]
s_add_u32 m0, s43, 21504
v_mfma_f32_16x16x32_bf16 v[224:227], a[120:123], a[72:75], v[224:227]
v_mfma_f32_16x16x32_bf16 v[232:235], a[120:123], a[76:79], v[232:235]
buffer_load_dwordx4 v3, s[12:15], s31 offen lds
v_mfma_f32_16x16x32_bf16 v[240:243], a[120:123], a[80:83], v[240:243]
v_mfma_f32_16x16x32_bf16 v[248:251], a[120:123], a[84:87], v[248:251]
s_add_u32 s31, s31, s33
v_mfma_f32_16x16x32_bf16 a[128:131], a[120:123], a[88:91], a[128:131]
v_mfma_f32_16x16x32_bf16 a[136:139], a[120:123], a[92:95], a[136:139]
v_mfma_f32_16x16x32_bf16 v[212:215], a[124:127], a[64:67], v[212:215]
s_add_u32 s37, s37, 32768
v_mfma_f32_16x16x32_bf16 v[220:223], a[124:127], a[68:71], v[220:223]
v_mfma_f32_16x16x32_bf16 v[228:231], a[124:127], a[72:75], v[228:231]
s_cmp_ge_u32 s37, s42
v_mfma_f32_16x16x32_bf16 v[236:239], a[124:127], a[76:79], v[236:239]
v_mfma_f32_16x16x32_bf16 v[244:247], a[124:127], a[80:83], v[244:247]
s_cselect_b32 s37, s41, s37
v_mfma_f32_16x16x32_bf16 v[252:255], a[124:127], a[84:87], v[252:255]
v_mfma_f32_16x16x32_bf16 a[132:135], a[124:127], a[88:91], a[132:135]
v_mfma_f32_16x16x32_bf16 a[140:143], a[124:127], a[92:95], a[140:143]
s_mov_b64 s[12:13], s[24:25]
s_mov_b64 s[14:15], s[26:27]
s_mov_b32 s31, s53
s_mov_b32 s32, s17
s_mov_b32 s33, s18
v_lshrrev_b32 v14, 4, v1
s_lshl_b32 s40, s50, 2
v_add_u32 v14, s40, v14
v_and_b32 v3, 15, v1
v_lshlrev_b32 v14, 1, v14
v_xor_b32 v3, v3, v14
v_lshlrev_b32 v3, 4, v3
v_lshrrev_b32 v0, 4, v1
s_movk_i32 s40, 8192
v_mul_lo_u32 v0, v0, s40
v_add_u32 v3, v3, v0
s_waitcnt vmcnt(16) lgkmcnt(0)
s_barrier
v_mfma_f32_16x16x32_bf16 v[16:19], a[32:35], a[0:3], v[16:19]
v_add_u32 v7, s38, v5
s_add_u32 m0, s34, 16384
v_mfma_f32_16x16x32_bf16 v[24:27], a[32:35], a[4:7], v[24:27]
ds_read_b64_tr_b16 a[96:97], v8 offset:49152
v_mfma_f32_16x16x32_bf16 v[32:35], a[32:35], a[8:11], v[32:35]
ds_read_b64_tr_b16 a[98:99], v8 offset:50176
buffer_load_dwordx4 v2, s[8:11], s28 offen lds
v_mfma_f32_16x16x32_bf16 v[40:43], a[32:35], a[12:15], v[40:43]
v_mfma_f32_16x16x32_bf16 v[48:51], a[32:35], a[16:19], v[48:51]
ds_read_b128 a[64:67], v7 offset:0
s_add_u32 s28, s28, s29
v_mfma_f32_16x16x32_bf16 v[56:59], a[32:35], a[20:23], v[56:59]
ds_read_b128 a[68:71], v7 offset:2048
v_mfma_f32_16x16x32_bf16 v[64:67], a[32:35], a[24:27], v[64:67]
s_add_u32 m0, s34, 20480
v_mfma_f32_16x16x32_bf16 v[72:75], a[32:35], a[28:31], v[72:75]
ds_read_b128 a[72:75], v7 offset:4096
v_mfma_f32_16x16x32_bf16 v[20:23], a[36:39], a[0:3], v[20:23]
buffer_load_dwordx4 v2, s[8:11], s28 offen lds
v_mfma_f32_16x16x32_bf16 v[28:31], a[36:39], a[4:7], v[28:31]
ds_read_b128 a[76:79], v7 offset:6144
v_mfma_f32_16x16x32_bf16 v[36:39], a[36:39], a[8:11], v[36:39]
ds_read_b128 a[80:83], v7 offset:8192
s_add_u32 s28, s28, s29
v_mfma_f32_16x16x32_bf16 v[44:47], a[36:39], a[12:15], v[44:47]
v_mfma_f32_16x16x32_bf16 v[52:55], a[36:39], a[16:19], v[52:55]
ds_read_b128 a[84:87], v7 offset:10240
s_add_u32 m0, s34, 24576
v_mfma_f32_16x16x32_bf16 v[60:63], a[36:39], a[20:23], v[60:63]
v_mfma_f32_16x16x32_bf16 v[68:71], a[36:39], a[24:27], v[68:71]
ds_read_b128 a[88:91], v7 offset:12288
buffer_load_dwordx4 v2, s[8:11], s28 offen lds
v_mfma_f32_16x16x32_bf16 v[76:79], a[36:39], a[28:31], v[76:79]
ds_read_b128 a[92:95], v7 offset:14336
v_mfma_f32_16x16x32_bf16 v[80:83], a[40:43], a[0:3], v[80:83]
s_add_u32 s28, s28, s29
v_mfma_f32_16x16x32_bf16 v[88:91], a[40:43], a[4:7], v[88:91]
ds_read_b64_tr_b16 a[100:101], v9 offset:49152
v_mfma_f32_16x16x32_bf16 v[96:99], a[40:43], a[8:11], v[96:99]
ds_read_b64_tr_b16 a[102:103], v9 offset:50176
s_add_u32 m0, s34, 28672
v_mfma_f32_16x16x32_bf16 v[104:107], a[40:43], a[12:15], v[104:107]
v_mfma_f32_16x16x32_bf16 v[112:115], a[40:43], a[16:19], v[112:115]
ds_read_b64_tr_b16 a[104:105], v10 offset:49152
v_mfma_f32_16x16x32_bf16 v[120:123], a[40:43], a[20:23], v[120:123]
buffer_load_dwordx4 v2, s[8:11], s28 offen lds
v_mfma_f32_16x16x32_bf16 v[128:131], a[40:43], a[24:27], v[128:131]
ds_read_b64_tr_b16 a[106:107], v10 offset:50176
v_mfma_f32_16x16x32_bf16 v[136:139], a[40:43], a[28:31], v[136:139]
ds_read_b64_tr_b16 a[108:109], v11 offset:49152
s_add_u32 s28, s28, s30
v_mfma_f32_16x16x32_bf16 v[84:87], a[44:47], a[0:3], v[84:87]
v_mfma_f32_16x16x32_bf16 v[92:95], a[44:47], a[4:7], v[92:95]
ds_read_b64_tr_b16 a[110:111], v11 offset:50176
s_add_u32 s34, s34, 32768
v_mfma_f32_16x16x32_bf16 v[100:103], a[44:47], a[8:11], v[100:103]
v_mfma_f32_16x16x32_bf16 v[108:111], a[44:47], a[12:15], v[108:111]
ds_read_b64_tr_b16 a[112:113], v8 offset:57344
s_cmp_ge_u32 s34, s36
v_mfma_f32_16x16x32_bf16 v[116:119], a[44:47], a[16:19], v[116:119]
ds_read_b64_tr_b16 a[114:115], v8 offset:58368
v_mfma_f32_16x16x32_bf16 v[124:127], a[44:47], a[20:23], v[124:127]
s_cselect_b32 s34, s35, s34
v_mfma_f32_16x16x32_bf16 v[132:135], a[44:47], a[24:27], v[132:135]
ds_read_b64_tr_b16 a[116:117], v9 offset:57344
v_mfma_f32_16x16x32_bf16 v[140:143], a[44:47], a[28:31], v[140:143]
ds_read_b64_tr_b16 a[118:119], v9 offset:58368
s_add_u32 m0, s43, 32768
v_mfma_f32_16x16x32_bf16 v[144:147], a[48:51], a[0:3], v[144:147]
v_mfma_f32_16x16x32_bf16 v[152:155], a[48:51], a[4:7], v[152:155]
ds_read_b64_tr_b16 a[120:121], v10 offset:57344
buffer_load_dwordx4 v3, s[12:15], s31 offen lds
v_mfma_f32_16x16x32_bf16 v[160:163], a[48:51], a[8:11], v[160:163]
v_mfma_f32_16x16x32_bf16 v[168:171], a[48:51], a[12:15], v[168:171]
ds_read_b64_tr_b16 a[122:123], v10 offset:58368
s_add_u32 s31, s31, s32
v_mfma_f32_16x16x32_bf16 v[176:179], a[48:51], a[16:19], v[176:179]
ds_read_b64_tr_b16 a[124:125], v11 offset:57344
v_mfma_f32_16x16x32_bf16 v[184:187], a[48:51], a[20:23], v[184:187]
s_add_u32 m0, s43, 33792
v_mfma_f32_16x16x32_bf16 v[192:195], a[48:51], a[24:27], v[192:195]
ds_read_b64_tr_b16 a[126:127], v11 offset:58368
v_mfma_f32_16x16x32_bf16 v[200:203], a[48:51], a[28:31], v[200:203]
buffer_load_dwordx4 v3, s[12:15], s31 offen lds
v_mfma_f32_16x16x32_bf16 v[148:151], a[52:55], a[0:3], v[148:151]
v_mfma_f32_16x16x32_bf16 v[156:159], a[52:55], a[4:7], v[156:159]
v_mfma_f32_16x16x32_bf16 v[164:167], a[52:55], a[8:11], v[164:167]
s_add_u32 s31, s31, s33
v_mfma_f32_16x16x32_bf16 v[172:175], a[52:55], a[12:15], v[172:175]
v_mfma_f32_16x16x32_bf16 v[180:183], a[52:55], a[16:19], v[180:183]
s_add_u32 m0, s43, 36864
v_mfma_f32_16x16x32_bf16 v[188:191], a[52:55], a[20:23], v[188:191]
v_mfma_f32_16x16x32_bf16 v[196:199], a[52:55], a[24:27], v[196:199]
buffer_load_dwordx4 v3, s[12:15], s31 offen lds
v_mfma_f32_16x16x32_bf16 v[204:207], a[52:55], a[28:31], v[204:207]
v_mfma_f32_16x16x32_bf16 v[208:211], a[56:59], a[0:3], v[208:211]
s_add_u32 s31, s31, s32
v_mfma_f32_16x16x32_bf16 v[216:219], a[56:59], a[4:7], v[216:219]
v_mfma_f32_16x16x32_bf16 v[224:227], a[56:59], a[8:11], v[224:227]
s_add_u32 m0, s43, 37888
v_mfma_f32_16x16x32_bf16 v[232:235], a[56:59], a[12:15], v[232:235]
v_mfma_f32_16x16x32_bf16 v[240:243], a[56:59], a[16:19], v[240:243]
buffer_load_dwordx4 v3, s[12:15], s31 offen lds
v_mfma_f32_16x16x32_bf16 v[248:251], a[56:59], a[20:23], v[248:251]
v_mfma_f32_16x16x32_bf16 a[128:131], a[56:59], a[24:27], a[128:131]
s_add_u32 s31, s31, s33
v_mfma_f32_16x16x32_bf16 a[136:139], a[56:59], a[28:31], a[136:139]
v_mfma_f32_16x16x32_bf16 v[212:215], a[60:63], a[0:3], v[212:215]
s_add_u32 s38, s38, 32768
v_mfma_f32_16x16x32_bf16 v[220:223], a[60:63], a[4:7], v[220:223]
v_mfma_f32_16x16x32_bf16 v[228:231], a[60:63], a[8:11], v[228:231]
s_cmp_ge_u32 s38, s42
v_mfma_f32_16x16x32_bf16 v[236:239], a[60:63], a[12:15], v[236:239]
v_mfma_f32_16x16x32_bf16 v[244:247], a[60:63], a[16:19], v[244:247]
s_cselect_b32 s38, s41, s38
v_mfma_f32_16x16x32_bf16 v[252:255], a[60:63], a[20:23], v[252:255]
v_mfma_f32_16x16x32_bf16 a[132:135], a[60:63], a[24:27], a[132:135]
v_mfma_f32_16x16x32_bf16 a[140:143], a[60:63], a[28:31], a[140:143]
s_waitcnt vmcnt(16) lgkmcnt(0)
s_barrier
s_cmp_lg_u32 s3, 0
s_cbranch_scc1 fused_kernel_wfc_34
s_mov_b32 s68, 0x5b0d000
v_mov_b32 v13, 1
v_mov_b32 v14, 0
s_mov_b64 s[70:71], exec
s_mov_b64 exec, 1
buffer_atomic_add v13, v14, s[4:7], s68 offen
s_mov_b64 exec, s[70:71]
fused_kernel_wfc_34:
v_mfma_f32_16x16x32_bf16 v[16:19], a[96:99], a[64:67], v[16:19]
v_add_u32 v6, s37, v4
s_add_u32 m0, s34, 0
v_mfma_f32_16x16x32_bf16 v[24:27], a[96:99], a[68:71], v[24:27]
ds_read_b64_tr_b16 a[32:33], v8 offset:0
v_mfma_f32_16x16x32_bf16 v[32:35], a[96:99], a[72:75], v[32:35]
ds_read_b64_tr_b16 a[34:35], v8 offset:1024
buffer_load_dwordx4 v2, s[8:11], s28 offen lds
v_mfma_f32_16x16x32_bf16 v[40:43], a[96:99], a[76:79], v[40:43]
v_mfma_f32_16x16x32_bf16 v[48:51], a[96:99], a[80:83], v[48:51]
ds_read_b128 a[0:3], v6 offset:0
s_add_u32 s28, s28, s29
v_mfma_f32_16x16x32_bf16 v[56:59], a[96:99], a[84:87], v[56:59]
ds_read_b128 a[4:7], v6 offset:2048
v_mfma_f32_16x16x32_bf16 v[64:67], a[96:99], a[88:91], v[64:67]
v_mfma_f32_16x16x32_bf16 v[72:75], a[96:99], a[92:95], v[72:75]
ds_read_b128 a[8:11], v6 offset:4096
s_add_u32 m0, s34, 4096
v_mfma_f32_16x16x32_bf16 v[20:23], a[100:103], a[64:67], v[20:23]
v_mfma_f32_16x16x32_bf16 v[28:31], a[100:103], a[68:71], v[28:31]
ds_read_b128 a[12:15], v6 offset:6144
buffer_load_dwordx4 v2, s[8:11], s28 offen lds
v_mfma_f32_16x16x32_bf16 v[36:39], a[100:103], a[72:75], v[36:39]
ds_read_b128 a[16:19], v6 offset:8192
v_mfma_f32_16x16x32_bf16 v[44:47], a[100:103], a[76:79], v[44:47]
s_add_u32 s28, s28, s29
v_mfma_f32_16x16x32_bf16 v[52:55], a[100:103], a[80:83], v[52:55]
ds_read_b128 a[20:23], v6 offset:10240
v_mfma_f32_16x16x32_bf16 v[60:63], a[100:103], a[84:87], v[60:63]
v_mfma_f32_16x16x32_bf16 v[68:71], a[100:103], a[88:91], v[68:71]
ds_read_b128 a[24:27], v6 offset:12288
s_add_u32 m0, s34, 8192
v_mfma_f32_16x16x32_bf16 v[76:79], a[100:103], a[92:95], v[76:79]
ds_read_b128 a[28:31], v6 offset:14336
v_mfma_f32_16x16x32_bf16 v[80:83], a[104:107], a[64:67], v[80:83]
buffer_load_dwordx4 v2, s[8:11], s28 offen lds
v_mfma_f32_16x16x32_bf16 v[88:91], a[104:107], a[68:71], v[88:91]
ds_read_b64_tr_b16 a[36:37], v9 offset:0
v_mfma_f32_16x16x32_bf16 v[96:99], a[104:107], a[72:75], v[96:99]
ds_read_b64_tr_b16 a[38:39], v9 offset:1024
s_add_u32 s28, s28, s29
v_mfma_f32_16x16x32_bf16 v[104:107], a[104:107], a[76:79], v[104:107]
v_mfma_f32_16x16x32_bf16 v[112:115], a[104:107], a[80:83], v[112:115]
ds_read_b64_tr_b16 a[40:41], v10 offset:0
v_mfma_f32_16x16x32_bf16 v[120:123], a[104:107], a[84:87], v[120:123]
s_add_u32 m0, s34, 12288
v_mfma_f32_16x16x32_bf16 v[128:131], a[104:107], a[88:91], v[128:131]
ds_read_b64_tr_b16 a[42:43], v10 offset:1024
v_mfma_f32_16x16x32_bf16 v[136:139], a[104:107], a[92:95], v[136:139]
ds_read_b64_tr_b16 a[44:45], v11 offset:0
buffer_load_dwordx4 v2, s[8:11], s28 offen lds
v_mfma_f32_16x16x32_bf16 v[84:87], a[108:111], a[64:67], v[84:87]
v_mfma_f32_16x16x32_bf16 v[92:95], a[108:111], a[68:71], v[92:95]
ds_read_b64_tr_b16 a[46:47], v11 offset:1024
s_add_u32 s28, s28, s29
v_mfma_f32_16x16x32_bf16 v[100:103], a[108:111], a[72:75], v[100:103]
v_mfma_f32_16x16x32_bf16 v[108:111], a[108:111], a[76:79], v[108:111]
ds_read_b64_tr_b16 a[48:49], v8 offset:8192
v_mfma_f32_16x16x32_bf16 v[116:119], a[108:111], a[80:83], v[116:119]
ds_read_b64_tr_b16 a[50:51], v8 offset:9216
s_add_u32 m0, s43, 49152
v_mfma_f32_16x16x32_bf16 v[124:127], a[108:111], a[84:87], v[124:127]
v_mfma_f32_16x16x32_bf16 v[132:135], a[108:111], a[88:91], v[132:135]
ds_read_b64_tr_b16 a[52:53], v9 offset:8192
buffer_load_dwordx4 v3, s[12:15], s31 offen lds
v_mfma_f32_16x16x32_bf16 v[140:143], a[108:111], a[92:95], v[140:143]
ds_read_b64_tr_b16 a[54:55], v9 offset:9216
v_mfma_f32_16x16x32_bf16 v[144:147], a[112:115], a[64:67], v[144:147]
s_add_u32 s31, s31, s32
v_mfma_f32_16x16x32_bf16 v[152:155], a[112:115], a[68:71], v[152:155]
ds_read_b64_tr_b16 a[56:57], v10 offset:8192
v_mfma_f32_16x16x32_bf16 v[160:163], a[112:115], a[72:75], v[160:163]
v_mfma_f32_16x16x32_bf16 v[168:171], a[112:115], a[76:79], v[168:171]
ds_read_b64_tr_b16 a[58:59], v10 offset:9216
s_add_u32 m0, s43, 50176
v_mfma_f32_16x16x32_bf16 v[176:179], a[112:115], a[80:83], v[176:179]
ds_read_b64_tr_b16 a[60:61], v11 offset:8192
v_mfma_f32_16x16x32_bf16 v[184:187], a[112:115], a[84:87], v[184:187]
buffer_load_dwordx4 v3, s[12:15], s31 offen lds
v_mfma_f32_16x16x32_bf16 v[192:195], a[112:115], a[88:91], v[192:195]
ds_read_b64_tr_b16 a[62:63], v11 offset:9216
v_mfma_f32_16x16x32_bf16 v[200:203], a[112:115], a[92:95], v[200:203]
s_add_u32 s31, s31, s33
v_mfma_f32_16x16x32_bf16 v[148:151], a[116:119], a[64:67], v[148:151]
v_mfma_f32_16x16x32_bf16 v[156:159], a[116:119], a[68:71], v[156:159]
v_mfma_f32_16x16x32_bf16 v[164:167], a[116:119], a[72:75], v[164:167]
s_add_u32 m0, s43, 53248
v_mfma_f32_16x16x32_bf16 v[172:175], a[116:119], a[76:79], v[172:175]
v_mfma_f32_16x16x32_bf16 v[180:183], a[116:119], a[80:83], v[180:183]
buffer_load_dwordx4 v3, s[12:15], s31 offen lds
v_mfma_f32_16x16x32_bf16 v[188:191], a[116:119], a[84:87], v[188:191]
v_mfma_f32_16x16x32_bf16 v[196:199], a[116:119], a[88:91], v[196:199]
s_add_u32 s31, s31, s32
v_mfma_f32_16x16x32_bf16 v[204:207], a[116:119], a[92:95], v[204:207]
v_mfma_f32_16x16x32_bf16 v[208:211], a[120:123], a[64:67], v[208:211]
v_mfma_f32_16x16x32_bf16 v[216:219], a[120:123], a[68:71], v[216:219]
s_add_u32 m0, s43, 54272
v_mfma_f32_16x16x32_bf16 v[224:227], a[120:123], a[72:75], v[224:227]
v_mfma_f32_16x16x32_bf16 v[232:235], a[120:123], a[76:79], v[232:235]
buffer_load_dwordx4 v3, s[12:15], s31 offen lds
v_mfma_f32_16x16x32_bf16 v[240:243], a[120:123], a[80:83], v[240:243]
v_mfma_f32_16x16x32_bf16 v[248:251], a[120:123], a[84:87], v[248:251]
s_add_u32 s31, s31, s33
v_mfma_f32_16x16x32_bf16 a[128:131], a[120:123], a[88:91], a[128:131]
v_mfma_f32_16x16x32_bf16 a[136:139], a[120:123], a[92:95], a[136:139]
v_mfma_f32_16x16x32_bf16 v[212:215], a[124:127], a[64:67], v[212:215]
s_add_u32 s37, s37, 32768
v_mfma_f32_16x16x32_bf16 v[220:223], a[124:127], a[68:71], v[220:223]
v_mfma_f32_16x16x32_bf16 v[228:231], a[124:127], a[72:75], v[228:231]
s_cmp_ge_u32 s37, s42
v_mfma_f32_16x16x32_bf16 v[236:239], a[124:127], a[76:79], v[236:239]
v_mfma_f32_16x16x32_bf16 v[244:247], a[124:127], a[80:83], v[244:247]
s_cselect_b32 s37, s41, s37
v_mfma_f32_16x16x32_bf16 v[252:255], a[124:127], a[84:87], v[252:255]
v_mfma_f32_16x16x32_bf16 a[132:135], a[124:127], a[88:91], a[132:135]
v_mfma_f32_16x16x32_bf16 a[140:143], a[124:127], a[92:95], a[140:143]
s_waitcnt vmcnt(16) lgkmcnt(0)
s_barrier
v_mfma_f32_16x16x32_bf16 v[16:19], a[32:35], a[0:3], v[16:19]
v_add_u32 v7, s38, v5
s_add_u32 m0, s34, 16384
v_mfma_f32_16x16x32_bf16 v[24:27], a[32:35], a[4:7], v[24:27]
ds_read_b64_tr_b16 a[96:97], v8 offset:16384
v_mfma_f32_16x16x32_bf16 v[32:35], a[32:35], a[8:11], v[32:35]
ds_read_b64_tr_b16 a[98:99], v8 offset:17408
buffer_load_dwordx4 v2, s[8:11], s28 offen lds
v_mfma_f32_16x16x32_bf16 v[40:43], a[32:35], a[12:15], v[40:43]
v_mfma_f32_16x16x32_bf16 v[48:51], a[32:35], a[16:19], v[48:51]
ds_read_b128 a[64:67], v7 offset:0
s_add_u32 s28, s28, s29
v_mfma_f32_16x16x32_bf16 v[56:59], a[32:35], a[20:23], v[56:59]
ds_read_b128 a[68:71], v7 offset:2048
v_mfma_f32_16x16x32_bf16 v[64:67], a[32:35], a[24:27], v[64:67]
s_add_u32 m0, s34, 20480
v_mfma_f32_16x16x32_bf16 v[72:75], a[32:35], a[28:31], v[72:75]
ds_read_b128 a[72:75], v7 offset:4096
v_mfma_f32_16x16x32_bf16 v[20:23], a[36:39], a[0:3], v[20:23]
buffer_load_dwordx4 v2, s[8:11], s28 offen lds
v_mfma_f32_16x16x32_bf16 v[28:31], a[36:39], a[4:7], v[28:31]
ds_read_b128 a[76:79], v7 offset:6144
v_mfma_f32_16x16x32_bf16 v[36:39], a[36:39], a[8:11], v[36:39]
ds_read_b128 a[80:83], v7 offset:8192
s_add_u32 s28, s28, s29
v_mfma_f32_16x16x32_bf16 v[44:47], a[36:39], a[12:15], v[44:47]
v_mfma_f32_16x16x32_bf16 v[52:55], a[36:39], a[16:19], v[52:55]
ds_read_b128 a[84:87], v7 offset:10240
s_add_u32 m0, s34, 24576
v_mfma_f32_16x16x32_bf16 v[60:63], a[36:39], a[20:23], v[60:63]
v_mfma_f32_16x16x32_bf16 v[68:71], a[36:39], a[24:27], v[68:71]
ds_read_b128 a[88:91], v7 offset:12288
buffer_load_dwordx4 v2, s[8:11], s28 offen lds
v_mfma_f32_16x16x32_bf16 v[76:79], a[36:39], a[28:31], v[76:79]
ds_read_b128 a[92:95], v7 offset:14336
v_mfma_f32_16x16x32_bf16 v[80:83], a[40:43], a[0:3], v[80:83]
s_add_u32 s28, s28, s29
v_mfma_f32_16x16x32_bf16 v[88:91], a[40:43], a[4:7], v[88:91]
ds_read_b64_tr_b16 a[100:101], v9 offset:16384
v_mfma_f32_16x16x32_bf16 v[96:99], a[40:43], a[8:11], v[96:99]
ds_read_b64_tr_b16 a[102:103], v9 offset:17408
s_add_u32 m0, s34, 28672
v_mfma_f32_16x16x32_bf16 v[104:107], a[40:43], a[12:15], v[104:107]
v_mfma_f32_16x16x32_bf16 v[112:115], a[40:43], a[16:19], v[112:115]
ds_read_b64_tr_b16 a[104:105], v10 offset:16384
v_mfma_f32_16x16x32_bf16 v[120:123], a[40:43], a[20:23], v[120:123]
buffer_load_dwordx4 v2, s[8:11], s28 offen lds
v_mfma_f32_16x16x32_bf16 v[128:131], a[40:43], a[24:27], v[128:131]
ds_read_b64_tr_b16 a[106:107], v10 offset:17408
v_mfma_f32_16x16x32_bf16 v[136:139], a[40:43], a[28:31], v[136:139]
ds_read_b64_tr_b16 a[108:109], v11 offset:16384
s_add_u32 s28, s28, s30
v_mfma_f32_16x16x32_bf16 v[84:87], a[44:47], a[0:3], v[84:87]
v_mfma_f32_16x16x32_bf16 v[92:95], a[44:47], a[4:7], v[92:95]
ds_read_b64_tr_b16 a[110:111], v11 offset:17408
s_add_u32 s34, s34, 32768
v_mfma_f32_16x16x32_bf16 v[100:103], a[44:47], a[8:11], v[100:103]
v_mfma_f32_16x16x32_bf16 v[108:111], a[44:47], a[12:15], v[108:111]
ds_read_b64_tr_b16 a[112:113], v8 offset:24576
s_cmp_ge_u32 s34, s36
v_mfma_f32_16x16x32_bf16 v[116:119], a[44:47], a[16:19], v[116:119]
ds_read_b64_tr_b16 a[114:115], v8 offset:25600
v_mfma_f32_16x16x32_bf16 v[124:127], a[44:47], a[20:23], v[124:127]
s_cselect_b32 s34, s35, s34
v_mfma_f32_16x16x32_bf16 v[132:135], a[44:47], a[24:27], v[132:135]
ds_read_b64_tr_b16 a[116:117], v9 offset:24576
v_mfma_f32_16x16x32_bf16 v[140:143], a[44:47], a[28:31], v[140:143]
ds_read_b64_tr_b16 a[118:119], v9 offset:25600
s_add_u32 m0, s43, 0
v_mfma_f32_16x16x32_bf16 v[144:147], a[48:51], a[0:3], v[144:147]
v_mfma_f32_16x16x32_bf16 v[152:155], a[48:51], a[4:7], v[152:155]
ds_read_b64_tr_b16 a[120:121], v10 offset:24576
buffer_load_dwordx4 v3, s[12:15], s31 offen lds
v_mfma_f32_16x16x32_bf16 v[160:163], a[48:51], a[8:11], v[160:163]
v_mfma_f32_16x16x32_bf16 v[168:171], a[48:51], a[12:15], v[168:171]
ds_read_b64_tr_b16 a[122:123], v10 offset:25600
s_add_u32 s31, s31, s32
v_mfma_f32_16x16x32_bf16 v[176:179], a[48:51], a[16:19], v[176:179]
ds_read_b64_tr_b16 a[124:125], v11 offset:24576
v_mfma_f32_16x16x32_bf16 v[184:187], a[48:51], a[20:23], v[184:187]
s_add_u32 m0, s43, 1024
v_mfma_f32_16x16x32_bf16 v[192:195], a[48:51], a[24:27], v[192:195]
ds_read_b64_tr_b16 a[126:127], v11 offset:25600
v_mfma_f32_16x16x32_bf16 v[200:203], a[48:51], a[28:31], v[200:203]
buffer_load_dwordx4 v3, s[12:15], s31 offen lds
v_mfma_f32_16x16x32_bf16 v[148:151], a[52:55], a[0:3], v[148:151]
v_mfma_f32_16x16x32_bf16 v[156:159], a[52:55], a[4:7], v[156:159]
v_mfma_f32_16x16x32_bf16 v[164:167], a[52:55], a[8:11], v[164:167]
s_add_u32 s31, s31, s33
v_mfma_f32_16x16x32_bf16 v[172:175], a[52:55], a[12:15], v[172:175]
v_mfma_f32_16x16x32_bf16 v[180:183], a[52:55], a[16:19], v[180:183]
s_add_u32 m0, s43, 4096
v_mfma_f32_16x16x32_bf16 v[188:191], a[52:55], a[20:23], v[188:191]
v_mfma_f32_16x16x32_bf16 v[196:199], a[52:55], a[24:27], v[196:199]
buffer_load_dwordx4 v3, s[12:15], s31 offen lds
v_mfma_f32_16x16x32_bf16 v[204:207], a[52:55], a[28:31], v[204:207]
v_mfma_f32_16x16x32_bf16 v[208:211], a[56:59], a[0:3], v[208:211]
s_add_u32 s31, s31, s32
v_mfma_f32_16x16x32_bf16 v[216:219], a[56:59], a[4:7], v[216:219]
v_mfma_f32_16x16x32_bf16 v[224:227], a[56:59], a[8:11], v[224:227]
s_add_u32 m0, s43, 5120
v_mfma_f32_16x16x32_bf16 v[232:235], a[56:59], a[12:15], v[232:235]
v_mfma_f32_16x16x32_bf16 v[240:243], a[56:59], a[16:19], v[240:243]
buffer_load_dwordx4 v3, s[12:15], s31 offen lds
v_mfma_f32_16x16x32_bf16 v[248:251], a[56:59], a[20:23], v[248:251]
v_mfma_f32_16x16x32_bf16 a[128:131], a[56:59], a[24:27], a[128:131]
s_add_u32 s31, s31, s33
v_mfma_f32_16x16x32_bf16 a[136:139], a[56:59], a[28:31], a[136:139]
v_mfma_f32_16x16x32_bf16 v[212:215], a[60:63], a[0:3], v[212:215]
s_add_u32 s38, s38, 32768
v_mfma_f32_16x16x32_bf16 v[220:223], a[60:63], a[4:7], v[220:223]
v_mfma_f32_16x16x32_bf16 v[228:231], a[60:63], a[8:11], v[228:231]
s_cmp_ge_u32 s38, s42
v_mfma_f32_16x16x32_bf16 v[236:239], a[60:63], a[12:15], v[236:239]
v_mfma_f32_16x16x32_bf16 v[244:247], a[60:63], a[16:19], v[244:247]
s_cselect_b32 s38, s41, s38
v_mfma_f32_16x16x32_bf16 v[252:255], a[60:63], a[20:23], v[252:255]
v_mfma_f32_16x16x32_bf16 a[132:135], a[60:63], a[24:27], a[132:135]
v_mfma_f32_16x16x32_bf16 a[140:143], a[60:63], a[28:31], a[140:143]
s_waitcnt vmcnt(16) lgkmcnt(0)
s_barrier
v_mfma_f32_16x16x32_bf16 v[16:19], a[96:99], a[64:67], v[16:19]
v_add_u32 v6, s37, v4
s_add_u32 m0, s34, 0
v_mfma_f32_16x16x32_bf16 v[24:27], a[96:99], a[68:71], v[24:27]
ds_read_b64_tr_b16 a[32:33], v8 offset:32768
v_mfma_f32_16x16x32_bf16 v[32:35], a[96:99], a[72:75], v[32:35]
ds_read_b64_tr_b16 a[34:35], v8 offset:33792
buffer_load_dwordx4 v2, s[8:11], s28 offen lds
v_mfma_f32_16x16x32_bf16 v[40:43], a[96:99], a[76:79], v[40:43]
v_mfma_f32_16x16x32_bf16 v[48:51], a[96:99], a[80:83], v[48:51]
ds_read_b128 a[0:3], v6 offset:0
s_add_u32 s28, s28, s29
v_mfma_f32_16x16x32_bf16 v[56:59], a[96:99], a[84:87], v[56:59]
ds_read_b128 a[4:7], v6 offset:2048
v_mfma_f32_16x16x32_bf16 v[64:67], a[96:99], a[88:91], v[64:67]
v_mfma_f32_16x16x32_bf16 v[72:75], a[96:99], a[92:95], v[72:75]
ds_read_b128 a[8:11], v6 offset:4096
s_add_u32 m0, s34, 4096
v_mfma_f32_16x16x32_bf16 v[20:23], a[100:103], a[64:67], v[20:23]
v_mfma_f32_16x16x32_bf16 v[28:31], a[100:103], a[68:71], v[28:31]
ds_read_b128 a[12:15], v6 offset:6144
buffer_load_dwordx4 v2, s[8:11], s28 offen lds
v_mfma_f32_16x16x32_bf16 v[36:39], a[100:103], a[72:75], v[36:39]
ds_read_b128 a[16:19], v6 offset:8192
v_mfma_f32_16x16x32_bf16 v[44:47], a[100:103], a[76:79], v[44:47]
s_add_u32 s28, s28, s29
v_mfma_f32_16x16x32_bf16 v[52:55], a[100:103], a[80:83], v[52:55]
ds_read_b128 a[20:23], v6 offset:10240
v_mfma_f32_16x16x32_bf16 v[60:63], a[100:103], a[84:87], v[60:63]
v_mfma_f32_16x16x32_bf16 v[68:71], a[100:103], a[88:91], v[68:71]
ds_read_b128 a[24:27], v6 offset:12288
s_add_u32 m0, s34, 8192
v_mfma_f32_16x16x32_bf16 v[76:79], a[100:103], a[92:95], v[76:79]
ds_read_b128 a[28:31], v6 offset:14336
v_mfma_f32_16x16x32_bf16 v[80:83], a[104:107], a[64:67], v[80:83]
buffer_load_dwordx4 v2, s[8:11], s28 offen lds
v_mfma_f32_16x16x32_bf16 v[88:91], a[104:107], a[68:71], v[88:91]
ds_read_b64_tr_b16 a[36:37], v9 offset:32768
v_mfma_f32_16x16x32_bf16 v[96:99], a[104:107], a[72:75], v[96:99]
ds_read_b64_tr_b16 a[38:39], v9 offset:33792
s_add_u32 s28, s28, s29
v_mfma_f32_16x16x32_bf16 v[104:107], a[104:107], a[76:79], v[104:107]
v_mfma_f32_16x16x32_bf16 v[112:115], a[104:107], a[80:83], v[112:115]
ds_read_b64_tr_b16 a[40:41], v10 offset:32768
v_mfma_f32_16x16x32_bf16 v[120:123], a[104:107], a[84:87], v[120:123]
s_add_u32 m0, s34, 12288
v_mfma_f32_16x16x32_bf16 v[128:131], a[104:107], a[88:91], v[128:131]
ds_read_b64_tr_b16 a[42:43], v10 offset:33792
v_mfma_f32_16x16x32_bf16 v[136:139], a[104:107], a[92:95], v[136:139]
ds_read_b64_tr_b16 a[44:45], v11 offset:32768
buffer_load_dwordx4 v2, s[8:11], s28 offen lds
v_mfma_f32_16x16x32_bf16 v[84:87], a[108:111], a[64:67], v[84:87]
v_mfma_f32_16x16x32_bf16 v[92:95], a[108:111], a[68:71], v[92:95]
ds_read_b64_tr_b16 a[46:47], v11 offset:33792
s_add_u32 s28, s28, s29
v_mfma_f32_16x16x32_bf16 v[100:103], a[108:111], a[72:75], v[100:103]
v_mfma_f32_16x16x32_bf16 v[108:111], a[108:111], a[76:79], v[108:111]
ds_read_b64_tr_b16 a[48:49], v8 offset:40960
v_mfma_f32_16x16x32_bf16 v[116:119], a[108:111], a[80:83], v[116:119]
ds_read_b64_tr_b16 a[50:51], v8 offset:41984
s_add_u32 m0, s43, 16384
v_mfma_f32_16x16x32_bf16 v[124:127], a[108:111], a[84:87], v[124:127]
v_mfma_f32_16x16x32_bf16 v[132:135], a[108:111], a[88:91], v[132:135]
ds_read_b64_tr_b16 a[52:53], v9 offset:40960
buffer_load_dwordx4 v3, s[12:15], s31 offen lds
v_mfma_f32_16x16x32_bf16 v[140:143], a[108:111], a[92:95], v[140:143]
ds_read_b64_tr_b16 a[54:55], v9 offset:41984
v_mfma_f32_16x16x32_bf16 v[144:147], a[112:115], a[64:67], v[144:147]
s_add_u32 s31, s31, s32
v_mfma_f32_16x16x32_bf16 v[152:155], a[112:115], a[68:71], v[152:155]
ds_read_b64_tr_b16 a[56:57], v10 offset:40960
v_mfma_f32_16x16x32_bf16 v[160:163], a[112:115], a[72:75], v[160:163]
v_mfma_f32_16x16x32_bf16 v[168:171], a[112:115], a[76:79], v[168:171]
ds_read_b64_tr_b16 a[58:59], v10 offset:41984
s_add_u32 m0, s43, 17408
v_mfma_f32_16x16x32_bf16 v[176:179], a[112:115], a[80:83], v[176:179]
ds_read_b64_tr_b16 a[60:61], v11 offset:40960
v_mfma_f32_16x16x32_bf16 v[184:187], a[112:115], a[84:87], v[184:187]
buffer_load_dwordx4 v3, s[12:15], s31 offen lds
v_mfma_f32_16x16x32_bf16 v[192:195], a[112:115], a[88:91], v[192:195]
ds_read_b64_tr_b16 a[62:63], v11 offset:41984
v_mfma_f32_16x16x32_bf16 v[200:203], a[112:115], a[92:95], v[200:203]
s_add_u32 s31, s31, s33
v_mfma_f32_16x16x32_bf16 v[148:151], a[116:119], a[64:67], v[148:151]
v_mfma_f32_16x16x32_bf16 v[156:159], a[116:119], a[68:71], v[156:159]
v_mfma_f32_16x16x32_bf16 v[164:167], a[116:119], a[72:75], v[164:167]
s_add_u32 m0, s43, 20480
v_mfma_f32_16x16x32_bf16 v[172:175], a[116:119], a[76:79], v[172:175]
v_mfma_f32_16x16x32_bf16 v[180:183], a[116:119], a[80:83], v[180:183]
buffer_load_dwordx4 v3, s[12:15], s31 offen lds
v_mfma_f32_16x16x32_bf16 v[188:191], a[116:119], a[84:87], v[188:191]
v_mfma_f32_16x16x32_bf16 v[196:199], a[116:119], a[88:91], v[196:199]
s_add_u32 s31, s31, s32
v_mfma_f32_16x16x32_bf16 v[204:207], a[116:119], a[92:95], v[204:207]
v_mfma_f32_16x16x32_bf16 v[208:211], a[120:123], a[64:67], v[208:211]
v_mfma_f32_16x16x32_bf16 v[216:219], a[120:123], a[68:71], v[216:219]
s_add_u32 m0, s43, 21504
v_mfma_f32_16x16x32_bf16 v[224:227], a[120:123], a[72:75], v[224:227]
v_mfma_f32_16x16x32_bf16 v[232:235], a[120:123], a[76:79], v[232:235]
buffer_load_dwordx4 v3, s[12:15], s31 offen lds
v_mfma_f32_16x16x32_bf16 v[240:243], a[120:123], a[80:83], v[240:243]
v_mfma_f32_16x16x32_bf16 v[248:251], a[120:123], a[84:87], v[248:251]
s_add_u32 s31, s31, s33
v_mfma_f32_16x16x32_bf16 a[128:131], a[120:123], a[88:91], a[128:131]
v_mfma_f32_16x16x32_bf16 a[136:139], a[120:123], a[92:95], a[136:139]
v_mfma_f32_16x16x32_bf16 v[212:215], a[124:127], a[64:67], v[212:215]
s_add_u32 s37, s37, 32768
v_mfma_f32_16x16x32_bf16 v[220:223], a[124:127], a[68:71], v[220:223]
v_mfma_f32_16x16x32_bf16 v[228:231], a[124:127], a[72:75], v[228:231]
s_cmp_ge_u32 s37, s42
v_mfma_f32_16x16x32_bf16 v[236:239], a[124:127], a[76:79], v[236:239]
v_mfma_f32_16x16x32_bf16 v[244:247], a[124:127], a[80:83], v[244:247]
s_cselect_b32 s37, s41, s37
v_mfma_f32_16x16x32_bf16 v[252:255], a[124:127], a[84:87], v[252:255]
v_mfma_f32_16x16x32_bf16 a[132:135], a[124:127], a[88:91], a[132:135]
v_mfma_f32_16x16x32_bf16 a[140:143], a[124:127], a[92:95], a[140:143]
s_nop 7
v_pk_mul_f32 v[16:17], v[16:17], s[56:57]
v_pk_mul_f32 v[18:19], v[18:19], s[56:57]
v_pk_mul_f32 v[20:21], v[20:21], s[56:57]
v_pk_mul_f32 v[22:23], v[22:23], s[56:57]
v_cvt_pk_bf16_f32 v16, v16, v17
v_cvt_pk_bf16_f32 v17, v18, v19
v_cvt_pk_bf16_f32 v18, v20, v21
v_cvt_pk_bf16_f32 v19, v22, v23
v_accvgpr_write_b32 a144, v16
v_accvgpr_write_b32 a145, v17
v_accvgpr_write_b32 a146, v18
v_accvgpr_write_b32 a147, v19
v_accvgpr_read_b32 v16, a136
v_accvgpr_read_b32 v20, a140
v_accvgpr_read_b32 v17, a137
v_accvgpr_read_b32 v21, a141
v_accvgpr_read_b32 v18, a138
v_accvgpr_read_b32 v22, a142
v_accvgpr_read_b32 v19, a139
v_accvgpr_read_b32 v23, a143
v_pk_mul_f32 v[16:17], v[16:17], s[56:57]
v_pk_mul_f32 v[18:19], v[18:19], s[56:57]
v_pk_mul_f32 v[20:21], v[20:21], s[56:57]
v_pk_mul_f32 v[22:23], v[22:23], s[56:57]
v_cvt_pk_bf16_f32 v16, v16, v17
v_cvt_pk_bf16_f32 v17, v18, v19
v_cvt_pk_bf16_f32 v18, v20, v21
v_cvt_pk_bf16_f32 v19, v22, v23
s_add_u32 s40, s45, 62464
buffer_store_dwordx4 v[16:19], v12, s[4:7], s40 offen sc1
s_nop 1
v_accvgpr_read_b32 v16, a128
v_accvgpr_read_b32 v20, a132
v_accvgpr_read_b32 v17, a129
v_accvgpr_read_b32 v21, a133
v_accvgpr_read_b32 v18, a130
v_accvgpr_read_b32 v22, a134
v_accvgpr_read_b32 v19, a131
v_accvgpr_read_b32 v23, a135
v_pk_mul_f32 v[16:17], v[16:17], s[56:57]
v_pk_mul_f32 v[18:19], v[18:19], s[56:57]
v_pk_mul_f32 v[20:21], v[20:21], s[56:57]
v_pk_mul_f32 v[22:23], v[22:23], s[56:57]
v_cvt_pk_bf16_f32 v16, v16, v17
v_cvt_pk_bf16_f32 v17, v18, v19
v_cvt_pk_bf16_f32 v18, v20, v21
v_cvt_pk_bf16_f32 v19, v22, v23
v_accvgpr_write_b32 a252, v16
v_accvgpr_write_b32 a253, v17
v_accvgpr_write_b32 a254, v18
v_accvgpr_write_b32 a255, v19
s_cmp_eq_u32 s47, 1
s_cbranch_scc1 fused_kernel_qb1
fused_kernel_qb0:
s_waitcnt vmcnt(17) lgkmcnt(0)
s_barrier
v_mfma_f32_16x16x32_bf16 v[16:19], a[32:35], a[0:3], 0
v_add_u32 v7, s38, v5
s_add_u32 m0, s34, 16384
v_pk_mul_f32 v[24:25], v[24:25], s[56:57]
v_pk_mul_f32 v[26:27], v[26:27], s[56:57]
v_pk_mul_f32 v[28:29], v[28:29], s[56:57]
v_pk_mul_f32 v[30:31], v[30:31], s[56:57]
v_cvt_pk_bf16_f32 v24, v24, v25
v_cvt_pk_bf16_f32 v25, v26, v27
v_cvt_pk_bf16_f32 v26, v28, v29
v_cvt_pk_bf16_f32 v27, v30, v31
v_accvgpr_write_b32 a160, v24
v_accvgpr_write_b32 a161, v25
v_accvgpr_write_b32 a162, v26
v_accvgpr_write_b32 a163, v27
v_mfma_f32_16x16x32_bf16 v[24:27], a[32:35], a[4:7], 0
ds_read_b64_tr_b16 a[96:97], v8 offset:49152
v_pk_mul_f32 v[32:33], v[32:33], s[56:57]
v_pk_mul_f32 v[34:35], v[34:35], s[56:57]
v_pk_mul_f32 v[36:37], v[36:37], s[56:57]
v_pk_mul_f32 v[38:39], v[38:39], s[56:57]
v_cvt_pk_bf16_f32 v32, v32, v33
v_cvt_pk_bf16_f32 v33, v34, v35
v_cvt_pk_bf16_f32 v34, v36, v37
v_cvt_pk_bf16_f32 v35, v38, v39
v_accvgpr_write_b32 a176, v32
v_accvgpr_write_b32 a177, v33
v_accvgpr_write_b32 a178, v34
v_accvgpr_write_b32 a179, v35
v_mfma_f32_16x16x32_bf16 v[32:35], a[32:35], a[8:11], 0
ds_read_b64_tr_b16 a[98:99], v8 offset:50176
buffer_load_dwordx4 v2, s[8:11], s28 offen lds
v_pk_mul_f32 v[40:41], v[40:41], s[56:57]
v_pk_mul_f32 v[42:43], v[42:43], s[56:57]
v_pk_mul_f32 v[44:45], v[44:45], s[56:57]
v_pk_mul_f32 v[46:47], v[46:47], s[56:57]
v_cvt_pk_bf16_f32 v40, v40, v41
v_cvt_pk_bf16_f32 v41, v42, v43
v_cvt_pk_bf16_f32 v42, v44, v45
v_cvt_pk_bf16_f32 v43, v46, v47
v_accvgpr_write_b32 a192, v40
v_accvgpr_write_b32 a193, v41
v_accvgpr_write_b32 a194, v42
v_accvgpr_write_b32 a195, v43
v_mfma_f32_16x16x32_bf16 v[40:43], a[32:35], a[12:15], 0
v_pk_mul_f32 v[48:49], v[48:49], s[56:57]
v_pk_mul_f32 v[50:51], v[50:51], s[56:57]
v_pk_mul_f32 v[52:53], v[52:53], s[56:57]
v_pk_mul_f32 v[54:55], v[54:55], s[56:57]
v_cvt_pk_bf16_f32 v48, v48, v49
v_cvt_pk_bf16_f32 v49, v50, v51
v_cvt_pk_bf16_f32 v50, v52, v53
v_cvt_pk_bf16_f32 v51, v54, v55
v_accvgpr_write_b32 a208, v48
v_accvgpr_write_b32 a209, v49
v_accvgpr_write_b32 a210, v50
v_accvgpr_write_b32 a211, v51
v_mfma_f32_16x16x32_bf16 v[48:51], a[32:35], a[16:19], 0
ds_read_b128 a[64:67], v7 offset:0
s_add_u32 s28, s28, s29
v_pk_mul_f32 v[56:57], v[56:57], s[56:57]
v_pk_mul_f32 v[58:59], v[58:59], s[56:57]
v_pk_mul_f32 v[60:61], v[60:61], s[56:57]
v_pk_mul_f32 v[62:63], v[62:63], s[56:57]
v_cvt_pk_bf16_f32 v56, v56, v57
v_cvt_pk_bf16_f32 v57, v58, v59
v_cvt_pk_bf16_f32 v58, v60, v61
v_cvt_pk_bf16_f32 v59, v62, v63
v_accvgpr_write_b32 a224, v56
v_accvgpr_write_b32 a225, v57
v_accvgpr_write_b32 a226, v58
v_accvgpr_write_b32 a227, v59
v_mfma_f32_16x16x32_bf16 v[56:59], a[32:35], a[20:23], 0
ds_read_b128 a[68:71], v7 offset:2048
v_pk_mul_f32 v[64:65], v[64:65], s[56:57]
v_pk_mul_f32 v[66:67], v[66:67], s[56:57]
v_pk_mul_f32 v[68:69], v[68:69], s[56:57]
v_pk_mul_f32 v[70:71], v[70:71], s[56:57]
v_cvt_pk_bf16_f32 v64, v64, v65
v_cvt_pk_bf16_f32 v65, v66, v67
v_cvt_pk_bf16_f32 v66, v68, v69
v_cvt_pk_bf16_f32 v67, v70, v71
v_accvgpr_write_b32 a240, v64
v_accvgpr_write_b32 a241, v65
v_accvgpr_write_b32 a242, v66
v_accvgpr_write_b32 a243, v67
v_mfma_f32_16x16x32_bf16 v[64:67], a[32:35], a[24:27], 0
s_add_u32 m0, s34, 20480
v_pk_mul_f32 v[72:73], v[72:73], s[56:57]
v_pk_mul_f32 v[74:75], v[74:75], s[56:57]
v_pk_mul_f32 v[76:77], v[76:77], s[56:57]
v_pk_mul_f32 v[78:79], v[78:79], s[56:57]
v_cvt_pk_bf16_f32 v72, v72, v73
v_cvt_pk_bf16_f32 v73, v74, v75
v_cvt_pk_bf16_f32 v74, v76, v77
v_cvt_pk_bf16_f32 v75, v78, v79
s_add_u32 s40, s45, 57344
buffer_store_dwordx4 v[72:75], v12, s[4:7], s40 offen sc1
s_nop 1
v_mfma_f32_16x16x32_bf16 v[72:75], a[32:35], a[28:31], 0
ds_read_b128 a[72:75], v7 offset:4096
v_mfma_f32_16x16x32_bf16 v[20:23], a[36:39], a[0:3], 0
buffer_load_dwordx4 v2, s[8:11], s28 offen lds
v_mfma_f32_16x16x32_bf16 v[28:31], a[36:39], a[4:7], 0
ds_read_b128 a[76:79], v7 offset:6144
v_mfma_f32_16x16x32_bf16 v[36:39], a[36:39], a[8:11], 0
ds_read_b128 a[80:83], v7 offset:8192
s_add_u32 s28, s28, s29
v_mfma_f32_16x16x32_bf16 v[44:47], a[36:39], a[12:15], 0
v_mfma_f32_16x16x32_bf16 v[52:55], a[36:39], a[16:19], 0
ds_read_b128 a[84:87], v7 offset:10240
s_add_u32 m0, s34, 24576
v_mfma_f32_16x16x32_bf16 v[60:63], a[36:39], a[20:23], 0
v_mfma_f32_16x16x32_bf16 v[68:71], a[36:39], a[24:27], 0
ds_read_b128 a[88:91], v7 offset:12288
buffer_load_dwordx4 v2, s[8:11], s28 offen lds
v_mfma_f32_16x16x32_bf16 v[76:79], a[36:39], a[28:31], 0
ds_read_b128 a[92:95], v7 offset:14336
v_pk_mul_f32 v[80:81], v[80:81], s[56:57]
v_pk_mul_f32 v[82:83], v[82:83], s[56:57]
v_pk_mul_f32 v[84:85], v[84:85], s[56:57]
v_pk_mul_f32 v[86:87], v[86:87], s[56:57]
v_cvt_pk_bf16_f32 v80, v80, v81
v_cvt_pk_bf16_f32 v81, v82, v83
v_cvt_pk_bf16_f32 v82, v84, v85
v_cvt_pk_bf16_f32 v83, v86, v87
v_accvgpr_write_b32 a148, v80
v_accvgpr_write_b32 a149, v81
v_accvgpr_write_b32 a150, v82
v_accvgpr_write_b32 a151, v83
v_mfma_f32_16x16x32_bf16 v[80:83], a[40:43], a[0:3], 0
s_add_u32 s28, s28, s29
v_pk_mul_f32 v[88:89], v[88:89], s[56:57]
v_pk_mul_f32 v[90:91], v[90:91], s[56:57]
v_pk_mul_f32 v[92:93], v[92:93], s[56:57]
v_pk_mul_f32 v[94:95], v[94:95], s[56:57]
v_cvt_pk_bf16_f32 v88, v88, v89
v_cvt_pk_bf16_f32 v89, v90, v91
v_cvt_pk_bf16_f32 v90, v92, v93
v_cvt_pk_bf16_f32 v91, v94, v95
v_accvgpr_write_b32 a164, v88
v_accvgpr_write_b32 a165, v89
v_accvgpr_write_b32 a166, v90
v_accvgpr_write_b32 a167, v91
v_mfma_f32_16x16x32_bf16 v[88:91], a[40:43], a[4:7], 0
ds_read_b64_tr_b16 a[100:101], v9 offset:49152
v_pk_mul_f32 v[96:97], v[96:97], s[56:57]
v_pk_mul_f32 v[98:99], v[98:99], s[56:57]
v_pk_mul_f32 v[100:101], v[100:101], s[56:57]
v_pk_mul_f32 v[102:103], v[102:103], s[56:57]
v_cvt_pk_bf16_f32 v96, v96, v97
v_cvt_pk_bf16_f32 v97, v98, v99
v_cvt_pk_bf16_f32 v98, v100, v101
v_cvt_pk_bf16_f32 v99, v102, v103
v_accvgpr_write_b32 a180, v96
v_accvgpr_write_b32 a181, v97
v_accvgpr_write_b32 a182, v98
v_accvgpr_write_b32 a183, v99
v_mfma_f32_16x16x32_bf16 v[96:99], a[40:43], a[8:11], 0
ds_read_b64_tr_b16 a[102:103], v9 offset:50176
s_add_u32 m0, s34, 28672
v_pk_mul_f32 v[104:105], v[104:105], s[56:57]
v_pk_mul_f32 v[106:107], v[106:107], s[56:57]
v_pk_mul_f32 v[108:109], v[108:109], s[56:57]
v_pk_mul_f32 v[110:111], v[110:111], s[56:57]
v_cvt_pk_bf16_f32 v104, v104, v105
v_cvt_pk_bf16_f32 v105, v106, v107
v_cvt_pk_bf16_f32 v106, v108, v109
v_cvt_pk_bf16_f32 v107, v110, v111
v_accvgpr_write_b32 a196, v104
v_accvgpr_write_b32 a197, v105
v_accvgpr_write_b32 a198, v106
v_accvgpr_write_b32 a199, v107
v_mfma_f32_16x16x32_bf16 v[104:107], a[40:43], a[12:15], 0
v_pk_mul_f32 v[112:113], v[112:113], s[56:57]
v_pk_mul_f32 v[114:115], v[114:115], s[56:57]
v_pk_mul_f32 v[116:117], v[116:117], s[56:57]
v_pk_mul_f32 v[118:119], v[118:119], s[56:57]
v_cvt_pk_bf16_f32 v112, v112, v113
v_cvt_pk_bf16_f32 v113, v114, v115
v_cvt_pk_bf16_f32 v114, v116, v117
v_cvt_pk_bf16_f32 v115, v118, v119
v_accvgpr_write_b32 a212, v112
v_accvgpr_write_b32 a213, v113
v_accvgpr_write_b32 a214, v114
v_accvgpr_write_b32 a215, v115
v_mfma_f32_16x16x32_bf16 v[112:115], a[40:43], a[16:19], 0
ds_read_b64_tr_b16 a[104:105], v10 offset:49152
v_pk_mul_f32 v[120:121], v[120:121], s[56:57]
v_pk_mul_f32 v[122:123], v[122:123], s[56:57]
v_pk_mul_f32 v[124:125], v[124:125], s[56:57]
v_pk_mul_f32 v[126:127], v[126:127], s[56:57]
v_cvt_pk_bf16_f32 v120, v120, v121
v_cvt_pk_bf16_f32 v121, v122, v123
v_cvt_pk_bf16_f32 v122, v124, v125
v_cvt_pk_bf16_f32 v123, v126, v127
v_accvgpr_write_b32 a228, v120
v_accvgpr_write_b32 a229, v121
v_accvgpr_write_b32 a230, v122
v_accvgpr_write_b32 a231, v123
v_mfma_f32_16x16x32_bf16 v[120:123], a[40:43], a[20:23], 0
buffer_load_dwordx4 v2, s[8:11], s28 offen lds
v_pk_mul_f32 v[128:129], v[128:129], s[56:57]
v_pk_mul_f32 v[130:131], v[130:131], s[56:57]
v_pk_mul_f32 v[132:133], v[132:133], s[56:57]
v_pk_mul_f32 v[134:135], v[134:135], s[56:57]
v_cvt_pk_bf16_f32 v128, v128, v129
v_cvt_pk_bf16_f32 v129, v130, v131
v_cvt_pk_bf16_f32 v130, v132, v133
v_cvt_pk_bf16_f32 v131, v134, v135
v_accvgpr_write_b32 a244, v128
v_accvgpr_write_b32 a245, v129
v_accvgpr_write_b32 a246, v130
v_accvgpr_write_b32 a247, v131
v_mfma_f32_16x16x32_bf16 v[128:131], a[40:43], a[24:27], 0
ds_read_b64_tr_b16 a[106:107], v10 offset:50176
v_pk_mul_f32 v[136:137], v[136:137], s[56:57]
v_pk_mul_f32 v[138:139], v[138:139], s[56:57]
v_pk_mul_f32 v[140:141], v[140:141], s[56:57]
v_pk_mul_f32 v[142:143], v[142:143], s[56:57]
v_cvt_pk_bf16_f32 v136, v136, v137
v_cvt_pk_bf16_f32 v137, v138, v139
v_cvt_pk_bf16_f32 v138, v140, v141
v_cvt_pk_bf16_f32 v139, v142, v143
s_add_u32 s40, s45, 58368
buffer_store_dwordx4 v[136:139], v12, s[4:7], s40 offen sc1
s_nop 1
v_mfma_f32_16x16x32_bf16 v[136:139], a[40:43], a[28:31], 0
ds_read_b64_tr_b16 a[108:109], v11 offset:49152
s_add_u32 s28, s28, s30
v_mfma_f32_16x16x32_bf16 v[84:87], a[44:47], a[0:3], 0
v_mfma_f32_16x16x32_bf16 v[92:95], a[44:47], a[4:7], 0
ds_read_b64_tr_b16 a[110:111], v11 offset:50176
s_add_u32 s34, s34, 32768
v_mfma_f32_16x16x32_bf16 v[100:103], a[44:47], a[8:11], 0
v_mfma_f32_16x16x32_bf16 v[108:111], a[44:47], a[12:15], 0
ds_read_b64_tr_b16 a[112:113], v8 offset:57344
s_cmp_ge_u32 s34, s36
v_mfma_f32_16x16x32_bf16 v[116:119], a[44:47], a[16:19], 0
ds_read_b64_tr_b16 a[114:115], v8 offset:58368
v_mfma_f32_16x16x32_bf16 v[124:127], a[44:47], a[20:23], 0
s_cselect_b32 s34, s35, s34
v_mfma_f32_16x16x32_bf16 v[132:135], a[44:47], a[24:27], 0
ds_read_b64_tr_b16 a[116:117], v9 offset:57344
v_mfma_f32_16x16x32_bf16 v[140:143], a[44:47], a[28:31], 0
ds_read_b64_tr_b16 a[118:119], v9 offset:58368
s_add_u32 m0, s43, 32768
v_pk_mul_f32 v[144:145], v[144:145], s[56:57]
v_pk_mul_f32 v[146:147], v[146:147], s[56:57]
v_pk_mul_f32 v[148:149], v[148:149], s[56:57]
v_pk_mul_f32 v[150:151], v[150:151], s[56:57]
v_cvt_pk_bf16_f32 v144, v144, v145
v_cvt_pk_bf16_f32 v145, v146, v147
v_cvt_pk_bf16_f32 v146, v148, v149
v_cvt_pk_bf16_f32 v147, v150, v151
v_accvgpr_write_b32 a152, v144
v_accvgpr_write_b32 a153, v145
v_accvgpr_write_b32 a154, v146
v_accvgpr_write_b32 a155, v147
v_mfma_f32_16x16x32_bf16 v[144:147], a[48:51], a[0:3], 0
v_pk_mul_f32 v[152:153], v[152:153], s[56:57]
v_pk_mul_f32 v[154:155], v[154:155], s[56:57]
v_pk_mul_f32 v[156:157], v[156:157], s[56:57]
v_pk_mul_f32 v[158:159], v[158:159], s[56:57]
v_cvt_pk_bf16_f32 v152, v152, v153
v_cvt_pk_bf16_f32 v153, v154, v155
v_cvt_pk_bf16_f32 v154, v156, v157
v_cvt_pk_bf16_f32 v155, v158, v159
v_accvgpr_write_b32 a168, v152
v_accvgpr_write_b32 a169, v153
v_accvgpr_write_b32 a170, v154
v_accvgpr_write_b32 a171, v155
v_mfma_f32_16x16x32_bf16 v[152:155], a[48:51], a[4:7], 0
ds_read_b64_tr_b16 a[120:121], v10 offset:57344
buffer_load_dwordx4 v3, s[12:15], s31 offen lds
v_pk_mul_f32 v[160:161], v[160:161], s[56:57]
v_pk_mul_f32 v[162:163], v[162:163], s[56:57]
v_pk_mul_f32 v[164:165], v[164:165], s[56:57]
v_pk_mul_f32 v[166:167], v[166:167], s[56:57]
v_cvt_pk_bf16_f32 v160, v160, v161
v_cvt_pk_bf16_f32 v161, v162, v163
v_cvt_pk_bf16_f32 v162, v164, v165
v_cvt_pk_bf16_f32 v163, v166, v167
v_accvgpr_write_b32 a184, v160
v_accvgpr_write_b32 a185, v161
v_accvgpr_write_b32 a186, v162
v_accvgpr_write_b32 a187, v163
v_mfma_f32_16x16x32_bf16 v[160:163], a[48:51], a[8:11], 0
v_pk_mul_f32 v[168:169], v[168:169], s[56:57]
v_pk_mul_f32 v[170:171], v[170:171], s[56:57]
v_pk_mul_f32 v[172:173], v[172:173], s[56:57]
v_pk_mul_f32 v[174:175], v[174:175], s[56:57]
v_cvt_pk_bf16_f32 v168, v168, v169
v_cvt_pk_bf16_f32 v169, v170, v171
v_cvt_pk_bf16_f32 v170, v172, v173
v_cvt_pk_bf16_f32 v171, v174, v175
v_accvgpr_write_b32 a200, v168
v_accvgpr_write_b32 a201, v169
v_accvgpr_write_b32 a202, v170
v_accvgpr_write_b32 a203, v171
v_mfma_f32_16x16x32_bf16 v[168:171], a[48:51], a[12:15], 0
ds_read_b64_tr_b16 a[122:123], v10 offset:58368
s_add_u32 s31, s31, s32
v_pk_mul_f32 v[176:177], v[176:177], s[56:57]
v_pk_mul_f32 v[178:179], v[178:179], s[56:57]
v_pk_mul_f32 v[180:181], v[180:181], s[56:57]
v_pk_mul_f32 v[182:183], v[182:183], s[56:57]
v_cvt_pk_bf16_f32 v176, v176, v177
v_cvt_pk_bf16_f32 v177, v178, v179
v_cvt_pk_bf16_f32 v178, v180, v181
v_cvt_pk_bf16_f32 v179, v182, v183
v_accvgpr_write_b32 a216, v176
v_accvgpr_write_b32 a217, v177
v_accvgpr_write_b32 a218, v178
v_accvgpr_write_b32 a219, v179
v_mfma_f32_16x16x32_bf16 v[176:179], a[48:51], a[16:19], 0
ds_read_b64_tr_b16 a[124:125], v11 offset:57344
v_pk_mul_f32 v[184:185], v[184:185], s[56:57]
v_pk_mul_f32 v[186:187], v[186:187], s[56:57]
v_pk_mul_f32 v[188:189], v[188:189], s[56:57]
v_pk_mul_f32 v[190:191], v[190:191], s[56:57]
v_cvt_pk_bf16_f32 v184, v184, v185
v_cvt_pk_bf16_f32 v185, v186, v187
v_cvt_pk_bf16_f32 v186, v188, v189
v_cvt_pk_bf16_f32 v187, v190, v191
v_accvgpr_write_b32 a232, v184
v_accvgpr_write_b32 a233, v185
v_accvgpr_write_b32 a234, v186
v_accvgpr_write_b32 a235, v187
v_mfma_f32_16x16x32_bf16 v[184:187], a[48:51], a[20:23], 0
s_add_u32 m0, s43, 33792
v_pk_mul_f32 v[192:193], v[192:193], s[56:57]
v_pk_mul_f32 v[194:195], v[194:195], s[56:57]
v_pk_mul_f32 v[196:197], v[196:197], s[56:57]
v_pk_mul_f32 v[198:199], v[198:199], s[56:57]
v_cvt_pk_bf16_f32 v192, v192, v193
v_cvt_pk_bf16_f32 v193, v194, v195
v_cvt_pk_bf16_f32 v194, v196, v197
v_cvt_pk_bf16_f32 v195, v198, v199
v_accvgpr_write_b32 a248, v192
v_accvgpr_write_b32 a249, v193
v_accvgpr_write_b32 a250, v194
v_accvgpr_write_b32 a251, v195
v_mfma_f32_16x16x32_bf16 v[192:195], a[48:51], a[24:27], 0
ds_read_b64_tr_b16 a[126:127], v11 offset:58368
v_pk_mul_f32 v[200:201], v[200:201], s[56:57]
v_pk_mul_f32 v[202:203], v[202:203], s[56:57]
v_pk_mul_f32 v[204:205], v[204:205], s[56:57]
v_pk_mul_f32 v[206:207], v[206:207], s[56:57]
v_cvt_pk_bf16_f32 v200, v200, v201
v_cvt_pk_bf16_f32 v201, v202, v203
v_cvt_pk_bf16_f32 v202, v204, v205
v_cvt_pk_bf16_f32 v203, v206, v207
s_add_u32 s40, s45, 61440
buffer_store_dwordx4 v[200:203], v12, s[4:7], s40 offen sc1
s_nop 1
v_mfma_f32_16x16x32_bf16 v[200:203], a[48:51], a[28:31], 0
buffer_load_dwordx4 v3, s[12:15], s31 offen lds
v_mfma_f32_16x16x32_bf16 v[148:151], a[52:55], a[0:3], 0
v_mfma_f32_16x16x32_bf16 v[156:159], a[52:55], a[4:7], 0
v_mfma_f32_16x16x32_bf16 v[164:167], a[52:55], a[8:11], 0
s_add_u32 s31, s31, s33
v_mfma_f32_16x16x32_bf16 v[172:175], a[52:55], a[12:15], 0
v_mfma_f32_16x16x32_bf16 v[180:183], a[52:55], a[16:19], 0
s_add_u32 m0, s43, 36864
v_mfma_f32_16x16x32_bf16 v[188:191], a[52:55], a[20:23], 0
v_mfma_f32_16x16x32_bf16 v[196:199], a[52:55], a[24:27], 0
buffer_load_dwordx4 v3, s[12:15], s31 offen lds
v_mfma_f32_16x16x32_bf16 v[204:207], a[52:55], a[28:31], 0
v_pk_mul_f32 v[208:209], v[208:209], s[56:57]
v_pk_mul_f32 v[210:211], v[210:211], s[56:57]
v_pk_mul_f32 v[212:213], v[212:213], s[56:57]
v_pk_mul_f32 v[214:215], v[214:215], s[56:57]
v_cvt_pk_bf16_f32 v208, v208, v209
v_cvt_pk_bf16_f32 v209, v210, v211
v_cvt_pk_bf16_f32 v210, v212, v213
v_cvt_pk_bf16_f32 v211, v214, v215
v_accvgpr_write_b32 a156, v208
v_accvgpr_write_b32 a157, v209
v_accvgpr_write_b32 a158, v210
v_accvgpr_write_b32 a159, v211
v_mfma_f32_16x16x32_bf16 v[208:211], a[56:59], a[0:3], 0
s_add_u32 s31, s31, s32
v_pk_mul_f32 v[216:217], v[216:217], s[56:57]
v_pk_mul_f32 v[218:219], v[218:219], s[56:57]
v_pk_mul_f32 v[220:221], v[220:221], s[56:57]
v_pk_mul_f32 v[222:223], v[222:223], s[56:57]
v_cvt_pk_bf16_f32 v216, v216, v217
v_cvt_pk_bf16_f32 v217, v218, v219
v_cvt_pk_bf16_f32 v218, v220, v221
v_cvt_pk_bf16_f32 v219, v222, v223
v_accvgpr_write_b32 a172, v216
v_accvgpr_write_b32 a173, v217
v_accvgpr_write_b32 a174, v218
v_accvgpr_write_b32 a175, v219
v_mfma_f32_16x16x32_bf16 v[216:219], a[56:59], a[4:7], 0
v_pk_mul_f32 v[224:225], v[224:225], s[56:57]
v_pk_mul_f32 v[226:227], v[226:227], s[56:57]
v_pk_mul_f32 v[228:229], v[228:229], s[56:57]
v_pk_mul_f32 v[230:231], v[230:231], s[56:57]
v_cvt_pk_bf16_f32 v224, v224, v225
v_cvt_pk_bf16_f32 v225, v226, v227
v_cvt_pk_bf16_f32 v226, v228, v229
v_cvt_pk_bf16_f32 v227, v230, v231
v_accvgpr_write_b32 a188, v224
v_accvgpr_write_b32 a189, v225
v_accvgpr_write_b32 a190, v226
v_accvgpr_write_b32 a191, v227
v_mfma_f32_16x16x32_bf16 v[224:227], a[56:59], a[8:11], 0
s_add_u32 m0, s43, 37888
v_pk_mul_f32 v[232:233], v[232:233], s[56:57]
v_pk_mul_f32 v[234:235], v[234:235], s[56:57]
v_pk_mul_f32 v[236:237], v[236:237], s[56:57]
v_pk_mul_f32 v[238:239], v[238:239], s[56:57]
v_cvt_pk_bf16_f32 v232, v232, v233
v_cvt_pk_bf16_f32 v233, v234, v235
v_cvt_pk_bf16_f32 v234, v236, v237
v_cvt_pk_bf16_f32 v235, v238, v239
v_accvgpr_write_b32 a204, v232
v_accvgpr_write_b32 a205, v233
v_accvgpr_write_b32 a206, v234
v_accvgpr_write_b32 a207, v235
v_mfma_f32_16x16x32_bf16 v[232:235], a[56:59], a[12:15], 0
v_pk_mul_f32 v[240:241], v[240:241], s[56:57]
v_pk_mul_f32 v[242:243], v[242:243], s[56:57]
v_pk_mul_f32 v[244:245], v[244:245], s[56:57]
v_pk_mul_f32 v[246:247], v[246:247], s[56:57]
v_cvt_pk_bf16_f32 v240, v240, v241
v_cvt_pk_bf16_f32 v241, v242, v243
v_cvt_pk_bf16_f32 v242, v244, v245
v_cvt_pk_bf16_f32 v243, v246, v247
v_accvgpr_write_b32 a220, v240
v_accvgpr_write_b32 a221, v241
v_accvgpr_write_b32 a222, v242
v_accvgpr_write_b32 a223, v243
v_mfma_f32_16x16x32_bf16 v[240:243], a[56:59], a[16:19], 0
buffer_load_dwordx4 v3, s[12:15], s31 offen lds
v_pk_mul_f32 v[248:249], v[248:249], s[56:57]
v_pk_mul_f32 v[250:251], v[250:251], s[56:57]
v_pk_mul_f32 v[252:253], v[252:253], s[56:57]
v_pk_mul_f32 v[254:255], v[254:255], s[56:57]
v_cvt_pk_bf16_f32 v248, v248, v249
v_cvt_pk_bf16_f32 v249, v250, v251
v_cvt_pk_bf16_f32 v250, v252, v253
v_cvt_pk_bf16_f32 v251, v254, v255
v_accvgpr_write_b32 a236, v248
v_accvgpr_write_b32 a237, v249
v_accvgpr_write_b32 a238, v250
v_accvgpr_write_b32 a239, v251
v_mfma_f32_16x16x32_bf16 v[248:251], a[56:59], a[20:23], 0
v_mfma_f32_16x16x32_bf16 a[128:131], a[56:59], a[24:27], 0
s_add_u32 s31, s31, s33
v_mfma_f32_16x16x32_bf16 a[136:139], a[56:59], a[28:31], 0
v_mfma_f32_16x16x32_bf16 v[212:215], a[60:63], a[0:3], 0
s_add_u32 s38, s38, 32768
v_mfma_f32_16x16x32_bf16 v[220:223], a[60:63], a[4:7], 0
v_mfma_f32_16x16x32_bf16 v[228:231], a[60:63], a[8:11], 0
s_cmp_ge_u32 s38, s42
v_mfma_f32_16x16x32_bf16 v[236:239], a[60:63], a[12:15], 0
v_mfma_f32_16x16x32_bf16 v[244:247], a[60:63], a[16:19], 0
s_cselect_b32 s38, s41, s38
v_mfma_f32_16x16x32_bf16 v[252:255], a[60:63], a[20:23], 0
v_mfma_f32_16x16x32_bf16 a[132:135], a[60:63], a[24:27], 0
v_mfma_f32_16x16x32_bf16 a[140:143], a[60:63], a[28:31], 0
s_waitcnt vmcnt(17) lgkmcnt(0)
s_barrier
v_mfma_f32_16x16x32_bf16 v[16:19], a[96:99], a[64:67], v[16:19]
v_add_u32 v6, s37, v4
s_add_u32 m0, s34, 0
v_mfma_f32_16x16x32_bf16 v[24:27], a[96:99], a[68:71], v[24:27]
ds_read_b64_tr_b16 a[32:33], v8 offset:0
buffer_load_dwordx4 v2, s[8:11], s28 offen lds
v_mfma_f32_16x16x32_bf16 v[32:35], a[96:99], a[72:75], v[32:35]
ds_read_b64_tr_b16 a[34:35], v8 offset:1024
v_mfma_f32_16x16x32_bf16 v[40:43], a[96:99], a[76:79], v[40:43]
s_add_u32 s28, s28, s29
v_mfma_f32_16x16x32_bf16 v[48:51], a[96:99], a[80:83], v[48:51]
ds_read_b128 a[0:3], v6 offset:0
v_mfma_f32_16x16x32_bf16 v[56:59], a[96:99], a[84:87], v[56:59]
ds_read_b128 a[4:7], v6 offset:2048
s_add_u32 m0, s34, 4096
v_mfma_f32_16x16x32_bf16 v[64:67], a[96:99], a[88:91], v[64:67]
v_mfma_f32_16x16x32_bf16 v[72:75], a[96:99], a[92:95], v[72:75]
ds_read_b128 a[8:11], v6 offset:4096
buffer_load_dwordx4 v2, s[8:11], s28 offen lds
v_mfma_f32_16x16x32_bf16 v[20:23], a[100:103], a[64:67], v[20:23]
v_mfma_f32_16x16x32_bf16 v[28:31], a[100:103], a[68:71], v[28:31]
ds_read_b128 a[12:15], v6 offset:6144
s_add_u32 s28, s28, s29
v_mfma_f32_16x16x32_bf16 v[36:39], a[100:103], a[72:75], v[36:39]
ds_read_b128 a[16:19], v6 offset:8192
s_add_u32 m0, s34, 8192
v_mfma_f32_16x16x32_bf16 v[44:47], a[100:103], a[76:79], v[44:47]
v_mfma_f32_16x16x32_bf16 v[52:55], a[100:103], a[80:83], v[52:55]
ds_read_b128 a[20:23], v6 offset:10240
buffer_load_dwordx4 v2, s[8:11], s28 offen lds
v_mfma_f32_16x16x32_bf16 v[60:63], a[100:103], a[84:87], v[60:63]
v_mfma_f32_16x16x32_bf16 v[68:71], a[100:103], a[88:91], v[68:71]
ds_read_b128 a[24:27], v6 offset:12288
s_add_u32 s28, s28, s29
v_mfma_f32_16x16x32_bf16 v[76:79], a[100:103], a[92:95], v[76:79]
ds_read_b128 a[28:31], v6 offset:14336
v_mfma_f32_16x16x32_bf16 v[80:83], a[104:107], a[64:67], v[80:83]
s_add_u32 m0, s34, 12288
v_mfma_f32_16x16x32_bf16 v[88:91], a[104:107], a[68:71], v[88:91]
ds_read_b64_tr_b16 a[36:37], v9 offset:0
v_mfma_f32_16x16x32_bf16 v[96:99], a[104:107], a[72:75], v[96:99]
ds_read_b64_tr_b16 a[38:39], v9 offset:1024
buffer_load_dwordx4 v2, s[8:11], s28 offen lds
v_mfma_f32_16x16x32_bf16 v[104:107], a[104:107], a[76:79], v[104:107]
s_add_u32 s28, s28, s29
v_mfma_f32_16x16x32_bf16 v[112:115], a[104:107], a[80:83], v[112:115]
ds_read_b64_tr_b16 a[40:41], v10 offset:0
v_mfma_f32_16x16x32_bf16 v[120:123], a[104:107], a[84:87], v[120:123]
s_add_u32 m0, s43, 49152
v_mfma_f32_16x16x32_bf16 v[128:131], a[104:107], a[88:91], v[128:131]
ds_read_b64_tr_b16 a[42:43], v10 offset:1024
v_mfma_f32_16x16x32_bf16 v[136:139], a[104:107], a[92:95], v[136:139]
ds_read_b64_tr_b16 a[44:45], v11 offset:0
buffer_load_dwordx4 v3, s[12:15], s31 offen lds
v_mfma_f32_16x16x32_bf16 v[84:87], a[108:111], a[64:67], v[84:87]
v_mfma_f32_16x16x32_bf16 v[92:95], a[108:111], a[68:71], v[92:95]
ds_read_b64_tr_b16 a[46:47], v11 offset:1024
s_add_u32 s31, s31, s32
v_mfma_f32_16x16x32_bf16 v[100:103], a[108:111], a[72:75], v[100:103]
v_mfma_f32_16x16x32_bf16 v[108:111], a[108:111], a[76:79], v[108:111]
ds_read_b64_tr_b16 a[48:49], v8 offset:8192
s_add_u32 m0, s43, 50176
v_mfma_f32_16x16x32_bf16 v[116:119], a[108:111], a[80:83], v[116:119]
ds_read_b64_tr_b16 a[50:51], v8 offset:9216
buffer_load_dwordx4 v3, s[12:15], s31 offen lds
v_mfma_f32_16x16x32_bf16 v[124:127], a[108:111], a[84:87], v[124:127]
v_mfma_f32_16x16x32_bf16 v[132:135], a[108:111], a[88:91], v[132:135]
ds_read_b64_tr_b16 a[52:53], v9 offset:8192
s_add_u32 s31, s31, s33
v_mfma_f32_16x16x32_bf16 v[140:143], a[108:111], a[92:95], v[140:143]
ds_read_b64_tr_b16 a[54:55], v9 offset:9216
v_mfma_f32_16x16x32_bf16 v[144:147], a[112:115], a[64:67], v[144:147]
s_add_u32 m0, s43, 53248
v_mfma_f32_16x16x32_bf16 v[152:155], a[112:115], a[68:71], v[152:155]
ds_read_b64_tr_b16 a[56:57], v10 offset:8192
v_mfma_f32_16x16x32_bf16 v[160:163], a[112:115], a[72:75], v[160:163]
buffer_load_dwordx4 v3, s[12:15], s31 offen lds
v_mfma_f32_16x16x32_bf16 v[168:171], a[112:115], a[76:79], v[168:171]
ds_read_b64_tr_b16 a[58:59], v10 offset:9216
v_mfma_f32_16x16x32_bf16 v[176:179], a[112:115], a[80:83], v[176:179]
ds_read_b64_tr_b16 a[60:61], v11 offset:8192
s_add_u32 s31, s31, s32
v_mfma_f32_16x16x32_bf16 v[184:187], a[112:115], a[84:87], v[184:187]
s_add_u32 m0, s43, 54272
v_mfma_f32_16x16x32_bf16 v[192:195], a[112:115], a[88:91], v[192:195]
ds_read_b64_tr_b16 a[62:63], v11 offset:9216
v_mfma_f32_16x16x32_bf16 v[200:203], a[112:115], a[92:95], v[200:203]
buffer_load_dwordx4 v3, s[12:15], s31 offen lds
v_mfma_f32_16x16x32_bf16 v[148:151], a[116:119], a[64:67], v[148:151]
v_mfma_f32_16x16x32_bf16 v[156:159], a[116:119], a[68:71], v[156:159]
s_add_u32 s31, s31, s33
v_mfma_f32_16x16x32_bf16 v[164:167], a[116:119], a[72:75], v[164:167]
v_mfma_f32_16x16x32_bf16 v[172:175], a[116:119], a[76:79], v[172:175]
s_add_u32 s37, s37, 32768
v_mfma_f32_16x16x32_bf16 v[180:183], a[116:119], a[80:83], v[180:183]
v_mfma_f32_16x16x32_bf16 v[188:191], a[116:119], a[84:87], v[188:191]
s_cmp_ge_u32 s37, s42
v_mfma_f32_16x16x32_bf16 v[196:199], a[116:119], a[88:91], v[196:199]
s_cselect_b32 s37, s41, s37
v_mfma_f32_16x16x32_bf16 v[204:207], a[116:119], a[92:95], v[204:207]
v_mfma_f32_16x16x32_bf16 v[208:211], a[120:123], a[64:67], v[208:211]
s_add_u32 s40, s45, 0
v_mfma_f32_16x16x32_bf16 v[216:219], a[120:123], a[68:71], v[216:219]
v_mfma_f32_16x16x32_bf16 v[224:227], a[120:123], a[72:75], v[224:227]
buffer_store_dwordx4 a[144:147], v12, s[4:7], s40 offen sc1
v_mfma_f32_16x16x32_bf16 v[232:235], a[120:123], a[76:79], v[232:235]
v_mfma_f32_16x16x32_bf16 v[240:243], a[120:123], a[80:83], v[240:243]
s_add_u32 s40, s45, 1024
v_mfma_f32_16x16x32_bf16 v[248:251], a[120:123], a[84:87], v[248:251]
v_mfma_f32_16x16x32_bf16 a[128:131], a[120:123], a[88:91], a[128:131]
buffer_store_dwordx4 a[148:151], v12, s[4:7], s40 offen sc1
v_mfma_f32_16x16x32_bf16 a[136:139], a[120:123], a[92:95], a[136:139]
s_add_u32 s40, s45, 4096
v_mfma_f32_16x16x32_bf16 v[212:215], a[124:127], a[64:67], v[212:215]
v_mfma_f32_16x16x32_bf16 v[220:223], a[124:127], a[68:71], v[220:223]
buffer_store_dwordx4 a[152:155], v12, s[4:7], s40 offen sc1
v_mfma_f32_16x16x32_bf16 v[228:231], a[124:127], a[72:75], v[228:231]
v_mfma_f32_16x16x32_bf16 v[236:239], a[124:127], a[76:79], v[236:239]
s_add_u32 s40, s45, 5120
v_mfma_f32_16x16x32_bf16 v[244:247], a[124:127], a[80:83], v[244:247]
v_mfma_f32_16x16x32_bf16 v[252:255], a[124:127], a[84:87], v[252:255]
buffer_store_dwordx4 a[156:159], v12, s[4:7], s40 offen sc1
v_mfma_f32_16x16x32_bf16 a[132:135], a[124:127], a[88:91], a[132:135]
v_mfma_f32_16x16x32_bf16 a[140:143], a[124:127], a[92:95], a[140:143]
s_waitcnt vmcnt(21) lgkmcnt(0)
s_barrier
v_mfma_f32_16x16x32_bf16 v[16:19], a[32:35], a[0:3], v[16:19]
v_add_u32 v7, s38, v5
s_add_u32 m0, s34, 16384
v_mfma_f32_16x16x32_bf16 v[24:27], a[32:35], a[4:7], v[24:27]
ds_read_b64_tr_b16 a[96:97], v8 offset:16384
buffer_load_dwordx4 v2, s[8:11], s28 offen lds
v_mfma_f32_16x16x32_bf16 v[32:35], a[32:35], a[8:11], v[32:35]
ds_read_b64_tr_b16 a[98:99], v8 offset:17408
v_mfma_f32_16x16x32_bf16 v[40:43], a[32:35], a[12:15], v[40:43]
s_add_u32 s28, s28, s29
v_mfma_f32_16x16x32_bf16 v[48:51], a[32:35], a[16:19], v[48:51]
ds_read_b128 a[64:67], v7 offset:0
s_add_u32 m0, s34, 20480
v_mfma_f32_16x16x32_bf16 v[56:59], a[32:35], a[20:23], v[56:59]
ds_read_b128 a[68:71], v7 offset:2048
v_mfma_f32_16x16x32_bf16 v[64:67], a[32:35], a[24:27], v[64:67]
buffer_load_dwordx4 v2, s[8:11], s28 offen lds
v_mfma_f32_16x16x32_bf16 v[72:75], a[32:35], a[28:31], v[72:75]
ds_read_b128 a[72:75], v7 offset:4096
v_mfma_f32_16x16x32_bf16 v[20:23], a[36:39], a[0:3], v[20:23]
s_add_u32 s28, s28, s29
v_mfma_f32_16x16x32_bf16 v[28:31], a[36:39], a[4:7], v[28:31]
ds_read_b128 a[76:79], v7 offset:6144
s_add_u32 m0, s34, 24576
v_mfma_f32_16x16x32_bf16 v[36:39], a[36:39], a[8:11], v[36:39]
ds_read_b128 a[80:83], v7 offset:8192
v_mfma_f32_16x16x32_bf16 v[44:47], a[36:39], a[12:15], v[44:47]
buffer_load_dwordx4 v2, s[8:11], s28 offen lds
v_mfma_f32_16x16x32_bf16 v[52:55], a[36:39], a[16:19], v[52:55]
ds_read_b128 a[84:87], v7 offset:10240
v_mfma_f32_16x16x32_bf16 v[60:63], a[36:39], a[20:23], v[60:63]
s_add_u32 s28, s28, s29
v_mfma_f32_16x16x32_bf16 v[68:71], a[36:39], a[24:27], v[68:71]
ds_read_b128 a[88:91], v7 offset:12288
s_add_u32 m0, s34, 28672
v_mfma_f32_16x16x32_bf16 v[76:79], a[36:39], a[28:31], v[76:79]
ds_read_b128 a[92:95], v7 offset:14336
v_mfma_f32_16x16x32_bf16 v[80:83], a[40:43], a[0:3], v[80:83]
buffer_load_dwordx4 v2, s[8:11], s28 offen lds
v_mfma_f32_16x16x32_bf16 v[88:91], a[40:43], a[4:7], v[88:91]
ds_read_b64_tr_b16 a[100:101], v9 offset:16384
v_mfma_f32_16x16x32_bf16 v[96:99], a[40:43], a[8:11], v[96:99]
ds_read_b64_tr_b16 a[102:103], v9 offset:17408
s_add_u32 s28, s28, s30
v_mfma_f32_16x16x32_bf16 v[104:107], a[40:43], a[12:15], v[104:107]
s_add_u32 s34, s34, 32768
v_mfma_f32_16x16x32_bf16 v[112:115], a[40:43], a[16:19], v[112:115]
ds_read_b64_tr_b16 a[104:105], v10 offset:16384
v_mfma_f32_16x16x32_bf16 v[120:123], a[40:43], a[20:23], v[120:123]
s_cmp_ge_u32 s34, s36
v_mfma_f32_16x16x32_bf16 v[128:131], a[40:43], a[24:27], v[128:131]
ds_read_b64_tr_b16 a[106:107], v10 offset:17408
v_mfma_f32_16x16x32_bf16 v[136:139], a[40:43], a[28:31], v[136:139]
ds_read_b64_tr_b16 a[108:109], v11 offset:16384
s_cselect_b32 s34, s35, s34
v_mfma_f32_16x16x32_bf16 v[84:87], a[44:47], a[0:3], v[84:87]
s_add_u32 m0, s43, 0
v_mfma_f32_16x16x32_bf16 v[92:95], a[44:47], a[4:7], v[92:95]
ds_read_b64_tr_b16 a[110:111], v11 offset:17408
v_mfma_f32_16x16x32_bf16 v[100:103], a[44:47], a[8:11], v[100:103]
buffer_load_dwordx4 v3, s[12:15], s31 offen lds
v_mfma_f32_16x16x32_bf16 v[108:111], a[44:47], a[12:15], v[108:111]
ds_read_b64_tr_b16 a[112:113], v8 offset:24576
v_mfma_f32_16x16x32_bf16 v[116:119], a[44:47], a[16:19], v[116:119]
ds_read_b64_tr_b16 a[114:115], v8 offset:25600
s_add_u32 s31, s31, s32
v_mfma_f32_16x16x32_bf16 v[124:127], a[44:47], a[20:23], v[124:127]
s_add_u32 m0, s43, 1024
v_mfma_f32_16x16x32_bf16 v[132:135], a[44:47], a[24:27], v[132:135]
ds_read_b64_tr_b16 a[116:117], v9 offset:24576
v_mfma_f32_16x16x32_bf16 v[140:143], a[44:47], a[28:31], v[140:143]
ds_read_b64_tr_b16 a[118:119], v9 offset:25600
buffer_load_dwordx4 v3, s[12:15], s31 offen lds
v_mfma_f32_16x16x32_bf16 v[144:147], a[48:51], a[0:3], v[144:147]
v_mfma_f32_16x16x32_bf16 v[152:155], a[48:51], a[4:7], v[152:155]
ds_read_b64_tr_b16 a[120:121], v10 offset:24576
s_add_u32 s31, s31, s33
v_mfma_f32_16x16x32_bf16 v[160:163], a[48:51], a[8:11], v[160:163]
s_add_u32 m0, s43, 4096
v_mfma_f32_16x16x32_bf16 v[168:171], a[48:51], a[12:15], v[168:171]
ds_read_b64_tr_b16 a[122:123], v10 offset:25600
v_mfma_f32_16x16x32_bf16 v[176:179], a[48:51], a[16:19], v[176:179]
ds_read_b64_tr_b16 a[124:125], v11 offset:24576
buffer_load_dwordx4 v3, s[12:15], s31 offen lds
v_mfma_f32_16x16x32_bf16 v[184:187], a[48:51], a[20:23], v[184:187]
v_mfma_f32_16x16x32_bf16 v[192:195], a[48:51], a[24:27], v[192:195]
ds_read_b64_tr_b16 a[126:127], v11 offset:25600
s_add_u32 s31, s31, s32
v_mfma_f32_16x16x32_bf16 v[200:203], a[48:51], a[28:31], v[200:203]
s_add_u32 m0, s43, 5120
v_mfma_f32_16x16x32_bf16 v[148:151], a[52:55], a[0:3], v[148:151]
v_mfma_f32_16x16x32_bf16 v[156:159], a[52:55], a[4:7], v[156:159]
buffer_load_dwordx4 v3, s[12:15], s31 offen lds
v_mfma_f32_16x16x32_bf16 v[164:167], a[52:55], a[8:11], v[164:167]
v_mfma_f32_16x16x32_bf16 v[172:175], a[52:55], a[12:15], v[172:175]
s_add_u32 s31, s31, s33
v_mfma_f32_16x16x32_bf16 v[180:183], a[52:55], a[16:19], v[180:183]
s_add_u32 s38, s38, 32768
v_mfma_f32_16x16x32_bf16 v[188:191], a[52:55], a[20:23], v[188:191]
v_mfma_f32_16x16x32_bf16 v[196:199], a[52:55], a[24:27], v[196:199]
s_cmp_ge_u32 s38, s42
v_mfma_f32_16x16x32_bf16 v[204:207], a[52:55], a[28:31], v[204:207]
v_mfma_f32_16x16x32_bf16 v[208:211], a[56:59], a[0:3], v[208:211]
s_cselect_b32 s38, s41, s38
v_mfma_f32_16x16x32_bf16 v[216:219], a[56:59], a[4:7], v[216:219]
s_add_u32 s40, s45, 8192
v_mfma_f32_16x16x32_bf16 v[224:227], a[56:59], a[8:11], v[224:227]
v_mfma_f32_16x16x32_bf16 v[232:235], a[56:59], a[12:15], v[232:235]
buffer_store_dwordx4 a[160:163], v12, s[4:7], s40 offen sc1
v_mfma_f32_16x16x32_bf16 v[240:243], a[56:59], a[16:19], v[240:243]
v_mfma_f32_16x16x32_bf16 v[248:251], a[56:59], a[20:23], v[248:251]
s_add_u32 s40, s45, 9216
v_mfma_f32_16x16x32_bf16 a[128:131], a[56:59], a[24:27], a[128:131]
buffer_store_dwordx4 a[164:167], v12, s[4:7], s40 offen sc1
v_mfma_f32_16x16x32_bf16 a[136:139], a[56:59], a[28:31], a[136:139]
v_mfma_f32_16x16x32_bf16 v[212:215], a[60:63], a[0:3], v[212:215]
s_add_u32 s40, s45, 12288
v_mfma_f32_16x16x32_bf16 v[220:223], a[60:63], a[4:7], v[220:223]
v_mfma_f32_16x16x32_bf16 v[228:231], a[60:63], a[8:11], v[228:231]
buffer_store_dwordx4 a[168:171], v12, s[4:7], s40 offen sc1
v_mfma_f32_16x16x32_bf16 v[236:239], a[60:63], a[12:15], v[236:239]
s_add_u32 s40, s45, 13312
v_mfma_f32_16x16x32_bf16 v[244:247], a[60:63], a[16:19], v[244:247]
v_mfma_f32_16x16x32_bf16 v[252:255], a[60:63], a[20:23], v[252:255]
buffer_store_dwordx4 a[172:175], v12, s[4:7], s40 offen sc1
v_mfma_f32_16x16x32_bf16 a[132:135], a[60:63], a[24:27], a[132:135]
v_mfma_f32_16x16x32_bf16 a[140:143], a[60:63], a[28:31], a[140:143]
s_waitcnt vmcnt(24) lgkmcnt(0)
s_barrier
v_mfma_f32_16x16x32_bf16 v[16:19], a[96:99], a[64:67], v[16:19]
v_add_u32 v6, s37, v4
s_add_u32 m0, s34, 0
v_mfma_f32_16x16x32_bf16 v[24:27], a[96:99], a[68:71], v[24:27]
ds_read_b64_tr_b16 a[32:33], v8 offset:32768
buffer_load_dwordx4 v2, s[8:11], s28 offen lds
v_mfma_f32_16x16x32_bf16 v[32:35], a[96:99], a[72:75], v[32:35]
ds_read_b64_tr_b16 a[34:35], v8 offset:33792
v_mfma_f32_16x16x32_bf16 v[40:43], a[96:99], a[76:79], v[40:43]
s_add_u32 s28, s28, s29
v_mfma_f32_16x16x32_bf16 v[48:51], a[96:99], a[80:83], v[48:51]
ds_read_b128 a[0:3], v6 offset:0
v_mfma_f32_16x16x32_bf16 v[56:59], a[96:99], a[84:87], v[56:59]
ds_read_b128 a[4:7], v6 offset:2048
s_add_u32 m0, s34, 4096
v_mfma_f32_16x16x32_bf16 v[64:67], a[96:99], a[88:91], v[64:67]
v_mfma_f32_16x16x32_bf16 v[72:75], a[96:99], a[92:95], v[72:75]
ds_read_b128 a[8:11], v6 offset:4096
buffer_load_dwordx4 v2, s[8:11], s28 offen lds
v_mfma_f32_16x16x32_bf16 v[20:23], a[100:103], a[64:67], v[20:23]
v_mfma_f32_16x16x32_bf16 v[28:31], a[100:103], a[68:71], v[28:31]
ds_read_b128 a[12:15], v6 offset:6144
s_add_u32 s28, s28, s29
v_mfma_f32_16x16x32_bf16 v[36:39], a[100:103], a[72:75], v[36:39]
ds_read_b128 a[16:19], v6 offset:8192
s_add_u32 m0, s34, 8192
v_mfma_f32_16x16x32_bf16 v[44:47], a[100:103], a[76:79], v[44:47]
v_mfma_f32_16x16x32_bf16 v[52:55], a[100:103], a[80:83], v[52:55]
ds_read_b128 a[20:23], v6 offset:10240
buffer_load_dwordx4 v2, s[8:11], s28 offen lds
v_mfma_f32_16x16x32_bf16 v[60:63], a[100:103], a[84:87], v[60:63]
v_mfma_f32_16x16x32_bf16 v[68:71], a[100:103], a[88:91], v[68:71]
ds_read_b128 a[24:27], v6 offset:12288
s_add_u32 s28, s28, s29
v_mfma_f32_16x16x32_bf16 v[76:79], a[100:103], a[92:95], v[76:79]
ds_read_b128 a[28:31], v6 offset:14336
v_mfma_f32_16x16x32_bf16 v[80:83], a[104:107], a[64:67], v[80:83]
s_add_u32 m0, s34, 12288
v_mfma_f32_16x16x32_bf16 v[88:91], a[104:107], a[68:71], v[88:91]
ds_read_b64_tr_b16 a[36:37], v9 offset:32768
v_mfma_f32_16x16x32_bf16 v[96:99], a[104:107], a[72:75], v[96:99]
ds_read_b64_tr_b16 a[38:39], v9 offset:33792
buffer_load_dwordx4 v2, s[8:11], s28 offen lds
v_mfma_f32_16x16x32_bf16 v[104:107], a[104:107], a[76:79], v[104:107]
s_add_u32 s28, s28, s29
v_mfma_f32_16x16x32_bf16 v[112:115], a[104:107], a[80:83], v[112:115]
ds_read_b64_tr_b16 a[40:41], v10 offset:32768
v_mfma_f32_16x16x32_bf16 v[120:123], a[104:107], a[84:87], v[120:123]
s_add_u32 m0, s43, 16384
v_mfma_f32_16x16x32_bf16 v[128:131], a[104:107], a[88:91], v[128:131]
ds_read_b64_tr_b16 a[42:43], v10 offset:33792
v_mfma_f32_16x16x32_bf16 v[136:139], a[104:107], a[92:95], v[136:139]
ds_read_b64_tr_b16 a[44:45], v11 offset:32768
buffer_load_dwordx4 v3, s[12:15], s31 offen lds
v_mfma_f32_16x16x32_bf16 v[84:87], a[108:111], a[64:67], v[84:87]
v_mfma_f32_16x16x32_bf16 v[92:95], a[108:111], a[68:71], v[92:95]
ds_read_b64_tr_b16 a[46:47], v11 offset:33792
s_add_u32 s31, s31, s32
v_mfma_f32_16x16x32_bf16 v[100:103], a[108:111], a[72:75], v[100:103]
v_mfma_f32_16x16x32_bf16 v[108:111], a[108:111], a[76:79], v[108:111]
ds_read_b64_tr_b16 a[48:49], v8 offset:40960
s_add_u32 m0, s43, 17408
v_mfma_f32_16x16x32_bf16 v[116:119], a[108:111], a[80:83], v[116:119]
ds_read_b64_tr_b16 a[50:51], v8 offset:41984
buffer_load_dwordx4 v3, s[12:15], s31 offen lds
v_mfma_f32_16x16x32_bf16 v[124:127], a[108:111], a[84:87], v[124:127]
v_mfma_f32_16x16x32_bf16 v[132:135], a[108:111], a[88:91], v[132:135]
ds_read_b64_tr_b16 a[52:53], v9 offset:40960
s_add_u32 s31, s31, s33
v_mfma_f32_16x16x32_bf16 v[140:143], a[108:111], a[92:95], v[140:143]
ds_read_b64_tr_b16 a[54:55], v9 offset:41984
v_mfma_f32_16x16x32_bf16 v[144:147], a[112:115], a[64:67], v[144:147]
s_add_u32 m0, s43, 20480
v_mfma_f32_16x16x32_bf16 v[152:155], a[112:115], a[68:71], v[152:155]
ds_read_b64_tr_b16 a[56:57], v10 offset:40960
v_mfma_f32_16x16x32_bf16 v[160:163], a[112:115], a[72:75], v[160:163]
buffer_load_dwordx4 v3, s[12:15], s31 offen lds
v_mfma_f32_16x16x32_bf16 v[168:171], a[112:115], a[76:79], v[168:171]
ds_read_b64_tr_b16 a[58:59], v10 offset:41984
v_mfma_f32_16x16x32_bf16 v[176:179], a[112:115], a[80:83], v[176:179]
ds_read_b64_tr_b16 a[60:61], v11 offset:40960
s_add_u32 s31, s31, s32
v_mfma_f32_16x16x32_bf16 v[184:187], a[112:115], a[84:87], v[184:187]
s_add_u32 m0, s43, 21504
v_mfma_f32_16x16x32_bf16 v[192:195], a[112:115], a[88:91], v[192:195]
ds_read_b64_tr_b16 a[62:63], v11 offset:41984
v_mfma_f32_16x16x32_bf16 v[200:203], a[112:115], a[92:95], v[200:203]
buffer_load_dwordx4 v3, s[12:15], s31 offen lds
v_mfma_f32_16x16x32_bf16 v[148:151], a[116:119], a[64:67], v[148:151]
v_mfma_f32_16x16x32_bf16 v[156:159], a[116:119], a[68:71], v[156:159]
s_add_u32 s31, s31, s33
v_mfma_f32_16x16x32_bf16 v[164:167], a[116:119], a[72:75], v[164:167]
v_mfma_f32_16x16x32_bf16 v[172:175], a[116:119], a[76:79], v[172:175]
s_add_u32 s37, s37, 32768
v_mfma_f32_16x16x32_bf16 v[180:183], a[116:119], a[80:83], v[180:183]
v_mfma_f32_16x16x32_bf16 v[188:191], a[116:119], a[84:87], v[188:191]
s_cmp_ge_u32 s37, s42
v_mfma_f32_16x16x32_bf16 v[196:199], a[116:119], a[88:91], v[196:199]
s_cselect_b32 s37, s41, s37
v_mfma_f32_16x16x32_bf16 v[204:207], a[116:119], a[92:95], v[204:207]
v_mfma_f32_16x16x32_bf16 v[208:211], a[120:123], a[64:67], v[208:211]
s_add_u32 s40, s45, 16384
v_mfma_f32_16x16x32_bf16 v[216:219], a[120:123], a[68:71], v[216:219]
v_mfma_f32_16x16x32_bf16 v[224:227], a[120:123], a[72:75], v[224:227]
buffer_store_dwordx4 a[176:179], v12, s[4:7], s40 offen sc1
v_mfma_f32_16x16x32_bf16 v[232:235], a[120:123], a[76:79], v[232:235]
v_mfma_f32_16x16x32_bf16 v[240:243], a[120:123], a[80:83], v[240:243]
s_add_u32 s40, s45, 17408
v_mfma_f32_16x16x32_bf16 v[248:251], a[120:123], a[84:87], v[248:251]
v_mfma_f32_16x16x32_bf16 a[128:131], a[120:123], a[88:91], a[128:131]
buffer_store_dwordx4 a[180:183], v12, s[4:7], s40 offen sc1
v_mfma_f32_16x16x32_bf16 a[136:139], a[120:123], a[92:95], a[136:139]
s_add_u32 s40, s45, 20480
v_mfma_f32_16x16x32_bf16 v[212:215], a[124:127], a[64:67], v[212:215]
v_mfma_f32_16x16x32_bf16 v[220:223], a[124:127], a[68:71], v[220:223]
buffer_store_dwordx4 a[184:187], v12, s[4:7], s40 offen sc1
v_mfma_f32_16x16x32_bf16 v[228:231], a[124:127], a[72:75], v[228:231]
v_mfma_f32_16x16x32_bf16 v[236:239], a[124:127], a[76:79], v[236:239]
s_add_u32 s40, s45, 21504
v_mfma_f32_16x16x32_bf16 v[244:247], a[124:127], a[80:83], v[244:247]
v_mfma_f32_16x16x32_bf16 v[252:255], a[124:127], a[84:87], v[252:255]
buffer_store_dwordx4 a[188:191], v12, s[4:7], s40 offen sc1
v_mfma_f32_16x16x32_bf16 a[132:135], a[124:127], a[88:91], a[132:135]
v_mfma_f32_16x16x32_bf16 a[140:143], a[124:127], a[92:95], a[140:143]
s_waitcnt vmcnt(28) lgkmcnt(0)
s_barrier
v_mfma_f32_16x16x32_bf16 v[16:19], a[32:35], a[0:3], v[16:19]
v_add_u32 v7, s38, v5
s_add_u32 m0, s34, 16384
v_mfma_f32_16x16x32_bf16 v[24:27], a[32:35], a[4:7], v[24:27]
ds_read_b64_tr_b16 a[96:97], v8 offset:49152
buffer_load_dwordx4 v2, s[8:11], s28 offen lds
v_mfma_f32_16x16x32_bf16 v[32:35], a[32:35], a[8:11], v[32:35]
ds_read_b64_tr_b16 a[98:99], v8 offset:50176
v_mfma_f32_16x16x32_bf16 v[40:43], a[32:35], a[12:15], v[40:43]
s_add_u32 s28, s28, s29
v_mfma_f32_16x16x32_bf16 v[48:51], a[32:35], a[16:19], v[48:51]
ds_read_b128 a[64:67], v7 offset:0
s_add_u32 m0, s34, 20480
v_mfma_f32_16x16x32_bf16 v[56:59], a[32:35], a[20:23], v[56:59]
ds_read_b128 a[68:71], v7 offset:2048
v_mfma_f32_16x16x32_bf16 v[64:67], a[32:35], a[24:27], v[64:67]
buffer_load_dwordx4 v2, s[8:11], s28 offen lds
v_mfma_f32_16x16x32_bf16 v[72:75], a[32:35], a[28:31], v[72:75]
ds_read_b128 a[72:75], v7 offset:4096
v_mfma_f32_16x16x32_bf16 v[20:23], a[36:39], a[0:3], v[20:23]
s_add_u32 s28, s28, s29
v_mfma_f32_16x16x32_bf16 v[28:31], a[36:39], a[4:7], v[28:31]
ds_read_b128 a[76:79], v7 offset:6144
s_add_u32 m0, s34, 24576
v_mfma_f32_16x16x32_bf16 v[36:39], a[36:39], a[8:11], v[36:39]
ds_read_b128 a[80:83], v7 offset:8192
v_mfma_f32_16x16x32_bf16 v[44:47], a[36:39], a[12:15], v[44:47]
buffer_load_dwordx4 v2, s[8:11], s28 offen lds
v_mfma_f32_16x16x32_bf16 v[52:55], a[36:39], a[16:19], v[52:55]
ds_read_b128 a[84:87], v7 offset:10240
v_mfma_f32_16x16x32_bf16 v[60:63], a[36:39], a[20:23], v[60:63]
s_add_u32 s28, s28, s29
v_mfma_f32_16x16x32_bf16 v[68:71], a[36:39], a[24:27], v[68:71]
ds_read_b128 a[88:91], v7 offset:12288
s_add_u32 m0, s34, 28672
v_mfma_f32_16x16x32_bf16 v[76:79], a[36:39], a[28:31], v[76:79]
ds_read_b128 a[92:95], v7 offset:14336
v_mfma_f32_16x16x32_bf16 v[80:83], a[40:43], a[0:3], v[80:83]
buffer_load_dwordx4 v2, s[8:11], s28 offen lds
v_mfma_f32_16x16x32_bf16 v[88:91], a[40:43], a[4:7], v[88:91]
ds_read_b64_tr_b16 a[100:101], v9 offset:49152
v_mfma_f32_16x16x32_bf16 v[96:99], a[40:43], a[8:11], v[96:99]
ds_read_b64_tr_b16 a[102:103], v9 offset:50176
s_add_u32 s28, s28, s30
v_mfma_f32_16x16x32_bf16 v[104:107], a[40:43], a[12:15], v[104:107]
s_add_u32 s34, s34, 32768
v_mfma_f32_16x16x32_bf16 v[112:115], a[40:43], a[16:19], v[112:115]
ds_read_b64_tr_b16 a[104:105], v10 offset:49152
v_mfma_f32_16x16x32_bf16 v[120:123], a[40:43], a[20:23], v[120:123]
s_cmp_ge_u32 s34, s36
v_mfma_f32_16x16x32_bf16 v[128:131], a[40:43], a[24:27], v[128:131]
ds_read_b64_tr_b16 a[106:107], v10 offset:50176
v_mfma_f32_16x16x32_bf16 v[136:139], a[40:43], a[28:31], v[136:139]
ds_read_b64_tr_b16 a[108:109], v11 offset:49152
s_cselect_b32 s34, s35, s34
v_mfma_f32_16x16x32_bf16 v[84:87], a[44:47], a[0:3], v[84:87]
s_add_u32 m0, s43, 32768
v_mfma_f32_16x16x32_bf16 v[92:95], a[44:47], a[4:7], v[92:95]
ds_read_b64_tr_b16 a[110:111], v11 offset:50176
v_mfma_f32_16x16x32_bf16 v[100:103], a[44:47], a[8:11], v[100:103]
buffer_load_dwordx4 v3, s[12:15], s31 offen lds
v_mfma_f32_16x16x32_bf16 v[108:111], a[44:47], a[12:15], v[108:111]
ds_read_b64_tr_b16 a[112:113], v8 offset:57344
v_mfma_f32_16x16x32_bf16 v[116:119], a[44:47], a[16:19], v[116:119]
ds_read_b64_tr_b16 a[114:115], v8 offset:58368
s_add_u32 s31, s31, s32
v_mfma_f32_16x16x32_bf16 v[124:127], a[44:47], a[20:23], v[124:127]
s_add_u32 m0, s43, 33792
v_mfma_f32_16x16x32_bf16 v[132:135], a[44:47], a[24:27], v[132:135]
ds_read_b64_tr_b16 a[116:117], v9 offset:57344
v_mfma_f32_16x16x32_bf16 v[140:143], a[44:47], a[28:31], v[140:143]
ds_read_b64_tr_b16 a[118:119], v9 offset:58368
buffer_load_dwordx4 v3, s[12:15], s31 offen lds
v_mfma_f32_16x16x32_bf16 v[144:147], a[48:51], a[0:3], v[144:147]
v_mfma_f32_16x16x32_bf16 v[152:155], a[48:51], a[4:7], v[152:155]
ds_read_b64_tr_b16 a[120:121], v10 offset:57344
s_add_u32 s31, s31, s33
v_mfma_f32_16x16x32_bf16 v[160:163], a[48:51], a[8:11], v[160:163]
s_add_u32 m0, s43, 36864
v_mfma_f32_16x16x32_bf16 v[168:171], a[48:51], a[12:15], v[168:171]
ds_read_b64_tr_b16 a[122:123], v10 offset:58368
v_mfma_f32_16x16x32_bf16 v[176:179], a[48:51], a[16:19], v[176:179]
ds_read_b64_tr_b16 a[124:125], v11 offset:57344
buffer_load_dwordx4 v3, s[12:15], s31 offen lds
v_mfma_f32_16x16x32_bf16 v[184:187], a[48:51], a[20:23], v[184:187]
v_mfma_f32_16x16x32_bf16 v[192:195], a[48:51], a[24:27], v[192:195]
ds_read_b64_tr_b16 a[126:127], v11 offset:58368
s_add_u32 s31, s31, s32
v_mfma_f32_16x16x32_bf16 v[200:203], a[48:51], a[28:31], v[200:203]
s_add_u32 m0, s43, 37888
v_mfma_f32_16x16x32_bf16 v[148:151], a[52:55], a[0:3], v[148:151]
v_mfma_f32_16x16x32_bf16 v[156:159], a[52:55], a[4:7], v[156:159]
buffer_load_dwordx4 v3, s[12:15], s31 offen lds
v_mfma_f32_16x16x32_bf16 v[164:167], a[52:55], a[8:11], v[164:167]
v_mfma_f32_16x16x32_bf16 v[172:175], a[52:55], a[12:15], v[172:175]
s_add_u32 s31, s31, s33
v_mfma_f32_16x16x32_bf16 v[180:183], a[52:55], a[16:19], v[180:183]
s_add_u32 s38, s38, 32768
v_mfma_f32_16x16x32_bf16 v[188:191], a[52:55], a[20:23], v[188:191]
v_mfma_f32_16x16x32_bf16 v[196:199], a[52:55], a[24:27], v[196:199]
s_cmp_ge_u32 s38, s42
v_mfma_f32_16x16x32_bf16 v[204:207], a[52:55], a[28:31], v[204:207]
v_mfma_f32_16x16x32_bf16 v[208:211], a[56:59], a[0:3], v[208:211]
s_cselect_b32 s38, s41, s38
v_mfma_f32_16x16x32_bf16 v[216:219], a[56:59], a[4:7], v[216:219]
s_add_u32 s40, s45, 24576
v_mfma_f32_16x16x32_bf16 v[224:227], a[56:59], a[8:11], v[224:227]
v_mfma_f32_16x16x32_bf16 v[232:235], a[56:59], a[12:15], v[232:235]
buffer_store_dwordx4 a[192:195], v12, s[4:7], s40 offen sc1
v_mfma_f32_16x16x32_bf16 v[240:243], a[56:59], a[16:19], v[240:243]
v_mfma_f32_16x16x32_bf16 v[248:251], a[56:59], a[20:23], v[248:251]
s_add_u32 s40, s45, 25600
v_mfma_f32_16x16x32_bf16 a[128:131], a[56:59], a[24:27], a[128:131]
buffer_store_dwordx4 a[196:199], v12, s[4:7], s40 offen sc1
v_mfma_f32_16x16x32_bf16 a[136:139], a[56:59], a[28:31], a[136:139]
v_mfma_f32_16x16x32_bf16 v[212:215], a[60:63], a[0:3], v[212:215]
s_add_u32 s40, s45, 28672
v_mfma_f32_16x16x32_bf16 v[220:223], a[60:63], a[4:7], v[220:223]
v_mfma_f32_16x16x32_bf16 v[228:231], a[60:63], a[8:11], v[228:231]
buffer_store_dwordx4 a[200:203], v12, s[4:7], s40 offen sc1
v_mfma_f32_16x16x32_bf16 v[236:239], a[60:63], a[12:15], v[236:239]
s_add_u32 s40, s45, 29696
v_mfma_f32_16x16x32_bf16 v[244:247], a[60:63], a[16:19], v[244:247]
v_mfma_f32_16x16x32_bf16 v[252:255], a[60:63], a[20:23], v[252:255]
buffer_store_dwordx4 a[204:207], v12, s[4:7], s40 offen sc1
v_mfma_f32_16x16x32_bf16 a[132:135], a[60:63], a[24:27], a[132:135]
v_mfma_f32_16x16x32_bf16 a[140:143], a[60:63], a[28:31], a[140:143]
s_waitcnt vmcnt(28) lgkmcnt(0)
s_barrier
v_mfma_f32_16x16x32_bf16 v[16:19], a[96:99], a[64:67], v[16:19]
v_add_u32 v6, s37, v4
s_add_u32 m0, s34, 0
v_mfma_f32_16x16x32_bf16 v[24:27], a[96:99], a[68:71], v[24:27]
ds_read_b64_tr_b16 a[32:33], v8 offset:0
buffer_load_dwordx4 v2, s[8:11], s28 offen lds
v_mfma_f32_16x16x32_bf16 v[32:35], a[96:99], a[72:75], v[32:35]
ds_read_b64_tr_b16 a[34:35], v8 offset:1024
v_mfma_f32_16x16x32_bf16 v[40:43], a[96:99], a[76:79], v[40:43]
s_add_u32 s28, s28, s29
v_mfma_f32_16x16x32_bf16 v[48:51], a[96:99], a[80:83], v[48:51]
ds_read_b128 a[0:3], v6 offset:0
v_mfma_f32_16x16x32_bf16 v[56:59], a[96:99], a[84:87], v[56:59]
ds_read_b128 a[4:7], v6 offset:2048
s_add_u32 m0, s34, 4096
v_mfma_f32_16x16x32_bf16 v[64:67], a[96:99], a[88:91], v[64:67]
v_mfma_f32_16x16x32_bf16 v[72:75], a[96:99], a[92:95], v[72:75]
ds_read_b128 a[8:11], v6 offset:4096
buffer_load_dwordx4 v2, s[8:11], s28 offen lds
v_mfma_f32_16x16x32_bf16 v[20:23], a[100:103], a[64:67], v[20:23]
v_mfma_f32_16x16x32_bf16 v[28:31], a[100:103], a[68:71], v[28:31]
ds_read_b128 a[12:15], v6 offset:6144
s_add_u32 s28, s28, s29
v_mfma_f32_16x16x32_bf16 v[36:39], a[100:103], a[72:75], v[36:39]
ds_read_b128 a[16:19], v6 offset:8192
s_add_u32 m0, s34, 8192
v_mfma_f32_16x16x32_bf16 v[44:47], a[100:103], a[76:79], v[44:47]
v_mfma_f32_16x16x32_bf16 v[52:55], a[100:103], a[80:83], v[52:55]
ds_read_b128 a[20:23], v6 offset:10240
buffer_load_dwordx4 v2, s[8:11], s28 offen lds
v_mfma_f32_16x16x32_bf16 v[60:63], a[100:103], a[84:87], v[60:63]
v_mfma_f32_16x16x32_bf16 v[68:71], a[100:103], a[88:91], v[68:71]
ds_read_b128 a[24:27], v6 offset:12288
s_add_u32 s28, s28, s29
v_mfma_f32_16x16x32_bf16 v[76:79], a[100:103], a[92:95], v[76:79]
ds_read_b128 a[28:31], v6 offset:14336
v_mfma_f32_16x16x32_bf16 v[80:83], a[104:107], a[64:67], v[80:83]
s_add_u32 m0, s34, 12288
v_mfma_f32_16x16x32_bf16 v[88:91], a[104:107], a[68:71], v[88:91]
ds_read_b64_tr_b16 a[36:37], v9 offset:0
v_mfma_f32_16x16x32_bf16 v[96:99], a[104:107], a[72:75], v[96:99]
ds_read_b64_tr_b16 a[38:39], v9 offset:1024
buffer_load_dwordx4 v2, s[8:11], s28 offen lds
v_mfma_f32_16x16x32_bf16 v[104:107], a[104:107], a[76:79], v[104:107]
s_add_u32 s28, s28, s29
v_mfma_f32_16x16x32_bf16 v[112:115], a[104:107], a[80:83], v[112:115]
ds_read_b64_tr_b16 a[40:41], v10 offset:0
v_mfma_f32_16x16x32_bf16 v[120:123], a[104:107], a[84:87], v[120:123]
s_add_u32 m0, s43, 49152
v_mfma_f32_16x16x32_bf16 v[128:131], a[104:107], a[88:91], v[128:131]
ds_read_b64_tr_b16 a[42:43], v10 offset:1024
v_mfma_f32_16x16x32_bf16 v[136:139], a[104:107], a[92:95], v[136:139]
ds_read_b64_tr_b16 a[44:45], v11 offset:0
buffer_load_dwordx4 v3, s[12:15], s31 offen lds
v_mfma_f32_16x16x32_bf16 v[84:87], a[108:111], a[64:67], v[84:87]
v_mfma_f32_16x16x32_bf16 v[92:95], a[108:111], a[68:71], v[92:95]
ds_read_b64_tr_b16 a[46:47], v11 offset:1024
s_add_u32 s31, s31, s32
v_mfma_f32_16x16x32_bf16 v[100:103], a[108:111], a[72:75], v[100:103]
v_mfma_f32_16x16x32_bf16 v[108:111], a[108:111], a[76:79], v[108:111]
ds_read_b64_tr_b16 a[48:49], v8 offset:8192
s_add_u32 m0, s43, 50176
v_mfma_f32_16x16x32_bf16 v[116:119], a[108:111], a[80:83], v[116:119]
ds_read_b64_tr_b16 a[50:51], v8 offset:9216
buffer_load_dwordx4 v3, s[12:15], s31 offen lds
v_mfma_f32_16x16x32_bf16 v[124:127], a[108:111], a[84:87], v[124:127]
v_mfma_f32_16x16x32_bf16 v[132:135], a[108:111], a[88:91], v[132:135]
ds_read_b64_tr_b16 a[52:53], v9 offset:8192
s_add_u32 s31, s31, s33
v_mfma_f32_16x16x32_bf16 v[140:143], a[108:111], a[92:95], v[140:143]
ds_read_b64_tr_b16 a[54:55], v9 offset:9216
v_mfma_f32_16x16x32_bf16 v[144:147], a[112:115], a[64:67], v[144:147]
s_add_u32 m0, s43, 53248
v_mfma_f32_16x16x32_bf16 v[152:155], a[112:115], a[68:71], v[152:155]
ds_read_b64_tr_b16 a[56:57], v10 offset:8192
v_mfma_f32_16x16x32_bf16 v[160:163], a[112:115], a[72:75], v[160:163]
buffer_load_dwordx4 v3, s[12:15], s31 offen lds
v_mfma_f32_16x16x32_bf16 v[168:171], a[112:115], a[76:79], v[168:171]
ds_read_b64_tr_b16 a[58:59], v10 offset:9216
v_mfma_f32_16x16x32_bf16 v[176:179], a[112:115], a[80:83], v[176:179]
ds_read_b64_tr_b16 a[60:61], v11 offset:8192
s_add_u32 s31, s31, s32
v_mfma_f32_16x16x32_bf16 v[184:187], a[112:115], a[84:87], v[184:187]
s_add_u32 m0, s43, 54272
v_mfma_f32_16x16x32_bf16 v[192:195], a[112:115], a[88:91], v[192:195]
ds_read_b64_tr_b16 a[62:63], v11 offset:9216
v_mfma_f32_16x16x32_bf16 v[200:203], a[112:115], a[92:95], v[200:203]
buffer_load_dwordx4 v3, s[12:15], s31 offen lds
v_mfma_f32_16x16x32_bf16 v[148:151], a[116:119], a[64:67], v[148:151]
v_mfma_f32_16x16x32_bf16 v[156:159], a[116:119], a[68:71], v[156:159]
s_add_u32 s31, s31, s33
v_mfma_f32_16x16x32_bf16 v[164:167], a[116:119], a[72:75], v[164:167]
v_mfma_f32_16x16x32_bf16 v[172:175], a[116:119], a[76:79], v[172:175]
s_add_u32 s37, s37, 32768
v_mfma_f32_16x16x32_bf16 v[180:183], a[116:119], a[80:83], v[180:183]
v_mfma_f32_16x16x32_bf16 v[188:191], a[116:119], a[84:87], v[188:191]
s_cmp_ge_u32 s37, s42
v_mfma_f32_16x16x32_bf16 v[196:199], a[116:119], a[88:91], v[196:199]
s_cselect_b32 s37, s41, s37
v_mfma_f32_16x16x32_bf16 v[204:207], a[116:119], a[92:95], v[204:207]
v_mfma_f32_16x16x32_bf16 v[208:211], a[120:123], a[64:67], v[208:211]
s_add_u32 s40, s45, 32768
v_mfma_f32_16x16x32_bf16 v[216:219], a[120:123], a[68:71], v[216:219]
v_mfma_f32_16x16x32_bf16 v[224:227], a[120:123], a[72:75], v[224:227]
buffer_store_dwordx4 a[208:211], v12, s[4:7], s40 offen sc1
v_mfma_f32_16x16x32_bf16 v[232:235], a[120:123], a[76:79], v[232:235]
v_mfma_f32_16x16x32_bf16 v[240:243], a[120:123], a[80:83], v[240:243]
s_add_u32 s40, s45, 33792
v_mfma_f32_16x16x32_bf16 v[248:251], a[120:123], a[84:87], v[248:251]
v_mfma_f32_16x16x32_bf16 a[128:131], a[120:123], a[88:91], a[128:131]
buffer_store_dwordx4 a[212:215], v12, s[4:7], s40 offen sc1
v_mfma_f32_16x16x32_bf16 a[136:139], a[120:123], a[92:95], a[136:139]
s_add_u32 s40, s45, 36864
v_mfma_f32_16x16x32_bf16 v[212:215], a[124:127], a[64:67], v[212:215]
v_mfma_f32_16x16x32_bf16 v[220:223], a[124:127], a[68:71], v[220:223]
buffer_store_dwordx4 a[216:219], v12, s[4:7], s40 offen sc1
v_mfma_f32_16x16x32_bf16 v[228:231], a[124:127], a[72:75], v[228:231]
v_mfma_f32_16x16x32_bf16 v[236:239], a[124:127], a[76:79], v[236:239]
s_add_u32 s40, s45, 37888
v_mfma_f32_16x16x32_bf16 v[244:247], a[124:127], a[80:83], v[244:247]
v_mfma_f32_16x16x32_bf16 v[252:255], a[124:127], a[84:87], v[252:255]
buffer_store_dwordx4 a[220:223], v12, s[4:7], s40 offen sc1
v_mfma_f32_16x16x32_bf16 a[132:135], a[124:127], a[88:91], a[132:135]
v_mfma_f32_16x16x32_bf16 a[140:143], a[124:127], a[92:95], a[140:143]
s_waitcnt vmcnt(28) lgkmcnt(0)
s_barrier
v_mfma_f32_16x16x32_bf16 v[16:19], a[32:35], a[0:3], v[16:19]
v_add_u32 v7, s38, v5
s_add_u32 m0, s34, 16384
v_mfma_f32_16x16x32_bf16 v[24:27], a[32:35], a[4:7], v[24:27]
ds_read_b64_tr_b16 a[96:97], v8 offset:16384
buffer_load_dwordx4 v2, s[8:11], s28 offen lds
v_mfma_f32_16x16x32_bf16 v[32:35], a[32:35], a[8:11], v[32:35]
ds_read_b64_tr_b16 a[98:99], v8 offset:17408
v_mfma_f32_16x16x32_bf16 v[40:43], a[32:35], a[12:15], v[40:43]
s_add_u32 s28, s28, s29
v_mfma_f32_16x16x32_bf16 v[48:51], a[32:35], a[16:19], v[48:51]
ds_read_b128 a[64:67], v7 offset:0
s_add_u32 m0, s34, 20480
v_mfma_f32_16x16x32_bf16 v[56:59], a[32:35], a[20:23], v[56:59]
ds_read_b128 a[68:71], v7 offset:2048
v_mfma_f32_16x16x32_bf16 v[64:67], a[32:35], a[24:27], v[64:67]
buffer_load_dwordx4 v2, s[8:11], s28 offen lds
v_mfma_f32_16x16x32_bf16 v[72:75], a[32:35], a[28:31], v[72:75]
ds_read_b128 a[72:75], v7 offset:4096
v_mfma_f32_16x16x32_bf16 v[20:23], a[36:39], a[0:3], v[20:23]
s_add_u32 s28, s28, s29
v_mfma_f32_16x16x32_bf16 v[28:31], a[36:39], a[4:7], v[28:31]
ds_read_b128 a[76:79], v7 offset:6144
s_add_u32 m0, s34, 24576
v_mfma_f32_16x16x32_bf16 v[36:39], a[36:39], a[8:11], v[36:39]
ds_read_b128 a[80:83], v7 offset:8192
v_mfma_f32_16x16x32_bf16 v[44:47], a[36:39], a[12:15], v[44:47]
buffer_load_dwordx4 v2, s[8:11], s28 offen lds
v_mfma_f32_16x16x32_bf16 v[52:55], a[36:39], a[16:19], v[52:55]
ds_read_b128 a[84:87], v7 offset:10240
v_mfma_f32_16x16x32_bf16 v[60:63], a[36:39], a[20:23], v[60:63]
s_add_u32 s28, s28, s29
v_mfma_f32_16x16x32_bf16 v[68:71], a[36:39], a[24:27], v[68:71]
ds_read_b128 a[88:91], v7 offset:12288
s_add_u32 m0, s34, 28672
v_mfma_f32_16x16x32_bf16 v[76:79], a[36:39], a[28:31], v[76:79]
ds_read_b128 a[92:95], v7 offset:14336
v_mfma_f32_16x16x32_bf16 v[80:83], a[40:43], a[0:3], v[80:83]
buffer_load_dwordx4 v2, s[8:11], s28 offen lds
v_mfma_f32_16x16x32_bf16 v[88:91], a[40:43], a[4:7], v[88:91]
ds_read_b64_tr_b16 a[100:101], v9 offset:16384
v_mfma_f32_16x16x32_bf16 v[96:99], a[40:43], a[8:11], v[96:99]
ds_read_b64_tr_b16 a[102:103], v9 offset:17408
s_add_u32 s28, s28, s30
v_mfma_f32_16x16x32_bf16 v[104:107], a[40:43], a[12:15], v[104:107]
s_add_u32 s34, s34, 32768
v_mfma_f32_16x16x32_bf16 v[112:115], a[40:43], a[16:19], v[112:115]
ds_read_b64_tr_b16 a[104:105], v10 offset:16384
v_mfma_f32_16x16x32_bf16 v[120:123], a[40:43], a[20:23], v[120:123]
s_cmp_ge_u32 s34, s36
v_mfma_f32_16x16x32_bf16 v[128:131], a[40:43], a[24:27], v[128:131]
ds_read_b64_tr_b16 a[106:107], v10 offset:17408
v_mfma_f32_16x16x32_bf16 v[136:139], a[40:43], a[28:31], v[136:139]
ds_read_b64_tr_b16 a[108:109], v11 offset:16384
s_cselect_b32 s34, s35, s34
v_mfma_f32_16x16x32_bf16 v[84:87], a[44:47], a[0:3], v[84:87]
s_add_u32 m0, s43, 0
v_mfma_f32_16x16x32_bf16 v[92:95], a[44:47], a[4:7], v[92:95]
ds_read_b64_tr_b16 a[110:111], v11 offset:17408
v_mfma_f32_16x16x32_bf16 v[100:103], a[44:47], a[8:11], v[100:103]
buffer_load_dwordx4 v3, s[12:15], s31 offen lds
v_mfma_f32_16x16x32_bf16 v[108:111], a[44:47], a[12:15], v[108:111]
ds_read_b64_tr_b16 a[112:113], v8 offset:24576
v_mfma_f32_16x16x32_bf16 v[116:119], a[44:47], a[16:19], v[116:119]
ds_read_b64_tr_b16 a[114:115], v8 offset:25600
s_add_u32 s31, s31, s32
v_mfma_f32_16x16x32_bf16 v[124:127], a[44:47], a[20:23], v[124:127]
s_add_u32 m0, s43, 1024
v_mfma_f32_16x16x32_bf16 v[132:135], a[44:47], a[24:27], v[132:135]
ds_read_b64_tr_b16 a[116:117], v9 offset:24576
v_mfma_f32_16x16x32_bf16 v[140:143], a[44:47], a[28:31], v[140:143]
ds_read_b64_tr_b16 a[118:119], v9 offset:25600
buffer_load_dwordx4 v3, s[12:15], s31 offen lds
v_mfma_f32_16x16x32_bf16 v[144:147], a[48:51], a[0:3], v[144:147]
v_mfma_f32_16x16x32_bf16 v[152:155], a[48:51], a[4:7], v[152:155]
ds_read_b64_tr_b16 a[120:121], v10 offset:24576
s_add_u32 s31, s31, s33
v_mfma_f32_16x16x32_bf16 v[160:163], a[48:51], a[8:11], v[160:163]
s_add_u32 m0, s43, 4096
v_mfma_f32_16x16x32_bf16 v[168:171], a[48:51], a[12:15], v[168:171]
ds_read_b64_tr_b16 a[122:123], v10 offset:25600
v_mfma_f32_16x16x32_bf16 v[176:179], a[48:51], a[16:19], v[176:179]
ds_read_b64_tr_b16 a[124:125], v11 offset:24576
buffer_load_dwordx4 v3, s[12:15], s31 offen lds
v_mfma_f32_16x16x32_bf16 v[184:187], a[48:51], a[20:23], v[184:187]
v_mfma_f32_16x16x32_bf16 v[192:195], a[48:51], a[24:27], v[192:195]
ds_read_b64_tr_b16 a[126:127], v11 offset:25600
s_add_u32 s31, s31, s32
v_mfma_f32_16x16x32_bf16 v[200:203], a[48:51], a[28:31], v[200:203]
s_add_u32 m0, s43, 5120
v_mfma_f32_16x16x32_bf16 v[148:151], a[52:55], a[0:3], v[148:151]
v_mfma_f32_16x16x32_bf16 v[156:159], a[52:55], a[4:7], v[156:159]
buffer_load_dwordx4 v3, s[12:15], s31 offen lds
v_mfma_f32_16x16x32_bf16 v[164:167], a[52:55], a[8:11], v[164:167]
v_mfma_f32_16x16x32_bf16 v[172:175], a[52:55], a[12:15], v[172:175]
s_add_u32 s31, s31, s33
v_mfma_f32_16x16x32_bf16 v[180:183], a[52:55], a[16:19], v[180:183]
s_add_u32 s38, s38, 32768
v_mfma_f32_16x16x32_bf16 v[188:191], a[52:55], a[20:23], v[188:191]
v_mfma_f32_16x16x32_bf16 v[196:199], a[52:55], a[24:27], v[196:199]
s_cmp_ge_u32 s38, s42
v_mfma_f32_16x16x32_bf16 v[204:207], a[52:55], a[28:31], v[204:207]
v_mfma_f32_16x16x32_bf16 v[208:211], a[56:59], a[0:3], v[208:211]
s_cselect_b32 s38, s41, s38
v_mfma_f32_16x16x32_bf16 v[216:219], a[56:59], a[4:7], v[216:219]
s_add_u32 s40, s45, 40960
v_mfma_f32_16x16x32_bf16 v[224:227], a[56:59], a[8:11], v[224:227]
v_mfma_f32_16x16x32_bf16 v[232:235], a[56:59], a[12:15], v[232:235]
buffer_store_dwordx4 a[224:227], v12, s[4:7], s40 offen sc1
v_mfma_f32_16x16x32_bf16 v[240:243], a[56:59], a[16:19], v[240:243]
v_mfma_f32_16x16x32_bf16 v[248:251], a[56:59], a[20:23], v[248:251]
s_add_u32 s40, s45, 41984
v_mfma_f32_16x16x32_bf16 a[128:131], a[56:59], a[24:27], a[128:131]
buffer_store_dwordx4 a[228:231], v12, s[4:7], s40 offen sc1
v_mfma_f32_16x16x32_bf16 a[136:139], a[56:59], a[28:31], a[136:139]
v_mfma_f32_16x16x32_bf16 v[212:215], a[60:63], a[0:3], v[212:215]
s_add_u32 s40, s45, 45056
v_mfma_f32_16x16x32_bf16 v[220:223], a[60:63], a[4:7], v[220:223]
v_mfma_f32_16x16x32_bf16 v[228:231], a[60:63], a[8:11], v[228:231]
buffer_store_dwordx4 a[232:235], v12, s[4:7], s40 offen sc1
v_mfma_f32_16x16x32_bf16 v[236:239], a[60:63], a[12:15], v[236:239]
s_add_u32 s40, s45, 46080
v_mfma_f32_16x16x32_bf16 v[244:247], a[60:63], a[16:19], v[244:247]
v_mfma_f32_16x16x32_bf16 v[252:255], a[60:63], a[20:23], v[252:255]
buffer_store_dwordx4 a[236:239], v12, s[4:7], s40 offen sc1
v_mfma_f32_16x16x32_bf16 a[132:135], a[60:63], a[24:27], a[132:135]
v_mfma_f32_16x16x32_bf16 a[140:143], a[60:63], a[28:31], a[140:143]
s_waitcnt vmcnt(28) lgkmcnt(0)
s_barrier
v_mfma_f32_16x16x32_bf16 v[16:19], a[96:99], a[64:67], v[16:19]
v_add_u32 v6, s37, v4
s_add_u32 m0, s34, 0
v_mfma_f32_16x16x32_bf16 v[24:27], a[96:99], a[68:71], v[24:27]
ds_read_b64_tr_b16 a[32:33], v8 offset:32768
buffer_load_dwordx4 v2, s[8:11], s28 offen lds
v_mfma_f32_16x16x32_bf16 v[32:35], a[96:99], a[72:75], v[32:35]
ds_read_b64_tr_b16 a[34:35], v8 offset:33792
v_mfma_f32_16x16x32_bf16 v[40:43], a[96:99], a[76:79], v[40:43]
s_add_u32 s28, s28, s29
v_mfma_f32_16x16x32_bf16 v[48:51], a[96:99], a[80:83], v[48:51]
ds_read_b128 a[0:3], v6 offset:0
v_mfma_f32_16x16x32_bf16 v[56:59], a[96:99], a[84:87], v[56:59]
ds_read_b128 a[4:7], v6 offset:2048
s_add_u32 m0, s34, 4096
v_mfma_f32_16x16x32_bf16 v[64:67], a[96:99], a[88:91], v[64:67]
v_mfma_f32_16x16x32_bf16 v[72:75], a[96:99], a[92:95], v[72:75]
ds_read_b128 a[8:11], v6 offset:4096
buffer_load_dwordx4 v2, s[8:11], s28 offen lds
v_mfma_f32_16x16x32_bf16 v[20:23], a[100:103], a[64:67], v[20:23]
v_mfma_f32_16x16x32_bf16 v[28:31], a[100:103], a[68:71], v[28:31]
ds_read_b128 a[12:15], v6 offset:6144
s_add_u32 s28, s28, s29
v_mfma_f32_16x16x32_bf16 v[36:39], a[100:103], a[72:75], v[36:39]
ds_read_b128 a[16:19], v6 offset:8192
s_add_u32 m0, s34, 8192
v_mfma_f32_16x16x32_bf16 v[44:47], a[100:103], a[76:79], v[44:47]
v_mfma_f32_16x16x32_bf16 v[52:55], a[100:103], a[80:83], v[52:55]
ds_read_b128 a[20:23], v6 offset:10240
buffer_load_dwordx4 v2, s[8:11], s28 offen lds
v_mfma_f32_16x16x32_bf16 v[60:63], a[100:103], a[84:87], v[60:63]
v_mfma_f32_16x16x32_bf16 v[68:71], a[100:103], a[88:91], v[68:71]
ds_read_b128 a[24:27], v6 offset:12288
s_add_u32 s28, s28, s29
v_mfma_f32_16x16x32_bf16 v[76:79], a[100:103], a[92:95], v[76:79]
ds_read_b128 a[28:31], v6 offset:14336
v_mfma_f32_16x16x32_bf16 v[80:83], a[104:107], a[64:67], v[80:83]
s_add_u32 m0, s34, 12288
v_mfma_f32_16x16x32_bf16 v[88:91], a[104:107], a[68:71], v[88:91]
ds_read_b64_tr_b16 a[36:37], v9 offset:32768
v_mfma_f32_16x16x32_bf16 v[96:99], a[104:107], a[72:75], v[96:99]
ds_read_b64_tr_b16 a[38:39], v9 offset:33792
buffer_load_dwordx4 v2, s[8:11], s28 offen lds
v_mfma_f32_16x16x32_bf16 v[104:107], a[104:107], a[76:79], v[104:107]
s_add_u32 s28, s28, s29
v_mfma_f32_16x16x32_bf16 v[112:115], a[104:107], a[80:83], v[112:115]
ds_read_b64_tr_b16 a[40:41], v10 offset:32768
v_mfma_f32_16x16x32_bf16 v[120:123], a[104:107], a[84:87], v[120:123]
s_add_u32 m0, s43, 16384
v_mfma_f32_16x16x32_bf16 v[128:131], a[104:107], a[88:91], v[128:131]
ds_read_b64_tr_b16 a[42:43], v10 offset:33792
v_mfma_f32_16x16x32_bf16 v[136:139], a[104:107], a[92:95], v[136:139]
ds_read_b64_tr_b16 a[44:45], v11 offset:32768
buffer_load_dwordx4 v3, s[12:15], s31 offen lds
v_mfma_f32_16x16x32_bf16 v[84:87], a[108:111], a[64:67], v[84:87]
v_mfma_f32_16x16x32_bf16 v[92:95], a[108:111], a[68:71], v[92:95]
ds_read_b64_tr_b16 a[46:47], v11 offset:33792
s_add_u32 s31, s31, s32
v_mfma_f32_16x16x32_bf16 v[100:103], a[108:111], a[72:75], v[100:103]
v_mfma_f32_16x16x32_bf16 v[108:111], a[108:111], a[76:79], v[108:111]
ds_read_b64_tr_b16 a[48:49], v8 offset:40960
s_add_u32 m0, s43, 17408
v_mfma_f32_16x16x32_bf16 v[116:119], a[108:111], a[80:83], v[116:119]
ds_read_b64_tr_b16 a[50:51], v8 offset:41984
buffer_load_dwordx4 v3, s[12:15], s31 offen lds
v_mfma_f32_16x16x32_bf16 v[124:127], a[108:111], a[84:87], v[124:127]
v_mfma_f32_16x16x32_bf16 v[132:135], a[108:111], a[88:91], v[132:135]
ds_read_b64_tr_b16 a[52:53], v9 offset:40960
s_add_u32 s31, s31, s33
v_mfma_f32_16x16x32_bf16 v[140:143], a[108:111], a[92:95], v[140:143]
ds_read_b64_tr_b16 a[54:55], v9 offset:41984
v_mfma_f32_16x16x32_bf16 v[144:147], a[112:115], a[64:67], v[144:147]
s_add_u32 m0, s43, 20480
v_mfma_f32_16x16x32_bf16 v[152:155], a[112:115], a[68:71], v[152:155]
ds_read_b64_tr_b16 a[56:57], v10 offset:40960
v_mfma_f32_16x16x32_bf16 v[160:163], a[112:115], a[72:75], v[160:163]
buffer_load_dwordx4 v3, s[12:15], s31 offen lds
v_mfma_f32_16x16x32_bf16 v[168:171], a[112:115], a[76:79], v[168:171]
ds_read_b64_tr_b16 a[58:59], v10 offset:41984
v_mfma_f32_16x16x32_bf16 v[176:179], a[112:115], a[80:83], v[176:179]
ds_read_b64_tr_b16 a[60:61], v11 offset:40960
s_add_u32 s31, s31, s32
v_mfma_f32_16x16x32_bf16 v[184:187], a[112:115], a[84:87], v[184:187]
s_add_u32 m0, s43, 21504
v_mfma_f32_16x16x32_bf16 v[192:195], a[112:115], a[88:91], v[192:195]
ds_read_b64_tr_b16 a[62:63], v11 offset:41984
v_mfma_f32_16x16x32_bf16 v[200:203], a[112:115], a[92:95], v[200:203]
buffer_load_dwordx4 v3, s[12:15], s31 offen lds
v_mfma_f32_16x16x32_bf16 v[148:151], a[116:119], a[64:67], v[148:151]
v_mfma_f32_16x16x32_bf16 v[156:159], a[116:119], a[68:71], v[156:159]
s_add_u32 s31, s31, s33
v_mfma_f32_16x16x32_bf16 v[164:167], a[116:119], a[72:75], v[164:167]
v_mfma_f32_16x16x32_bf16 v[172:175], a[116:119], a[76:79], v[172:175]
s_add_u32 s37, s37, 32768
v_mfma_f32_16x16x32_bf16 v[180:183], a[116:119], a[80:83], v[180:183]
v_mfma_f32_16x16x32_bf16 v[188:191], a[116:119], a[84:87], v[188:191]
s_cmp_ge_u32 s37, s42
v_mfma_f32_16x16x32_bf16 v[196:199], a[116:119], a[88:91], v[196:199]
s_cselect_b32 s37, s41, s37
v_mfma_f32_16x16x32_bf16 v[204:207], a[116:119], a[92:95], v[204:207]
v_mfma_f32_16x16x32_bf16 v[208:211], a[120:123], a[64:67], v[208:211]
s_add_u32 s40, s45, 49152
v_mfma_f32_16x16x32_bf16 v[216:219], a[120:123], a[68:71], v[216:219]
v_mfma_f32_16x16x32_bf16 v[224:227], a[120:123], a[72:75], v[224:227]
buffer_store_dwordx4 a[240:243], v12, s[4:7], s40 offen sc1
v_mfma_f32_16x16x32_bf16 v[232:235], a[120:123], a[76:79], v[232:235]
v_mfma_f32_16x16x32_bf16 v[240:243], a[120:123], a[80:83], v[240:243]
s_add_u32 s40, s45, 50176
v_mfma_f32_16x16x32_bf16 v[248:251], a[120:123], a[84:87], v[248:251]
v_mfma_f32_16x16x32_bf16 a[128:131], a[120:123], a[88:91], a[128:131]
buffer_store_dwordx4 a[244:247], v12, s[4:7], s40 offen sc1
v_mfma_f32_16x16x32_bf16 a[136:139], a[120:123], a[92:95], a[136:139]
s_add_u32 s40, s45, 53248
v_mfma_f32_16x16x32_bf16 v[212:215], a[124:127], a[64:67], v[212:215]
v_mfma_f32_16x16x32_bf16 v[220:223], a[124:127], a[68:71], v[220:223]
buffer_store_dwordx4 a[248:251], v12, s[4:7], s40 offen sc1
v_mfma_f32_16x16x32_bf16 v[228:231], a[124:127], a[72:75], v[228:231]
v_mfma_f32_16x16x32_bf16 v[236:239], a[124:127], a[76:79], v[236:239]
s_add_u32 s40, s45, 54272
v_mfma_f32_16x16x32_bf16 v[244:247], a[124:127], a[80:83], v[244:247]
v_mfma_f32_16x16x32_bf16 v[252:255], a[124:127], a[84:87], v[252:255]
buffer_store_dwordx4 a[252:255], v12, s[4:7], s40 offen sc1
v_mfma_f32_16x16x32_bf16 a[132:135], a[124:127], a[88:91], a[132:135]
v_mfma_f32_16x16x32_bf16 a[140:143], a[124:127], a[92:95], a[140:143]
s_waitcnt vmcnt(28) lgkmcnt(0)
s_barrier
v_mfma_f32_16x16x32_bf16 v[16:19], a[32:35], a[0:3], v[16:19]
v_add_u32 v7, s38, v5
s_add_u32 m0, s34, 16384
v_mfma_f32_16x16x32_bf16 v[24:27], a[32:35], a[4:7], v[24:27]
ds_read_b64_tr_b16 a[96:97], v8 offset:49152
v_mfma_f32_16x16x32_bf16 v[32:35], a[32:35], a[8:11], v[32:35]
ds_read_b64_tr_b16 a[98:99], v8 offset:50176
buffer_load_dwordx4 v2, s[8:11], s28 offen lds
v_mfma_f32_16x16x32_bf16 v[40:43], a[32:35], a[12:15], v[40:43]
v_mfma_f32_16x16x32_bf16 v[48:51], a[32:35], a[16:19], v[48:51]
ds_read_b128 a[64:67], v7 offset:0
s_add_u32 s28, s28, s29
v_mfma_f32_16x16x32_bf16 v[56:59], a[32:35], a[20:23], v[56:59]
ds_read_b128 a[68:71], v7 offset:2048
v_mfma_f32_16x16x32_bf16 v[64:67], a[32:35], a[24:27], v[64:67]
s_add_u32 m0, s34, 20480
v_mfma_f32_16x16x32_bf16 v[72:75], a[32:35], a[28:31], v[72:75]
ds_read_b128 a[72:75], v7 offset:4096
v_mfma_f32_16x16x32_bf16 v[20:23], a[36:39], a[0:3], v[20:23]
buffer_load_dwordx4 v2, s[8:11], s28 offen lds
v_mfma_f32_16x16x32_bf16 v[28:31], a[36:39], a[4:7], v[28:31]
ds_read_b128 a[76:79], v7 offset:6144
v_mfma_f32_16x16x32_bf16 v[36:39], a[36:39], a[8:11], v[36:39]
ds_read_b128 a[80:83], v7 offset:8192
s_add_u32 s28, s28, s29
v_mfma_f32_16x16x32_bf16 v[44:47], a[36:39], a[12:15], v[44:47]
v_mfma_f32_16x16x32_bf16 v[52:55], a[36:39], a[16:19], v[52:55]
ds_read_b128 a[84:87], v7 offset:10240
s_add_u32 m0, s34, 24576
v_mfma_f32_16x16x32_bf16 v[60:63], a[36:39], a[20:23], v[60:63]
v_mfma_f32_16x16x32_bf16 v[68:71], a[36:39], a[24:27], v[68:71]
ds_read_b128 a[88:91], v7 offset:12288
buffer_load_dwordx4 v2, s[8:11], s28 offen lds
v_mfma_f32_16x16x32_bf16 v[76:79], a[36:39], a[28:31], v[76:79]
ds_read_b128 a[92:95], v7 offset:14336
v_mfma_f32_16x16x32_bf16 v[80:83], a[40:43], a[0:3], v[80:83]
s_add_u32 s28, s28, s29
v_mfma_f32_16x16x32_bf16 v[88:91], a[40:43], a[4:7], v[88:91]
ds_read_b64_tr_b16 a[100:101], v9 offset:49152
v_mfma_f32_16x16x32_bf16 v[96:99], a[40:43], a[8:11], v[96:99]
ds_read_b64_tr_b16 a[102:103], v9 offset:50176
s_add_u32 m0, s34, 28672
v_mfma_f32_16x16x32_bf16 v[104:107], a[40:43], a[12:15], v[104:107]
v_mfma_f32_16x16x32_bf16 v[112:115], a[40:43], a[16:19], v[112:115]
ds_read_b64_tr_b16 a[104:105], v10 offset:49152
v_mfma_f32_16x16x32_bf16 v[120:123], a[40:43], a[20:23], v[120:123]
buffer_load_dwordx4 v2, s[8:11], s28 offen lds
v_mfma_f32_16x16x32_bf16 v[128:131], a[40:43], a[24:27], v[128:131]
ds_read_b64_tr_b16 a[106:107], v10 offset:50176
v_mfma_f32_16x16x32_bf16 v[136:139], a[40:43], a[28:31], v[136:139]
ds_read_b64_tr_b16 a[108:109], v11 offset:49152
s_add_u32 s28, s28, s30
v_mfma_f32_16x16x32_bf16 v[84:87], a[44:47], a[0:3], v[84:87]
v_mfma_f32_16x16x32_bf16 v[92:95], a[44:47], a[4:7], v[92:95]
ds_read_b64_tr_b16 a[110:111], v11 offset:50176
s_add_u32 s34, s34, 32768
v_mfma_f32_16x16x32_bf16 v[100:103], a[44:47], a[8:11], v[100:103]
v_mfma_f32_16x16x32_bf16 v[108:111], a[44:47], a[12:15], v[108:111]
ds_read_b64_tr_b16 a[112:113], v8 offset:57344
s_cmp_ge_u32 s34, s36
v_mfma_f32_16x16x32_bf16 v[116:119], a[44:47], a[16:19], v[116:119]
ds_read_b64_tr_b16 a[114:115], v8 offset:58368
v_mfma_f32_16x16x32_bf16 v[124:127], a[44:47], a[20:23], v[124:127]
s_cselect_b32 s34, s35, s34
v_mfma_f32_16x16x32_bf16 v[132:135], a[44:47], a[24:27], v[132:135]
ds_read_b64_tr_b16 a[116:117], v9 offset:57344
v_mfma_f32_16x16x32_bf16 v[140:143], a[44:47], a[28:31], v[140:143]
ds_read_b64_tr_b16 a[118:119], v9 offset:58368
s_add_u32 m0, s43, 32768
v_mfma_f32_16x16x32_bf16 v[144:147], a[48:51], a[0:3], v[144:147]
v_mfma_f32_16x16x32_bf16 v[152:155], a[48:51], a[4:7], v[152:155]
ds_read_b64_tr_b16 a[120:121], v10 offset:57344
buffer_load_dwordx4 v3, s[12:15], s31 offen lds
v_mfma_f32_16x16x32_bf16 v[160:163], a[48:51], a[8:11], v[160:163]
v_mfma_f32_16x16x32_bf16 v[168:171], a[48:51], a[12:15], v[168:171]
ds_read_b64_tr_b16 a[122:123], v10 offset:58368
s_add_u32 s31, s31, s32
v_mfma_f32_16x16x32_bf16 v[176:179], a[48:51], a[16:19], v[176:179]
ds_read_b64_tr_b16 a[124:125], v11 offset:57344
v_mfma_f32_16x16x32_bf16 v[184:187], a[48:51], a[20:23], v[184:187]
s_add_u32 m0, s43, 33792
v_mfma_f32_16x16x32_bf16 v[192:195], a[48:51], a[24:27], v[192:195]
ds_read_b64_tr_b16 a[126:127], v11 offset:58368
v_mfma_f32_16x16x32_bf16 v[200:203], a[48:51], a[28:31], v[200:203]
buffer_load_dwordx4 v3, s[12:15], s31 offen lds
v_mfma_f32_16x16x32_bf16 v[148:151], a[52:55], a[0:3], v[148:151]
v_mfma_f32_16x16x32_bf16 v[156:159], a[52:55], a[4:7], v[156:159]
v_mfma_f32_16x16x32_bf16 v[164:167], a[52:55], a[8:11], v[164:167]
s_add_u32 s31, s31, s33
v_mfma_f32_16x16x32_bf16 v[172:175], a[52:55], a[12:15], v[172:175]
v_mfma_f32_16x16x32_bf16 v[180:183], a[52:55], a[16:19], v[180:183]
s_add_u32 m0, s43, 36864
v_mfma_f32_16x16x32_bf16 v[188:191], a[52:55], a[20:23], v[188:191]
v_mfma_f32_16x16x32_bf16 v[196:199], a[52:55], a[24:27], v[196:199]
buffer_load_dwordx4 v3, s[12:15], s31 offen lds
v_mfma_f32_16x16x32_bf16 v[204:207], a[52:55], a[28:31], v[204:207]
v_mfma_f32_16x16x32_bf16 v[208:211], a[56:59], a[0:3], v[208:211]
s_add_u32 s31, s31, s32
v_mfma_f32_16x16x32_bf16 v[216:219], a[56:59], a[4:7], v[216:219]
v_mfma_f32_16x16x32_bf16 v[224:227], a[56:59], a[8:11], v[224:227]
s_add_u32 m0, s43, 37888
v_mfma_f32_16x16x32_bf16 v[232:235], a[56:59], a[12:15], v[232:235]
v_mfma_f32_16x16x32_bf16 v[240:243], a[56:59], a[16:19], v[240:243]
buffer_load_dwordx4 v3, s[12:15], s31 offen lds
v_mfma_f32_16x16x32_bf16 v[248:251], a[56:59], a[20:23], v[248:251]
v_mfma_f32_16x16x32_bf16 a[128:131], a[56:59], a[24:27], a[128:131]
s_add_u32 s31, s31, s33
v_mfma_f32_16x16x32_bf16 a[136:139], a[56:59], a[28:31], a[136:139]
v_mfma_f32_16x16x32_bf16 v[212:215], a[60:63], a[0:3], v[212:215]
s_add_u32 s38, s38, 32768
v_mfma_f32_16x16x32_bf16 v[220:223], a[60:63], a[4:7], v[220:223]
v_mfma_f32_16x16x32_bf16 v[228:231], a[60:63], a[8:11], v[228:231]
s_cmp_ge_u32 s38, s42
v_mfma_f32_16x16x32_bf16 v[236:239], a[60:63], a[12:15], v[236:239]
v_mfma_f32_16x16x32_bf16 v[244:247], a[60:63], a[16:19], v[244:247]
s_cselect_b32 s38, s41, s38
v_mfma_f32_16x16x32_bf16 v[252:255], a[60:63], a[20:23], v[252:255]
v_mfma_f32_16x16x32_bf16 a[132:135], a[60:63], a[24:27], a[132:135]
v_mfma_f32_16x16x32_bf16 a[140:143], a[60:63], a[28:31], a[140:143]
s_waitcnt vmcnt(8) lgkmcnt(0)
s_barrier
s_add_u32 s62, s48, 48
s_cmp_lg_u32 s3, 0
s_cbranch_scc1 fused_kernel_qc_35
s_lshl_b32 s68, s62, 7
s_add_u32 s68, s68, 0x5b00000
v_mov_b32 v13, 1
v_mov_b32 v14, 0
s_mov_b64 s[70:71], exec
s_mov_b64 exec, 1
buffer_atomic_add v13, v14, s[4:7], s68 offen
s_mov_b64 exec, s[70:71]
fused_kernel_qc_35:
v_mfma_f32_16x16x32_bf16 v[16:19], a[96:99], a[64:67], v[16:19]
v_add_u32 v6, s37, v4
s_add_u32 m0, s34, 0
v_mfma_f32_16x16x32_bf16 v[24:27], a[96:99], a[68:71], v[24:27]
ds_read_b64_tr_b16 a[32:33], v8 offset:0
v_mfma_f32_16x16x32_bf16 v[32:35], a[96:99], a[72:75], v[32:35]
ds_read_b64_tr_b16 a[34:35], v8 offset:1024
buffer_load_dwordx4 v2, s[8:11], s28 offen lds
v_mfma_f32_16x16x32_bf16 v[40:43], a[96:99], a[76:79], v[40:43]
v_mfma_f32_16x16x32_bf16 v[48:51], a[96:99], a[80:83], v[48:51]
ds_read_b128 a[0:3], v6 offset:0
s_add_u32 s28, s28, s29
v_mfma_f32_16x16x32_bf16 v[56:59], a[96:99], a[84:87], v[56:59]
ds_read_b128 a[4:7], v6 offset:2048
v_mfma_f32_16x16x32_bf16 v[64:67], a[96:99], a[88:91], v[64:67]
v_mfma_f32_16x16x32_bf16 v[72:75], a[96:99], a[92:95], v[72:75]
ds_read_b128 a[8:11], v6 offset:4096
s_add_u32 m0, s34, 4096
v_mfma_f32_16x16x32_bf16 v[20:23], a[100:103], a[64:67], v[20:23]
v_mfma_f32_16x16x32_bf16 v[28:31], a[100:103], a[68:71], v[28:31]
ds_read_b128 a[12:15], v6 offset:6144
buffer_load_dwordx4 v2, s[8:11], s28 offen lds
v_mfma_f32_16x16x32_bf16 v[36:39], a[100:103], a[72:75], v[36:39]
ds_read_b128 a[16:19], v6 offset:8192
v_mfma_f32_16x16x32_bf16 v[44:47], a[100:103], a[76:79], v[44:47]
s_add_u32 s28, s28, s29
v_mfma_f32_16x16x32_bf16 v[52:55], a[100:103], a[80:83], v[52:55]
ds_read_b128 a[20:23], v6 offset:10240
v_mfma_f32_16x16x32_bf16 v[60:63], a[100:103], a[84:87], v[60:63]
v_mfma_f32_16x16x32_bf16 v[68:71], a[100:103], a[88:91], v[68:71]
ds_read_b128 a[24:27], v6 offset:12288
s_add_u32 m0, s34, 8192
v_mfma_f32_16x16x32_bf16 v[76:79], a[100:103], a[92:95], v[76:79]
ds_read_b128 a[28:31], v6 offset:14336
v_mfma_f32_16x16x32_bf16 v[80:83], a[104:107], a[64:67], v[80:83]
buffer_load_dwordx4 v2, s[8:11], s28 offen lds
v_mfma_f32_16x16x32_bf16 v[88:91], a[104:107], a[68:71], v[88:91]
ds_read_b64_tr_b16 a[36:37], v9 offset:0
v_mfma_f32_16x16x32_bf16 v[96:99], a[104:107], a[72:75], v[96:99]
ds_read_b64_tr_b16 a[38:39], v9 offset:1024
s_add_u32 s28, s28, s29
v_mfma_f32_16x16x32_bf16 v[104:107], a[104:107], a[76:79], v[104:107]
v_mfma_f32_16x16x32_bf16 v[112:115], a[104:107], a[80:83], v[112:115]
ds_read_b64_tr_b16 a[40:41], v10 offset:0
v_mfma_f32_16x16x32_bf16 v[120:123], a[104:107], a[84:87], v[120:123]
s_add_u32 m0, s34, 12288
v_mfma_f32_16x16x32_bf16 v[128:131], a[104:107], a[88:91], v[128:131]
ds_read_b64_tr_b16 a[42:43], v10 offset:1024
v_mfma_f32_16x16x32_bf16 v[136:139], a[104:107], a[92:95], v[136:139]
ds_read_b64_tr_b16 a[44:45], v11 offset:0
buffer_load_dwordx4 v2, s[8:11], s28 offen lds
v_mfma_f32_16x16x32_bf16 v[84:87], a[108:111], a[64:67], v[84:87]
v_mfma_f32_16x16x32_bf16 v[92:95], a[108:111], a[68:71], v[92:95]
ds_read_b64_tr_b16 a[46:47], v11 offset:1024
s_add_u32 s28, s28, s29
v_mfma_f32_16x16x32_bf16 v[100:103], a[108:111], a[72:75], v[100:103]
v_mfma_f32_16x16x32_bf16 v[108:111], a[108:111], a[76:79], v[108:111]
ds_read_b64_tr_b16 a[48:49], v8 offset:8192
v_mfma_f32_16x16x32_bf16 v[116:119], a[108:111], a[80:83], v[116:119]
ds_read_b64_tr_b16 a[50:51], v8 offset:9216
s_add_u32 m0, s43, 49152
v_mfma_f32_16x16x32_bf16 v[124:127], a[108:111], a[84:87], v[124:127]
v_mfma_f32_16x16x32_bf16 v[132:135], a[108:111], a[88:91], v[132:135]
ds_read_b64_tr_b16 a[52:53], v9 offset:8192
buffer_load_dwordx4 v3, s[12:15], s31 offen lds
v_mfma_f32_16x16x32_bf16 v[140:143], a[108:111], a[92:95], v[140:143]
ds_read_b64_tr_b16 a[54:55], v9 offset:9216
v_mfma_f32_16x16x32_bf16 v[144:147], a[112:115], a[64:67], v[144:147]
s_add_u32 s31, s31, s32
v_mfma_f32_16x16x32_bf16 v[152:155], a[112:115], a[68:71], v[152:155]
ds_read_b64_tr_b16 a[56:57], v10 offset:8192
v_mfma_f32_16x16x32_bf16 v[160:163], a[112:115], a[72:75], v[160:163]
v_mfma_f32_16x16x32_bf16 v[168:171], a[112:115], a[76:79], v[168:171]
ds_read_b64_tr_b16 a[58:59], v10 offset:9216
s_add_u32 m0, s43, 50176
v_mfma_f32_16x16x32_bf16 v[176:179], a[112:115], a[80:83], v[176:179]
ds_read_b64_tr_b16 a[60:61], v11 offset:8192
v_mfma_f32_16x16x32_bf16 v[184:187], a[112:115], a[84:87], v[184:187]
buffer_load_dwordx4 v3, s[12:15], s31 offen lds
v_mfma_f32_16x16x32_bf16 v[192:195], a[112:115], a[88:91], v[192:195]
ds_read_b64_tr_b16 a[62:63], v11 offset:9216
v_mfma_f32_16x16x32_bf16 v[200:203], a[112:115], a[92:95], v[200:203]
s_add_u32 s31, s31, s33
v_mfma_f32_16x16x32_bf16 v[148:151], a[116:119], a[64:67], v[148:151]
v_mfma_f32_16x16x32_bf16 v[156:159], a[116:119], a[68:71], v[156:159]
v_mfma_f32_16x16x32_bf16 v[164:167], a[116:119], a[72:75], v[164:167]
s_add_u32 m0, s43, 53248
v_mfma_f32_16x16x32_bf16 v[172:175], a[116:119], a[76:79], v[172:175]
v_mfma_f32_16x16x32_bf16 v[180:183], a[116:119], a[80:83], v[180:183]
buffer_load_dwordx4 v3, s[12:15], s31 offen lds
v_mfma_f32_16x16x32_bf16 v[188:191], a[116:119], a[84:87], v[188:191]
v_mfma_f32_16x16x32_bf16 v[196:199], a[116:119], a[88:91], v[196:199]
s_add_u32 s31, s31, s32
v_mfma_f32_16x16x32_bf16 v[204:207], a[116:119], a[92:95], v[204:207]
v_mfma_f32_16x16x32_bf16 v[208:211], a[120:123], a[64:67], v[208:211]
v_mfma_f32_16x16x32_bf16 v[216:219], a[120:123], a[68:71], v[216:219]
s_add_u32 m0, s43, 54272
v_mfma_f32_16x16x32_bf16 v[224:227], a[120:123], a[72:75], v[224:227]
v_mfma_f32_16x16x32_bf16 v[232:235], a[120:123], a[76:79], v[232:235]
buffer_load_dwordx4 v3, s[12:15], s31 offen lds
v_mfma_f32_16x16x32_bf16 v[240:243], a[120:123], a[80:83], v[240:243]
v_mfma_f32_16x16x32_bf16 v[248:251], a[120:123], a[84:87], v[248:251]
s_add_u32 s31, s31, s33
v_mfma_f32_16x16x32_bf16 a[128:131], a[120:123], a[88:91], a[128:131]
v_mfma_f32_16x16x32_bf16 a[136:139], a[120:123], a[92:95], a[136:139]
v_mfma_f32_16x16x32_bf16 v[212:215], a[124:127], a[64:67], v[212:215]
s_add_u32 s37, s37, 32768
v_mfma_f32_16x16x32_bf16 v[220:223], a[124:127], a[68:71], v[220:223]
v_mfma_f32_16x16x32_bf16 v[228:231], a[124:127], a[72:75], v[228:231]
s_cmp_ge_u32 s37, s42
v_mfma_f32_16x16x32_bf16 v[236:239], a[124:127], a[76:79], v[236:239]
v_mfma_f32_16x16x32_bf16 v[244:247], a[124:127], a[80:83], v[244:247]
s_cselect_b32 s37, s41, s37
v_mfma_f32_16x16x32_bf16 v[252:255], a[124:127], a[84:87], v[252:255]
v_mfma_f32_16x16x32_bf16 a[132:135], a[124:127], a[88:91], a[132:135]
v_mfma_f32_16x16x32_bf16 a[140:143], a[124:127], a[92:95], a[140:143]
s_cmp_ge_u32 s3, 2
s_cbranch_scc1 tch_a_36
s_mov_b32 s68, s12
s_mov_b32 s69, s13
s_mov_b32 s70, s14
s_mov_b32 s71, 0x20000
v_lshrrev_b32 v13, 2, v1
v_lshlrev_b32 v13, 13, v13
v_and_b32 v0, 3, v1
v_lshl_add_u32 v13, v0, 7, v13
s_bfe_u32 s40, s2, 0x20004
s_lshl_b32 s40, s40, 5
s_lshl_b32 s60, s3, 4
s_add_u32 s40, s40, s60
s_add_u32 s40, s40, 640
s_lshl_b32 s40, s40, 13
s_lshl_b32 s60, s48, 9
s_add_u32 s84, s40, s60
s_mov_b32 s85, 1048576
s_branch tch_done_37
tch_a_36:
s_mov_b32 s68, s8
s_mov_b32 s69, s9
s_mov_b32 s70, s10
s_mov_b32 s71, 0x20000
v_min_u32 v13, 15, v1
v_lshrrev_b32 v0, 1, v13
v_lshlrev_b32 v0, 11, v0
v_and_b32 v13, 1, v13
v_lshl_add_u32 v13, v13, 7, v0
s_lshl_b32 s40, s47, 1
s_and_b32 s60, s48, 1
s_add_u32 s40, s40, s60
s_lshl_b32 s40, s40, 3
s_and_b32 s60, s2, 7
s_add_u32 s40, s40, s60
s_bfe_u32 s60, s2, 0x20004
s_lshl_b32 s61, s49, 2
s_add_u32 s60, s60, s61
s_lshl_b32 s40, s40, 3
s_lshl_b32 s60, s60, 8
s_add_u32 s40, s40, s60
s_lshl_b32 s40, s40, 11
s_add_u32 s84, s40, 1280
s_movk_i32 s85, 256
s_cmp_eq_u32 s3, 3
s_cselect_b32 s84, 0x70000000, s84
tch_done_37:
s_mov_b32 s39, 5
s_mov_b32 s58, 100
s_branch fused_kernel_L0_0
fused_kernel_qb1:
s_waitcnt vmcnt(17) lgkmcnt(0)
s_barrier
v_mfma_f32_16x16x32_bf16 v[16:19], a[0:3], a[32:35], 0
v_add_u32 v7, s38, v5
s_add_u32 m0, s34, 16384
v_mfma_f32_16x16x32_bf16 v[20:23], a[4:7], a[32:35], 0
ds_read_b64_tr_b16 a[96:97], v8 offset:49152
v_pk_mul_f32 v[80:81], v[80:81], s[56:57]
v_pk_mul_f32 v[82:83], v[82:83], s[56:57]
v_pk_mul_f32 v[84:85], v[84:85], s[56:57]
v_pk_mul_f32 v[86:87], v[86:87], s[56:57]
v_cvt_pk_bf16_f32 v80, v80, v81
v_cvt_pk_bf16_f32 v81, v82, v83
v_cvt_pk_bf16_f32 v82, v84, v85
v_cvt_pk_bf16_f32 v83, v86, v87
v_accvgpr_write_b32 a148, v80
v_accvgpr_write_b32 a149, v81
v_accvgpr_write_b32 a150, v82
v_accvgpr_write_b32 a151, v83
v_mfma_f32_16x16x32_bf16 v[80:83], a[8:11], a[32:35], 0
ds_read_b64_tr_b16 a[98:99], v8 offset:50176
buffer_load_dwordx4 v2, s[8:11], s28 offen lds
v_mfma_f32_16x16x32_bf16 v[84:87], a[12:15], a[32:35], 0
v_pk_mul_f32 v[144:145], v[144:145], s[56:57]
v_pk_mul_f32 v[146:147], v[146:147], s[56:57]
v_pk_mul_f32 v[148:149], v[148:149], s[56:57]
v_pk_mul_f32 v[150:151], v[150:151], s[56:57]
v_cvt_pk_bf16_f32 v144, v144, v145
v_cvt_pk_bf16_f32 v145, v146, v147
v_cvt_pk_bf16_f32 v146, v148, v149
v_cvt_pk_bf16_f32 v147, v150, v151
v_accvgpr_write_b32 a152, v144
v_accvgpr_write_b32 a153, v145
v_accvgpr_write_b32 a154, v146
v_accvgpr_write_b32 a155, v147
v_mfma_f32_16x16x32_bf16 v[144:147], a[16:19], a[32:35], 0
ds_read_b128 a[64:67], v7 offset:0
s_add_u32 s28, s28, s29
v_mfma_f32_16x16x32_bf16 v[148:151], a[20:23], a[32:35], 0
ds_read_b128 a[68:71], v7 offset:2048
v_pk_mul_f32 v[208:209], v[208:209], s[56:57]
v_pk_mul_f32 v[210:211], v[210:211], s[56:57]
v_pk_mul_f32 v[212:213], v[212:213], s[56:57]
v_pk_mul_f32 v[214:215], v[214:215], s[56:57]
v_cvt_pk_bf16_f32 v208, v208, v209
v_cvt_pk_bf16_f32 v209, v210, v211
v_cvt_pk_bf16_f32 v210, v212, v213
v_cvt_pk_bf16_f32 v211, v214, v215
v_accvgpr_write_b32 a156, v208
v_accvgpr_write_b32 a157, v209
v_accvgpr_write_b32 a158, v210
v_accvgpr_write_b32 a159, v211
v_mfma_f32_16x16x32_bf16 v[208:211], a[24:27], a[32:35], 0
s_add_u32 m0, s34, 20480
v_mfma_f32_16x16x32_bf16 v[212:215], a[28:31], a[32:35], 0
ds_read_b128 a[72:75], v7 offset:4096
v_pk_mul_f32 v[24:25], v[24:25], s[56:57]
v_pk_mul_f32 v[26:27], v[26:27], s[56:57]
v_pk_mul_f32 v[28:29], v[28:29], s[56:57]
v_pk_mul_f32 v[30:31], v[30:31], s[56:57]
v_cvt_pk_bf16_f32 v24, v24, v25
v_cvt_pk_bf16_f32 v25, v26, v27
v_cvt_pk_bf16_f32 v26, v28, v29
v_cvt_pk_bf16_f32 v27, v30, v31
v_accvgpr_write_b32 a160, v24
v_accvgpr_write_b32 a161, v25
v_accvgpr_write_b32 a162, v26
v_accvgpr_write_b32 a163, v27
v_mfma_f32_16x16x32_bf16 v[24:27], a[0:3], a[36:39], 0
buffer_load_dwordx4 v2, s[8:11], s28 offen lds
v_mfma_f32_16x16x32_bf16 v[28:31], a[4:7], a[36:39], 0
ds_read_b128 a[76:79], v7 offset:6144
v_pk_mul_f32 v[88:89], v[88:89], s[56:57]
v_pk_mul_f32 v[90:91], v[90:91], s[56:57]
v_pk_mul_f32 v[92:93], v[92:93], s[56:57]
v_pk_mul_f32 v[94:95], v[94:95], s[56:57]
v_cvt_pk_bf16_f32 v88, v88, v89
v_cvt_pk_bf16_f32 v89, v90, v91
v_cvt_pk_bf16_f32 v90, v92, v93
v_cvt_pk_bf16_f32 v91, v94, v95
v_accvgpr_write_b32 a164, v88
v_accvgpr_write_b32 a165, v89
v_accvgpr_write_b32 a166, v90
v_accvgpr_write_b32 a167, v91
v_mfma_f32_16x16x32_bf16 v[88:91], a[8:11], a[36:39], 0
ds_read_b128 a[80:83], v7 offset:8192
s_add_u32 s28, s28, s29
v_mfma_f32_16x16x32_bf16 v[92:95], a[12:15], a[36:39], 0
v_pk_mul_f32 v[152:153], v[152:153], s[56:57]
v_pk_mul_f32 v[154:155], v[154:155], s[56:57]
v_pk_mul_f32 v[156:157], v[156:157], s[56:57]
v_pk_mul_f32 v[158:159], v[158:159], s[56:57]
v_cvt_pk_bf16_f32 v152, v152, v153
v_cvt_pk_bf16_f32 v153, v154, v155
v_cvt_pk_bf16_f32 v154, v156, v157
v_cvt_pk_bf16_f32 v155, v158, v159
v_accvgpr_write_b32 a168, v152
v_accvgpr_write_b32 a169, v153
v_accvgpr_write_b32 a170, v154
v_accvgpr_write_b32 a171, v155
v_mfma_f32_16x16x32_bf16 v[152:155], a[16:19], a[36:39], 0
ds_read_b128 a[84:87], v7 offset:10240
s_add_u32 m0, s34, 24576
v_mfma_f32_16x16x32_bf16 v[156:159], a[20:23], a[36:39], 0
v_pk_mul_f32 v[216:217], v[216:217], s[56:57]
v_pk_mul_f32 v[218:219], v[218:219], s[56:57]
v_pk_mul_f32 v[220:221], v[220:221], s[56:57]
v_pk_mul_f32 v[222:223], v[222:223], s[56:57]
v_cvt_pk_bf16_f32 v216, v216, v217
v_cvt_pk_bf16_f32 v217, v218, v219
v_cvt_pk_bf16_f32 v218, v220, v221
v_cvt_pk_bf16_f32 v219, v222, v223
v_accvgpr_write_b32 a172, v216
v_accvgpr_write_b32 a173, v217
v_accvgpr_write_b32 a174, v218
v_accvgpr_write_b32 a175, v219
v_mfma_f32_16x16x32_bf16 v[216:219], a[24:27], a[36:39], 0
ds_read_b128 a[88:91], v7 offset:12288
buffer_load_dwordx4 v2, s[8:11], s28 offen lds
v_mfma_f32_16x16x32_bf16 v[220:223], a[28:31], a[36:39], 0
ds_read_b128 a[92:95], v7 offset:14336
v_pk_mul_f32 v[32:33], v[32:33], s[56:57]
v_pk_mul_f32 v[34:35], v[34:35], s[56:57]
v_pk_mul_f32 v[36:37], v[36:37], s[56:57]
v_pk_mul_f32 v[38:39], v[38:39], s[56:57]
v_cvt_pk_bf16_f32 v32, v32, v33
v_cvt_pk_bf16_f32 v33, v34, v35
v_cvt_pk_bf16_f32 v34, v36, v37
v_cvt_pk_bf16_f32 v35, v38, v39
v_accvgpr_write_b32 a176, v32
v_accvgpr_write_b32 a177, v33
v_accvgpr_write_b32 a178, v34
v_accvgpr_write_b32 a179, v35
v_mfma_f32_16x16x32_bf16 v[32:35], a[0:3], a[40:43], 0
s_add_u32 s28, s28, s29
v_mfma_f32_16x16x32_bf16 v[36:39], a[4:7], a[40:43], 0
ds_read_b64_tr_b16 a[100:101], v9 offset:49152
v_pk_mul_f32 v[96:97], v[96:97], s[56:57]
v_pk_mul_f32 v[98:99], v[98:99], s[56:57]
v_pk_mul_f32 v[100:101], v[100:101], s[56:57]
v_pk_mul_f32 v[102:103], v[102:103], s[56:57]
v_cvt_pk_bf16_f32 v96, v96, v97
v_cvt_pk_bf16_f32 v97, v98, v99
v_cvt_pk_bf16_f32 v98, v100, v101
v_cvt_pk_bf16_f32 v99, v102, v103
v_accvgpr_write_b32 a180, v96
v_accvgpr_write_b32 a181, v97
v_accvgpr_write_b32 a182, v98
v_accvgpr_write_b32 a183, v99
v_mfma_f32_16x16x32_bf16 v[96:99], a[8:11], a[40:43], 0
ds_read_b64_tr_b16 a[102:103], v9 offset:50176
s_add_u32 m0, s34, 28672
v_mfma_f32_16x16x32_bf16 v[100:103], a[12:15], a[40:43], 0
v_pk_mul_f32 v[160:161], v[160:161], s[56:57]
v_pk_mul_f32 v[162:163], v[162:163], s[56:57]
v_pk_mul_f32 v[164:165], v[164:165], s[56:57]
v_pk_mul_f32 v[166:167], v[166:167], s[56:57]
v_cvt_pk_bf16_f32 v160, v160, v161
v_cvt_pk_bf16_f32 v161, v162, v163
v_cvt_pk_bf16_f32 v162, v164, v165
v_cvt_pk_bf16_f32 v163, v166, v167
v_accvgpr_write_b32 a184, v160
v_accvgpr_write_b32 a185, v161
v_accvgpr_write_b32 a186, v162
v_accvgpr_write_b32 a187, v163
v_mfma_f32_16x16x32_bf16 v[160:163], a[16:19], a[40:43], 0
ds_read_b64_tr_b16 a[104:105], v10 offset:49152
v_mfma_f32_16x16x32_bf16 v[164:167], a[20:23], a[40:43], 0
buffer_load_dwordx4 v2, s[8:11], s28 offen lds
v_pk_mul_f32 v[224:225], v[224:225], s[56:57]
v_pk_mul_f32 v[226:227], v[226:227], s[56:57]
v_pk_mul_f32 v[228:229], v[228:229], s[56:57]
v_pk_mul_f32 v[230:231], v[230:231], s[56:57]
v_cvt_pk_bf16_f32 v224, v224, v225
v_cvt_pk_bf16_f32 v225, v226, v227
v_cvt_pk_bf16_f32 v226, v228, v229
v_cvt_pk_bf16_f32 v227, v230, v231
v_accvgpr_write_b32 a188, v224
v_accvgpr_write_b32 a189, v225
v_accvgpr_write_b32 a190, v226
v_accvgpr_write_b32 a191, v227
v_mfma_f32_16x16x32_bf16 v[224:227], a[24:27], a[40:43], 0
ds_read_b64_tr_b16 a[106:107], v10 offset:50176
v_mfma_f32_16x16x32_bf16 v[228:231], a[28:31], a[40:43], 0
ds_read_b64_tr_b16 a[108:109], v11 offset:49152
s_add_u32 s28, s28, s30
v_pk_mul_f32 v[40:41], v[40:41], s[56:57]
v_pk_mul_f32 v[42:43], v[42:43], s[56:57]
v_pk_mul_f32 v[44:45], v[44:45], s[56:57]
v_pk_mul_f32 v[46:47], v[46:47], s[56:57]
v_cvt_pk_bf16_f32 v40, v40, v41
v_cvt_pk_bf16_f32 v41, v42, v43
v_cvt_pk_bf16_f32 v42, v44, v45
v_cvt_pk_bf16_f32 v43, v46, v47
v_accvgpr_write_b32 a192, v40
v_accvgpr_write_b32 a193, v41
v_accvgpr_write_b32 a194, v42
v_accvgpr_write_b32 a195, v43
v_mfma_f32_16x16x32_bf16 v[40:43], a[0:3], a[44:47], 0
v_mfma_f32_16x16x32_bf16 v[44:47], a[4:7], a[44:47], 0
ds_read_b64_tr_b16 a[110:111], v11 offset:50176
s_add_u32 s34, s34, 32768
v_pk_mul_f32 v[104:105], v[104:105], s[56:57]
v_pk_mul_f32 v[106:107], v[106:107], s[56:57]
v_pk_mul_f32 v[108:109], v[108:109], s[56:57]
v_pk_mul_f32 v[110:111], v[110:111], s[56:57]
v_cvt_pk_bf16_f32 v104, v104, v105
v_cvt_pk_bf16_f32 v105, v106, v107
v_cvt_pk_bf16_f32 v106, v108, v109
v_cvt_pk_bf16_f32 v107, v110, v111
v_accvgpr_write_b32 a196, v104
v_accvgpr_write_b32 a197, v105
v_accvgpr_write_b32 a198, v106
v_accvgpr_write_b32 a199, v107
v_mfma_f32_16x16x32_bf16 v[104:107], a[8:11], a[44:47], 0
v_mfma_f32_16x16x32_bf16 v[108:111], a[12:15], a[44:47], 0
ds_read_b64_tr_b16 a[112:113], v8 offset:57344
s_cmp_ge_u32 s34, s36
v_pk_mul_f32 v[168:169], v[168:169], s[56:57]
v_pk_mul_f32 v[170:171], v[170:171], s[56:57]
v_pk_mul_f32 v[172:173], v[172:173], s[56:57]
v_pk_mul_f32 v[174:175], v[174:175], s[56:57]
v_cvt_pk_bf16_f32 v168, v168, v169
v_cvt_pk_bf16_f32 v169, v170, v171
v_cvt_pk_bf16_f32 v170, v172, v173
v_cvt_pk_bf16_f32 v171, v174, v175
v_accvgpr_write_b32 a200, v168
v_accvgpr_write_b32 a201, v169
v_accvgpr_write_b32 a202, v170
v_accvgpr_write_b32 a203, v171
v_mfma_f32_16x16x32_bf16 v[168:171], a[16:19], a[44:47], 0
ds_read_b64_tr_b16 a[114:115], v8 offset:58368
v_mfma_f32_16x16x32_bf16 v[172:175], a[20:23], a[44:47], 0
s_cselect_b32 s34, s35, s34
v_pk_mul_f32 v[232:233], v[232:233], s[56:57]
v_pk_mul_f32 v[234:235], v[234:235], s[56:57]
v_pk_mul_f32 v[236:237], v[236:237], s[56:57]
v_pk_mul_f32 v[238:239], v[238:239], s[56:57]
v_cvt_pk_bf16_f32 v232, v232, v233
v_cvt_pk_bf16_f32 v233, v234, v235
v_cvt_pk_bf16_f32 v234, v236, v237
v_cvt_pk_bf16_f32 v235, v238, v239
v_accvgpr_write_b32 a204, v232
v_accvgpr_write_b32 a205, v233
v_accvgpr_write_b32 a206, v234
v_accvgpr_write_b32 a207, v235
v_mfma_f32_16x16x32_bf16 v[232:235], a[24:27], a[44:47], 0
ds_read_b64_tr_b16 a[116:117], v9 offset:57344
v_mfma_f32_16x16x32_bf16 v[236:239], a[28:31], a[44:47], 0
ds_read_b64_tr_b16 a[118:119], v9 offset:58368
s_add_u32 m0, s43, 32768
v_pk_mul_f32 v[48:49], v[48:49], s[56:57]
v_pk_mul_f32 v[50:51], v[50:51], s[56:57]
v_pk_mul_f32 v[52:53], v[52:53], s[56:57]
v_pk_mul_f32 v[54:55], v[54:55], s[56:57]
v_cvt_pk_bf16_f32 v48, v48, v49
v_cvt_pk_bf16_f32 v49, v50, v51
v_cvt_pk_bf16_f32 v50, v52, v53
v_cvt_pk_bf16_f32 v51, v54, v55
v_accvgpr_write_b32 a208, v48
v_accvgpr_write_b32 a209, v49
v_accvgpr_write_b32 a210, v50
v_accvgpr_write_b32 a211, v51
v_mfma_f32_16x16x32_bf16 v[48:51], a[0:3], a[48:51], 0
v_mfma_f32_16x16x32_bf16 v[52:55], a[4:7], a[48:51], 0
ds_read_b64_tr_b16 a[120:121], v10 offset:57344
buffer_load_dwordx4 v3, s[12:15], s31 offen lds
v_pk_mul_f32 v[112:113], v[112:113], s[56:57]
v_pk_mul_f32 v[114:115], v[114:115], s[56:57]
v_pk_mul_f32 v[116:117], v[116:117], s[56:57]
v_pk_mul_f32 v[118:119], v[118:119], s[56:57]
v_cvt_pk_bf16_f32 v112, v112, v113
v_cvt_pk_bf16_f32 v113, v114, v115
v_cvt_pk_bf16_f32 v114, v116, v117
v_cvt_pk_bf16_f32 v115, v118, v119
v_accvgpr_write_b32 a212, v112
v_accvgpr_write_b32 a213, v113
v_accvgpr_write_b32 a214, v114
v_accvgpr_write_b32 a215, v115
v_mfma_f32_16x16x32_bf16 v[112:115], a[8:11], a[48:51], 0
v_mfma_f32_16x16x32_bf16 v[116:119], a[12:15], a[48:51], 0
ds_read_b64_tr_b16 a[122:123], v10 offset:58368
s_add_u32 s31, s31, s32
v_pk_mul_f32 v[176:177], v[176:177], s[56:57]
v_pk_mul_f32 v[178:179], v[178:179], s[56:57]
v_pk_mul_f32 v[180:181], v[180:181], s[56:57]
v_pk_mul_f32 v[182:183], v[182:183], s[56:57]
v_cvt_pk_bf16_f32 v176, v176, v177
v_cvt_pk_bf16_f32 v177, v178, v179
v_cvt_pk_bf16_f32 v178, v180, v181
v_cvt_pk_bf16_f32 v179, v182, v183
v_accvgpr_write_b32 a216, v176
v_accvgpr_write_b32 a217, v177
v_accvgpr_write_b32 a218, v178
v_accvgpr_write_b32 a219, v179
v_mfma_f32_16x16x32_bf16 v[176:179], a[16:19], a[48:51], 0
ds_read_b64_tr_b16 a[124:125], v11 offset:57344
v_mfma_f32_16x16x32_bf16 v[180:183], a[20:23], a[48:51], 0
s_add_u32 m0, s43, 33792
v_pk_mul_f32 v[240:241], v[240:241], s[56:57]
v_pk_mul_f32 v[242:243], v[242:243], s[56:57]
v_pk_mul_f32 v[244:245], v[244:245], s[56:57]
v_pk_mul_f32 v[246:247], v[246:247], s[56:57]
v_cvt_pk_bf16_f32 v240, v240, v241
v_cvt_pk_bf16_f32 v241, v242, v243
v_cvt_pk_bf16_f32 v242, v244, v245
v_cvt_pk_bf16_f32 v243, v246, v247
v_accvgpr_write_b32 a220, v240
v_accvgpr_write_b32 a221, v241
v_accvgpr_write_b32 a222, v242
v_accvgpr_write_b32 a223, v243
v_mfma_f32_16x16x32_bf16 v[240:243], a[24:27], a[48:51], 0
ds_read_b64_tr_b16 a[126:127], v11 offset:58368
v_mfma_f32_16x16x32_bf16 v[244:247], a[28:31], a[48:51], 0
buffer_load_dwordx4 v3, s[12:15], s31 offen lds
v_pk_mul_f32 v[56:57], v[56:57], s[56:57]
v_pk_mul_f32 v[58:59], v[58:59], s[56:57]
v_pk_mul_f32 v[60:61], v[60:61], s[56:57]
v_pk_mul_f32 v[62:63], v[62:63], s[56:57]
v_cvt_pk_bf16_f32 v56, v56, v57
v_cvt_pk_bf16_f32 v57, v58, v59
v_cvt_pk_bf16_f32 v58, v60, v61
v_cvt_pk_bf16_f32 v59, v62, v63
v_accvgpr_write_b32 a224, v56
v_accvgpr_write_b32 a225, v57
v_accvgpr_write_b32 a226, v58
v_accvgpr_write_b32 a227, v59
v_mfma_f32_16x16x32_bf16 v[56:59], a[0:3], a[52:55], 0
v_mfma_f32_16x16x32_bf16 v[60:63], a[4:7], a[52:55], 0
v_pk_mul_f32 v[120:121], v[120:121], s[56:57]
v_pk_mul_f32 v[122:123], v[122:123], s[56:57]
v_pk_mul_f32 v[124:125], v[124:125], s[56:57]
v_pk_mul_f32 v[126:127], v[126:127], s[56:57]
v_cvt_pk_bf16_f32 v120, v120, v121
v_cvt_pk_bf16_f32 v121, v122, v123
v_cvt_pk_bf16_f32 v122, v124, v125
v_cvt_pk_bf16_f32 v123, v126, v127
v_accvgpr_write_b32 a228, v120
v_accvgpr_write_b32 a229, v121
v_accvgpr_write_b32 a230, v122
v_accvgpr_write_b32 a231, v123
v_mfma_f32_16x16x32_bf16 v[120:123], a[8:11], a[52:55], 0
s_add_u32 s31, s31, s33
v_mfma_f32_16x16x32_bf16 v[124:127], a[12:15], a[52:55], 0
v_pk_mul_f32 v[184:185], v[184:185], s[56:57]
v_pk_mul_f32 v[186:187], v[186:187], s[56:57]
v_pk_mul_f32 v[188:189], v[188:189], s[56:57]
v_pk_mul_f32 v[190:191], v[190:191], s[56:57]
v_cvt_pk_bf16_f32 v184, v184, v185
v_cvt_pk_bf16_f32 v185, v186, v187
v_cvt_pk_bf16_f32 v186, v188, v189
v_cvt_pk_bf16_f32 v187, v190, v191
v_accvgpr_write_b32 a232, v184
v_accvgpr_write_b32 a233, v185
v_accvgpr_write_b32 a234, v186
v_accvgpr_write_b32 a235, v187
v_mfma_f32_16x16x32_bf16 v[184:187], a[16:19], a[52:55], 0
s_add_u32 m0, s43, 36864
v_mfma_f32_16x16x32_bf16 v[188:191], a[20:23], a[52:55], 0
v_pk_mul_f32 v[248:249], v[248:249], s[56:57]
v_pk_mul_f32 v[250:251], v[250:251], s[56:57]
v_pk_mul_f32 v[252:253], v[252:253], s[56:57]
v_pk_mul_f32 v[254:255], v[254:255], s[56:57]
v_cvt_pk_bf16_f32 v248, v248, v249
v_cvt_pk_bf16_f32 v249, v250, v251
v_cvt_pk_bf16_f32 v250, v252, v253
v_cvt_pk_bf16_f32 v251, v254, v255
v_accvgpr_write_b32 a236, v248
v_accvgpr_write_b32 a237, v249
v_accvgpr_write_b32 a238, v250
v_accvgpr_write_b32 a239, v251
v_mfma_f32_16x16x32_bf16 v[248:251], a[24:27], a[52:55], 0
buffer_load_dwordx4 v3, s[12:15], s31 offen lds
v_mfma_f32_16x16x32_bf16 v[252:255], a[28:31], a[52:55], 0
v_pk_mul_f32 v[64:65], v[64:65], s[56:57]
v_pk_mul_f32 v[66:67], v[66:67], s[56:57]
v_pk_mul_f32 v[68:69], v[68:69], s[56:57]
v_pk_mul_f32 v[70:71], v[70:71], s[56:57]
v_cvt_pk_bf16_f32 v64, v64, v65
v_cvt_pk_bf16_f32 v65, v66, v67
v_cvt_pk_bf16_f32 v66, v68, v69
v_cvt_pk_bf16_f32 v67, v70, v71
v_accvgpr_write_b32 a240, v64
v_accvgpr_write_b32 a241, v65
v_accvgpr_write_b32 a242, v66
v_accvgpr_write_b32 a243, v67
v_mfma_f32_16x16x32_bf16 v[64:67], a[0:3], a[56:59], 0
s_add_u32 s31, s31, s32
v_mfma_f32_16x16x32_bf16 v[68:71], a[4:7], a[56:59], 0
v_pk_mul_f32 v[128:129], v[128:129], s[56:57]
v_pk_mul_f32 v[130:131], v[130:131], s[56:57]
v_pk_mul_f32 v[132:133], v[132:133], s[56:57]
v_pk_mul_f32 v[134:135], v[134:135], s[56:57]
v_cvt_pk_bf16_f32 v128, v128, v129
v_cvt_pk_bf16_f32 v129, v130, v131
v_cvt_pk_bf16_f32 v130, v132, v133
v_cvt_pk_bf16_f32 v131, v134, v135
v_accvgpr_write_b32 a244, v128
v_accvgpr_write_b32 a245, v129
v_accvgpr_write_b32 a246, v130
v_accvgpr_write_b32 a247, v131
v_mfma_f32_16x16x32_bf16 v[128:131], a[8:11], a[56:59], 0
s_add_u32 m0, s43, 37888
v_mfma_f32_16x16x32_bf16 v[132:135], a[12:15], a[56:59], 0
v_pk_mul_f32 v[192:193], v[192:193], s[56:57]
v_pk_mul_f32 v[194:195], v[194:195], s[56:57]
v_pk_mul_f32 v[196:197], v[196:197], s[56:57]
v_pk_mul_f32 v[198:199], v[198:199], s[56:57]
v_cvt_pk_bf16_f32 v192, v192, v193
v_cvt_pk_bf16_f32 v193, v194, v195
v_cvt_pk_bf16_f32 v194, v196, v197
v_cvt_pk_bf16_f32 v195, v198, v199
v_accvgpr_write_b32 a248, v192
v_accvgpr_write_b32 a249, v193
v_accvgpr_write_b32 a250, v194
v_accvgpr_write_b32 a251, v195
v_mfma_f32_16x16x32_bf16 v[192:195], a[16:19], a[56:59], 0
buffer_load_dwordx4 v3, s[12:15], s31 offen lds
v_mfma_f32_16x16x32_bf16 v[196:199], a[20:23], a[56:59], 0
v_mfma_f32_16x16x32_bf16 a[128:131], a[24:27], a[56:59], 0
s_add_u32 s31, s31, s33
v_mfma_f32_16x16x32_bf16 a[132:135], a[28:31], a[56:59], 0
v_pk_mul_f32 v[72:73], v[72:73], s[56:57]
v_pk_mul_f32 v[74:75], v[74:75], s[56:57]
v_pk_mul_f32 v[76:77], v[76:77], s[56:57]
v_pk_mul_f32 v[78:79], v[78:79], s[56:57]
v_cvt_pk_bf16_f32 v72, v72, v73
v_cvt_pk_bf16_f32 v73, v74, v75
v_cvt_pk_bf16_f32 v74, v76, v77
v_cvt_pk_bf16_f32 v75, v78, v79
s_add_u32 s40, s45, 57344
buffer_store_dwordx4 v[72:75], v12, s[4:7], s40 offen sc1
s_nop 1
v_mfma_f32_16x16x32_bf16 v[72:75], a[0:3], a[60:63], 0
s_add_u32 s38, s38, 32768
v_mfma_f32_16x16x32_bf16 v[76:79], a[4:7], a[60:63], 0
v_pk_mul_f32 v[136:137], v[136:137], s[56:57]
v_pk_mul_f32 v[138:139], v[138:139], s[56:57]
v_pk_mul_f32 v[140:141], v[140:141], s[56:57]
v_pk_mul_f32 v[142:143], v[142:143], s[56:57]
v_cvt_pk_bf16_f32 v136, v136, v137
v_cvt_pk_bf16_f32 v137, v138, v139
v_cvt_pk_bf16_f32 v138, v140, v141
v_cvt_pk_bf16_f32 v139, v142, v143
s_add_u32 s40, s45, 58368
buffer_store_dwordx4 v[136:139], v12, s[4:7], s40 offen sc1
s_nop 1
v_mfma_f32_16x16x32_bf16 v[136:139], a[8:11], a[60:63], 0
s_cmp_ge_u32 s38, s42
v_mfma_f32_16x16x32_bf16 v[140:143], a[12:15], a[60:63], 0
v_pk_mul_f32 v[200:201], v[200:201], s[56:57]
v_pk_mul_f32 v[202:203], v[202:203], s[56:57]
v_pk_mul_f32 v[204:205], v[204:205], s[56:57]
v_pk_mul_f32 v[206:207], v[206:207], s[56:57]
v_cvt_pk_bf16_f32 v200, v200, v201
v_cvt_pk_bf16_f32 v201, v202, v203
v_cvt_pk_bf16_f32 v202, v204, v205
v_cvt_pk_bf16_f32 v203, v206, v207
s_add_u32 s40, s45, 61440
buffer_store_dwordx4 v[200:203], v12, s[4:7], s40 offen sc1
s_nop 1
v_mfma_f32_16x16x32_bf16 v[200:203], a[16:19], a[60:63], 0
s_cselect_b32 s38, s41, s38
v_mfma_f32_16x16x32_bf16 v[204:207], a[20:23], a[60:63], 0
v_mfma_f32_16x16x32_bf16 a[136:139], a[24:27], a[60:63], 0
v_mfma_f32_16x16x32_bf16 a[140:143], a[28:31], a[60:63], 0
s_waitcnt vmcnt(17) lgkmcnt(0)
s_barrier
v_mfma_f32_16x16x32_bf16 v[16:19], a[64:67], a[96:99], v[16:19]
v_add_u32 v6, s37, v4
s_add_u32 m0, s34, 0
v_mfma_f32_16x16x32_bf16 v[20:23], a[68:71], a[96:99], v[20:23]
ds_read_b64_tr_b16 a[32:33], v8 offset:0
buffer_load_dwordx4 v2, s[8:11], s28 offen lds
v_mfma_f32_16x16x32_bf16 v[80:83], a[72:75], a[96:99], v[80:83]
ds_read_b64_tr_b16 a[34:35], v8 offset:1024
v_mfma_f32_16x16x32_bf16 v[84:87], a[76:79], a[96:99], v[84:87]
s_add_u32 s28, s28, s29
v_mfma_f32_16x16x32_bf16 v[144:147], a[80:83], a[96:99], v[144:147]
ds_read_b128 a[0:3], v6 offset:0
v_mfma_f32_16x16x32_bf16 v[148:151], a[84:87], a[96:99], v[148:151]
ds_read_b128 a[4:7], v6 offset:2048
s_add_u32 m0, s34, 4096
v_mfma_f32_16x16x32_bf16 v[208:211], a[88:91], a[96:99], v[208:211]
v_mfma_f32_16x16x32_bf16 v[212:215], a[92:95], a[96:99], v[212:215]
ds_read_b128 a[8:11], v6 offset:4096
buffer_load_dwordx4 v2, s[8:11], s28 offen lds
v_mfma_f32_16x16x32_bf16 v[24:27], a[64:67], a[100:103], v[24:27]
v_mfma_f32_16x16x32_bf16 v[28:31], a[68:71], a[100:103], v[28:31]
ds_read_b128 a[12:15], v6 offset:6144
s_add_u32 s28, s28, s29
v_mfma_f32_16x16x32_bf16 v[88:91], a[72:75], a[100:103], v[88:91]
ds_read_b128 a[16:19], v6 offset:8192
s_add_u32 m0, s34, 8192
v_mfma_f32_16x16x32_bf16 v[92:95], a[76:79], a[100:103], v[92:95]
v_mfma_f32_16x16x32_bf16 v[152:155], a[80:83], a[100:103], v[152:155]
ds_read_b128 a[20:23], v6 offset:10240
buffer_load_dwordx4 v2, s[8:11], s28 offen lds
v_mfma_f32_16x16x32_bf16 v[156:159], a[84:87], a[100:103], v[156:159]
v_mfma_f32_16x16x32_bf16 v[216:219], a[88:91], a[100:103], v[216:219]
ds_read_b128 a[24:27], v6 offset:12288
s_add_u32 s28, s28, s29
v_mfma_f32_16x16x32_bf16 v[220:223], a[92:95], a[100:103], v[220:223]
ds_read_b128 a[28:31], v6 offset:14336
v_mfma_f32_16x16x32_bf16 v[32:35], a[64:67], a[104:107], v[32:35]
s_add_u32 m0, s34, 12288
v_mfma_f32_16x16x32_bf16 v[36:39], a[68:71], a[104:107], v[36:39]
ds_read_b64_tr_b16 a[36:37], v9 offset:0
v_mfma_f32_16x16x32_bf16 v[96:99], a[72:75], a[104:107], v[96:99]
ds_read_b64_tr_b16 a[38:39], v9 offset:1024
buffer_load_dwordx4 v2, s[8:11], s28 offen lds
v_mfma_f32_16x16x32_bf16 v[100:103], a[76:79], a[104:107], v[100:103]
s_add_u32 s28, s28, s29
v_mfma_f32_16x16x32_bf16 v[160:163], a[80:83], a[104:107], v[160:163]
ds_read_b64_tr_b16 a[40:41], v10 offset:0
v_mfma_f32_16x16x32_bf16 v[164:167], a[84:87], a[104:107], v[164:167]
s_add_u32 m0, s43, 49152
v_mfma_f32_16x16x32_bf16 v[224:227], a[88:91], a[104:107], v[224:227]
ds_read_b64_tr_b16 a[42:43], v10 offset:1024
v_mfma_f32_16x16x32_bf16 v[228:231], a[92:95], a[104:107], v[228:231]
ds_read_b64_tr_b16 a[44:45], v11 offset:0
buffer_load_dwordx4 v3, s[12:15], s31 offen lds
v_mfma_f32_16x16x32_bf16 v[40:43], a[64:67], a[108:111], v[40:43]
v_mfma_f32_16x16x32_bf16 v[44:47], a[68:71], a[108:111], v[44:47]
ds_read_b64_tr_b16 a[46:47], v11 offset:1024
s_add_u32 s31, s31, s32
v_mfma_f32_16x16x32_bf16 v[104:107], a[72:75], a[108:111], v[104:107]
v_mfma_f32_16x16x32_bf16 v[108:111], a[76:79], a[108:111], v[108:111]
ds_read_b64_tr_b16 a[48:49], v8 offset:8192
s_add_u32 m0, s43, 50176
v_mfma_f32_16x16x32_bf16 v[168:171], a[80:83], a[108:111], v[168:171]
ds_read_b64_tr_b16 a[50:51], v8 offset:9216
buffer_load_dwordx4 v3, s[12:15], s31 offen lds
v_mfma_f32_16x16x32_bf16 v[172:175], a[84:87], a[108:111], v[172:175]
v_mfma_f32_16x16x32_bf16 v[232:235], a[88:91], a[108:111], v[232:235]
ds_read_b64_tr_b16 a[52:53], v9 offset:8192
s_add_u32 s31, s31, s33
v_mfma_f32_16x16x32_bf16 v[236:239], a[92:95], a[108:111], v[236:239]
ds_read_b64_tr_b16 a[54:55], v9 offset:9216
v_mfma_f32_16x16x32_bf16 v[48:51], a[64:67], a[112:115], v[48:51]
s_add_u32 m0, s43, 53248
v_mfma_f32_16x16x32_bf16 v[52:55], a[68:71], a[112:115], v[52:55]
ds_read_b64_tr_b16 a[56:57], v10 offset:8192
v_mfma_f32_16x16x32_bf16 v[112:115], a[72:75], a[112:115], v[112:115]
buffer_load_dwordx4 v3, s[12:15], s31 offen lds
v_mfma_f32_16x16x32_bf16 v[116:119], a[76:79], a[112:115], v[116:119]
ds_read_b64_tr_b16 a[58:59], v10 offset:9216
v_mfma_f32_16x16x32_bf16 v[176:179], a[80:83], a[112:115], v[176:179]
ds_read_b64_tr_b16 a[60:61], v11 offset:8192
s_add_u32 s31, s31, s32
v_mfma_f32_16x16x32_bf16 v[180:183], a[84:87], a[112:115], v[180:183]
s_add_u32 m0, s43, 54272
v_mfma_f32_16x16x32_bf16 v[240:243], a[88:91], a[112:115], v[240:243]
ds_read_b64_tr_b16 a[62:63], v11 offset:9216
v_mfma_f32_16x16x32_bf16 v[244:247], a[92:95], a[112:115], v[244:247]
buffer_load_dwordx4 v3, s[12:15], s31 offen lds
v_mfma_f32_16x16x32_bf16 v[56:59], a[64:67], a[116:119], v[56:59]
v_mfma_f32_16x16x32_bf16 v[60:63], a[68:71], a[116:119], v[60:63]
s_add_u32 s31, s31, s33
v_mfma_f32_16x16x32_bf16 v[120:123], a[72:75], a[116:119], v[120:123]
v_mfma_f32_16x16x32_bf16 v[124:127], a[76:79], a[116:119], v[124:127]
s_add_u32 s37, s37, 32768
v_mfma_f32_16x16x32_bf16 v[184:187], a[80:83], a[116:119], v[184:187]
v_mfma_f32_16x16x32_bf16 v[188:191], a[84:87], a[116:119], v[188:191]
s_cmp_ge_u32 s37, s42
v_mfma_f32_16x16x32_bf16 v[248:251], a[88:91], a[116:119], v[248:251]
s_cselect_b32 s37, s41, s37
v_mfma_f32_16x16x32_bf16 v[252:255], a[92:95], a[116:119], v[252:255]
v_mfma_f32_16x16x32_bf16 v[64:67], a[64:67], a[120:123], v[64:67]
s_add_u32 s40, s45, 0
v_mfma_f32_16x16x32_bf16 v[68:71], a[68:71], a[120:123], v[68:71]
v_mfma_f32_16x16x32_bf16 v[128:131], a[72:75], a[120:123], v[128:131]
buffer_store_dwordx4 a[144:147], v12, s[4:7], s40 offen sc1
v_mfma_f32_16x16x32_bf16 v[132:135], a[76:79], a[120:123], v[132:135]
v_mfma_f32_16x16x32_bf16 v[192:195], a[80:83], a[120:123], v[192:195]
s_add_u32 s40, s45, 1024
v_mfma_f32_16x16x32_bf16 v[196:199], a[84:87], a[120:123], v[196:199]
v_mfma_f32_16x16x32_bf16 a[128:131], a[88:91], a[120:123], a[128:131]
buffer_store_dwordx4 a[148:151], v12, s[4:7], s40 offen sc1
v_mfma_f32_16x16x32_bf16 a[132:135], a[92:95], a[120:123], a[132:135]
s_add_u32 s40, s45, 4096
v_mfma_f32_16x16x32_bf16 v[72:75], a[64:67], a[124:127], v[72:75]
v_mfma_f32_16x16x32_bf16 v[76:79], a[68:71], a[124:127], v[76:79]
buffer_store_dwordx4 a[152:155], v12, s[4:7], s40 offen sc1
v_mfma_f32_16x16x32_bf16 v[136:139], a[72:75], a[124:127], v[136:139]
v_mfma_f32_16x16x32_bf16 v[140:143], a[76:79], a[124:127], v[140:143]
s_add_u32 s40, s45, 5120
v_mfma_f32_16x16x32_bf16 v[200:203], a[80:83], a[124:127], v[200:203]
v_mfma_f32_16x16x32_bf16 v[204:207], a[84:87], a[124:127], v[204:207]
buffer_store_dwordx4 a[156:159], v12, s[4:7], s40 offen sc1
v_mfma_f32_16x16x32_bf16 a[136:139], a[88:91], a[124:127], a[136:139]
v_mfma_f32_16x16x32_bf16 a[140:143], a[92:95], a[124:127], a[140:143]
s_waitcnt vmcnt(21) lgkmcnt(0)
s_barrier
v_mfma_f32_16x16x32_bf16 v[16:19], a[0:3], a[32:35], v[16:19]
v_add_u32 v7, s38, v5
s_add_u32 m0, s34, 16384
v_mfma_f32_16x16x32_bf16 v[20:23], a[4:7], a[32:35], v[20:23]
ds_read_b64_tr_b16 a[96:97], v8 offset:16384
buffer_load_dwordx4 v2, s[8:11], s28 offen lds
v_mfma_f32_16x16x32_bf16 v[80:83], a[8:11], a[32:35], v[80:83]
ds_read_b64_tr_b16 a[98:99], v8 offset:17408
v_mfma_f32_16x16x32_bf16 v[84:87], a[12:15], a[32:35], v[84:87]
s_add_u32 s28, s28, s29
v_mfma_f32_16x16x32_bf16 v[144:147], a[16:19], a[32:35], v[144:147]
ds_read_b128 a[64:67], v7 offset:0
s_add_u32 m0, s34, 20480
v_mfma_f32_16x16x32_bf16 v[148:151], a[20:23], a[32:35], v[148:151]
ds_read_b128 a[68:71], v7 offset:2048
v_mfma_f32_16x16x32_bf16 v[208:211], a[24:27], a[32:35], v[208:211]
buffer_load_dwordx4 v2, s[8:11], s28 offen lds
v_mfma_f32_16x16x32_bf16 v[212:215], a[28:31], a[32:35], v[212:215]
ds_read_b128 a[72:75], v7 offset:4096
v_mfma_f32_16x16x32_bf16 v[24:27], a[0:3], a[36:39], v[24:27]
s_add_u32 s28, s28, s29
v_mfma_f32_16x16x32_bf16 v[28:31], a[4:7], a[36:39], v[28:31]
ds_read_b128 a[76:79], v7 offset:6144
s_add_u32 m0, s34, 24576
v_mfma_f32_16x16x32_bf16 v[88:91], a[8:11], a[36:39], v[88:91]
ds_read_b128 a[80:83], v7 offset:8192
v_mfma_f32_16x16x32_bf16 v[92:95], a[12:15], a[36:39], v[92:95]
buffer_load_dwordx4 v2, s[8:11], s28 offen lds
v_mfma_f32_16x16x32_bf16 v[152:155], a[16:19], a[36:39], v[152:155]
ds_read_b128 a[84:87], v7 offset:10240
v_mfma_f32_16x16x32_bf16 v[156:159], a[20:23], a[36:39], v[156:159]
s_add_u32 s28, s28, s29
v_mfma_f32_16x16x32_bf16 v[216:219], a[24:27], a[36:39], v[216:219]
ds_read_b128 a[88:91], v7 offset:12288
s_add_u32 m0, s34, 28672
v_mfma_f32_16x16x32_bf16 v[220:223], a[28:31], a[36:39], v[220:223]
ds_read_b128 a[92:95], v7 offset:14336
v_mfma_f32_16x16x32_bf16 v[32:35], a[0:3], a[40:43], v[32:35]
buffer_load_dwordx4 v2, s[8:11], s28 offen lds
v_mfma_f32_16x16x32_bf16 v[36:39], a[4:7], a[40:43], v[36:39]
ds_read_b64_tr_b16 a[100:101], v9 offset:16384
v_mfma_f32_16x16x32_bf16 v[96:99], a[8:11], a[40:43], v[96:99]
ds_read_b64_tr_b16 a[102:103], v9 offset:17408
s_add_u32 s28, s28, s30
v_mfma_f32_16x16x32_bf16 v[100:103], a[12:15], a[40:43], v[100:103]
s_add_u32 s34, s34, 32768
v_mfma_f32_16x16x32_bf16 v[160:163], a[16:19], a[40:43], v[160:163]
ds_read_b64_tr_b16 a[104:105], v10 offset:16384
v_mfma_f32_16x16x32_bf16 v[164:167], a[20:23], a[40:43], v[164:167]
s_cmp_ge_u32 s34, s36
v_mfma_f32_16x16x32_bf16 v[224:227], a[24:27], a[40:43], v[224:227]
ds_read_b64_tr_b16 a[106:107], v10 offset:17408
v_mfma_f32_16x16x32_bf16 v[228:231], a[28:31], a[40:43], v[228:231]
ds_read_b64_tr_b16 a[108:109], v11 offset:16384
s_cselect_b32 s34, s35, s34
v_mfma_f32_16x16x32_bf16 v[40:43], a[0:3], a[44:47], v[40:43]
s_add_u32 m0, s43, 0
v_mfma_f32_16x16x32_bf16 v[44:47], a[4:7], a[44:47], v[44:47]
ds_read_b64_tr_b16 a[110:111], v11 offset:17408
v_mfma_f32_16x16x32_bf16 v[104:107], a[8:11], a[44:47], v[104:107]
buffer_load_dwordx4 v3, s[12:15], s31 offen lds
v_mfma_f32_16x16x32_bf16 v[108:111], a[12:15], a[44:47], v[108:111]
ds_read_b64_tr_b16 a[112:113], v8 offset:24576
v_mfma_f32_16x16x32_bf16 v[168:171], a[16:19], a[44:47], v[168:171]
ds_read_b64_tr_b16 a[114:115], v8 offset:25600
s_add_u32 s31, s31, s32
v_mfma_f32_16x16x32_bf16 v[172:175], a[20:23], a[44:47], v[172:175]
s_add_u32 m0, s43, 1024
v_mfma_f32_16x16x32_bf16 v[232:235], a[24:27], a[44:47], v[232:235]
ds_read_b64_tr_b16 a[116:117], v9 offset:24576
v_mfma_f32_16x16x32_bf16 v[236:239], a[28:31], a[44:47], v[236:239]
ds_read_b64_tr_b16 a[118:119], v9 offset:25600
buffer_load_dwordx4 v3, s[12:15], s31 offen lds
v_mfma_f32_16x16x32_bf16 v[48:51], a[0:3], a[48:51], v[48:51]
v_mfma_f32_16x16x32_bf16 v[52:55], a[4:7], a[48:51], v[52:55]
ds_read_b64_tr_b16 a[120:121], v10 offset:24576
s_add_u32 s31, s31, s33
v_mfma_f32_16x16x32_bf16 v[112:115], a[8:11], a[48:51], v[112:115]
s_add_u32 m0, s43, 4096
v_mfma_f32_16x16x32_bf16 v[116:119], a[12:15], a[48:51], v[116:119]
ds_read_b64_tr_b16 a[122:123], v10 offset:25600
v_mfma_f32_16x16x32_bf16 v[176:179], a[16:19], a[48:51], v[176:179]
ds_read_b64_tr_b16 a[124:125], v11 offset:24576
buffer_load_dwordx4 v3, s[12:15], s31 offen lds
v_mfma_f32_16x16x32_bf16 v[180:183], a[20:23], a[48:51], v[180:183]
v_mfma_f32_16x16x32_bf16 v[240:243], a[24:27], a[48:51], v[240:243]
ds_read_b64_tr_b16 a[126:127], v11 offset:25600
s_add_u32 s31, s31, s32
v_mfma_f32_16x16x32_bf16 v[244:247], a[28:31], a[48:51], v[244:247]
s_add_u32 m0, s43, 5120
v_mfma_f32_16x16x32_bf16 v[56:59], a[0:3], a[52:55], v[56:59]
v_mfma_f32_16x16x32_bf16 v[60:63], a[4:7], a[52:55], v[60:63]
buffer_load_dwordx4 v3, s[12:15], s31 offen lds
v_mfma_f32_16x16x32_bf16 v[120:123], a[8:11], a[52:55], v[120:123]
v_mfma_f32_16x16x32_bf16 v[124:127], a[12:15], a[52:55], v[124:127]
s_add_u32 s31, s31, s33
v_mfma_f32_16x16x32_bf16 v[184:187], a[16:19], a[52:55], v[184:187]
s_add_u32 s38, s38, 32768
v_mfma_f32_16x16x32_bf16 v[188:191], a[20:23], a[52:55], v[188:191]
v_mfma_f32_16x16x32_bf16 v[248:251], a[24:27], a[52:55], v[248:251]
s_cmp_ge_u32 s38, s42
v_mfma_f32_16x16x32_bf16 v[252:255], a[28:31], a[52:55], v[252:255]
v_mfma_f32_16x16x32_bf16 v[64:67], a[0:3], a[56:59], v[64:67]
s_cselect_b32 s38, s41, s38
v_mfma_f32_16x16x32_bf16 v[68:71], a[4:7], a[56:59], v[68:71]
s_add_u32 s40, s45, 8192
v_mfma_f32_16x16x32_bf16 v[128:131], a[8:11], a[56:59], v[128:131]
v_mfma_f32_16x16x32_bf16 v[132:135], a[12:15], a[56:59], v[132:135]
buffer_store_dwordx4 a[160:163], v12, s[4:7], s40 offen sc1
v_mfma_f32_16x16x32_bf16 v[192:195], a[16:19], a[56:59], v[192:195]
v_mfma_f32_16x16x32_bf16 v[196:199], a[20:23], a[56:59], v[196:199]
s_add_u32 s40, s45, 9216
v_mfma_f32_16x16x32_bf16 a[128:131], a[24:27], a[56:59], a[128:131]
buffer_store_dwordx4 a[164:167], v12, s[4:7], s40 offen sc1
v_mfma_f32_16x16x32_bf16 a[132:135], a[28:31], a[56:59], a[132:135]
v_mfma_f32_16x16x32_bf16 v[72:75], a[0:3], a[60:63], v[72:75]
s_add_u32 s40, s45, 12288
v_mfma_f32_16x16x32_bf16 v[76:79], a[4:7], a[60:63], v[76:79]
v_mfma_f32_16x16x32_bf16 v[136:139], a[8:11], a[60:63], v[136:139]
buffer_store_dwordx4 a[168:171], v12, s[4:7], s40 offen sc1
v_mfma_f32_16x16x32_bf16 v[140:143], a[12:15], a[60:63], v[140:143]
s_add_u32 s40, s45, 13312
v_mfma_f32_16x16x32_bf16 v[200:203], a[16:19], a[60:63], v[200:203]
v_mfma_f32_16x16x32_bf16 v[204:207], a[20:23], a[60:63], v[204:207]
buffer_store_dwordx4 a[172:175], v12, s[4:7], s40 offen sc1
v_mfma_f32_16x16x32_bf16 a[136:139], a[24:27], a[60:63], a[136:139]
v_mfma_f32_16x16x32_bf16 a[140:143], a[28:31], a[60:63], a[140:143]
s_waitcnt vmcnt(24) lgkmcnt(0)
s_barrier
v_mfma_f32_16x16x32_bf16 v[16:19], a[64:67], a[96:99], v[16:19]
v_add_u32 v6, s37, v4
s_add_u32 m0, s34, 0
v_mfma_f32_16x16x32_bf16 v[20:23], a[68:71], a[96:99], v[20:23]
ds_read_b64_tr_b16 a[32:33], v8 offset:32768
buffer_load_dwordx4 v2, s[8:11], s28 offen lds
v_mfma_f32_16x16x32_bf16 v[80:83], a[72:75], a[96:99], v[80:83]
ds_read_b64_tr_b16 a[34:35], v8 offset:33792
v_mfma_f32_16x16x32_bf16 v[84:87], a[76:79], a[96:99], v[84:87]
s_add_u32 s28, s28, s29
v_mfma_f32_16x16x32_bf16 v[144:147], a[80:83], a[96:99], v[144:147]
ds_read_b128 a[0:3], v6 offset:0
v_mfma_f32_16x16x32_bf16 v[148:151], a[84:87], a[96:99], v[148:151]
ds_read_b128 a[4:7], v6 offset:2048
s_add_u32 m0, s34, 4096
v_mfma_f32_16x16x32_bf16 v[208:211], a[88:91], a[96:99], v[208:211]
v_mfma_f32_16x16x32_bf16 v[212:215], a[92:95], a[96:99], v[212:215]
ds_read_b128 a[8:11], v6 offset:4096
buffer_load_dwordx4 v2, s[8:11], s28 offen lds
v_mfma_f32_16x16x32_bf16 v[24:27], a[64:67], a[100:103], v[24:27]
v_mfma_f32_16x16x32_bf16 v[28:31], a[68:71], a[100:103], v[28:31]
ds_read_b128 a[12:15], v6 offset:6144
s_add_u32 s28, s28, s29
v_mfma_f32_16x16x32_bf16 v[88:91], a[72:75], a[100:103], v[88:91]
ds_read_b128 a[16:19], v6 offset:8192
s_add_u32 m0, s34, 8192
v_mfma_f32_16x16x32_bf16 v[92:95], a[76:79], a[100:103], v[92:95]
v_mfma_f32_16x16x32_bf16 v[152:155], a[80:83], a[100:103], v[152:155]
ds_read_b128 a[20:23], v6 offset:10240
buffer_load_dwordx4 v2, s[8:11], s28 offen lds
v_mfma_f32_16x16x32_bf16 v[156:159], a[84:87], a[100:103], v[156:159]
v_mfma_f32_16x16x32_bf16 v[216:219], a[88:91], a[100:103], v[216:219]
ds_read_b128 a[24:27], v6 offset:12288
s_add_u32 s28, s28, s29
v_mfma_f32_16x16x32_bf16 v[220:223], a[92:95], a[100:103], v[220:223]
ds_read_b128 a[28:31], v6 offset:14336
v_mfma_f32_16x16x32_bf16 v[32:35], a[64:67], a[104:107], v[32:35]
s_add_u32 m0, s34, 12288
v_mfma_f32_16x16x32_bf16 v[36:39], a[68:71], a[104:107], v[36:39]
ds_read_b64_tr_b16 a[36:37], v9 offset:32768
v_mfma_f32_16x16x32_bf16 v[96:99], a[72:75], a[104:107], v[96:99]
ds_read_b64_tr_b16 a[38:39], v9 offset:33792
buffer_load_dwordx4 v2, s[8:11], s28 offen lds
v_mfma_f32_16x16x32_bf16 v[100:103], a[76:79], a[104:107], v[100:103]
s_add_u32 s28, s28, s29
v_mfma_f32_16x16x32_bf16 v[160:163], a[80:83], a[104:107], v[160:163]
ds_read_b64_tr_b16 a[40:41], v10 offset:32768
v_mfma_f32_16x16x32_bf16 v[164:167], a[84:87], a[104:107], v[164:167]
s_add_u32 m0, s43, 16384
v_mfma_f32_16x16x32_bf16 v[224:227], a[88:91], a[104:107], v[224:227]
ds_read_b64_tr_b16 a[42:43], v10 offset:33792
v_mfma_f32_16x16x32_bf16 v[228:231], a[92:95], a[104:107], v[228:231]
ds_read_b64_tr_b16 a[44:45], v11 offset:32768
buffer_load_dwordx4 v3, s[12:15], s31 offen lds
v_mfma_f32_16x16x32_bf16 v[40:43], a[64:67], a[108:111], v[40:43]
v_mfma_f32_16x16x32_bf16 v[44:47], a[68:71], a[108:111], v[44:47]
ds_read_b64_tr_b16 a[46:47], v11 offset:33792
s_add_u32 s31, s31, s32
v_mfma_f32_16x16x32_bf16 v[104:107], a[72:75], a[108:111], v[104:107]
v_mfma_f32_16x16x32_bf16 v[108:111], a[76:79], a[108:111], v[108:111]
ds_read_b64_tr_b16 a[48:49], v8 offset:40960
s_add_u32 m0, s43, 17408
v_mfma_f32_16x16x32_bf16 v[168:171], a[80:83], a[108:111], v[168:171]
ds_read_b64_tr_b16 a[50:51], v8 offset:41984
buffer_load_dwordx4 v3, s[12:15], s31 offen lds
v_mfma_f32_16x16x32_bf16 v[172:175], a[84:87], a[108:111], v[172:175]
v_mfma_f32_16x16x32_bf16 v[232:235], a[88:91], a[108:111], v[232:235]
ds_read_b64_tr_b16 a[52:53], v9 offset:40960
s_add_u32 s31, s31, s33
v_mfma_f32_16x16x32_bf16 v[236:239], a[92:95], a[108:111], v[236:239]
ds_read_b64_tr_b16 a[54:55], v9 offset:41984
v_mfma_f32_16x16x32_bf16 v[48:51], a[64:67], a[112:115], v[48:51]
s_add_u32 m0, s43, 20480
v_mfma_f32_16x16x32_bf16 v[52:55], a[68:71], a[112:115], v[52:55]
ds_read_b64_tr_b16 a[56:57], v10 offset:40960
v_mfma_f32_16x16x32_bf16 v[112:115], a[72:75], a[112:115], v[112:115]
buffer_load_dwordx4 v3, s[12:15], s31 offen lds
v_mfma_f32_16x16x32_bf16 v[116:119], a[76:79], a[112:115], v[116:119]
ds_read_b64_tr_b16 a[58:59], v10 offset:41984
v_mfma_f32_16x16x32_bf16 v[176:179], a[80:83], a[112:115], v[176:179]
ds_read_b64_tr_b16 a[60:61], v11 offset:40960
s_add_u32 s31, s31, s32
v_mfma_f32_16x16x32_bf16 v[180:183], a[84:87], a[112:115], v[180:183]
s_add_u32 m0, s43, 21504
v_mfma_f32_16x16x32_bf16 v[240:243], a[88:91], a[112:115], v[240:243]
ds_read_b64_tr_b16 a[62:63], v11 offset:41984
v_mfma_f32_16x16x32_bf16 v[244:247], a[92:95], a[112:115], v[244:247]
buffer_load_dwordx4 v3, s[12:15], s31 offen lds
v_mfma_f32_16x16x32_bf16 v[56:59], a[64:67], a[116:119], v[56:59]
v_mfma_f32_16x16x32_bf16 v[60:63], a[68:71], a[116:119], v[60:63]
s_add_u32 s31, s31, s33
v_mfma_f32_16x16x32_bf16 v[120:123], a[72:75], a[116:119], v[120:123]
v_mfma_f32_16x16x32_bf16 v[124:127], a[76:79], a[116:119], v[124:127]
s_add_u32 s37, s37, 32768
v_mfma_f32_16x16x32_bf16 v[184:187], a[80:83], a[116:119], v[184:187]
v_mfma_f32_16x16x32_bf16 v[188:191], a[84:87], a[116:119], v[188:191]
s_cmp_ge_u32 s37, s42
v_mfma_f32_16x16x32_bf16 v[248:251], a[88:91], a[116:119], v[248:251]
s_cselect_b32 s37, s41, s37
v_mfma_f32_16x16x32_bf16 v[252:255], a[92:95], a[116:119], v[252:255]
v_mfma_f32_16x16x32_bf16 v[64:67], a[64:67], a[120:123], v[64:67]
s_add_u32 s40, s45, 16384
v_mfma_f32_16x16x32_bf16 v[68:71], a[68:71], a[120:123], v[68:71]
v_mfma_f32_16x16x32_bf16 v[128:131], a[72:75], a[120:123], v[128:131]
buffer_store_dwordx4 a[176:179], v12, s[4:7], s40 offen sc1
v_mfma_f32_16x16x32_bf16 v[132:135], a[76:79], a[120:123], v[132:135]
v_mfma_f32_16x16x32_bf16 v[192:195], a[80:83], a[120:123], v[192:195]
s_add_u32 s40, s45, 17408
v_mfma_f32_16x16x32_bf16 v[196:199], a[84:87], a[120:123], v[196:199]
v_mfma_f32_16x16x32_bf16 a[128:131], a[88:91], a[120:123], a[128:131]
buffer_store_dwordx4 a[180:183], v12, s[4:7], s40 offen sc1
v_mfma_f32_16x16x32_bf16 a[132:135], a[92:95], a[120:123], a[132:135]
s_add_u32 s40, s45, 20480
v_mfma_f32_16x16x32_bf16 v[72:75], a[64:67], a[124:127], v[72:75]
v_mfma_f32_16x16x32_bf16 v[76:79], a[68:71], a[124:127], v[76:79]
buffer_store_dwordx4 a[184:187], v12, s[4:7], s40 offen sc1
v_mfma_f32_16x16x32_bf16 v[136:139], a[72:75], a[124:127], v[136:139]
v_mfma_f32_16x16x32_bf16 v[140:143], a[76:79], a[124:127], v[140:143]
s_add_u32 s40, s45, 21504
v_mfma_f32_16x16x32_bf16 v[200:203], a[80:83], a[124:127], v[200:203]
v_mfma_f32_16x16x32_bf16 v[204:207], a[84:87], a[124:127], v[204:207]
buffer_store_dwordx4 a[188:191], v12, s[4:7], s40 offen sc1
v_mfma_f32_16x16x32_bf16 a[136:139], a[88:91], a[124:127], a[136:139]
v_mfma_f32_16x16x32_bf16 a[140:143], a[92:95], a[124:127], a[140:143]
s_waitcnt vmcnt(28) lgkmcnt(0)
s_barrier
v_mfma_f32_16x16x32_bf16 v[16:19], a[0:3], a[32:35], v[16:19]
v_add_u32 v7, s38, v5
s_add_u32 m0, s34, 16384
v_mfma_f32_16x16x32_bf16 v[20:23], a[4:7], a[32:35], v[20:23]
ds_read_b64_tr_b16 a[96:97], v8 offset:49152
buffer_load_dwordx4 v2, s[8:11], s28 offen lds
v_mfma_f32_16x16x32_bf16 v[80:83], a[8:11], a[32:35], v[80:83]
ds_read_b64_tr_b16 a[98:99], v8 offset:50176
v_mfma_f32_16x16x32_bf16 v[84:87], a[12:15], a[32:35], v[84:87]
s_add_u32 s28, s28, s29
v_mfma_f32_16x16x32_bf16 v[144:147], a[16:19], a[32:35], v[144:147]
ds_read_b128 a[64:67], v7 offset:0
s_add_u32 m0, s34, 20480
v_mfma_f32_16x16x32_bf16 v[148:151], a[20:23], a[32:35], v[148:151]
ds_read_b128 a[68:71], v7 offset:2048
v_mfma_f32_16x16x32_bf16 v[208:211], a[24:27], a[32:35], v[208:211]
buffer_load_dwordx4 v2, s[8:11], s28 offen lds
v_mfma_f32_16x16x32_bf16 v[212:215], a[28:31], a[32:35], v[212:215]
ds_read_b128 a[72:75], v7 offset:4096
v_mfma_f32_16x16x32_bf16 v[24:27], a[0:3], a[36:39], v[24:27]
s_add_u32 s28, s28, s29
v_mfma_f32_16x16x32_bf16 v[28:31], a[4:7], a[36:39], v[28:31]
ds_read_b128 a[76:79], v7 offset:6144
s_add_u32 m0, s34, 24576
v_mfma_f32_16x16x32_bf16 v[88:91], a[8:11], a[36:39], v[88:91]
ds_read_b128 a[80:83], v7 offset:8192
v_mfma_f32_16x16x32_bf16 v[92:95], a[12:15], a[36:39], v[92:95]
buffer_load_dwordx4 v2, s[8:11], s28 offen lds
v_mfma_f32_16x16x32_bf16 v[152:155], a[16:19], a[36:39], v[152:155]
ds_read_b128 a[84:87], v7 offset:10240
v_mfma_f32_16x16x32_bf16 v[156:159], a[20:23], a[36:39], v[156:159]
s_add_u32 s28, s28, s29
v_mfma_f32_16x16x32_bf16 v[216:219], a[24:27], a[36:39], v[216:219]
ds_read_b128 a[88:91], v7 offset:12288
s_add_u32 m0, s34, 28672
v_mfma_f32_16x16x32_bf16 v[220:223], a[28:31], a[36:39], v[220:223]
ds_read_b128 a[92:95], v7 offset:14336
v_mfma_f32_16x16x32_bf16 v[32:35], a[0:3], a[40:43], v[32:35]
buffer_load_dwordx4 v2, s[8:11], s28 offen lds
v_mfma_f32_16x16x32_bf16 v[36:39], a[4:7], a[40:43], v[36:39]
ds_read_b64_tr_b16 a[100:101], v9 offset:49152
v_mfma_f32_16x16x32_bf16 v[96:99], a[8:11], a[40:43], v[96:99]
ds_read_b64_tr_b16 a[102:103], v9 offset:50176
s_add_u32 s28, s28, s30
v_mfma_f32_16x16x32_bf16 v[100:103], a[12:15], a[40:43], v[100:103]
s_add_u32 s34, s34, 32768
v_mfma_f32_16x16x32_bf16 v[160:163], a[16:19], a[40:43], v[160:163]
ds_read_b64_tr_b16 a[104:105], v10 offset:49152
v_mfma_f32_16x16x32_bf16 v[164:167], a[20:23], a[40:43], v[164:167]
s_cmp_ge_u32 s34, s36
v_mfma_f32_16x16x32_bf16 v[224:227], a[24:27], a[40:43], v[224:227]
ds_read_b64_tr_b16 a[106:107], v10 offset:50176
v_mfma_f32_16x16x32_bf16 v[228:231], a[28:31], a[40:43], v[228:231]
ds_read_b64_tr_b16 a[108:109], v11 offset:49152
s_cselect_b32 s34, s35, s34
v_mfma_f32_16x16x32_bf16 v[40:43], a[0:3], a[44:47], v[40:43]
s_add_u32 m0, s43, 32768
v_mfma_f32_16x16x32_bf16 v[44:47], a[4:7], a[44:47], v[44:47]
ds_read_b64_tr_b16 a[110:111], v11 offset:50176
v_mfma_f32_16x16x32_bf16 v[104:107], a[8:11], a[44:47], v[104:107]
buffer_load_dwordx4 v3, s[12:15], s31 offen lds
v_mfma_f32_16x16x32_bf16 v[108:111], a[12:15], a[44:47], v[108:111]
ds_read_b64_tr_b16 a[112:113], v8 offset:57344
v_mfma_f32_16x16x32_bf16 v[168:171], a[16:19], a[44:47], v[168:171]
ds_read_b64_tr_b16 a[114:115], v8 offset:58368
s_add_u32 s31, s31, s32
v_mfma_f32_16x16x32_bf16 v[172:175], a[20:23], a[44:47], v[172:175]
s_add_u32 m0, s43, 33792
v_mfma_f32_16x16x32_bf16 v[232:235], a[24:27], a[44:47], v[232:235]
ds_read_b64_tr_b16 a[116:117], v9 offset:57344
v_mfma_f32_16x16x32_bf16 v[236:239], a[28:31], a[44:47], v[236:239]
ds_read_b64_tr_b16 a[118:119], v9 offset:58368
buffer_load_dwordx4 v3, s[12:15], s31 offen lds
v_mfma_f32_16x16x32_bf16 v[48:51], a[0:3], a[48:51], v[48:51]
v_mfma_f32_16x16x32_bf16 v[52:55], a[4:7], a[48:51], v[52:55]
ds_read_b64_tr_b16 a[120:121], v10 offset:57344
s_add_u32 s31, s31, s33
v_mfma_f32_16x16x32_bf16 v[112:115], a[8:11], a[48:51], v[112:115]
s_add_u32 m0, s43, 36864
v_mfma_f32_16x16x32_bf16 v[116:119], a[12:15], a[48:51], v[116:119]
ds_read_b64_tr_b16 a[122:123], v10 offset:58368
v_mfma_f32_16x16x32_bf16 v[176:179], a[16:19], a[48:51], v[176:179]
ds_read_b64_tr_b16 a[124:125], v11 offset:57344
buffer_load_dwordx4 v3, s[12:15], s31 offen lds
v_mfma_f32_16x16x32_bf16 v[180:183], a[20:23], a[48:51], v[180:183]
v_mfma_f32_16x16x32_bf16 v[240:243], a[24:27], a[48:51], v[240:243]
ds_read_b64_tr_b16 a[126:127], v11 offset:58368
s_add_u32 s31, s31, s32
v_mfma_f32_16x16x32_bf16 v[244:247], a[28:31], a[48:51], v[244:247]
s_add_u32 m0, s43, 37888
v_mfma_f32_16x16x32_bf16 v[56:59], a[0:3], a[52:55], v[56:59]
v_mfma_f32_16x16x32_bf16 v[60:63], a[4:7], a[52:55], v[60:63]
buffer_load_dwordx4 v3, s[12:15], s31 offen lds
v_mfma_f32_16x16x32_bf16 v[120:123], a[8:11], a[52:55], v[120:123]
v_mfma_f32_16x16x32_bf16 v[124:127], a[12:15], a[52:55], v[124:127]
s_add_u32 s31, s31, s33
v_mfma_f32_16x16x32_bf16 v[184:187], a[16:19], a[52:55], v[184:187]
s_add_u32 s38, s38, 32768
v_mfma_f32_16x16x32_bf16 v[188:191], a[20:23], a[52:55], v[188:191]
v_mfma_f32_16x16x32_bf16 v[248:251], a[24:27], a[52:55], v[248:251]
s_cmp_ge_u32 s38, s42
v_mfma_f32_16x16x32_bf16 v[252:255], a[28:31], a[52:55], v[252:255]
v_mfma_f32_16x16x32_bf16 v[64:67], a[0:3], a[56:59], v[64:67]
s_cselect_b32 s38, s41, s38
v_mfma_f32_16x16x32_bf16 v[68:71], a[4:7], a[56:59], v[68:71]
s_add_u32 s40, s45, 24576
v_mfma_f32_16x16x32_bf16 v[128:131], a[8:11], a[56:59], v[128:131]
v_mfma_f32_16x16x32_bf16 v[132:135], a[12:15], a[56:59], v[132:135]
buffer_store_dwordx4 a[192:195], v12, s[4:7], s40 offen sc1
v_mfma_f32_16x16x32_bf16 v[192:195], a[16:19], a[56:59], v[192:195]
v_mfma_f32_16x16x32_bf16 v[196:199], a[20:23], a[56:59], v[196:199]
s_add_u32 s40, s45, 25600
v_mfma_f32_16x16x32_bf16 a[128:131], a[24:27], a[56:59], a[128:131]
buffer_store_dwordx4 a[196:199], v12, s[4:7], s40 offen sc1
v_mfma_f32_16x16x32_bf16 a[132:135], a[28:31], a[56:59], a[132:135]
v_mfma_f32_16x16x32_bf16 v[72:75], a[0:3], a[60:63], v[72:75]
s_add_u32 s40, s45, 28672
v_mfma_f32_16x16x32_bf16 v[76:79], a[4:7], a[60:63], v[76:79]
v_mfma_f32_16x16x32_bf16 v[136:139], a[8:11], a[60:63], v[136:139]
buffer_store_dwordx4 a[200:203], v12, s[4:7], s40 offen sc1
v_mfma_f32_16x16x32_bf16 v[140:143], a[12:15], a[60:63], v[140:143]
s_add_u32 s40, s45, 29696
v_mfma_f32_16x16x32_bf16 v[200:203], a[16:19], a[60:63], v[200:203]
v_mfma_f32_16x16x32_bf16 v[204:207], a[20:23], a[60:63], v[204:207]
buffer_store_dwordx4 a[204:207], v12, s[4:7], s40 offen sc1
v_mfma_f32_16x16x32_bf16 a[136:139], a[24:27], a[60:63], a[136:139]
v_mfma_f32_16x16x32_bf16 a[140:143], a[28:31], a[60:63], a[140:143]
s_waitcnt vmcnt(28) lgkmcnt(0)
s_barrier
v_mfma_f32_16x16x32_bf16 v[16:19], a[64:67], a[96:99], v[16:19]
v_add_u32 v6, s37, v4
s_add_u32 m0, s34, 0
v_mfma_f32_16x16x32_bf16 v[20:23], a[68:71], a[96:99], v[20:23]
ds_read_b64_tr_b16 a[32:33], v8 offset:0
buffer_load_dwordx4 v2, s[8:11], s28 offen lds
v_mfma_f32_16x16x32_bf16 v[80:83], a[72:75], a[96:99], v[80:83]
ds_read_b64_tr_b16 a[34:35], v8 offset:1024
v_mfma_f32_16x16x32_bf16 v[84:87], a[76:79], a[96:99], v[84:87]
s_add_u32 s28, s28, s29
v_mfma_f32_16x16x32_bf16 v[144:147], a[80:83], a[96:99], v[144:147]
ds_read_b128 a[0:3], v6 offset:0
v_mfma_f32_16x16x32_bf16 v[148:151], a[84:87], a[96:99], v[148:151]
ds_read_b128 a[4:7], v6 offset:2048
s_add_u32 m0, s34, 4096
v_mfma_f32_16x16x32_bf16 v[208:211], a[88:91], a[96:99], v[208:211]
v_mfma_f32_16x16x32_bf16 v[212:215], a[92:95], a[96:99], v[212:215]
ds_read_b128 a[8:11], v6 offset:4096
buffer_load_dwordx4 v2, s[8:11], s28 offen lds
v_mfma_f32_16x16x32_bf16 v[24:27], a[64:67], a[100:103], v[24:27]
v_mfma_f32_16x16x32_bf16 v[28:31], a[68:71], a[100:103], v[28:31]
ds_read_b128 a[12:15], v6 offset:6144
s_add_u32 s28, s28, s29
v_mfma_f32_16x16x32_bf16 v[88:91], a[72:75], a[100:103], v[88:91]
ds_read_b128 a[16:19], v6 offset:8192
s_add_u32 m0, s34, 8192
v_mfma_f32_16x16x32_bf16 v[92:95], a[76:79], a[100:103], v[92:95]
v_mfma_f32_16x16x32_bf16 v[152:155], a[80:83], a[100:103], v[152:155]
ds_read_b128 a[20:23], v6 offset:10240
buffer_load_dwordx4 v2, s[8:11], s28 offen lds
v_mfma_f32_16x16x32_bf16 v[156:159], a[84:87], a[100:103], v[156:159]
v_mfma_f32_16x16x32_bf16 v[216:219], a[88:91], a[100:103], v[216:219]
ds_read_b128 a[24:27], v6 offset:12288
s_add_u32 s28, s28, s29
v_mfma_f32_16x16x32_bf16 v[220:223], a[92:95], a[100:103], v[220:223]
ds_read_b128 a[28:31], v6 offset:14336
v_mfma_f32_16x16x32_bf16 v[32:35], a[64:67], a[104:107], v[32:35]
s_add_u32 m0, s34, 12288
v_mfma_f32_16x16x32_bf16 v[36:39], a[68:71], a[104:107], v[36:39]
ds_read_b64_tr_b16 a[36:37], v9 offset:0
v_mfma_f32_16x16x32_bf16 v[96:99], a[72:75], a[104:107], v[96:99]
ds_read_b64_tr_b16 a[38:39], v9 offset:1024
buffer_load_dwordx4 v2, s[8:11], s28 offen lds
v_mfma_f32_16x16x32_bf16 v[100:103], a[76:79], a[104:107], v[100:103]
s_add_u32 s28, s28, s29
v_mfma_f32_16x16x32_bf16 v[160:163], a[80:83], a[104:107], v[160:163]
ds_read_b64_tr_b16 a[40:41], v10 offset:0
v_mfma_f32_16x16x32_bf16 v[164:167], a[84:87], a[104:107], v[164:167]
s_add_u32 m0, s43, 49152
v_mfma_f32_16x16x32_bf16 v[224:227], a[88:91], a[104:107], v[224:227]
ds_read_b64_tr_b16 a[42:43], v10 offset:1024
v_mfma_f32_16x16x32_bf16 v[228:231], a[92:95], a[104:107], v[228:231]
ds_read_b64_tr_b16 a[44:45], v11 offset:0
buffer_load_dwordx4 v3, s[12:15], s31 offen lds
v_mfma_f32_16x16x32_bf16 v[40:43], a[64:67], a[108:111], v[40:43]
v_mfma_f32_16x16x32_bf16 v[44:47], a[68:71], a[108:111], v[44:47]
ds_read_b64_tr_b16 a[46:47], v11 offset:1024
s_add_u32 s31, s31, s32
v_mfma_f32_16x16x32_bf16 v[104:107], a[72:75], a[108:111], v[104:107]
v_mfma_f32_16x16x32_bf16 v[108:111], a[76:79], a[108:111], v[108:111]
ds_read_b64_tr_b16 a[48:49], v8 offset:8192
s_add_u32 m0, s43, 50176
v_mfma_f32_16x16x32_bf16 v[168:171], a[80:83], a[108:111], v[168:171]
ds_read_b64_tr_b16 a[50:51], v8 offset:9216
buffer_load_dwordx4 v3, s[12:15], s31 offen lds
v_mfma_f32_16x16x32_bf16 v[172:175], a[84:87], a[108:111], v[172:175]
v_mfma_f32_16x16x32_bf16 v[232:235], a[88:91], a[108:111], v[232:235]
ds_read_b64_tr_b16 a[52:53], v9 offset:8192
s_add_u32 s31, s31, s33
v_mfma_f32_16x16x32_bf16 v[236:239], a[92:95], a[108:111], v[236:239]
ds_read_b64_tr_b16 a[54:55], v9 offset:9216
v_mfma_f32_16x16x32_bf16 v[48:51], a[64:67], a[112:115], v[48:51]
s_add_u32 m0, s43, 53248
v_mfma_f32_16x16x32_bf16 v[52:55], a[68:71], a[112:115], v[52:55]
ds_read_b64_tr_b16 a[56:57], v10 offset:8192
v_mfma_f32_16x16x32_bf16 v[112:115], a[72:75], a[112:115], v[112:115]
buffer_load_dwordx4 v3, s[12:15], s31 offen lds
v_mfma_f32_16x16x32_bf16 v[116:119], a[76:79], a[112:115], v[116:119]
ds_read_b64_tr_b16 a[58:59], v10 offset:9216
v_mfma_f32_16x16x32_bf16 v[176:179], a[80:83], a[112:115], v[176:179]
ds_read_b64_tr_b16 a[60:61], v11 offset:8192
s_add_u32 s31, s31, s32
v_mfma_f32_16x16x32_bf16 v[180:183], a[84:87], a[112:115], v[180:183]
s_add_u32 m0, s43, 54272
v_mfma_f32_16x16x32_bf16 v[240:243], a[88:91], a[112:115], v[240:243]
ds_read_b64_tr_b16 a[62:63], v11 offset:9216
v_mfma_f32_16x16x32_bf16 v[244:247], a[92:95], a[112:115], v[244:247]
buffer_load_dwordx4 v3, s[12:15], s31 offen lds
v_mfma_f32_16x16x32_bf16 v[56:59], a[64:67], a[116:119], v[56:59]
v_mfma_f32_16x16x32_bf16 v[60:63], a[68:71], a[116:119], v[60:63]
s_add_u32 s31, s31, s33
v_mfma_f32_16x16x32_bf16 v[120:123], a[72:75], a[116:119], v[120:123]
v_mfma_f32_16x16x32_bf16 v[124:127], a[76:79], a[116:119], v[124:127]
s_add_u32 s37, s37, 32768
v_mfma_f32_16x16x32_bf16 v[184:187], a[80:83], a[116:119], v[184:187]
v_mfma_f32_16x16x32_bf16 v[188:191], a[84:87], a[116:119], v[188:191]
s_cmp_ge_u32 s37, s42
v_mfma_f32_16x16x32_bf16 v[248:251], a[88:91], a[116:119], v[248:251]
s_cselect_b32 s37, s41, s37
v_mfma_f32_16x16x32_bf16 v[252:255], a[92:95], a[116:119], v[252:255]
v_mfma_f32_16x16x32_bf16 v[64:67], a[64:67], a[120:123], v[64:67]
s_add_u32 s40, s45, 32768
v_mfma_f32_16x16x32_bf16 v[68:71], a[68:71], a[120:123], v[68:71]
v_mfma_f32_16x16x32_bf16 v[128:131], a[72:75], a[120:123], v[128:131]
buffer_store_dwordx4 a[208:211], v12, s[4:7], s40 offen sc1
v_mfma_f32_16x16x32_bf16 v[132:135], a[76:79], a[120:123], v[132:135]
v_mfma_f32_16x16x32_bf16 v[192:195], a[80:83], a[120:123], v[192:195]
s_add_u32 s40, s45, 33792
v_mfma_f32_16x16x32_bf16 v[196:199], a[84:87], a[120:123], v[196:199]
v_mfma_f32_16x16x32_bf16 a[128:131], a[88:91], a[120:123], a[128:131]
buffer_store_dwordx4 a[212:215], v12, s[4:7], s40 offen sc1
v_mfma_f32_16x16x32_bf16 a[132:135], a[92:95], a[120:123], a[132:135]
s_add_u32 s40, s45, 36864
v_mfma_f32_16x16x32_bf16 v[72:75], a[64:67], a[124:127], v[72:75]
v_mfma_f32_16x16x32_bf16 v[76:79], a[68:71], a[124:127], v[76:79]
buffer_store_dwordx4 a[216:219], v12, s[4:7], s40 offen sc1
v_mfma_f32_16x16x32_bf16 v[136:139], a[72:75], a[124:127], v[136:139]
v_mfma_f32_16x16x32_bf16 v[140:143], a[76:79], a[124:127], v[140:143]
s_add_u32 s40, s45, 37888
v_mfma_f32_16x16x32_bf16 v[200:203], a[80:83], a[124:127], v[200:203]
v_mfma_f32_16x16x32_bf16 v[204:207], a[84:87], a[124:127], v[204:207]
buffer_store_dwordx4 a[220:223], v12, s[4:7], s40 offen sc1
v_mfma_f32_16x16x32_bf16 a[136:139], a[88:91], a[124:127], a[136:139]
v_mfma_f32_16x16x32_bf16 a[140:143], a[92:95], a[124:127], a[140:143]
s_waitcnt vmcnt(28) lgkmcnt(0)
s_barrier
v_mfma_f32_16x16x32_bf16 v[16:19], a[0:3], a[32:35], v[16:19]
v_add_u32 v7, s38, v5
s_add_u32 m0, s34, 16384
v_mfma_f32_16x16x32_bf16 v[20:23], a[4:7], a[32:35], v[20:23]
ds_read_b64_tr_b16 a[96:97], v8 offset:16384
buffer_load_dwordx4 v2, s[8:11], s28 offen lds
v_mfma_f32_16x16x32_bf16 v[80:83], a[8:11], a[32:35], v[80:83]
ds_read_b64_tr_b16 a[98:99], v8 offset:17408
v_mfma_f32_16x16x32_bf16 v[84:87], a[12:15], a[32:35], v[84:87]
s_add_u32 s28, s28, s29
v_mfma_f32_16x16x32_bf16 v[144:147], a[16:19], a[32:35], v[144:147]
ds_read_b128 a[64:67], v7 offset:0
s_add_u32 m0, s34, 20480
v_mfma_f32_16x16x32_bf16 v[148:151], a[20:23], a[32:35], v[148:151]
ds_read_b128 a[68:71], v7 offset:2048
v_mfma_f32_16x16x32_bf16 v[208:211], a[24:27], a[32:35], v[208:211]
buffer_load_dwordx4 v2, s[8:11], s28 offen lds
v_mfma_f32_16x16x32_bf16 v[212:215], a[28:31], a[32:35], v[212:215]
ds_read_b128 a[72:75], v7 offset:4096
v_mfma_f32_16x16x32_bf16 v[24:27], a[0:3], a[36:39], v[24:27]
s_add_u32 s28, s28, s29
v_mfma_f32_16x16x32_bf16 v[28:31], a[4:7], a[36:39], v[28:31]
ds_read_b128 a[76:79], v7 offset:6144
s_add_u32 m0, s34, 24576
v_mfma_f32_16x16x32_bf16 v[88:91], a[8:11], a[36:39], v[88:91]
ds_read_b128 a[80:83], v7 offset:8192
v_mfma_f32_16x16x32_bf16 v[92:95], a[12:15], a[36:39], v[92:95]
buffer_load_dwordx4 v2, s[8:11], s28 offen lds
v_mfma_f32_16x16x32_bf16 v[152:155], a[16:19], a[36:39], v[152:155]
ds_read_b128 a[84:87], v7 offset:10240
v_mfma_f32_16x16x32_bf16 v[156:159], a[20:23], a[36:39], v[156:159]
s_add_u32 s28, s28, s29
v_mfma_f32_16x16x32_bf16 v[216:219], a[24:27], a[36:39], v[216:219]
ds_read_b128 a[88:91], v7 offset:12288
s_add_u32 m0, s34, 28672
v_mfma_f32_16x16x32_bf16 v[220:223], a[28:31], a[36:39], v[220:223]
ds_read_b128 a[92:95], v7 offset:14336
v_mfma_f32_16x16x32_bf16 v[32:35], a[0:3], a[40:43], v[32:35]
buffer_load_dwordx4 v2, s[8:11], s28 offen lds
v_mfma_f32_16x16x32_bf16 v[36:39], a[4:7], a[40:43], v[36:39]
ds_read_b64_tr_b16 a[100:101], v9 offset:16384
v_mfma_f32_16x16x32_bf16 v[96:99], a[8:11], a[40:43], v[96:99]
ds_read_b64_tr_b16 a[102:103], v9 offset:17408
s_add_u32 s28, s28, s30
v_mfma_f32_16x16x32_bf16 v[100:103], a[12:15], a[40:43], v[100:103]
s_add_u32 s34, s34, 32768
v_mfma_f32_16x16x32_bf16 v[160:163], a[16:19], a[40:43], v[160:163]
ds_read_b64_tr_b16 a[104:105], v10 offset:16384
v_mfma_f32_16x16x32_bf16 v[164:167], a[20:23], a[40:43], v[164:167]
s_cmp_ge_u32 s34, s36
v_mfma_f32_16x16x32_bf16 v[224:227], a[24:27], a[40:43], v[224:227]
ds_read_b64_tr_b16 a[106:107], v10 offset:17408
v_mfma_f32_16x16x32_bf16 v[228:231], a[28:31], a[40:43], v[228:231]
ds_read_b64_tr_b16 a[108:109], v11 offset:16384
s_cselect_b32 s34, s35, s34
v_mfma_f32_16x16x32_bf16 v[40:43], a[0:3], a[44:47], v[40:43]
s_add_u32 m0, s43, 0
v_mfma_f32_16x16x32_bf16 v[44:47], a[4:7], a[44:47], v[44:47]
ds_read_b64_tr_b16 a[110:111], v11 offset:17408
v_mfma_f32_16x16x32_bf16 v[104:107], a[8:11], a[44:47], v[104:107]
buffer_load_dwordx4 v3, s[12:15], s31 offen lds
v_mfma_f32_16x16x32_bf16 v[108:111], a[12:15], a[44:47], v[108:111]
ds_read_b64_tr_b16 a[112:113], v8 offset:24576
v_mfma_f32_16x16x32_bf16 v[168:171], a[16:19], a[44:47], v[168:171]
ds_read_b64_tr_b16 a[114:115], v8 offset:25600
s_add_u32 s31, s31, s32
v_mfma_f32_16x16x32_bf16 v[172:175], a[20:23], a[44:47], v[172:175]
s_add_u32 m0, s43, 1024
v_mfma_f32_16x16x32_bf16 v[232:235], a[24:27], a[44:47], v[232:235]
ds_read_b64_tr_b16 a[116:117], v9 offset:24576
v_mfma_f32_16x16x32_bf16 v[236:239], a[28:31], a[44:47], v[236:239]
ds_read_b64_tr_b16 a[118:119], v9 offset:25600
buffer_load_dwordx4 v3, s[12:15], s31 offen lds
v_mfma_f32_16x16x32_bf16 v[48:51], a[0:3], a[48:51], v[48:51]
v_mfma_f32_16x16x32_bf16 v[52:55], a[4:7], a[48:51], v[52:55]
ds_read_b64_tr_b16 a[120:121], v10 offset:24576
s_add_u32 s31, s31, s33
v_mfma_f32_16x16x32_bf16 v[112:115], a[8:11], a[48:51], v[112:115]
s_add_u32 m0, s43, 4096
v_mfma_f32_16x16x32_bf16 v[116:119], a[12:15], a[48:51], v[116:119]
ds_read_b64_tr_b16 a[122:123], v10 offset:25600
v_mfma_f32_16x16x32_bf16 v[176:179], a[16:19], a[48:51], v[176:179]
ds_read_b64_tr_b16 a[124:125], v11 offset:24576
buffer_load_dwordx4 v3, s[12:15], s31 offen lds
v_mfma_f32_16x16x32_bf16 v[180:183], a[20:23], a[48:51], v[180:183]
v_mfma_f32_16x16x32_bf16 v[240:243], a[24:27], a[48:51], v[240:243]
ds_read_b64_tr_b16 a[126:127], v11 offset:25600
s_add_u32 s31, s31, s32
v_mfma_f32_16x16x32_bf16 v[244:247], a[28:31], a[48:51], v[244:247]
s_add_u32 m0, s43, 5120
v_mfma_f32_16x16x32_bf16 v[56:59], a[0:3], a[52:55], v[56:59]
v_mfma_f32_16x16x32_bf16 v[60:63], a[4:7], a[52:55], v[60:63]
buffer_load_dwordx4 v3, s[12:15], s31 offen lds
v_mfma_f32_16x16x32_bf16 v[120:123], a[8:11], a[52:55], v[120:123]
v_mfma_f32_16x16x32_bf16 v[124:127], a[12:15], a[52:55], v[124:127]
s_add_u32 s31, s31, s33
v_mfma_f32_16x16x32_bf16 v[184:187], a[16:19], a[52:55], v[184:187]
s_add_u32 s38, s38, 32768
v_mfma_f32_16x16x32_bf16 v[188:191], a[20:23], a[52:55], v[188:191]
v_mfma_f32_16x16x32_bf16 v[248:251], a[24:27], a[52:55], v[248:251]
s_cmp_ge_u32 s38, s42
v_mfma_f32_16x16x32_bf16 v[252:255], a[28:31], a[52:55], v[252:255]
v_mfma_f32_16x16x32_bf16 v[64:67], a[0:3], a[56:59], v[64:67]
s_cselect_b32 s38, s41, s38
v_mfma_f32_16x16x32_bf16 v[68:71], a[4:7], a[56:59], v[68:71]
s_add_u32 s40, s45, 40960
v_mfma_f32_16x16x32_bf16 v[128:131], a[8:11], a[56:59], v[128:131]
v_mfma_f32_16x16x32_bf16 v[132:135], a[12:15], a[56:59], v[132:135]
buffer_store_dwordx4 a[224:227], v12, s[4:7], s40 offen sc1
v_mfma_f32_16x16x32_bf16 v[192:195], a[16:19], a[56:59], v[192:195]
v_mfma_f32_16x16x32_bf16 v[196:199], a[20:23], a[56:59], v[196:199]
s_add_u32 s40, s45, 41984
v_mfma_f32_16x16x32_bf16 a[128:131], a[24:27], a[56:59], a[128:131]
buffer_store_dwordx4 a[228:231], v12, s[4:7], s40 offen sc1
v_mfma_f32_16x16x32_bf16 a[132:135], a[28:31], a[56:59], a[132:135]
v_mfma_f32_16x16x32_bf16 v[72:75], a[0:3], a[60:63], v[72:75]
s_add_u32 s40, s45, 45056
v_mfma_f32_16x16x32_bf16 v[76:79], a[4:7], a[60:63], v[76:79]
v_mfma_f32_16x16x32_bf16 v[136:139], a[8:11], a[60:63], v[136:139]
buffer_store_dwordx4 a[232:235], v12, s[4:7], s40 offen sc1
v_mfma_f32_16x16x32_bf16 v[140:143], a[12:15], a[60:63], v[140:143]
s_add_u32 s40, s45, 46080
v_mfma_f32_16x16x32_bf16 v[200:203], a[16:19], a[60:63], v[200:203]
v_mfma_f32_16x16x32_bf16 v[204:207], a[20:23], a[60:63], v[204:207]
buffer_store_dwordx4 a[236:239], v12, s[4:7], s40 offen sc1
v_mfma_f32_16x16x32_bf16 a[136:139], a[24:27], a[60:63], a[136:139]
v_mfma_f32_16x16x32_bf16 a[140:143], a[28:31], a[60:63], a[140:143]
s_waitcnt vmcnt(28) lgkmcnt(0)
s_barrier
v_mfma_f32_16x16x32_bf16 v[16:19], a[64:67], a[96:99], v[16:19]
v_add_u32 v6, s37, v4
s_add_u32 m0, s34, 0
v_mfma_f32_16x16x32_bf16 v[20:23], a[68:71], a[96:99], v[20:23]
ds_read_b64_tr_b16 a[32:33], v8 offset:32768
buffer_load_dwordx4 v2, s[8:11], s28 offen lds
v_mfma_f32_16x16x32_bf16 v[80:83], a[72:75], a[96:99], v[80:83]
ds_read_b64_tr_b16 a[34:35], v8 offset:33792
v_mfma_f32_16x16x32_bf16 v[84:87], a[76:79], a[96:99], v[84:87]
s_add_u32 s28, s28, s29
v_mfma_f32_16x16x32_bf16 v[144:147], a[80:83], a[96:99], v[144:147]
ds_read_b128 a[0:3], v6 offset:0
v_mfma_f32_16x16x32_bf16 v[148:151], a[84:87], a[96:99], v[148:151]
ds_read_b128 a[4:7], v6 offset:2048
s_add_u32 m0, s34, 4096
v_mfma_f32_16x16x32_bf16 v[208:211], a[88:91], a[96:99], v[208:211]
v_mfma_f32_16x16x32_bf16 v[212:215], a[92:95], a[96:99], v[212:215]
ds_read_b128 a[8:11], v6 offset:4096
buffer_load_dwordx4 v2, s[8:11], s28 offen lds
v_mfma_f32_16x16x32_bf16 v[24:27], a[64:67], a[100:103], v[24:27]
v_mfma_f32_16x16x32_bf16 v[28:31], a[68:71], a[100:103], v[28:31]
ds_read_b128 a[12:15], v6 offset:6144
s_add_u32 s28, s28, s29
v_mfma_f32_16x16x32_bf16 v[88:91], a[72:75], a[100:103], v[88:91]
ds_read_b128 a[16:19], v6 offset:8192
s_add_u32 m0, s34, 8192
v_mfma_f32_16x16x32_bf16 v[92:95], a[76:79], a[100:103], v[92:95]
v_mfma_f32_16x16x32_bf16 v[152:155], a[80:83], a[100:103], v[152:155]
ds_read_b128 a[20:23], v6 offset:10240
buffer_load_dwordx4 v2, s[8:11], s28 offen lds
v_mfma_f32_16x16x32_bf16 v[156:159], a[84:87], a[100:103], v[156:159]
v_mfma_f32_16x16x32_bf16 v[216:219], a[88:91], a[100:103], v[216:219]
ds_read_b128 a[24:27], v6 offset:12288
s_add_u32 s28, s28, s29
v_mfma_f32_16x16x32_bf16 v[220:223], a[92:95], a[100:103], v[220:223]
ds_read_b128 a[28:31], v6 offset:14336
v_mfma_f32_16x16x32_bf16 v[32:35], a[64:67], a[104:107], v[32:35]
s_add_u32 m0, s34, 12288
v_mfma_f32_16x16x32_bf16 v[36:39], a[68:71], a[104:107], v[36:39]
ds_read_b64_tr_b16 a[36:37], v9 offset:32768
v_mfma_f32_16x16x32_bf16 v[96:99], a[72:75], a[104:107], v[96:99]
ds_read_b64_tr_b16 a[38:39], v9 offset:33792
buffer_load_dwordx4 v2, s[8:11], s28 offen lds
v_mfma_f32_16x16x32_bf16 v[100:103], a[76:79], a[104:107], v[100:103]
s_add_u32 s28, s28, s29
v_mfma_f32_16x16x32_bf16 v[160:163], a[80:83], a[104:107], v[160:163]
ds_read_b64_tr_b16 a[40:41], v10 offset:32768
v_mfma_f32_16x16x32_bf16 v[164:167], a[84:87], a[104:107], v[164:167]
s_add_u32 m0, s43, 16384
v_mfma_f32_16x16x32_bf16 v[224:227], a[88:91], a[104:107], v[224:227]
ds_read_b64_tr_b16 a[42:43], v10 offset:33792
v_mfma_f32_16x16x32_bf16 v[228:231], a[92:95], a[104:107], v[228:231]
ds_read_b64_tr_b16 a[44:45], v11 offset:32768
buffer_load_dwordx4 v3, s[12:15], s31 offen lds
v_mfma_f32_16x16x32_bf16 v[40:43], a[64:67], a[108:111], v[40:43]
v_mfma_f32_16x16x32_bf16 v[44:47], a[68:71], a[108:111], v[44:47]
ds_read_b64_tr_b16 a[46:47], v11 offset:33792
s_add_u32 s31, s31, s32
v_mfma_f32_16x16x32_bf16 v[104:107], a[72:75], a[108:111], v[104:107]
v_mfma_f32_16x16x32_bf16 v[108:111], a[76:79], a[108:111], v[108:111]
ds_read_b64_tr_b16 a[48:49], v8 offset:40960
s_add_u32 m0, s43, 17408
v_mfma_f32_16x16x32_bf16 v[168:171], a[80:83], a[108:111], v[168:171]
ds_read_b64_tr_b16 a[50:51], v8 offset:41984
buffer_load_dwordx4 v3, s[12:15], s31 offen lds
v_mfma_f32_16x16x32_bf16 v[172:175], a[84:87], a[108:111], v[172:175]
v_mfma_f32_16x16x32_bf16 v[232:235], a[88:91], a[108:111], v[232:235]
ds_read_b64_tr_b16 a[52:53], v9 offset:40960
s_add_u32 s31, s31, s33
v_mfma_f32_16x16x32_bf16 v[236:239], a[92:95], a[108:111], v[236:239]
ds_read_b64_tr_b16 a[54:55], v9 offset:41984
v_mfma_f32_16x16x32_bf16 v[48:51], a[64:67], a[112:115], v[48:51]
s_add_u32 m0, s43, 20480
v_mfma_f32_16x16x32_bf16 v[52:55], a[68:71], a[112:115], v[52:55]
ds_read_b64_tr_b16 a[56:57], v10 offset:40960
v_mfma_f32_16x16x32_bf16 v[112:115], a[72:75], a[112:115], v[112:115]
buffer_load_dwordx4 v3, s[12:15], s31 offen lds
v_mfma_f32_16x16x32_bf16 v[116:119], a[76:79], a[112:115], v[116:119]
ds_read_b64_tr_b16 a[58:59], v10 offset:41984
v_mfma_f32_16x16x32_bf16 v[176:179], a[80:83], a[112:115], v[176:179]
ds_read_b64_tr_b16 a[60:61], v11 offset:40960
s_add_u32 s31, s31, s32
v_mfma_f32_16x16x32_bf16 v[180:183], a[84:87], a[112:115], v[180:183]
s_add_u32 m0, s43, 21504
v_mfma_f32_16x16x32_bf16 v[240:243], a[88:91], a[112:115], v[240:243]
ds_read_b64_tr_b16 a[62:63], v11 offset:41984
v_mfma_f32_16x16x32_bf16 v[244:247], a[92:95], a[112:115], v[244:247]
buffer_load_dwordx4 v3, s[12:15], s31 offen lds
v_mfma_f32_16x16x32_bf16 v[56:59], a[64:67], a[116:119], v[56:59]
v_mfma_f32_16x16x32_bf16 v[60:63], a[68:71], a[116:119], v[60:63]
s_add_u32 s31, s31, s33
v_mfma_f32_16x16x32_bf16 v[120:123], a[72:75], a[116:119], v[120:123]
v_mfma_f32_16x16x32_bf16 v[124:127], a[76:79], a[116:119], v[124:127]
s_add_u32 s37, s37, 32768
v_mfma_f32_16x16x32_bf16 v[184:187], a[80:83], a[116:119], v[184:187]
v_mfma_f32_16x16x32_bf16 v[188:191], a[84:87], a[116:119], v[188:191]
s_cmp_ge_u32 s37, s42
v_mfma_f32_16x16x32_bf16 v[248:251], a[88:91], a[116:119], v[248:251]
s_cselect_b32 s37, s41, s37
v_mfma_f32_16x16x32_bf16 v[252:255], a[92:95], a[116:119], v[252:255]
v_mfma_f32_16x16x32_bf16 v[64:67], a[64:67], a[120:123], v[64:67]
s_add_u32 s40, s45, 49152
v_mfma_f32_16x16x32_bf16 v[68:71], a[68:71], a[120:123], v[68:71]
v_mfma_f32_16x16x32_bf16 v[128:131], a[72:75], a[120:123], v[128:131]
buffer_store_dwordx4 a[240:243], v12, s[4:7], s40 offen sc1
v_mfma_f32_16x16x32_bf16 v[132:135], a[76:79], a[120:123], v[132:135]
v_mfma_f32_16x16x32_bf16 v[192:195], a[80:83], a[120:123], v[192:195]
s_add_u32 s40, s45, 50176
v_mfma_f32_16x16x32_bf16 v[196:199], a[84:87], a[120:123], v[196:199]
v_mfma_f32_16x16x32_bf16 a[128:131], a[88:91], a[120:123], a[128:131]
buffer_store_dwordx4 a[244:247], v12, s[4:7], s40 offen sc1
v_mfma_f32_16x16x32_bf16 a[132:135], a[92:95], a[120:123], a[132:135]
s_add_u32 s40, s45, 53248
v_mfma_f32_16x16x32_bf16 v[72:75], a[64:67], a[124:127], v[72:75]
v_mfma_f32_16x16x32_bf16 v[76:79], a[68:71], a[124:127], v[76:79]
buffer_store_dwordx4 a[248:251], v12, s[4:7], s40 offen sc1
v_mfma_f32_16x16x32_bf16 v[136:139], a[72:75], a[124:127], v[136:139]
v_mfma_f32_16x16x32_bf16 v[140:143], a[76:79], a[124:127], v[140:143]
s_add_u32 s40, s45, 54272
v_mfma_f32_16x16x32_bf16 v[200:203], a[80:83], a[124:127], v[200:203]
v_mfma_f32_16x16x32_bf16 v[204:207], a[84:87], a[124:127], v[204:207]
buffer_store_dwordx4 a[252:255], v12, s[4:7], s40 offen sc1
v_mfma_f32_16x16x32_bf16 a[136:139], a[88:91], a[124:127], a[136:139]
v_mfma_f32_16x16x32_bf16 a[140:143], a[92:95], a[124:127], a[140:143]
s_waitcnt vmcnt(28) lgkmcnt(0)
s_barrier
v_mfma_f32_16x16x32_bf16 v[16:19], a[0:3], a[32:35], v[16:19]
v_add_u32 v7, s38, v5
s_add_u32 m0, s34, 16384
v_mfma_f32_16x16x32_bf16 v[20:23], a[4:7], a[32:35], v[20:23]
ds_read_b64_tr_b16 a[96:97], v8 offset:49152
v_mfma_f32_16x16x32_bf16 v[80:83], a[8:11], a[32:35], v[80:83]
ds_read_b64_tr_b16 a[98:99], v8 offset:50176
buffer_load_dwordx4 v2, s[8:11], s28 offen lds
v_mfma_f32_16x16x32_bf16 v[84:87], a[12:15], a[32:35], v[84:87]
v_mfma_f32_16x16x32_bf16 v[144:147], a[16:19], a[32:35], v[144:147]
ds_read_b128 a[64:67], v7 offset:0
s_add_u32 s28, s28, s29
v_mfma_f32_16x16x32_bf16 v[148:151], a[20:23], a[32:35], v[148:151]
ds_read_b128 a[68:71], v7 offset:2048
v_mfma_f32_16x16x32_bf16 v[208:211], a[24:27], a[32:35], v[208:211]
s_add_u32 m0, s34, 20480
v_mfma_f32_16x16x32_bf16 v[212:215], a[28:31], a[32:35], v[212:215]
ds_read_b128 a[72:75], v7 offset:4096
v_mfma_f32_16x16x32_bf16 v[24:27], a[0:3], a[36:39], v[24:27]
buffer_load_dwordx4 v2, s[8:11], s28 offen lds
v_mfma_f32_16x16x32_bf16 v[28:31], a[4:7], a[36:39], v[28:31]
ds_read_b128 a[76:79], v7 offset:6144
v_mfma_f32_16x16x32_bf16 v[88:91], a[8:11], a[36:39], v[88:91]
ds_read_b128 a[80:83], v7 offset:8192
s_add_u32 s28, s28, s29
v_mfma_f32_16x16x32_bf16 v[92:95], a[12:15], a[36:39], v[92:95]
v_mfma_f32_16x16x32_bf16 v[152:155], a[16:19], a[36:39], v[152:155]
ds_read_b128 a[84:87], v7 offset:10240
s_add_u32 m0, s34, 24576
v_mfma_f32_16x16x32_bf16 v[156:159], a[20:23], a[36:39], v[156:159]
v_mfma_f32_16x16x32_bf16 v[216:219], a[24:27], a[36:39], v[216:219]
ds_read_b128 a[88:91], v7 offset:12288
buffer_load_dwordx4 v2, s[8:11], s28 offen lds
v_mfma_f32_16x16x32_bf16 v[220:223], a[28:31], a[36:39], v[220:223]
ds_read_b128 a[92:95], v7 offset:14336
v_mfma_f32_16x16x32_bf16 v[32:35], a[0:3], a[40:43], v[32:35]
s_add_u32 s28, s28, s29
v_mfma_f32_16x16x32_bf16 v[36:39], a[4:7], a[40:43], v[36:39]
ds_read_b64_tr_b16 a[100:101], v9 offset:49152
v_mfma_f32_16x16x32_bf16 v[96:99], a[8:11], a[40:43], v[96:99]
ds_read_b64_tr_b16 a[102:103], v9 offset:50176
s_add_u32 m0, s34, 28672
v_mfma_f32_16x16x32_bf16 v[100:103], a[12:15], a[40:43], v[100:103]
v_mfma_f32_16x16x32_bf16 v[160:163], a[16:19], a[40:43], v[160:163]
ds_read_b64_tr_b16 a[104:105], v10 offset:49152
v_mfma_f32_16x16x32_bf16 v[164:167], a[20:23], a[40:43], v[164:167]
buffer_load_dwordx4 v2, s[8:11], s28 offen lds
v_mfma_f32_16x16x32_bf16 v[224:227], a[24:27], a[40:43], v[224:227]
ds_read_b64_tr_b16 a[106:107], v10 offset:50176
v_mfma_f32_16x16x32_bf16 v[228:231], a[28:31], a[40:43], v[228:231]
ds_read_b64_tr_b16 a[108:109], v11 offset:49152
s_add_u32 s28, s28, s30
v_mfma_f32_16x16x32_bf16 v[40:43], a[0:3], a[44:47], v[40:43]
v_mfma_f32_16x16x32_bf16 v[44:47], a[4:7], a[44:47], v[44:47]
ds_read_b64_tr_b16 a[110:111], v11 offset:50176
s_add_u32 s34, s34, 32768
v_mfma_f32_16x16x32_bf16 v[104:107], a[8:11], a[44:47], v[104:107]
v_mfma_f32_16x16x32_bf16 v[108:111], a[12:15], a[44:47], v[108:111]
ds_read_b64_tr_b16 a[112:113], v8 offset:57344
s_cmp_ge_u32 s34, s36
v_mfma_f32_16x16x32_bf16 v[168:171], a[16:19], a[44:47], v[168:171]
ds_read_b64_tr_b16 a[114:115], v8 offset:58368
v_mfma_f32_16x16x32_bf16 v[172:175], a[20:23], a[44:47], v[172:175]
s_cselect_b32 s34, s35, s34
v_mfma_f32_16x16x32_bf16 v[232:235], a[24:27], a[44:47], v[232:235]
ds_read_b64_tr_b16 a[116:117], v9 offset:57344
v_mfma_f32_16x16x32_bf16 v[236:239], a[28:31], a[44:47], v[236:239]
ds_read_b64_tr_b16 a[118:119], v9 offset:58368
s_add_u32 m0, s43, 32768
v_mfma_f32_16x16x32_bf16 v[48:51], a[0:3], a[48:51], v[48:51]
v_mfma_f32_16x16x32_bf16 v[52:55], a[4:7], a[48:51], v[52:55]
ds_read_b64_tr_b16 a[120:121], v10 offset:57344
buffer_load_dwordx4 v3, s[12:15], s31 offen lds
v_mfma_f32_16x16x32_bf16 v[112:115], a[8:11], a[48:51], v[112:115]
v_mfma_f32_16x16x32_bf16 v[116:119], a[12:15], a[48:51], v[116:119]
ds_read_b64_tr_b16 a[122:123], v10 offset:58368
s_add_u32 s31, s31, s32
v_mfma_f32_16x16x32_bf16 v[176:179], a[16:19], a[48:51], v[176:179]
ds_read_b64_tr_b16 a[124:125], v11 offset:57344
v_mfma_f32_16x16x32_bf16 v[180:183], a[20:23], a[48:51], v[180:183]
s_add_u32 m0, s43, 33792
v_mfma_f32_16x16x32_bf16 v[240:243], a[24:27], a[48:51], v[240:243]
ds_read_b64_tr_b16 a[126:127], v11 offset:58368
v_mfma_f32_16x16x32_bf16 v[244:247], a[28:31], a[48:51], v[244:247]
buffer_load_dwordx4 v3, s[12:15], s31 offen lds
v_mfma_f32_16x16x32_bf16 v[56:59], a[0:3], a[52:55], v[56:59]
v_mfma_f32_16x16x32_bf16 v[60:63], a[4:7], a[52:55], v[60:63]
v_mfma_f32_16x16x32_bf16 v[120:123], a[8:11], a[52:55], v[120:123]
s_add_u32 s31, s31, s33
v_mfma_f32_16x16x32_bf16 v[124:127], a[12:15], a[52:55], v[124:127]
v_mfma_f32_16x16x32_bf16 v[184:187], a[16:19], a[52:55], v[184:187]
s_add_u32 m0, s43, 36864
v_mfma_f32_16x16x32_bf16 v[188:191], a[20:23], a[52:55], v[188:191]
v_mfma_f32_16x16x32_bf16 v[248:251], a[24:27], a[52:55], v[248:251]
buffer_load_dwordx4 v3, s[12:15], s31 offen lds
v_mfma_f32_16x16x32_bf16 v[252:255], a[28:31], a[52:55], v[252:255]
v_mfma_f32_16x16x32_bf16 v[64:67], a[0:3], a[56:59], v[64:67]
s_add_u32 s31, s31, s32
v_mfma_f32_16x16x32_bf16 v[68:71], a[4:7], a[56:59], v[68:71]
v_mfma_f32_16x16x32_bf16 v[128:131], a[8:11], a[56:59], v[128:131]
s_add_u32 m0, s43, 37888
v_mfma_f32_16x16x32_bf16 v[132:135], a[12:15], a[56:59], v[132:135]
v_mfma_f32_16x16x32_bf16 v[192:195], a[16:19], a[56:59], v[192:195]
buffer_load_dwordx4 v3, s[12:15], s31 offen lds
v_mfma_f32_16x16x32_bf16 v[196:199], a[20:23], a[56:59], v[196:199]
v_mfma_f32_16x16x32_bf16 a[128:131], a[24:27], a[56:59], a[128:131]
s_add_u32 s31, s31, s33
v_mfma_f32_16x16x32_bf16 a[132:135], a[28:31], a[56:59], a[132:135]
v_mfma_f32_16x16x32_bf16 v[72:75], a[0:3], a[60:63], v[72:75]
s_add_u32 s38, s38, 32768
v_mfma_f32_16x16x32_bf16 v[76:79], a[4:7], a[60:63], v[76:79]
v_mfma_f32_16x16x32_bf16 v[136:139], a[8:11], a[60:63], v[136:139]
s_cmp_ge_u32 s38, s42
v_mfma_f32_16x16x32_bf16 v[140:143], a[12:15], a[60:63], v[140:143]
v_mfma_f32_16x16x32_bf16 v[200:203], a[16:19], a[60:63], v[200:203]
s_cselect_b32 s38, s41, s38
v_mfma_f32_16x16x32_bf16 v[204:207], a[20:23], a[60:63], v[204:207]
v_mfma_f32_16x16x32_bf16 a[136:139], a[24:27], a[60:63], a[136:139]
v_mfma_f32_16x16x32_bf16 a[140:143], a[28:31], a[60:63], a[140:143]
s_waitcnt vmcnt(8) lgkmcnt(0)
s_barrier
s_add_u32 s62, s48, 48
s_cmp_lg_u32 s3, 0
s_cbranch_scc1 fused_kernel_qc_38
s_lshl_b32 s68, s62, 7
s_add_u32 s68, s68, 0x5b00000
v_mov_b32 v13, 1
v_mov_b32 v14, 0
s_mov_b64 s[70:71], exec
s_mov_b64 exec, 1
buffer_atomic_add v13, v14, s[4:7], s68 offen
s_mov_b64 exec, s[70:71]
fused_kernel_qc_38:
v_mfma_f32_16x16x32_bf16 v[16:19], a[64:67], a[96:99], v[16:19]
v_add_u32 v6, s37, v4
s_add_u32 m0, s34, 0
v_mfma_f32_16x16x32_bf16 v[20:23], a[68:71], a[96:99], v[20:23]
ds_read_b64_tr_b16 a[32:33], v8 offset:0
v_mfma_f32_16x16x32_bf16 v[80:83], a[72:75], a[96:99], v[80:83]
ds_read_b64_tr_b16 a[34:35], v8 offset:1024
buffer_load_dwordx4 v2, s[8:11], s28 offen lds
v_mfma_f32_16x16x32_bf16 v[84:87], a[76:79], a[96:99], v[84:87]
v_mfma_f32_16x16x32_bf16 v[144:147], a[80:83], a[96:99], v[144:147]
ds_read_b128 a[0:3], v6 offset:0
s_add_u32 s28, s28, s29
v_mfma_f32_16x16x32_bf16 v[148:151], a[84:87], a[96:99], v[148:151]
ds_read_b128 a[4:7], v6 offset:2048
v_mfma_f32_16x16x32_bf16 v[208:211], a[88:91], a[96:99], v[208:211]
v_mfma_f32_16x16x32_bf16 v[212:215], a[92:95], a[96:99], v[212:215]
ds_read_b128 a[8:11], v6 offset:4096
s_add_u32 m0, s34, 4096
v_mfma_f32_16x16x32_bf16 v[24:27], a[64:67], a[100:103], v[24:27]
v_mfma_f32_16x16x32_bf16 v[28:31], a[68:71], a[100:103], v[28:31]
ds_read_b128 a[12:15], v6 offset:6144
buffer_load_dwordx4 v2, s[8:11], s28 offen lds
v_mfma_f32_16x16x32_bf16 v[88:91], a[72:75], a[100:103], v[88:91]
ds_read_b128 a[16:19], v6 offset:8192
v_mfma_f32_16x16x32_bf16 v[92:95], a[76:79], a[100:103], v[92:95]
s_add_u32 s28, s28, s29
v_mfma_f32_16x16x32_bf16 v[152:155], a[80:83], a[100:103], v[152:155]
ds_read_b128 a[20:23], v6 offset:10240
v_mfma_f32_16x16x32_bf16 v[156:159], a[84:87], a[100:103], v[156:159]
v_mfma_f32_16x16x32_bf16 v[216:219], a[88:91], a[100:103], v[216:219]
ds_read_b128 a[24:27], v6 offset:12288
s_add_u32 m0, s34, 8192
v_mfma_f32_16x16x32_bf16 v[220:223], a[92:95], a[100:103], v[220:223]
ds_read_b128 a[28:31], v6 offset:14336
v_mfma_f32_16x16x32_bf16 v[32:35], a[64:67], a[104:107], v[32:35]
buffer_load_dwordx4 v2, s[8:11], s28 offen lds
v_mfma_f32_16x16x32_bf16 v[36:39], a[68:71], a[104:107], v[36:39]
ds_read_b64_tr_b16 a[36:37], v9 offset:0
v_mfma_f32_16x16x32_bf16 v[96:99], a[72:75], a[104:107], v[96:99]
ds_read_b64_tr_b16 a[38:39], v9 offset:1024
s_add_u32 s28, s28, s29
v_mfma_f32_16x16x32_bf16 v[100:103], a[76:79], a[104:107], v[100:103]
v_mfma_f32_16x16x32_bf16 v[160:163], a[80:83], a[104:107], v[160:163]
ds_read_b64_tr_b16 a[40:41], v10 offset:0
v_mfma_f32_16x16x32_bf16 v[164:167], a[84:87], a[104:107], v[164:167]
s_add_u32 m0, s34, 12288
v_mfma_f32_16x16x32_bf16 v[224:227], a[88:91], a[104:107], v[224:227]
ds_read_b64_tr_b16 a[42:43], v10 offset:1024
v_mfma_f32_16x16x32_bf16 v[228:231], a[92:95], a[104:107], v[228:231]
ds_read_b64_tr_b16 a[44:45], v11 offset:0
buffer_load_dwordx4 v2, s[8:11], s28 offen lds
v_mfma_f32_16x16x32_bf16 v[40:43], a[64:67], a[108:111], v[40:43]
v_mfma_f32_16x16x32_bf16 v[44:47], a[68:71], a[108:111], v[44:47]
ds_read_b64_tr_b16 a[46:47], v11 offset:1024
s_add_u32 s28, s28, s29
v_mfma_f32_16x16x32_bf16 v[104:107], a[72:75], a[108:111], v[104:107]
v_mfma_f32_16x16x32_bf16 v[108:111], a[76:79], a[108:111], v[108:111]
ds_read_b64_tr_b16 a[48:49], v8 offset:8192
v_mfma_f32_16x16x32_bf16 v[168:171], a[80:83], a[108:111], v[168:171]
ds_read_b64_tr_b16 a[50:51], v8 offset:9216
s_add_u32 m0, s43, 49152
v_mfma_f32_16x16x32_bf16 v[172:175], a[84:87], a[108:111], v[172:175]
v_mfma_f32_16x16x32_bf16 v[232:235], a[88:91], a[108:111], v[232:235]
ds_read_b64_tr_b16 a[52:53], v9 offset:8192
buffer_load_dwordx4 v3, s[12:15], s31 offen lds
v_mfma_f32_16x16x32_bf16 v[236:239], a[92:95], a[108:111], v[236:239]
ds_read_b64_tr_b16 a[54:55], v9 offset:9216
v_mfma_f32_16x16x32_bf16 v[48:51], a[64:67], a[112:115], v[48:51]
s_add_u32 s31, s31, s32
v_mfma_f32_16x16x32_bf16 v[52:55], a[68:71], a[112:115], v[52:55]
ds_read_b64_tr_b16 a[56:57], v10 offset:8192
v_mfma_f32_16x16x32_bf16 v[112:115], a[72:75], a[112:115], v[112:115]
v_mfma_f32_16x16x32_bf16 v[116:119], a[76:79], a[112:115], v[116:119]
ds_read_b64_tr_b16 a[58:59], v10 offset:9216
s_add_u32 m0, s43, 50176
v_mfma_f32_16x16x32_bf16 v[176:179], a[80:83], a[112:115], v[176:179]
ds_read_b64_tr_b16 a[60:61], v11 offset:8192
v_mfma_f32_16x16x32_bf16 v[180:183], a[84:87], a[112:115], v[180:183]
buffer_load_dwordx4 v3, s[12:15], s31 offen lds
v_mfma_f32_16x16x32_bf16 v[240:243], a[88:91], a[112:115], v[240:243]
ds_read_b64_tr_b16 a[62:63], v11 offset:9216
v_mfma_f32_16x16x32_bf16 v[244:247], a[92:95], a[112:115], v[244:247]
s_add_u32 s31, s31, s33
v_mfma_f32_16x16x32_bf16 v[56:59], a[64:67], a[116:119], v[56:59]
v_mfma_f32_16x16x32_bf16 v[60:63], a[68:71], a[116:119], v[60:63]
v_mfma_f32_16x16x32_bf16 v[120:123], a[72:75], a[116:119], v[120:123]
s_add_u32 m0, s43, 53248
v_mfma_f32_16x16x32_bf16 v[124:127], a[76:79], a[116:119], v[124:127]
v_mfma_f32_16x16x32_bf16 v[184:187], a[80:83], a[116:119], v[184:187]
buffer_load_dwordx4 v3, s[12:15], s31 offen lds
v_mfma_f32_16x16x32_bf16 v[188:191], a[84:87], a[116:119], v[188:191]
v_mfma_f32_16x16x32_bf16 v[248:251], a[88:91], a[116:119], v[248:251]
s_add_u32 s31, s31, s32
v_mfma_f32_16x16x32_bf16 v[252:255], a[92:95], a[116:119], v[252:255]
v_mfma_f32_16x16x32_bf16 v[64:67], a[64:67], a[120:123], v[64:67]
v_mfma_f32_16x16x32_bf16 v[68:71], a[68:71], a[120:123], v[68:71]
s_add_u32 m0, s43, 54272
v_mfma_f32_16x16x32_bf16 v[128:131], a[72:75], a[120:123], v[128:131]
v_mfma_f32_16x16x32_bf16 v[132:135], a[76:79], a[120:123], v[132:135]
buffer_load_dwordx4 v3, s[12:15], s31 offen lds
v_mfma_f32_16x16x32_bf16 v[192:195], a[80:83], a[120:123], v[192:195]
v_mfma_f32_16x16x32_bf16 v[196:199], a[84:87], a[120:123], v[196:199]
s_add_u32 s31, s31, s33
v_mfma_f32_16x16x32_bf16 a[128:131], a[88:91], a[120:123], a[128:131]
v_mfma_f32_16x16x32_bf16 a[132:135], a[92:95], a[120:123], a[132:135]
v_mfma_f32_16x16x32_bf16 v[72:75], a[64:67], a[124:127], v[72:75]
s_add_u32 s37, s37, 32768
v_mfma_f32_16x16x32_bf16 v[76:79], a[68:71], a[124:127], v[76:79]
v_mfma_f32_16x16x32_bf16 v[136:139], a[72:75], a[124:127], v[136:139]
s_cmp_ge_u32 s37, s42
v_mfma_f32_16x16x32_bf16 v[140:143], a[76:79], a[124:127], v[140:143]
v_mfma_f32_16x16x32_bf16 v[200:203], a[80:83], a[124:127], v[200:203]
s_cselect_b32 s37, s41, s37
v_mfma_f32_16x16x32_bf16 v[204:207], a[84:87], a[124:127], v[204:207]
v_mfma_f32_16x16x32_bf16 a[136:139], a[88:91], a[124:127], a[136:139]
v_mfma_f32_16x16x32_bf16 a[140:143], a[92:95], a[124:127], a[140:143]
s_cmp_ge_u32 s3, 2
s_cbranch_scc1 tch_a_39
s_mov_b32 s68, s12
s_mov_b32 s69, s13
s_mov_b32 s70, s14
s_mov_b32 s71, 0x20000
v_lshrrev_b32 v13, 2, v1
v_lshlrev_b32 v13, 13, v13
v_and_b32 v0, 3, v1
v_lshl_add_u32 v13, v0, 7, v13
s_bfe_u32 s40, s2, 0x20004
s_lshl_b32 s40, s40, 5
s_lshl_b32 s60, s3, 4
s_add_u32 s40, s40, s60
s_add_u32 s40, s40, 640
s_lshl_b32 s40, s40, 13
s_lshl_b32 s60, s48, 9
s_add_u32 s84, s40, s60
s_mov_b32 s85, 1048576
s_branch tch_done_40
tch_a_39:
s_mov_b32 s68, s8
s_mov_b32 s69, s9
s_mov_b32 s70, s10
s_mov_b32 s71, 0x20000
v_min_u32 v13, 15, v1
v_lshrrev_b32 v0, 1, v13
v_lshlrev_b32 v0, 11, v0
v_and_b32 v13, 1, v13
v_lshl_add_u32 v13, v13, 7, v0
s_lshl_b32 s40, s47, 1
s_and_b32 s60, s48, 1
s_add_u32 s40, s40, s60
s_lshl_b32 s40, s40, 3
s_and_b32 s60, s2, 7
s_add_u32 s40, s40, s60
s_bfe_u32 s60, s2, 0x20004
s_lshl_b32 s61, s49, 2
s_add_u32 s60, s60, s61
s_lshl_b32 s40, s40, 3
s_lshl_b32 s60, s60, 8
s_add_u32 s40, s40, s60
s_lshl_b32 s40, s40, 11
s_add_u32 s84, s40, 1280
s_movk_i32 s85, 256
s_cmp_eq_u32 s3, 3
s_cselect_b32 s84, 0x70000000, s84
tch_done_40:
s_mov_b32 s39, 5
s_mov_b32 s58, 100
s_branch fused_kernel_L0_1
fused_kernel_qtail0:
s_waitcnt vmcnt(16) lgkmcnt(0)
s_barrier
v_mfma_f32_16x16x32_bf16 v[16:19], a[32:35], a[0:3], v[16:19]
v_add_u32 v7, s38, v5
s_add_u32 s38, s38, 32768
v_mfma_f32_16x16x32_bf16 v[24:27], a[32:35], a[4:7], v[24:27]
ds_read_b64_tr_b16 a[96:97], v8 offset:16384
v_mfma_f32_16x16x32_bf16 v[32:35], a[32:35], a[8:11], v[32:35]
ds_read_b64_tr_b16 a[98:99], v8 offset:17408
v_mfma_f32_16x16x32_bf16 v[40:43], a[32:35], a[12:15], v[40:43]
s_cmp_ge_u32 s38, s42
v_mfma_f32_16x16x32_bf16 v[48:51], a[32:35], a[16:19], v[48:51]
ds_read_b128 a[64:67], v7 offset:0
v_mfma_f32_16x16x32_bf16 v[56:59], a[32:35], a[20:23], v[56:59]
ds_read_b128 a[68:71], v7 offset:2048
v_mfma_f32_16x16x32_bf16 v[64:67], a[32:35], a[24:27], v[64:67]
v_mfma_f32_16x16x32_bf16 v[72:75], a[32:35], a[28:31], v[72:75]
ds_read_b128 a[72:75], v7 offset:4096
s_cselect_b32 s38, s41, s38
v_mfma_f32_16x16x32_bf16 v[20:23], a[36:39], a[0:3], v[20:23]
v_mfma_f32_16x16x32_bf16 v[28:31], a[36:39], a[4:7], v[28:31]
ds_read_b128 a[76:79], v7 offset:6144
v_mfma_f32_16x16x32_bf16 v[36:39], a[36:39], a[8:11], v[36:39]
ds_read_b128 a[80:83], v7 offset:8192
v_mfma_f32_16x16x32_bf16 v[44:47], a[36:39], a[12:15], v[44:47]
s_add_u32 s58, s48, 0
v_mfma_f32_16x16x32_bf16 v[52:55], a[36:39], a[16:19], v[52:55]
ds_read_b128 a[84:87], v7 offset:10240
v_mfma_f32_16x16x32_bf16 v[60:63], a[36:39], a[20:23], v[60:63]
v_mfma_f32_16x16x32_bf16 v[68:71], a[36:39], a[24:27], v[68:71]
ds_read_b128 a[88:91], v7 offset:12288
s_lshl_b32 s58, s58, 7
v_mfma_f32_16x16x32_bf16 v[76:79], a[36:39], a[28:31], v[76:79]
ds_read_b128 a[92:95], v7 offset:14336
v_mfma_f32_16x16x32_bf16 v[80:83], a[40:43], a[0:3], v[80:83]
v_mfma_f32_16x16x32_bf16 v[88:91], a[40:43], a[4:7], v[88:91]
ds_read_b64_tr_b16 a[100:101], v9 offset:16384
v_mfma_f32_16x16x32_bf16 v[96:99], a[40:43], a[8:11], v[96:99]
ds_read_b64_tr_b16 a[102:103], v9 offset:17408
s_add_u32 s58, s58, 0x5b00000
v_mfma_f32_16x16x32_bf16 v[104:107], a[40:43], a[12:15], v[104:107]
v_mfma_f32_16x16x32_bf16 v[112:115], a[40:43], a[16:19], v[112:115]
ds_read_b64_tr_b16 a[104:105], v10 offset:16384
v_mfma_f32_16x16x32_bf16 v[120:123], a[40:43], a[20:23], v[120:123]
v_mfma_f32_16x16x32_bf16 v[128:131], a[40:43], a[24:27], v[128:131]
ds_read_b64_tr_b16 a[106:107], v10 offset:17408
s_add_u32 s59, s48, 48
v_mfma_f32_16x16x32_bf16 v[136:139], a[40:43], a[28:31], v[136:139]
ds_read_b64_tr_b16 a[108:109], v11 offset:16384
v_mfma_f32_16x16x32_bf16 v[84:87], a[44:47], a[0:3], v[84:87]
v_mfma_f32_16x16x32_bf16 v[92:95], a[44:47], a[4:7], v[92:95]
ds_read_b64_tr_b16 a[110:111], v11 offset:17408
s_lshl_b32 s59, s59, 7
v_mfma_f32_16x16x32_bf16 v[100:103], a[44:47], a[8:11], v[100:103]
v_mfma_f32_16x16x32_bf16 v[108:111], a[44:47], a[12:15], v[108:111]
ds_read_b64_tr_b16 a[112:113], v8 offset:24576
v_mfma_f32_16x16x32_bf16 v[116:119], a[44:47], a[16:19], v[116:119]
ds_read_b64_tr_b16 a[114:115], v8 offset:25600
v_mfma_f32_16x16x32_bf16 v[124:127], a[44:47], a[20:23], v[124:127]
s_add_u32 s59, s59, 0x5b00000
v_mfma_f32_16x16x32_bf16 v[132:135], a[44:47], a[24:27], v[132:135]
ds_read_b64_tr_b16 a[116:117], v9 offset:24576
v_mfma_f32_16x16x32_bf16 v[140:143], a[44:47], a[28:31], v[140:143]
ds_read_b64_tr_b16 a[118:119], v9 offset:25600
v_mfma_f32_16x16x32_bf16 v[144:147], a[48:51], a[0:3], v[144:147]
v_mfma_f32_16x16x32_bf16 v[152:155], a[48:51], a[4:7], v[152:155]
ds_read_b64_tr_b16 a[120:121], v10 offset:24576
s_add_u32 s66, s48, 32
v_mfma_f32_16x16x32_bf16 v[160:163], a[48:51], a[8:11], v[160:163]
v_mfma_f32_16x16x32_bf16 v[168:171], a[48:51], a[12:15], v[168:171]
ds_read_b64_tr_b16 a[122:123], v10 offset:25600
v_mfma_f32_16x16x32_bf16 v[176:179], a[48:51], a[16:19], v[176:179]
ds_read_b64_tr_b16 a[124:125], v11 offset:24576
v_mfma_f32_16x16x32_bf16 v[184:187], a[48:51], a[20:23], v[184:187]
s_lshl_b32 s66, s66, 7
v_mfma_f32_16x16x32_bf16 v[192:195], a[48:51], a[24:27], v[192:195]
ds_read_b64_tr_b16 a[126:127], v11 offset:25600
v_mfma_f32_16x16x32_bf16 v[200:203], a[48:51], a[28:31], v[200:203]
v_mfma_f32_16x16x32_bf16 v[148:151], a[52:55], a[0:3], v[148:151]
s_add_u32 s66, s66, 0x5b00000
v_mfma_f32_16x16x32_bf16 v[156:159], a[52:55], a[4:7], v[156:159]
v_mfma_f32_16x16x32_bf16 v[164:167], a[52:55], a[8:11], v[164:167]
v_mfma_f32_16x16x32_bf16 v[172:175], a[52:55], a[12:15], v[172:175]
v_mfma_f32_16x16x32_bf16 v[180:183], a[52:55], a[16:19], v[180:183]
s_mov_b32 s66, s58
v_mfma_f32_16x16x32_bf16 v[188:191], a[52:55], a[20:23], v[188:191]
v_mfma_f32_16x16x32_bf16 v[196:199], a[52:55], a[24:27], v[196:199]
v_mfma_f32_16x16x32_bf16 v[204:207], a[52:55], a[28:31], v[204:207]
v_mfma_f32_16x16x32_bf16 v[208:211], a[56:59], a[0:3], v[208:211]
v_mov_b32 v13, s66
v_mfma_f32_16x16x32_bf16 v[216:219], a[56:59], a[4:7], v[216:219]
v_mfma_f32_16x16x32_bf16 v[224:227], a[56:59], a[8:11], v[224:227]
v_mfma_f32_16x16x32_bf16 v[232:235], a[56:59], a[12:15], v[232:235]
v_writelane_b32 v13, s58, 0
v_mfma_f32_16x16x32_bf16 v[240:243], a[56:59], a[16:19], v[240:243]
v_mfma_f32_16x16x32_bf16 v[248:251], a[56:59], a[20:23], v[248:251]
v_mfma_f32_16x16x32_bf16 a[128:131], a[56:59], a[24:27], a[128:131]
v_mfma_f32_16x16x32_bf16 a[136:139], a[56:59], a[28:31], a[136:139]
v_writelane_b32 v13, s59, 1
v_mfma_f32_16x16x32_bf16 v[212:215], a[60:63], a[0:3], v[212:215]
v_mfma_f32_16x16x32_bf16 v[220:223], a[60:63], a[4:7], v[220:223]
v_mfma_f32_16x16x32_bf16 v[228:231], a[60:63], a[8:11], v[228:231]
v_mfma_f32_16x16x32_bf16 v[236:239], a[60:63], a[12:15], v[236:239]
buffer_load_dword v14, v13, s[4:7], 0 offen sc1
v_mfma_f32_16x16x32_bf16 v[244:247], a[60:63], a[16:19], v[244:247]
v_mfma_f32_16x16x32_bf16 v[252:255], a[60:63], a[20:23], v[252:255]
v_mfma_f32_16x16x32_bf16 a[132:135], a[60:63], a[24:27], a[132:135]
v_mfma_f32_16x16x32_bf16 a[140:143], a[60:63], a[28:31], a[140:143]
s_waitcnt vmcnt(0) lgkmcnt(0)
s_mov_b32 s67, 0x80000
fused_kernel_dpoll_42:
v_readlane_b32 s66, v14, 0
v_readlane_b32 s68, v14, 1
v_readlane_b32 s69, v14, 2
s_sub_u32 s67, s67, 1
s_cmp_eq_u32 s67, 0
s_cbranch_scc1 fused_kernel_dok_41
s_min_u32 s66, s66, s68
s_min_u32 s66, s66, s69
s_cmp_ge_u32 s66, 8
s_cbranch_scc1 fused_kernel_dok_41
s_sleep 1
buffer_load_dword v14, v13, s[4:7], 0 offen sc1
s_waitcnt vmcnt(0)
s_branch fused_kernel_dpoll_42
fused_kernel_dok_41:
s_barrier
v_mfma_f32_16x16x32_bf16 v[16:19], a[96:99], a[64:67], v[16:19]
s_and_b32 s28, s2, 7
s_lshr_b32 s29, s2, 3
s_lshr_b32 s30, s29, 4
v_mfma_f32_16x16x32_bf16 v[24:27], a[96:99], a[68:71], v[24:27]
s_lshl_b32 s8, s28, 1
s_add_u32 s8, s8, s30
v_mfma_f32_16x16x32_bf16 v[32:35], a[96:99], a[72:75], v[32:35]
s_bfe_u32 s9, s29, 0x30001
s_and_b32 s10, s29, 1
s_lshl_b32 s37, s8, 3
v_mfma_f32_16x16x32_bf16 v[40:43], a[96:99], a[76:79], v[40:43]
s_add_u32 s37, s37, s9
s_lshl_b32 s33, s3, 12
v_mfma_f32_16x16x32_bf16 v[48:51], a[96:99], a[80:83], v[48:51]
s_sub_u32 s22, 15, s9
s_lshl_b32 s29, s22, 2
v_mfma_f32_16x16x32_bf16 v[56:59], a[96:99], a[84:87], v[56:59]
s_add_u32 s29, s29, 4
s_cmp_eq_u32 s9, 0
s_cselect_b32 s30, 40, 38
v_mfma_f32_16x16x32_bf16 v[64:67], a[96:99], a[88:91], v[64:67]
s_min_u32 s30, s29, s30
s_sub_u32 s11, s29, s30
v_mfma_f32_16x16x32_bf16 v[72:75], a[96:99], a[92:95], v[72:75]
s_lshl_b32 s58, s9, 2
s_add_u32 s58, s58, 4
v_mfma_f32_16x16x32_bf16 v[20:23], a[100:103], a[64:67], v[20:23]
s_cmp_eq_u32 s11, 0
s_cselect_b32 s32, 0, 1
s_cselect_b32 s38, 0, 3
v_mfma_f32_16x16x32_bf16 v[28:31], a[100:103], a[68:71], v[28:31]
s_cmp_eq_u32 s10, 0
s_cselect_b32 s32, s32, s38
v_mfma_f32_16x16x32_bf16 v[36:39], a[100:103], a[72:75], v[36:39]
s_cselect_b32 s34, s30, s58
s_cselect_b32 s22, s22, s9
v_mfma_f32_16x16x32_bf16 v[44:47], a[100:103], a[76:79], v[44:47]
s_mov_b32 s35, 0
s_lshl_b32 s28, s8, 20
s_add_u32 s28, s28, s33
v_mfma_f32_16x16x32_bf16 v[52:55], a[100:103], a[80:83], v[52:55]
s_add_u32 s12, s28, 0x1200000
s_add_u32 s13, s28, 0x2200000
v_mfma_f32_16x16x32_bf16 v[60:63], a[100:103], a[84:87], v[60:63]
s_lshl_b32 s31, s58, 14
s_add_u32 s14, s12, s31
v_mfma_f32_16x16x32_bf16 v[68:71], a[100:103], a[88:91], v[68:71]
s_add_u32 s15, s13, s31
s_lshl_b32 s31, s30, 14
s_add_u32 s16, s12, s31
v_mfma_f32_16x16x32_bf16 v[76:79], a[100:103], a[92:95], v[76:79]
s_add_u32 s17, s13, s31
s_cmp_eq_u32 s32, 3
v_mfma_f32_16x16x32_bf16 v[80:83], a[104:107], a[64:67], v[80:83]
s_cselect_b32 s14, s14, -1
s_cselect_b32 s15, s15, -1
v_mfma_f32_16x16x32_bf16 v[88:91], a[104:107], a[68:71], v[88:91]
s_add_u32 s20, s33, 163840
s_mov_b32 s25, s30
s_sub_u32 s39, s58, 7
v_mfma_f32_16x16x32_bf16 v[96:99], a[104:107], a[72:75], v[96:99]
s_cmp_eq_u32 s32, 3
s_cselect_b32 s39, s39, -1
v_mfma_f32_16x16x32_bf16 v[104:107], a[104:107], a[76:79], v[104:107]
s_cmp_eq_u32 s9, 0
s_cselect_b32 s39, -1, s39
v_mfma_f32_16x16x32_bf16 v[112:115], a[104:107], a[80:83], v[112:115]
s_cmp_eq_u32 s10, 0
s_cselect_b32 s39, 25, s39
s_mov_b32 s38, 0
v_mfma_f32_16x16x32_bf16 v[120:123], a[104:107], a[84:87], v[120:123]
s_cmp_eq_u32 s9, 0
s_cselect_b32 s59, 1, 0
v_mfma_f32_16x16x32_bf16 v[128:131], a[104:107], a[88:91], v[128:131]
s_cmp_eq_u32 s32, 3
s_cselect_b32 s59, s59, 0
s_lshl_b32 s24, s22, 2
v_mfma_f32_16x16x32_bf16 v[136:139], a[104:107], a[92:95], v[136:139]
s_mov_b32 s23, s35
s_sub_u32 s21, s34, 2
v_mfma_f32_16x16x32_bf16 v[84:87], a[108:111], a[64:67], v[84:87]
s_lshr_b32 s21, s21, 1
s_lshl_b32 s28, s8, 6
v_mfma_f32_16x16x32_bf16 v[92:95], a[108:111], a[68:71], v[92:95]
s_lshl_b32 s29, s22, 2
s_add_u32 s28, s28, s29
s_add_u32 s28, s28, s3
v_mfma_f32_16x16x32_bf16 v[100:103], a[108:111], a[72:75], v[100:103]
s_lshl_b32 s28, s28, 14
s_add_u32 s36, s28, 0x200000
v_mfma_f32_16x16x32_bf16 v[108:111], a[108:111], a[76:79], v[108:111]
v_lshlrev_b32 v12, 4, v1
v_bfe_u32 v0, v1, 4, 1
v_mfma_f32_16x16x32_bf16 v[116:119], a[108:111], a[80:83], v[116:119]
v_lshlrev_b32 v0, 13, v0
v_lshrrev_b32 v14, 5, v1
v_lshl_add_u32 v0, v14, 8, v0
v_mfma_f32_16x16x32_bf16 v[124:127], a[108:111], a[84:87], v[124:127]
v_and_b32 v14, 15, v1
v_lshl_add_u32 v0, v14, 4, v0
v_mfma_f32_16x16x32_bf16 v[132:135], a[108:111], a[88:91], v[132:135]
s_add_u32 s28, s36, 0
buffer_load_dwordx4 a[0:3], v0, s[4:7], s28 offen offset:0
v_mfma_f32_16x16x32_bf16 v[140:143], a[108:111], a[92:95], v[140:143]
buffer_load_dwordx4 a[4:7], v0, s[4:7], s28 offen offset:512
buffer_load_dwordx4 a[8:11], v0, s[4:7], s28 offen offset:1024
buffer_load_dwordx4 a[12:15], v0, s[4:7], s28 offen offset:1536
v_mfma_f32_16x16x32_bf16 v[144:147], a[112:115], a[64:67], v[144:147]
buffer_load_dwordx4 a[16:19], v0, s[4:7], s28 offen offset:2048
buffer_load_dwordx4 a[20:23], v0, s[4:7], s28 offen offset:2560
v_mfma_f32_16x16x32_bf16 v[152:155], a[112:115], a[68:71], v[152:155]
buffer_load_dwordx4 a[24:27], v0, s[4:7], s28 offen offset:3072
buffer_load_dwordx4 a[28:31], v0, s[4:7], s28 offen offset:3584
v_mfma_f32_16x16x32_bf16 v[160:163], a[112:115], a[72:75], v[160:163]
s_add_u32 s28, s36, 4096
buffer_load_dwordx4 a[32:35], v0, s[4:7], s28 offen offset:0
buffer_load_dwordx4 a[36:39], v0, s[4:7], s28 offen offset:512
v_mfma_f32_16x16x32_bf16 v[168:171], a[112:115], a[76:79], v[168:171]
buffer_load_dwordx4 a[40:43], v0, s[4:7], s28 offen offset:1024
buffer_load_dwordx4 a[44:47], v0, s[4:7], s28 offen offset:1536
v_mfma_f32_16x16x32_bf16 v[176:179], a[112:115], a[80:83], v[176:179]
buffer_load_dwordx4 a[48:51], v0, s[4:7], s28 offen offset:2048
buffer_load_dwordx4 a[52:55], v0, s[4:7], s28 offen offset:2560
v_mfma_f32_16x16x32_bf16 v[184:187], a[112:115], a[84:87], v[184:187]
buffer_load_dwordx4 a[56:59], v0, s[4:7], s28 offen offset:3072
buffer_load_dwordx4 a[60:63], v0, s[4:7], s28 offen offset:3584
s_add_u32 m0, s33, 0
v_mfma_f32_16x16x32_bf16 v[192:195], a[112:115], a[88:91], v[192:195]
buffer_load_dwordx4 v12, s[4:7], s12 offen offset:0 lds
buffer_load_dwordx4 v12, s[4:7], s12 offen offset:1024 lds
v_mfma_f32_16x16x32_bf16 v[200:203], a[112:115], a[92:95], v[200:203]
buffer_load_dwordx4 v12, s[4:7], s12 offen offset:2048 lds
buffer_load_dwordx4 v12, s[4:7], s12 offen offset:3072 lds
v_mfma_f32_16x16x32_bf16 v[148:151], a[116:119], a[64:67], v[148:151]
s_add_u32 s12, s12, 16384
s_cmp_eq_u32 s12, s14
s_cselect_b32 s12, s16, s12
v_mfma_f32_16x16x32_bf16 v[156:159], a[116:119], a[68:71], v[156:159]
s_add_u32 m0, s33, 32768
s_nop 0
buffer_load_dwordx4 v12, s[4:7], s12 offen offset:0 lds
v_mfma_f32_16x16x32_bf16 v[164:167], a[116:119], a[72:75], v[164:167]
buffer_load_dwordx4 v12, s[4:7], s12 offen offset:1024 lds
buffer_load_dwordx4 v12, s[4:7], s12 offen offset:2048 lds
buffer_load_dwordx4 v12, s[4:7], s12 offen offset:3072 lds
v_mfma_f32_16x16x32_bf16 v[172:175], a[116:119], a[76:79], v[172:175]
s_add_u32 s12, s12, 16384
s_cmp_eq_u32 s12, s14
v_mfma_f32_16x16x32_bf16 v[180:183], a[116:119], a[80:83], v[180:183]
s_cselect_b32 s12, s16, s12
s_add_u32 m0, s33, 65536
v_mfma_f32_16x16x32_bf16 v[188:191], a[116:119], a[84:87], v[188:191]
buffer_load_dwordx4 v12, s[4:7], s12 offen offset:0 lds
buffer_load_dwordx4 v12, s[4:7], s12 offen offset:1024 lds
buffer_load_dwordx4 v12, s[4:7], s12 offen offset:2048 lds
v_mfma_f32_16x16x32_bf16 v[196:199], a[116:119], a[88:91], v[196:199]
buffer_load_dwordx4 v12, s[4:7], s12 offen offset:3072 lds
s_add_u32 s12, s12, 16384
v_mfma_f32_16x16x32_bf16 v[204:207], a[116:119], a[92:95], v[204:207]
s_cmp_eq_u32 s12, s14
s_cselect_b32 s12, s16, s12
v_mfma_f32_16x16x32_bf16 v[208:211], a[120:123], a[64:67], v[208:211]
s_add_u32 m0, s33, 98304
s_nop 0
buffer_load_dwordx4 v12, s[4:7], s12 offen offset:0 lds
buffer_load_dwordx4 v12, s[4:7], s12 offen offset:1024 lds
v_mfma_f32_16x16x32_bf16 v[216:219], a[120:123], a[68:71], v[216:219]
buffer_load_dwordx4 v12, s[4:7], s12 offen offset:2048 lds
buffer_load_dwordx4 v12, s[4:7], s12 offen offset:3072 lds
v_mfma_f32_16x16x32_bf16 v[224:227], a[120:123], a[72:75], v[224:227]
s_add_u32 s12, s12, 16384
s_cmp_eq_u32 s12, s14
v_mfma_f32_16x16x32_bf16 v[232:235], a[120:123], a[76:79], v[232:235]
s_cselect_b32 s12, s16, s12
s_add_u32 m0, s33, 114688
s_nop 0
buffer_load_dwordx4 v12, s[4:7], s13 offen offset:0 lds
v_mfma_f32_16x16x32_bf16 v[240:243], a[120:123], a[80:83], v[240:243]
buffer_load_dwordx4 v12, s[4:7], s13 offen offset:1024 lds
buffer_load_dwordx4 v12, s[4:7], s13 offen offset:2048 lds
v_mfma_f32_16x16x32_bf16 v[248:251], a[120:123], a[84:87], v[248:251]
buffer_load_dwordx4 v12, s[4:7], s13 offen offset:3072 lds
s_add_u32 s13, s13, 16384
v_mfma_f32_16x16x32_bf16 a[128:131], a[120:123], a[88:91], a[128:131]
s_cmp_eq_u32 s13, s15
s_cselect_b32 s13, s17, s13
s_cmp_eq_u32 s59, 1
v_mfma_f32_16x16x32_bf16 a[136:139], a[120:123], a[92:95], a[136:139]
s_cselect_b32 s30, 0x70000000, s12
s_cselect_b32 s31, 0, 16384
v_mfma_f32_16x16x32_bf16 v[212:215], a[124:127], a[64:67], v[212:215]
s_add_u32 m0, s33, 131072
s_nop 0
buffer_load_dwordx4 v12, s[4:7], s30 offen offset:0 lds
v_mfma_f32_16x16x32_bf16 v[220:223], a[124:127], a[68:71], v[220:223]
buffer_load_dwordx4 v12, s[4:7], s30 offen offset:1024 lds
buffer_load_dwordx4 v12, s[4:7], s30 offen offset:2048 lds
buffer_load_dwordx4 v12, s[4:7], s30 offen offset:3072 lds
v_mfma_f32_16x16x32_bf16 v[228:231], a[124:127], a[72:75], v[228:231]
s_add_u32 s12, s12, s31
s_cmp_eq_u32 s12, s14
v_mfma_f32_16x16x32_bf16 v[236:239], a[124:127], a[76:79], v[236:239]
s_cselect_b32 s12, s16, s12
s_add_u32 m0, s33, 147456
v_mfma_f32_16x16x32_bf16 v[244:247], a[124:127], a[80:83], v[244:247]
buffer_load_dwordx4 v12, s[4:7], s13 offen offset:0 lds
buffer_load_dwordx4 v12, s[4:7], s13 offen offset:1024 lds
buffer_load_dwordx4 v12, s[4:7], s13 offen offset:2048 lds
v_mfma_f32_16x16x32_bf16 v[252:255], a[124:127], a[84:87], v[252:255]
buffer_load_dwordx4 v12, s[4:7], s13 offen offset:3072 lds
s_add_u32 s13, s13, 16384
v_mfma_f32_16x16x32_bf16 a[132:135], a[124:127], a[88:91], a[132:135]
s_cmp_eq_u32 s13, s15
s_cselect_b32 s13, s17, s13
v_mfma_f32_16x16x32_bf16 a[140:143], a[124:127], a[92:95], a[140:143]
s_nop 7
v_cvt_pk_bf16_f32 v200, v200, v201
v_cvt_pk_bf16_f32 v201, v202, v203
v_cvt_pk_bf16_f32 v202, v204, v205
v_cvt_pk_bf16_f32 v203, v206, v207
s_add_u32 s40, s44, 61440
buffer_store_dwordx4 v[200:203], v12, s[4:7], s40 offen sc1
s_nop 1
v_cvt_pk_bf16_f32 v136, v136, v137
v_cvt_pk_bf16_f32 v137, v138, v139
v_cvt_pk_bf16_f32 v138, v140, v141
v_cvt_pk_bf16_f32 v139, v142, v143
s_add_u32 s40, s44, 58368
buffer_store_dwordx4 v[136:139], v12, s[4:7], s40 offen sc1
s_nop 1
v_cvt_pk_bf16_f32 v72, v72, v73
v_cvt_pk_bf16_f32 v73, v74, v75
v_cvt_pk_bf16_f32 v74, v76, v77
v_cvt_pk_bf16_f32 v75, v78, v79
s_add_u32 s40, s44, 57344
buffer_store_dwordx4 v[72:75], v12, s[4:7], s40 offen sc1
s_nop 1
v_cvt_pk_bf16_f32 v192, v192, v193
v_cvt_pk_bf16_f32 v193, v194, v195
v_cvt_pk_bf16_f32 v194, v196, v197
v_cvt_pk_bf16_f32 v195, v198, v199
v_accvgpr_write_b32 a248, v192
v_accvgpr_write_b32 a249, v193
v_accvgpr_write_b32 a250, v194
v_accvgpr_write_b32 a251, v195
v_cvt_pk_bf16_f32 v128, v128, v129
v_cvt_pk_bf16_f32 v129, v130, v131
v_cvt_pk_bf16_f32 v130, v132, v133
v_cvt_pk_bf16_f32 v131, v134, v135
v_accvgpr_write_b32 a244, v128
v_accvgpr_write_b32 a245, v129
v_accvgpr_write_b32 a246, v130
v_accvgpr_write_b32 a247, v131
v_cvt_pk_bf16_f32 v64, v64, v65
v_cvt_pk_bf16_f32 v65, v66, v67
v_cvt_pk_bf16_f32 v66, v68, v69
v_cvt_pk_bf16_f32 v67, v70, v71
v_accvgpr_write_b32 a240, v64
v_accvgpr_write_b32 a241, v65
v_accvgpr_write_b32 a242, v66
v_accvgpr_write_b32 a243, v67
v_cvt_pk_bf16_f32 v248, v248, v249
v_cvt_pk_bf16_f32 v249, v250, v251
v_cvt_pk_bf16_f32 v250, v252, v253
v_cvt_pk_bf16_f32 v251, v254, v255
v_accvgpr_write_b32 a236, v248
v_accvgpr_write_b32 a237, v249
v_accvgpr_write_b32 a238, v250
v_accvgpr_write_b32 a239, v251
v_cvt_pk_bf16_f32 v184, v184, v185
v_cvt_pk_bf16_f32 v185, v186, v187
v_cvt_pk_bf16_f32 v186, v188, v189
v_cvt_pk_bf16_f32 v187, v190, v191
v_accvgpr_write_b32 a232, v184
v_accvgpr_write_b32 a233, v185
v_accvgpr_write_b32 a234, v186
v_accvgpr_write_b32 a235, v187
v_cvt_pk_bf16_f32 v120, v120, v121
v_cvt_pk_bf16_f32 v121, v122, v123
v_cvt_pk_bf16_f32 v122, v124, v125
v_cvt_pk_bf16_f32 v123, v126, v127
v_accvgpr_write_b32 a228, v120
v_accvgpr_write_b32 a229, v121
v_accvgpr_write_b32 a230, v122
v_accvgpr_write_b32 a231, v123
v_cvt_pk_bf16_f32 v56, v56, v57
v_cvt_pk_bf16_f32 v57, v58, v59
v_cvt_pk_bf16_f32 v58, v60, v61
v_cvt_pk_bf16_f32 v59, v62, v63
v_accvgpr_write_b32 a224, v56
v_accvgpr_write_b32 a225, v57
v_accvgpr_write_b32 a226, v58
v_accvgpr_write_b32 a227, v59
v_cvt_pk_bf16_f32 v240, v240, v241
v_cvt_pk_bf16_f32 v241, v242, v243
v_cvt_pk_bf16_f32 v242, v244, v245
v_cvt_pk_bf16_f32 v243, v246, v247
v_accvgpr_write_b32 a220, v240
v_accvgpr_write_b32 a221, v241
v_accvgpr_write_b32 a222, v242
v_accvgpr_write_b32 a223, v243
v_cvt_pk_bf16_f32 v176, v176, v177
v_cvt_pk_bf16_f32 v177, v178, v179
v_cvt_pk_bf16_f32 v178, v180, v181
v_cvt_pk_bf16_f32 v179, v182, v183
v_accvgpr_write_b32 a216, v176
v_accvgpr_write_b32 a217, v177
v_accvgpr_write_b32 a218, v178
v_accvgpr_write_b32 a219, v179
v_cvt_pk_bf16_f32 v112, v112, v113
v_cvt_pk_bf16_f32 v113, v114, v115
v_cvt_pk_bf16_f32 v114, v116, v117
v_cvt_pk_bf16_f32 v115, v118, v119
v_accvgpr_write_b32 a212, v112
v_accvgpr_write_b32 a213, v113
v_accvgpr_write_b32 a214, v114
v_accvgpr_write_b32 a215, v115
v_cvt_pk_bf16_f32 v48, v48, v49
v_cvt_pk_bf16_f32 v49, v50, v51
v_cvt_pk_bf16_f32 v50, v52, v53
v_cvt_pk_bf16_f32 v51, v54, v55
v_accvgpr_write_b32 a208, v48
v_accvgpr_write_b32 a209, v49
v_accvgpr_write_b32 a210, v50
v_accvgpr_write_b32 a211, v51
v_cvt_pk_bf16_f32 v232, v232, v233
v_cvt_pk_bf16_f32 v233, v234, v235
v_cvt_pk_bf16_f32 v234, v236, v237
v_cvt_pk_bf16_f32 v235, v238, v239
v_accvgpr_write_b32 a204, v232
v_accvgpr_write_b32 a205, v233
v_accvgpr_write_b32 a206, v234
v_accvgpr_write_b32 a207, v235
v_cvt_pk_bf16_f32 v168, v168, v169
v_cvt_pk_bf16_f32 v169, v170, v171
v_cvt_pk_bf16_f32 v170, v172, v173
v_cvt_pk_bf16_f32 v171, v174, v175
v_accvgpr_write_b32 a200, v168
v_accvgpr_write_b32 a201, v169
v_accvgpr_write_b32 a202, v170
v_accvgpr_write_b32 a203, v171
v_cvt_pk_bf16_f32 v104, v104, v105
v_cvt_pk_bf16_f32 v105, v106, v107
v_cvt_pk_bf16_f32 v106, v108, v109
v_cvt_pk_bf16_f32 v107, v110, v111
v_accvgpr_write_b32 a196, v104
v_accvgpr_write_b32 a197, v105
v_accvgpr_write_b32 a198, v106
v_accvgpr_write_b32 a199, v107
v_cvt_pk_bf16_f32 v40, v40, v41
v_cvt_pk_bf16_f32 v41, v42, v43
v_cvt_pk_bf16_f32 v42, v44, v45
v_cvt_pk_bf16_f32 v43, v46, v47
v_accvgpr_write_b32 a192, v40
v_accvgpr_write_b32 a193, v41
v_accvgpr_write_b32 a194, v42
v_accvgpr_write_b32 a195, v43
v_cvt_pk_bf16_f32 v224, v224, v225
v_cvt_pk_bf16_f32 v225, v226, v227
v_cvt_pk_bf16_f32 v226, v228, v229
v_cvt_pk_bf16_f32 v227, v230, v231
v_accvgpr_write_b32 a188, v224
v_accvgpr_write_b32 a189, v225
v_accvgpr_write_b32 a190, v226
v_accvgpr_write_b32 a191, v227
v_cvt_pk_bf16_f32 v160, v160, v161
v_cvt_pk_bf16_f32 v161, v162, v163
v_cvt_pk_bf16_f32 v162, v164, v165
v_cvt_pk_bf16_f32 v163, v166, v167
v_accvgpr_write_b32 a184, v160
v_accvgpr_write_b32 a185, v161
v_accvgpr_write_b32 a186, v162
v_accvgpr_write_b32 a187, v163
v_cvt_pk_bf16_f32 v96, v96, v97
v_cvt_pk_bf16_f32 v97, v98, v99
v_cvt_pk_bf16_f32 v98, v100, v101
v_cvt_pk_bf16_f32 v99, v102, v103
v_accvgpr_write_b32 a180, v96
v_accvgpr_write_b32 a181, v97
v_accvgpr_write_b32 a182, v98
v_accvgpr_write_b32 a183, v99
v_cvt_pk_bf16_f32 v32, v32, v33
v_cvt_pk_bf16_f32 v33, v34, v35
v_cvt_pk_bf16_f32 v34, v36, v37
v_cvt_pk_bf16_f32 v35, v38, v39
v_accvgpr_write_b32 a176, v32
v_accvgpr_write_b32 a177, v33
v_accvgpr_write_b32 a178, v34
v_accvgpr_write_b32 a179, v35
v_cvt_pk_bf16_f32 v216, v216, v217
v_cvt_pk_bf16_f32 v217, v218, v219
v_cvt_pk_bf16_f32 v218, v220, v221
v_cvt_pk_bf16_f32 v219, v222, v223
v_accvgpr_write_b32 a172, v216
v_accvgpr_write_b32 a173, v217
v_accvgpr_write_b32 a174, v218
v_accvgpr_write_b32 a175, v219
v_cvt_pk_bf16_f32 v152, v152, v153
v_cvt_pk_bf16_f32 v153, v154, v155
v_cvt_pk_bf16_f32 v154, v156, v157
v_cvt_pk_bf16_f32 v155, v158, v159
v_accvgpr_write_b32 a168, v152
v_accvgpr_write_b32 a169, v153
v_accvgpr_write_b32 a170, v154
v_accvgpr_write_b32 a171, v155
v_cvt_pk_bf16_f32 v88, v88, v89
v_cvt_pk_bf16_f32 v89, v90, v91
v_cvt_pk_bf16_f32 v90, v92, v93
v_cvt_pk_bf16_f32 v91, v94, v95
v_accvgpr_write_b32 a164, v88
v_accvgpr_write_b32 a165, v89
v_accvgpr_write_b32 a166, v90
v_accvgpr_write_b32 a167, v91
v_cvt_pk_bf16_f32 v24, v24, v25
v_cvt_pk_bf16_f32 v25, v26, v27
v_cvt_pk_bf16_f32 v26, v28, v29
v_cvt_pk_bf16_f32 v27, v30, v31
v_accvgpr_write_b32 a160, v24
v_accvgpr_write_b32 a161, v25
v_accvgpr_write_b32 a162, v26
v_accvgpr_write_b32 a163, v27
v_cvt_pk_bf16_f32 v208, v208, v209
v_cvt_pk_bf16_f32 v209, v210, v211
v_cvt_pk_bf16_f32 v210, v212, v213
v_cvt_pk_bf16_f32 v211, v214, v215
v_accvgpr_write_b32 a156, v208
v_accvgpr_write_b32 a157, v209
v_accvgpr_write_b32 a158, v210
v_accvgpr_write_b32 a159, v211
v_cvt_pk_bf16_f32 v144, v144, v145
v_cvt_pk_bf16_f32 v145, v146, v147
v_cvt_pk_bf16_f32 v146, v148, v149
v_cvt_pk_bf16_f32 v147, v150, v151
v_accvgpr_write_b32 a152, v144
v_accvgpr_write_b32 a153, v145
v_accvgpr_write_b32 a154, v146
v_accvgpr_write_b32 a155, v147
v_cvt_pk_bf16_f32 v80, v80, v81
v_cvt_pk_bf16_f32 v81, v82, v83
v_cvt_pk_bf16_f32 v82, v84, v85
v_cvt_pk_bf16_f32 v83, v86, v87
v_accvgpr_write_b32 a148, v80
v_accvgpr_write_b32 a149, v81
v_accvgpr_write_b32 a150, v82
v_accvgpr_write_b32 a151, v83
v_cvt_pk_bf16_f32 v16, v16, v17
v_cvt_pk_bf16_f32 v17, v18, v19
v_cvt_pk_bf16_f32 v18, v20, v21
v_cvt_pk_bf16_f32 v19, v22, v23
v_accvgpr_write_b32 a144, v16
v_accvgpr_write_b32 a145, v17
v_accvgpr_write_b32 a146, v18
v_accvgpr_write_b32 a147, v19
v_accvgpr_read_b32 v16, a136
v_accvgpr_read_b32 v20, a140
v_accvgpr_read_b32 v17, a137
v_accvgpr_read_b32 v21, a141
v_accvgpr_read_b32 v18, a138
v_accvgpr_read_b32 v22, a142
v_accvgpr_read_b32 v19, a139
v_accvgpr_read_b32 v23, a143
v_cvt_pk_bf16_f32 v16, v16, v17
v_cvt_pk_bf16_f32 v17, v18, v19
v_cvt_pk_bf16_f32 v18, v20, v21
v_cvt_pk_bf16_f32 v19, v22, v23
s_add_u32 s40, s44, 62464
buffer_store_dwordx4 v[16:19], v12, s[4:7], s40 offen sc1
s_nop 1
v_accvgpr_read_b32 v16, a128
v_accvgpr_read_b32 v20, a132
v_accvgpr_read_b32 v17, a129
v_accvgpr_read_b32 v21, a133
v_accvgpr_read_b32 v18, a130
v_accvgpr_read_b32 v22, a134
v_accvgpr_read_b32 v19, a131
v_accvgpr_read_b32 v23, a135
v_cvt_pk_bf16_f32 v16, v16, v17
v_cvt_pk_bf16_f32 v17, v18, v19
v_cvt_pk_bf16_f32 v18, v20, v21
v_cvt_pk_bf16_f32 v19, v22, v23
v_accvgpr_write_b32 a252, v16
v_accvgpr_write_b32 a253, v17
v_accvgpr_write_b32 a254, v18
v_accvgpr_write_b32 a255, v19
s_branch fused_kernel_qend
fused_kernel_qtail1:
s_waitcnt vmcnt(16) lgkmcnt(0)
s_barrier
v_mfma_f32_16x16x32_bf16 v[16:19], a[0:3], a[32:35], v[16:19]
v_add_u32 v7, s38, v5
s_add_u32 s38, s38, 32768
v_mfma_f32_16x16x32_bf16 v[20:23], a[4:7], a[32:35], v[20:23]
ds_read_b64_tr_b16 a[96:97], v8 offset:16384
v_mfma_f32_16x16x32_bf16 v[80:83], a[8:11], a[32:35], v[80:83]
ds_read_b64_tr_b16 a[98:99], v8 offset:17408
v_mfma_f32_16x16x32_bf16 v[84:87], a[12:15], a[32:35], v[84:87]
s_cmp_ge_u32 s38, s42
v_mfma_f32_16x16x32_bf16 v[144:147], a[16:19], a[32:35], v[144:147]
ds_read_b128 a[64:67], v7 offset:0
v_mfma_f32_16x16x32_bf16 v[148:151], a[20:23], a[32:35], v[148:151]
ds_read_b128 a[68:71], v7 offset:2048
v_mfma_f32_16x16x32_bf16 v[208:211], a[24:27], a[32:35], v[208:211]
v_mfma_f32_16x16x32_bf16 v[212:215], a[28:31], a[32:35], v[212:215]
ds_read_b128 a[72:75], v7 offset:4096
s_cselect_b32 s38, s41, s38
v_mfma_f32_16x16x32_bf16 v[24:27], a[0:3], a[36:39], v[24:27]
v_mfma_f32_16x16x32_bf16 v[28:31], a[4:7], a[36:39], v[28:31]
ds_read_b128 a[76:79], v7 offset:6144
v_mfma_f32_16x16x32_bf16 v[88:91], a[8:11], a[36:39], v[88:91]
ds_read_b128 a[80:83], v7 offset:8192
v_mfma_f32_16x16x32_bf16 v[92:95], a[12:15], a[36:39], v[92:95]
s_add_u32 s58, s48, 0
v_mfma_f32_16x16x32_bf16 v[152:155], a[16:19], a[36:39], v[152:155]
ds_read_b128 a[84:87], v7 offset:10240
v_mfma_f32_16x16x32_bf16 v[156:159], a[20:23], a[36:39], v[156:159]
v_mfma_f32_16x16x32_bf16 v[216:219], a[24:27], a[36:39], v[216:219]
ds_read_b128 a[88:91], v7 offset:12288
s_lshl_b32 s58, s58, 7
v_mfma_f32_16x16x32_bf16 v[220:223], a[28:31], a[36:39], v[220:223]
ds_read_b128 a[92:95], v7 offset:14336
v_mfma_f32_16x16x32_bf16 v[32:35], a[0:3], a[40:43], v[32:35]
v_mfma_f32_16x16x32_bf16 v[36:39], a[4:7], a[40:43], v[36:39]
ds_read_b64_tr_b16 a[100:101], v9 offset:16384
v_mfma_f32_16x16x32_bf16 v[96:99], a[8:11], a[40:43], v[96:99]
ds_read_b64_tr_b16 a[102:103], v9 offset:17408
s_add_u32 s58, s58, 0x5b00000
v_mfma_f32_16x16x32_bf16 v[100:103], a[12:15], a[40:43], v[100:103]
v_mfma_f32_16x16x32_bf16 v[160:163], a[16:19], a[40:43], v[160:163]
ds_read_b64_tr_b16 a[104:105], v10 offset:16384
v_mfma_f32_16x16x32_bf16 v[164:167], a[20:23], a[40:43], v[164:167]
v_mfma_f32_16x16x32_bf16 v[224:227], a[24:27], a[40:43], v[224:227]
ds_read_b64_tr_b16 a[106:107], v10 offset:17408
s_add_u32 s59, s48, 48
v_mfma_f32_16x16x32_bf16 v[228:231], a[28:31], a[40:43], v[228:231]
ds_read_b64_tr_b16 a[108:109], v11 offset:16384
v_mfma_f32_16x16x32_bf16 v[40:43], a[0:3], a[44:47], v[40:43]
v_mfma_f32_16x16x32_bf16 v[44:47], a[4:7], a[44:47], v[44:47]
ds_read_b64_tr_b16 a[110:111], v11 offset:17408
s_lshl_b32 s59, s59, 7
v_mfma_f32_16x16x32_bf16 v[104:107], a[8:11], a[44:47], v[104:107]
v_mfma_f32_16x16x32_bf16 v[108:111], a[12:15], a[44:47], v[108:111]
ds_read_b64_tr_b16 a[112:113], v8 offset:24576
v_mfma_f32_16x16x32_bf16 v[168:171], a[16:19], a[44:47], v[168:171]
ds_read_b64_tr_b16 a[114:115], v8 offset:25600
v_mfma_f32_16x16x32_bf16 v[172:175], a[20:23], a[44:47], v[172:175]
s_add_u32 s59, s59, 0x5b00000
v_mfma_f32_16x16x32_bf16 v[232:235], a[24:27], a[44:47], v[232:235]
ds_read_b64_tr_b16 a[116:117], v9 offset:24576
v_mfma_f32_16x16x32_bf16 v[236:239], a[28:31], a[44:47], v[236:239]
ds_read_b64_tr_b16 a[118:119], v9 offset:25600
v_mfma_f32_16x16x32_bf16 v[48:51], a[0:3], a[48:51], v[48:51]
v_mfma_f32_16x16x32_bf16 v[52:55], a[4:7], a[48:51], v[52:55]
ds_read_b64_tr_b16 a[120:121], v10 offset:24576
s_add_u32 s66, s48, 32
v_mfma_f32_16x16x32_bf16 v[112:115], a[8:11], a[48:51], v[112:115]
v_mfma_f32_16x16x32_bf16 v[116:119], a[12:15], a[48:51], v[116:119]
ds_read_b64_tr_b16 a[122:123], v10 offset:25600
v_mfma_f32_16x16x32_bf16 v[176:179], a[16:19], a[48:51], v[176:179]
ds_read_b64_tr_b16 a[124:125], v11 offset:24576
v_mfma_f32_16x16x32_bf16 v[180:183], a[20:23], a[48:51], v[180:183]
s_lshl_b32 s66, s66, 7
v_mfma_f32_16x16x32_bf16 v[240:243], a[24:27], a[48:51], v[240:243]
ds_read_b64_tr_b16 a[126:127], v11 offset:25600
v_mfma_f32_16x16x32_bf16 v[244:247], a[28:31], a[48:51], v[244:247]
v_mfma_f32_16x16x32_bf16 v[56:59], a[0:3], a[52:55], v[56:59]
s_add_u32 s66, s66, 0x5b00000
v_mfma_f32_16x16x32_bf16 v[60:63], a[4:7], a[52:55], v[60:63]
v_mfma_f32_16x16x32_bf16 v[120:123], a[8:11], a[52:55], v[120:123]
v_mfma_f32_16x16x32_bf16 v[124:127], a[12:15], a[52:55], v[124:127]
v_mfma_f32_16x16x32_bf16 v[184:187], a[16:19], a[52:55], v[184:187]
s_mov_b32 s66, s58
v_mfma_f32_16x16x32_bf16 v[188:191], a[20:23], a[52:55], v[188:191]
v_mfma_f32_16x16x32_bf16 v[248:251], a[24:27], a[52:55], v[248:251]
v_mfma_f32_16x16x32_bf16 v[252:255], a[28:31], a[52:55], v[252:255]
v_mfma_f32_16x16x32_bf16 v[64:67], a[0:3], a[56:59], v[64:67]
v_mov_b32 v13, s66
v_mfma_f32_16x16x32_bf16 v[68:71], a[4:7], a[56:59], v[68:71]
v_mfma_f32_16x16x32_bf16 v[128:131], a[8:11], a[56:59], v[128:131]
v_mfma_f32_16x16x32_bf16 v[132:135], a[12:15], a[56:59], v[132:135]
v_writelane_b32 v13, s58, 0
v_mfma_f32_16x16x32_bf16 v[192:195], a[16:19], a[56:59], v[192:195]
v_mfma_f32_16x16x32_bf16 v[196:199], a[20:23], a[56:59], v[196:199]
v_mfma_f32_16x16x32_bf16 a[128:131], a[24:27], a[56:59], a[128:131]
v_mfma_f32_16x16x32_bf16 a[132:135], a[28:31], a[56:59], a[132:135]
v_writelane_b32 v13, s59, 1
v_mfma_f32_16x16x32_bf16 v[72:75], a[0:3], a[60:63], v[72:75]
v_mfma_f32_16x16x32_bf16 v[76:79], a[4:7], a[60:63], v[76:79]
v_mfma_f32_16x16x32_bf16 v[136:139], a[8:11], a[60:63], v[136:139]
v_mfma_f32_16x16x32_bf16 v[140:143], a[12:15], a[60:63], v[140:143]
buffer_load_dword v14, v13, s[4:7], 0 offen sc1
v_mfma_f32_16x16x32_bf16 v[200:203], a[16:19], a[60:63], v[200:203]
v_mfma_f32_16x16x32_bf16 v[204:207], a[20:23], a[60:63], v[204:207]
v_mfma_f32_16x16x32_bf16 a[136:139], a[24:27], a[60:63], a[136:139]
v_mfma_f32_16x16x32_bf16 a[140:143], a[28:31], a[60:63], a[140:143]
s_waitcnt vmcnt(0) lgkmcnt(0)
s_mov_b32 s67, 0x80000
fused_kernel_dpoll_44:
v_readlane_b32 s66, v14, 0
v_readlane_b32 s68, v14, 1
v_readlane_b32 s69, v14, 2
s_sub_u32 s67, s67, 1
s_cmp_eq_u32 s67, 0
s_cbranch_scc1 fused_kernel_dok_43
s_min_u32 s66, s66, s68
s_min_u32 s66, s66, s69
s_cmp_ge_u32 s66, 8
s_cbranch_scc1 fused_kernel_dok_43
s_sleep 1
buffer_load_dword v14, v13, s[4:7], 0 offen sc1
s_waitcnt vmcnt(0)
s_branch fused_kernel_dpoll_44
fused_kernel_dok_43:
s_barrier
v_mfma_f32_16x16x32_bf16 v[16:19], a[64:67], a[96:99], v[16:19]
s_and_b32 s28, s2, 7
s_lshr_b32 s29, s2, 3
s_lshr_b32 s30, s29, 4
v_mfma_f32_16x16x32_bf16 v[20:23], a[68:71], a[96:99], v[20:23]
s_lshl_b32 s8, s28, 1
s_add_u32 s8, s8, s30
v_mfma_f32_16x16x32_bf16 v[80:83], a[72:75], a[96:99], v[80:83]
s_bfe_u32 s9, s29, 0x30001
s_and_b32 s10, s29, 1
s_lshl_b32 s37, s8, 3
v_mfma_f32_16x16x32_bf16 v[84:87], a[76:79], a[96:99], v[84:87]
s_add_u32 s37, s37, s9
s_lshl_b32 s33, s3, 12
v_mfma_f32_16x16x32_bf16 v[144:147], a[80:83], a[96:99], v[144:147]
s_sub_u32 s22, 15, s9
s_lshl_b32 s29, s22, 2
v_mfma_f32_16x16x32_bf16 v[148:151], a[84:87], a[96:99], v[148:151]
s_add_u32 s29, s29, 4
s_cmp_eq_u32 s9, 0
s_cselect_b32 s30, 40, 38
v_mfma_f32_16x16x32_bf16 v[208:211], a[88:91], a[96:99], v[208:211]
s_min_u32 s30, s29, s30
s_sub_u32 s11, s29, s30
v_mfma_f32_16x16x32_bf16 v[212:215], a[92:95], a[96:99], v[212:215]
s_lshl_b32 s58, s9, 2
s_add_u32 s58, s58, 4
v_mfma_f32_16x16x32_bf16 v[24:27], a[64:67], a[100:103], v[24:27]
s_cmp_eq_u32 s11, 0
s_cselect_b32 s32, 0, 1
s_cselect_b32 s38, 0, 3
v_mfma_f32_16x16x32_bf16 v[28:31], a[68:71], a[100:103], v[28:31]
s_cmp_eq_u32 s10, 0
s_cselect_b32 s32, s32, s38
v_mfma_f32_16x16x32_bf16 v[88:91], a[72:75], a[100:103], v[88:91]
s_cselect_b32 s34, s30, s58
s_cselect_b32 s22, s22, s9
v_mfma_f32_16x16x32_bf16 v[92:95], a[76:79], a[100:103], v[92:95]
s_mov_b32 s35, 0
s_lshl_b32 s28, s8, 20
s_add_u32 s28, s28, s33
v_mfma_f32_16x16x32_bf16 v[152:155], a[80:83], a[100:103], v[152:155]
s_add_u32 s12, s28, 0x1200000
s_add_u32 s13, s28, 0x2200000
v_mfma_f32_16x16x32_bf16 v[156:159], a[84:87], a[100:103], v[156:159]
s_lshl_b32 s31, s58, 14
s_add_u32 s14, s12, s31
v_mfma_f32_16x16x32_bf16 v[216:219], a[88:91], a[100:103], v[216:219]
s_add_u32 s15, s13, s31
s_lshl_b32 s31, s30, 14
s_add_u32 s16, s12, s31
v_mfma_f32_16x16x32_bf16 v[220:223], a[92:95], a[100:103], v[220:223]
s_add_u32 s17, s13, s31
s_cmp_eq_u32 s32, 3
v_mfma_f32_16x16x32_bf16 v[32:35], a[64:67], a[104:107], v[32:35]
s_cselect_b32 s14, s14, -1
s_cselect_b32 s15, s15, -1
v_mfma_f32_16x16x32_bf16 v[36:39], a[68:71], a[104:107], v[36:39]
s_add_u32 s20, s33, 163840
s_mov_b32 s25, s30
s_sub_u32 s39, s58, 7
v_mfma_f32_16x16x32_bf16 v[96:99], a[72:75], a[104:107], v[96:99]
s_cmp_eq_u32 s32, 3
s_cselect_b32 s39, s39, -1
v_mfma_f32_16x16x32_bf16 v[100:103], a[76:79], a[104:107], v[100:103]
s_cmp_eq_u32 s9, 0
s_cselect_b32 s39, -1, s39
v_mfma_f32_16x16x32_bf16 v[160:163], a[80:83], a[104:107], v[160:163]
s_cmp_eq_u32 s10, 0
s_cselect_b32 s39, 25, s39
s_mov_b32 s38, 0
v_mfma_f32_16x16x32_bf16 v[164:167], a[84:87], a[104:107], v[164:167]
s_cmp_eq_u32 s9, 0
s_cselect_b32 s59, 1, 0
v_mfma_f32_16x16x32_bf16 v[224:227], a[88:91], a[104:107], v[224:227]
s_cmp_eq_u32 s32, 3
s_cselect_b32 s59, s59, 0
s_lshl_b32 s24, s22, 2
v_mfma_f32_16x16x32_bf16 v[228:231], a[92:95], a[104:107], v[228:231]
s_mov_b32 s23, s35
s_sub_u32 s21, s34, 2
v_mfma_f32_16x16x32_bf16 v[40:43], a[64:67], a[108:111], v[40:43]
s_lshr_b32 s21, s21, 1
s_lshl_b32 s28, s8, 6
v_mfma_f32_16x16x32_bf16 v[44:47], a[68:71], a[108:111], v[44:47]
s_lshl_b32 s29, s22, 2
s_add_u32 s28, s28, s29
s_add_u32 s28, s28, s3
v_mfma_f32_16x16x32_bf16 v[104:107], a[72:75], a[108:111], v[104:107]
s_lshl_b32 s28, s28, 14
s_add_u32 s36, s28, 0x200000
v_mfma_f32_16x16x32_bf16 v[108:111], a[76:79], a[108:111], v[108:111]
v_lshlrev_b32 v12, 4, v1
v_bfe_u32 v0, v1, 4, 1
v_mfma_f32_16x16x32_bf16 v[168:171], a[80:83], a[108:111], v[168:171]
v_lshlrev_b32 v0, 13, v0
v_lshrrev_b32 v14, 5, v1
v_lshl_add_u32 v0, v14, 8, v0
v_mfma_f32_16x16x32_bf16 v[172:175], a[84:87], a[108:111], v[172:175]
v_and_b32 v14, 15, v1
v_lshl_add_u32 v0, v14, 4, v0
v_mfma_f32_16x16x32_bf16 v[232:235], a[88:91], a[108:111], v[232:235]
s_add_u32 s28, s36, 0
buffer_load_dwordx4 a[0:3], v0, s[4:7], s28 offen offset:0
v_mfma_f32_16x16x32_bf16 v[236:239], a[92:95], a[108:111], v[236:239]
buffer_load_dwordx4 a[4:7], v0, s[4:7], s28 offen offset:512
buffer_load_dwordx4 a[8:11], v0, s[4:7], s28 offen offset:1024
buffer_load_dwordx4 a[12:15], v0, s[4:7], s28 offen offset:1536
v_mfma_f32_16x16x32_bf16 v[48:51], a[64:67], a[112:115], v[48:51]
buffer_load_dwordx4 a[16:19], v0, s[4:7], s28 offen offset:2048
buffer_load_dwordx4 a[20:23], v0, s[4:7], s28 offen offset:2560
v_mfma_f32_16x16x32_bf16 v[52:55], a[68:71], a[112:115], v[52:55]
buffer_load_dwordx4 a[24:27], v0, s[4:7], s28 offen offset:3072
buffer_load_dwordx4 a[28:31], v0, s[4:7], s28 offen offset:3584
v_mfma_f32_16x16x32_bf16 v[112:115], a[72:75], a[112:115], v[112:115]
s_add_u32 s28, s36, 4096
buffer_load_dwordx4 a[32:35], v0, s[4:7], s28 offen offset:0
buffer_load_dwordx4 a[36:39], v0, s[4:7], s28 offen offset:512
v_mfma_f32_16x16x32_bf16 v[116:119], a[76:79], a[112:115], v[116:119]
buffer_load_dwordx4 a[40:43], v0, s[4:7], s28 offen offset:1024
buffer_load_dwordx4 a[44:47], v0, s[4:7], s28 offen offset:1536
v_mfma_f32_16x16x32_bf16 v[176:179], a[80:83], a[112:115], v[176:179]
buffer_load_dwordx4 a[48:51], v0, s[4:7], s28 offen offset:2048
buffer_load_dwordx4 a[52:55], v0, s[4:7], s28 offen offset:2560
v_mfma_f32_16x16x32_bf16 v[180:183], a[84:87], a[112:115], v[180:183]
buffer_load_dwordx4 a[56:59], v0, s[4:7], s28 offen offset:3072
buffer_load_dwordx4 a[60:63], v0, s[4:7], s28 offen offset:3584
s_add_u32 m0, s33, 0
v_mfma_f32_16x16x32_bf16 v[240:243], a[88:91], a[112:115], v[240:243]
buffer_load_dwordx4 v12, s[4:7], s12 offen offset:0 lds
buffer_load_dwordx4 v12, s[4:7], s12 offen offset:1024 lds
v_mfma_f32_16x16x32_bf16 v[244:247], a[92:95], a[112:115], v[244:247]
buffer_load_dwordx4 v12, s[4:7], s12 offen offset:2048 lds
buffer_load_dwordx4 v12, s[4:7], s12 offen offset:3072 lds
v_mfma_f32_16x16x32_bf16 v[56:59], a[64:67], a[116:119], v[56:59]
s_add_u32 s12, s12, 16384
s_cmp_eq_u32 s12, s14
s_cselect_b32 s12, s16, s12
v_mfma_f32_16x16x32_bf16 v[60:63], a[68:71], a[116:119], v[60:63]
s_add_u32 m0, s33, 32768
s_nop 0
buffer_load_dwordx4 v12, s[4:7], s12 offen offset:0 lds
v_mfma_f32_16x16x32_bf16 v[120:123], a[72:75], a[116:119], v[120:123]
buffer_load_dwordx4 v12, s[4:7], s12 offen offset:1024 lds
buffer_load_dwordx4 v12, s[4:7], s12 offen offset:2048 lds
buffer_load_dwordx4 v12, s[4:7], s12 offen offset:3072 lds
v_mfma_f32_16x16x32_bf16 v[124:127], a[76:79], a[116:119], v[124:127]
s_add_u32 s12, s12, 16384
s_cmp_eq_u32 s12, s14
v_mfma_f32_16x16x32_bf16 v[184:187], a[80:83], a[116:119], v[184:187]
s_cselect_b32 s12, s16, s12
s_add_u32 m0, s33, 65536
v_mfma_f32_16x16x32_bf16 v[188:191], a[84:87], a[116:119], v[188:191]
buffer_load_dwordx4 v12, s[4:7], s12 offen offset:0 lds
buffer_load_dwordx4 v12, s[4:7], s12 offen offset:1024 lds
buffer_load_dwordx4 v12, s[4:7], s12 offen offset:2048 lds
v_mfma_f32_16x16x32_bf16 v[248:251], a[88:91], a[116:119], v[248:251]
buffer_load_dwordx4 v12, s[4:7], s12 offen offset:3072 lds
s_add_u32 s12, s12, 16384
v_mfma_f32_16x16x32_bf16 v[252:255], a[92:95], a[116:119], v[252:255]
s_cmp_eq_u32 s12, s14
s_cselect_b32 s12, s16, s12
v_mfma_f32_16x16x32_bf16 v[64:67], a[64:67], a[120:123], v[64:67]
s_add_u32 m0, s33, 98304
s_nop 0
buffer_load_dwordx4 v12, s[4:7], s12 offen offset:0 lds
buffer_load_dwordx4 v12, s[4:7], s12 offen offset:1024 lds
v_mfma_f32_16x16x32_bf16 v[68:71], a[68:71], a[120:123], v[68:71]
buffer_load_dwordx4 v12, s[4:7], s12 offen offset:2048 lds
buffer_load_dwordx4 v12, s[4:7], s12 offen offset:3072 lds
v_mfma_f32_16x16x32_bf16 v[128:131], a[72:75], a[120:123], v[128:131]
s_add_u32 s12, s12, 16384
s_cmp_eq_u32 s12, s14
v_mfma_f32_16x16x32_bf16 v[132:135], a[76:79], a[120:123], v[132:135]
s_cselect_b32 s12, s16, s12
s_add_u32 m0, s33, 114688
s_nop 0
buffer_load_dwordx4 v12, s[4:7], s13 offen offset:0 lds
v_mfma_f32_16x16x32_bf16 v[192:195], a[80:83], a[120:123], v[192:195]
buffer_load_dwordx4 v12, s[4:7], s13 offen offset:1024 lds
buffer_load_dwordx4 v12, s[4:7], s13 offen offset:2048 lds
v_mfma_f32_16x16x32_bf16 v[196:199], a[84:87], a[120:123], v[196:199]
buffer_load_dwordx4 v12, s[4:7], s13 offen offset:3072 lds
s_add_u32 s13, s13, 16384
v_mfma_f32_16x16x32_bf16 a[128:131], a[88:91], a[120:123], a[128:131]
s_cmp_eq_u32 s13, s15
s_cselect_b32 s13, s17, s13
s_cmp_eq_u32 s59, 1
v_mfma_f32_16x16x32_bf16 a[132:135], a[92:95], a[120:123], a[132:135]
s_cselect_b32 s30, 0x70000000, s12
s_cselect_b32 s31, 0, 16384
v_mfma_f32_16x16x32_bf16 v[72:75], a[64:67], a[124:127], v[72:75]
s_add_u32 m0, s33, 131072
s_nop 0
buffer_load_dwordx4 v12, s[4:7], s30 offen offset:0 lds
v_mfma_f32_16x16x32_bf16 v[76:79], a[68:71], a[124:127], v[76:79]
buffer_load_dwordx4 v12, s[4:7], s30 offen offset:1024 lds
buffer_load_dwordx4 v12, s[4:7], s30 offen offset:2048 lds
buffer_load_dwordx4 v12, s[4:7], s30 offen offset:3072 lds
v_mfma_f32_16x16x32_bf16 v[136:139], a[72:75], a[124:127], v[136:139]
s_add_u32 s12, s12, s31
s_cmp_eq_u32 s12, s14
v_mfma_f32_16x16x32_bf16 v[140:143], a[76:79], a[124:127], v[140:143]
s_cselect_b32 s12, s16, s12
s_add_u32 m0, s33, 147456
v_mfma_f32_16x16x32_bf16 v[200:203], a[80:83], a[124:127], v[200:203]
buffer_load_dwordx4 v12, s[4:7], s13 offen offset:0 lds
buffer_load_dwordx4 v12, s[4:7], s13 offen offset:1024 lds
buffer_load_dwordx4 v12, s[4:7], s13 offen offset:2048 lds
v_mfma_f32_16x16x32_bf16 v[204:207], a[84:87], a[124:127], v[204:207]
buffer_load_dwordx4 v12, s[4:7], s13 offen offset:3072 lds
s_add_u32 s13, s13, 16384
v_mfma_f32_16x16x32_bf16 a[136:139], a[88:91], a[124:127], a[136:139]
s_cmp_eq_u32 s13, s15
s_cselect_b32 s13, s17, s13
v_mfma_f32_16x16x32_bf16 a[140:143], a[92:95], a[124:127], a[140:143]
s_nop 7
v_cvt_pk_bf16_f32 v248, v248, v249
v_cvt_pk_bf16_f32 v249, v250, v251
v_cvt_pk_bf16_f32 v250, v252, v253
v_cvt_pk_bf16_f32 v251, v254, v255
s_add_u32 s40, s44, 61440
buffer_store_dwordx4 v[248:251], v12, s[4:7], s40 offen sc1
s_nop 1
v_cvt_pk_bf16_f32 v232, v232, v233
v_cvt_pk_bf16_f32 v233, v234, v235
v_cvt_pk_bf16_f32 v234, v236, v237
v_cvt_pk_bf16_f32 v235, v238, v239
s_add_u32 s40, s44, 58368
buffer_store_dwordx4 v[232:235], v12, s[4:7], s40 offen sc1
s_nop 1
v_cvt_pk_bf16_f32 v216, v216, v217
v_cvt_pk_bf16_f32 v217, v218, v219
v_cvt_pk_bf16_f32 v218, v220, v221
v_cvt_pk_bf16_f32 v219, v222, v223
s_add_u32 s40, s44, 57344
buffer_store_dwordx4 v[216:219], v12, s[4:7], s40 offen sc1
s_nop 1
v_cvt_pk_bf16_f32 v240, v240, v241
v_cvt_pk_bf16_f32 v241, v242, v243
v_cvt_pk_bf16_f32 v242, v244, v245
v_cvt_pk_bf16_f32 v243, v246, v247
v_accvgpr_write_b32 a248, v240
v_accvgpr_write_b32 a249, v241
v_accvgpr_write_b32 a250, v242
v_accvgpr_write_b32 a251, v243
v_cvt_pk_bf16_f32 v224, v224, v225
v_cvt_pk_bf16_f32 v225, v226, v227
v_cvt_pk_bf16_f32 v226, v228, v229
v_cvt_pk_bf16_f32 v227, v230, v231
v_accvgpr_write_b32 a244, v224
v_accvgpr_write_b32 a245, v225
v_accvgpr_write_b32 a246, v226
v_accvgpr_write_b32 a247, v227
v_cvt_pk_bf16_f32 v208, v208, v209
v_cvt_pk_bf16_f32 v209, v210, v211
v_cvt_pk_bf16_f32 v210, v212, v213
v_cvt_pk_bf16_f32 v211, v214, v215
v_accvgpr_write_b32 a240, v208
v_accvgpr_write_b32 a241, v209
v_accvgpr_write_b32 a242, v210
v_accvgpr_write_b32 a243, v211
v_cvt_pk_bf16_f32 v200, v200, v201
v_cvt_pk_bf16_f32 v201, v202, v203
v_cvt_pk_bf16_f32 v202, v204, v205
v_cvt_pk_bf16_f32 v203, v206, v207
v_accvgpr_write_b32 a236, v200
v_accvgpr_write_b32 a237, v201
v_accvgpr_write_b32 a238, v202
v_accvgpr_write_b32 a239, v203
v_cvt_pk_bf16_f32 v184, v184, v185
v_cvt_pk_bf16_f32 v185, v186, v187
v_cvt_pk_bf16_f32 v186, v188, v189
v_cvt_pk_bf16_f32 v187, v190, v191
v_accvgpr_write_b32 a232, v184
v_accvgpr_write_b32 a233, v185
v_accvgpr_write_b32 a234, v186
v_accvgpr_write_b32 a235, v187
v_cvt_pk_bf16_f32 v168, v168, v169
v_cvt_pk_bf16_f32 v169, v170, v171
v_cvt_pk_bf16_f32 v170, v172, v173
v_cvt_pk_bf16_f32 v171, v174, v175
v_accvgpr_write_b32 a228, v168
v_accvgpr_write_b32 a229, v169
v_accvgpr_write_b32 a230, v170
v_accvgpr_write_b32 a231, v171
v_cvt_pk_bf16_f32 v152, v152, v153
v_cvt_pk_bf16_f32 v153, v154, v155
v_cvt_pk_bf16_f32 v154, v156, v157
v_cvt_pk_bf16_f32 v155, v158, v159
v_accvgpr_write_b32 a224, v152
v_accvgpr_write_b32 a225, v153
v_accvgpr_write_b32 a226, v154
v_accvgpr_write_b32 a227, v155
v_cvt_pk_bf16_f32 v192, v192, v193
v_cvt_pk_bf16_f32 v193, v194, v195
v_cvt_pk_bf16_f32 v194, v196, v197
v_cvt_pk_bf16_f32 v195, v198, v199
v_accvgpr_write_b32 a220, v192
v_accvgpr_write_b32 a221, v193
v_accvgpr_write_b32 a222, v194
v_accvgpr_write_b32 a223, v195
v_cvt_pk_bf16_f32 v176, v176, v177
v_cvt_pk_bf16_f32 v177, v178, v179
v_cvt_pk_bf16_f32 v178, v180, v181
v_cvt_pk_bf16_f32 v179, v182, v183
v_accvgpr_write_b32 a216, v176
v_accvgpr_write_b32 a217, v177
v_accvgpr_write_b32 a218, v178
v_accvgpr_write_b32 a219, v179
v_cvt_pk_bf16_f32 v160, v160, v161
v_cvt_pk_bf16_f32 v161, v162, v163
v_cvt_pk_bf16_f32 v162, v164, v165
v_cvt_pk_bf16_f32 v163, v166, v167
v_accvgpr_write_b32 a212, v160
v_accvgpr_write_b32 a213, v161
v_accvgpr_write_b32 a214, v162
v_accvgpr_write_b32 a215, v163
v_cvt_pk_bf16_f32 v144, v144, v145
v_cvt_pk_bf16_f32 v145, v146, v147
v_cvt_pk_bf16_f32 v146, v148, v149
v_cvt_pk_bf16_f32 v147, v150, v151
v_accvgpr_write_b32 a208, v144
v_accvgpr_write_b32 a209, v145
v_accvgpr_write_b32 a210, v146
v_accvgpr_write_b32 a211, v147
v_cvt_pk_bf16_f32 v136, v136, v137
v_cvt_pk_bf16_f32 v137, v138, v139
v_cvt_pk_bf16_f32 v138, v140, v141
v_cvt_pk_bf16_f32 v139, v142, v143
v_accvgpr_write_b32 a204, v136
v_accvgpr_write_b32 a205, v137
v_accvgpr_write_b32 a206, v138
v_accvgpr_write_b32 a207, v139
v_cvt_pk_bf16_f32 v120, v120, v121
v_cvt_pk_bf16_f32 v121, v122, v123
v_cvt_pk_bf16_f32 v122, v124, v125
v_cvt_pk_bf16_f32 v123, v126, v127
v_accvgpr_write_b32 a200, v120
v_accvgpr_write_b32 a201, v121
v_accvgpr_write_b32 a202, v122
v_accvgpr_write_b32 a203, v123
v_cvt_pk_bf16_f32 v104, v104, v105
v_cvt_pk_bf16_f32 v105, v106, v107
v_cvt_pk_bf16_f32 v106, v108, v109
v_cvt_pk_bf16_f32 v107, v110, v111
v_accvgpr_write_b32 a196, v104
v_accvgpr_write_b32 a197, v105
v_accvgpr_write_b32 a198, v106
v_accvgpr_write_b32 a199, v107
v_cvt_pk_bf16_f32 v88, v88, v89
v_cvt_pk_bf16_f32 v89, v90, v91
v_cvt_pk_bf16_f32 v90, v92, v93
v_cvt_pk_bf16_f32 v91, v94, v95
v_accvgpr_write_b32 a192, v88
v_accvgpr_write_b32 a193, v89
v_accvgpr_write_b32 a194, v90
v_accvgpr_write_b32 a195, v91
v_cvt_pk_bf16_f32 v128, v128, v129
v_cvt_pk_bf16_f32 v129, v130, v131
v_cvt_pk_bf16_f32 v130, v132, v133
v_cvt_pk_bf16_f32 v131, v134, v135
v_accvgpr_write_b32 a188, v128
v_accvgpr_write_b32 a189, v129
v_accvgpr_write_b32 a190, v130
v_accvgpr_write_b32 a191, v131
v_cvt_pk_bf16_f32 v112, v112, v113
v_cvt_pk_bf16_f32 v113, v114, v115
v_cvt_pk_bf16_f32 v114, v116, v117
v_cvt_pk_bf16_f32 v115, v118, v119
v_accvgpr_write_b32 a184, v112
v_accvgpr_write_b32 a185, v113
v_accvgpr_write_b32 a186, v114
v_accvgpr_write_b32 a187, v115
v_cvt_pk_bf16_f32 v96, v96, v97
v_cvt_pk_bf16_f32 v97, v98, v99
v_cvt_pk_bf16_f32 v98, v100, v101
v_cvt_pk_bf16_f32 v99, v102, v103
v_accvgpr_write_b32 a180, v96
v_accvgpr_write_b32 a181, v97
v_accvgpr_write_b32 a182, v98
v_accvgpr_write_b32 a183, v99
v_cvt_pk_bf16_f32 v80, v80, v81
v_cvt_pk_bf16_f32 v81, v82, v83
v_cvt_pk_bf16_f32 v82, v84, v85
v_cvt_pk_bf16_f32 v83, v86, v87
v_accvgpr_write_b32 a176, v80
v_accvgpr_write_b32 a177, v81
v_accvgpr_write_b32 a178, v82
v_accvgpr_write_b32 a179, v83
v_cvt_pk_bf16_f32 v72, v72, v73
v_cvt_pk_bf16_f32 v73, v74, v75
v_cvt_pk_bf16_f32 v74, v76, v77
v_cvt_pk_bf16_f32 v75, v78, v79
v_accvgpr_write_b32 a172, v72
v_accvgpr_write_b32 a173, v73
v_accvgpr_write_b32 a174, v74
v_accvgpr_write_b32 a175, v75
v_cvt_pk_bf16_f32 v56, v56, v57
v_cvt_pk_bf16_f32 v57, v58, v59
v_cvt_pk_bf16_f32 v58, v60, v61
v_cvt_pk_bf16_f32 v59, v62, v63
v_accvgpr_write_b32 a168, v56
v_accvgpr_write_b32 a169, v57
v_accvgpr_write_b32 a170, v58
v_accvgpr_write_b32 a171, v59
v_cvt_pk_bf16_f32 v40, v40, v41
v_cvt_pk_bf16_f32 v41, v42, v43
v_cvt_pk_bf16_f32 v42, v44, v45
v_cvt_pk_bf16_f32 v43, v46, v47
v_accvgpr_write_b32 a164, v40
v_accvgpr_write_b32 a165, v41
v_accvgpr_write_b32 a166, v42
v_accvgpr_write_b32 a167, v43
v_cvt_pk_bf16_f32 v24, v24, v25
v_cvt_pk_bf16_f32 v25, v26, v27
v_cvt_pk_bf16_f32 v26, v28, v29
v_cvt_pk_bf16_f32 v27, v30, v31
v_accvgpr_write_b32 a160, v24
v_accvgpr_write_b32 a161, v25
v_accvgpr_write_b32 a162, v26
v_accvgpr_write_b32 a163, v27
v_cvt_pk_bf16_f32 v64, v64, v65
v_cvt_pk_bf16_f32 v65, v66, v67
v_cvt_pk_bf16_f32 v66, v68, v69
v_cvt_pk_bf16_f32 v67, v70, v71
v_accvgpr_write_b32 a156, v64
v_accvgpr_write_b32 a157, v65
v_accvgpr_write_b32 a158, v66
v_accvgpr_write_b32 a159, v67
v_cvt_pk_bf16_f32 v48, v48, v49
v_cvt_pk_bf16_f32 v49, v50, v51
v_cvt_pk_bf16_f32 v50, v52, v53
v_cvt_pk_bf16_f32 v51, v54, v55
v_accvgpr_write_b32 a152, v48
v_accvgpr_write_b32 a153, v49
v_accvgpr_write_b32 a154, v50
v_accvgpr_write_b32 a155, v51
v_cvt_pk_bf16_f32 v32, v32, v33
v_cvt_pk_bf16_f32 v33, v34, v35
v_cvt_pk_bf16_f32 v34, v36, v37
v_cvt_pk_bf16_f32 v35, v38, v39
v_accvgpr_write_b32 a148, v32
v_accvgpr_write_b32 a149, v33
v_accvgpr_write_b32 a150, v34
v_accvgpr_write_b32 a151, v35
v_cvt_pk_bf16_f32 v16, v16, v17
v_cvt_pk_bf16_f32 v17, v18, v19
v_cvt_pk_bf16_f32 v18, v20, v21
v_cvt_pk_bf16_f32 v19, v22, v23
v_accvgpr_write_b32 a144, v16
v_accvgpr_write_b32 a145, v17
v_accvgpr_write_b32 a146, v18
v_accvgpr_write_b32 a147, v19
v_accvgpr_read_b32 v16, a136
v_accvgpr_read_b32 v20, a140
v_accvgpr_read_b32 v17, a137
v_accvgpr_read_b32 v21, a141
v_accvgpr_read_b32 v18, a138
v_accvgpr_read_b32 v22, a142
v_accvgpr_read_b32 v19, a139
v_accvgpr_read_b32 v23, a143
v_cvt_pk_bf16_f32 v16, v16, v17
v_cvt_pk_bf16_f32 v17, v18, v19
v_cvt_pk_bf16_f32 v18, v20, v21
v_cvt_pk_bf16_f32 v19, v22, v23
s_add_u32 s40, s44, 62464
buffer_store_dwordx4 v[16:19], v12, s[4:7], s40 offen sc1
s_nop 1
v_accvgpr_read_b32 v16, a128
v_accvgpr_read_b32 v20, a132
v_accvgpr_read_b32 v17, a129
v_accvgpr_read_b32 v21, a133
v_accvgpr_read_b32 v18, a130
v_accvgpr_read_b32 v22, a134
v_accvgpr_read_b32 v19, a131
v_accvgpr_read_b32 v23, a135
v_cvt_pk_bf16_f32 v16, v16, v17
v_cvt_pk_bf16_f32 v17, v18, v19
v_cvt_pk_bf16_f32 v18, v20, v21
v_cvt_pk_bf16_f32 v19, v22, v23
v_accvgpr_write_b32 a252, v16
v_accvgpr_write_b32 a253, v17
v_accvgpr_write_b32 a254, v18
v_accvgpr_write_b32 a255, v19
fused_kernel_qend:
v_mov_b32 v126, 0
v_subrev_u32 v2, s33, v0
v_mov_b32 v10, 0x5b800000
v_lshrrev_b32 v16, 5, v1
v_lshlrev_b32 v16, 2, v16
v_and_b32 v17, 31, v1
v_sub_u32 v9, v16, v17
v_bfe_u32 v16, v1, 4, 1
s_mov_b32 s28, 188416
v_mul_lo_u32 v16, v16, s28
v_lshrrev_b32 v17, 5, v1
v_lshl_add_u32 v16, v17, 8, v16
v_and_b32 v17, 15, v1
v_lshl_add_u32 v11, v17, 4, v16
v_mov_b32 v128, 0
v_mov_b32 v129, 0
v_mov_b32 v130, 0
v_mov_b32 v131, 0
v_mov_b32 v132, 0
v_mov_b32 v133, 0
v_mov_b32 v134, 0
v_mov_b32 v135, 0
v_mov_b32 v136, 0
v_mov_b32 v137, 0
v_mov_b32 v138, 0
v_mov_b32 v139, 0
v_mov_b32 v140, 0
v_mov_b32 v141, 0
v_mov_b32 v142, 0
v_mov_b32 v143, 0
v_mov_b32 v144, 0
v_mov_b32 v145, 0
v_mov_b32 v146, 0
v_mov_b32 v147, 0
v_mov_b32 v148, 0
v_mov_b32 v149, 0
v_mov_b32 v150, 0
v_mov_b32 v151, 0
v_mov_b32 v152, 0
v_mov_b32 v153, 0
v_mov_b32 v154, 0
v_mov_b32 v155, 0
v_mov_b32 v156, 0
v_mov_b32 v157, 0
v_mov_b32 v158, 0
v_mov_b32 v159, 0
v_mov_b32 v160, 0
v_mov_b32 v161, 0
v_mov_b32 v162, 0
v_mov_b32 v163, 0
v_mov_b32 v164, 0
v_mov_b32 v165, 0
v_mov_b32 v166, 0
v_mov_b32 v167, 0
v_mov_b32 v168, 0
v_mov_b32 v169, 0
v_mov_b32 v170, 0
v_mov_b32 v171, 0
v_mov_b32 v172, 0
v_mov_b32 v173, 0
v_mov_b32 v174, 0
v_mov_b32 v175, 0
v_mov_b32 v176, 0
v_mov_b32 v177, 0
v_mov_b32 v178, 0
v_mov_b32 v179, 0
v_mov_b32 v180, 0
v_mov_b32 v181, 0
v_mov_b32 v182, 0
v_mov_b32 v183, 0
v_mov_b32 v184, 0
v_mov_b32 v185, 0
v_mov_b32 v186, 0
v_mov_b32 v187, 0
v_mov_b32 v188, 0
v_mov_b32 v189, 0
v_mov_b32 v190, 0
v_mov_b32 v191, 0
v_mov_b32 v192, 0
v_mov_b32 v193, 0
v_mov_b32 v194, 0
v_mov_b32 v195, 0
v_mov_b32 v196, 0
v_mov_b32 v197, 0
v_mov_b32 v198, 0
v_mov_b32 v199, 0
v_mov_b32 v200, 0
v_mov_b32 v201, 0
v_mov_b32 v202, 0
v_mov_b32 v203, 0
v_mov_b32 v204, 0
v_mov_b32 v205, 0
v_mov_b32 v206, 0
v_mov_b32 v207, 0
v_mov_b32 v208, 0
v_mov_b32 v209, 0
v_mov_b32 v210, 0
v_mov_b32 v211, 0
v_mov_b32 v212, 0
v_mov_b32 v213, 0
v_mov_b32 v214, 0
v_mov_b32 v215, 0
v_mov_b32 v216, 0
v_mov_b32 v217, 0
v_mov_b32 v218, 0
v_mov_b32 v219, 0
v_mov_b32 v220, 0
v_mov_b32 v221, 0
v_mov_b32 v222, 0
v_mov_b32 v223, 0
v_mov_b32 v224, 0
v_mov_b32 v225, 0
v_mov_b32 v226, 0
v_mov_b32 v227, 0
v_mov_b32 v228, 0
v_mov_b32 v229, 0
v_mov_b32 v230, 0
v_mov_b32 v231, 0
v_mov_b32 v232, 0
v_mov_b32 v233, 0
v_mov_b32 v234, 0
v_mov_b32 v235, 0
v_mov_b32 v236, 0
v_mov_b32 v237, 0
v_mov_b32 v238, 0
v_mov_b32 v239, 0
v_mov_b32 v240, 0
v_mov_b32 v241, 0
v_mov_b32 v242, 0
v_mov_b32 v243, 0
v_mov_b32 v244, 0
v_mov_b32 v245, 0
v_mov_b32 v246, 0
v_mov_b32 v247, 0
v_mov_b32 v248, 0
v_mov_b32 v249, 0
v_mov_b32 v250, 0
v_mov_b32 v251, 0
v_mov_b32 v252, 0
v_mov_b32 v253, 0
v_mov_b32 v254, 0
v_mov_b32 v255, 0
s_mov_b32 s49, 0xffff
s_mov_b32 s48, 2
s_cmp_eq_u32 s59, 1
s_cselect_b32 s48, 1, s48
s_branch fused_kernel_dstart2
fused_kernel_dstart:
s_waitcnt vmcnt(63)
s_barrier
s_mov_b32 s18, s33
s_mov_b32 s19, s33
v_add_u32 v3, s18, v2
ds_read_b128 a[64:67], v3 offset:0
ds_read_b128 a[68:71], v3 offset:512
ds_read_b128 a[72:75], v3 offset:1024
ds_read_b128 a[76:79], v3 offset:1536
ds_read_b128 a[80:83], v3 offset:2048
ds_read_b128 a[84:87], v3 offset:2560
ds_read_b128 a[88:91], v3 offset:3072
ds_read_b128 a[92:95], v3 offset:3584
s_waitcnt lgkmcnt(4)
v_mfma_f32_32x32x16_bf16 v[16:31], a[64:67], a[0:3], 0
ds_read_b128 a[64:67], v3 offset:4096
v_mfma_f32_32x32x16_bf16 v[16:31], a[68:71], a[4:7], v[16:31]
ds_read_b128 a[68:71], v3 offset:4608
s_add_u32 m0, s33, 65536
s_nop 0
buffer_load_dwordx4 v12, s[4:7], s12 offen offset:0 lds
buffer_load_dwordx4 v12, s[4:7], s12 offen offset:1024 lds
buffer_load_dwordx4 v12, s[4:7], s12 offen offset:2048 lds
buffer_load_dwordx4 v12, s[4:7], s12 offen offset:3072 lds
v_mfma_f32_32x32x16_bf16 v[16:31], a[72:75], a[8:11], v[16:31]
ds_read_b128 a[72:75], v3 offset:5120
s_add_u32 s12, s12, 16384
s_cmp_eq_u32 s12, s14
s_cselect_b32 s12, s16, s12
s_add_u32 m0, s33, 98304
s_nop 0
buffer_load_dwordx4 v12, s[4:7], s12 offen offset:0 lds
v_mfma_f32_32x32x16_bf16 v[16:31], a[76:79], a[12:15], v[16:31]
ds_read_b128 a[76:79], v3 offset:5632
buffer_load_dwordx4 v12, s[4:7], s12 offen offset:1024 lds
buffer_load_dwordx4 v12, s[4:7], s12 offen offset:2048 lds
buffer_load_dwordx4 v12, s[4:7], s12 offen offset:3072 lds
s_add_u32 s12, s12, 16384
s_cmp_eq_u32 s12, s14
s_waitcnt lgkmcnt(4)
v_mfma_f32_32x32x16_bf16 v[16:31], a[80:83], a[16:19], v[16:31]
ds_read_b128 a[80:83], v3 offset:6144
s_cselect_b32 s12, s16, s12
s_add_u32 m0, s33, 114688
s_nop 0
buffer_load_dwordx4 v12, s[4:7], s13 offen offset:0 lds
buffer_load_dwordx4 v12, s[4:7], s13 offen offset:1024 lds
buffer_load_dwordx4 v12, s[4:7], s13 offen offset:2048 lds
v_mfma_f32_32x32x16_bf16 v[16:31], a[84:87], a[20:23], v[16:31]
ds_read_b128 a[84:87], v3 offset:6656
buffer_load_dwordx4 v12, s[4:7], s13 offen offset:3072 lds
s_add_u32 s13, s13, 16384
s_cmp_eq_u32 s13, s15
s_cselect_b32 s13, s17, s13
s_add_u32 s19, s18, 32768
v_mfma_f32_32x32x16_bf16 v[16:31], a[88:91], a[24:27], v[16:31]
ds_read_b128 a[88:91], v3 offset:7168
s_cmp_ge_u32 s19, s20
s_cselect_b32 s31, 163840, 0
s_sub_u32 s19, s19, s31
v_add_u32 v4, s19, v2
v_mfma_f32_32x32x16_bf16 v[16:31], a[92:95], a[28:31], v[16:31]
ds_read_b128 a[92:95], v3 offset:7680
s_waitcnt vmcnt(63) lgkmcnt(0)
s_barrier
s_waitcnt lgkmcnt(4)
v_mfma_f32_32x32x16_bf16 v[16:31], a[64:67], a[32:35], v[16:31]
ds_read_b128 a[64:67], v4 offset:0
v_mfma_f32_32x32x16_bf16 v[16:31], a[68:71], a[36:39], v[16:31]
ds_read_b128 a[68:71], v4 offset:512
v_mfma_f32_32x32x16_bf16 v[16:31], a[72:75], a[40:43], v[16:31]
ds_read_b128 a[72:75], v4 offset:1024
v_mfma_f32_32x32x16_bf16 v[16:31], a[76:79], a[44:47], v[16:31]
ds_read_b128 a[76:79], v4 offset:1536
s_waitcnt lgkmcnt(4)
v_mfma_f32_32x32x16_bf16 v[16:31], a[80:83], a[48:51], v[16:31]
ds_read_b128 a[80:83], v4 offset:2048
v_mfma_f32_32x32x16_bf16 v[16:31], a[84:87], a[52:55], v[16:31]
ds_read_b128 a[84:87], v4 offset:2560
v_mfma_f32_32x32x16_bf16 v[16:31], a[88:91], a[56:59], v[16:31]
ds_read_b128 a[88:91], v4 offset:3072
v_mfma_f32_32x32x16_bf16 v[16:31], a[92:95], a[60:63], v[16:31]
ds_read_b128 a[92:95], v4 offset:3584
s_waitcnt lgkmcnt(4)
v_mfma_f32_32x32x16_bf16 v[32:47], a[64:67], a[0:3], 0
ds_read_b128 a[64:67], v4 offset:4096
s_cmp_lt_u32 s23, s24
s_cbranch_scc0 fused_kernel_mstub_45
fused_kernel_mback_46:
v_mfma_f32_32x32x16_bf16 v[32:47], a[68:71], a[4:7], v[32:47]
ds_read_b128 a[68:71], v4 offset:4608
s_add_u32 m0, s33, 131072
s_nop 0
buffer_load_dwordx4 v12, s[4:7], s12 offen offset:0 lds
buffer_load_dwordx4 v12, s[4:7], s12 offen offset:1024 lds
buffer_load_dwordx4 v12, s[4:7], s12 offen offset:2048 lds
buffer_load_dwordx4 v12, s[4:7], s12 offen offset:3072 lds
s_add_u32 s12, s12, 16384
s_cmp_eq_u32 s12, s14
s_nop 3
v_max3_f32 v88, v16, v17, v18
v_max3_f32 v88, v88, v19, v20
v_max3_f32 v88, v88, v21, v22
v_max3_f32 v88, v88, v23, v24
v_max3_f32 v88, v88, v25, v26
v_mfma_f32_32x32x16_bf16 v[32:47], a[72:75], a[8:11], v[32:47]
ds_read_b128 a[72:75], v4 offset:5120
s_cselect_b32 s12, s16, s12
s_add_u32 m0, s33, 147456
s_nop 0
buffer_load_dwordx4 v12, s[4:7], s13 offen offset:0 lds
buffer_load_dwordx4 v12, s[4:7], s13 offen offset:1024 lds
buffer_load_dwordx4 v12, s[4:7], s13 offen offset:2048 lds
buffer_load_dwordx4 v12, s[4:7], s13 offen offset:3072 lds
v_max3_f32 v88, v88, v27, v28
v_max3_f32 v88, v88, v29, v30
v_max_f32 v88, v88, v31
v_mov_b32 v89, v88
s_nop 1
v_permlane32_swap_b32 v88, v89
v_mfma_f32_32x32x16_bf16 v[32:47], a[76:79], a[12:15], v[32:47]
ds_read_b128 a[76:79], v4 offset:5632
s_add_u32 s13, s13, 16384
s_cmp_eq_u32 s13, s15
s_cselect_b32 s13, s17, s13
s_mov_b32 m0, s18
s_nop 0
buffer_load_dwordx4 v12, s[4:7], s12 offen offset:0 lds
buffer_load_dwordx4 v12, s[4:7], s12 offen offset:1024 lds
s_nop 1
v_max_f32 v88, v88, v89
v_sub_f32 v16, v16, v88
v_sub_f32 v17, v17, v88
v_sub_f32 v18, v18, v88
v_sub_f32 v19, v19, v88
s_waitcnt lgkmcnt(4)
v_mfma_f32_32x32x16_bf16 v[32:47], a[80:83], a[16:19], v[32:47]
ds_read_b128 a[80:83], v4 offset:6144
buffer_load_dwordx4 v12, s[4:7], s12 offen offset:2048 lds
buffer_load_dwordx4 v12, s[4:7], s12 offen offset:3072 lds
s_add_u32 m0, s18, 16384
s_add_u32 s18, s19, 32768
s_cmp_ge_u32 s18, s20
s_cselect_b32 s31, 163840, 0
v_sub_f32 v20, v20, v88
v_sub_f32 v21, v21, v88
v_sub_f32 v22, v22, v88
v_sub_f32 v23, v23, v88
v_sub_f32 v24, v24, v88
v_sub_f32 v25, v25, v88
v_mfma_f32_32x32x16_bf16 v[32:47], a[84:87], a[20:23], v[32:47]
ds_read_b128 a[84:87], v4 offset:6656
s_sub_u32 s18, s18, s31
v_add_u32 v3, s18, v2
s_add_u32 s12, s12, 16384
buffer_load_dwordx4 v12, s[4:7], s13 offen offset:0 lds
buffer_load_dwordx4 v12, s[4:7], s13 offen offset:1024 lds
buffer_load_dwordx4 v12, s[4:7], s13 offen offset:2048 lds
v_sub_f32 v26, v26, v88
v_sub_f32 v27, v27, v88
v_sub_f32 v28, v28, v88
v_sub_f32 v29, v29, v88
v_sub_f32 v30, v30, v88
v_mfma_f32_32x32x16_bf16 v[32:47], a[88:91], a[24:27], v[32:47]
ds_read_b128 a[88:91], v4 offset:7168
buffer_load_dwordx4 v12, s[4:7], s13 offen offset:3072 lds
s_cmp_eq_u32 s12, s14
s_cselect_b32 s12, s16, s12
s_add_u32 s13, s13, 16384
s_cmp_eq_u32 s13, s15
s_cselect_b32 s13, s17, s13
v_sub_f32 v31, v31, v88
v_exp_f32 v80, v16
v_exp_f32 v81, v17
v_exp_f32 v82, v18
v_exp_f32 v83, v19
v_cvt_pk_bf16_f32 v48, v80, v81
v_mfma_f32_32x32x16_bf16 v[32:47], a[92:95], a[28:31], v[32:47]
ds_read_b128 a[92:95], v4 offset:7680
v_exp_f32 v84, v20
v_add_f32 v7, v80, v82
v_exp_f32 v85, v21
v_add_f32 v8, v81, v83
v_cvt_pk_bf16_f32 v49, v82, v83
v_exp_f32 v86, v22
s_waitcnt vmcnt(16) lgkmcnt(0)
s_barrier
s_waitcnt lgkmcnt(4)
v_mfma_f32_32x32x16_bf16 v[32:47], a[64:67], a[32:35], v[32:47]
ds_read_b128 a[64:67], v3 offset:0
v_add_f32 v7, v7, v84
v_exp_f32 v87, v23
v_add_f32 v8, v8, v85
v_cvt_pk_bf16_f32 v52, v84, v85
v_exp_f32 v80, v24
v_add_f32 v7, v7, v86
v_mfma_f32_32x32x16_bf16 v[32:47], a[68:71], a[36:39], v[32:47]
ds_read_b128 a[68:71], v3 offset:512
s_add_u32 s23, s23, 1
v_exp_f32 v81, v25
v_add_f32 v8, v8, v87
v_cvt_pk_bf16_f32 v53, v86, v87
v_exp_f32 v82, v26
v_add_f32 v7, v7, v80
v_exp_f32 v83, v27
v_mfma_f32_32x32x16_bf16 v[32:47], a[72:75], a[40:43], v[32:47]
ds_read_b128 a[72:75], v3 offset:1024
v_add_f32 v8, v8, v81
v_cvt_pk_bf16_f32 v50, v80, v81
v_exp_f32 v84, v28
v_add_f32 v7, v7, v82
v_exp_f32 v85, v29
v_mfma_f32_32x32x16_bf16 v[32:47], a[76:79], a[44:47], v[32:47]
ds_read_b128 a[76:79], v3 offset:1536
v_add_f32 v8, v8, v83
v_cvt_pk_bf16_f32 v51, v82, v83
v_exp_f32 v86, v30
v_add_f32 v7, v7, v84
v_exp_f32 v87, v31
v_add_f32 v8, v8, v85
s_waitcnt lgkmcnt(4)
v_mfma_f32_32x32x16_bf16 v[32:47], a[80:83], a[48:51], v[32:47]
ds_read_b128 a[80:83], v3 offset:2048
v_cvt_pk_bf16_f32 v54, v84, v85
v_add_f32 v7, v7, v86
v_add_f32 v8, v8, v87
v_cvt_pk_bf16_f32 v55, v86, v87
v_add_f32 v7, v7, v8
v_sub_f32 v64, 0, v88
v_mfma_f32_32x32x16_bf16 v[32:47], a[84:87], a[52:55], v[32:47]
ds_read_b128 a[84:87], v3 offset:2560
v_sub_f32 v65, 0, v88
v_sub_f32 v66, 0, v88
v_sub_f32 v67, 0, v88
v_sub_f32 v68, 0, v88
v_sub_f32 v69, 0, v88
v_sub_f32 v70, 0, v88
v_mfma_f32_32x32x16_bf16 v[32:47], a[88:91], a[56:59], v[32:47]
ds_read_b128 a[88:91], v3 offset:3072
v_sub_f32 v71, 0, v88
v_sub_f32 v72, 0, v88
v_sub_f32 v73, 0, v88
v_sub_f32 v74, 0, v88
v_sub_f32 v75, 0, v88
v_sub_f32 v76, 0, v88
v_mfma_f32_32x32x16_bf16 v[32:47], a[92:95], a[60:63], v[32:47]
ds_read_b128 a[92:95], v3 offset:3584
v_sub_f32 v77, 0, v88
v_sub_f32 v78, 0, v88
v_sub_f32 v79, 0, v88
v_mov_b32 v5, v88
v_mov_b32 v6, v7
s_nop 11
v_sub_f32 v32, v32, v88
v_sub_f32 v33, v33, v88
v_sub_f32 v34, v34, v88
v_sub_f32 v35, v35, v88
v_sub_f32 v36, v36, v88
v_sub_f32 v37, v37, v88
v_sub_f32 v38, v38, v88
v_sub_f32 v39, v39, v88
v_sub_f32 v40, v40, v88
v_sub_f32 v41, v41, v88
v_sub_f32 v42, v42, v88
v_sub_f32 v43, v43, v88
v_sub_f32 v44, v44, v88
v_sub_f32 v45, v45, v88
v_sub_f32 v46, v46, v88
v_sub_f32 v47, v47, v88
s_cmp_eq_u32 s49, 0xffff
s_cbranch_scc1 fused_kernel_nohst_47
s_add_u32 s40, s46, 0
buffer_store_dwordx4 a[144:147], v12, s[4:7], s40 offen sc1
s_add_u32 s40, s46, 1024
buffer_store_dwordx4 a[148:151], v12, s[4:7], s40 offen sc1
s_add_u32 s40, s46, 188416
buffer_store_dwordx4 a[152:155], v12, s[4:7], s40 offen sc1
s_add_u32 s40, s46, 189440
buffer_store_dwordx4 a[156:159], v12, s[4:7], s40 offen sc1
s_add_u32 s40, s46, 376832
buffer_store_dwordx4 a[160:163], v12, s[4:7], s40 offen sc1
s_add_u32 s40, s46, 377856
buffer_store_dwordx4 a[164:167], v12, s[4:7], s40 offen sc1
s_add_u32 s40, s46, 565248
buffer_store_dwordx4 a[168:171], v12, s[4:7], s40 offen sc1
s_add_u32 s40, s46, 566272
buffer_store_dwordx4 a[172:175], v12, s[4:7], s40 offen sc1
s_add_u32 s40, s46, 753664
buffer_store_dwordx4 a[176:179], v12, s[4:7], s40 offen sc1
s_add_u32 s40, s46, 754688
buffer_store_dwordx4 a[180:183], v12, s[4:7], s40 offen sc1
s_add_u32 s40, s46, 942080
buffer_store_dwordx4 a[184:187], v12, s[4:7], s40 offen sc1
s_add_u32 s40, s46, 943104
buffer_store_dwordx4 a[188:191], v12, s[4:7], s40 offen sc1
s_add_u32 s40, s46, 1130496
buffer_store_dwordx4 a[192:195], v12, s[4:7], s40 offen sc1
s_add_u32 s40, s46, 1131520
buffer_store_dwordx4 a[196:199], v12, s[4:7], s40 offen sc1
s_add_u32 s40, s46, 1318912
buffer_store_dwordx4 a[200:203], v12, s[4:7], s40 offen sc1
s_add_u32 s40, s46, 1319936
buffer_store_dwordx4 a[204:207], v12, s[4:7], s40 offen sc1
fused_kernel_nohst_47:
s_branch fused_kernel_zdone
fused_kernel_dstart2:
s_waitcnt vmcnt(24)
s_barrier
s_mov_b32 s18, s33
s_mov_b32 s19, s33
v_add_u32 v3, s18, v2
ds_read_b128 a[64:67], v3 offset:0
ds_read_b128 a[68:71], v3 offset:512
ds_read_b128 a[72:75], v3 offset:1024
ds_read_b128 a[76:79], v3 offset:1536
ds_read_b128 a[80:83], v3 offset:2048
ds_read_b128 a[84:87], v3 offset:2560
ds_read_b128 a[88:91], v3 offset:3072
ds_read_b128 a[92:95], v3 offset:3584
s_waitcnt lgkmcnt(4)
v_mfma_f32_32x32x16_bf16 v[16:31], a[64:67], a[0:3], 0
ds_read_b128 a[64:67], v3 offset:4096
v_mfma_f32_32x32x16_bf16 v[16:31], a[68:71], a[4:7], v[16:31]
ds_read_b128 a[68:71], v3 offset:4608
s_add_u32 s40, s44, 0
buffer_store_dwordx4 a[144:147], v12, s[4:7], s40 offen sc1
s_add_u32 s40, s44, 1024
buffer_store_dwordx4 a[148:151], v12, s[4:7], s40 offen sc1
s_add_u32 s40, s44, 4096
buffer_store_dwordx4 a[152:155], v12, s[4:7], s40 offen sc1
v_mfma_f32_32x32x16_bf16 v[16:31], a[72:75], a[8:11], v[16:31]
ds_read_b128 a[72:75], v3 offset:5120
s_add_u32 s40, s44, 5120
buffer_store_dwordx4 a[156:159], v12, s[4:7], s40 offen sc1
s_add_u32 s40, s44, 8192
buffer_store_dwordx4 a[160:163], v12, s[4:7], s40 offen sc1
s_add_u32 s40, s44, 9216
v_mfma_f32_32x32x16_bf16 v[16:31], a[76:79], a[12:15], v[16:31]
ds_read_b128 a[76:79], v3 offset:5632
buffer_store_dwordx4 a[164:167], v12, s[4:7], s40 offen sc1
s_add_u32 s40, s44, 12288
buffer_store_dwordx4 a[168:171], v12, s[4:7], s40 offen sc1
s_add_u32 s40, s44, 13312
buffer_store_dwordx4 a[172:175], v12, s[4:7], s40 offen sc1
s_add_u32 s40, s44, 16384
s_waitcnt lgkmcnt(4)
v_mfma_f32_32x32x16_bf16 v[16:31], a[80:83], a[16:19], v[16:31]
ds_read_b128 a[80:83], v3 offset:6144
buffer_store_dwordx4 a[176:179], v12, s[4:7], s40 offen sc1
s_add_u32 s40, s44, 17408
buffer_store_dwordx4 a[180:183], v12, s[4:7], s40 offen sc1
s_add_u32 s40, s44, 20480
buffer_store_dwordx4 a[184:187], v12, s[4:7], s40 offen sc1
v_mfma_f32_32x32x16_bf16 v[16:31], a[84:87], a[20:23], v[16:31]
ds_read_b128 a[84:87], v3 offset:6656
s_add_u32 s40, s44, 21504
buffer_store_dwordx4 a[188:191], v12, s[4:7], s40 offen sc1
s_add_u32 s40, s44, 24576
buffer_store_dwordx4 a[192:195], v12, s[4:7], s40 offen sc1
s_add_u32 s40, s44, 25600
buffer_store_dwordx4 a[196:199], v12, s[4:7], s40 offen sc1
v_mfma_f32_32x32x16_bf16 v[16:31], a[88:91], a[24:27], v[16:31]
ds_read_b128 a[88:91], v3 offset:7168
s_add_u32 s19, s18, 32768
s_cmp_ge_u32 s19, s20
s_cselect_b32 s31, 163840, 0
s_sub_u32 s19, s19, s31
v_add_u32 v4, s19, v2
v_mfma_f32_32x32x16_bf16 v[16:31], a[92:95], a[28:31], v[16:31]
ds_read_b128 a[92:95], v3 offset:7680
s_waitcnt vmcnt(63) lgkmcnt(0)
s_barrier
s_waitcnt lgkmcnt(4)
v_mfma_f32_32x32x16_bf16 v[16:31], a[64:67], a[32:35], v[16:31]
ds_read_b128 a[64:67], v4 offset:0
v_mfma_f32_32x32x16_bf16 v[16:31], a[68:71], a[36:39], v[16:31]
ds_read_b128 a[68:71], v4 offset:512
v_mfma_f32_32x32x16_bf16 v[16:31], a[72:75], a[40:43], v[16:31]
ds_read_b128 a[72:75], v4 offset:1024
v_mfma_f32_32x32x16_bf16 v[16:31], a[76:79], a[44:47], v[16:31]
ds_read_b128 a[76:79], v4 offset:1536
s_waitcnt lgkmcnt(4)
v_mfma_f32_32x32x16_bf16 v[16:31], a[80:83], a[48:51], v[16:31]
ds_read_b128 a[80:83], v4 offset:2048
v_mfma_f32_32x32x16_bf16 v[16:31], a[84:87], a[52:55], v[16:31]
ds_read_b128 a[84:87], v4 offset:2560
v_mfma_f32_32x32x16_bf16 v[16:31], a[88:91], a[56:59], v[16:31]
ds_read_b128 a[88:91], v4 offset:3072
v_mfma_f32_32x32x16_bf16 v[16:31], a[92:95], a[60:63], v[16:31]
ds_read_b128 a[92:95], v4 offset:3584
s_cmp_eq_u32 s48, 1
s_cbranch_scc0 fused_kernel_nom1_48
s_add_u32 s40, s44, 28672
buffer_store_dwordx4 a[200:203], v12, s[4:7], s40 offen sc1
s_add_u32 s40, s44, 29696
buffer_store_dwordx4 a[204:207], v12, s[4:7], s40 offen sc1
s_add_u32 s40, s44, 32768
buffer_store_dwordx4 a[208:211], v12, s[4:7], s40 offen sc1
s_add_u32 s40, s44, 33792
buffer_store_dwordx4 a[212:215], v12, s[4:7], s40 offen sc1
s_add_u32 s40, s44, 36864
buffer_store_dwordx4 a[216:219], v12, s[4:7], s40 offen sc1
s_add_u32 s40, s44, 37888
buffer_store_dwordx4 a[220:223], v12, s[4:7], s40 offen sc1
s_add_u32 s40, s44, 40960
buffer_store_dwordx4 a[224:227], v12, s[4:7], s40 offen sc1
s_add_u32 s40, s44, 41984
buffer_store_dwordx4 a[228:231], v12, s[4:7], s40 offen sc1
s_add_u32 s40, s44, 45056
buffer_store_dwordx4 a[232:235], v12, s[4:7], s40 offen sc1
s_add_u32 s40, s44, 46080
buffer_store_dwordx4 a[236:239], v12, s[4:7], s40 offen sc1
s_add_u32 s40, s44, 49152
buffer_store_dwordx4 a[240:243], v12, s[4:7], s40 offen sc1
s_add_u32 s40, s44, 50176
buffer_store_dwordx4 a[244:247], v12, s[4:7], s40 offen sc1
s_add_u32 s40, s44, 53248
buffer_store_dwordx4 a[248:251], v12, s[4:7], s40 offen sc1
s_add_u32 s40, s44, 54272
buffer_store_dwordx4 a[252:255], v12, s[4:7], s40 offen sc1
s_waitcnt vmcnt(0)
s_barrier
s_add_u32 s62, s8, 32
s_cmp_lg_u32 s3, 0
s_cbranch_scc1 fused_kernel_kvhi0_49
s_lshl_b32 s68, s62, 7
s_add_u32 s68, s68, 0x5b00000
v_mov_b32 v88, 1
v_mov_b32 v89, 0
s_mov_b64 s[70:71], exec
s_mov_b64 exec, 1
buffer_atomic_add v88, v89, s[4:7], s68 offen
s_mov_b64 exec, s[70:71]
fused_kernel_kvhi0_49:
s_call_b64 s[26:27], fused_kernel_hiwait_now
s_add_u32 m0, s33, 131072
s_nop 0
buffer_load_dwordx4 v12, s[4:7], s12 offen offset:0 lds
buffer_load_dwordx4 v12, s[4:7], s12 offen offset:1024 lds
buffer_load_dwordx4 v12, s[4:7], s12 offen offset:2048 lds
buffer_load_dwordx4 v12, s[4:7], s12 offen offset:3072 lds
s_add_u32 s12, s12, 16384
s_cmp_eq_u32 s12, s14
s_cselect_b32 s12, s16, s12
fused_kernel_nom1_48:
s_waitcnt lgkmcnt(4)
v_mfma_f32_32x32x16_bf16 v[32:47], a[64:67], a[0:3], 0
ds_read_b128 a[64:67], v4 offset:4096
s_cmp_lt_u32 s23, s24
s_cbranch_scc0 fused_kernel_mstub_50
fused_kernel_mback_51:
v_mfma_f32_32x32x16_bf16 v[32:47], a[68:71], a[4:7], v[32:47]
ds_read_b128 a[68:71], v4 offset:4608
s_add_u32 s40, s44, 28672
buffer_store_dwordx4 a[200:203], v12, s[4:7], s40 offen sc1
s_add_u32 s40, s44, 29696
buffer_store_dwordx4 a[204:207], v12, s[4:7], s40 offen sc1
s_add_u32 s40, s44, 32768
buffer_store_dwordx4 a[208:211], v12, s[4:7], s40 offen sc1
s_add_u32 s40, s44, 33792
buffer_store_dwordx4 a[212:215], v12, s[4:7], s40 offen sc1
s_add_u32 s40, s44, 36864
s_nop 3
v_max3_f32 v88, v16, v17, v18
v_max3_f32 v88, v88, v19, v20
v_max3_f32 v88, v88, v21, v22
v_max3_f32 v88, v88, v23, v24
v_max3_f32 v88, v88, v25, v26
v_mfma_f32_32x32x16_bf16 v[32:47], a[72:75], a[8:11], v[32:47]
ds_read_b128 a[72:75], v4 offset:5120
buffer_store_dwordx4 a[216:219], v12, s[4:7], s40 offen sc1
s_add_u32 s40, s44, 37888
buffer_store_dwordx4 a[220:223], v12, s[4:7], s40 offen sc1
s_add_u32 s40, s44, 40960
buffer_store_dwordx4 a[224:227], v12, s[4:7], s40 offen sc1
s_add_u32 s40, s44, 41984
buffer_store_dwordx4 a[228:231], v12, s[4:7], s40 offen sc1
s_add_u32 s40, s44, 45056
v_max3_f32 v88, v88, v27, v28
v_max3_f32 v88, v88, v29, v30
v_max_f32 v88, v88, v31
v_mov_b32 v89, v88
s_nop 1
v_permlane32_swap_b32 v88, v89
v_mfma_f32_32x32x16_bf16 v[32:47], a[76:79], a[12:15], v[32:47]
ds_read_b128 a[76:79], v4 offset:5632
buffer_store_dwordx4 a[232:235], v12, s[4:7], s40 offen sc1
s_add_u32 s40, s44, 46080
buffer_store_dwordx4 a[236:239], v12, s[4:7], s40 offen sc1
s_add_u32 s40, s44, 49152
buffer_store_dwordx4 a[240:243], v12, s[4:7], s40 offen sc1
s_add_u32 s40, s44, 50176
buffer_store_dwordx4 a[244:247], v12, s[4:7], s40 offen sc1
s_add_u32 s40, s44, 53248
s_nop 1
v_max_f32 v88, v88, v89
v_sub_f32 v16, v16, v88
v_sub_f32 v17, v17, v88
v_sub_f32 v18, v18, v88
v_sub_f32 v19, v19, v88
s_waitcnt lgkmcnt(4)
v_mfma_f32_32x32x16_bf16 v[32:47], a[80:83], a[16:19], v[32:47]
ds_read_b128 a[80:83], v4 offset:6144
buffer_store_dwordx4 a[248:251], v12, s[4:7], s40 offen sc1
s_add_u32 s40, s44, 54272
buffer_store_dwordx4 a[252:255], v12, s[4:7], s40 offen sc1
s_mov_b32 m0, s18
s_nop 0
buffer_load_dwordx4 v12, s[4:7], s12 offen offset:0 lds
buffer_load_dwordx4 v12, s[4:7], s12 offen offset:1024 lds
buffer_load_dwordx4 v12, s[4:7], s12 offen offset:2048 lds
buffer_load_dwordx4 v12, s[4:7], s12 offen offset:3072 lds
v_sub_f32 v20, v20, v88
v_sub_f32 v21, v21, v88
v_sub_f32 v22, v22, v88
v_sub_f32 v23, v23, v88
v_sub_f32 v24, v24, v88
v_sub_f32 v25, v25, v88
v_mfma_f32_32x32x16_bf16 v[32:47], a[84:87], a[20:23], v[32:47]
ds_read_b128 a[84:87], v4 offset:6656
s_add_u32 m0, s18, 16384
s_add_u32 s18, s19, 32768
s_cmp_ge_u32 s18, s20
s_cselect_b32 s31, 163840, 0
s_sub_u32 s18, s18, s31
v_add_u32 v3, s18, v2
s_add_u32 s12, s12, 16384
buffer_load_dwordx4 v12, s[4:7], s13 offen offset:0 lds
v_sub_f32 v26, v26, v88
v_sub_f32 v27, v27, v88
v_sub_f32 v28, v28, v88
v_sub_f32 v29, v29, v88
v_sub_f32 v30, v30, v88
v_mfma_f32_32x32x16_bf16 v[32:47], a[88:91], a[24:27], v[32:47]
ds_read_b128 a[88:91], v4 offset:7168
buffer_load_dwordx4 v12, s[4:7], s13 offen offset:1024 lds
buffer_load_dwordx4 v12, s[4:7], s13 offen offset:2048 lds
buffer_load_dwordx4 v12, s[4:7], s13 offen offset:3072 lds
s_cmp_eq_u32 s12, s14
s_cselect_b32 s12, s16, s12
s_add_u32 s13, s13, 16384
s_cmp_eq_u32 s13, s15
s_cselect_b32 s13, s17, s13
v_sub_f32 v31, v31, v88
v_exp_f32 v80, v16
v_exp_f32 v81, v17
v_exp_f32 v82, v18
v_exp_f32 v83, v19
v_cvt_pk_bf16_f32 v48, v80, v81
v_mfma_f32_32x32x16_bf16 v[32:47], a[92:95], a[28:31], v[32:47]
ds_read_b128 a[92:95], v4 offset:7680
v_exp_f32 v84, v20
v_add_f32 v7, v80, v82
v_exp_f32 v85, v21
v_add_f32 v8, v81, v83
v_cvt_pk_bf16_f32 v49, v82, v83
v_exp_f32 v86, v22
s_waitcnt vmcnt(48) lgkmcnt(0)
s_barrier
s_waitcnt lgkmcnt(4)
v_mfma_f32_32x32x16_bf16 v[32:47], a[64:67], a[32:35], v[32:47]
ds_read_b128 a[64:67], v3 offset:0
v_add_f32 v7, v7, v84
v_exp_f32 v87, v23
v_add_f32 v8, v8, v85
v_cvt_pk_bf16_f32 v52, v84, v85
v_exp_f32 v80, v24
v_add_f32 v7, v7, v86
v_mfma_f32_32x32x16_bf16 v[32:47], a[68:71], a[36:39], v[32:47]
ds_read_b128 a[68:71], v3 offset:512
s_add_u32 s23, s23, 1
v_exp_f32 v81, v25
v_add_f32 v8, v8, v87
v_cvt_pk_bf16_f32 v53, v86, v87
v_exp_f32 v82, v26
v_add_f32 v7, v7, v80
v_exp_f32 v83, v27
v_mfma_f32_32x32x16_bf16 v[32:47], a[72:75], a[40:43], v[32:47]
ds_read_b128 a[72:75], v3 offset:1024
v_add_f32 v8, v8, v81
v_cvt_pk_bf16_f32 v50, v80, v81
v_exp_f32 v84, v28
v_add_f32 v7, v7, v82
v_exp_f32 v85, v29
v_mfma_f32_32x32x16_bf16 v[32:47], a[76:79], a[44:47], v[32:47]
ds_read_b128 a[76:79], v3 offset:1536
v_add_f32 v8, v8, v83
v_cvt_pk_bf16_f32 v51, v82, v83
v_exp_f32 v86, v30
v_add_f32 v7, v7, v84
v_exp_f32 v87, v31
v_add_f32 v8, v8, v85
s_waitcnt lgkmcnt(4)
v_mfma_f32_32x32x16_bf16 v[32:47], a[80:83], a[48:51], v[32:47]
ds_read_b128 a[80:83], v3 offset:2048
v_cvt_pk_bf16_f32 v54, v84, v85
v_add_f32 v7, v7, v86
v_add_f32 v8, v8, v87
v_cvt_pk_bf16_f32 v55, v86, v87
v_add_f32 v7, v7, v8
v_sub_f32 v64, 0, v88
v_mfma_f32_32x32x16_bf16 v[32:47], a[84:87], a[52:55], v[32:47]
ds_read_b128 a[84:87], v3 offset:2560
v_sub_f32 v65, 0, v88
v_sub_f32 v66, 0, v88
v_sub_f32 v67, 0, v88
v_sub_f32 v68, 0, v88
v_sub_f32 v69, 0, v88
v_sub_f32 v70, 0, v88
v_mfma_f32_32x32x16_bf16 v[32:47], a[88:91], a[56:59], v[32:47]
ds_read_b128 a[88:91], v3 offset:3072
v_sub_f32 v71, 0, v88
v_sub_f32 v72, 0, v88
v_sub_f32 v73, 0, v88
v_sub_f32 v74, 0, v88
v_sub_f32 v75, 0, v88
v_sub_f32 v76, 0, v88
v_mfma_f32_32x32x16_bf16 v[32:47], a[92:95], a[60:63], v[32:47]
ds_read_b128 a[92:95], v3 offset:3584
v_sub_f32 v77, 0, v88
v_sub_f32 v78, 0, v88
v_sub_f32 v79, 0, v88
v_mov_b32 v5, v88
v_mov_b32 v6, v7
s_nop 11
v_sub_f32 v32, v32, v88
v_sub_f32 v33, v33, v88
v_sub_f32 v34, v34, v88
v_sub_f32 v35, v35, v88
v_sub_f32 v36, v36, v88
v_sub_f32 v37, v37, v88
v_sub_f32 v38, v38, v88
v_sub_f32 v39, v39, v88
v_sub_f32 v40, v40, v88
v_sub_f32 v41, v41, v88
v_sub_f32 v42, v42, v88
v_sub_f32 v43, v43, v88
v_sub_f32 v44, v44, v88
v_sub_f32 v45, v45, v88
v_sub_f32 v46, v46, v88
v_sub_f32 v47, v47, v88
s_cmp_eq_u32 s48, 2
s_cbranch_scc0 fused_kernel_nokvf_52
s_waitcnt vmcnt(8)
s_barrier
s_add_u32 s62, s8, 32
s_cmp_lg_u32 s3, 0
s_cbranch_scc1 fused_kernel_kvhi_53
s_lshl_b32 s68, s62, 7
s_add_u32 s68, s68, 0x5b00000
v_mov_b32 v88, 1
v_mov_b32 v89, 0
s_mov_b64 s[70:71], exec
s_mov_b64 exec, 1
buffer_atomic_add v88, v89, s[4:7], s68 offen
s_mov_b64 exec, s[70:71]
fused_kernel_kvhi_53:
fused_kernel_nokvf_52:
s_branch fused_kernel_zdone
fused_kernel_seg:
s_waitcnt lgkmcnt(4)
v_mfma_f32_32x32x16_bf16 v[16:31], a[64:67], a[0:3], 0
ds_read_b128 a[64:67], v3 offset:4096
v_mfma_f32_32x32x16_bf16 v[16:31], a[68:71], a[4:7], v[16:31]
ds_read_b128 a[68:71], v3 offset:4608
s_add_u32 s19, s18, 32768
v_mfma_f32_32x32x16_bf16 v[16:31], a[72:75], a[8:11], v[16:31]
ds_read_b128 a[72:75], v3 offset:5120
s_cmp_ge_u32 s19, s20
v_mfma_f32_32x32x16_bf16 v[16:31], a[76:79], a[12:15], v[16:31]
ds_read_b128 a[76:79], v3 offset:5632
s_cselect_b32 s31, 163840, 0
s_waitcnt lgkmcnt(4)
v_mfma_f32_32x32x16_bf16 v[16:31], a[80:83], a[16:19], v[16:31]
ds_read_b128 a[80:83], v3 offset:6144
s_sub_u32 s19, s19, s31
v_mfma_f32_32x32x16_bf16 v[16:31], a[84:87], a[20:23], v[16:31]
ds_read_b128 a[84:87], v3 offset:6656
v_add_u32 v4, s19, v2
v_mfma_f32_32x32x16_bf16 v[16:31], a[88:91], a[24:27], v[16:31]
ds_read_b128 a[88:91], v3 offset:7168
v_mfma_f32_32x32x16_bf16 v[16:31], a[92:95], a[28:31], v[16:31]
ds_read_b128 a[92:95], v3 offset:7680
s_waitcnt vmcnt(63) lgkmcnt(0)
s_barrier
s_waitcnt lgkmcnt(4)
v_mfma_f32_32x32x16_bf16 v[16:31], a[64:67], a[32:35], v[16:31]
ds_read_b128 a[64:67], v4 offset:0
v_mfma_f32_32x32x16_bf16 v[16:31], a[68:71], a[36:39], v[16:31]
ds_read_b128 a[68:71], v4 offset:512
v_mfma_f32_32x32x16_bf16 v[16:31], a[72:75], a[40:43], v[16:31]
ds_read_b128 a[72:75], v4 offset:1024
v_mfma_f32_32x32x16_bf16 v[16:31], a[76:79], a[44:47], v[16:31]
ds_read_b128 a[76:79], v4 offset:1536
s_waitcnt lgkmcnt(4)
v_mfma_f32_32x32x16_bf16 v[16:31], a[80:83], a[48:51], v[16:31]
ds_read_b128 a[80:83], v4 offset:2048
v_mfma_f32_32x32x16_bf16 v[16:31], a[84:87], a[52:55], v[16:31]
ds_read_b128 a[84:87], v4 offset:2560
v_mfma_f32_32x32x16_bf16 v[16:31], a[88:91], a[56:59], v[16:31]
ds_read_b128 a[88:91], v4 offset:3072
v_mfma_f32_32x32x16_bf16 v[16:31], a[92:95], a[60:63], v[16:31]
ds_read_b128 a[92:95], v4 offset:3584
s_waitcnt lgkmcnt(4)
v_mfma_f32_32x32x16_bf16 v[32:47], a[64:67], a[0:3], 0
ds_read_b128 a[64:67], v4 offset:4096
s_cmp_lt_u32 s23, s24
s_cbranch_scc0 fused_kernel_mstub_54
fused_kernel_mback_55:
v_mfma_f32_32x32x16_bf16 v[32:47], a[68:71], a[4:7], v[32:47]
ds_read_b128 a[68:71], v4 offset:4608
s_mov_b32 m0, s18
s_nop 0
buffer_load_dwordx4 v12, s[4:7], s12 offen offset:0 lds
buffer_load_dwordx4 v12, s[4:7], s12 offen offset:1024 lds
buffer_load_dwordx4 v12, s[4:7], s12 offen offset:2048 lds
s_nop 3
v_max3_f32 v88, v16, v17, v18
v_max3_f32 v88, v88, v19, v20
v_max3_f32 v88, v88, v21, v22
v_max3_f32 v88, v88, v23, v24
v_max3_f32 v88, v88, v25, v26
v_mfma_f32_32x32x16_bf16 v[32:47], a[72:75], a[8:11], v[32:47]
ds_read_b128 a[72:75], v4 offset:5120
buffer_load_dwordx4 v12, s[4:7], s12 offen offset:3072 lds
s_add_u32 m0, s18, 16384
s_add_u32 s18, s19, 32768
v_max3_f32 v88, v88, v27, v28
v_max3_f32 v88, v88, v29, v30
v_max_f32 v88, v88, v31
v_mov_b32 v89, v88
s_nop 1
v_permlane32_swap_b32 v88, v89
v_mfma_f32_32x32x16_bf16 v[32:47], a[76:79], a[12:15], v[32:47]
ds_read_b128 a[76:79], v4 offset:5632
s_cmp_ge_u32 s18, s20
s_cselect_b32 s31, 163840, 0
s_sub_u32 s18, s18, s31
v_add_u32 v3, s18, v2
s_nop 1
v_max_f32 v88, v88, v89
v_sub_f32 v16, v16, v88
v_sub_f32 v17, v17, v88
v_sub_f32 v18, v18, v88
v_sub_f32 v19, v19, v88
s_waitcnt lgkmcnt(4)
v_mfma_f32_32x32x16_bf16 v[32:47], a[80:83], a[16:19], v[32:47]
ds_read_b128 a[80:83], v4 offset:6144
s_add_u32 s12, s12, 16384
buffer_load_dwordx4 v12, s[4:7], s13 offen offset:0 lds
buffer_load_dwordx4 v12, s[4:7], s13 offen offset:1024 lds
v_sub_f32 v20, v20, v88
v_sub_f32 v21, v21, v88
v_sub_f32 v22, v22, v88
v_sub_f32 v23, v23, v88
v_sub_f32 v24, v24, v88
v_sub_f32 v25, v25, v88
v_mfma_f32_32x32x16_bf16 v[32:47], a[84:87], a[20:23], v[32:47]
ds_read_b128 a[84:87], v4 offset:6656
buffer_load_dwordx4 v12, s[4:7], s13 offen offset:2048 lds
buffer_load_dwordx4 v12, s[4:7], s13 offen offset:3072 lds
s_cmp_eq_u32 s12, s14
s_cselect_b32 s12, s16, s12
v_sub_f32 v26, v26, v88
v_sub_f32 v27, v27, v88
v_sub_f32 v28, v28, v88
v_sub_f32 v29, v29, v88
v_sub_f32 v30, v30, v88
v_mfma_f32_32x32x16_bf16 v[32:47], a[88:91], a[24:27], v[32:47]
ds_read_b128 a[88:91], v4 offset:7168
s_add_u32 s13, s13, 16384
s_cmp_eq_u32 s13, s15
s_cselect_b32 s13, s17, s13
v_sub_f32 v31, v31, v88
v_exp_f32 v80, v16
v_exp_f32 v81, v17
v_exp_f32 v82, v18
v_exp_f32 v83, v19
v_cvt_pk_bf16_f32 v48, v80, v81
v_mfma_f32_32x32x16_bf16 v[32:47], a[92:95], a[28:31], v[32:47]
ds_read_b128 a[92:95], v4 offset:7680
v_exp_f32 v84, v20
v_add_f32 v7, v80, v82
v_exp_f32 v85, v21
v_add_f32 v8, v81, v83
v_cvt_pk_bf16_f32 v49, v82, v83
v_exp_f32 v86, v22
s_waitcnt vmcnt(16) lgkmcnt(0)
s_barrier
s_waitcnt lgkmcnt(4)
v_mfma_f32_32x32x16_bf16 v[32:47], a[64:67], a[32:35], v[32:47]
ds_read_b128 a[64:67], v3 offset:0
v_add_f32 v7, v7, v84
v_exp_f32 v87, v23
v_add_f32 v8, v8, v85
v_cvt_pk_bf16_f32 v52, v84, v85
v_exp_f32 v80, v24
v_add_f32 v7, v7, v86
v_mfma_f32_32x32x16_bf16 v[32:47], a[68:71], a[36:39], v[32:47]
ds_read_b128 a[68:71], v3 offset:512
s_add_u32 s23, s23, 1
v_exp_f32 v81, v25
v_add_f32 v8, v8, v87
v_cvt_pk_bf16_f32 v53, v86, v87
v_exp_f32 v82, v26
v_add_f32 v7, v7, v80
v_exp_f32 v83, v27
v_mfma_f32_32x32x16_bf16 v[32:47], a[72:75], a[40:43], v[32:47]
ds_read_b128 a[72:75], v3 offset:1024
v_add_f32 v8, v8, v81
v_cvt_pk_bf16_f32 v50, v80, v81
v_exp_f32 v84, v28
v_add_f32 v7, v7, v82
v_exp_f32 v85, v29
v_mfma_f32_32x32x16_bf16 v[32:47], a[76:79], a[44:47], v[32:47]
ds_read_b128 a[76:79], v3 offset:1536
v_add_f32 v8, v8, v83
v_cvt_pk_bf16_f32 v51, v82, v83
v_exp_f32 v86, v30
v_add_f32 v7, v7, v84
v_exp_f32 v87, v31
v_add_f32 v8, v8, v85
s_waitcnt lgkmcnt(4)
v_mfma_f32_32x32x16_bf16 v[32:47], a[80:83], a[48:51], v[32:47]
ds_read_b128 a[80:83], v3 offset:2048
v_cvt_pk_bf16_f32 v54, v84, v85
v_add_f32 v7, v7, v86
v_add_f32 v8, v8, v87
v_cvt_pk_bf16_f32 v55, v86, v87
v_add_f32 v7, v7, v8
v_sub_f32 v64, 0, v88
v_mfma_f32_32x32x16_bf16 v[32:47], a[84:87], a[52:55], v[32:47]
ds_read_b128 a[84:87], v3 offset:2560
v_sub_f32 v65, 0, v88
v_sub_f32 v66, 0, v88
v_sub_f32 v67, 0, v88
v_sub_f32 v68, 0, v88
v_sub_f32 v69, 0, v88
v_sub_f32 v70, 0, v88
v_mfma_f32_32x32x16_bf16 v[32:47], a[88:91], a[56:59], v[32:47]
ds_read_b128 a[88:91], v3 offset:3072
v_sub_f32 v71, 0, v88
v_sub_f32 v72, 0, v88
v_sub_f32 v73, 0, v88
v_sub_f32 v74, 0, v88
v_sub_f32 v75, 0, v88
v_sub_f32 v76, 0, v88
v_mfma_f32_32x32x16_bf16 v[32:47], a[92:95], a[60:63], v[32:47]
ds_read_b128 a[92:95], v3 offset:3584
v_sub_f32 v77, 0, v88
v_sub_f32 v78, 0, v88
v_sub_f32 v79, 0, v88
v_mov_b32 v5, v88
v_mov_b32 v6, v7
s_nop 11
v_sub_f32 v32, v32, v88
v_sub_f32 v33, v33, v88
v_sub_f32 v34, v34, v88
v_sub_f32 v35, v35, v88
v_sub_f32 v36, v36, v88
v_sub_f32 v37, v37, v88
v_sub_f32 v38, v38, v88
v_sub_f32 v39, v39, v88
v_sub_f32 v40, v40, v88
v_sub_f32 v41, v41, v88
v_sub_f32 v42, v42, v88
v_sub_f32 v43, v43, v88
v_sub_f32 v44, v44, v88
v_sub_f32 v45, v45, v88
v_sub_f32 v46, v46, v88
v_sub_f32 v47, v47, v88
fused_kernel_zdone:
s_cmp_eq_u32 s21, 0
s_cbranch_scc1 fused_kernel_tail
.p2align 6
fused_kernel_loop:
s_waitcnt lgkmcnt(4)
v_mfma_f32_32x32x16_bf16 v[16:31], a[64:67], a[0:3], v[64:79]
ds_read_b128 a[64:67], v3 offset:4096
s_cmp_lt_u32 s23, s24
s_cbranch_scc0 fused_kernel_mstub_56
fused_kernel_mback_57:
s_cmp_eq_u32 s23, s39
s_cbranch_scc1 fused_kernel_hstub_58
fused_kernel_hback_59:
v_mfma_f32_32x32x16_bf16 v[16:31], a[68:71], a[4:7], v[16:31]
ds_read_b128 a[68:71], v3 offset:4608
s_mov_b32 m0, s19
s_add_u32 s30, s19, 16384
v_exp_f32 v80, v32
v_exp_f32 v81, v33
v_mfma_f32_32x32x16_bf16 v[16:31], a[72:75], a[8:11], v[16:31]
ds_read_b128 a[72:75], v3 offset:5120
s_add_u32 s19, s18, 32768
v_exp_f32 v82, v34
v_mfma_f32_32x32x16_bf16 v[16:31], a[76:79], a[12:15], v[16:31]
ds_read_b128 a[76:79], v3 offset:5632
s_cmp_ge_u32 s19, s20
s_cselect_b32 s31, 163840, 0
v_exp_f32 v83, v35
v_cvt_pk_bf16_f32 v56, v80, v81
s_waitcnt lgkmcnt(4)
v_mfma_f32_32x32x16_bf16 v[16:31], a[80:83], a[16:19], v[16:31]
ds_read_b128 a[80:83], v3 offset:6144
s_sub_u32 s19, s19, s31
v_exp_f32 v84, v36
v_mfma_f32_32x32x16_bf16 v[16:31], a[84:87], a[20:23], v[16:31]
ds_read_b128 a[84:87], v3 offset:6656
v_add_u32 v4, s19, v2
buffer_load_dwordx4 v12, s[4:7], s12 offen offset:0 lds
v_add_f32 v7, v80, v82
v_mfma_f32_32x32x16_bf16 v[16:31], a[88:91], a[24:27], v[16:31]
ds_read_b128 a[88:91], v3 offset:7168
v_exp_f32 v85, v37
v_add_f32 v8, v81, v83
v_mfma_f32_32x32x16_bf16 v[16:31], a[92:95], a[28:31], v[16:31]
ds_read_b128 a[92:95], v3 offset:7680
buffer_load_dwordx4 v12, s[4:7], s12 offen offset:1024 lds
v_cvt_pk_bf16_f32 v57, v82, v83
s_waitcnt lgkmcnt(4)
v_mfma_f32_32x32x16_bf16 v[16:31], a[64:67], a[32:35], v[16:31]
ds_read_b128 a[64:67], v4 offset:16384
v_exp_f32 v86, v38
v_mfma_f32_32x32x16_bf16 v[16:31], a[68:71], a[36:39], v[16:31]
ds_read_b128 a[68:71], v4 offset:17408
buffer_load_dwordx4 v12, s[4:7], s12 offen offset:2048 lds
v_add_f32 v7, v7, v84
v_exp_f32 v87, v39
v_mfma_f32_32x32x16_bf16 v[16:31], a[72:75], a[40:43], v[16:31]
ds_read_b128 a[72:75], v4 offset:18432
v_add_f32 v8, v8, v85
v_mfma_f32_32x32x16_bf16 v[16:31], a[76:79], a[44:47], v[16:31]
ds_read_b128 a[76:79], v4 offset:19456
buffer_load_dwordx4 v12, s[4:7], s12 offen offset:3072 lds
v_cvt_pk_bf16_f32 v60, v84, v85
v_exp_f32 v80, v40
s_waitcnt lgkmcnt(4)
v_mfma_f32_32x32x16_bf16 v[16:31], a[80:83], a[48:51], v[16:31]
ds_read_b128 a[80:83], v4 offset:20480
s_mov_b32 m0, s30
s_add_u32 s12, s12, 16384
v_add_f32 v7, v7, v86
v_mfma_f32_32x32x16_bf16 v[16:31], a[84:87], a[52:55], v[16:31]
ds_read_b128 a[84:87], v4 offset:21504
s_cmp_eq_u32 s12, s14
s_cselect_b32 s12, s16, s12
v_exp_f32 v81, v41
v_mfma_f32_32x32x16_bf16 v[16:31], a[88:91], a[56:59], v[16:31]
ds_read_b128 a[88:91], v4 offset:22528
buffer_load_dwordx4 v12, s[4:7], s13 offen offset:0 lds
v_add_f32 v8, v8, v87
v_cvt_pk_bf16_f32 v61, v86, v87
v_mfma_f32_32x32x16_bf16 v[16:31], a[92:95], a[60:63], v[16:31]
ds_read_b128 a[92:95], v4 offset:23552
v_exp_f32 v82, v42
s_waitcnt lgkmcnt(4)
v_mfma_f32_32x32x16_bf16 v[128:143], a[64:67], v[48:51], v[128:143]
ds_read_b128 a[64:67], v4 offset:16896
buffer_load_dwordx4 v12, s[4:7], s13 offen offset:1024 lds
v_add_f32 v7, v7, v80
v_mfma_f32_32x32x16_bf16 v[144:159], a[68:71], v[48:51], v[144:159]
ds_read_b128 a[68:71], v4 offset:17920
v_exp_f32 v83, v43
v_add_f32 v8, v8, v81
v_mfma_f32_32x32x16_bf16 v[160:175], a[72:75], v[48:51], v[160:175]
ds_read_b128 a[72:75], v4 offset:18944
buffer_load_dwordx4 v12, s[4:7], s13 offen offset:2048 lds
v_cvt_pk_bf16_f32 v58, v80, v81
v_mfma_f32_32x32x16_bf16 v[176:191], a[76:79], v[48:51], v[176:191]
ds_read_b128 a[76:79], v4 offset:19968
v_exp_f32 v84, v44
s_waitcnt lgkmcnt(4)
v_mfma_f32_32x32x16_bf16 v[192:207], a[80:83], v[48:51], v[192:207]
ds_read_b128 a[80:83], v4 offset:20992
buffer_load_dwordx4 v12, s[4:7], s13 offen offset:3072 lds
v_add_f32 v7, v7, v82
v_exp_f32 v85, v45
v_mfma_f32_32x32x16_bf16 v[208:223], a[84:87], v[48:51], v[208:223]
ds_read_b128 a[84:87], v4 offset:22016
s_add_u32 s13, s13, 16384
v_add_f32 v8, v8, v83
v_mfma_f32_32x32x16_bf16 v[224:239], a[88:91], v[48:51], v[224:239]
ds_read_b128 a[88:91], v4 offset:23040
s_cmp_eq_u32 s13, s15
s_cselect_b32 s13, s17, s13
v_cvt_pk_bf16_f32 v59, v82, v83
v_exp_f32 v86, v46
v_mfma_f32_32x32x16_bf16 v[240:255], a[92:95], v[48:51], v[240:255]
ds_read_b128 a[92:95], v4 offset:24064
v_add_f32 v7, v7, v84
s_waitcnt vmcnt(16)
s_barrier
s_waitcnt lgkmcnt(4)
v_mfma_f32_32x32x16_bf16 v[128:143], a[64:67], v[52:55], v[128:143]
ds_read_b128 a[64:67], v4 offset:0
v_exp_f32 v87, v47
v_mfma_f32_32x32x16_bf16 v[144:159], a[68:71], v[52:55], v[144:159]
ds_read_b128 a[68:71], v4 offset:512
v_add_f32 v8, v8, v85
v_cvt_pk_bf16_f32 v62, v84, v85
v_mfma_f32_32x32x16_bf16 v[160:175], a[72:75], v[52:55], v[160:175]
ds_read_b128 a[72:75], v4 offset:1024
s_add_u32 s23, s23, 1
v_add_f32 v7, v7, v86
v_mfma_f32_32x32x16_bf16 v[176:191], a[76:79], v[52:55], v[176:191]
ds_read_b128 a[76:79], v4 offset:1536
v_add_f32 v8, v8, v87
s_waitcnt lgkmcnt(4)
v_mfma_f32_32x32x16_bf16 v[192:207], a[80:83], v[52:55], v[192:207]
ds_read_b128 a[80:83], v4 offset:2048
v_cvt_pk_bf16_f32 v63, v86, v87
v_add_f32 v7, v7, v8
v_mfma_f32_32x32x16_bf16 v[208:223], a[84:87], v[52:55], v[208:223]
ds_read_b128 a[84:87], v4 offset:2560
v_cmp_nle_f32 vcc, v7, v10
v_mfma_f32_32x32x16_bf16 v[224:239], a[88:91], v[52:55], v[224:239]
ds_read_b128 a[88:91], v4 offset:3072
v_add_f32 v14, v6, v7
v_mfma_f32_32x32x16_bf16 v[240:255], a[92:95], v[52:55], v[240:255]
ds_read_b128 a[92:95], v4 offset:3584
s_cbranch_vccnz fused_kernel_fstub_60
fused_kernel_fback_61:
s_waitcnt lgkmcnt(4)
v_mfma_f32_32x32x16_bf16 v[32:47], a[64:67], a[0:3], v[64:79]
ds_read_b128 a[64:67], v4 offset:4096
s_cmp_lt_u32 s23, s24
s_cbranch_scc0 fused_kernel_mstub_62
fused_kernel_mback_63:
v_mfma_f32_32x32x16_bf16 v[32:47], a[68:71], a[4:7], v[32:47]
ds_read_b128 a[68:71], v4 offset:4608
s_mov_b32 m0, s18
s_add_u32 s30, s18, 16384
v_exp_f32 v80, v16
v_exp_f32 v81, v17
v_mfma_f32_32x32x16_bf16 v[32:47], a[72:75], a[8:11], v[32:47]
ds_read_b128 a[72:75], v4 offset:5120
s_add_u32 s18, s19, 32768
v_exp_f32 v82, v18
v_mfma_f32_32x32x16_bf16 v[32:47], a[76:79], a[12:15], v[32:47]
ds_read_b128 a[76:79], v4 offset:5632
s_cmp_ge_u32 s18, s20
s_cselect_b32 s31, 163840, 0
v_exp_f32 v83, v19
v_cvt_pk_bf16_f32 v48, v80, v81
s_waitcnt lgkmcnt(4)
v_mfma_f32_32x32x16_bf16 v[32:47], a[80:83], a[16:19], v[32:47]
ds_read_b128 a[80:83], v4 offset:6144
s_sub_u32 s18, s18, s31
v_exp_f32 v84, v20
v_mfma_f32_32x32x16_bf16 v[32:47], a[84:87], a[20:23], v[32:47]
ds_read_b128 a[84:87], v4 offset:6656
v_add_u32 v3, s18, v2
buffer_load_dwordx4 v12, s[4:7], s12 offen offset:0 lds
v_add_f32 v7, v80, v82
v_mfma_f32_32x32x16_bf16 v[32:47], a[88:91], a[24:27], v[32:47]
ds_read_b128 a[88:91], v4 offset:7168
v_exp_f32 v85, v21
v_add_f32 v8, v81, v83
v_mfma_f32_32x32x16_bf16 v[32:47], a[92:95], a[28:31], v[32:47]
ds_read_b128 a[92:95], v4 offset:7680
buffer_load_dwordx4 v12, s[4:7], s12 offen offset:1024 lds
v_cvt_pk_bf16_f32 v49, v82, v83
s_waitcnt lgkmcnt(4)
v_mfma_f32_32x32x16_bf16 v[32:47], a[64:67], a[32:35], v[32:47]
ds_read_b128 a[64:67], v3 offset:16384
v_exp_f32 v86, v22
v_mfma_f32_32x32x16_bf16 v[32:47], a[68:71], a[36:39], v[32:47]
ds_read_b128 a[68:71], v3 offset:17408
buffer_load_dwordx4 v12, s[4:7], s12 offen offset:2048 lds
v_add_f32 v7, v7, v84
v_exp_f32 v87, v23
v_mfma_f32_32x32x16_bf16 v[32:47], a[72:75], a[40:43], v[32:47]
ds_read_b128 a[72:75], v3 offset:18432
v_add_f32 v8, v8, v85
v_mfma_f32_32x32x16_bf16 v[32:47], a[76:79], a[44:47], v[32:47]
ds_read_b128 a[76:79], v3 offset:19456
buffer_load_dwordx4 v12, s[4:7], s12 offen offset:3072 lds
v_cvt_pk_bf16_f32 v52, v84, v85
v_exp_f32 v80, v24
s_waitcnt lgkmcnt(4)
v_mfma_f32_32x32x16_bf16 v[32:47], a[80:83], a[48:51], v[32:47]
ds_read_b128 a[80:83], v3 offset:20480
s_mov_b32 m0, s30
s_add_u32 s12, s12, 16384
v_add_f32 v7, v7, v86
v_mfma_f32_32x32x16_bf16 v[32:47], a[84:87], a[52:55], v[32:47]
ds_read_b128 a[84:87], v3 offset:21504
s_cmp_eq_u32 s12, s14
s_cselect_b32 s12, s16, s12
v_exp_f32 v81, v25
v_mfma_f32_32x32x16_bf16 v[32:47], a[88:91], a[56:59], v[32:47]
ds_read_b128 a[88:91], v3 offset:22528
buffer_load_dwordx4 v12, s[4:7], s13 offen offset:0 lds
v_add_f32 v8, v8, v87
v_cvt_pk_bf16_f32 v53, v86, v87
v_mfma_f32_32x32x16_bf16 v[32:47], a[92:95], a[60:63], v[32:47]
ds_read_b128 a[92:95], v3 offset:23552
v_exp_f32 v82, v26
s_waitcnt lgkmcnt(4)
v_mfma_f32_32x32x16_bf16 v[128:143], a[64:67], v[56:59], v[128:143]
ds_read_b128 a[64:67], v3 offset:16896
buffer_load_dwordx4 v12, s[4:7], s13 offen offset:1024 lds
v_add_f32 v7, v7, v80
v_mfma_f32_32x32x16_bf16 v[144:159], a[68:71], v[56:59], v[144:159]
ds_read_b128 a[68:71], v3 offset:17920
v_exp_f32 v83, v27
v_add_f32 v8, v8, v81
v_mfma_f32_32x32x16_bf16 v[160:175], a[72:75], v[56:59], v[160:175]
ds_read_b128 a[72:75], v3 offset:18944
buffer_load_dwordx4 v12, s[4:7], s13 offen offset:2048 lds
v_cvt_pk_bf16_f32 v50, v80, v81
v_mfma_f32_32x32x16_bf16 v[176:191], a[76:79], v[56:59], v[176:191]
ds_read_b128 a[76:79], v3 offset:19968
v_exp_f32 v84, v28
s_waitcnt lgkmcnt(4)
v_mfma_f32_32x32x16_bf16 v[192:207], a[80:83], v[56:59], v[192:207]
ds_read_b128 a[80:83], v3 offset:20992
buffer_load_dwordx4 v12, s[4:7], s13 offen offset:3072 lds
v_add_f32 v7, v7, v82
v_exp_f32 v85, v29
v_mfma_f32_32x32x16_bf16 v[208:223], a[84:87], v[56:59], v[208:223]
ds_read_b128 a[84:87], v3 offset:22016
s_add_u32 s13, s13, 16384
v_add_f32 v8, v8, v83
v_mfma_f32_32x32x16_bf16 v[224:239], a[88:91], v[56:59], v[224:239]
ds_read_b128 a[88:91], v3 offset:23040
s_cmp_eq_u32 s13, s15
s_cselect_b32 s13, s17, s13
v_cvt_pk_bf16_f32 v51, v82, v83
v_exp_f32 v86, v30
v_mfma_f32_32x32x16_bf16 v[240:255], a[92:95], v[56:59], v[240:255]
ds_read_b128 a[92:95], v3 offset:24064
v_add_f32 v7, v7, v84
s_waitcnt vmcnt(16)
s_barrier
s_waitcnt lgkmcnt(4)
v_mfma_f32_32x32x16_bf16 v[128:143], a[64:67], v[60:63], v[128:143]
ds_read_b128 a[64:67], v3 offset:0
v_exp_f32 v87, v31
v_mfma_f32_32x32x16_bf16 v[144:159], a[68:71], v[60:63], v[144:159]
ds_read_b128 a[68:71], v3 offset:512
v_add_f32 v8, v8, v85
v_cvt_pk_bf16_f32 v54, v84, v85
v_mfma_f32_32x32x16_bf16 v[160:175], a[72:75], v[60:63], v[160:175]
ds_read_b128 a[72:75], v3 offset:1024
s_add_u32 s23, s23, 1
v_add_f32 v7, v7, v86
v_mfma_f32_32x32x16_bf16 v[176:191], a[76:79], v[60:63], v[176:191]
ds_read_b128 a[76:79], v3 offset:1536
s_sub_u32 s21, s21, 1
v_add_f32 v8, v8, v87
s_waitcnt lgkmcnt(4)
v_mfma_f32_32x32x16_bf16 v[192:207], a[80:83], v[60:63], v[192:207]
ds_read_b128 a[80:83], v3 offset:2048
v_cvt_pk_bf16_f32 v55, v86, v87
v_add_f32 v7, v7, v8
v_mfma_f32_32x32x16_bf16 v[208:223], a[84:87], v[60:63], v[208:223]
ds_read_b128 a[84:87], v3 offset:2560
s_cmp_lg_u32 s21, 0
v_cmp_nle_f32 vcc, v7, v10
v_mfma_f32_32x32x16_bf16 v[224:239], a[88:91], v[60:63], v[224:239]
ds_read_b128 a[88:91], v3 offset:3072
v_add_f32 v6, v14, v7
v_mfma_f32_32x32x16_bf16 v[240:255], a[92:95], v[60:63], v[240:255]
ds_read_b128 a[92:95], v3 offset:3584
s_cbranch_vccnz fused_kernel_fstub_64
fused_kernel_fback_65:
s_cbranch_scc1 fused_kernel_loop
fused_kernel_tail:
s_cmp_eq_u32 s32, 3
s_cbranch_scc0 fused_kernel_noq_66
s_sub_u32 s30, 15, s9
s_lshl_b32 s28, s8, 6
s_lshl_b32 s29, s30, 2
s_add_u32 s28, s28, s29
s_add_u32 s28, s28, s3
s_lshl_b32 s28, s28, 14
s_add_u32 s36, s28, 0x200000
s_add_u32 s28, s36, 0
buffer_load_dwordx4 a[0:3], v0, s[4:7], s28 offen offset:0
buffer_load_dwordx4 a[4:7], v0, s[4:7], s28 offen offset:512
buffer_load_dwordx4 a[8:11], v0, s[4:7], s28 offen offset:1024
buffer_load_dwordx4 a[12:15], v0, s[4:7], s28 offen offset:1536
buffer_load_dwordx4 a[16:19], v0, s[4:7], s28 offen offset:2048
buffer_load_dwordx4 a[20:23], v0, s[4:7], s28 offen offset:2560
buffer_load_dwordx4 a[24:27], v0, s[4:7], s28 offen offset:3072
buffer_load_dwordx4 a[28:31], v0, s[4:7], s28 offen offset:3584
s_add_u32 s28, s36, 4096
buffer_load_dwordx4 a[32:35], v0, s[4:7], s28 offen offset:0
buffer_load_dwordx4 a[36:39], v0, s[4:7], s28 offen offset:512
buffer_load_dwordx4 a[40:43], v0, s[4:7], s28 offen offset:1024
buffer_load_dwordx4 a[44:47], v0, s[4:7], s28 offen offset:1536
buffer_load_dwordx4 a[48:51], v0, s[4:7], s28 offen offset:2048
buffer_load_dwordx4 a[52:55], v0, s[4:7], s28 offen offset:2560
buffer_load_dwordx4 a[56:59], v0, s[4:7], s28 offen offset:3072
buffer_load_dwordx4 a[60:63], v0, s[4:7], s28 offen offset:3584
s_branch fused_kernel_reqd_67
fused_kernel_noq_66:
s_add_u32 s28, s37, 160
s_lshl_b32 s28, s28, 7
s_add_u32 s28, s28, 0x5b00000
v_mov_b32 v126, s28
s_cmp_lg_u32 s3, 3
s_cbranch_scc1 fused_kernel_nocp_68
s_getpc_b64 s[98:99]
fused_kernel_cp_69:
s_add_u32 s98, s98, fused_kernel_ecode-fused_kernel_cp_69
s_addc_u32 s99, s99, 0
s_lshr_b32 s100, s2, 3
s_mul_i32 s101, s100, 32768
s_lshr_b32 s101, s101, 16
s_mul_i32 s101, s101, 2
s_sub_u32 s100, s100, s101
s_lshl_b32 s100, s100, 13
v_lshlrev_b32 v125, 7, v1
v_add_u32 v125, s100, v125
v_min_u32 v125, fused_kernel_codeend-fused_kernel_ecode-256, v125
global_load_dword a255, v125, s[98:99]
fused_kernel_nocp_68:
s_bfe_u32 s66, s2, 0x10003
s_lshl_b32 s66, s66, 2
s_and_b32 s67, s2, 1
s_lshl_b32 s67, s67, 1
s_add_u32 s66, s66, s67
s_lshr_b32 s67, s2, 7
s_add_u32 s66, s66, s67
s_add_u32 s66, s66, 16
s_lshl_b32 s66, s66, 7
s_add_u32 s66, s66, 0x5b00000
s_mov_b32 s67, 0x5b0d000
v_writelane_b32 v126, s67, 1
v_writelane_b32 v126, s66, 2
buffer_load_dword v127, v126, s[4:7], 0 offen sc1
fused_kernel_reqd_67:
s_add_u32 s30, s18, 32768
s_cmp_ge_u32 s30, s20
s_cselect_b32 s31, 163840, 0
s_sub_u32 s30, s30, s31
v_add_u32 v13, s30, v2
ds_read_b128 a[64:67], v13 offset:16384
ds_read_b128 a[68:71], v13 offset:17408
ds_read_b128 a[72:75], v13 offset:18432
ds_read_b128 a[76:79], v13 offset:19456
ds_read_b128 a[80:83], v13 offset:20480
ds_read_b128 a[84:87], v13 offset:21504
ds_read_b128 a[88:91], v13 offset:22528
ds_read_b128 a[92:95], v13 offset:23552
s_waitcnt lgkmcnt(4)
v_mfma_f32_32x32x16_bf16 v[128:143], a[64:67], v[48:51], v[128:143]
ds_read_b128 a[64:67], v13 offset:16896
s_cmp_lt_u32 s23, s24
s_cbranch_scc0 fused_kernel_mstub_70
fused_kernel_mback_71:
v_mfma_f32_32x32x16_bf16 v[144:159], a[68:71], v[48:51], v[144:159]
ds_read_b128 a[68:71], v13 offset:17920
s_mov_b32 m0, s19
s_nop 0
buffer_load_dwordx4 v12, s[4:7], s12 offen offset:0 lds
buffer_load_dwordx4 v12, s[4:7], s12 offen offset:1024 lds
buffer_load_dwordx4 v12, s[4:7], s12 offen offset:2048 lds
v_exp_f32 v80, v32
v_exp_f32 v81, v33
v_exp_f32 v82, v34
v_mfma_f32_32x32x16_bf16 v[160:175], a[72:75], v[48:51], v[160:175]
ds_read_b128 a[72:75], v13 offset:18944
buffer_load_dwordx4 v12, s[4:7], s12 offen offset:3072 lds
s_add_u32 m0, s19, 16384
s_add_u32 s12, s12, 16384
buffer_load_dwordx4 v12, s[4:7], s13 offen offset:0 lds
v_exp_f32 v83, v35
v_cvt_pk_bf16_f32 v56, v80, v81
v_exp_f32 v84, v36
v_mfma_f32_32x32x16_bf16 v[176:191], a[76:79], v[48:51], v[176:191]
ds_read_b128 a[76:79], v13 offset:19968
buffer_load_dwordx4 v12, s[4:7], s13 offen offset:1024 lds
buffer_load_dwordx4 v12, s[4:7], s13 offen offset:2048 lds
buffer_load_dwordx4 v12, s[4:7], s13 offen offset:3072 lds
v_add_f32 v7, v80, v82
v_exp_f32 v85, v37
v_add_f32 v8, v81, v83
s_waitcnt lgkmcnt(4)
v_mfma_f32_32x32x16_bf16 v[192:207], a[80:83], v[48:51], v[192:207]
ds_read_b128 a[80:83], v13 offset:20992
s_cmp_eq_u32 s12, s14
s_cselect_b32 s12, s16, s12
s_add_u32 s13, s13, 16384
s_cmp_eq_u32 s13, s15
v_cvt_pk_bf16_f32 v57, v82, v83
v_exp_f32 v86, v38
v_add_f32 v7, v7, v84
v_mfma_f32_32x32x16_bf16 v[208:223], a[84:87], v[48:51], v[208:223]
ds_read_b128 a[84:87], v13 offset:22016
s_cselect_b32 s13, s17, s13
s_mov_b32 s19, s30
s_add_u32 s30, s30, 32768
s_cmp_ge_u32 s30, s20
v_exp_f32 v87, v39
v_add_f32 v8, v8, v85
v_cvt_pk_bf16_f32 v60, v84, v85
v_mfma_f32_32x32x16_bf16 v[224:239], a[88:91], v[48:51], v[224:239]
ds_read_b128 a[88:91], v13 offset:23040
s_cselect_b32 s31, 163840, 0
s_sub_u32 s30, s30, s31
v_add_u32 v4, s30, v2
v_exp_f32 v80, v40
v_add_f32 v7, v7, v86
v_exp_f32 v81, v41
v_mfma_f32_32x32x16_bf16 v[240:255], a[92:95], v[48:51], v[240:255]
ds_read_b128 a[92:95], v13 offset:24064
v_add_f32 v8, v8, v87
v_cvt_pk_bf16_f32 v61, v86, v87
v_exp_f32 v82, v42
s_waitcnt vmcnt(16)
s_barrier
s_waitcnt lgkmcnt(4)
v_mfma_f32_32x32x16_bf16 v[128:143], a[64:67], v[52:55], v[128:143]
ds_read_b128 a[64:67], v4 offset:16384
v_add_f32 v7, v7, v80
v_exp_f32 v83, v43
v_add_f32 v8, v8, v81
v_mfma_f32_32x32x16_bf16 v[144:159], a[68:71], v[52:55], v[144:159]
ds_read_b128 a[68:71], v4 offset:17408
s_add_u32 s23, s23, 1
v_cvt_pk_bf16_f32 v58, v80, v81
v_exp_f32 v84, v44
v_add_f32 v7, v7, v82
v_mfma_f32_32x32x16_bf16 v[160:175], a[72:75], v[52:55], v[160:175]
ds_read_b128 a[72:75], v4 offset:18432
v_exp_f32 v85, v45
v_add_f32 v8, v8, v83
v_cvt_pk_bf16_f32 v59, v82, v83
v_mfma_f32_32x32x16_bf16 v[176:191], a[76:79], v[52:55], v[176:191]
ds_read_b128 a[76:79], v4 offset:19456
v_exp_f32 v86, v46
v_add_f32 v7, v7, v84
v_exp_f32 v87, v47
s_waitcnt lgkmcnt(4)
v_mfma_f32_32x32x16_bf16 v[192:207], a[80:83], v[52:55], v[192:207]
ds_read_b128 a[80:83], v4 offset:20480
v_add_f32 v8, v8, v85
v_cvt_pk_bf16_f32 v62, v84, v85
v_add_f32 v7, v7, v86
v_mfma_f32_32x32x16_bf16 v[208:223], a[84:87], v[52:55], v[208:223]
ds_read_b128 a[84:87], v4 offset:21504
v_add_f32 v8, v8, v87
v_cvt_pk_bf16_f32 v63, v86, v87
v_add_f32 v7, v7, v8
v_mfma_f32_32x32x16_bf16 v[224:239], a[88:91], v[52:55], v[224:239]
ds_read_b128 a[88:91], v4 offset:22528
v_cmp_nle_f32 vcc, v7, v10
v_add_f32 v14, v6, v7
v_mfma_f32_32x32x16_bf16 v[240:255], a[92:95], v[52:55], v[240:255]
ds_read_b128 a[92:95], v4 offset:23552
s_cbranch_vccnz fused_kernel_fstub_72
fused_kernel_fback_73:
s_cmp_eq_u32 s32, 2
s_cbranch_scc0 fused_kernel_nopl_74
s_waitcnt vmcnt(8)
s_mov_b32 s67, 0x80000
fused_kernel_ppoll_76:
v_readlane_b32 s66, v127, 0
s_sub_u32 s67, s67, 1
s_cmp_eq_u32 s67, 0
s_cbranch_scc1 fused_kernel_pok_75
s_cmp_ge_u32 s66, 1
s_cbranch_scc1 fused_kernel_pok_75
s_sleep 2
buffer_load_dword v127, v126, s[4:7], 0 offen sc1
s_waitcnt vmcnt(0)
s_branch fused_kernel_ppoll_76
fused_kernel_pok_75:
s_lshl_b32 s28, s37, 11
s_lshl_b32 s29, s3, 9
s_add_u32 s28, s28, s29
s_add_u32 s28, s28, 0x5a00000
v_lshlrev_b32 v94, 3, v1
buffer_load_dwordx2 v[92:93], v94, s[4:7], s28 offen sc1
s_lshl_b32 s28, s37, 16
s_lshl_b32 s29, s3, 14
s_add_u32 s28, s28, s29
s_add_u32 s28, s28, 0x4a00000
s_add_u32 s29, s28, 0
buffer_load_dwordx4 v[16:19], v12, s[4:7], s29 offen offset:0 sc1
s_add_u32 s29, s28, 0
buffer_load_dwordx4 v[20:23], v12, s[4:7], s29 offen offset:1024 sc1
s_add_u32 s29, s28, 0
buffer_load_dwordx4 v[24:27], v12, s[4:7], s29 offen offset:2048 sc1
s_add_u32 s29, s28, 0
buffer_load_dwordx4 v[28:31], v12, s[4:7], s29 offen offset:3072 sc1
s_add_u32 s29, s28, 4096
buffer_load_dwordx4 v[32:35], v12, s[4:7], s29 offen offset:0 sc1
s_add_u32 s29, s28, 4096
buffer_load_dwordx4 v[36:39], v12, s[4:7], s29 offen offset:1024 sc1
s_add_u32 s29, s28, 4096
buffer_load_dwordx4 v[40:43], v12, s[4:7], s29 offen offset:2048 sc1
s_add_u32 s29, s28, 4096
buffer_load_dwordx4 v[44:47], v12, s[4:7], s29 offen offset:3072 sc1
s_add_u32 s29, s28, 8192
buffer_load_dwordx4 v[48:51], v12, s[4:7], s29 offen offset:0 sc1
s_add_u32 s29, s28, 8192
buffer_load_dwordx4 v[52:55], v12, s[4:7], s29 offen offset:1024 sc1
s_add_u32 s29, s28, 8192
buffer_load_dwordx4 v[64:67], v12, s[4:7], s29 offen offset:2048 sc1
s_add_u32 s29, s28, 8192
buffer_load_dwordx4 v[68:71], v12, s[4:7], s29 offen offset:3072 sc1
s_add_u32 s29, s28, 12288
buffer_load_dwordx4 v[72:75], v12, s[4:7], s29 offen offset:0 sc1
s_add_u32 s29, s28, 12288
buffer_load_dwordx4 v[76:79], v12, s[4:7], s29 offen offset:1024 sc1
s_add_u32 s29, s28, 12288
buffer_load_dwordx4 v[96:99], v12, s[4:7], s29 offen offset:2048 sc1
s_add_u32 s29, s28, 12288
buffer_load_dwordx4 v[100:103], v12, s[4:7], s29 offen offset:3072 sc1
fused_kernel_nopl_74:
s_waitcnt lgkmcnt(4)
v_mfma_f32_32x32x16_bf16 v[128:143], a[64:67], v[56:59], v[128:143]
ds_read_b128 a[64:67], v4 offset:16896
v_mfma_f32_32x32x16_bf16 v[144:159], a[68:71], v[56:59], v[144:159]
ds_read_b128 a[68:71], v4 offset:17920
v_mfma_f32_32x32x16_bf16 v[160:175], a[72:75], v[56:59], v[160:175]
ds_read_b128 a[72:75], v4 offset:18944
v_mfma_f32_32x32x16_bf16 v[176:191], a[76:79], v[56:59], v[176:191]
ds_read_b128 a[76:79], v4 offset:19968
s_waitcnt lgkmcnt(4)
v_mfma_f32_32x32x16_bf16 v[192:207], a[80:83], v[56:59], v[192:207]
ds_read_b128 a[80:83], v4 offset:20992
v_mfma_f32_32x32x16_bf16 v[208:223], a[84:87], v[56:59], v[208:223]
ds_read_b128 a[84:87], v4 offset:22016
v_mfma_f32_32x32x16_bf16 v[224:239], a[88:91], v[56:59], v[224:239]
ds_read_b128 a[88:91], v4 offset:23040
v_mfma_f32_32x32x16_bf16 v[240:255], a[92:95], v[56:59], v[240:255]
ds_read_b128 a[92:95], v4 offset:24064
s_waitcnt vmcnt(16)
s_barrier
s_waitcnt lgkmcnt(4)
v_mfma_f32_32x32x16_bf16 v[128:143], a[64:67], v[60:63], v[128:143]
ds_read_b128 a[64:67], v3 offset:0
v_mfma_f32_32x32x16_bf16 v[144:159], a[68:71], v[60:63], v[144:159]
ds_read_b128 a[68:71], v3 offset:512
v_mfma_f32_32x32x16_bf16 v[160:175], a[72:75], v[60:63], v[160:175]
ds_read_b128 a[72:75], v3 offset:1024
v_mfma_f32_32x32x16_bf16 v[176:191], a[76:79], v[60:63], v[176:191]
ds_read_b128 a[76:79], v3 offset:1536
s_waitcnt lgkmcnt(4)
v_mfma_f32_32x32x16_bf16 v[192:207], a[80:83], v[60:63], v[192:207]
ds_read_b128 a[80:83], v3 offset:2048
v_mfma_f32_32x32x16_bf16 v[208:223], a[84:87], v[60:63], v[208:223]
ds_read_b128 a[84:87], v3 offset:2560
v_mfma_f32_32x32x16_bf16 v[224:239], a[88:91], v[60:63], v[224:239]
ds_read_b128 a[88:91], v3 offset:3072
v_mfma_f32_32x32x16_bf16 v[240:255], a[92:95], v[60:63], v[240:255]
ds_read_b128 a[92:95], v3 offset:3584
s_nop 15
v_mov_b32 v80, v14
s_nop 1
v_permlane32_swap_b32 v14, v80
s_nop 1
v_add_f32 v14, v14, v80
s_cmp_eq_u32 s32, 2
s_cbranch_scc1 fused_kernel_merge
v_rcp_f32 v104, v14
s_cmp_eq_u32 s32, 1
s_cbranch_scc1 fused_kernel_part
s_lshl_b32 s28, s22, 3
s_lshl_b32 s29, s3, 1
s_add_u32 s28, s28, s29
s_mul_i32 s28, s28, 184
s_lshl_b32 s29, s8, 3
s_add_u32 s28, s28, s29
s_lshl_b32 s28, s28, 10
s_add_u32 s28, s28, 0x3200000
v_pk_mul_f32 v[80:81], v[128:129], v[104:105] op_sel_hi:[1,0]
v_pk_mul_f32 v[82:83], v[130:131], v[104:105] op_sel_hi:[1,0]
v_pk_mul_f32 v[84:85], v[136:137], v[104:105] op_sel_hi:[1,0]
v_pk_mul_f32 v[86:87], v[138:139], v[104:105] op_sel_hi:[1,0]
v_cvt_pk_bf16_f32 v108, v80, v81
v_cvt_pk_bf16_f32 v109, v82, v83
v_cvt_pk_bf16_f32 v110, v84, v85
v_cvt_pk_bf16_f32 v111, v86, v87
s_add_u32 s29, s28, 0
buffer_store_dwordx4 v[108:111], v11, s[4:7], s29 offen offset:0 sc1
v_pk_mul_f32 v[80:81], v[132:133], v[104:105] op_sel_hi:[1,0]
v_pk_mul_f32 v[82:83], v[134:135], v[104:105] op_sel_hi:[1,0]
v_pk_mul_f32 v[84:85], v[140:141], v[104:105] op_sel_hi:[1,0]
v_pk_mul_f32 v[86:87], v[142:143], v[104:105] op_sel_hi:[1,0]
v_cvt_pk_bf16_f32 v112, v80, v81
v_cvt_pk_bf16_f32 v113, v82, v83
v_cvt_pk_bf16_f32 v114, v84, v85
v_cvt_pk_bf16_f32 v115, v86, v87
s_add_u32 s29, s28, 0
buffer_store_dwordx4 v[112:115], v11, s[4:7], s29 offen offset:512 sc1
v_pk_mul_f32 v[80:81], v[144:145], v[104:105] op_sel_hi:[1,0]
v_pk_mul_f32 v[82:83], v[146:147], v[104:105] op_sel_hi:[1,0]
v_pk_mul_f32 v[84:85], v[152:153], v[104:105] op_sel_hi:[1,0]
v_pk_mul_f32 v[86:87], v[154:155], v[104:105] op_sel_hi:[1,0]
v_cvt_pk_bf16_f32 v116, v80, v81
v_cvt_pk_bf16_f32 v117, v82, v83
v_cvt_pk_bf16_f32 v118, v84, v85
v_cvt_pk_bf16_f32 v119, v86, v87
s_add_u32 s29, s28, 1024
buffer_store_dwordx4 v[116:119], v11, s[4:7], s29 offen offset:0 sc1
v_pk_mul_f32 v[80:81], v[148:149], v[104:105] op_sel_hi:[1,0]
v_pk_mul_f32 v[82:83], v[150:151], v[104:105] op_sel_hi:[1,0]
v_pk_mul_f32 v[84:85], v[156:157], v[104:105] op_sel_hi:[1,0]
v_pk_mul_f32 v[86:87], v[158:159], v[104:105] op_sel_hi:[1,0]
v_cvt_pk_bf16_f32 v120, v80, v81
v_cvt_pk_bf16_f32 v121, v82, v83
v_cvt_pk_bf16_f32 v122, v84, v85
v_cvt_pk_bf16_f32 v123, v86, v87
s_add_u32 s29, s28, 1024
buffer_store_dwordx4 v[120:123], v11, s[4:7], s29 offen offset:512 sc1
v_pk_mul_f32 v[80:81], v[160:161], v[104:105] op_sel_hi:[1,0]
v_pk_mul_f32 v[82:83], v[162:163], v[104:105] op_sel_hi:[1,0]
v_pk_mul_f32 v[84:85], v[168:169], v[104:105] op_sel_hi:[1,0]
v_pk_mul_f32 v[86:87], v[170:171], v[104:105] op_sel_hi:[1,0]
v_cvt_pk_bf16_f32 v108, v80, v81
v_cvt_pk_bf16_f32 v109, v82, v83
v_cvt_pk_bf16_f32 v110, v84, v85
v_cvt_pk_bf16_f32 v111, v86, v87
s_add_u32 s29, s28, 2048
buffer_store_dwordx4 v[108:111], v11, s[4:7], s29 offen offset:0 sc1
v_pk_mul_f32 v[80:81], v[164:165], v[104:105] op_sel_hi:[1,0]
v_pk_mul_f32 v[82:83], v[166:167], v[104:105] op_sel_hi:[1,0]
v_pk_mul_f32 v[84:85], v[172:173], v[104:105] op_sel_hi:[1,0]
v_pk_mul_f32 v[86:87], v[174:175], v[104:105] op_sel_hi:[1,0]
v_cvt_pk_bf16_f32 v112, v80, v81
v_cvt_pk_bf16_f32 v113, v82, v83
v_cvt_pk_bf16_f32 v114, v84, v85
v_cvt_pk_bf16_f32 v115, v86, v87
s_add_u32 s29, s28, 2048
buffer_store_dwordx4 v[112:115], v11, s[4:7], s29 offen offset:512 sc1
v_pk_mul_f32 v[80:81], v[176:177], v[104:105] op_sel_hi:[1,0]
v_pk_mul_f32 v[82:83], v[178:179], v[104:105] op_sel_hi:[1,0]
v_pk_mul_f32 v[84:85], v[184:185], v[104:105] op_sel_hi:[1,0]
v_pk_mul_f32 v[86:87], v[186:187], v[104:105] op_sel_hi:[1,0]
v_cvt_pk_bf16_f32 v116, v80, v81
v_cvt_pk_bf16_f32 v117, v82, v83
v_cvt_pk_bf16_f32 v118, v84, v85
v_cvt_pk_bf16_f32 v119, v86, v87
s_add_u32 s29, s28, 3072
buffer_store_dwordx4 v[116:119], v11, s[4:7], s29 offen offset:0 sc1
v_pk_mul_f32 v[80:81], v[180:181], v[104:105] op_sel_hi:[1,0]
v_pk_mul_f32 v[82:83], v[182:183], v[104:105] op_sel_hi:[1,0]
v_pk_mul_f32 v[84:85], v[188:189], v[104:105] op_sel_hi:[1,0]
v_pk_mul_f32 v[86:87], v[190:191], v[104:105] op_sel_hi:[1,0]
v_cvt_pk_bf16_f32 v120, v80, v81
v_cvt_pk_bf16_f32 v121, v82, v83
v_cvt_pk_bf16_f32 v122, v84, v85
v_cvt_pk_bf16_f32 v123, v86, v87
s_add_u32 s29, s28, 3072
buffer_store_dwordx4 v[120:123], v11, s[4:7], s29 offen offset:512 sc1
v_pk_mul_f32 v[80:81], v[192:193], v[104:105] op_sel_hi:[1,0]
v_pk_mul_f32 v[82:83], v[194:195], v[104:105] op_sel_hi:[1,0]
v_pk_mul_f32 v[84:85], v[200:201], v[104:105] op_sel_hi:[1,0]
v_pk_mul_f32 v[86:87], v[202:203], v[104:105] op_sel_hi:[1,0]
v_cvt_pk_bf16_f32 v108, v80, v81
v_cvt_pk_bf16_f32 v109, v82, v83
v_cvt_pk_bf16_f32 v110, v84, v85
v_cvt_pk_bf16_f32 v111, v86, v87
s_add_u32 s29, s28, 4096
buffer_store_dwordx4 v[108:111], v11, s[4:7], s29 offen offset:0 sc1
v_pk_mul_f32 v[80:81], v[196:197], v[104:105] op_sel_hi:[1,0]
v_pk_mul_f32 v[82:83], v[198:199], v[104:105] op_sel_hi:[1,0]
v_pk_mul_f32 v[84:85], v[204:205], v[104:105] op_sel_hi:[1,0]
v_pk_mul_f32 v[86:87], v[206:207], v[104:105] op_sel_hi:[1,0]
v_cvt_pk_bf16_f32 v112, v80, v81
v_cvt_pk_bf16_f32 v113, v82, v83
v_cvt_pk_bf16_f32 v114, v84, v85
v_cvt_pk_bf16_f32 v115, v86, v87
s_add_u32 s29, s28, 4096
buffer_store_dwordx4 v[112:115], v11, s[4:7], s29 offen offset:512 sc1
v_pk_mul_f32 v[80:81], v[208:209], v[104:105] op_sel_hi:[1,0]
v_pk_mul_f32 v[82:83], v[210:211], v[104:105] op_sel_hi:[1,0]
v_pk_mul_f32 v[84:85], v[216:217], v[104:105] op_sel_hi:[1,0]
v_pk_mul_f32 v[86:87], v[218:219], v[104:105] op_sel_hi:[1,0]
v_cvt_pk_bf16_f32 v116, v80, v81
v_cvt_pk_bf16_f32 v117, v82, v83
v_cvt_pk_bf16_f32 v118, v84, v85
v_cvt_pk_bf16_f32 v119, v86, v87
s_add_u32 s29, s28, 5120
buffer_store_dwordx4 v[116:119], v11, s[4:7], s29 offen offset:0 sc1
v_pk_mul_f32 v[80:81], v[212:213], v[104:105] op_sel_hi:[1,0]
v_pk_mul_f32 v[82:83], v[214:215], v[104:105] op_sel_hi:[1,0]
v_pk_mul_f32 v[84:85], v[220:221], v[104:105] op_sel_hi:[1,0]
v_pk_mul_f32 v[86:87], v[222:223], v[104:105] op_sel_hi:[1,0]
v_cvt_pk_bf16_f32 v120, v80, v81
v_cvt_pk_bf16_f32 v121, v82, v83
v_cvt_pk_bf16_f32 v122, v84, v85
v_cvt_pk_bf16_f32 v123, v86, v87
s_add_u32 s29, s28, 5120
buffer_store_dwordx4 v[120:123], v11, s[4:7], s29 offen offset:512 sc1
v_pk_mul_f32 v[80:81], v[224:225], v[104:105] op_sel_hi:[1,0]
v_pk_mul_f32 v[82:83], v[226:227], v[104:105] op_sel_hi:[1,0]
v_pk_mul_f32 v[84:85], v[232:233], v[104:105] op_sel_hi:[1,0]
v_pk_mul_f32 v[86:87], v[234:235], v[104:105] op_sel_hi:[1,0]
v_cvt_pk_bf16_f32 v108, v80, v81
v_cvt_pk_bf16_f32 v109, v82, v83
v_cvt_pk_bf16_f32 v110, v84, v85
v_cvt_pk_bf16_f32 v111, v86, v87
s_add_u32 s29, s28, 6144
buffer_store_dwordx4 v[108:111], v11, s[4:7], s29 offen offset:0 sc1
v_pk_mul_f32 v[80:81], v[228:229], v[104:105] op_sel_hi:[1,0]
v_pk_mul_f32 v[82:83], v[230:231], v[104:105] op_sel_hi:[1,0]
v_pk_mul_f32 v[84:85], v[236:237], v[104:105] op_sel_hi:[1,0]
v_pk_mul_f32 v[86:87], v[238:239], v[104:105] op_sel_hi:[1,0]
v_cvt_pk_bf16_f32 v112, v80, v81
v_cvt_pk_bf16_f32 v113, v82, v83
v_cvt_pk_bf16_f32 v114, v84, v85
v_cvt_pk_bf16_f32 v115, v86, v87
s_add_u32 s29, s28, 6144
buffer_store_dwordx4 v[112:115], v11, s[4:7], s29 offen offset:512 sc1
v_pk_mul_f32 v[80:81], v[240:241], v[104:105] op_sel_hi:[1,0]
v_pk_mul_f32 v[82:83], v[242:243], v[104:105] op_sel_hi:[1,0]
v_pk_mul_f32 v[84:85], v[248:249], v[104:105] op_sel_hi:[1,0]
v_pk_mul_f32 v[86:87], v[250:251], v[104:105] op_sel_hi:[1,0]
v_cvt_pk_bf16_f32 v116, v80, v81
v_cvt_pk_bf16_f32 v117, v82, v83
v_cvt_pk_bf16_f32 v118, v84, v85
v_cvt_pk_bf16_f32 v119, v86, v87
s_add_u32 s29, s28, 7168
buffer_store_dwordx4 v[116:119], v11, s[4:7], s29 offen offset:0 sc1
v_pk_mul_f32 v[80:81], v[244:245], v[104:105] op_sel_hi:[1,0]
v_pk_mul_f32 v[82:83], v[246:247], v[104:105] op_sel_hi:[1,0]
v_pk_mul_f32 v[84:85], v[252:253], v[104:105] op_sel_hi:[1,0]
v_pk_mul_f32 v[86:87], v[254:255], v[104:105] op_sel_hi:[1,0]
v_cvt_pk_bf16_f32 v120, v80, v81
v_cvt_pk_bf16_f32 v121, v82, v83
v_cvt_pk_bf16_f32 v122, v84, v85
v_cvt_pk_bf16_f32 v123, v86, v87
s_add_u32 s29, s28, 7168
buffer_store_dwordx4 v[120:123], v11, s[4:7], s29 offen offset:512 sc1
s_cmp_eq_u32 s32, 0
s_cbranch_scc1 fused_kernel_fin
v_mov_b32 v128, 0
v_mov_b32 v129, 0
v_mov_b32 v130, 0
v_mov_b32 v131, 0
v_mov_b32 v132, 0
v_mov_b32 v133, 0
v_mov_b32 v134, 0
v_mov_b32 v135, 0
v_mov_b32 v136, 0
v_mov_b32 v137, 0
v_mov_b32 v138, 0
v_mov_b32 v139, 0
v_mov_b32 v140, 0
v_mov_b32 v141, 0
v_mov_b32 v142, 0
v_mov_b32 v143, 0
v_mov_b32 v144, 0
v_mov_b32 v145, 0
v_mov_b32 v146, 0
v_mov_b32 v147, 0
v_mov_b32 v148, 0
v_mov_b32 v149, 0
v_mov_b32 v150, 0
v_mov_b32 v151, 0
v_mov_b32 v152, 0
v_mov_b32 v153, 0
v_mov_b32 v154, 0
v_mov_b32 v155, 0
v_mov_b32 v156, 0
v_mov_b32 v157, 0
v_mov_b32 v158, 0
v_mov_b32 v159, 0
v_mov_b32 v160, 0
v_mov_b32 v161, 0
v_mov_b32 v162, 0
v_mov_b32 v163, 0
v_mov_b32 v164, 0
v_mov_b32 v165, 0
v_mov_b32 v166, 0
v_mov_b32 v167, 0
v_mov_b32 v168, 0
v_mov_b32 v169, 0
v_mov_b32 v170, 0
v_mov_b32 v171, 0
v_mov_b32 v172, 0
v_mov_b32 v173, 0
v_mov_b32 v174, 0
v_mov_b32 v175, 0
v_mov_b32 v176, 0
v_mov_b32 v177, 0
v_mov_b32 v178, 0
v_mov_b32 v179, 0
v_mov_b32 v180, 0
v_mov_b32 v181, 0
v_mov_b32 v182, 0
v_mov_b32 v183, 0
v_mov_b32 v184, 0
v_mov_b32 v185, 0
v_mov_b32 v186, 0
v_mov_b32 v187, 0
v_mov_b32 v188, 0
v_mov_b32 v189, 0
v_mov_b32 v190, 0
v_mov_b32 v191, 0
v_mov_b32 v192, 0
v_mov_b32 v193, 0
v_mov_b32 v194, 0
v_mov_b32 v195, 0
v_mov_b32 v196, 0
v_mov_b32 v197, 0
v_mov_b32 v198, 0
v_mov_b32 v199, 0
v_mov_b32 v200, 0
v_mov_b32 v201, 0
v_mov_b32 v202, 0
v_mov_b32 v203, 0
v_mov_b32 v204, 0
v_mov_b32 v205, 0
v_mov_b32 v206, 0
v_mov_b32 v207, 0
v_mov_b32 v208, 0
v_mov_b32 v209, 0
v_mov_b32 v210, 0
v_mov_b32 v211, 0
v_mov_b32 v212, 0
v_mov_b32 v213, 0
v_mov_b32 v214, 0
v_mov_b32 v215, 0
v_mov_b32 v216, 0
v_mov_b32 v217, 0
v_mov_b32 v218, 0
v_mov_b32 v219, 0
v_mov_b32 v220, 0
v_mov_b32 v221, 0
v_mov_b32 v222, 0
v_mov_b32 v223, 0
v_mov_b32 v224, 0
v_mov_b32 v225, 0
v_mov_b32 v226, 0
v_mov_b32 v227, 0
v_mov_b32 v228, 0
v_mov_b32 v229, 0
v_mov_b32 v230, 0
v_mov_b32 v231, 0
v_mov_b32 v232, 0
v_mov_b32 v233, 0
v_mov_b32 v234, 0
v_mov_b32 v235, 0
v_mov_b32 v236, 0
v_mov_b32 v237, 0
v_mov_b32 v238, 0
v_mov_b32 v239, 0
v_mov_b32 v240, 0
v_mov_b32 v241, 0
v_mov_b32 v242, 0
v_mov_b32 v243, 0
v_mov_b32 v244, 0
v_mov_b32 v245, 0
v_mov_b32 v246, 0
v_mov_b32 v247, 0
v_mov_b32 v248, 0
v_mov_b32 v249, 0
v_mov_b32 v250, 0
v_mov_b32 v251, 0
v_mov_b32 v252, 0
v_mov_b32 v253, 0
v_mov_b32 v254, 0
v_mov_b32 v255, 0
s_waitcnt vmcnt(0)
s_barrier
s_lshl_b32 s66, s22, 2
s_lshr_b32 s67, s8, 2
s_add_u32 s66, s66, s67
s_add_u32 s66, s66, 288
s_cmp_lg_u32 s3, 0
s_cbranch_scc1 fused_kernel_ctx1_77
s_lshl_b32 s68, s66, 7
s_add_u32 s68, s68, 0x5b00000
v_mov_b32 v80, 1
v_mov_b32 v81, 0
s_mov_b64 s[70:71], exec
s_mov_b64 exec, 1
buffer_atomic_add v80, v81, s[4:7], s68 offen
s_mov_b64 exec, s[70:71]
fused_kernel_ctx1_77:
s_mov_b32 s32, 2
s_sub_u32 s22, 15, s9
s_mov_b32 s35, s25
s_mov_b32 s34, s11
s_lshl_b32 s24, s22, 2
s_mov_b32 s23, s35
s_sub_u32 s21, s34, 2
s_lshr_b32 s21, s21, 1
s_branch fused_kernel_seg
fused_kernel_part:
s_lshl_b32 s28, s37, 16
s_lshl_b32 s29, s3, 14
s_add_u32 s28, s28, s29
s_add_u32 s28, s28, 0x4a00000
v_pk_mul_f32 v[80:81], v[128:129], v[104:105] op_sel_hi:[1,0]
v_pk_mul_f32 v[82:83], v[130:131], v[104:105] op_sel_hi:[1,0]
v_pk_mul_f32 v[84:85], v[136:137], v[104:105] op_sel_hi:[1,0]
v_pk_mul_f32 v[86:87], v[138:139], v[104:105] op_sel_hi:[1,0]
v_cvt_pk_bf16_f32 v108, v80, v81
v_cvt_pk_bf16_f32 v109, v82, v83
v_cvt_pk_bf16_f32 v110, v84, v85
v_cvt_pk_bf16_f32 v111, v86, v87
s_add_u32 s29, s28, 0
buffer_store_dwordx4 v[108:111], v12, s[4:7], s29 offen offset:0 sc1
v_pk_mul_f32 v[80:81], v[132:133], v[104:105] op_sel_hi:[1,0]
v_pk_mul_f32 v[82:83], v[134:135], v[104:105] op_sel_hi:[1,0]
v_pk_mul_f32 v[84:85], v[140:141], v[104:105] op_sel_hi:[1,0]
v_pk_mul_f32 v[86:87], v[142:143], v[104:105] op_sel_hi:[1,0]
v_cvt_pk_bf16_f32 v112, v80, v81
v_cvt_pk_bf16_f32 v113, v82, v83
v_cvt_pk_bf16_f32 v114, v84, v85
v_cvt_pk_bf16_f32 v115, v86, v87
s_add_u32 s29, s28, 0
buffer_store_dwordx4 v[112:115], v12, s[4:7], s29 offen offset:1024 sc1
v_pk_mul_f32 v[80:81], v[144:145], v[104:105] op_sel_hi:[1,0]
v_pk_mul_f32 v[82:83], v[146:147], v[104:105] op_sel_hi:[1,0]
v_pk_mul_f32 v[84:85], v[152:153], v[104:105] op_sel_hi:[1,0]
v_pk_mul_f32 v[86:87], v[154:155], v[104:105] op_sel_hi:[1,0]
v_cvt_pk_bf16_f32 v116, v80, v81
v_cvt_pk_bf16_f32 v117, v82, v83
v_cvt_pk_bf16_f32 v118, v84, v85
v_cvt_pk_bf16_f32 v119, v86, v87
s_add_u32 s29, s28, 0
buffer_store_dwordx4 v[116:119], v12, s[4:7], s29 offen offset:2048 sc1
v_pk_mul_f32 v[80:81], v[148:149], v[104:105] op_sel_hi:[1,0]
v_pk_mul_f32 v[82:83], v[150:151], v[104:105] op_sel_hi:[1,0]
v_pk_mul_f32 v[84:85], v[156:157], v[104:105] op_sel_hi:[1,0]
v_pk_mul_f32 v[86:87], v[158:159], v[104:105] op_sel_hi:[1,0]
v_cvt_pk_bf16_f32 v120, v80, v81
v_cvt_pk_bf16_f32 v121, v82, v83
v_cvt_pk_bf16_f32 v122, v84, v85
v_cvt_pk_bf16_f32 v123, v86, v87
s_add_u32 s29, s28, 0
buffer_store_dwordx4 v[120:123], v12, s[4:7], s29 offen offset:3072 sc1
v_pk_mul_f32 v[80:81], v[160:161], v[104:105] op_sel_hi:[1,0]
v_pk_mul_f32 v[82:83], v[162:163], v[104:105] op_sel_hi:[1,0]
v_pk_mul_f32 v[84:85], v[168:169], v[104:105] op_sel_hi:[1,0]
v_pk_mul_f32 v[86:87], v[170:171], v[104:105] op_sel_hi:[1,0]
v_cvt_pk_bf16_f32 v108, v80, v81
v_cvt_pk_bf16_f32 v109, v82, v83
v_cvt_pk_bf16_f32 v110, v84, v85
v_cvt_pk_bf16_f32 v111, v86, v87
s_add_u32 s29, s28, 4096
buffer_store_dwordx4 v[108:111], v12, s[4:7], s29 offen offset:0 sc1
v_pk_mul_f32 v[80:81], v[164:165], v[104:105] op_sel_hi:[1,0]
v_pk_mul_f32 v[82:83], v[166:167], v[104:105] op_sel_hi:[1,0]
v_pk_mul_f32 v[84:85], v[172:173], v[104:105] op_sel_hi:[1,0]
v_pk_mul_f32 v[86:87], v[174:175], v[104:105] op_sel_hi:[1,0]
v_cvt_pk_bf16_f32 v112, v80, v81
v_cvt_pk_bf16_f32 v113, v82, v83
v_cvt_pk_bf16_f32 v114, v84, v85
v_cvt_pk_bf16_f32 v115, v86, v87
s_add_u32 s29, s28, 4096
buffer_store_dwordx4 v[112:115], v12, s[4:7], s29 offen offset:1024 sc1
v_pk_mul_f32 v[80:81], v[176:177], v[104:105] op_sel_hi:[1,0]
v_pk_mul_f32 v[82:83], v[178:179], v[104:105] op_sel_hi:[1,0]
v_pk_mul_f32 v[84:85], v[184:185], v[104:105] op_sel_hi:[1,0]
v_pk_mul_f32 v[86:87], v[186:187], v[104:105] op_sel_hi:[1,0]
v_cvt_pk_bf16_f32 v116, v80, v81
v_cvt_pk_bf16_f32 v117, v82, v83
v_cvt_pk_bf16_f32 v118, v84, v85
v_cvt_pk_bf16_f32 v119, v86, v87
s_add_u32 s29, s28, 4096
buffer_store_dwordx4 v[116:119], v12, s[4:7], s29 offen offset:2048 sc1
v_pk_mul_f32 v[80:81], v[180:181], v[104:105] op_sel_hi:[1,0]
v_pk_mul_f32 v[82:83], v[182:183], v[104:105] op_sel_hi:[1,0]
v_pk_mul_f32 v[84:85], v[188:189], v[104:105] op_sel_hi:[1,0]
v_pk_mul_f32 v[86:87], v[190:191], v[104:105] op_sel_hi:[1,0]
v_cvt_pk_bf16_f32 v120, v80, v81
v_cvt_pk_bf16_f32 v121, v82, v83
v_cvt_pk_bf16_f32 v122, v84, v85
v_cvt_pk_bf16_f32 v123, v86, v87
s_add_u32 s29, s28, 4096
buffer_store_dwordx4 v[120:123], v12, s[4:7], s29 offen offset:3072 sc1
v_pk_mul_f32 v[80:81], v[192:193], v[104:105] op_sel_hi:[1,0]
v_pk_mul_f32 v[82:83], v[194:195], v[104:105] op_sel_hi:[1,0]
v_pk_mul_f32 v[84:85], v[200:201], v[104:105] op_sel_hi:[1,0]
v_pk_mul_f32 v[86:87], v[202:203], v[104:105] op_sel_hi:[1,0]
v_cvt_pk_bf16_f32 v108, v80, v81
v_cvt_pk_bf16_f32 v109, v82, v83
v_cvt_pk_bf16_f32 v110, v84, v85
v_cvt_pk_bf16_f32 v111, v86, v87
s_add_u32 s29, s28, 8192
buffer_store_dwordx4 v[108:111], v12, s[4:7], s29 offen offset:0 sc1
v_pk_mul_f32 v[80:81], v[196:197], v[104:105] op_sel_hi:[1,0]
v_pk_mul_f32 v[82:83], v[198:199], v[104:105] op_sel_hi:[1,0]
v_pk_mul_f32 v[84:85], v[204:205], v[104:105] op_sel_hi:[1,0]
v_pk_mul_f32 v[86:87], v[206:207], v[104:105] op_sel_hi:[1,0]
v_cvt_pk_bf16_f32 v112, v80, v81
v_cvt_pk_bf16_f32 v113, v82, v83
v_cvt_pk_bf16_f32 v114, v84, v85
v_cvt_pk_bf16_f32 v115, v86, v87
s_add_u32 s29, s28, 8192
buffer_store_dwordx4 v[112:115], v12, s[4:7], s29 offen offset:1024 sc1
v_pk_mul_f32 v[80:81], v[208:209], v[104:105] op_sel_hi:[1,0]
v_pk_mul_f32 v[82:83], v[210:211], v[104:105] op_sel_hi:[1,0]
v_pk_mul_f32 v[84:85], v[216:217], v[104:105] op_sel_hi:[1,0]
v_pk_mul_f32 v[86:87], v[218:219], v[104:105] op_sel_hi:[1,0]
v_cvt_pk_bf16_f32 v116, v80, v81
v_cvt_pk_bf16_f32 v117, v82, v83
v_cvt_pk_bf16_f32 v118, v84, v85
v_cvt_pk_bf16_f32 v119, v86, v87
s_add_u32 s29, s28, 8192
buffer_store_dwordx4 v[116:119], v12, s[4:7], s29 offen offset:2048 sc1
v_pk_mul_f32 v[80:81], v[212:213], v[104:105] op_sel_hi:[1,0]
v_pk_mul_f32 v[82:83], v[214:215], v[104:105] op_sel_hi:[1,0]
v_pk_mul_f32 v[84:85], v[220:221], v[104:105] op_sel_hi:[1,0]
v_pk_mul_f32 v[86:87], v[222:223], v[104:105] op_sel_hi:[1,0]
v_cvt_pk_bf16_f32 v120, v80, v81
v_cvt_pk_bf16_f32 v121, v82, v83
v_cvt_pk_bf16_f32 v122, v84, v85
v_cvt_pk_bf16_f32 v123, v86, v87
s_add_u32 s29, s28, 8192
buffer_store_dwordx4 v[120:123], v12, s[4:7], s29 offen offset:3072 sc1
v_pk_mul_f32 v[80:81], v[224:225], v[104:105] op_sel_hi:[1,0]
v_pk_mul_f32 v[82:83], v[226:227], v[104:105] op_sel_hi:[1,0]
v_pk_mul_f32 v[84:85], v[232:233], v[104:105] op_sel_hi:[1,0]
v_pk_mul_f32 v[86:87], v[234:235], v[104:105] op_sel_hi:[1,0]
v_cvt_pk_bf16_f32 v108, v80, v81
v_cvt_pk_bf16_f32 v109, v82, v83
v_cvt_pk_bf16_f32 v110, v84, v85
v_cvt_pk_bf16_f32 v111, v86, v87
s_add_u32 s29, s28, 12288
buffer_store_dwordx4 v[108:111], v12, s[4:7], s29 offen offset:0 sc1
v_pk_mul_f32 v[80:81], v[228:229], v[104:105] op_sel_hi:[1,0]
v_pk_mul_f32 v[82:83], v[230:231], v[104:105] op_sel_hi:[1,0]
v_pk_mul_f32 v[84:85], v[236:237], v[104:105] op_sel_hi:[1,0]
v_pk_mul_f32 v[86:87], v[238:239], v[104:105] op_sel_hi:[1,0]
v_cvt_pk_bf16_f32 v112, v80, v81
v_cvt_pk_bf16_f32 v113, v82, v83
v_cvt_pk_bf16_f32 v114, v84, v85
v_cvt_pk_bf16_f32 v115, v86, v87
s_add_u32 s29, s28, 12288
buffer_store_dwordx4 v[112:115], v12, s[4:7], s29 offen offset:1024 sc1
v_pk_mul_f32 v[80:81], v[240:241], v[104:105] op_sel_hi:[1,0]
v_pk_mul_f32 v[82:83], v[242:243], v[104:105] op_sel_hi:[1,0]
v_pk_mul_f32 v[84:85], v[248:249], v[104:105] op_sel_hi:[1,0]
v_pk_mul_f32 v[86:87], v[250:251], v[104:105] op_sel_hi:[1,0]
v_cvt_pk_bf16_f32 v116, v80, v81
v_cvt_pk_bf16_f32 v117, v82, v83
v_cvt_pk_bf16_f32 v118, v84, v85
v_cvt_pk_bf16_f32 v119, v86, v87
s_add_u32 s29, s28, 12288
buffer_store_dwordx4 v[116:119], v12, s[4:7], s29 offen offset:2048 sc1
v_pk_mul_f32 v[80:81], v[244:245], v[104:105] op_sel_hi:[1,0]
v_pk_mul_f32 v[82:83], v[246:247], v[104:105] op_sel_hi:[1,0]
v_pk_mul_f32 v[84:85], v[252:253], v[104:105] op_sel_hi:[1,0]
v_pk_mul_f32 v[86:87], v[254:255], v[104:105] op_sel_hi:[1,0]
v_cvt_pk_bf16_f32 v120, v80, v81
v_cvt_pk_bf16_f32 v121, v82, v83
v_cvt_pk_bf16_f32 v122, v84, v85
v_cvt_pk_bf16_f32 v123, v86, v87
s_add_u32 s29, s28, 12288
buffer_store_dwordx4 v[120:123], v12, s[4:7], s29 offen offset:3072 sc1
v_mov_b32 v80, v5
v_mov_b32 v81, v14
s_lshl_b32 s28, s37, 11
s_lshl_b32 s29, s3, 9
s_add_u32 s28, s28, s29
s_add_u32 s28, s28, 0x5a00000
v_lshlrev_b32 v82, 3, v1
buffer_store_dwordx2 v[80:81], v82, s[4:7], s28 offen sc1
s_branch fused_kernel_fin
fused_kernel_merge:
s_waitcnt vmcnt(16)
v_max_f32 v104, v5, v92
v_sub_f32 v105, v5, v104
v_sub_f32 v106, v92, v104
v_exp_f32 v105, v105
v_exp_f32 v106, v106
s_nop 0
v_mul_f32 v106, v106, v93
v_fma_f32 v104, v14, v105, v106
v_rcp_f32 v104, v104
s_nop 0
v_mul_f32 v2, v106, v104
v_mul_f32 v106, v105, v104
s_lshl_b32 s28, s22, 3
s_lshl_b32 s29, s3, 1
s_add_u32 s28, s28, s29
s_mul_i32 s28, s28, 184
s_lshl_b32 s29, s8, 3
s_add_u32 s28, s28, s29
s_lshl_b32 s28, s28, 10
s_add_u32 s28, s28, 0x3200000
s_waitcnt vmcnt(15)
v_lshlrev_b32 v88, 16, v16
v_and_b32 v89, 0xffff0000, v16
v_lshlrev_b32 v90, 16, v17
v_and_b32 v91, 0xffff0000, v17
v_lshlrev_b32 v92, 16, v18
v_and_b32 v93, 0xffff0000, v18
v_lshlrev_b32 v94, 16, v19
v_and_b32 v95, 0xffff0000, v19
v_pk_mul_f32 v[80:81], v[128:129], v[106:107] op_sel_hi:[1,0]
v_pk_fma_f32 v[80:81], v[88:89], v[2:3], v[80:81] op_sel_hi:[1,0,1]
v_pk_mul_f32 v[82:83], v[130:131], v[106:107] op_sel_hi:[1,0]
v_pk_fma_f32 v[82:83], v[90:91], v[2:3], v[82:83] op_sel_hi:[1,0,1]
v_pk_mul_f32 v[84:85], v[136:137], v[106:107] op_sel_hi:[1,0]
v_pk_fma_f32 v[84:85], v[92:93], v[2:3], v[84:85] op_sel_hi:[1,0,1]
v_pk_mul_f32 v[86:87], v[138:139], v[106:107] op_sel_hi:[1,0]
v_pk_fma_f32 v[86:87], v[94:95], v[2:3], v[86:87] op_sel_hi:[1,0,1]
v_cvt_pk_bf16_f32 v108, v80, v81
v_cvt_pk_bf16_f32 v109, v82, v83
v_cvt_pk_bf16_f32 v110, v84, v85
v_cvt_pk_bf16_f32 v111, v86, v87
s_add_u32 s29, s28, 0
buffer_store_dwordx4 v[108:111], v11, s[4:7], s29 offen offset:0 sc1
s_waitcnt vmcnt(15)
v_lshlrev_b32 v88, 16, v20
v_and_b32 v89, 0xffff0000, v20
v_lshlrev_b32 v90, 16, v21
v_and_b32 v91, 0xffff0000, v21
v_lshlrev_b32 v92, 16, v22
v_and_b32 v93, 0xffff0000, v22
v_lshlrev_b32 v94, 16, v23
v_and_b32 v95, 0xffff0000, v23
v_pk_mul_f32 v[80:81], v[132:133], v[106:107] op_sel_hi:[1,0]
v_pk_fma_f32 v[80:81], v[88:89], v[2:3], v[80:81] op_sel_hi:[1,0,1]
v_pk_mul_f32 v[82:83], v[134:135], v[106:107] op_sel_hi:[1,0]
v_pk_fma_f32 v[82:83], v[90:91], v[2:3], v[82:83] op_sel_hi:[1,0,1]
v_pk_mul_f32 v[84:85], v[140:141], v[106:107] op_sel_hi:[1,0]
v_pk_fma_f32 v[84:85], v[92:93], v[2:3], v[84:85] op_sel_hi:[1,0,1]
v_pk_mul_f32 v[86:87], v[142:143], v[106:107] op_sel_hi:[1,0]
v_pk_fma_f32 v[86:87], v[94:95], v[2:3], v[86:87] op_sel_hi:[1,0,1]
v_cvt_pk_bf16_f32 v112, v80, v81
v_cvt_pk_bf16_f32 v113, v82, v83
v_cvt_pk_bf16_f32 v114, v84, v85
v_cvt_pk_bf16_f32 v115, v86, v87
s_add_u32 s29, s28, 0
buffer_store_dwordx4 v[112:115], v11, s[4:7], s29 offen offset:512 sc1
s_waitcnt vmcnt(15)
v_lshlrev_b32 v88, 16, v24
v_and_b32 v89, 0xffff0000, v24
v_lshlrev_b32 v90, 16, v25
v_and_b32 v91, 0xffff0000, v25
v_lshlrev_b32 v92, 16, v26
v_and_b32 v93, 0xffff0000, v26
v_lshlrev_b32 v94, 16, v27
v_and_b32 v95, 0xffff0000, v27
v_pk_mul_f32 v[80:81], v[144:145], v[106:107] op_sel_hi:[1,0]
v_pk_fma_f32 v[80:81], v[88:89], v[2:3], v[80:81] op_sel_hi:[1,0,1]
v_pk_mul_f32 v[82:83], v[146:147], v[106:107] op_sel_hi:[1,0]
v_pk_fma_f32 v[82:83], v[90:91], v[2:3], v[82:83] op_sel_hi:[1,0,1]
v_pk_mul_f32 v[84:85], v[152:153], v[106:107] op_sel_hi:[1,0]
v_pk_fma_f32 v[84:85], v[92:93], v[2:3], v[84:85] op_sel_hi:[1,0,1]
v_pk_mul_f32 v[86:87], v[154:155], v[106:107] op_sel_hi:[1,0]
v_pk_fma_f32 v[86:87], v[94:95], v[2:3], v[86:87] op_sel_hi:[1,0,1]
v_cvt_pk_bf16_f32 v116, v80, v81
v_cvt_pk_bf16_f32 v117, v82, v83
v_cvt_pk_bf16_f32 v118, v84, v85
v_cvt_pk_bf16_f32 v119, v86, v87
s_add_u32 s29, s28, 1024
buffer_store_dwordx4 v[116:119], v11, s[4:7], s29 offen offset:0 sc1
s_waitcnt vmcnt(15)
v_lshlrev_b32 v88, 16, v28
v_and_b32 v89, 0xffff0000, v28
v_lshlrev_b32 v90, 16, v29
v_and_b32 v91, 0xffff0000, v29
v_lshlrev_b32 v92, 16, v30
v_and_b32 v93, 0xffff0000, v30
v_lshlrev_b32 v94, 16, v31
v_and_b32 v95, 0xffff0000, v31
v_pk_mul_f32 v[80:81], v[148:149], v[106:107] op_sel_hi:[1,0]
v_pk_fma_f32 v[80:81], v[88:89], v[2:3], v[80:81] op_sel_hi:[1,0,1]
v_pk_mul_f32 v[82:83], v[150:151], v[106:107] op_sel_hi:[1,0]
v_pk_fma_f32 v[82:83], v[90:91], v[2:3], v[82:83] op_sel_hi:[1,0,1]
v_pk_mul_f32 v[84:85], v[156:157], v[106:107] op_sel_hi:[1,0]
v_pk_fma_f32 v[84:85], v[92:93], v[2:3], v[84:85] op_sel_hi:[1,0,1]
v_pk_mul_f32 v[86:87], v[158:159], v[106:107] op_sel_hi:[1,0]
v_pk_fma_f32 v[86:87], v[94:95], v[2:3], v[86:87] op_sel_hi:[1,0,1]
v_cvt_pk_bf16_f32 v120, v80, v81
v_cvt_pk_bf16_f32 v121, v82, v83
v_cvt_pk_bf16_f32 v122, v84, v85
v_cvt_pk_bf16_f32 v123, v86, v87
s_add_u32 s29, s28, 1024
buffer_store_dwordx4 v[120:123], v11, s[4:7], s29 offen offset:512 sc1
s_waitcnt vmcnt(15)
v_lshlrev_b32 v88, 16, v32
v_and_b32 v89, 0xffff0000, v32
v_lshlrev_b32 v90, 16, v33
v_and_b32 v91, 0xffff0000, v33
v_lshlrev_b32 v92, 16, v34
v_and_b32 v93, 0xffff0000, v34
v_lshlrev_b32 v94, 16, v35
v_and_b32 v95, 0xffff0000, v35
v_pk_mul_f32 v[80:81], v[160:161], v[106:107] op_sel_hi:[1,0]
v_pk_fma_f32 v[80:81], v[88:89], v[2:3], v[80:81] op_sel_hi:[1,0,1]
v_pk_mul_f32 v[82:83], v[162:163], v[106:107] op_sel_hi:[1,0]
v_pk_fma_f32 v[82:83], v[90:91], v[2:3], v[82:83] op_sel_hi:[1,0,1]
v_pk_mul_f32 v[84:85], v[168:169], v[106:107] op_sel_hi:[1,0]
v_pk_fma_f32 v[84:85], v[92:93], v[2:3], v[84:85] op_sel_hi:[1,0,1]
v_pk_mul_f32 v[86:87], v[170:171], v[106:107] op_sel_hi:[1,0]
v_pk_fma_f32 v[86:87], v[94:95], v[2:3], v[86:87] op_sel_hi:[1,0,1]
v_cvt_pk_bf16_f32 v108, v80, v81
v_cvt_pk_bf16_f32 v109, v82, v83
v_cvt_pk_bf16_f32 v110, v84, v85
v_cvt_pk_bf16_f32 v111, v86, v87
s_add_u32 s29, s28, 2048
buffer_store_dwordx4 v[108:111], v11, s[4:7], s29 offen offset:0 sc1
s_waitcnt vmcnt(15)
v_lshlrev_b32 v88, 16, v36
v_and_b32 v89, 0xffff0000, v36
v_lshlrev_b32 v90, 16, v37
v_and_b32 v91, 0xffff0000, v37
v_lshlrev_b32 v92, 16, v38
v_and_b32 v93, 0xffff0000, v38
v_lshlrev_b32 v94, 16, v39
v_and_b32 v95, 0xffff0000, v39
v_pk_mul_f32 v[80:81], v[164:165], v[106:107] op_sel_hi:[1,0]
v_pk_fma_f32 v[80:81], v[88:89], v[2:3], v[80:81] op_sel_hi:[1,0,1]
v_pk_mul_f32 v[82:83], v[166:167], v[106:107] op_sel_hi:[1,0]
v_pk_fma_f32 v[82:83], v[90:91], v[2:3], v[82:83] op_sel_hi:[1,0,1]
v_pk_mul_f32 v[84:85], v[172:173], v[106:107] op_sel_hi:[1,0]
v_pk_fma_f32 v[84:85], v[92:93], v[2:3], v[84:85] op_sel_hi:[1,0,1]
v_pk_mul_f32 v[86:87], v[174:175], v[106:107] op_sel_hi:[1,0]
v_pk_fma_f32 v[86:87], v[94:95], v[2:3], v[86:87] op_sel_hi:[1,0,1]
v_cvt_pk_bf16_f32 v112, v80, v81
v_cvt_pk_bf16_f32 v113, v82, v83
v_cvt_pk_bf16_f32 v114, v84, v85
v_cvt_pk_bf16_f32 v115, v86, v87
s_add_u32 s29, s28, 2048
buffer_store_dwordx4 v[112:115], v11, s[4:7], s29 offen offset:512 sc1
s_waitcnt vmcnt(15)
v_lshlrev_b32 v88, 16, v40
v_and_b32 v89, 0xffff0000, v40
v_lshlrev_b32 v90, 16, v41
v_and_b32 v91, 0xffff0000, v41
v_lshlrev_b32 v92, 16, v42
v_and_b32 v93, 0xffff0000, v42
v_lshlrev_b32 v94, 16, v43
v_and_b32 v95, 0xffff0000, v43
v_pk_mul_f32 v[80:81], v[176:177], v[106:107] op_sel_hi:[1,0]
v_pk_fma_f32 v[80:81], v[88:89], v[2:3], v[80:81] op_sel_hi:[1,0,1]
v_pk_mul_f32 v[82:83], v[178:179], v[106:107] op_sel_hi:[1,0]
v_pk_fma_f32 v[82:83], v[90:91], v[2:3], v[82:83] op_sel_hi:[1,0,1]
v_pk_mul_f32 v[84:85], v[184:185], v[106:107] op_sel_hi:[1,0]
v_pk_fma_f32 v[84:85], v[92:93], v[2:3], v[84:85] op_sel_hi:[1,0,1]
v_pk_mul_f32 v[86:87], v[186:187], v[106:107] op_sel_hi:[1,0]
v_pk_fma_f32 v[86:87], v[94:95], v[2:3], v[86:87] op_sel_hi:[1,0,1]
v_cvt_pk_bf16_f32 v116, v80, v81
v_cvt_pk_bf16_f32 v117, v82, v83
v_cvt_pk_bf16_f32 v118, v84, v85
v_cvt_pk_bf16_f32 v119, v86, v87
s_add_u32 s29, s28, 3072
buffer_store_dwordx4 v[116:119], v11, s[4:7], s29 offen offset:0 sc1
s_waitcnt vmcnt(15)
v_lshlrev_b32 v88, 16, v44
v_and_b32 v89, 0xffff0000, v44
v_lshlrev_b32 v90, 16, v45
v_and_b32 v91, 0xffff0000, v45
v_lshlrev_b32 v92, 16, v46
v_and_b32 v93, 0xffff0000, v46
v_lshlrev_b32 v94, 16, v47
v_and_b32 v95, 0xffff0000, v47
v_pk_mul_f32 v[80:81], v[180:181], v[106:107] op_sel_hi:[1,0]
v_pk_fma_f32 v[80:81], v[88:89], v[2:3], v[80:81] op_sel_hi:[1,0,1]
v_pk_mul_f32 v[82:83], v[182:183], v[106:107] op_sel_hi:[1,0]
v_pk_fma_f32 v[82:83], v[90:91], v[2:3], v[82:83] op_sel_hi:[1,0,1]
v_pk_mul_f32 v[84:85], v[188:189], v[106:107] op_sel_hi:[1,0]
v_pk_fma_f32 v[84:85], v[92:93], v[2:3], v[84:85] op_sel_hi:[1,0,1]
v_pk_mul_f32 v[86:87], v[190:191], v[106:107] op_sel_hi:[1,0]
v_pk_fma_f32 v[86:87], v[94:95], v[2:3], v[86:87] op_sel_hi:[1,0,1]
v_cvt_pk_bf16_f32 v120, v80, v81
v_cvt_pk_bf16_f32 v121, v82, v83
v_cvt_pk_bf16_f32 v122, v84, v85
v_cvt_pk_bf16_f32 v123, v86, v87
s_add_u32 s29, s28, 3072
buffer_store_dwordx4 v[120:123], v11, s[4:7], s29 offen offset:512 sc1
s_waitcnt vmcnt(15)
v_lshlrev_b32 v88, 16, v48
v_and_b32 v89, 0xffff0000, v48
v_lshlrev_b32 v90, 16, v49
v_and_b32 v91, 0xffff0000, v49
v_lshlrev_b32 v92, 16, v50
v_and_b32 v93, 0xffff0000, v50
v_lshlrev_b32 v94, 16, v51
v_and_b32 v95, 0xffff0000, v51
v_pk_mul_f32 v[80:81], v[192:193], v[106:107] op_sel_hi:[1,0]
v_pk_fma_f32 v[80:81], v[88:89], v[2:3], v[80:81] op_sel_hi:[1,0,1]
v_pk_mul_f32 v[82:83], v[194:195], v[106:107] op_sel_hi:[1,0]
v_pk_fma_f32 v[82:83], v[90:91], v[2:3], v[82:83] op_sel_hi:[1,0,1]
v_pk_mul_f32 v[84:85], v[200:201], v[106:107] op_sel_hi:[1,0]
v_pk_fma_f32 v[84:85], v[92:93], v[2:3], v[84:85] op_sel_hi:[1,0,1]
v_pk_mul_f32 v[86:87], v[202:203], v[106:107] op_sel_hi:[1,0]
v_pk_fma_f32 v[86:87], v[94:95], v[2:3], v[86:87] op_sel_hi:[1,0,1]
v_cvt_pk_bf16_f32 v108, v80, v81
v_cvt_pk_bf16_f32 v109, v82, v83
v_cvt_pk_bf16_f32 v110, v84, v85
v_cvt_pk_bf16_f32 v111, v86, v87
s_add_u32 s29, s28, 4096
buffer_store_dwordx4 v[108:111], v11, s[4:7], s29 offen offset:0 sc1
s_waitcnt vmcnt(15)
v_lshlrev_b32 v88, 16, v52
v_and_b32 v89, 0xffff0000, v52
v_lshlrev_b32 v90, 16, v53
v_and_b32 v91, 0xffff0000, v53
v_lshlrev_b32 v92, 16, v54
v_and_b32 v93, 0xffff0000, v54
v_lshlrev_b32 v94, 16, v55
v_and_b32 v95, 0xffff0000, v55
v_pk_mul_f32 v[80:81], v[196:197], v[106:107] op_sel_hi:[1,0]
v_pk_fma_f32 v[80:81], v[88:89], v[2:3], v[80:81] op_sel_hi:[1,0,1]
v_pk_mul_f32 v[82:83], v[198:199], v[106:107] op_sel_hi:[1,0]
v_pk_fma_f32 v[82:83], v[90:91], v[2:3], v[82:83] op_sel_hi:[1,0,1]
v_pk_mul_f32 v[84:85], v[204:205], v[106:107] op_sel_hi:[1,0]
v_pk_fma_f32 v[84:85], v[92:93], v[2:3], v[84:85] op_sel_hi:[1,0,1]
v_pk_mul_f32 v[86:87], v[206:207], v[106:107] op_sel_hi:[1,0]
v_pk_fma_f32 v[86:87], v[94:95], v[2:3], v[86:87] op_sel_hi:[1,0,1]
v_cvt_pk_bf16_f32 v112, v80, v81
v_cvt_pk_bf16_f32 v113, v82, v83
v_cvt_pk_bf16_f32 v114, v84, v85
v_cvt_pk_bf16_f32 v115, v86, v87
s_add_u32 s29, s28, 4096
buffer_store_dwordx4 v[112:115], v11, s[4:7], s29 offen offset:512 sc1
s_waitcnt vmcnt(15)
v_lshlrev_b32 v88, 16, v64
v_and_b32 v89, 0xffff0000, v64
v_lshlrev_b32 v90, 16, v65
v_and_b32 v91, 0xffff0000, v65
v_lshlrev_b32 v92, 16, v66
v_and_b32 v93, 0xffff0000, v66
v_lshlrev_b32 v94, 16, v67
v_and_b32 v95, 0xffff0000, v67
v_pk_mul_f32 v[80:81], v[208:209], v[106:107] op_sel_hi:[1,0]
v_pk_fma_f32 v[80:81], v[88:89], v[2:3], v[80:81] op_sel_hi:[1,0,1]
v_pk_mul_f32 v[82:83], v[210:211], v[106:107] op_sel_hi:[1,0]
v_pk_fma_f32 v[82:83], v[90:91], v[2:3], v[82:83] op_sel_hi:[1,0,1]
v_pk_mul_f32 v[84:85], v[216:217], v[106:107] op_sel_hi:[1,0]
v_pk_fma_f32 v[84:85], v[92:93], v[2:3], v[84:85] op_sel_hi:[1,0,1]
v_pk_mul_f32 v[86:87], v[218:219], v[106:107] op_sel_hi:[1,0]
v_pk_fma_f32 v[86:87], v[94:95], v[2:3], v[86:87] op_sel_hi:[1,0,1]
v_cvt_pk_bf16_f32 v116, v80, v81
v_cvt_pk_bf16_f32 v117, v82, v83
v_cvt_pk_bf16_f32 v118, v84, v85
v_cvt_pk_bf16_f32 v119, v86, v87
s_add_u32 s29, s28, 5120
buffer_store_dwordx4 v[116:119], v11, s[4:7], s29 offen offset:0 sc1
s_waitcnt vmcnt(15)
v_lshlrev_b32 v88, 16, v68
v_and_b32 v89, 0xffff0000, v68
v_lshlrev_b32 v90, 16, v69
v_and_b32 v91, 0xffff0000, v69
v_lshlrev_b32 v92, 16, v70
v_and_b32 v93, 0xffff0000, v70
v_lshlrev_b32 v94, 16, v71
v_and_b32 v95, 0xffff0000, v71
v_pk_mul_f32 v[80:81], v[212:213], v[106:107] op_sel_hi:[1,0]
v_pk_fma_f32 v[80:81], v[88:89], v[2:3], v[80:81] op_sel_hi:[1,0,1]
v_pk_mul_f32 v[82:83], v[214:215], v[106:107] op_sel_hi:[1,0]
v_pk_fma_f32 v[82:83], v[90:91], v[2:3], v[82:83] op_sel_hi:[1,0,1]
v_pk_mul_f32 v[84:85], v[220:221], v[106:107] op_sel_hi:[1,0]
v_pk_fma_f32 v[84:85], v[92:93], v[2:3], v[84:85] op_sel_hi:[1,0,1]
v_pk_mul_f32 v[86:87], v[222:223], v[106:107] op_sel_hi:[1,0]
v_pk_fma_f32 v[86:87], v[94:95], v[2:3], v[86:87] op_sel_hi:[1,0,1]
v_cvt_pk_bf16_f32 v120, v80, v81
v_cvt_pk_bf16_f32 v121, v82, v83
v_cvt_pk_bf16_f32 v122, v84, v85
v_cvt_pk_bf16_f32 v123, v86, v87
s_add_u32 s29, s28, 5120
buffer_store_dwordx4 v[120:123], v11, s[4:7], s29 offen offset:512 sc1
s_waitcnt vmcnt(15)
v_lshlrev_b32 v88, 16, v72
v_and_b32 v89, 0xffff0000, v72
v_lshlrev_b32 v90, 16, v73
v_and_b32 v91, 0xffff0000, v73
v_lshlrev_b32 v92, 16, v74
v_and_b32 v93, 0xffff0000, v74
v_lshlrev_b32 v94, 16, v75
v_and_b32 v95, 0xffff0000, v75
v_pk_mul_f32 v[80:81], v[224:225], v[106:107] op_sel_hi:[1,0]
v_pk_fma_f32 v[80:81], v[88:89], v[2:3], v[80:81] op_sel_hi:[1,0,1]
v_pk_mul_f32 v[82:83], v[226:227], v[106:107] op_sel_hi:[1,0]
v_pk_fma_f32 v[82:83], v[90:91], v[2:3], v[82:83] op_sel_hi:[1,0,1]
v_pk_mul_f32 v[84:85], v[232:233], v[106:107] op_sel_hi:[1,0]
v_pk_fma_f32 v[84:85], v[92:93], v[2:3], v[84:85] op_sel_hi:[1,0,1]
v_pk_mul_f32 v[86:87], v[234:235], v[106:107] op_sel_hi:[1,0]
v_pk_fma_f32 v[86:87], v[94:95], v[2:3], v[86:87] op_sel_hi:[1,0,1]
v_cvt_pk_bf16_f32 v108, v80, v81
v_cvt_pk_bf16_f32 v109, v82, v83
v_cvt_pk_bf16_f32 v110, v84, v85
v_cvt_pk_bf16_f32 v111, v86, v87
s_add_u32 s29, s28, 6144
buffer_store_dwordx4 v[108:111], v11, s[4:7], s29 offen offset:0 sc1
s_waitcnt vmcnt(15)
v_lshlrev_b32 v88, 16, v76
v_and_b32 v89, 0xffff0000, v76
v_lshlrev_b32 v90, 16, v77
v_and_b32 v91, 0xffff0000, v77
v_lshlrev_b32 v92, 16, v78
v_and_b32 v93, 0xffff0000, v78
v_lshlrev_b32 v94, 16, v79
v_and_b32 v95, 0xffff0000, v79
v_pk_mul_f32 v[80:81], v[228:229], v[106:107] op_sel_hi:[1,0]
v_pk_fma_f32 v[80:81], v[88:89], v[2:3], v[80:81] op_sel_hi:[1,0,1]
v_pk_mul_f32 v[82:83], v[230:231], v[106:107] op_sel_hi:[1,0]
v_pk_fma_f32 v[82:83], v[90:91], v[2:3], v[82:83] op_sel_hi:[1,0,1]
v_pk_mul_f32 v[84:85], v[236:237], v[106:107] op_sel_hi:[1,0]
v_pk_fma_f32 v[84:85], v[92:93], v[2:3], v[84:85] op_sel_hi:[1,0,1]
v_pk_mul_f32 v[86:87], v[238:239], v[106:107] op_sel_hi:[1,0]
v_pk_fma_f32 v[86:87], v[94:95], v[2:3], v[86:87] op_sel_hi:[1,0,1]
v_cvt_pk_bf16_f32 v112, v80, v81
v_cvt_pk_bf16_f32 v113, v82, v83
v_cvt_pk_bf16_f32 v114, v84, v85
v_cvt_pk_bf16_f32 v115, v86, v87
s_add_u32 s29, s28, 6144
buffer_store_dwordx4 v[112:115], v11, s[4:7], s29 offen offset:512 sc1
s_waitcnt vmcnt(15)
v_lshlrev_b32 v88, 16, v96
v_and_b32 v89, 0xffff0000, v96
v_lshlrev_b32 v90, 16, v97
v_and_b32 v91, 0xffff0000, v97
v_lshlrev_b32 v92, 16, v98
v_and_b32 v93, 0xffff0000, v98
v_lshlrev_b32 v94, 16, v99
v_and_b32 v95, 0xffff0000, v99
v_pk_mul_f32 v[80:81], v[240:241], v[106:107] op_sel_hi:[1,0]
v_pk_fma_f32 v[80:81], v[88:89], v[2:3], v[80:81] op_sel_hi:[1,0,1]
v_pk_mul_f32 v[82:83], v[242:243], v[106:107] op_sel_hi:[1,0]
v_pk_fma_f32 v[82:83], v[90:91], v[2:3], v[82:83] op_sel_hi:[1,0,1]
v_pk_mul_f32 v[84:85], v[248:249], v[106:107] op_sel_hi:[1,0]
v_pk_fma_f32 v[84:85], v[92:93], v[2:3], v[84:85] op_sel_hi:[1,0,1]
v_pk_mul_f32 v[86:87], v[250:251], v[106:107] op_sel_hi:[1,0]
v_pk_fma_f32 v[86:87], v[94:95], v[2:3], v[86:87] op_sel_hi:[1,0,1]
v_cvt_pk_bf16_f32 v116, v80, v81
v_cvt_pk_bf16_f32 v117, v82, v83
v_cvt_pk_bf16_f32 v118, v84, v85
v_cvt_pk_bf16_f32 v119, v86, v87
s_add_u32 s29, s28, 7168
buffer_store_dwordx4 v[116:119], v11, s[4:7], s29 offen offset:0 sc1
s_waitcnt vmcnt(15)
v_lshlrev_b32 v88, 16, v100
v_and_b32 v89, 0xffff0000, v100
v_lshlrev_b32 v90, 16, v101
v_and_b32 v91, 0xffff0000, v101
v_lshlrev_b32 v92, 16, v102
v_and_b32 v93, 0xffff0000, v102
v_lshlrev_b32 v94, 16, v103
v_and_b32 v95, 0xffff0000, v103
v_pk_mul_f32 v[80:81], v[244:245], v[106:107] op_sel_hi:[1,0]
v_pk_fma_f32 v[80:81], v[88:89], v[2:3], v[80:81] op_sel_hi:[1,0,1]
v_pk_mul_f32 v[82:83], v[246:247], v[106:107] op_sel_hi:[1,0]
v_pk_fma_f32 v[82:83], v[90:91], v[2:3], v[82:83] op_sel_hi:[1,0,1]
v_pk_mul_f32 v[84:85], v[252:253], v[106:107] op_sel_hi:[1,0]
v_pk_fma_f32 v[84:85], v[92:93], v[2:3], v[84:85] op_sel_hi:[1,0,1]
v_pk_mul_f32 v[86:87], v[254:255], v[106:107] op_sel_hi:[1,0]
v_pk_fma_f32 v[86:87], v[94:95], v[2:3], v[86:87] op_sel_hi:[1,0,1]
v_cvt_pk_bf16_f32 v120, v80, v81
v_cvt_pk_bf16_f32 v121, v82, v83
v_cvt_pk_bf16_f32 v122, v84, v85
v_cvt_pk_bf16_f32 v123, v86, v87
s_add_u32 s29, s28, 7168
buffer_store_dwordx4 v[120:123], v11, s[4:7], s29 offen offset:512 sc1
fused_kernel_fin:
s_mov_b32 s67, 0x80000
fused_kernel_epoll_79:
v_readlane_b32 s66, v127, 1
v_readlane_b32 s68, v127, 2
s_sub_u32 s67, s67, 1
s_cmp_eq_u32 s67, 0
s_cbranch_scc1 fused_kernel_eok_78
s_cmp_ge_u32 s66, 128
s_cselect_b32 s68, s68, 0
s_cmp_ge_u32 s68, 56
s_cbranch_scc1 fused_kernel_eok_78
s_sleep 2
buffer_load_dword v127, v126, s[4:7], 0 offen sc1
s_waitcnt vmcnt(0)
s_branch fused_kernel_epoll_79
fused_kernel_eok_78:
s_waitcnt lgkmcnt(0)
s_barrier
s_and_b32 s55, s2, 7
s_lshr_b32 s56, s2, 3
s_lshr_b32 s50, s55, 1
s_and_b32 s57, s56, 1
s_lshl_b32 s57, s57, 3
s_and_b32 s58, s55, 1
s_lshl_b32 s58, s58, 2
s_add_u32 s57, s57, s58
s_lshr_b32 s58, s56, 3
s_add_u32 s51, s57, s58
s_bfe_u32 s52, s56, 0x20001
s_lshl_b32 s53, s51, 2
s_add_u32 s53, s53, s52
s_mov_b32 s40, s92
s_and_b32 s41, s93, 0xffff
s_mov_b32 s42, 0x1c0000
s_mov_b32 s43, 0x20000
s_mov_b32 s44, s72
s_and_b32 s45, s73, 0xffff
s_mov_b32 s46, 0x1c0000
s_mov_b32 s47, 0x20000
s_mul_i32 s55, s52, 7
s_lshl_b32 s56, s3, 1
s_add_u32 s55, s55, s56
s_lshl_b32 s55, s55, 10
s_add_u32 s55, s55, 0x6c00000
s_mul_i32 s56, s50, 401408
s_add_u32 s60, s55, s56
s_mul_i32 s56, s50, 917504
s_add_u32 s61, s55, s56
s_add_u32 s62, s60, 1024
s_add_u32 s63, s61, 1024
s_cmp_eq_u32 s3, 3
s_cselect_b32 s62, 0x70000000, s62
s_cselect_b32 s63, 0x70000000, s63
s_lshl_b32 s54, s3, 11
s_lshl_b32 s55, s51, 3
s_lshl_b32 s56, s3, 1
s_add_u32 s55, s55, s56
s_mul_i32 s55, s55, 184
s_lshl_b32 s55, s55, 10
s_add_u32 s55, s55, 0x3200000
s_mul_i32 s56, s50, 14336
s_add_u32 s64, s55, s56
s_lshl_b32 s56, s50, 15
s_add_u32 s65, s55, s56
v_and_b32 v3, 15, v1
v_lshrrev_b32 v4, 4, v1
s_movk_i32 s55, 896
v_mul_lo_u32 v3, v3, s55
v_lshl_add_u32 v4, v4, 3, v3
s_lshl_b32 s55, s51, 7
s_lshl_b32 s56, s3, 5
s_add_u32 s55, s55, s56
s_mul_i32 s55, s55, 896
s_mul_i32 s56, s52, 224
s_add_u32 s59, s55, s56
s_add_u32 m0, s54, 0
s_add_u32 s55, s60, 3670016
buffer_load_dwordx4 v12, s[4:7], s55 offen lds
s_add_u32 m0, s54, 1024
s_add_u32 s55, s62, 3670016
buffer_load_dwordx4 v12, s[4:7], s55 offen lds
s_add_u32 m0, s54, 8192
s_add_u32 s55, s60, 3698688
buffer_load_dwordx4 v12, s[4:7], s55 offen lds
s_add_u32 m0, s54, 9216
s_add_u32 s55, s62, 3698688
buffer_load_dwordx4 v12, s[4:7], s55 offen lds
s_add_u32 m0, s54, 16384
s_add_u32 s55, s60, 3727360
buffer_load_dwordx4 v12, s[4:7], s55 offen lds
s_add_u32 m0, s54, 17408
s_add_u32 s55, s62, 3727360
buffer_load_dwordx4 v12, s[4:7], s55 offen lds
s_add_u32 m0, s54, 24576
s_add_u32 s55, s60, 3756032
buffer_load_dwordx4 v12, s[4:7], s55 offen lds
s_add_u32 m0, s54, 25600
s_add_u32 s55, s62, 3756032
buffer_load_dwordx4 v12, s[4:7], s55 offen lds
s_add_u32 s56, s64, 131072
buffer_load_dwordx4 a[96:99], v12, s[4:7], s56 offen
s_add_u32 s56, s64, 319488
buffer_load_dwordx4 a[100:103], v12, s[4:7], s56 offen
s_add_u32 s56, s64, 132096
buffer_load_dwordx4 a[104:107], v12, s[4:7], s56 offen
s_add_u32 s56, s64, 320512
buffer_load_dwordx4 a[108:111], v12, s[4:7], s56 offen
s_add_u32 s56, s64, 133120
buffer_load_dwordx4 a[112:115], v12, s[4:7], s56 offen
s_add_u32 s56, s64, 321536
buffer_load_dwordx4 a[116:119], v12, s[4:7], s56 offen
s_add_u32 s56, s64, 134144
buffer_load_dwordx4 a[120:123], v12, s[4:7], s56 offen
s_add_u32 s56, s64, 322560
buffer_load_dwordx4 a[124:127], v12, s[4:7], s56 offen
s_waitcnt vmcnt(16)
s_barrier
s_cmp_eq_u32 s32, 1
s_cbranch_scc0 fused_kernel_pubc_80
s_add_u32 s66, s37, 160
s_branch fused_kernel_pubd_81
fused_kernel_pubc_80:
s_lshl_b32 s66, s22, 2
s_lshr_b32 s67, s8, 2
s_add_u32 s66, s66, s67
s_add_u32 s66, s66, 288
fused_kernel_pubd_81:
s_cmp_lg_u32 s3, 0
s_cbranch_scc1 fused_kernel_pub_82
s_lshl_b32 s68, s66, 7
s_add_u32 s68, s68, 0x5b00000
v_mov_b32 v80, 1
v_mov_b32 v81, 0
s_mov_b64 s[70:71], exec
s_mov_b64 exec, 1
buffer_atomic_add v80, v81, s[4:7], s68 offen
s_mov_b64 exec, s[70:71]
fused_kernel_pub_82:
fused_kernel_ecode:
s_mov_b32 s40, s92
s_and_b32 s41, s93, 0xffff
s_mov_b32 s42, 0x1c0000
s_mov_b32 s43, 0x20000
s_mov_b32 s44, s72
s_and_b32 s45, s73, 0xffff
s_mov_b32 s46, 0x1c0000
s_mov_b32 s47, 0x20000
v_mov_b32 v5, v4
v_mov_b32 v3, v12
v_add_u32 v4, 0x10000, v12
s_waitcnt vmcnt(4)
s_barrier
ds_read_b128 v[72:75], v3 offset:0
ds_read_b128 v[76:79], v3 offset:1024
ds_read_b128 v[80:83], v3 offset:2048
ds_read_b128 v[84:87], v3 offset:3072
ds_read_b128 v[88:91], v3 offset:4096
ds_read_b128 v[92:95], v3 offset:5120
ds_read_b128 v[96:99], v3 offset:6144
s_waitcnt lgkmcnt(0)
v_mfma_f32_16x16x32_bf16 v[16:19], v[72:75], a[96:99], 0
ds_read_b128 v[100:103], v3 offset:8192
s_add_u32 s56, s64, 135168
buffer_load_dwordx4 a[128:131], v12, s[4:7], s56 offen
s_add_u32 s56, s64, 323584
v_mfma_f32_16x16x32_bf16 v[44:47], v[72:75], a[100:103], 0
ds_read_b128 v[104:107], v3 offset:9216
buffer_load_dwordx4 a[132:135], v12, s[4:7], s56 offen
s_add_u32 s56, s64, 136192
buffer_load_dwordx4 a[136:139], v12, s[4:7], s56 offen
v_mfma_f32_16x16x32_bf16 v[20:23], v[76:79], a[96:99], 0
ds_read_b128 v[108:111], v3 offset:10240
s_add_u32 s56, s64, 324608
buffer_load_dwordx4 a[140:143], v12, s[4:7], s56 offen
s_add_u32 m0, s54, 32768
v_mfma_f32_16x16x32_bf16 v[48:51], v[76:79], a[100:103], 0
ds_read_b128 v[112:115], v3 offset:11264
s_add_u32 s55, s60, 3784704
buffer_load_dwordx4 v12, s[4:7], s55 offen lds
s_add_u32 m0, s54, 33792
v_mfma_f32_16x16x32_bf16 v[24:27], v[80:83], a[96:99], 0
ds_read_b128 v[116:119], v3 offset:12288
s_add_u32 s55, s62, 3784704
buffer_load_dwordx4 v12, s[4:7], s55 offen lds
s_add_u32 m0, s54, 40960
v_mfma_f32_16x16x32_bf16 v[52:55], v[80:83], a[100:103], 0
ds_read_b128 v[120:123], v3 offset:13312
s_add_u32 s55, s60, 3813376
buffer_load_dwordx4 v12, s[4:7], s55 offen lds
s_add_u32 m0, s54, 41984
v_mfma_f32_16x16x32_bf16 v[28:31], v[84:87], a[96:99], 0
ds_read_b128 v[124:127], v3 offset:14336
s_add_u32 s55, s62, 3813376
buffer_load_dwordx4 v12, s[4:7], s55 offen lds
v_mfma_f32_16x16x32_bf16 v[56:59], v[84:87], a[100:103], 0
s_add_u32 s56, s64, 137216
buffer_load_dwordx4 a[144:147], v12, s[4:7], s56 offen
s_add_u32 s56, s64, 325632
v_mfma_f32_16x16x32_bf16 v[32:35], v[88:91], a[96:99], 0
buffer_load_dwordx4 a[148:151], v12, s[4:7], s56 offen
s_add_u32 s56, s64, 138240
buffer_load_dwordx4 a[152:155], v12, s[4:7], s56 offen
v_mfma_f32_16x16x32_bf16 v[60:63], v[88:91], a[100:103], 0
s_add_u32 s56, s64, 326656
buffer_load_dwordx4 a[156:159], v12, s[4:7], s56 offen
s_add_u32 m0, s54, 49152
v_mfma_f32_16x16x32_bf16 v[36:39], v[92:95], a[96:99], 0
s_add_u32 s55, s60, 3842048
buffer_load_dwordx4 v12, s[4:7], s55 offen lds
s_add_u32 m0, s54, 50176
v_mfma_f32_16x16x32_bf16 v[64:67], v[92:95], a[100:103], 0
s_add_u32 s55, s62, 3842048
buffer_load_dwordx4 v12, s[4:7], s55 offen lds
s_add_u32 m0, s54, 57344
v_mfma_f32_16x16x32_bf16 v[40:43], v[96:99], a[96:99], 0
s_add_u32 s55, s60, 3870720
buffer_load_dwordx4 v12, s[4:7], s55 offen lds
s_add_u32 m0, s54, 58368
v_mfma_f32_16x16x32_bf16 v[68:71], v[96:99], a[100:103], 0
s_add_u32 s55, s62, 3870720
buffer_load_dwordx4 v12, s[4:7], s55 offen lds
s_waitcnt vmcnt(16)
s_barrier
s_waitcnt lgkmcnt(0)
v_mfma_f32_16x16x32_bf16 v[16:19], v[100:103], a[104:107], v[16:19]
ds_read_b128 v[72:75], v3 offset:16384
s_add_u32 s56, s64, 139264
buffer_load_dwordx4 a[160:163], v12, s[4:7], s56 offen
s_add_u32 s56, s64, 327680
v_mfma_f32_16x16x32_bf16 v[44:47], v[100:103], a[108:111], v[44:47]
ds_read_b128 v[76:79], v3 offset:17408
buffer_load_dwordx4 a[164:167], v12, s[4:7], s56 offen
s_add_u32 s56, s64, 140288
v_mfma_f32_16x16x32_bf16 v[20:23], v[104:107], a[104:107], v[20:23]
ds_read_b128 v[80:83], v3 offset:18432
buffer_load_dwordx4 a[168:171], v12, s[4:7], s56 offen
s_add_u32 s56, s64, 328704
v_mfma_f32_16x16x32_bf16 v[48:51], v[104:107], a[108:111], v[48:51]
ds_read_b128 v[84:87], v3 offset:19456
buffer_load_dwordx4 a[172:175], v12, s[4:7], s56 offen
s_add_u32 m0, s54, 65536
s_add_u32 s55, s60, 3899392
v_mfma_f32_16x16x32_bf16 v[24:27], v[108:111], a[104:107], v[24:27]
ds_read_b128 v[88:91], v3 offset:20480
buffer_load_dwordx4 v12, s[4:7], s55 offen lds
s_add_u32 m0, s54, 66560
v_mfma_f32_16x16x32_bf16 v[52:55], v[108:111], a[108:111], v[52:55]
ds_read_b128 v[92:95], v3 offset:21504
s_add_u32 s55, s62, 3899392
buffer_load_dwordx4 v12, s[4:7], s55 offen lds
v_mfma_f32_16x16x32_bf16 v[28:31], v[112:115], a[104:107], v[28:31]
ds_read_b128 v[96:99], v3 offset:22528
s_add_u32 m0, s54, 73728
s_add_u32 s55, s60, 3928064
v_mfma_f32_16x16x32_bf16 v[56:59], v[112:115], a[108:111], v[56:59]
buffer_load_dwordx4 v12, s[4:7], s55 offen lds
s_add_u32 m0, s54, 74752
s_add_u32 s55, s62, 3928064
v_mfma_f32_16x16x32_bf16 v[32:35], v[116:119], a[104:107], v[32:35]
buffer_load_dwordx4 v12, s[4:7], s55 offen lds
s_add_u32 m0, s54, 81920
v_mfma_f32_16x16x32_bf16 v[60:63], v[116:119], a[108:111], v[60:63]
s_add_u32 s55, s60, 3956736
buffer_load_dwordx4 v12, s[4:7], s55 offen lds
v_mfma_f32_16x16x32_bf16 v[36:39], v[120:123], a[104:107], v[36:39]
s_add_u32 m0, s54, 82944
s_add_u32 s55, s62, 3956736
buffer_load_dwordx4 v12, s[4:7], s55 offen lds
v_mfma_f32_16x16x32_bf16 v[64:67], v[120:123], a[108:111], v[64:67]
s_add_u32 m0, s54, 90112
s_add_u32 s55, s60, 3985408
v_mfma_f32_16x16x32_bf16 v[40:43], v[124:127], a[104:107], v[40:43]
buffer_load_dwordx4 v12, s[4:7], s55 offen lds
s_add_u32 m0, s54, 91136
v_mfma_f32_16x16x32_bf16 v[68:71], v[124:127], a[108:111], v[68:71]
s_add_u32 s55, s62, 3985408
buffer_load_dwordx4 v12, s[4:7], s55 offen lds
s_waitcnt lgkmcnt(0)
v_mfma_f32_16x16x32_bf16 v[16:19], v[72:75], a[112:115], v[16:19]
ds_read_b128 v[100:103], v3 offset:24576
v_mfma_f32_16x16x32_bf16 v[44:47], v[72:75], a[116:119], v[44:47]
ds_read_b128 v[104:107], v3 offset:25600
v_mfma_f32_16x16x32_bf16 v[20:23], v[76:79], a[112:115], v[20:23]
ds_read_b128 v[108:111], v3 offset:26624
v_mfma_f32_16x16x32_bf16 v[48:51], v[76:79], a[116:119], v[48:51]
ds_read_b128 v[112:115], v3 offset:27648
v_mfma_f32_16x16x32_bf16 v[24:27], v[80:83], a[112:115], v[24:27]
ds_read_b128 v[116:119], v3 offset:28672
v_mfma_f32_16x16x32_bf16 v[52:55], v[80:83], a[116:119], v[52:55]
ds_read_b128 v[120:123], v3 offset:29696
v_mfma_f32_16x16x32_bf16 v[28:31], v[84:87], a[112:115], v[28:31]
ds_read_b128 v[124:127], v3 offset:30720
v_mfma_f32_16x16x32_bf16 v[56:59], v[84:87], a[116:119], v[56:59]
v_mfma_f32_16x16x32_bf16 v[32:35], v[88:91], a[112:115], v[32:35]
v_mfma_f32_16x16x32_bf16 v[60:63], v[88:91], a[116:119], v[60:63]
v_mfma_f32_16x16x32_bf16 v[36:39], v[92:95], a[112:115], v[36:39]
v_mfma_f32_16x16x32_bf16 v[64:67], v[92:95], a[116:119], v[64:67]
v_mfma_f32_16x16x32_bf16 v[40:43], v[96:99], a[112:115], v[40:43]
v_mfma_f32_16x16x32_bf16 v[68:71], v[96:99], a[116:119], v[68:71]
s_waitcnt vmcnt(20)
s_barrier
s_waitcnt lgkmcnt(0)
v_mfma_f32_16x16x32_bf16 v[16:19], v[100:103], a[120:123], v[16:19]
ds_read_b128 v[72:75], v3 offset:32768
s_add_u32 s56, s64, 141312
buffer_load_dwordx4 a[96:99], v12, s[4:7], s56 offen
s_add_u32 s56, s64, 329728
v_mfma_f32_16x16x32_bf16 v[44:47], v[100:103], a[124:127], v[44:47]
ds_read_b128 v[76:79], v3 offset:33792
buffer_load_dwordx4 a[100:103], v12, s[4:7], s56 offen
s_add_u32 s56, s64, 142336
v_mfma_f32_16x16x32_bf16 v[20:23], v[104:107], a[120:123], v[20:23]
ds_read_b128 v[80:83], v3 offset:34816
buffer_load_dwordx4 a[104:107], v12, s[4:7], s56 offen
s_add_u32 s56, s64, 330752
v_mfma_f32_16x16x32_bf16 v[48:51], v[104:107], a[124:127], v[48:51]
ds_read_b128 v[84:87], v3 offset:35840
buffer_load_dwordx4 a[108:111], v12, s[4:7], s56 offen
s_add_u32 m0, s54, 98304
s_add_u32 s55, s60, 4014080
v_mfma_f32_16x16x32_bf16 v[24:27], v[108:111], a[120:123], v[24:27]
ds_read_b128 v[88:91], v3 offset:36864
buffer_load_dwordx4 v12, s[4:7], s55 offen lds
s_add_u32 m0, s54, 99328
v_mfma_f32_16x16x32_bf16 v[52:55], v[108:111], a[124:127], v[52:55]
ds_read_b128 v[92:95], v3 offset:37888
s_add_u32 s55, s62, 4014080
buffer_load_dwordx4 v12, s[4:7], s55 offen lds
v_mfma_f32_16x16x32_bf16 v[28:31], v[112:115], a[120:123], v[28:31]
ds_read_b128 v[96:99], v3 offset:38912
s_add_u32 m0, s54, 106496
s_add_u32 s55, s60, 4042752
v_mfma_f32_16x16x32_bf16 v[56:59], v[112:115], a[124:127], v[56:59]
buffer_load_dwordx4 v12, s[4:7], s55 offen lds
s_add_u32 m0, s54, 107520
s_add_u32 s55, s62, 4042752
v_mfma_f32_16x16x32_bf16 v[32:35], v[116:119], a[120:123], v[32:35]
buffer_load_dwordx4 v12, s[4:7], s55 offen lds
s_add_u32 m0, s54, 114688
v_mfma_f32_16x16x32_bf16 v[60:63], v[116:119], a[124:127], v[60:63]
s_add_u32 s55, s61, 0
buffer_load_dwordx4 v12, s[4:7], s55 offen lds
v_mfma_f32_16x16x32_bf16 v[36:39], v[120:123], a[120:123], v[36:39]
s_add_u32 m0, s54, 115712
s_add_u32 s55, s63, 0
buffer_load_dwordx4 v12, s[4:7], s55 offen lds
v_mfma_f32_16x16x32_bf16 v[64:67], v[120:123], a[124:127], v[64:67]
s_add_u32 m0, s54, 122880
s_add_u32 s55, s61, 28672
v_mfma_f32_16x16x32_bf16 v[40:43], v[124:127], a[120:123], v[40:43]
buffer_load_dwordx4 v12, s[4:7], s55 offen lds
s_add_u32 m0, s54, 123904
v_mfma_f32_16x16x32_bf16 v[68:71], v[124:127], a[124:127], v[68:71]
s_add_u32 s55, s63, 28672
buffer_load_dwordx4 v12, s[4:7], s55 offen lds
s_waitcnt lgkmcnt(0)
v_mfma_f32_16x16x32_bf16 v[16:19], v[72:75], a[128:131], v[16:19]
ds_read_b128 v[100:103], v3 offset:40960
v_mfma_f32_16x16x32_bf16 v[44:47], v[72:75], a[132:135], v[44:47]
ds_read_b128 v[104:107], v3 offset:41984
v_mfma_f32_16x16x32_bf16 v[20:23], v[76:79], a[128:131], v[20:23]
ds_read_b128 v[108:111], v3 offset:43008
v_mfma_f32_16x16x32_bf16 v[48:51], v[76:79], a[132:135], v[48:51]
ds_read_b128 v[112:115], v3 offset:44032
v_mfma_f32_16x16x32_bf16 v[24:27], v[80:83], a[128:131], v[24:27]
ds_read_b128 v[116:119], v3 offset:45056
v_mfma_f32_16x16x32_bf16 v[52:55], v[80:83], a[132:135], v[52:55]
ds_read_b128 v[120:123], v3 offset:46080
v_mfma_f32_16x16x32_bf16 v[28:31], v[84:87], a[128:131], v[28:31]
ds_read_b128 v[124:127], v3 offset:47104
v_mfma_f32_16x16x32_bf16 v[56:59], v[84:87], a[132:135], v[56:59]
v_mfma_f32_16x16x32_bf16 v[32:35], v[88:91], a[128:131], v[32:35]
v_mfma_f32_16x16x32_bf16 v[60:63], v[88:91], a[132:135], v[60:63]
v_mfma_f32_16x16x32_bf16 v[36:39], v[92:95], a[128:131], v[36:39]
v_mfma_f32_16x16x32_bf16 v[64:67], v[92:95], a[132:135], v[64:67]
v_mfma_f32_16x16x32_bf16 v[40:43], v[96:99], a[128:131], v[40:43]
v_mfma_f32_16x16x32_bf16 v[68:71], v[96:99], a[132:135], v[68:71]
s_waitcnt vmcnt(24)
s_barrier
s_waitcnt lgkmcnt(0)
v_mfma_f32_16x16x32_bf16 v[16:19], v[100:103], a[136:139], v[16:19]
ds_read_b128 v[72:75], v3 offset:49152
s_add_u32 s56, s64, 143360
buffer_load_dwordx4 a[112:115], v12, s[4:7], s56 offen
s_add_u32 s56, s64, 331776
v_mfma_f32_16x16x32_bf16 v[44:47], v[100:103], a[140:143], v[44:47]
ds_read_b128 v[76:79], v3 offset:50176
buffer_load_dwordx4 a[116:119], v12, s[4:7], s56 offen
s_add_u32 s56, s64, 144384
v_mfma_f32_16x16x32_bf16 v[20:23], v[104:107], a[136:139], v[20:23]
ds_read_b128 v[80:83], v3 offset:51200
buffer_load_dwordx4 a[120:123], v12, s[4:7], s56 offen
s_add_u32 s56, s64, 332800
v_mfma_f32_16x16x32_bf16 v[48:51], v[104:107], a[140:143], v[48:51]
ds_read_b128 v[84:87], v3 offset:52224
buffer_load_dwordx4 a[124:127], v12, s[4:7], s56 offen
s_add_u32 m0, s54, 0
s_add_u32 s55, s61, 57344
v_mfma_f32_16x16x32_bf16 v[24:27], v[108:111], a[136:139], v[24:27]
ds_read_b128 v[88:91], v3 offset:53248
buffer_load_dwordx4 v12, s[4:7], s55 offen lds
s_add_u32 m0, s54, 1024
v_mfma_f32_16x16x32_bf16 v[52:55], v[108:111], a[140:143], v[52:55]
ds_read_b128 v[92:95], v3 offset:54272
s_add_u32 s55, s63, 57344
buffer_load_dwordx4 v12, s[4:7], s55 offen lds
v_mfma_f32_16x16x32_bf16 v[28:31], v[112:115], a[136:139], v[28:31]
ds_read_b128 v[96:99], v3 offset:55296
s_add_u32 m0, s54, 8192
s_add_u32 s55, s61, 86016
v_mfma_f32_16x16x32_bf16 v[56:59], v[112:115], a[140:143], v[56:59]
buffer_load_dwordx4 v12, s[4:7], s55 offen lds
s_add_u32 m0, s54, 9216
s_add_u32 s55, s63, 86016
v_mfma_f32_16x16x32_bf16 v[32:35], v[116:119], a[136:139], v[32:35]
buffer_load_dwordx4 v12, s[4:7], s55 offen lds
s_add_u32 m0, s54, 16384
v_mfma_f32_16x16x32_bf16 v[60:63], v[116:119], a[140:143], v[60:63]
s_add_u32 s55, s61, 114688
buffer_load_dwordx4 v12, s[4:7], s55 offen lds
v_mfma_f32_16x16x32_bf16 v[36:39], v[120:123], a[136:139], v[36:39]
s_add_u32 m0, s54, 17408
s_add_u32 s55, s63, 114688
buffer_load_dwordx4 v12, s[4:7], s55 offen lds
v_mfma_f32_16x16x32_bf16 v[64:67], v[120:123], a[140:143], v[64:67]
s_add_u32 m0, s54, 24576
s_add_u32 s55, s61, 143360
v_mfma_f32_16x16x32_bf16 v[40:43], v[124:127], a[136:139], v[40:43]
buffer_load_dwordx4 v12, s[4:7], s55 offen lds
s_add_u32 m0, s54, 25600
v_mfma_f32_16x16x32_bf16 v[68:71], v[124:127], a[140:143], v[68:71]
s_add_u32 s55, s63, 143360
buffer_load_dwordx4 v12, s[4:7], s55 offen lds
s_waitcnt lgkmcnt(0)
v_mfma_f32_16x16x32_bf16 v[16:19], v[72:75], a[144:147], v[16:19]
ds_read_b128 v[100:103], v3 offset:57344
v_mfma_f32_16x16x32_bf16 v[44:47], v[72:75], a[148:151], v[44:47]
ds_read_b128 v[104:107], v3 offset:58368
v_mfma_f32_16x16x32_bf16 v[20:23], v[76:79], a[144:147], v[20:23]
ds_read_b128 v[108:111], v3 offset:59392
v_mfma_f32_16x16x32_bf16 v[48:51], v[76:79], a[148:151], v[48:51]
ds_read_b128 v[112:115], v3 offset:60416
v_mfma_f32_16x16x32_bf16 v[24:27], v[80:83], a[144:147], v[24:27]
ds_read_b128 v[116:119], v3 offset:61440
v_mfma_f32_16x16x32_bf16 v[52:55], v[80:83], a[148:151], v[52:55]
ds_read_b128 v[120:123], v3 offset:62464
v_mfma_f32_16x16x32_bf16 v[28:31], v[84:87], a[144:147], v[28:31]
ds_read_b128 v[124:127], v3 offset:63488
v_mfma_f32_16x16x32_bf16 v[56:59], v[84:87], a[148:151], v[56:59]
v_mfma_f32_16x16x32_bf16 v[32:35], v[88:91], a[144:147], v[32:35]
v_mfma_f32_16x16x32_bf16 v[60:63], v[88:91], a[148:151], v[60:63]
v_mfma_f32_16x16x32_bf16 v[36:39], v[92:95], a[144:147], v[36:39]
v_mfma_f32_16x16x32_bf16 v[64:67], v[92:95], a[148:151], v[64:67]
v_mfma_f32_16x16x32_bf16 v[40:43], v[96:99], a[144:147], v[40:43]
v_mfma_f32_16x16x32_bf16 v[68:71], v[96:99], a[148:151], v[68:71]
s_waitcnt vmcnt(28)
s_barrier
s_waitcnt lgkmcnt(0)
v_mfma_f32_16x16x32_bf16 v[16:19], v[100:103], a[152:155], v[16:19]
ds_read_b128 v[72:75], v4 offset:0
s_add_u32 m0, s54, 32768
v_mfma_f32_16x16x32_bf16 v[44:47], v[100:103], a[156:159], v[44:47]
ds_read_b128 v[76:79], v4 offset:1024
s_add_u32 s55, s61, 172032
v_mfma_f32_16x16x32_bf16 v[20:23], v[104:107], a[152:155], v[20:23]
ds_read_b128 v[80:83], v4 offset:2048
buffer_load_dwordx4 v12, s[4:7], s55 offen lds
v_mfma_f32_16x16x32_bf16 v[48:51], v[104:107], a[156:159], v[48:51]
ds_read_b128 v[84:87], v4 offset:3072
s_add_u32 m0, s54, 33792
v_mfma_f32_16x16x32_bf16 v[24:27], v[108:111], a[152:155], v[24:27]
ds_read_b128 v[88:91], v4 offset:4096
s_add_u32 s55, s63, 172032
v_mfma_f32_16x16x32_bf16 v[52:55], v[108:111], a[156:159], v[52:55]
ds_read_b128 v[92:95], v4 offset:5120
buffer_load_dwordx4 v12, s[4:7], s55 offen lds
v_mfma_f32_16x16x32_bf16 v[28:31], v[112:115], a[152:155], v[28:31]
ds_read_b128 v[96:99], v4 offset:6144
v_mfma_f32_16x16x32_bf16 v[56:59], v[112:115], a[156:159], v[56:59]
s_add_u32 m0, s54, 40960
v_mfma_f32_16x16x32_bf16 v[32:35], v[116:119], a[152:155], v[32:35]
s_add_u32 s55, s61, 200704
v_mfma_f32_16x16x32_bf16 v[60:63], v[116:119], a[156:159], v[60:63]
buffer_load_dwordx4 v12, s[4:7], s55 offen lds
v_mfma_f32_16x16x32_bf16 v[36:39], v[120:123], a[152:155], v[36:39]
s_add_u32 m0, s54, 41984
v_mfma_f32_16x16x32_bf16 v[64:67], v[120:123], a[156:159], v[64:67]
s_add_u32 s55, s63, 200704
v_mfma_f32_16x16x32_bf16 v[40:43], v[124:127], a[152:155], v[40:43]
buffer_load_dwordx4 v12, s[4:7], s55 offen lds
v_mfma_f32_16x16x32_bf16 v[68:71], v[124:127], a[156:159], v[68:71]
s_waitcnt lgkmcnt(0)
v_mfma_f32_16x16x32_bf16 v[16:19], v[72:75], a[160:163], v[16:19]
ds_read_b128 v[100:103], v4 offset:8192
v_mfma_f32_16x16x32_bf16 v[44:47], v[72:75], a[164:167], v[44:47]
ds_read_b128 v[104:107], v4 offset:9216
v_mfma_f32_16x16x32_bf16 v[20:23], v[76:79], a[160:163], v[20:23]
ds_read_b128 v[108:111], v4 offset:10240
v_mfma_f32_16x16x32_bf16 v[48:51], v[76:79], a[164:167], v[48:51]
ds_read_b128 v[112:115], v4 offset:11264
v_mfma_f32_16x16x32_bf16 v[24:27], v[80:83], a[160:163], v[24:27]
ds_read_b128 v[116:119], v4 offset:12288
v_mfma_f32_16x16x32_bf16 v[52:55], v[80:83], a[164:167], v[52:55]
ds_read_b128 v[120:123], v4 offset:13312
v_mfma_f32_16x16x32_bf16 v[28:31], v[84:87], a[160:163], v[28:31]
ds_read_b128 v[124:127], v4 offset:14336
v_mfma_f32_16x16x32_bf16 v[56:59], v[84:87], a[164:167], v[56:59]
v_mfma_f32_16x16x32_bf16 v[32:35], v[88:91], a[160:163], v[32:35]
v_mfma_f32_16x16x32_bf16 v[60:63], v[88:91], a[164:167], v[60:63]
v_mfma_f32_16x16x32_bf16 v[36:39], v[92:95], a[160:163], v[36:39]
v_mfma_f32_16x16x32_bf16 v[64:67], v[92:95], a[164:167], v[64:67]
v_mfma_f32_16x16x32_bf16 v[40:43], v[96:99], a[160:163], v[40:43]
v_mfma_f32_16x16x32_bf16 v[68:71], v[96:99], a[164:167], v[68:71]
s_cmp_lg_u32 s3, 0
s_cbranch_scc1 fused_kernel_ctx_ok_83
s_lshl_b32 s66, s51, 2
s_add_u32 s66, s66, s50
s_add_u32 s66, s66, 288
s_lshl_b32 s66, s66, 7
s_add_u32 s66, s66, 0x5b00000
s_mov_b32 s58, 0x80000
fused_kernel_ctx_poll_84:
buffer_load_dword v13, off, s[4:7], s66 sc1
s_waitcnt vmcnt(0)
v_readfirstlane_b32 s57, v13
s_sub_u32 s58, s58, 1
s_cmp_eq_u32 s58, 0
s_cbranch_scc1 fused_kernel_ctx_ok_83
s_cmp_ge_u32 s57, 4
s_cbranch_scc1 fused_kernel_ctx_ok_83
s_sleep 1
s_branch fused_kernel_ctx_poll_84
fused_kernel_ctx_ok_83:
s_barrier
s_waitcnt vmcnt(24)
s_barrier
s_waitcnt lgkmcnt(0)
v_mfma_f32_16x16x32_bf16 v[16:19], v[100:103], a[168:171], v[16:19]
ds_read_b128 v[72:75], v4 offset:16384
s_add_u32 s56, s65, 0
buffer_load_dwordx4 a[128:131], v12, s[4:7], s56 offen
v_mfma_f32_16x16x32_bf16 v[44:47], v[100:103], a[172:175], v[44:47]
ds_read_b128 v[76:79], v4 offset:17408
s_add_u32 s56, s65, 188416
buffer_load_dwordx4 a[132:135], v12, s[4:7], s56 offen
v_mfma_f32_16x16x32_bf16 v[20:23], v[104:107], a[168:171], v[20:23]
ds_read_b128 v[80:83], v4 offset:18432
s_add_u32 s56, s65, 1024
buffer_load_dwordx4 a[136:139], v12, s[4:7], s56 offen
v_mfma_f32_16x16x32_bf16 v[48:51], v[104:107], a[172:175], v[48:51]
ds_read_b128 v[84:87], v4 offset:19456
s_add_u32 s56, s65, 189440
buffer_load_dwordx4 a[140:143], v12, s[4:7], s56 offen
v_mfma_f32_16x16x32_bf16 v[24:27], v[108:111], a[168:171], v[24:27]
ds_read_b128 v[88:91], v4 offset:20480
s_add_u32 m0, s54, 49152
s_add_u32 s55, s61, 229376
v_mfma_f32_16x16x32_bf16 v[52:55], v[108:111], a[172:175], v[52:55]
ds_read_b128 v[92:95], v4 offset:21504
buffer_load_dwordx4 v12, s[4:7], s55 offen lds
s_add_u32 m0, s54, 50176
v_mfma_f32_16x16x32_bf16 v[28:31], v[112:115], a[168:171], v[28:31]
ds_read_b128 v[96:99], v4 offset:22528
s_add_u32 s55, s63, 229376
buffer_load_dwordx4 v12, s[4:7], s55 offen lds
v_mfma_f32_16x16x32_bf16 v[56:59], v[112:115], a[172:175], v[56:59]
s_add_u32 m0, s54, 57344
s_add_u32 s55, s61, 258048
v_mfma_f32_16x16x32_bf16 v[32:35], v[116:119], a[168:171], v[32:35]
buffer_load_dwordx4 v12, s[4:7], s55 offen lds
s_add_u32 m0, s54, 58368
v_mfma_f32_16x16x32_bf16 v[60:63], v[116:119], a[172:175], v[60:63]
s_add_u32 s55, s63, 258048
buffer_load_dwordx4 v12, s[4:7], s55 offen lds
v_mfma_f32_16x16x32_bf16 v[36:39], v[120:123], a[168:171], v[36:39]
s_add_u32 s56, s65, 2048
buffer_load_dwordx4 a[144:147], v12, s[4:7], s56 offen
v_mfma_f32_16x16x32_bf16 v[64:67], v[120:123], a[172:175], v[64:67]
s_add_u32 s56, s65, 190464
buffer_load_dwordx4 a[148:151], v12, s[4:7], s56 offen
v_mfma_f32_16x16x32_bf16 v[40:43], v[124:127], a[168:171], v[40:43]
s_add_u32 s56, s65, 3072
buffer_load_dwordx4 a[152:155], v12, s[4:7], s56 offen
v_mfma_f32_16x16x32_bf16 v[68:71], v[124:127], a[172:175], v[68:71]
s_add_u32 s56, s65, 191488
buffer_load_dwordx4 a[156:159], v12, s[4:7], s56 offen
s_waitcnt lgkmcnt(0)
v_mfma_f32_16x16x32_bf16 v[16:19], v[72:75], a[96:99], v[16:19]
ds_read_b128 v[100:103], v4 offset:24576
v_mfma_f32_16x16x32_bf16 v[44:47], v[72:75], a[100:103], v[44:47]
ds_read_b128 v[104:107], v4 offset:25600
v_mfma_f32_16x16x32_bf16 v[20:23], v[76:79], a[96:99], v[20:23]
ds_read_b128 v[108:111], v4 offset:26624
v_mfma_f32_16x16x32_bf16 v[48:51], v[76:79], a[100:103], v[48:51]
ds_read_b128 v[112:115], v4 offset:27648
v_mfma_f32_16x16x32_bf16 v[24:27], v[80:83], a[96:99], v[24:27]
ds_read_b128 v[116:119], v4 offset:28672
v_mfma_f32_16x16x32_bf16 v[52:55], v[80:83], a[100:103], v[52:55]
ds_read_b128 v[120:123], v4 offset:29696
v_mfma_f32_16x16x32_bf16 v[28:31], v[84:87], a[96:99], v[28:31]
ds_read_b128 v[124:127], v4 offset:30720
v_mfma_f32_16x16x32_bf16 v[56:59], v[84:87], a[100:103], v[56:59]
v_mfma_f32_16x16x32_bf16 v[32:35], v[88:91], a[96:99], v[32:35]
v_mfma_f32_16x16x32_bf16 v[60:63], v[88:91], a[100:103], v[60:63]
v_mfma_f32_16x16x32_bf16 v[36:39], v[92:95], a[96:99], v[36:39]
v_mfma_f32_16x16x32_bf16 v[64:67], v[92:95], a[100:103], v[64:67]
v_mfma_f32_16x16x32_bf16 v[40:43], v[96:99], a[96:99], v[40:43]
v_mfma_f32_16x16x32_bf16 v[68:71], v[96:99], a[100:103], v[68:71]
s_waitcnt vmcnt(24)
s_barrier
s_waitcnt lgkmcnt(0)
v_mfma_f32_16x16x32_bf16 v[16:19], v[100:103], a[104:107], v[16:19]
ds_read_b128 v[72:75], v4 offset:32768
s_add_u32 s56, s65, 4096
buffer_load_dwordx4 a[160:163], v12, s[4:7], s56 offen
v_mfma_f32_16x16x32_bf16 v[44:47], v[100:103], a[108:111], v[44:47]
ds_read_b128 v[76:79], v4 offset:33792
s_add_u32 s56, s65, 192512
v_mfma_f32_16x16x32_bf16 v[20:23], v[104:107], a[104:107], v[20:23]
ds_read_b128 v[80:83], v4 offset:34816
buffer_load_dwordx4 a[164:167], v12, s[4:7], s56 offen
s_add_u32 s56, s65, 5120
v_mfma_f32_16x16x32_bf16 v[48:51], v[104:107], a[108:111], v[48:51]
ds_read_b128 v[84:87], v4 offset:35840
buffer_load_dwordx4 a[168:171], v12, s[4:7], s56 offen
v_mfma_f32_16x16x32_bf16 v[24:27], v[108:111], a[104:107], v[24:27]
ds_read_b128 v[88:91], v4 offset:36864
s_add_u32 s56, s65, 193536
buffer_load_dwordx4 a[172:175], v12, s[4:7], s56 offen
v_mfma_f32_16x16x32_bf16 v[52:55], v[108:111], a[108:111], v[52:55]
ds_read_b128 v[92:95], v4 offset:37888
s_add_u32 m0, s54, 65536
v_mfma_f32_16x16x32_bf16 v[28:31], v[112:115], a[104:107], v[28:31]
ds_read_b128 v[96:99], v4 offset:38912
s_add_u32 s55, s61, 286720
v_mfma_f32_16x16x32_bf16 v[56:59], v[112:115], a[108:111], v[56:59]
buffer_load_dwordx4 v12, s[4:7], s55 offen lds
s_add_u32 m0, s54, 66560
v_mfma_f32_16x16x32_bf16 v[32:35], v[116:119], a[104:107], v[32:35]
s_add_u32 s55, s63, 286720
v_mfma_f32_16x16x32_bf16 v[60:63], v[116:119], a[108:111], v[60:63]
buffer_load_dwordx4 v12, s[4:7], s55 offen lds
s_add_u32 m0, s54, 73728
v_mfma_f32_16x16x32_bf16 v[36:39], v[120:123], a[104:107], v[36:39]
s_add_u32 s55, s61, 315392
v_mfma_f32_16x16x32_bf16 v[64:67], v[120:123], a[108:111], v[64:67]
buffer_load_dwordx4 v12, s[4:7], s55 offen lds
s_add_u32 m0, s54, 74752
v_mfma_f32_16x16x32_bf16 v[40:43], v[124:127], a[104:107], v[40:43]
s_add_u32 s55, s63, 315392
v_mfma_f32_16x16x32_bf16 v[68:71], v[124:127], a[108:111], v[68:71]
buffer_load_dwordx4 v12, s[4:7], s55 offen lds
s_waitcnt lgkmcnt(0)
v_mfma_f32_16x16x32_bf16 v[16:19], v[72:75], a[112:115], v[16:19]
ds_read_b128 v[100:103], v4 offset:40960
v_mfma_f32_16x16x32_bf16 v[44:47], v[72:75], a[116:119], v[44:47]
ds_read_b128 v[104:107], v4 offset:41984
v_mfma_f32_16x16x32_bf16 v[20:23], v[76:79], a[112:115], v[20:23]
ds_read_b128 v[108:111], v4 offset:43008
v_mfma_f32_16x16x32_bf16 v[48:51], v[76:79], a[116:119], v[48:51]
ds_read_b128 v[112:115], v4 offset:44032
v_mfma_f32_16x16x32_bf16 v[24:27], v[80:83], a[112:115], v[24:27]
ds_read_b128 v[116:119], v4 offset:45056
v_mfma_f32_16x16x32_bf16 v[52:55], v[80:83], a[116:119], v[52:55]
ds_read_b128 v[120:123], v4 offset:46080
v_mfma_f32_16x16x32_bf16 v[28:31], v[84:87], a[112:115], v[28:31]
ds_read_b128 v[124:127], v4 offset:47104
v_mfma_f32_16x16x32_bf16 v[56:59], v[84:87], a[116:119], v[56:59]
v_mfma_f32_16x16x32_bf16 v[32:35], v[88:91], a[112:115], v[32:35]
v_mfma_f32_16x16x32_bf16 v[60:63], v[88:91], a[116:119], v[60:63]
v_mfma_f32_16x16x32_bf16 v[36:39], v[92:95], a[112:115], v[36:39]
v_mfma_f32_16x16x32_bf16 v[64:67], v[92:95], a[116:119], v[64:67]
v_mfma_f32_16x16x32_bf16 v[40:43], v[96:99], a[112:115], v[40:43]
v_mfma_f32_16x16x32_bf16 v[68:71], v[96:99], a[116:119], v[68:71]
s_waitcnt vmcnt(16)
s_barrier
s_waitcnt lgkmcnt(0)
v_mfma_f32_16x16x32_bf16 v[16:19], v[100:103], a[120:123], v[16:19]
ds_read_b128 v[72:75], v4 offset:49152
s_add_u32 s56, s65, 6144
buffer_load_dwordx4 a[96:99], v12, s[4:7], s56 offen
v_mfma_f32_16x16x32_bf16 v[44:47], v[100:103], a[124:127], v[44:47]
ds_read_b128 v[76:79], v4 offset:50176
s_add_u32 s56, s65, 194560
v_mfma_f32_16x16x32_bf16 v[20:23], v[104:107], a[120:123], v[20:23]
ds_read_b128 v[80:83], v4 offset:51200
buffer_load_dwordx4 a[100:103], v12, s[4:7], s56 offen
s_add_u32 s56, s65, 7168
v_mfma_f32_16x16x32_bf16 v[48:51], v[104:107], a[124:127], v[48:51]
ds_read_b128 v[84:87], v4 offset:52224
buffer_load_dwordx4 a[104:107], v12, s[4:7], s56 offen
v_mfma_f32_16x16x32_bf16 v[24:27], v[108:111], a[120:123], v[24:27]
ds_read_b128 v[88:91], v4 offset:53248
s_add_u32 s56, s65, 195584
buffer_load_dwordx4 a[108:111], v12, s[4:7], s56 offen
v_mfma_f32_16x16x32_bf16 v[52:55], v[108:111], a[124:127], v[52:55]
ds_read_b128 v[92:95], v4 offset:54272
s_add_u32 m0, s54, 81920
v_mfma_f32_16x16x32_bf16 v[28:31], v[112:115], a[120:123], v[28:31]
ds_read_b128 v[96:99], v4 offset:55296
s_add_u32 s55, s61, 344064
v_mfma_f32_16x16x32_bf16 v[56:59], v[112:115], a[124:127], v[56:59]
buffer_load_dwordx4 v12, s[4:7], s55 offen lds
s_add_u32 m0, s54, 82944
v_mfma_f32_16x16x32_bf16 v[32:35], v[116:119], a[120:123], v[32:35]
s_add_u32 s55, s63, 344064
v_mfma_f32_16x16x32_bf16 v[60:63], v[116:119], a[124:127], v[60:63]
buffer_load_dwordx4 v12, s[4:7], s55 offen lds
s_add_u32 m0, s54, 90112
v_mfma_f32_16x16x32_bf16 v[36:39], v[120:123], a[120:123], v[36:39]
s_add_u32 s55, s61, 372736
v_mfma_f32_16x16x32_bf16 v[64:67], v[120:123], a[124:127], v[64:67]
buffer_load_dwordx4 v12, s[4:7], s55 offen lds
s_add_u32 m0, s54, 91136
v_mfma_f32_16x16x32_bf16 v[40:43], v[124:127], a[120:123], v[40:43]
s_add_u32 s55, s63, 372736
v_mfma_f32_16x16x32_bf16 v[68:71], v[124:127], a[124:127], v[68:71]
buffer_load_dwordx4 v12, s[4:7], s55 offen lds
s_waitcnt lgkmcnt(0)
v_mfma_f32_16x16x32_bf16 v[16:19], v[72:75], a[128:131], v[16:19]
ds_read_b128 v[100:103], v4 offset:57344
v_mfma_f32_16x16x32_bf16 v[44:47], v[72:75], a[132:135], v[44:47]
ds_read_b128 v[104:107], v4 offset:58368
v_mfma_f32_16x16x32_bf16 v[20:23], v[76:79], a[128:131], v[20:23]
ds_read_b128 v[108:111], v4 offset:59392
v_mfma_f32_16x16x32_bf16 v[48:51], v[76:79], a[132:135], v[48:51]
ds_read_b128 v[112:115], v4 offset:60416
v_mfma_f32_16x16x32_bf16 v[24:27], v[80:83], a[128:131], v[24:27]
ds_read_b128 v[116:119], v4 offset:61440
v_mfma_f32_16x16x32_bf16 v[52:55], v[80:83], a[132:135], v[52:55]
ds_read_b128 v[120:123], v4 offset:62464
v_mfma_f32_16x16x32_bf16 v[28:31], v[84:87], a[128:131], v[28:31]
ds_read_b128 v[124:127], v4 offset:63488
v_mfma_f32_16x16x32_bf16 v[56:59], v[84:87], a[132:135], v[56:59]
v_mfma_f32_16x16x32_bf16 v[32:35], v[88:91], a[128:131], v[32:35]
v_mfma_f32_16x16x32_bf16 v[60:63], v[88:91], a[132:135], v[60:63]
v_mfma_f32_16x16x32_bf16 v[36:39], v[92:95], a[128:131], v[36:39]
v_mfma_f32_16x16x32_bf16 v[64:67], v[92:95], a[132:135], v[64:67]
v_mfma_f32_16x16x32_bf16 v[40:43], v[96:99], a[128:131], v[40:43]
v_mfma_f32_16x16x32_bf16 v[68:71], v[96:99], a[132:135], v[68:71]
s_waitcnt vmcnt(16)
s_barrier
s_waitcnt lgkmcnt(0)
v_mfma_f32_16x16x32_bf16 v[16:19], v[100:103], a[136:139], v[16:19]
ds_read_b128 v[72:75], v3 offset:0
s_add_u32 s56, s65, 8192
buffer_load_dwordx4 a[112:115], v12, s[4:7], s56 offen
v_mfma_f32_16x16x32_bf16 v[44:47], v[100:103], a[140:143], v[44:47]
ds_read_b128 v[76:79], v3 offset:1024
s_add_u32 s56, s65, 196608
v_mfma_f32_16x16x32_bf16 v[20:23], v[104:107], a[136:139], v[20:23]
ds_read_b128 v[80:83], v3 offset:2048
buffer_load_dwordx4 a[116:119], v12, s[4:7], s56 offen
s_add_u32 s56, s65, 9216
v_mfma_f32_16x16x32_bf16 v[48:51], v[104:107], a[140:143], v[48:51]
ds_read_b128 v[84:87], v3 offset:3072
buffer_load_dwordx4 a[120:123], v12, s[4:7], s56 offen
v_mfma_f32_16x16x32_bf16 v[24:27], v[108:111], a[136:139], v[24:27]
ds_read_b128 v[88:91], v3 offset:4096
s_add_u32 s56, s65, 197632
buffer_load_dwordx4 a[124:127], v12, s[4:7], s56 offen
v_mfma_f32_16x16x32_bf16 v[52:55], v[108:111], a[140:143], v[52:55]
ds_read_b128 v[92:95], v3 offset:5120
s_add_u32 m0, s54, 98304
v_mfma_f32_16x16x32_bf16 v[28:31], v[112:115], a[136:139], v[28:31]
ds_read_b128 v[96:99], v3 offset:6144
s_add_u32 s55, s61, 401408
v_mfma_f32_16x16x32_bf16 v[56:59], v[112:115], a[140:143], v[56:59]
buffer_load_dwordx4 v12, s[4:7], s55 offen lds
s_add_u32 m0, s54, 99328
v_mfma_f32_16x16x32_bf16 v[32:35], v[116:119], a[136:139], v[32:35]
s_add_u32 s55, s63, 401408
v_mfma_f32_16x16x32_bf16 v[60:63], v[116:119], a[140:143], v[60:63]
buffer_load_dwordx4 v12, s[4:7], s55 offen lds
s_add_u32 m0, s54, 106496
v_mfma_f32_16x16x32_bf16 v[36:39], v[120:123], a[136:139], v[36:39]
s_add_u32 s55, s61, 430080
v_mfma_f32_16x16x32_bf16 v[64:67], v[120:123], a[140:143], v[64:67]
buffer_load_dwordx4 v12, s[4:7], s55 offen lds
s_add_u32 m0, s54, 107520
v_mfma_f32_16x16x32_bf16 v[40:43], v[124:127], a[136:139], v[40:43]
s_add_u32 s55, s63, 430080
v_mfma_f32_16x16x32_bf16 v[68:71], v[124:127], a[140:143], v[68:71]
buffer_load_dwordx4 v12, s[4:7], s55 offen lds
s_waitcnt lgkmcnt(0)
v_mfma_f32_16x16x32_bf16 v[16:19], v[72:75], a[144:147], v[16:19]
ds_read_b128 v[100:103], v3 offset:8192
v_mfma_f32_16x16x32_bf16 v[44:47], v[72:75], a[148:151], v[44:47]
ds_read_b128 v[104:107], v3 offset:9216
v_mfma_f32_16x16x32_bf16 v[20:23], v[76:79], a[144:147], v[20:23]
ds_read_b128 v[108:111], v3 offset:10240
v_mfma_f32_16x16x32_bf16 v[48:51], v[76:79], a[148:151], v[48:51]
ds_read_b128 v[112:115], v3 offset:11264
v_mfma_f32_16x16x32_bf16 v[24:27], v[80:83], a[144:147], v[24:27]
ds_read_b128 v[116:119], v3 offset:12288
v_mfma_f32_16x16x32_bf16 v[52:55], v[80:83], a[148:151], v[52:55]
ds_read_b128 v[120:123], v3 offset:13312
v_mfma_f32_16x16x32_bf16 v[28:31], v[84:87], a[144:147], v[28:31]
ds_read_b128 v[124:127], v3 offset:14336
v_mfma_f32_16x16x32_bf16 v[56:59], v[84:87], a[148:151], v[56:59]
v_mfma_f32_16x16x32_bf16 v[32:35], v[88:91], a[144:147], v[32:35]
v_mfma_f32_16x16x32_bf16 v[60:63], v[88:91], a[148:151], v[60:63]
v_mfma_f32_16x16x32_bf16 v[36:39], v[92:95], a[144:147], v[36:39]
v_mfma_f32_16x16x32_bf16 v[64:67], v[92:95], a[148:151], v[64:67]
v_mfma_f32_16x16x32_bf16 v[40:43], v[96:99], a[144:147], v[40:43]
v_mfma_f32_16x16x32_bf16 v[68:71], v[96:99], a[148:151], v[68:71]
s_waitcnt vmcnt(20)
s_barrier
s_waitcnt lgkmcnt(0)
v_mfma_f32_16x16x32_bf16 v[16:19], v[100:103], a[152:155], v[16:19]
ds_read_b128 v[72:75], v3 offset:16384
s_add_u32 s56, s65, 10240
buffer_load_dwordx4 a[128:131], v12, s[4:7], s56 offen
v_mfma_f32_16x16x32_bf16 v[44:47], v[100:103], a[156:159], v[44:47]
ds_read_b128 v[76:79], v3 offset:17408
s_add_u32 s56, s65, 198656
v_mfma_f32_16x16x32_bf16 v[20:23], v[104:107], a[152:155], v[20:23]
ds_read_b128 v[80:83], v3 offset:18432
buffer_load_dwordx4 a[132:135], v12, s[4:7], s56 offen
s_add_u32 s56, s65, 11264
v_mfma_f32_16x16x32_bf16 v[48:51], v[104:107], a[156:159], v[48:51]
ds_read_b128 v[84:87], v3 offset:19456
buffer_load_dwordx4 a[136:139], v12, s[4:7], s56 offen
v_mfma_f32_16x16x32_bf16 v[24:27], v[108:111], a[152:155], v[24:27]
ds_read_b128 v[88:91], v3 offset:20480
s_add_u32 s56, s65, 199680
buffer_load_dwordx4 a[140:143], v12, s[4:7], s56 offen
v_mfma_f32_16x16x32_bf16 v[52:55], v[108:111], a[156:159], v[52:55]
ds_read_b128 v[92:95], v3 offset:21504
s_add_u32 m0, s54, 114688
v_mfma_f32_16x16x32_bf16 v[28:31], v[112:115], a[152:155], v[28:31]
ds_read_b128 v[96:99], v3 offset:22528
s_add_u32 s55, s61, 458752
v_mfma_f32_16x16x32_bf16 v[56:59], v[112:115], a[156:159], v[56:59]
buffer_load_dwordx4 v12, s[4:7], s55 offen lds
s_add_u32 m0, s54, 115712
v_mfma_f32_16x16x32_bf16 v[32:35], v[116:119], a[152:155], v[32:35]
s_add_u32 s55, s63, 458752
v_mfma_f32_16x16x32_bf16 v[60:63], v[116:119], a[156:159], v[60:63]
buffer_load_dwordx4 v12, s[4:7], s55 offen lds
s_add_u32 m0, s54, 122880
v_mfma_f32_16x16x32_bf16 v[36:39], v[120:123], a[152:155], v[36:39]
s_add_u32 s55, s61, 487424
v_mfma_f32_16x16x32_bf16 v[64:67], v[120:123], a[156:159], v[64:67]
buffer_load_dwordx4 v12, s[4:7], s55 offen lds
s_add_u32 m0, s54, 123904
v_mfma_f32_16x16x32_bf16 v[40:43], v[124:127], a[152:155], v[40:43]
s_add_u32 s55, s63, 487424
v_mfma_f32_16x16x32_bf16 v[68:71], v[124:127], a[156:159], v[68:71]
buffer_load_dwordx4 v12, s[4:7], s55 offen lds
s_waitcnt lgkmcnt(0)
v_mfma_f32_16x16x32_bf16 v[16:19], v[72:75], a[160:163], v[16:19]
ds_read_b128 v[100:103], v3 offset:24576
v_mfma_f32_16x16x32_bf16 v[44:47], v[72:75], a[164:167], v[44:47]
ds_read_b128 v[104:107], v3 offset:25600
v_mfma_f32_16x16x32_bf16 v[20:23], v[76:79], a[160:163], v[20:23]
ds_read_b128 v[108:111], v3 offset:26624
v_mfma_f32_16x16x32_bf16 v[48:51], v[76:79], a[164:167], v[48:51]
ds_read_b128 v[112:115], v3 offset:27648
v_mfma_f32_16x16x32_bf16 v[24:27], v[80:83], a[160:163], v[24:27]
ds_read_b128 v[116:119], v3 offset:28672
v_mfma_f32_16x16x32_bf16 v[52:55], v[80:83], a[164:167], v[52:55]
ds_read_b128 v[120:123], v3 offset:29696
v_mfma_f32_16x16x32_bf16 v[28:31], v[84:87], a[160:163], v[28:31]
ds_read_b128 v[124:127], v3 offset:30720
v_mfma_f32_16x16x32_bf16 v[56:59], v[84:87], a[164:167], v[56:59]
v_mfma_f32_16x16x32_bf16 v[32:35], v[88:91], a[160:163], v[32:35]
v_mfma_f32_16x16x32_bf16 v[60:63], v[88:91], a[164:167], v[60:63]
v_mfma_f32_16x16x32_bf16 v[36:39], v[92:95], a[160:163], v[36:39]
v_mfma_f32_16x16x32_bf16 v[64:67], v[92:95], a[164:167], v[64:67]
v_mfma_f32_16x16x32_bf16 v[40:43], v[96:99], a[160:163], v[40:43]
v_mfma_f32_16x16x32_bf16 v[68:71], v[96:99], a[164:167], v[68:71]
s_waitcnt vmcnt(20)
s_barrier
s_waitcnt lgkmcnt(0)
v_mfma_f32_16x16x32_bf16 v[16:19], v[100:103], a[168:171], v[16:19]
ds_read_b128 v[72:75], v3 offset:32768
s_add_u32 s56, s65, 12288
buffer_load_dwordx4 a[144:147], v12, s[4:7], s56 offen
v_mfma_f32_16x16x32_bf16 v[44:47], v[100:103], a[172:175], v[44:47]
ds_read_b128 v[76:79], v3 offset:33792
s_add_u32 s56, s65, 200704
v_mfma_f32_16x16x32_bf16 v[20:23], v[104:107], a[168:171], v[20:23]
ds_read_b128 v[80:83], v3 offset:34816
buffer_load_dwordx4 a[148:151], v12, s[4:7], s56 offen
s_add_u32 s56, s65, 13312
v_mfma_f32_16x16x32_bf16 v[48:51], v[104:107], a[172:175], v[48:51]
ds_read_b128 v[84:87], v3 offset:35840
buffer_load_dwordx4 a[152:155], v12, s[4:7], s56 offen
v_mfma_f32_16x16x32_bf16 v[24:27], v[108:111], a[168:171], v[24:27]
ds_read_b128 v[88:91], v3 offset:36864
s_add_u32 s56, s65, 201728
buffer_load_dwordx4 a[156:159], v12, s[4:7], s56 offen
v_mfma_f32_16x16x32_bf16 v[52:55], v[108:111], a[172:175], v[52:55]
ds_read_b128 v[92:95], v3 offset:37888
s_add_u32 m0, s54, 0
v_mfma_f32_16x16x32_bf16 v[28:31], v[112:115], a[168:171], v[28:31]
ds_read_b128 v[96:99], v3 offset:38912
s_add_u32 s55, s61, 516096
v_mfma_f32_16x16x32_bf16 v[56:59], v[112:115], a[172:175], v[56:59]
buffer_load_dwordx4 v12, s[4:7], s55 offen lds
s_add_u32 m0, s54, 1024
v_mfma_f32_16x16x32_bf16 v[32:35], v[116:119], a[168:171], v[32:35]
s_add_u32 s55, s63, 516096
v_mfma_f32_16x16x32_bf16 v[60:63], v[116:119], a[172:175], v[60:63]
buffer_load_dwordx4 v12, s[4:7], s55 offen lds
s_add_u32 m0, s54, 8192
v_mfma_f32_16x16x32_bf16 v[36:39], v[120:123], a[168:171], v[36:39]
s_add_u32 s55, s61, 544768
v_mfma_f32_16x16x32_bf16 v[64:67], v[120:123], a[172:175], v[64:67]
buffer_load_dwordx4 v12, s[4:7], s55 offen lds
s_add_u32 m0, s54, 9216
v_mfma_f32_16x16x32_bf16 v[40:43], v[124:127], a[168:171], v[40:43]
s_add_u32 s55, s63, 544768
v_mfma_f32_16x16x32_bf16 v[68:71], v[124:127], a[172:175], v[68:71]
buffer_load_dwordx4 v12, s[4:7], s55 offen lds
s_waitcnt lgkmcnt(0)
v_mfma_f32_16x16x32_bf16 v[16:19], v[72:75], a[96:99], v[16:19]
ds_read_b128 v[100:103], v3 offset:40960
v_mfma_f32_16x16x32_bf16 v[44:47], v[72:75], a[100:103], v[44:47]
ds_read_b128 v[104:107], v3 offset:41984
v_mfma_f32_16x16x32_bf16 v[20:23], v[76:79], a[96:99], v[20:23]
ds_read_b128 v[108:111], v3 offset:43008
v_mfma_f32_16x16x32_bf16 v[48:51], v[76:79], a[100:103], v[48:51]
ds_read_b128 v[112:115], v3 offset:44032
v_mfma_f32_16x16x32_bf16 v[24:27], v[80:83], a[96:99], v[24:27]
ds_read_b128 v[116:119], v3 offset:45056
v_mfma_f32_16x16x32_bf16 v[52:55], v[80:83], a[100:103], v[52:55]
ds_read_b128 v[120:123], v3 offset:46080
v_mfma_f32_16x16x32_bf16 v[28:31], v[84:87], a[96:99], v[28:31]
ds_read_b128 v[124:127], v3 offset:47104
v_mfma_f32_16x16x32_bf16 v[56:59], v[84:87], a[100:103], v[56:59]
v_mfma_f32_16x16x32_bf16 v[32:35], v[88:91], a[96:99], v[32:35]
v_mfma_f32_16x16x32_bf16 v[60:63], v[88:91], a[100:103], v[60:63]
v_mfma_f32_16x16x32_bf16 v[36:39], v[92:95], a[96:99], v[36:39]
v_mfma_f32_16x16x32_bf16 v[64:67], v[92:95], a[100:103], v[64:67]
v_mfma_f32_16x16x32_bf16 v[40:43], v[96:99], a[96:99], v[40:43]
v_mfma_f32_16x16x32_bf16 v[68:71], v[96:99], a[100:103], v[68:71]
s_waitcnt vmcnt(20)
s_barrier
s_waitcnt lgkmcnt(0)
v_mfma_f32_16x16x32_bf16 v[16:19], v[100:103], a[104:107], v[16:19]
ds_read_b128 v[72:75], v3 offset:49152
s_add_u32 s56, s65, 14336
buffer_load_dwordx4 a[160:163], v12, s[4:7], s56 offen
v_mfma_f32_16x16x32_bf16 v[44:47], v[100:103], a[108:111], v[44:47]
ds_read_b128 v[76:79], v3 offset:50176
s_add_u32 s56, s65, 202752
v_mfma_f32_16x16x32_bf16 v[20:23], v[104:107], a[104:107], v[20:23]
ds_read_b128 v[80:83], v3 offset:51200
buffer_load_dwordx4 a[164:167], v12, s[4:7], s56 offen
s_add_u32 s56, s65, 15360
v_mfma_f32_16x16x32_bf16 v[48:51], v[104:107], a[108:111], v[48:51]
ds_read_b128 v[84:87], v3 offset:52224
buffer_load_dwordx4 a[168:171], v12, s[4:7], s56 offen
v_mfma_f32_16x16x32_bf16 v[24:27], v[108:111], a[104:107], v[24:27]
ds_read_b128 v[88:91], v3 offset:53248
s_add_u32 s56, s65, 203776
buffer_load_dwordx4 a[172:175], v12, s[4:7], s56 offen
v_mfma_f32_16x16x32_bf16 v[52:55], v[108:111], a[108:111], v[52:55]
ds_read_b128 v[92:95], v3 offset:54272
s_add_u32 m0, s54, 16384
v_mfma_f32_16x16x32_bf16 v[28:31], v[112:115], a[104:107], v[28:31]
ds_read_b128 v[96:99], v3 offset:55296
s_add_u32 s55, s61, 573440
v_mfma_f32_16x16x32_bf16 v[56:59], v[112:115], a[108:111], v[56:59]
buffer_load_dwordx4 v12, s[4:7], s55 offen lds
s_add_u32 m0, s54, 17408
v_mfma_f32_16x16x32_bf16 v[32:35], v[116:119], a[104:107], v[32:35]
s_add_u32 s55, s63, 573440
v_mfma_f32_16x16x32_bf16 v[60:63], v[116:119], a[108:111], v[60:63]
buffer_load_dwordx4 v12, s[4:7], s55 offen lds
s_add_u32 m0, s54, 24576
v_mfma_f32_16x16x32_bf16 v[36:39], v[120:123], a[104:107], v[36:39]
s_add_u32 s55, s61, 602112
v_mfma_f32_16x16x32_bf16 v[64:67], v[120:123], a[108:111], v[64:67]
buffer_load_dwordx4 v12, s[4:7], s55 offen lds
s_add_u32 m0, s54, 25600
v_mfma_f32_16x16x32_bf16 v[40:43], v[124:127], a[104:107], v[40:43]
s_add_u32 s55, s63, 602112
v_mfma_f32_16x16x32_bf16 v[68:71], v[124:127], a[108:111], v[68:71]
buffer_load_dwordx4 v12, s[4:7], s55 offen lds
s_waitcnt lgkmcnt(0)
v_mfma_f32_16x16x32_bf16 v[16:19], v[72:75], a[112:115], v[16:19]
ds_read_b128 v[100:103], v3 offset:57344
v_mfma_f32_16x16x32_bf16 v[44:47], v[72:75], a[116:119], v[44:47]
ds_read_b128 v[104:107], v3 offset:58368
v_mfma_f32_16x16x32_bf16 v[20:23], v[76:79], a[112:115], v[20:23]
ds_read_b128 v[108:111], v3 offset:59392
v_mfma_f32_16x16x32_bf16 v[48:51], v[76:79], a[116:119], v[48:51]
ds_read_b128 v[112:115], v3 offset:60416
v_mfma_f32_16x16x32_bf16 v[24:27], v[80:83], a[112:115], v[24:27]
ds_read_b128 v[116:119], v3 offset:61440
v_mfma_f32_16x16x32_bf16 v[52:55], v[80:83], a[116:119], v[52:55]
ds_read_b128 v[120:123], v3 offset:62464
v_mfma_f32_16x16x32_bf16 v[28:31], v[84:87], a[112:115], v[28:31]
ds_read_b128 v[124:127], v3 offset:63488
v_mfma_f32_16x16x32_bf16 v[56:59], v[84:87], a[116:119], v[56:59]
v_mfma_f32_16x16x32_bf16 v[32:35], v[88:91], a[112:115], v[32:35]
v_mfma_f32_16x16x32_bf16 v[60:63], v[88:91], a[116:119], v[60:63]
v_mfma_f32_16x16x32_bf16 v[36:39], v[92:95], a[112:115], v[36:39]
v_mfma_f32_16x16x32_bf16 v[64:67], v[92:95], a[116:119], v[64:67]
v_mfma_f32_16x16x32_bf16 v[40:43], v[96:99], a[112:115], v[40:43]
v_mfma_f32_16x16x32_bf16 v[68:71], v[96:99], a[116:119], v[68:71]
s_waitcnt vmcnt(20)
s_barrier
s_waitcnt lgkmcnt(0)
v_mfma_f32_16x16x32_bf16 v[16:19], v[100:103], a[120:123], v[16:19]
ds_read_b128 v[72:75], v4 offset:0
s_add_u32 s56, s65, 16384
buffer_load_dwordx4 a[96:99], v12, s[4:7], s56 offen
v_mfma_f32_16x16x32_bf16 v[44:47], v[100:103], a[124:127], v[44:47]
ds_read_b128 v[76:79], v4 offset:1024
s_add_u32 s56, s65, 204800
v_mfma_f32_16x16x32_bf16 v[20:23], v[104:107], a[120:123], v[20:23]
ds_read_b128 v[80:83], v4 offset:2048
buffer_load_dwordx4 a[100:103], v12, s[4:7], s56 offen
s_add_u32 s56, s65, 17408
v_mfma_f32_16x16x32_bf16 v[48:51], v[104:107], a[124:127], v[48:51]
ds_read_b128 v[84:87], v4 offset:3072
buffer_load_dwordx4 a[104:107], v12, s[4:7], s56 offen
v_mfma_f32_16x16x32_bf16 v[24:27], v[108:111], a[120:123], v[24:27]
ds_read_b128 v[88:91], v4 offset:4096
s_add_u32 s56, s65, 205824
buffer_load_dwordx4 a[108:111], v12, s[4:7], s56 offen
v_mfma_f32_16x16x32_bf16 v[52:55], v[108:111], a[124:127], v[52:55]
ds_read_b128 v[92:95], v4 offset:5120
s_add_u32 m0, s54, 32768
v_mfma_f32_16x16x32_bf16 v[28:31], v[112:115], a[120:123], v[28:31]
ds_read_b128 v[96:99], v4 offset:6144
s_add_u32 s55, s61, 630784
v_mfma_f32_16x16x32_bf16 v[56:59], v[112:115], a[124:127], v[56:59]
buffer_load_dwordx4 v12, s[4:7], s55 offen lds
s_add_u32 m0, s54, 33792
v_mfma_f32_16x16x32_bf16 v[32:35], v[116:119], a[120:123], v[32:35]
s_add_u32 s55, s63, 630784
v_mfma_f32_16x16x32_bf16 v[60:63], v[116:119], a[124:127], v[60:63]
buffer_load_dwordx4 v12, s[4:7], s55 offen lds
s_add_u32 m0, s54, 40960
v_mfma_f32_16x16x32_bf16 v[36:39], v[120:123], a[120:123], v[36:39]
s_add_u32 s55, s61, 659456
v_mfma_f32_16x16x32_bf16 v[64:67], v[120:123], a[124:127], v[64:67]
buffer_load_dwordx4 v12, s[4:7], s55 offen lds
s_add_u32 m0, s54, 41984
v_mfma_f32_16x16x32_bf16 v[40:43], v[124:127], a[120:123], v[40:43]
s_add_u32 s55, s63, 659456
v_mfma_f32_16x16x32_bf16 v[68:71], v[124:127], a[124:127], v[68:71]
buffer_load_dwordx4 v12, s[4:7], s55 offen lds
s_waitcnt lgkmcnt(0)
v_mfma_f32_16x16x32_bf16 v[16:19], v[72:75], a[128:131], v[16:19]
ds_read_b128 v[100:103], v4 offset:8192
v_mfma_f32_16x16x32_bf16 v[44:47], v[72:75], a[132:135], v[44:47]
ds_read_b128 v[104:107], v4 offset:9216
v_mfma_f32_16x16x32_bf16 v[20:23], v[76:79], a[128:131], v[20:23]
ds_read_b128 v[108:111], v4 offset:10240
v_mfma_f32_16x16x32_bf16 v[48:51], v[76:79], a[132:135], v[48:51]
ds_read_b128 v[112:115], v4 offset:11264
v_mfma_f32_16x16x32_bf16 v[24:27], v[80:83], a[128:131], v[24:27]
ds_read_b128 v[116:119], v4 offset:12288
v_mfma_f32_16x16x32_bf16 v[52:55], v[80:83], a[132:135], v[52:55]
ds_read_b128 v[120:123], v4 offset:13312
v_mfma_f32_16x16x32_bf16 v[28:31], v[84:87], a[128:131], v[28:31]
ds_read_b128 v[124:127], v4 offset:14336
v_mfma_f32_16x16x32_bf16 v[56:59], v[84:87], a[132:135], v[56:59]
v_mfma_f32_16x16x32_bf16 v[32:35], v[88:91], a[128:131], v[32:35]
v_mfma_f32_16x16x32_bf16 v[60:63], v[88:91], a[132:135], v[60:63]
v_mfma_f32_16x16x32_bf16 v[36:39], v[92:95], a[128:131], v[36:39]
v_mfma_f32_16x16x32_bf16 v[64:67], v[92:95], a[132:135], v[64:67]
v_mfma_f32_16x16x32_bf16 v[40:43], v[96:99], a[128:131], v[40:43]
v_mfma_f32_16x16x32_bf16 v[68:71], v[96:99], a[132:135], v[68:71]
s_waitcnt vmcnt(20)
s_barrier
s_waitcnt lgkmcnt(0)
v_mfma_f32_16x16x32_bf16 v[16:19], v[100:103], a[136:139], v[16:19]
ds_read_b128 v[72:75], v4 offset:16384
s_add_u32 s56, s65, 18432
buffer_load_dwordx4 a[112:115], v12, s[4:7], s56 offen
v_mfma_f32_16x16x32_bf16 v[44:47], v[100:103], a[140:143], v[44:47]
ds_read_b128 v[76:79], v4 offset:17408
s_add_u32 s56, s65, 206848
v_mfma_f32_16x16x32_bf16 v[20:23], v[104:107], a[136:139], v[20:23]
ds_read_b128 v[80:83], v4 offset:18432
buffer_load_dwordx4 a[116:119], v12, s[4:7], s56 offen
s_add_u32 s56, s65, 19456
v_mfma_f32_16x16x32_bf16 v[48:51], v[104:107], a[140:143], v[48:51]
ds_read_b128 v[84:87], v4 offset:19456
buffer_load_dwordx4 a[120:123], v12, s[4:7], s56 offen
v_mfma_f32_16x16x32_bf16 v[24:27], v[108:111], a[136:139], v[24:27]
ds_read_b128 v[88:91], v4 offset:20480
s_add_u32 s56, s65, 207872
buffer_load_dwordx4 a[124:127], v12, s[4:7], s56 offen
v_mfma_f32_16x16x32_bf16 v[52:55], v[108:111], a[140:143], v[52:55]
ds_read_b128 v[92:95], v4 offset:21504
s_add_u32 m0, s54, 49152
v_mfma_f32_16x16x32_bf16 v[28:31], v[112:115], a[136:139], v[28:31]
ds_read_b128 v[96:99], v4 offset:22528
s_add_u32 s55, s61, 688128
v_mfma_f32_16x16x32_bf16 v[56:59], v[112:115], a[140:143], v[56:59]
buffer_load_dwordx4 v12, s[4:7], s55 offen lds
s_add_u32 m0, s54, 50176
v_mfma_f32_16x16x32_bf16 v[32:35], v[116:119], a[136:139], v[32:35]
s_add_u32 s55, s63, 688128
v_mfma_f32_16x16x32_bf16 v[60:63], v[116:119], a[140:143], v[60:63]
buffer_load_dwordx4 v12, s[4:7], s55 offen lds
s_add_u32 m0, s54, 57344
v_mfma_f32_16x16x32_bf16 v[36:39], v[120:123], a[136:139], v[36:39]
s_add_u32 s55, s61, 716800
v_mfma_f32_16x16x32_bf16 v[64:67], v[120:123], a[140:143], v[64:67]
buffer_load_dwordx4 v12, s[4:7], s55 offen lds
s_add_u32 m0, s54, 58368
v_mfma_f32_16x16x32_bf16 v[40:43], v[124:127], a[136:139], v[40:43]
s_add_u32 s55, s63, 716800
v_mfma_f32_16x16x32_bf16 v[68:71], v[124:127], a[140:143], v[68:71]
buffer_load_dwordx4 v12, s[4:7], s55 offen lds
s_waitcnt lgkmcnt(0)
v_mfma_f32_16x16x32_bf16 v[16:19], v[72:75], a[144:147], v[16:19]
ds_read_b128 v[100:103], v4 offset:24576
v_mfma_f32_16x16x32_bf16 v[44:47], v[72:75], a[148:151], v[44:47]
ds_read_b128 v[104:107], v4 offset:25600
v_mfma_f32_16x16x32_bf16 v[20:23], v[76:79], a[144:147], v[20:23]
ds_read_b128 v[108:111], v4 offset:26624
v_mfma_f32_16x16x32_bf16 v[48:51], v[76:79], a[148:151], v[48:51]
ds_read_b128 v[112:115], v4 offset:27648
v_mfma_f32_16x16x32_bf16 v[24:27], v[80:83], a[144:147], v[24:27]
ds_read_b128 v[116:119], v4 offset:28672
v_mfma_f32_16x16x32_bf16 v[52:55], v[80:83], a[148:151], v[52:55]
ds_read_b128 v[120:123], v4 offset:29696
v_mfma_f32_16x16x32_bf16 v[28:31], v[84:87], a[144:147], v[28:31]
ds_read_b128 v[124:127], v4 offset:30720
v_mfma_f32_16x16x32_bf16 v[56:59], v[84:87], a[148:151], v[56:59]
v_mfma_f32_16x16x32_bf16 v[32:35], v[88:91], a[144:147], v[32:35]
v_mfma_f32_16x16x32_bf16 v[60:63], v[88:91], a[148:151], v[60:63]
v_mfma_f32_16x16x32_bf16 v[36:39], v[92:95], a[144:147], v[36:39]
v_mfma_f32_16x16x32_bf16 v[64:67], v[92:95], a[148:151], v[64:67]
v_mfma_f32_16x16x32_bf16 v[40:43], v[96:99], a[144:147], v[40:43]
v_mfma_f32_16x16x32_bf16 v[68:71], v[96:99], a[148:151], v[68:71]
s_waitcnt vmcnt(20)
s_barrier
s_waitcnt lgkmcnt(0)
v_mfma_f32_16x16x32_bf16 v[16:19], v[100:103], a[152:155], v[16:19]
ds_read_b128 v[72:75], v4 offset:32768
s_add_u32 s56, s65, 20480
buffer_load_dwordx4 a[128:131], v12, s[4:7], s56 offen
v_mfma_f32_16x16x32_bf16 v[44:47], v[100:103], a[156:159], v[44:47]
ds_read_b128 v[76:79], v4 offset:33792
s_add_u32 s56, s65, 208896
v_mfma_f32_16x16x32_bf16 v[20:23], v[104:107], a[152:155], v[20:23]
ds_read_b128 v[80:83], v4 offset:34816
buffer_load_dwordx4 a[132:135], v12, s[4:7], s56 offen
s_add_u32 s56, s65, 21504
v_mfma_f32_16x16x32_bf16 v[48:51], v[104:107], a[156:159], v[48:51]
ds_read_b128 v[84:87], v4 offset:35840
buffer_load_dwordx4 a[136:139], v12, s[4:7], s56 offen
v_mfma_f32_16x16x32_bf16 v[24:27], v[108:111], a[152:155], v[24:27]
ds_read_b128 v[88:91], v4 offset:36864
s_add_u32 s56, s65, 209920
buffer_load_dwordx4 a[140:143], v12, s[4:7], s56 offen
v_mfma_f32_16x16x32_bf16 v[52:55], v[108:111], a[156:159], v[52:55]
ds_read_b128 v[92:95], v4 offset:37888
s_add_u32 m0, s54, 65536
v_mfma_f32_16x16x32_bf16 v[28:31], v[112:115], a[152:155], v[28:31]
ds_read_b128 v[96:99], v4 offset:38912
s_add_u32 s55, s61, 745472
v_mfma_f32_16x16x32_bf16 v[56:59], v[112:115], a[156:159], v[56:59]
buffer_load_dwordx4 v12, s[4:7], s55 offen lds
s_add_u32 m0, s54, 66560
v_mfma_f32_16x16x32_bf16 v[32:35], v[116:119], a[152:155], v[32:35]
s_add_u32 s55, s63, 745472
v_mfma_f32_16x16x32_bf16 v[60:63], v[116:119], a[156:159], v[60:63]
buffer_load_dwordx4 v12, s[4:7], s55 offen lds
s_add_u32 m0, s54, 73728
v_mfma_f32_16x16x32_bf16 v[36:39], v[120:123], a[152:155], v[36:39]
s_add_u32 s55, s61, 774144
v_mfma_f32_16x16x32_bf16 v[64:67], v[120:123], a[156:159], v[64:67]
buffer_load_dwordx4 v12, s[4:7], s55 offen lds
s_add_u32 m0, s54, 74752
v_mfma_f32_16x16x32_bf16 v[40:43], v[124:127], a[152:155], v[40:43]
s_add_u32 s55, s63, 774144
v_mfma_f32_16x16x32_bf16 v[68:71], v[124:127], a[156:159], v[68:71]
buffer_load_dwordx4 v12, s[4:7], s55 offen lds
s_waitcnt lgkmcnt(0)
v_mfma_f32_16x16x32_bf16 v[16:19], v[72:75], a[160:163], v[16:19]
ds_read_b128 v[100:103], v4 offset:40960
v_mfma_f32_16x16x32_bf16 v[44:47], v[72:75], a[164:167], v[44:47]
ds_read_b128 v[104:107], v4 offset:41984
v_mfma_f32_16x16x32_bf16 v[20:23], v[76:79], a[160:163], v[20:23]
ds_read_b128 v[108:111], v4 offset:43008
v_mfma_f32_16x16x32_bf16 v[48:51], v[76:79], a[164:167], v[48:51]
ds_read_b128 v[112:115], v4 offset:44032
v_mfma_f32_16x16x32_bf16 v[24:27], v[80:83], a[160:163], v[24:27]
ds_read_b128 v[116:119], v4 offset:45056
v_mfma_f32_16x16x32_bf16 v[52:55], v[80:83], a[164:167], v[52:55]
ds_read_b128 v[120:123], v4 offset:46080
v_mfma_f32_16x16x32_bf16 v[28:31], v[84:87], a[160:163], v[28:31]
ds_read_b128 v[124:127], v4 offset:47104
v_mfma_f32_16x16x32_bf16 v[56:59], v[84:87], a[164:167], v[56:59]
v_mfma_f32_16x16x32_bf16 v[32:35], v[88:91], a[160:163], v[32:35]
v_mfma_f32_16x16x32_bf16 v[60:63], v[88:91], a[164:167], v[60:63]
v_mfma_f32_16x16x32_bf16 v[36:39], v[92:95], a[160:163], v[36:39]
v_mfma_f32_16x16x32_bf16 v[64:67], v[92:95], a[164:167], v[64:67]
v_mfma_f32_16x16x32_bf16 v[40:43], v[96:99], a[160:163], v[40:43]
v_mfma_f32_16x16x32_bf16 v[68:71], v[96:99], a[164:167], v[68:71]
s_waitcnt vmcnt(20)
s_barrier
s_waitcnt lgkmcnt(0)
v_mfma_f32_16x16x32_bf16 v[16:19], v[100:103], a[168:171], v[16:19]
ds_read_b128 v[72:75], v4 offset:49152
s_add_u32 s56, s65, 22528
buffer_load_dwordx4 a[144:147], v12, s[4:7], s56 offen
v_mfma_f32_16x16x32_bf16 v[44:47], v[100:103], a[172:175], v[44:47]
ds_read_b128 v[76:79], v4 offset:50176
s_add_u32 s56, s65, 210944
v_mfma_f32_16x16x32_bf16 v[20:23], v[104:107], a[168:171], v[20:23]
ds_read_b128 v[80:83], v4 offset:51200
buffer_load_dwordx4 a[148:151], v12, s[4:7], s56 offen
s_add_u32 s56, s65, 23552
v_mfma_f32_16x16x32_bf16 v[48:51], v[104:107], a[172:175], v[48:51]
ds_read_b128 v[84:87], v4 offset:52224
buffer_load_dwordx4 a[152:155], v12, s[4:7], s56 offen
v_mfma_f32_16x16x32_bf16 v[24:27], v[108:111], a[168:171], v[24:27]
ds_read_b128 v[88:91], v4 offset:53248
s_add_u32 s56, s65, 211968
buffer_load_dwordx4 a[156:159], v12, s[4:7], s56 offen
v_mfma_f32_16x16x32_bf16 v[52:55], v[108:111], a[172:175], v[52:55]
ds_read_b128 v[92:95], v4 offset:54272
s_add_u32 m0, s54, 81920
v_mfma_f32_16x16x32_bf16 v[28:31], v[112:115], a[168:171], v[28:31]
ds_read_b128 v[96:99], v4 offset:55296
s_add_u32 s55, s61, 802816
v_mfma_f32_16x16x32_bf16 v[56:59], v[112:115], a[172:175], v[56:59]
buffer_load_dwordx4 v12, s[4:7], s55 offen lds
s_add_u32 m0, s54, 82944
v_mfma_f32_16x16x32_bf16 v[32:35], v[116:119], a[168:171], v[32:35]
s_add_u32 s55, s63, 802816
v_mfma_f32_16x16x32_bf16 v[60:63], v[116:119], a[172:175], v[60:63]
buffer_load_dwordx4 v12, s[4:7], s55 offen lds
s_add_u32 m0, s54, 90112
v_mfma_f32_16x16x32_bf16 v[36:39], v[120:123], a[168:171], v[36:39]
s_add_u32 s55, s61, 831488
v_mfma_f32_16x16x32_bf16 v[64:67], v[120:123], a[172:175], v[64:67]
buffer_load_dwordx4 v12, s[4:7], s55 offen lds
s_add_u32 m0, s54, 91136
v_mfma_f32_16x16x32_bf16 v[40:43], v[124:127], a[168:171], v[40:43]
s_add_u32 s55, s63, 831488
v_mfma_f32_16x16x32_bf16 v[68:71], v[124:127], a[172:175], v[68:71]
buffer_load_dwordx4 v12, s[4:7], s55 offen lds
s_waitcnt lgkmcnt(0)
v_mfma_f32_16x16x32_bf16 v[16:19], v[72:75], a[96:99], v[16:19]
ds_read_b128 v[100:103], v4 offset:57344
v_mfma_f32_16x16x32_bf16 v[44:47], v[72:75], a[100:103], v[44:47]
ds_read_b128 v[104:107], v4 offset:58368
v_mfma_f32_16x16x32_bf16 v[20:23], v[76:79], a[96:99], v[20:23]
ds_read_b128 v[108:111], v4 offset:59392
v_mfma_f32_16x16x32_bf16 v[48:51], v[76:79], a[100:103], v[48:51]
ds_read_b128 v[112:115], v4 offset:60416
v_mfma_f32_16x16x32_bf16 v[24:27], v[80:83], a[96:99], v[24:27]
ds_read_b128 v[116:119], v4 offset:61440
v_mfma_f32_16x16x32_bf16 v[52:55], v[80:83], a[100:103], v[52:55]
ds_read_b128 v[120:123], v4 offset:62464
v_mfma_f32_16x16x32_bf16 v[28:31], v[84:87], a[96:99], v[28:31]
ds_read_b128 v[124:127], v4 offset:63488
v_mfma_f32_16x16x32_bf16 v[56:59], v[84:87], a[100:103], v[56:59]
v_mfma_f32_16x16x32_bf16 v[32:35], v[88:91], a[96:99], v[32:35]
v_mfma_f32_16x16x32_bf16 v[60:63], v[88:91], a[100:103], v[60:63]
v_mfma_f32_16x16x32_bf16 v[36:39], v[92:95], a[96:99], v[36:39]
v_mfma_f32_16x16x32_bf16 v[64:67], v[92:95], a[100:103], v[64:67]
v_mfma_f32_16x16x32_bf16 v[40:43], v[96:99], a[96:99], v[40:43]
v_mfma_f32_16x16x32_bf16 v[68:71], v[96:99], a[100:103], v[68:71]
s_waitcnt vmcnt(20)
s_barrier
s_waitcnt lgkmcnt(0)
v_mfma_f32_16x16x32_bf16 v[16:19], v[100:103], a[104:107], v[16:19]
ds_read_b128 v[72:75], v3 offset:0
s_add_u32 s56, s65, 24576
buffer_load_dwordx4 a[160:163], v12, s[4:7], s56 offen
v_mfma_f32_16x16x32_bf16 v[44:47], v[100:103], a[108:111], v[44:47]
ds_read_b128 v[76:79], v3 offset:1024
s_add_u32 s56, s65, 212992
v_mfma_f32_16x16x32_bf16 v[20:23], v[104:107], a[104:107], v[20:23]
ds_read_b128 v[80:83], v3 offset:2048
buffer_load_dwordx4 a[164:167], v12, s[4:7], s56 offen
s_add_u32 s56, s65, 25600
v_mfma_f32_16x16x32_bf16 v[48:51], v[104:107], a[108:111], v[48:51]
ds_read_b128 v[84:87], v3 offset:3072
buffer_load_dwordx4 a[168:171], v12, s[4:7], s56 offen
v_mfma_f32_16x16x32_bf16 v[24:27], v[108:111], a[104:107], v[24:27]
ds_read_b128 v[88:91], v3 offset:4096
s_add_u32 s56, s65, 214016
buffer_load_dwordx4 a[172:175], v12, s[4:7], s56 offen
v_mfma_f32_16x16x32_bf16 v[52:55], v[108:111], a[108:111], v[52:55]
ds_read_b128 v[92:95], v3 offset:5120
s_add_u32 m0, s54, 98304
v_mfma_f32_16x16x32_bf16 v[28:31], v[112:115], a[104:107], v[28:31]
ds_read_b128 v[96:99], v3 offset:6144
s_add_u32 s55, s61, 860160
v_mfma_f32_16x16x32_bf16 v[56:59], v[112:115], a[108:111], v[56:59]
buffer_load_dwordx4 v12, s[4:7], s55 offen lds
s_add_u32 m0, s54, 99328
v_mfma_f32_16x16x32_bf16 v[32:35], v[116:119], a[104:107], v[32:35]
s_add_u32 s55, s63, 860160
v_mfma_f32_16x16x32_bf16 v[60:63], v[116:119], a[108:111], v[60:63]
buffer_load_dwordx4 v12, s[4:7], s55 offen lds
s_add_u32 m0, s54, 106496
v_mfma_f32_16x16x32_bf16 v[36:39], v[120:123], a[104:107], v[36:39]
s_add_u32 s55, s61, 888832
v_mfma_f32_16x16x32_bf16 v[64:67], v[120:123], a[108:111], v[64:67]
buffer_load_dwordx4 v12, s[4:7], s55 offen lds
s_add_u32 m0, s54, 107520
v_mfma_f32_16x16x32_bf16 v[40:43], v[124:127], a[104:107], v[40:43]
s_add_u32 s55, s63, 888832
v_mfma_f32_16x16x32_bf16 v[68:71], v[124:127], a[108:111], v[68:71]
buffer_load_dwordx4 v12, s[4:7], s55 offen lds
s_waitcnt lgkmcnt(0)
v_mfma_f32_16x16x32_bf16 v[16:19], v[72:75], a[112:115], v[16:19]
ds_read_b128 v[100:103], v3 offset:8192
v_mfma_f32_16x16x32_bf16 v[44:47], v[72:75], a[116:119], v[44:47]
ds_read_b128 v[104:107], v3 offset:9216
v_mfma_f32_16x16x32_bf16 v[20:23], v[76:79], a[112:115], v[20:23]
ds_read_b128 v[108:111], v3 offset:10240
v_mfma_f32_16x16x32_bf16 v[48:51], v[76:79], a[116:119], v[48:51]
ds_read_b128 v[112:115], v3 offset:11264
v_mfma_f32_16x16x32_bf16 v[24:27], v[80:83], a[112:115], v[24:27]
ds_read_b128 v[116:119], v3 offset:12288
v_mfma_f32_16x16x32_bf16 v[52:55], v[80:83], a[116:119], v[52:55]
ds_read_b128 v[120:123], v3 offset:13312
v_mfma_f32_16x16x32_bf16 v[28:31], v[84:87], a[112:115], v[28:31]
ds_read_b128 v[124:127], v3 offset:14336
v_mfma_f32_16x16x32_bf16 v[56:59], v[84:87], a[116:119], v[56:59]
v_mfma_f32_16x16x32_bf16 v[32:35], v[88:91], a[112:115], v[32:35]
v_mfma_f32_16x16x32_bf16 v[60:63], v[88:91], a[116:119], v[60:63]
v_mfma_f32_16x16x32_bf16 v[36:39], v[92:95], a[112:115], v[36:39]
v_mfma_f32_16x16x32_bf16 v[64:67], v[92:95], a[116:119], v[64:67]
v_mfma_f32_16x16x32_bf16 v[40:43], v[96:99], a[112:115], v[40:43]
v_mfma_f32_16x16x32_bf16 v[68:71], v[96:99], a[116:119], v[68:71]
s_waitcnt vmcnt(20)
s_barrier
s_waitcnt lgkmcnt(0)
v_mfma_f32_16x16x32_bf16 v[16:19], v[100:103], a[120:123], v[16:19]
ds_read_b128 v[72:75], v3 offset:16384
s_add_u32 s56, s65, 26624
v_mfma_f32_16x16x32_bf16 v[44:47], v[100:103], a[124:127], v[44:47]
ds_read_b128 v[76:79], v3 offset:17408
buffer_load_dwordx4 a[96:99], v12, s[4:7], s56 offen
v_mfma_f32_16x16x32_bf16 v[20:23], v[104:107], a[120:123], v[20:23]
ds_read_b128 v[80:83], v3 offset:18432
v_mfma_f32_16x16x32_bf16 v[48:51], v[104:107], a[124:127], v[48:51]
ds_read_b128 v[84:87], v3 offset:19456
s_add_u32 s56, s65, 215040
v_mfma_f32_16x16x32_bf16 v[24:27], v[108:111], a[120:123], v[24:27]
ds_read_b128 v[88:91], v3 offset:20480
v_mfma_f32_16x16x32_bf16 v[52:55], v[108:111], a[124:127], v[52:55]
ds_read_b128 v[92:95], v3 offset:21504
buffer_load_dwordx4 a[100:103], v12, s[4:7], s56 offen
v_mfma_f32_16x16x32_bf16 v[28:31], v[112:115], a[120:123], v[28:31]
ds_read_b128 v[96:99], v3 offset:22528
v_mfma_f32_16x16x32_bf16 v[56:59], v[112:115], a[124:127], v[56:59]
s_add_u32 s56, s65, 27648
v_mfma_f32_16x16x32_bf16 v[32:35], v[116:119], a[120:123], v[32:35]
buffer_load_dwordx4 a[104:107], v12, s[4:7], s56 offen
v_mfma_f32_16x16x32_bf16 v[60:63], v[116:119], a[124:127], v[60:63]
v_mfma_f32_16x16x32_bf16 v[36:39], v[120:123], a[120:123], v[36:39]
s_add_u32 s56, s65, 216064
v_mfma_f32_16x16x32_bf16 v[64:67], v[120:123], a[124:127], v[64:67]
v_mfma_f32_16x16x32_bf16 v[40:43], v[124:127], a[120:123], v[40:43]
buffer_load_dwordx4 a[108:111], v12, s[4:7], s56 offen
v_mfma_f32_16x16x32_bf16 v[68:71], v[124:127], a[124:127], v[68:71]
s_waitcnt lgkmcnt(0)
v_mfma_f32_16x16x32_bf16 v[16:19], v[72:75], a[128:131], v[16:19]
ds_read_b128 v[100:103], v3 offset:24576
v_mfma_f32_16x16x32_bf16 v[44:47], v[72:75], a[132:135], v[44:47]
ds_read_b128 v[104:107], v3 offset:25600
v_mfma_f32_16x16x32_bf16 v[20:23], v[76:79], a[128:131], v[20:23]
ds_read_b128 v[108:111], v3 offset:26624
v_mfma_f32_16x16x32_bf16 v[48:51], v[76:79], a[132:135], v[48:51]
ds_read_b128 v[112:115], v3 offset:27648
v_mfma_f32_16x16x32_bf16 v[24:27], v[80:83], a[128:131], v[24:27]
ds_read_b128 v[116:119], v3 offset:28672
v_mfma_f32_16x16x32_bf16 v[52:55], v[80:83], a[132:135], v[52:55]
ds_read_b128 v[120:123], v3 offset:29696
v_mfma_f32_16x16x32_bf16 v[28:31], v[84:87], a[128:131], v[28:31]
ds_read_b128 v[124:127], v3 offset:30720
v_mfma_f32_16x16x32_bf16 v[56:59], v[84:87], a[132:135], v[56:59]
v_mfma_f32_16x16x32_bf16 v[32:35], v[88:91], a[128:131], v[32:35]
v_mfma_f32_16x16x32_bf16 v[60:63], v[88:91], a[132:135], v[60:63]
v_mfma_f32_16x16x32_bf16 v[36:39], v[92:95], a[128:131], v[36:39]
v_mfma_f32_16x16x32_bf16 v[64:67], v[92:95], a[132:135], v[64:67]
v_mfma_f32_16x16x32_bf16 v[40:43], v[96:99], a[128:131], v[40:43]
v_mfma_f32_16x16x32_bf16 v[68:71], v[96:99], a[132:135], v[68:71]
s_waitcnt vmcnt(16)
s_barrier
s_waitcnt lgkmcnt(0)
v_mfma_f32_16x16x32_bf16 v[16:19], v[100:103], a[136:139], v[16:19]
ds_read_b128 v[72:75], v3 offset:32768
s_add_u32 s56, s65, 28672
v_mfma_f32_16x16x32_bf16 v[44:47], v[100:103], a[140:143], v[44:47]
ds_read_b128 v[76:79], v3 offset:33792
buffer_load_dwordx4 a[112:115], v12, s[4:7], s56 offen
v_mfma_f32_16x16x32_bf16 v[20:23], v[104:107], a[136:139], v[20:23]
ds_read_b128 v[80:83], v3 offset:34816
v_mfma_f32_16x16x32_bf16 v[48:51], v[104:107], a[140:143], v[48:51]
ds_read_b128 v[84:87], v3 offset:35840
s_add_u32 s56, s65, 217088
v_mfma_f32_16x16x32_bf16 v[24:27], v[108:111], a[136:139], v[24:27]
ds_read_b128 v[88:91], v3 offset:36864
v_mfma_f32_16x16x32_bf16 v[52:55], v[108:111], a[140:143], v[52:55]
ds_read_b128 v[92:95], v3 offset:37888
buffer_load_dwordx4 a[116:119], v12, s[4:7], s56 offen
v_mfma_f32_16x16x32_bf16 v[28:31], v[112:115], a[136:139], v[28:31]
ds_read_b128 v[96:99], v3 offset:38912
v_mfma_f32_16x16x32_bf16 v[56:59], v[112:115], a[140:143], v[56:59]
s_add_u32 s56, s65, 29696
v_mfma_f32_16x16x32_bf16 v[32:35], v[116:119], a[136:139], v[32:35]
buffer_load_dwordx4 a[120:123], v12, s[4:7], s56 offen
v_mfma_f32_16x16x32_bf16 v[60:63], v[116:119], a[140:143], v[60:63]
v_mfma_f32_16x16x32_bf16 v[36:39], v[120:123], a[136:139], v[36:39]
s_add_u32 s56, s65, 218112
v_mfma_f32_16x16x32_bf16 v[64:67], v[120:123], a[140:143], v[64:67]
v_mfma_f32_16x16x32_bf16 v[40:43], v[124:127], a[136:139], v[40:43]
buffer_load_dwordx4 a[124:127], v12, s[4:7], s56 offen
v_mfma_f32_16x16x32_bf16 v[68:71], v[124:127], a[140:143], v[68:71]
s_waitcnt lgkmcnt(0)
v_mfma_f32_16x16x32_bf16 v[16:19], v[72:75], a[144:147], v[16:19]
ds_read_b128 v[100:103], v3 offset:40960
v_mfma_f32_16x16x32_bf16 v[44:47], v[72:75], a[148:151], v[44:47]
ds_read_b128 v[104:107], v3 offset:41984
v_mfma_f32_16x16x32_bf16 v[20:23], v[76:79], a[144:147], v[20:23]
ds_read_b128 v[108:111], v3 offset:43008
v_mfma_f32_16x16x32_bf16 v[48:51], v[76:79], a[148:151], v[48:51]
ds_read_b128 v[112:115], v3 offset:44032
v_mfma_f32_16x16x32_bf16 v[24:27], v[80:83], a[144:147], v[24:27]
ds_read_b128 v[116:119], v3 offset:45056
v_mfma_f32_16x16x32_bf16 v[52:55], v[80:83], a[148:151], v[52:55]
ds_read_b128 v[120:123], v3 offset:46080
v_mfma_f32_16x16x32_bf16 v[28:31], v[84:87], a[144:147], v[28:31]
ds_read_b128 v[124:127], v3 offset:47104
v_mfma_f32_16x16x32_bf16 v[56:59], v[84:87], a[148:151], v[56:59]
v_mfma_f32_16x16x32_bf16 v[32:35], v[88:91], a[144:147], v[32:35]
v_mfma_f32_16x16x32_bf16 v[60:63], v[88:91], a[148:151], v[60:63]
v_mfma_f32_16x16x32_bf16 v[36:39], v[92:95], a[144:147], v[36:39]
v_mfma_f32_16x16x32_bf16 v[64:67], v[92:95], a[148:151], v[64:67]
v_mfma_f32_16x16x32_bf16 v[40:43], v[96:99], a[144:147], v[40:43]
v_mfma_f32_16x16x32_bf16 v[68:71], v[96:99], a[148:151], v[68:71]
s_waitcnt vmcnt(12)
s_barrier
s_waitcnt lgkmcnt(0)
v_mfma_f32_16x16x32_bf16 v[16:19], v[100:103], a[152:155], v[16:19]
ds_read_b128 v[72:75], v3 offset:49152
s_add_u32 s56, s65, 30720
v_mfma_f32_16x16x32_bf16 v[44:47], v[100:103], a[156:159], v[44:47]
ds_read_b128 v[76:79], v3 offset:50176
buffer_load_dwordx4 a[128:131], v12, s[4:7], s56 offen
v_mfma_f32_16x16x32_bf16 v[20:23], v[104:107], a[152:155], v[20:23]
ds_read_b128 v[80:83], v3 offset:51200
v_mfma_f32_16x16x32_bf16 v[48:51], v[104:107], a[156:159], v[48:51]
ds_read_b128 v[84:87], v3 offset:52224
s_add_u32 s56, s65, 219136
v_mfma_f32_16x16x32_bf16 v[24:27], v[108:111], a[152:155], v[24:27]
ds_read_b128 v[88:91], v3 offset:53248
v_mfma_f32_16x16x32_bf16 v[52:55], v[108:111], a[156:159], v[52:55]
ds_read_b128 v[92:95], v3 offset:54272
buffer_load_dwordx4 a[132:135], v12, s[4:7], s56 offen
v_mfma_f32_16x16x32_bf16 v[28:31], v[112:115], a[152:155], v[28:31]
ds_read_b128 v[96:99], v3 offset:55296
v_mfma_f32_16x16x32_bf16 v[56:59], v[112:115], a[156:159], v[56:59]
s_add_u32 s56, s65, 31744
v_mfma_f32_16x16x32_bf16 v[32:35], v[116:119], a[152:155], v[32:35]
buffer_load_dwordx4 a[136:139], v12, s[4:7], s56 offen
v_mfma_f32_16x16x32_bf16 v[60:63], v[116:119], a[156:159], v[60:63]
v_mfma_f32_16x16x32_bf16 v[36:39], v[120:123], a[152:155], v[36:39]
s_add_u32 s56, s65, 220160
v_mfma_f32_16x16x32_bf16 v[64:67], v[120:123], a[156:159], v[64:67]
v_mfma_f32_16x16x32_bf16 v[40:43], v[124:127], a[152:155], v[40:43]
buffer_load_dwordx4 a[140:143], v12, s[4:7], s56 offen
v_mfma_f32_16x16x32_bf16 v[68:71], v[124:127], a[156:159], v[68:71]
s_waitcnt lgkmcnt(0)
v_mfma_f32_16x16x32_bf16 v[16:19], v[72:75], a[160:163], v[16:19]
ds_read_b128 v[100:103], v3 offset:57344
v_mfma_f32_16x16x32_bf16 v[44:47], v[72:75], a[164:167], v[44:47]
ds_read_b128 v[104:107], v3 offset:58368
v_mfma_f32_16x16x32_bf16 v[20:23], v[76:79], a[160:163], v[20:23]
ds_read_b128 v[108:111], v3 offset:59392
v_mfma_f32_16x16x32_bf16 v[48:51], v[76:79], a[164:167], v[48:51]
ds_read_b128 v[112:115], v3 offset:60416
v_mfma_f32_16x16x32_bf16 v[24:27], v[80:83], a[160:163], v[24:27]
ds_read_b128 v[116:119], v3 offset:61440
v_mfma_f32_16x16x32_bf16 v[52:55], v[80:83], a[164:167], v[52:55]
ds_read_b128 v[120:123], v3 offset:62464
v_mfma_f32_16x16x32_bf16 v[28:31], v[84:87], a[160:163], v[28:31]
ds_read_b128 v[124:127], v3 offset:63488
v_mfma_f32_16x16x32_bf16 v[56:59], v[84:87], a[164:167], v[56:59]
v_mfma_f32_16x16x32_bf16 v[32:35], v[88:91], a[160:163], v[32:35]
v_mfma_f32_16x16x32_bf16 v[60:63], v[88:91], a[164:167], v[60:63]
v_mfma_f32_16x16x32_bf16 v[36:39], v[92:95], a[160:163], v[36:39]
v_mfma_f32_16x16x32_bf16 v[64:67], v[92:95], a[164:167], v[64:67]
v_mfma_f32_16x16x32_bf16 v[40:43], v[96:99], a[160:163], v[40:43]
v_mfma_f32_16x16x32_bf16 v[68:71], v[96:99], a[164:167], v[68:71]
s_waitcnt vmcnt(8)
s_barrier
s_waitcnt lgkmcnt(0)
v_mfma_f32_16x16x32_bf16 v[16:19], v[100:103], a[168:171], v[16:19]
ds_read_b128 v[72:75], v4 offset:0
v_mfma_f32_16x16x32_bf16 v[44:47], v[100:103], a[172:175], v[44:47]
ds_read_b128 v[76:79], v4 offset:1024
v_mfma_f32_16x16x32_bf16 v[20:23], v[104:107], a[168:171], v[20:23]
ds_read_b128 v[80:83], v4 offset:2048
v_mfma_f32_16x16x32_bf16 v[48:51], v[104:107], a[172:175], v[48:51]
ds_read_b128 v[84:87], v4 offset:3072
v_mfma_f32_16x16x32_bf16 v[24:27], v[108:111], a[168:171], v[24:27]
ds_read_b128 v[88:91], v4 offset:4096
v_mfma_f32_16x16x32_bf16 v[52:55], v[108:111], a[172:175], v[52:55]
ds_read_b128 v[92:95], v4 offset:5120
v_mfma_f32_16x16x32_bf16 v[28:31], v[112:115], a[168:171], v[28:31]
ds_read_b128 v[96:99], v4 offset:6144
v_mfma_f32_16x16x32_bf16 v[56:59], v[112:115], a[172:175], v[56:59]
v_mfma_f32_16x16x32_bf16 v[32:35], v[116:119], a[168:171], v[32:35]
v_mfma_f32_16x16x32_bf16 v[60:63], v[116:119], a[172:175], v[60:63]
v_mfma_f32_16x16x32_bf16 v[36:39], v[120:123], a[168:171], v[36:39]
v_mfma_f32_16x16x32_bf16 v[64:67], v[120:123], a[172:175], v[64:67]
v_mfma_f32_16x16x32_bf16 v[40:43], v[124:127], a[168:171], v[40:43]
v_mfma_f32_16x16x32_bf16 v[68:71], v[124:127], a[172:175], v[68:71]
s_waitcnt lgkmcnt(0)
v_mfma_f32_16x16x32_bf16 v[16:19], v[72:75], a[96:99], v[16:19]
ds_read_b128 v[100:103], v4 offset:8192
v_mfma_f32_16x16x32_bf16 v[44:47], v[72:75], a[100:103], v[44:47]
ds_read_b128 v[104:107], v4 offset:9216
v_mfma_f32_16x16x32_bf16 v[20:23], v[76:79], a[96:99], v[20:23]
ds_read_b128 v[108:111], v4 offset:10240
v_mfma_f32_16x16x32_bf16 v[48:51], v[76:79], a[100:103], v[48:51]
ds_read_b128 v[112:115], v4 offset:11264
v_mfma_f32_16x16x32_bf16 v[24:27], v[80:83], a[96:99], v[24:27]
ds_read_b128 v[116:119], v4 offset:12288
v_mfma_f32_16x16x32_bf16 v[52:55], v[80:83], a[100:103], v[52:55]
ds_read_b128 v[120:123], v4 offset:13312
v_mfma_f32_16x16x32_bf16 v[28:31], v[84:87], a[96:99], v[28:31]
ds_read_b128 v[124:127], v4 offset:14336
v_mfma_f32_16x16x32_bf16 v[56:59], v[84:87], a[100:103], v[56:59]
v_mfma_f32_16x16x32_bf16 v[32:35], v[88:91], a[96:99], v[32:35]
v_mfma_f32_16x16x32_bf16 v[60:63], v[88:91], a[100:103], v[60:63]
v_mfma_f32_16x16x32_bf16 v[36:39], v[92:95], a[96:99], v[36:39]
v_mfma_f32_16x16x32_bf16 v[64:67], v[92:95], a[100:103], v[64:67]
v_mfma_f32_16x16x32_bf16 v[40:43], v[96:99], a[96:99], v[40:43]
v_mfma_f32_16x16x32_bf16 v[68:71], v[96:99], a[100:103], v[68:71]
s_waitcnt vmcnt(4)
s_barrier
s_waitcnt lgkmcnt(0)
v_mfma_f32_16x16x32_bf16 v[16:19], v[100:103], a[104:107], v[16:19]
ds_read_b128 v[72:75], v4 offset:16384
v_mfma_f32_16x16x32_bf16 v[44:47], v[100:103], a[108:111], v[44:47]
ds_read_b128 v[76:79], v4 offset:17408
v_mfma_f32_16x16x32_bf16 v[20:23], v[104:107], a[104:107], v[20:23]
ds_read_b128 v[80:83], v4 offset:18432
v_mfma_f32_16x16x32_bf16 v[48:51], v[104:107], a[108:111], v[48:51]
ds_read_b128 v[84:87], v4 offset:19456
v_mfma_f32_16x16x32_bf16 v[24:27], v[108:111], a[104:107], v[24:27]
ds_read_b128 v[88:91], v4 offset:20480
v_mfma_f32_16x16x32_bf16 v[52:55], v[108:111], a[108:111], v[52:55]
ds_read_b128 v[92:95], v4 offset:21504
v_mfma_f32_16x16x32_bf16 v[28:31], v[112:115], a[104:107], v[28:31]
ds_read_b128 v[96:99], v4 offset:22528
v_mfma_f32_16x16x32_bf16 v[56:59], v[112:115], a[108:111], v[56:59]
v_mfma_f32_16x16x32_bf16 v[32:35], v[116:119], a[104:107], v[32:35]
v_mfma_f32_16x16x32_bf16 v[60:63], v[116:119], a[108:111], v[60:63]
v_mfma_f32_16x16x32_bf16 v[36:39], v[120:123], a[104:107], v[36:39]
v_mfma_f32_16x16x32_bf16 v[64:67], v[120:123], a[108:111], v[64:67]
v_mfma_f32_16x16x32_bf16 v[40:43], v[124:127], a[104:107], v[40:43]
v_mfma_f32_16x16x32_bf16 v[68:71], v[124:127], a[108:111], v[68:71]
s_waitcnt lgkmcnt(0)
v_mfma_f32_16x16x32_bf16 v[16:19], v[72:75], a[112:115], v[16:19]
ds_read_b128 v[100:103], v4 offset:24576
v_mfma_f32_16x16x32_bf16 v[44:47], v[72:75], a[116:119], v[44:47]
ds_read_b128 v[104:107], v4 offset:25600
v_mfma_f32_16x16x32_bf16 v[20:23], v[76:79], a[112:115], v[20:23]
ds_read_b128 v[108:111], v4 offset:26624
v_mfma_f32_16x16x32_bf16 v[48:51], v[76:79], a[116:119], v[48:51]
ds_read_b128 v[112:115], v4 offset:27648
v_mfma_f32_16x16x32_bf16 v[24:27], v[80:83], a[112:115], v[24:27]
ds_read_b128 v[116:119], v4 offset:28672
v_mfma_f32_16x16x32_bf16 v[52:55], v[80:83], a[116:119], v[52:55]
ds_read_b128 v[120:123], v4 offset:29696
v_mfma_f32_16x16x32_bf16 v[28:31], v[84:87], a[112:115], v[28:31]
ds_read_b128 v[124:127], v4 offset:30720
v_mfma_f32_16x16x32_bf16 v[56:59], v[84:87], a[116:119], v[56:59]
v_mfma_f32_16x16x32_bf16 v[32:35], v[88:91], a[112:115], v[32:35]
v_mfma_f32_16x16x32_bf16 v[60:63], v[88:91], a[116:119], v[60:63]
v_mfma_f32_16x16x32_bf16 v[36:39], v[92:95], a[112:115], v[36:39]
v_mfma_f32_16x16x32_bf16 v[64:67], v[92:95], a[116:119], v[64:67]
v_mfma_f32_16x16x32_bf16 v[40:43], v[96:99], a[112:115], v[40:43]
v_mfma_f32_16x16x32_bf16 v[68:71], v[96:99], a[116:119], v[68:71]
s_waitcnt vmcnt(0)
s_barrier
s_waitcnt lgkmcnt(0)
v_mfma_f32_16x16x32_bf16 v[16:19], v[100:103], a[120:123], v[16:19]
ds_read_b128 v[72:75], v4 offset:32768
v_mfma_f32_16x16x32_bf16 v[44:47], v[100:103], a[124:127], v[44:47]
ds_read_b128 v[76:79], v4 offset:33792
v_mfma_f32_16x16x32_bf16 v[20:23], v[104:107], a[120:123], v[20:23]
ds_read_b128 v[80:83], v4 offset:34816
v_mfma_f32_16x16x32_bf16 v[48:51], v[104:107], a[124:127], v[48:51]
ds_read_b128 v[84:87], v4 offset:35840
v_mfma_f32_16x16x32_bf16 v[24:27], v[108:111], a[120:123], v[24:27]
ds_read_b128 v[88:91], v4 offset:36864
v_mfma_f32_16x16x32_bf16 v[52:55], v[108:111], a[124:127], v[52:55]
ds_read_b128 v[92:95], v4 offset:37888
v_mfma_f32_16x16x32_bf16 v[28:31], v[112:115], a[120:123], v[28:31]
ds_read_b128 v[96:99], v4 offset:38912
v_mfma_f32_16x16x32_bf16 v[56:59], v[112:115], a[124:127], v[56:59]
v_mfma_f32_16x16x32_bf16 v[32:35], v[116:119], a[120:123], v[32:35]
v_mfma_f32_16x16x32_bf16 v[60:63], v[116:119], a[124:127], v[60:63]
v_mfma_f32_16x16x32_bf16 v[36:39], v[120:123], a[120:123], v[36:39]
v_mfma_f32_16x16x32_bf16 v[64:67], v[120:123], a[124:127], v[64:67]
v_mfma_f32_16x16x32_bf16 v[40:43], v[124:127], a[120:123], v[40:43]
v_mfma_f32_16x16x32_bf16 v[68:71], v[124:127], a[124:127], v[68:71]
s_waitcnt lgkmcnt(0)
v_mfma_f32_16x16x32_bf16 v[16:19], v[72:75], a[128:131], v[16:19]
ds_read_b128 v[100:103], v4 offset:40960
v_mfma_f32_16x16x32_bf16 v[44:47], v[72:75], a[132:135], v[44:47]
ds_read_b128 v[104:107], v4 offset:41984
v_mfma_f32_16x16x32_bf16 v[20:23], v[76:79], a[128:131], v[20:23]
ds_read_b128 v[108:111], v4 offset:43008
v_mfma_f32_16x16x32_bf16 v[48:51], v[76:79], a[132:135], v[48:51]
ds_read_b128 v[112:115], v4 offset:44032
v_mfma_f32_16x16x32_bf16 v[24:27], v[80:83], a[128:131], v[24:27]
ds_read_b128 v[116:119], v4 offset:45056
v_mfma_f32_16x16x32_bf16 v[52:55], v[80:83], a[132:135], v[52:55]
ds_read_b128 v[120:123], v4 offset:46080
v_mfma_f32_16x16x32_bf16 v[28:31], v[84:87], a[128:131], v[28:31]
ds_read_b128 v[124:127], v4 offset:47104
v_mfma_f32_16x16x32_bf16 v[56:59], v[84:87], a[132:135], v[56:59]
v_mfma_f32_16x16x32_bf16 v[32:35], v[88:91], a[128:131], v[32:35]
v_mfma_f32_16x16x32_bf16 v[60:63], v[88:91], a[132:135], v[60:63]
v_mfma_f32_16x16x32_bf16 v[36:39], v[92:95], a[128:131], v[36:39]
v_mfma_f32_16x16x32_bf16 v[64:67], v[92:95], a[132:135], v[64:67]
v_mfma_f32_16x16x32_bf16 v[40:43], v[96:99], a[128:131], v[40:43]
v_mfma_f32_16x16x32_bf16 v[68:71], v[96:99], a[132:135], v[68:71]
s_waitcnt lgkmcnt(0)
v_mfma_f32_16x16x32_bf16 v[16:19], v[100:103], a[136:139], v[16:19]
v_mfma_f32_16x16x32_bf16 v[44:47], v[100:103], a[140:143], v[44:47]
v_mfma_f32_16x16x32_bf16 v[20:23], v[104:107], a[136:139], v[20:23]
v_mfma_f32_16x16x32_bf16 v[48:51], v[104:107], a[140:143], v[48:51]
v_mfma_f32_16x16x32_bf16 v[24:27], v[108:111], a[136:139], v[24:27]
v_mfma_f32_16x16x32_bf16 v[52:55], v[108:111], a[140:143], v[52:55]
v_mfma_f32_16x16x32_bf16 v[28:31], v[112:115], a[136:139], v[28:31]
v_mfma_f32_16x16x32_bf16 v[56:59], v[112:115], a[140:143], v[56:59]
v_mfma_f32_16x16x32_bf16 v[32:35], v[116:119], a[136:139], v[32:35]
v_mfma_f32_16x16x32_bf16 v[60:63], v[116:119], a[140:143], v[60:63]
v_mfma_f32_16x16x32_bf16 v[36:39], v[120:123], a[136:139], v[36:39]
v_mfma_f32_16x16x32_bf16 v[64:67], v[120:123], a[140:143], v[64:67]
v_mfma_f32_16x16x32_bf16 v[40:43], v[124:127], a[136:139], v[40:43]
v_mfma_f32_16x16x32_bf16 v[68:71], v[124:127], a[140:143], v[68:71]
s_nop 7
s_nop 1
s_lshl_b32 s55, s53, 2
s_add_u32 s55, s55, s3
s_lshl_b32 s55, s55, 2
s_add_u32 s55, s55, s50
s_mul_i32 s55, s55, 7168
s_add_u32 s55, s55, 0x5c00000
v_cvt_pk_bf16_f32 v16, v16, v17
v_cvt_pk_bf16_f32 v17, v18, v19
v_cvt_pk_bf16_f32 v18, v20, v21
v_cvt_pk_bf16_f32 v19, v22, v23
s_add_u32 s56, s55, 0
buffer_store_dwordx4 v[16:19], v12, s[4:7], s56 offen sc1
v_cvt_pk_bf16_f32 v24, v24, v25
v_cvt_pk_bf16_f32 v25, v26, v27
v_cvt_pk_bf16_f32 v26, v28, v29
v_cvt_pk_bf16_f32 v27, v30, v31
s_add_u32 s56, s55, 1024
buffer_store_dwordx4 v[24:27], v12, s[4:7], s56 offen sc1
v_cvt_pk_bf16_f32 v32, v32, v33
v_cvt_pk_bf16_f32 v33, v34, v35
v_cvt_pk_bf16_f32 v34, v36, v37
v_cvt_pk_bf16_f32 v35, v38, v39
s_add_u32 s56, s55, 2048
buffer_store_dwordx4 v[32:35], v12, s[4:7], s56 offen sc1
v_cvt_pk_bf16_f32 v40, v40, v41
v_cvt_pk_bf16_f32 v41, v42, v43
v_cvt_pk_bf16_f32 v42, v44, v45
v_cvt_pk_bf16_f32 v43, v46, v47
s_add_u32 s56, s55, 3072
buffer_store_dwordx4 v[40:43], v12, s[4:7], s56 offen sc1
v_cvt_pk_bf16_f32 v48, v48, v49
v_cvt_pk_bf16_f32 v49, v50, v51
v_cvt_pk_bf16_f32 v50, v52, v53
v_cvt_pk_bf16_f32 v51, v54, v55
s_add_u32 s56, s55, 4096
buffer_store_dwordx4 v[48:51], v12, s[4:7], s56 offen sc1
v_cvt_pk_bf16_f32 v56, v56, v57
v_cvt_pk_bf16_f32 v57, v58, v59
v_cvt_pk_bf16_f32 v58, v60, v61
v_cvt_pk_bf16_f32 v59, v62, v63
s_add_u32 s56, s55, 5120
buffer_store_dwordx4 v[56:59], v12, s[4:7], s56 offen sc1
v_cvt_pk_bf16_f32 v64, v64, v65
v_cvt_pk_bf16_f32 v65, v66, v67
v_cvt_pk_bf16_f32 v66, v68, v69
v_cvt_pk_bf16_f32 v67, v70, v71
s_add_u32 s56, s55, 6144
buffer_store_dwordx4 v[64:67], v12, s[4:7], s56 offen sc1
s_lshl_b32 s57, s51, 7
s_lshl_b32 s58, s50, 5
s_add_u32 s57, s57, s58
s_mul_i32 s57, s57, 896
s_mul_i32 s58, s52, 224
s_add_u32 s59, s57, s58
s_lshl_b32 s55, s3, 1
s_add_u32 s55, s55, 0
s_cmp_ge_u32 s55, 7
s_cselect_b32 s56, 14336, 0
s_cselect_b32 s57, 7, 0
s_sub_u32 s57, s55, s57
s_lshl_b32 s57, s57, 5
s_add_u32 s56, s56, s57
s_add_u32 s60, s56, s59
s_cmp_ge_u32 s55, 14
s_cselect_b32 s60, 0x70000000, s60
buffer_load_dwordx2 v[200:201], v5, s[44:47], s60 offen
s_lshl_b32 s55, s3, 1
s_add_u32 s55, s55, 1
s_cmp_ge_u32 s55, 7
s_cselect_b32 s56, 14336, 0
s_cselect_b32 s57, 7, 0
s_sub_u32 s57, s55, s57
s_lshl_b32 s57, s57, 5
s_add_u32 s56, s56, s57
s_add_u32 s61, s56, s59
s_cmp_ge_u32 s55, 14
s_cselect_b32 s61, 0x70000000, s61
buffer_load_dwordx2 v[202:203], v5, s[44:47], s61 offen
s_lshl_b32 s55, s3, 1
s_add_u32 s55, s55, 8
s_cmp_ge_u32 s55, 7
s_cselect_b32 s56, 14336, 0
s_cselect_b32 s57, 7, 0
s_sub_u32 s57, s55, s57
s_lshl_b32 s57, s57, 5
s_add_u32 s56, s56, s57
s_add_u32 s62, s56, s59
s_cmp_ge_u32 s55, 14
s_cselect_b32 s62, 0x70000000, s62
buffer_load_dwordx2 v[204:205], v5, s[44:47], s62 offen
s_lshl_b32 s55, s3, 1
s_add_u32 s55, s55, 9
s_cmp_ge_u32 s55, 7
s_cselect_b32 s56, 14336, 0
s_cselect_b32 s57, 7, 0
s_sub_u32 s57, s55, s57
s_lshl_b32 s57, s57, 5
s_add_u32 s56, s56, s57
s_add_u32 s63, s56, s59
s_cmp_ge_u32 s55, 14
s_cselect_b32 s63, 0x70000000, s63
buffer_load_dwordx2 v[206:207], v5, s[44:47], s63 offen
s_waitcnt vmcnt(4)
s_add_u32 s66, s53, 352
s_lshl_b32 s66, s66, 7
s_add_u32 s66, s66, 0x5b00000
v_mov_b32 v8, 1
s_mov_b64 s[68:69], exec
s_mov_b64 exec, 1
buffer_atomic_add v8, off, s[4:7], s66
s_mov_b64 exec, s[68:69]
s_add_u32 s66, s53, 352
s_lshl_b32 s66, s66, 7
s_add_u32 s66, s66, 0x5b00000
s_mov_b32 s58, 0x80000
fused_kernel_oc_poll_86:
buffer_load_dword v13, off, s[4:7], s66 sc1
s_waitcnt vmcnt(0)
v_readfirstlane_b32 s57, v13
s_sub_u32 s58, s58, 1
s_cmp_eq_u32 s58, 0
s_cbranch_scc1 fused_kernel_oc_ok_85
s_cmp_ge_u32 s57, 16
s_cbranch_scc1 fused_kernel_oc_ok_85
s_sleep 1
s_branch fused_kernel_oc_poll_86
fused_kernel_oc_ok_85:
s_lshl_b32 s55, s53, 2
s_add_u32 s55, s55, s50
s_mul_i32 s55, s55, 28672
s_lshl_b32 s56, s3, 10
s_add_u32 s55, s55, s56
s_add_u32 s55, s55, 0x5c00000
s_add_u32 s56, s55, 0
buffer_load_dwordx4 v[72:75], v12, s[4:7], s56 offen sc1
s_add_u32 s56, s55, 7168
buffer_load_dwordx4 v[76:79], v12, s[4:7], s56 offen sc1
s_add_u32 s56, s55, 14336
buffer_load_dwordx4 v[80:83], v12, s[4:7], s56 offen sc1
s_add_u32 s56, s55, 21504
buffer_load_dwordx4 v[84:87], v12, s[4:7], s56 offen sc1
s_add_u32 s56, s55, 4096
buffer_load_dwordx4 v[88:91], v12, s[4:7], s56 offen sc1
s_add_u32 s56, s55, 11264
buffer_load_dwordx4 v[92:95], v12, s[4:7], s56 offen sc1
s_add_u32 s56, s55, 18432
buffer_load_dwordx4 v[96:99], v12, s[4:7], s56 offen sc1
s_add_u32 s56, s55, 25600
buffer_load_dwordx4 v[100:103], v12, s[4:7], s56 offen sc1
s_waitcnt vmcnt(4)
v_lshlrev_b32 v112, 16, v72
v_and_b32 v113, 0xffff0000, v72
v_lshlrev_b32 v114, 16, v73
v_and_b32 v115, 0xffff0000, v73
v_lshlrev_b32 v116, 16, v74
v_and_b32 v117, 0xffff0000, v74
v_lshlrev_b32 v118, 16, v75
v_and_b32 v119, 0xffff0000, v75
v_lshlrev_b32 v130, 16, v76
v_and_b32 v131, 0xffff0000, v76
v_add_f32 v112, v112, v130
v_add_f32 v113, v113, v131
v_lshlrev_b32 v130, 16, v77
v_and_b32 v131, 0xffff0000, v77
v_add_f32 v114, v114, v130
v_add_f32 v115, v115, v131
v_lshlrev_b32 v130, 16, v78
v_and_b32 v131, 0xffff0000, v78
v_add_f32 v116, v116, v130
v_add_f32 v117, v117, v131
v_lshlrev_b32 v130, 16, v79
v_and_b32 v131, 0xffff0000, v79
v_add_f32 v118, v118, v130
v_add_f32 v119, v119, v131
v_lshlrev_b32 v130, 16, v80
v_and_b32 v131, 0xffff0000, v80
v_add_f32 v112, v112, v130
v_add_f32 v113, v113, v131
v_lshlrev_b32 v130, 16, v81
v_and_b32 v131, 0xffff0000, v81
v_add_f32 v114, v114, v130
v_add_f32 v115, v115, v131
v_lshlrev_b32 v130, 16, v82
v_and_b32 v131, 0xffff0000, v82
v_add_f32 v116, v116, v130
v_add_f32 v117, v117, v131
v_lshlrev_b32 v130, 16, v83
v_and_b32 v131, 0xffff0000, v83
v_add_f32 v118, v118, v130
v_add_f32 v119, v119, v131
v_lshlrev_b32 v130, 16, v84
v_and_b32 v131, 0xffff0000, v84
v_add_f32 v112, v112, v130
v_add_f32 v113, v113, v131
v_lshlrev_b32 v130, 16, v85
v_and_b32 v131, 0xffff0000, v85
v_add_f32 v114, v114, v130
v_add_f32 v115, v115, v131
v_lshlrev_b32 v130, 16, v86
v_and_b32 v131, 0xffff0000, v86
v_add_f32 v116, v116, v130
v_add_f32 v117, v117, v131
v_lshlrev_b32 v130, 16, v87
v_and_b32 v131, 0xffff0000, v87
v_add_f32 v118, v118, v130
v_add_f32 v119, v119, v131
v_lshlrev_b32 v132, 16, v200
v_and_b32 v133, 0xffff0000, v200
v_lshlrev_b32 v134, 16, v201
v_and_b32 v135, 0xffff0000, v201
v_add_f32 v112, v112, v132
v_add_f32 v113, v113, v133
v_add_f32 v114, v114, v134
v_add_f32 v115, v115, v135
v_cvt_pk_bf16_f32 v136, v112, v113
v_cvt_pk_bf16_f32 v137, v114, v115
buffer_store_dwordx2 v[136:137], v5, s[40:43], s60 offen
v_lshlrev_b32 v132, 16, v202
v_and_b32 v133, 0xffff0000, v202
v_lshlrev_b32 v134, 16, v203
v_and_b32 v135, 0xffff0000, v203
v_add_f32 v116, v116, v132
v_add_f32 v117, v117, v133
v_add_f32 v118, v118, v134
v_add_f32 v119, v119, v135
v_cvt_pk_bf16_f32 v138, v116, v117
v_cvt_pk_bf16_f32 v139, v118, v119
buffer_store_dwordx2 v[138:139], v5, s[40:43], s61 offen
s_waitcnt vmcnt(2)
v_lshlrev_b32 v120, 16, v88
v_and_b32 v121, 0xffff0000, v88
v_lshlrev_b32 v122, 16, v89
v_and_b32 v123, 0xffff0000, v89
v_lshlrev_b32 v124, 16, v90
v_and_b32 v125, 0xffff0000, v90
v_lshlrev_b32 v126, 16, v91
v_and_b32 v127, 0xffff0000, v91
v_lshlrev_b32 v130, 16, v92
v_and_b32 v131, 0xffff0000, v92
v_add_f32 v120, v120, v130
v_add_f32 v121, v121, v131
v_lshlrev_b32 v130, 16, v93
v_and_b32 v131, 0xffff0000, v93
v_add_f32 v122, v122, v130
v_add_f32 v123, v123, v131
v_lshlrev_b32 v130, 16, v94
v_and_b32 v131, 0xffff0000, v94
v_add_f32 v124, v124, v130
v_add_f32 v125, v125, v131
v_lshlrev_b32 v130, 16, v95
v_and_b32 v131, 0xffff0000, v95
v_add_f32 v126, v126, v130
v_add_f32 v127, v127, v131
v_lshlrev_b32 v130, 16, v96
v_and_b32 v131, 0xffff0000, v96
v_add_f32 v120, v120, v130
v_add_f32 v121, v121, v131
v_lshlrev_b32 v130, 16, v97
v_and_b32 v131, 0xffff0000, v97
v_add_f32 v122, v122, v130
v_add_f32 v123, v123, v131
v_lshlrev_b32 v130, 16, v98
v_and_b32 v131, 0xffff0000, v98
v_add_f32 v124, v124, v130
v_add_f32 v125, v125, v131
v_lshlrev_b32 v130, 16, v99
v_and_b32 v131, 0xffff0000, v99
v_add_f32 v126, v126, v130
v_add_f32 v127, v127, v131
v_lshlrev_b32 v130, 16, v100
v_and_b32 v131, 0xffff0000, v100
v_add_f32 v120, v120, v130
v_add_f32 v121, v121, v131
v_lshlrev_b32 v130, 16, v101
v_and_b32 v131, 0xffff0000, v101
v_add_f32 v122, v122, v130
v_add_f32 v123, v123, v131
v_lshlrev_b32 v130, 16, v102
v_and_b32 v131, 0xffff0000, v102
v_add_f32 v124, v124, v130
v_add_f32 v125, v125, v131
v_lshlrev_b32 v130, 16, v103
v_and_b32 v131, 0xffff0000, v103
v_add_f32 v126, v126, v130
v_add_f32 v127, v127, v131
v_lshlrev_b32 v132, 16, v204
v_and_b32 v133, 0xffff0000, v204
v_lshlrev_b32 v134, 16, v205
v_and_b32 v135, 0xffff0000, v205
v_add_f32 v120, v120, v132
v_add_f32 v121, v121, v133
v_add_f32 v122, v122, v134
v_add_f32 v123, v123, v135
v_cvt_pk_bf16_f32 v140, v120, v121
v_cvt_pk_bf16_f32 v141, v122, v123
buffer_store_dwordx2 v[140:141], v5, s[40:43], s62 offen
v_lshlrev_b32 v132, 16, v206
v_and_b32 v133, 0xffff0000, v206
v_lshlrev_b32 v134, 16, v207
v_and_b32 v135, 0xffff0000, v207
v_add_f32 v124, v124, v132
v_add_f32 v125, v125, v133
v_add_f32 v126, v126, v134
v_add_f32 v127, v127, v135
v_cvt_pk_bf16_f32 v142, v124, v125
v_cvt_pk_bf16_f32 v143, v126, v127
buffer_store_dwordx2 v[142:143], v5, s[40:43], s63 offen
fused_kernel_eexit:
s_waitcnt vmcnt(0) lgkmcnt(0)
fused_kernel_done:
s_endpgm
fused_kernel_mstub_45:
s_call_b64 s[26:27], fused_kernel_mask0
s_branch fused_kernel_mback_46
fused_kernel_mstub_50:
s_call_b64 s[26:27], fused_kernel_mask0
s_branch fused_kernel_mback_51
fused_kernel_mstub_54:
s_call_b64 s[26:27], fused_kernel_mask0
s_branch fused_kernel_mback_55
fused_kernel_mstub_56:
s_call_b64 s[26:27], fused_kernel_mask1
s_branch fused_kernel_mback_57
fused_kernel_hstub_58:
s_call_b64 s[26:27], fused_kernel_hiwait
s_branch fused_kernel_hback_59
fused_kernel_fstub_60:
s_call_b64 s[26:27], fused_kernel_fb1
s_branch fused_kernel_fback_61
fused_kernel_mstub_62:
s_call_b64 s[26:27], fused_kernel_mask0
s_branch fused_kernel_mback_63
fused_kernel_fstub_64:
s_call_b64 s[26:27], fused_kernel_fb0
s_branch fused_kernel_fback_65
fused_kernel_mstub_70:
s_call_b64 s[26:27], fused_kernel_mask1
s_branch fused_kernel_mback_71
fused_kernel_fstub_72:
s_call_b64 s[26:27], fused_kernel_fb1
s_branch fused_kernel_fback_73
fused_kernel_hiwait:
s_add_u32 s66, s8, 32
s_lshl_b32 s66, s66, 7
s_add_u32 s66, s66, 0x5b00000
s_mov_b32 s67, 0x80000
s_cmp_eq_u32 s38, 1
s_cbranch_scc1 fused_kernel_hst2_89
buffer_load_dword v125, off, s[4:7], s66 sc1
s_mov_b32 s38, 1
s_add_u32 s39, s39, 2
s_setpc_b64 s[26:27]
fused_kernel_hst2_89:
s_waitcnt vmcnt(16)
s_branch fused_kernel_hchk_90
fused_kernel_hiwait_now:
s_add_u32 s66, s8, 32
s_lshl_b32 s66, s66, 7
s_add_u32 s66, s66, 0x5b00000
s_mov_b32 s67, 0x80000
fused_kernel_hpoll_88:
buffer_load_dword v125, off, s[4:7], s66 sc1
s_waitcnt vmcnt(0)
fused_kernel_hchk_90:
v_readfirstlane_b32 s68, v125
s_sub_u32 s67, s67, 1
s_cmp_eq_u32 s67, 0
s_cbranch_scc1 fused_kernel_hok_87
s_cmp_ge_u32 s68, 8
s_cbranch_scc1 fused_kernel_hok_87
s_sleep 1
s_branch fused_kernel_hpoll_88
fused_kernel_hok_87:
s_cmp_eq_u32 s49, 0xffff
s_cbranch_scc1 fused_kernel_noguc_91
s_add_u32 s66, s49, 16
s_lshl_b32 s66, s66, 7
s_add_u32 s66, s66, 0x5b00000
v_mov_b32 v125, 1
s_mov_b64 s[68:69], exec
s_mov_b64 exec, 1
buffer_atomic_add v125, off, s[4:7], s66
s_mov_b64 exec, s[68:69]
fused_kernel_noguc_91:
s_setpc_b64 s[26:27]
fused_kernel_mask0:
s_add_u32 s28, s24, s3
s_sub_u32 s28, s28, s23
s_lshl_b32 s28, s28, 5
s_nop 7
v_sub_u32 v80, s28, v9
v_mov_b32 v81, 0xf1800000
v_cmp_gt_i32 s[50:51], 0, v80
v_cmp_gt_i32 s[52:53], 1, v80
v_cmp_gt_i32 s[54:55], 2, v80
v_cmp_gt_i32 s[56:57], 3, v80
v_cndmask_b32 v16, v16, v81, s[50:51]
v_cndmask_b32 v17, v17, v81, s[52:53]
v_cndmask_b32 v18, v18, v81, s[54:55]
v_cndmask_b32 v19, v19, v81, s[56:57]
v_cmp_gt_i32 s[50:51], 8, v80
v_cmp_gt_i32 s[52:53], 9, v80
v_cmp_gt_i32 s[54:55], 10, v80
v_cmp_gt_i32 s[56:57], 11, v80
v_cndmask_b32 v20, v20, v81, s[50:51]
v_cndmask_b32 v21, v21, v81, s[52:53]
v_cndmask_b32 v22, v22, v81, s[54:55]
v_cndmask_b32 v23, v23, v81, s[56:57]
v_cmp_gt_i32 s[50:51], 16, v80
v_cmp_gt_i32 s[52:53], 17, v80
v_cmp_gt_i32 s[54:55], 18, v80
v_cmp_gt_i32 s[56:57], 19, v80
v_cndmask_b32 v24, v24, v81, s[50:51]
v_cndmask_b32 v25, v25, v81, s[52:53]
v_cndmask_b32 v26, v26, v81, s[54:55]
v_cndmask_b32 v27, v27, v81, s[56:57]
v_cmp_gt_i32 s[50:51], 24, v80
v_cmp_gt_i32 s[52:53], 25, v80
v_cmp_gt_i32 s[54:55], 26, v80
v_cmp_gt_i32 s[56:57], 27, v80
v_cndmask_b32 v28, v28, v81, s[50:51]
v_cndmask_b32 v29, v29, v81, s[52:53]
v_cndmask_b32 v30, v30, v81, s[54:55]
v_cndmask_b32 v31, v31, v81, s[56:57]
s_setpc_b64 s[26:27]
fused_kernel_fb0:
s_nop 15
v_max3_f32 v88, v16, v17, v18
v_max3_f32 v88, v88, v19, v20
v_max3_f32 v88, v88, v21, v22
v_max3_f32 v88, v88, v23, v24
v_max3_f32 v88, v88, v25, v26
v_max3_f32 v88, v88, v27, v28
v_max3_f32 v88, v88, v29, v30
v_max_f32 v88, v88, v31
v_mov_b32 v89, v88
s_nop 1
v_permlane32_swap_b32 v88, v89
s_nop 1
v_max_f32 v88, v88, v89
v_max_f32 v88, 0, v88
v_sub_f32 v89, 0, v88
v_exp_f32 v89, v89
v_sub_f32 v16, v16, v88
v_sub_f32 v32, v32, v88
v_sub_f32 v64, v64, v88
v_sub_f32 v17, v17, v88
v_sub_f32 v33, v33, v88
v_sub_f32 v65, v65, v88
v_sub_f32 v18, v18, v88
v_sub_f32 v34, v34, v88
v_sub_f32 v66, v66, v88
v_sub_f32 v19, v19, v88
v_sub_f32 v35, v35, v88
v_sub_f32 v67, v67, v88
v_sub_f32 v20, v20, v88
v_sub_f32 v36, v36, v88
v_sub_f32 v68, v68, v88
v_sub_f32 v21, v21, v88
v_sub_f32 v37, v37, v88
v_sub_f32 v69, v69, v88
v_sub_f32 v22, v22, v88
v_sub_f32 v38, v38, v88
v_sub_f32 v70, v70, v88
v_sub_f32 v23, v23, v88
v_sub_f32 v39, v39, v88
v_sub_f32 v71, v71, v88
v_sub_f32 v24, v24, v88
v_sub_f32 v40, v40, v88
v_sub_f32 v72, v72, v88
v_sub_f32 v25, v25, v88
v_sub_f32 v41, v41, v88
v_sub_f32 v73, v73, v88
v_sub_f32 v26, v26, v88
v_sub_f32 v42, v42, v88
v_sub_f32 v74, v74, v88
v_sub_f32 v27, v27, v88
v_sub_f32 v43, v43, v88
v_sub_f32 v75, v75, v88
v_sub_f32 v28, v28, v88
v_sub_f32 v44, v44, v88
v_sub_f32 v76, v76, v88
v_sub_f32 v29, v29, v88
v_sub_f32 v45, v45, v88
v_sub_f32 v77, v77, v88
v_sub_f32 v30, v30, v88
v_sub_f32 v46, v46, v88
v_sub_f32 v78, v78, v88
v_sub_f32 v31, v31, v88
v_sub_f32 v47, v47, v88
v_sub_f32 v79, v79, v88
v_add_f32 v5, v5, v88
v_mul_f32 v128, v128, v89
v_mul_f32 v129, v129, v89
v_mul_f32 v130, v130, v89
v_mul_f32 v131, v131, v89
v_mul_f32 v132, v132, v89
v_mul_f32 v133, v133, v89
v_mul_f32 v134, v134, v89
v_mul_f32 v135, v135, v89
v_mul_f32 v136, v136, v89
v_mul_f32 v137, v137, v89
v_mul_f32 v138, v138, v89
v_mul_f32 v139, v139, v89
v_mul_f32 v140, v140, v89
v_mul_f32 v141, v141, v89
v_mul_f32 v142, v142, v89
v_mul_f32 v143, v143, v89
v_mul_f32 v144, v144, v89
v_mul_f32 v145, v145, v89
v_mul_f32 v146, v146, v89
v_mul_f32 v147, v147, v89
v_mul_f32 v148, v148, v89
v_mul_f32 v149, v149, v89
v_mul_f32 v150, v150, v89
v_mul_f32 v151, v151, v89
v_mul_f32 v152, v152, v89
v_mul_f32 v153, v153, v89
v_mul_f32 v154, v154, v89
v_mul_f32 v155, v155, v89
v_mul_f32 v156, v156, v89
v_mul_f32 v157, v157, v89
v_mul_f32 v158, v158, v89
v_mul_f32 v159, v159, v89
v_mul_f32 v160, v160, v89
v_mul_f32 v161, v161, v89
v_mul_f32 v162, v162, v89
v_mul_f32 v163, v163, v89
v_mul_f32 v164, v164, v89
v_mul_f32 v165, v165, v89
v_mul_f32 v166, v166, v89
v_mul_f32 v167, v167, v89
v_mul_f32 v168, v168, v89
v_mul_f32 v169, v169, v89
v_mul_f32 v170, v170, v89
v_mul_f32 v171, v171, v89
v_mul_f32 v172, v172, v89
v_mul_f32 v173, v173, v89
v_mul_f32 v174, v174, v89
v_mul_f32 v175, v175, v89
v_mul_f32 v176, v176, v89
v_mul_f32 v177, v177, v89
v_mul_f32 v178, v178, v89
v_mul_f32 v179, v179, v89
v_mul_f32 v180, v180, v89
v_mul_f32 v181, v181, v89
v_mul_f32 v182, v182, v89
v_mul_f32 v183, v183, v89
v_mul_f32 v184, v184, v89
v_mul_f32 v185, v185, v89
v_mul_f32 v186, v186, v89
v_mul_f32 v187, v187, v89
v_mul_f32 v188, v188, v89
v_mul_f32 v189, v189, v89
v_mul_f32 v190, v190, v89
v_mul_f32 v191, v191, v89
v_mul_f32 v192, v192, v89
v_mul_f32 v193, v193, v89
v_mul_f32 v194, v194, v89
v_mul_f32 v195, v195, v89
v_mul_f32 v196, v196, v89
v_mul_f32 v197, v197, v89
v_mul_f32 v198, v198, v89
v_mul_f32 v199, v199, v89
v_mul_f32 v200, v200, v89
v_mul_f32 v201, v201, v89
v_mul_f32 v202, v202, v89
v_mul_f32 v203, v203, v89
v_mul_f32 v204, v204, v89
v_mul_f32 v205, v205, v89
v_mul_f32 v206, v206, v89
v_mul_f32 v207, v207, v89
v_mul_f32 v208, v208, v89
v_mul_f32 v209, v209, v89
v_mul_f32 v210, v210, v89
v_mul_f32 v211, v211, v89
v_mul_f32 v212, v212, v89
v_mul_f32 v213, v213, v89
v_mul_f32 v214, v214, v89
v_mul_f32 v215, v215, v89
v_mul_f32 v216, v216, v89
v_mul_f32 v217, v217, v89
v_mul_f32 v218, v218, v89
v_mul_f32 v219, v219, v89
v_mul_f32 v220, v220, v89
v_mul_f32 v221, v221, v89
v_mul_f32 v222, v222, v89
v_mul_f32 v223, v223, v89
v_mul_f32 v224, v224, v89
v_mul_f32 v225, v225, v89
v_mul_f32 v226, v226, v89
v_mul_f32 v227, v227, v89
v_mul_f32 v228, v228, v89
v_mul_f32 v229, v229, v89
v_mul_f32 v230, v230, v89
v_mul_f32 v231, v231, v89
v_mul_f32 v232, v232, v89
v_mul_f32 v233, v233, v89
v_mul_f32 v234, v234, v89
v_mul_f32 v235, v235, v89
v_mul_f32 v236, v236, v89
v_mul_f32 v237, v237, v89
v_mul_f32 v238, v238, v89
v_mul_f32 v239, v239, v89
v_mul_f32 v240, v240, v89
v_mul_f32 v241, v241, v89
v_mul_f32 v242, v242, v89
v_mul_f32 v243, v243, v89
v_mul_f32 v244, v244, v89
v_mul_f32 v245, v245, v89
v_mul_f32 v246, v246, v89
v_mul_f32 v247, v247, v89
v_mul_f32 v248, v248, v89
v_mul_f32 v249, v249, v89
v_mul_f32 v250, v250, v89
v_mul_f32 v251, v251, v89
v_mul_f32 v252, v252, v89
v_mul_f32 v253, v253, v89
v_mul_f32 v254, v254, v89
v_mul_f32 v255, v255, v89
v_exp_f32 v80, v16
v_exp_f32 v81, v17
v_exp_f32 v82, v18
v_exp_f32 v83, v19
v_cvt_pk_bf16_f32 v48, v80, v81
v_exp_f32 v84, v20
v_add_f32 v7, v80, v82
v_exp_f32 v85, v21
v_add_f32 v8, v81, v83
v_cvt_pk_bf16_f32 v49, v82, v83
v_exp_f32 v86, v22
v_add_f32 v7, v7, v84
v_exp_f32 v87, v23
v_add_f32 v8, v8, v85
v_cvt_pk_bf16_f32 v52, v84, v85
v_exp_f32 v80, v24
v_add_f32 v7, v7, v86
v_exp_f32 v81, v25
v_add_f32 v8, v8, v87
v_cvt_pk_bf16_f32 v53, v86, v87
v_exp_f32 v82, v26
v_add_f32 v7, v7, v80
v_exp_f32 v83, v27
v_add_f32 v8, v8, v81
v_cvt_pk_bf16_f32 v50, v80, v81
v_exp_f32 v84, v28
v_add_f32 v7, v7, v82
v_exp_f32 v85, v29
v_add_f32 v8, v8, v83
v_cvt_pk_bf16_f32 v51, v82, v83
v_exp_f32 v86, v30
v_add_f32 v7, v7, v84
v_exp_f32 v87, v31
v_add_f32 v8, v8, v85
v_cvt_pk_bf16_f32 v54, v84, v85
v_add_f32 v7, v7, v86
v_add_f32 v8, v8, v87
v_cvt_pk_bf16_f32 v55, v86, v87
v_add_f32 v7, v7, v8
v_fma_f32 v6, v14, v89, v7
s_setpc_b64 s[26:27]
fused_kernel_mask1:
s_add_u32 s28, s24, s3
s_sub_u32 s28, s28, s23
s_lshl_b32 s28, s28, 5
s_nop 7
v_sub_u32 v80, s28, v9
v_mov_b32 v81, 0xf1800000
v_cmp_gt_i32 s[50:51], 0, v80
v_cmp_gt_i32 s[52:53], 1, v80
v_cmp_gt_i32 s[54:55], 2, v80
v_cmp_gt_i32 s[56:57], 3, v80
v_cndmask_b32 v32, v32, v81, s[50:51]
v_cndmask_b32 v33, v33, v81, s[52:53]
v_cndmask_b32 v34, v34, v81, s[54:55]
v_cndmask_b32 v35, v35, v81, s[56:57]
v_cmp_gt_i32 s[50:51], 8, v80
v_cmp_gt_i32 s[52:53], 9, v80
v_cmp_gt_i32 s[54:55], 10, v80
v_cmp_gt_i32 s[56:57], 11, v80
v_cndmask_b32 v36, v36, v81, s[50:51]
v_cndmask_b32 v37, v37, v81, s[52:53]
v_cndmask_b32 v38, v38, v81, s[54:55]
v_cndmask_b32 v39, v39, v81, s[56:57]
v_cmp_gt_i32 s[50:51], 16, v80
v_cmp_gt_i32 s[52:53], 17, v80
v_cmp_gt_i32 s[54:55], 18, v80
v_cmp_gt_i32 s[56:57], 19, v80
v_cndmask_b32 v40, v40, v81, s[50:51]
v_cndmask_b32 v41, v41, v81, s[52:53]
v_cndmask_b32 v42, v42, v81, s[54:55]
v_cndmask_b32 v43, v43, v81, s[56:57]
v_cmp_gt_i32 s[50:51], 24, v80
v_cmp_gt_i32 s[52:53], 25, v80
v_cmp_gt_i32 s[54:55], 26, v80
v_cmp_gt_i32 s[56:57], 27, v80
v_cndmask_b32 v44, v44, v81, s[50:51]
v_cndmask_b32 v45, v45, v81, s[52:53]
v_cndmask_b32 v46, v46, v81, s[54:55]
v_cndmask_b32 v47, v47, v81, s[56:57]
s_setpc_b64 s[26:27]
fused_kernel_fb1:
s_nop 15
v_max3_f32 v88, v32, v33, v34
v_max3_f32 v88, v88, v35, v36
v_max3_f32 v88, v88, v37, v38
v_max3_f32 v88, v88, v39, v40
v_max3_f32 v88, v88, v41, v42
v_max3_f32 v88, v88, v43, v44
v_max3_f32 v88, v88, v45, v46
v_max_f32 v88, v88, v47
v_mov_b32 v89, v88
s_nop 1
v_permlane32_swap_b32 v88, v89
s_nop 1
v_max_f32 v88, v88, v89
v_max_f32 v88, 0, v88
v_sub_f32 v89, 0, v88
v_exp_f32 v89, v89
v_sub_f32 v32, v32, v88
v_sub_f32 v16, v16, v88
v_sub_f32 v64, v64, v88
v_sub_f32 v33, v33, v88
v_sub_f32 v17, v17, v88
v_sub_f32 v65, v65, v88
v_sub_f32 v34, v34, v88
v_sub_f32 v18, v18, v88
v_sub_f32 v66, v66, v88
v_sub_f32 v35, v35, v88
v_sub_f32 v19, v19, v88
v_sub_f32 v67, v67, v88
v_sub_f32 v36, v36, v88
v_sub_f32 v20, v20, v88
v_sub_f32 v68, v68, v88
v_sub_f32 v37, v37, v88
v_sub_f32 v21, v21, v88
v_sub_f32 v69, v69, v88
v_sub_f32 v38, v38, v88
v_sub_f32 v22, v22, v88
v_sub_f32 v70, v70, v88
v_sub_f32 v39, v39, v88
v_sub_f32 v23, v23, v88
v_sub_f32 v71, v71, v88
v_sub_f32 v40, v40, v88
v_sub_f32 v24, v24, v88
v_sub_f32 v72, v72, v88
v_sub_f32 v41, v41, v88
v_sub_f32 v25, v25, v88
v_sub_f32 v73, v73, v88
v_sub_f32 v42, v42, v88
v_sub_f32 v26, v26, v88
v_sub_f32 v74, v74, v88
v_sub_f32 v43, v43, v88
v_sub_f32 v27, v27, v88
v_sub_f32 v75, v75, v88
v_sub_f32 v44, v44, v88
v_sub_f32 v28, v28, v88
v_sub_f32 v76, v76, v88
v_sub_f32 v45, v45, v88
v_sub_f32 v29, v29, v88
v_sub_f32 v77, v77, v88
v_sub_f32 v46, v46, v88
v_sub_f32 v30, v30, v88
v_sub_f32 v78, v78, v88
v_sub_f32 v47, v47, v88
v_sub_f32 v31, v31, v88
v_sub_f32 v79, v79, v88
v_add_f32 v5, v5, v88
v_mul_f32 v128, v128, v89
v_mul_f32 v129, v129, v89
v_mul_f32 v130, v130, v89
v_mul_f32 v131, v131, v89
v_mul_f32 v132, v132, v89
v_mul_f32 v133, v133, v89
v_mul_f32 v134, v134, v89
v_mul_f32 v135, v135, v89
v_mul_f32 v136, v136, v89
v_mul_f32 v137, v137, v89
v_mul_f32 v138, v138, v89
v_mul_f32 v139, v139, v89
v_mul_f32 v140, v140, v89
v_mul_f32 v141, v141, v89
v_mul_f32 v142, v142, v89
v_mul_f32 v143, v143, v89
v_mul_f32 v144, v144, v89
v_mul_f32 v145, v145, v89
v_mul_f32 v146, v146, v89
v_mul_f32 v147, v147, v89
v_mul_f32 v148, v148, v89
v_mul_f32 v149, v149, v89
v_mul_f32 v150, v150, v89
v_mul_f32 v151, v151, v89
v_mul_f32 v152, v152, v89
v_mul_f32 v153, v153, v89
v_mul_f32 v154, v154, v89
v_mul_f32 v155, v155, v89
v_mul_f32 v156, v156, v89
v_mul_f32 v157, v157, v89
v_mul_f32 v158, v158, v89
v_mul_f32 v159, v159, v89
v_mul_f32 v160, v160, v89
v_mul_f32 v161, v161, v89
v_mul_f32 v162, v162, v89
v_mul_f32 v163, v163, v89
v_mul_f32 v164, v164, v89
v_mul_f32 v165, v165, v89
v_mul_f32 v166, v166, v89
v_mul_f32 v167, v167, v89
v_mul_f32 v168, v168, v89
v_mul_f32 v169, v169, v89
v_mul_f32 v170, v170, v89
v_mul_f32 v171, v171, v89
v_mul_f32 v172, v172, v89
v_mul_f32 v173, v173, v89
v_mul_f32 v174, v174, v89
v_mul_f32 v175, v175, v89
v_mul_f32 v176, v176, v89
v_mul_f32 v177, v177, v89
v_mul_f32 v178, v178, v89
v_mul_f32 v179, v179, v89
v_mul_f32 v180, v180, v89
v_mul_f32 v181, v181, v89
v_mul_f32 v182, v182, v89
v_mul_f32 v183, v183, v89
v_mul_f32 v184, v184, v89
v_mul_f32 v185, v185, v89
v_mul_f32 v186, v186, v89
v_mul_f32 v187, v187, v89
v_mul_f32 v188, v188, v89
v_mul_f32 v189, v189, v89
v_mul_f32 v190, v190, v89
v_mul_f32 v191, v191, v89
v_mul_f32 v192, v192, v89
v_mul_f32 v193, v193, v89
v_mul_f32 v194, v194, v89
v_mul_f32 v195, v195, v89
v_mul_f32 v196, v196, v89
v_mul_f32 v197, v197, v89
v_mul_f32 v198, v198, v89
v_mul_f32 v199, v199, v89
v_mul_f32 v200, v200, v89
v_mul_f32 v201, v201, v89
v_mul_f32 v202, v202, v89
v_mul_f32 v203, v203, v89
v_mul_f32 v204, v204, v89
v_mul_f32 v205, v205, v89
v_mul_f32 v206, v206, v89
v_mul_f32 v207, v207, v89
v_mul_f32 v208, v208, v89
v_mul_f32 v209, v209, v89
v_mul_f32 v210, v210, v89
v_mul_f32 v211, v211, v89
v_mul_f32 v212, v212, v89
v_mul_f32 v213, v213, v89
v_mul_f32 v214, v214, v89
v_mul_f32 v215, v215, v89
v_mul_f32 v216, v216, v89
v_mul_f32 v217, v217, v89
v_mul_f32 v218, v218, v89
v_mul_f32 v219, v219, v89
v_mul_f32 v220, v220, v89
v_mul_f32 v221, v221, v89
v_mul_f32 v222, v222, v89
v_mul_f32 v223, v223, v89
v_mul_f32 v224, v224, v89
v_mul_f32 v225, v225, v89
v_mul_f32 v226, v226, v89
v_mul_f32 v227, v227, v89
v_mul_f32 v228, v228, v89
v_mul_f32 v229, v229, v89
v_mul_f32 v230, v230, v89
v_mul_f32 v231, v231, v89
v_mul_f32 v232, v232, v89
v_mul_f32 v233, v233, v89
v_mul_f32 v234, v234, v89
v_mul_f32 v235, v235, v89
v_mul_f32 v236, v236, v89
v_mul_f32 v237, v237, v89
v_mul_f32 v238, v238, v89
v_mul_f32 v239, v239, v89
v_mul_f32 v240, v240, v89
v_mul_f32 v241, v241, v89
v_mul_f32 v242, v242, v89
v_mul_f32 v243, v243, v89
v_mul_f32 v244, v244, v89
v_mul_f32 v245, v245, v89
v_mul_f32 v246, v246, v89
v_mul_f32 v247, v247, v89
v_mul_f32 v248, v248, v89
v_mul_f32 v249, v249, v89
v_mul_f32 v250, v250, v89
v_mul_f32 v251, v251, v89
v_mul_f32 v252, v252, v89
v_mul_f32 v253, v253, v89
v_mul_f32 v254, v254, v89
v_mul_f32 v255, v255, v89
v_exp_f32 v80, v32
v_exp_f32 v81, v33
v_exp_f32 v82, v34
v_exp_f32 v83, v35
v_cvt_pk_bf16_f32 v56, v80, v81
v_exp_f32 v84, v36
v_add_f32 v7, v80, v82
v_exp_f32 v85, v37
v_add_f32 v8, v81, v83
v_cvt_pk_bf16_f32 v57, v82, v83
v_exp_f32 v86, v38
v_add_f32 v7, v7, v84
v_exp_f32 v87, v39
v_add_f32 v8, v8, v85
v_cvt_pk_bf16_f32 v60, v84, v85
v_exp_f32 v80, v40
v_add_f32 v7, v7, v86
v_exp_f32 v81, v41
v_add_f32 v8, v8, v87
v_cvt_pk_bf16_f32 v61, v86, v87
v_exp_f32 v82, v42
v_add_f32 v7, v7, v80
v_exp_f32 v83, v43
v_add_f32 v8, v8, v81
v_cvt_pk_bf16_f32 v58, v80, v81
v_exp_f32 v84, v44
v_add_f32 v7, v7, v82
v_exp_f32 v85, v45
v_add_f32 v8, v8, v83
v_cvt_pk_bf16_f32 v59, v82, v83
v_exp_f32 v86, v46
v_add_f32 v7, v7, v84
v_exp_f32 v87, v47
v_add_f32 v8, v8, v85
v_cvt_pk_bf16_f32 v62, v84, v85
v_add_f32 v7, v7, v86
v_add_f32 v8, v8, v87
v_cvt_pk_bf16_f32 v63, v86, v87
v_add_f32 v7, v7, v8
v_fma_f32 v14, v6, v89, v7
s_setpc_b64 s[26:27]
fused_kernel_codeend:
s_endpgm
.section .rodata,"a"
.p2align 6
.amdhsa_kernel fused_kernel
  .amdhsa_next_free_vgpr 512
  .amdhsa_next_free_sgpr 102
  .amdhsa_accum_offset 256
  .amdhsa_group_segment_fixed_size 0
  .amdhsa_kernarg_size 104
  .amdhsa_user_sgpr_count 2
  .amdhsa_user_sgpr_kernarg_segment_ptr 1
  .amdhsa_system_sgpr_workgroup_id_x 1
  .amdhsa_float_denorm_mode_32 3
  .amdhsa_float_denorm_mode_16_64 3
.end_amdhsa_kernel
```
